```python
import torch

def _softmax(x, axis=-1):
    return torch.softmax(x, dim=axis)

def _gelu(x):
    return torch.nn.functional.gelu(x, approximate='tanh')

def _silu(x):
    return torch.nn.functional.silu(x)

def _sigmoid(x):
    return torch.sigmoid(x)

def _layernorm(x, axis=-1, eps=1e-05):
    m = x.mean(dim=axis, keepdim=True)
    v = x.var(dim=axis, keepdim=True, unbiased=False)
    return (x - m) / torch.sqrt(v + eps)

def _scatter_add(tgt, idx, src, axis=0):
    return tgt.clone().index_add_(axis, idx, src)

def _segment_sum(src, seg, n):
    out = torch.zeros((n,) + src.shape[1:], dtype=src.dtype)
    return out.index_add_(0, seg, src)

def _pad(x, pw):
    flat = tuple((v for pair in reversed(pw) for v in pair))
    return torch.nn.functional.pad(x, flat)
kernel_name = 'standalone__kv_cache_quant_pre_rope_vs_post_rope__sampling'

def setup_inputs():

    _w = lambda a: (lambda t: t.to(torch.bfloat16) if t.is_floating_point() else t)(torch.as_tensor(a))
    B, Sq, Skv = (8, 1, 2048)
    H, Dh0 = (32, 192)
    G = -1 if -1 > 0 else Dh0
    G = max(2, G // 2 * 2)
    Dh = max(G, Dh0 // G * G)
    Skv = max(Skv, Sq)
    ng = Dh // G
    bits = 4 if 4 > 1 else 4
    bits = max(2, min(8, bits))
    qmax = (1 << bits) - 1
    half = Dh // 2
    inv = 1.0 / 10000.0 ** (torch.arange(half) / max(1, half))
    ang_k = torch.arange(Skv)[:, None] * inv[None, :]
    ang_q = torch.arange(Skv - Sq, Skv)[:, None] * inv[None, :]
    kc = torch.cat([torch.cos(ang_k), torch.cos(ang_k)], dim=-1)
    ks = torch.cat([torch.sin(ang_k), torch.sin(ang_k)], dim=-1)
    qc = torch.cat([torch.cos(ang_q), torch.cos(ang_q)], dim=-1)
    qs = torch.cat([torch.sin(ang_q), torch.sin(ang_q)], dim=-1)
    qk_i = torch.randint(0, qmax + 1, (B, H, Skv, Dh)).to(torch.int32)
    qv_i = torch.randint(0, qmax + 1, (B, H, Skv, Dh)).to(torch.int32)
    ksc = torch.abs((lambda *s: torch.randn(*s, dtype=torch.bfloat16) * 0.2)(B, H, Skv, ng)) * 0.1 + 0.01
    kzp = torch.full((B, H, Skv, ng), qmax / 2.0)
    vsc = torch.abs((lambda *s: torch.randn(*s, dtype=torch.bfloat16) * 0.2)(B, H, Skv, ng)) * 0.1 + 0.01
    vzp = torch.full((B, H, Skv, ng), qmax / 2.0)
    return {'q': _w((lambda *s: torch.randn(*s, dtype=torch.bfloat16) * 6.4)(B, H, Sq, Dh) * 0.5), 'qk': _w(qk_i), 'k_scales': _w(ksc), 'k_zeros': _w(kzp), 'qv': _w(qv_i), 'v_scales': _w(vsc), 'v_zeros': _w(vzp), 'q_cos': _w(qc), 'q_sin': _w(qs), 'k_cos': _w(kc), 'k_sin': _w(ks)}

def reference(q, qk, k_scales, k_zeros, qv, v_scales, v_zeros, q_cos, q_sin, k_cos, k_sin):
    B, H, Sq, Dh = q.shape
    ng = k_scales.shape[-1]
    G = Dh // ng
    half = Dh // 2
    ks = (lambda x, n, axis: torch.repeat_interleave(x, n, dim=axis))(k_scales, G, axis=-1)
    kz = (lambda x, n, axis: torch.repeat_interleave(x, n, dim=axis))(k_zeros, G, axis=-1)
    k = ((lambda x, dt: x.to(dt))(qk, q.dtype) - kz) * ks
    vs = (lambda x, n, axis: torch.repeat_interleave(x, n, dim=axis))(v_scales, G, axis=-1)
    vz = (lambda x, n, axis: torch.repeat_interleave(x, n, dim=axis))(v_zeros, G, axis=-1)
    v = ((lambda x, dt: x.to(dt))(qv, q.dtype) - vz) * vs
    k1 = k[..., :half].clone()
    k2 = k[..., half:].clone()
    krh = torch.concatenate([-k2, k1], axis=-1)
    kr = k * k_cos[None, None, :, :] + krh * k_sin[None, None, :, :]
    q1 = q[..., :half].clone()
    q2 = q[..., half:].clone()
    qrh = torch.concatenate([-q2, q1], axis=-1)
    qr = q * q_cos[None, None, :, :] + qrh * q_sin[None, None, :, :]
    logits = torch.einsum('bhqd,bhkd->bhqk', qr, kr) * float(Dh) ** (-0.5)
    attn = _softmax(logits, axis=-1)
    out = torch.einsum('bhqk,bhkd->bhqd', attn, v)
    return out
```

```asm
; @launch grid=(256,1,1) block=(320,1,1) lds=156160
.amdgcn_target "amdgcn-amd-amdhsa--gfx950"
.text
.globl standalone__kv_cache_quant_pre_rope_vs_post_rope__sampling_kernel
.p2align 12
.type L_pad,@object
L_pad:
.fill 832, 4, 0xbf810000
.p2align 8
.type standalone__kv_cache_quant_pre_rope_vs_post_rope__sampling_kernel,@function
standalone__kv_cache_quant_pre_rope_vs_post_rope__sampling_kernel:
  s_cmpk_ge_u32 s2, 0x100
  s_cbranch_scc1 L_end
  s_load_dwordx16 s[4:19], s[0:1], 0
  s_load_dwordx8 s[20:27], s[0:1], 64
  v_readfirstlane_b32 s40, v0
  s_lshr_b32 s42, s2, 4
  s_cmp_lg_u32 s40, 0
  s_cbranch_scc1 L_s0
  s_setprio 3
  s_getpc_b64 s[64:65]
  s_and_b32 s44, s2, 24
  v_and_b32 v20, 63, v0
  v_lshl_add_u32 v1, v20, 5, s44
  v_lshlrev_b32 v1, 4, v1
  global_load_dword v2, v1, s[64:65] offset:1024
  v_min_u32 v21, 47, v20
  v_add_u32 v22, 24, v21
  v_subrev_u32 v23, 24, v21
  v_min_u32 v27, v22, v23
  s_mul_i32 s44, s42, 48
  v_add_lshl_u32 v22, v21, s44, 3
  v_add_lshl_u32 v23, v27, s44, 3
  v_lshlrev_b32 v26, 3, v21
  s_and_b32 s44, s2, 7
  s_lshr_b32 s45, s2, 3
  s_mul_i32 s68, s44, 96
  s_add_u32 s68, s68, s45
  v_and_b32 v3, 15, v21
  v_lshl_add_u32 v3, s68, 4, v3
  v_and_b32 v4, 48, v21
  v_lshl_add_u32 v3, v4, 5, v3
  v_lshlrev_b32 v3, 6, v3
  s_and_b32 s68, s45, 3
  s_lshl4_add_u32 s44, s68, s44
  s_lshr_b32 s45, s45, 2
  s_lshl_b32 s45, s45, 8
  s_add_u32 s44, s44, s45
  v_and_b32 v4, 7, v20
  v_lshl_add_u32 v4, s44, 3, v4
  v_and_b32 v5, 24, v20
  v_lshl_add_u32 v4, v5, 6, v4
  v_and_b32 v5, 32, v20
  v_lshl_add_u32 v4, v5, 1, v4
  v_lshlrev_b32 v4, 6, v4
  s_waitcnt lgkmcnt(0)
  global_load_dwordx2 v[108:109], v22, s[4:5]
  global_load_dwordx2 v[110:111], v23, s[4:5]
  global_load_dwordx2 v[104:105], v26, s[18:19]
  global_load_dwordx2 v[106:107], v26, s[20:21]
  v_lshlrev_b32 v27, 3, v27
  s_add_u32 s68, s42, 16
  s_mul_i32 s44, s68, 384
  s_add_u32 s32, s4, s44
  s_addc_u32 s33, s5, 0
  global_load_dwordx2 v[68:69], v26, s[32:33]
  global_load_dwordx2 v[70:71], v27, s[32:33]
  global_load_dword v5, v3, s[22:23]
  global_load_dword v6, v3, s[24:25]
  global_load_dword v7, v4, s[8:9]
  global_load_dword v8, v4, s[10:11]
  global_load_dword v9, v4, s[14:15]
  global_load_dword v10, v4, s[16:17]
  v_mov_b32 v15, 0
  v_cmp_gt_u32 vcc, 24, v21
  v_mov_b32 v48, 0
  v_mov_b32 v49, 0
  v_mov_b32 v50, 0
  v_mov_b32 v51, 0
  ds_write_b128 v15, v[48:51] offset:0
  ds_write_b128 v15, v[48:51] offset:16
  s_waitcnt lgkmcnt(0)
  s_barrier
  s_mov_b32 s66, 0xffff0000
  s_mov_b32 s67, 0x3dd53b95
  v_cndmask_b32_e64 v30, 1.0, -1.0, vcc
  v_lshlrev_b32 v35, 4, v21
  v_mov_b32 v28, v35
  v_lshlrev_b32 v29, 1, v27
  v_mov_b32 v22, 0x80008000
  v_cndmask_b32 v31, v15, v22, vcc
  v_mov_b32 v38, 1
  s_mov_b32 s43, 1
  s_waitcnt vmcnt(8)
  v_lshlrev_b32 v52, 16, v104
  v_and_b32 v53, s66, v104
  v_lshlrev_b32 v54, 16, v105
  v_and_b32 v55, s66, v105
  v_lshlrev_b32 v56, 16, v106
  v_and_b32 v57, s66, v106
  v_lshlrev_b32 v58, 16, v107
  v_and_b32 v59, s66, v107
L_hr:
  v_lshlrev_b32 v76, 16, v108
  v_and_b32 v77, s66, v108
  v_lshlrev_b32 v78, 16, v109
  v_and_b32 v79, s66, v109
  v_lshlrev_b32 v80, 16, v110
  v_and_b32 v81, s66, v110
  v_lshlrev_b32 v82, 16, v111
  v_and_b32 v83, s66, v111
  v_mul_f32 v76, v76, v52
  v_mul_f32 v77, v77, v53
  v_mul_f32 v78, v78, v54
  v_mul_f32 v79, v79, v55
  v_mul_f32 v80, v80, v56
  v_mul_f32 v81, v81, v57
  v_mul_f32 v82, v82, v58
  v_mul_f32 v83, v83, v59
  v_cvt_pk_bf16_f32 v84, v76, v80
  v_cvt_pk_bf16_f32 v85, v77, v81
  v_cvt_pk_bf16_f32 v86, v78, v82
  v_cvt_pk_bf16_f32 v87, v79, v83
  v_lshlrev_b32 v76, 16, v84
  v_and_b32 v80, s66, v84
  v_lshlrev_b32 v77, 16, v85
  v_and_b32 v81, s66, v85
  v_lshlrev_b32 v78, 16, v86
  v_and_b32 v82, s66, v86
  v_lshlrev_b32 v79, 16, v87
  v_and_b32 v83, s66, v87
  v_fma_f32 v76, v80, v30, v76
  v_fma_f32 v77, v81, v30, v77
  v_fma_f32 v78, v82, v30, v78
  v_fma_f32 v79, v83, v30, v79
  v_cvt_pk_bf16_f32 v84, v76, v77
  v_cvt_pk_bf16_f32 v85, v78, v79
  v_xor_b32 v86, v31, v84
  v_xor_b32 v87, v31, v85
  v_and_b32 v76, 0xffff, v84
  v_and_b32 v77, s66, v84
  v_and_b32 v78, 0xffff, v85
  v_and_b32 v79, s66, v85
  v_and_b32 v80, 0xffff, v86
  v_and_b32 v81, s66, v86
  v_and_b32 v82, 0xffff, v87
  v_and_b32 v83, s66, v87
  v_mov_b32 v22, s43
  ds_write_b128 v28, v[76:79] offset:512
  ds_write_b128 v29, v[80:83] offset:1280
  ds_write_b32 v15, v22 offset:16
  v_add_u32 v28, 2048, v28
  v_add_u32 v29, 2048, v29
  v_and_b32 v28, 0x1fff, v28
  v_and_b32 v29, 0x1fff, v29
  s_cmp_eq_u32 s43, 2
  s_cbranch_scc1 L_helper
  s_mov_b32 s43, 2
  s_waitcnt vmcnt(6)
  v_mov_b32 v108, v68
  v_mov_b32 v109, v69
  v_mov_b32 v110, v70
  v_mov_b32 v111, v71
  s_branch L_hr
L_s0:
  v_subrev_u32 v0, 64, v0
  s_sub_u32 s40, s40, 64
  s_and_b32 s41, s2, 7
  s_lshl_b32 s41, s41, 1
  s_bitcmp1_b32 s2, 3
  s_addc_u32 s41, s41, 0
  s_lshr_b32 s40, s40, 6
  v_lshrrev_b32 v24, 6, v0
  v_bfe_u32 v25, v0, 4, 2
  v_and_b32 v26, 15, v0
  v_and_b32 v27, 7, v0
  v_lshl_add_u32 v16, v27, 2, v24
  v_lshl_add_u32 v16, v16, 2, v25
  s_and_b32 s44, s41, 1
  v_add_u32 v22, s44, v16
  v_cmp_le_u32 vcc, 43, v22
  s_add_u32 s45, s44, 42
  v_mov_b32 v23, s45
  v_cndmask_b32 v23, 0, v23, vcc
  v_cmp_le_u32 vcc, 86, v22
  v_add_u32 v17, v16, v23
  s_sub_u32 s45, 43, s44
  v_mov_b32 v23, s45
  v_cndmask_b32 v23, 0, v23, vcc
  s_mul_i32 s44, s44, 43
  s_lshr_b32 s45, s41, 1
  s_lshl_b32 s45, s45, 8
  s_add_u32 s44, s44, s45
  v_add3_u32 v17, v17, v23, s44
  s_mul_i32 s101, s40, 24576
  s_add_u32 s101, s101, 57856
  v_cmp_gt_u32 vcc, 8, v26
  v_lshlrev_b32 v50, 4, v27
  v_mov_b32 v51, 0
  s_movk_i32 s100, 384
  v_lshlrev_b32 v22, 4, v26
  s_movk_i32 s45, 768
  v_mov_b32_dpp v3, v17 row_newbcast:0 row_mask:0xf bank_mask:0xf
  v_mov_b32_dpp v4, v17 row_newbcast:1 row_mask:0xf bank_mask:0xf
  v_mov_b32_dpp v5, v17 row_newbcast:2 row_mask:0xf bank_mask:0xf
  v_mov_b32_dpp v6, v17 row_newbcast:3 row_mask:0xf bank_mask:0xf
  v_mov_b32_dpp v7, v17 row_newbcast:4 row_mask:0xf bank_mask:0xf
  v_mov_b32_dpp v8, v17 row_newbcast:5 row_mask:0xf bank_mask:0xf
  v_mov_b32_dpp v9, v17 row_newbcast:6 row_mask:0xf bank_mask:0xf
  v_mov_b32_dpp v10, v17 row_newbcast:7 row_mask:0xf bank_mask:0xf
  v_mad_u32_u24 v3, v3, s45, v22
  v_mad_u32_u24 v4, v4, s45, v22
  v_mad_u32_u24 v5, v5, s45, v22
  v_mad_u32_u24 v6, v6, s45, v22
  v_mad_u32_u24 v7, v7, s45, v22
  v_mad_u32_u24 v8, v8, s45, v22
  v_mad_u32_u24 v9, v9, s45, v22
  v_mad_u32_u24 v10, v10, s45, v22
  s_mul_i32 s44, s42, 1572864
  s_mov_b32 s34, 51904512
  s_mov_b32 s35, 0x20000
  s_mov_b32 s80, 25165824
  s_mov_b32 s3, 50331648
  s_waitcnt lgkmcnt(0)
  s_add_u32 s32, s6, s44
  s_addc_u32 s33, s7, 0
  v_mov_b32 v23, s22
  v_mov_b32 v48, s24
  v_cndmask_b32 v48, v48, v23, vcc
  v_mov_b32 v23, s23
  v_mov_b32 v49, s25
  v_cndmask_b32 v49, v49, v23, vcc
  v_lshl_add_u64 v[48:49], v[50:51], 0, v[48:49]
  v_mov_b32_dpp v16, v17 row_newbcast:0 row_mask:0xf bank_mask:0xf
  s_add_u32 m0, s101, 0
  v_mad_u64_u32 v[50:51], s[64:65], v16, s100, v[48:49]
  global_load_lds_dwordx4 v[50:51], off offset:0
  buffer_load_dwordx4 v[84:87], v3, s[32:35], 0 offen offset:0 nt
  buffer_load_dwordx4 v[88:91], v3, s[32:35], 0 offen offset:256 nt
  s_add_u32 m0, s101, 896
  s_nop 0
  global_load_lds_dwordx4 v[50:51], off offset:128
  buffer_load_dwordx4 v[92:95], v3, s[32:35], 0 offen offset:512 nt
  buffer_load_dwordx4 v[96:99], v3, s[32:35], s80 offen offset:0 nt
  s_add_u32 m0, s101, 1792
  s_nop 0
  global_load_lds_dwordx4 v[50:51], off offset:256
  buffer_load_dwordx4 v[100:103], v3, s[32:35], s80 offen offset:256 nt
  s_barrier
  s_load_dwordx4 s[28:31], s[0:1], 96
  s_getpc_b64 s[82:83]
L_pc1:
  s_lshl_b32 s44, s2, 6
  s_add_u32 s44, s44, L_order-L_pc1
  s_add_u32 s82, s82, s44
  s_addc_u32 s83, s83, 0
  s_load_dwordx2 s[92:93], s[82:83], 0
  s_load_dwordx2 s[96:97], s[82:83], 8
  s_mov_b32 s94, 4000000
  v_mov_b32 v15, 0
  v_mov_b32 v12, v22
  v_lshrrev_b32 v23, 4, v0
  v_lshl_add_u32 v11, v23, 3, v27
  v_and_b32 v23, 8, v0
  v_lshl_add_u32 v11, v23, 8, v11
  v_lshlrev_b32 v11, 2, v11
  v_add_u32 v11, 41472, v11
  v_lshl_add_u32 v23, v25, 2, v22
  v_mad_u32_u24 v13, v24, s45, v23
  v_add_u32 v13, 57856, v13
  v_lshlrev_b32 v29, 2, v24
  v_mov_b32 v18, 0
  v_mov_b32 v42, 0
  s_mov_b32 s48, 0x1010101
  s_mov_b32 s49, s48
  s_mov_b32 s50, 0x2020202
  s_mov_b32 s51, s50
  s_mov_b32 s52, 0x4040404
  s_mov_b32 s53, s52
  s_mov_b32 s54, 0x8080808
  s_mov_b32 s55, s54
  s_mov_b32 s56, 0x10101010
  s_mov_b32 s57, s56
  s_mov_b32 s58, 0x20202020
  s_mov_b32 s59, s58
  s_mov_b32 s60, 0x40404040
  s_mov_b32 s61, s60
  s_mov_b32 s62, 0x80808080
  s_mov_b32 s63, s62
  s_mov_b32 s38, 1572864
  s_mov_b32 s39, 0x20000
  v_lshlrev_b32 v23, 8, v25
  v_add_u32 v23, s101, v23
  v_lshl_add_u32 v39, v26, 3, v23
  v_xor_b32 v40, 192, v39
  v_add_u32 v23, 2048, v40
  v_cndmask_b32 v41, v40, v23, vcc
  v_add_u32 v23, 1024, v40
  v_cndmask_b32 v40, v23, v40, vcc
  s_getreg_b32 s81, hwreg(HW_REG_HW_ID, 13, 2)
  s_getreg_b32 s79, hwreg(HW_REG_HW_ID, 8, 4)
  s_getreg_b32 s46, hwreg(HW_REG_XCC_ID, 0, 3)
  s_mul_i32 s46, s46, 4352
  s_add_u32 s46, s46, 8126464
  s_add_u32 s44, s46, 2048
  v_mov_b32 v34, s44
  s_and_b32 s45, s81, 2
  s_lshl_b32 s45, s45, 9
  s_lshl_b32 s44, s40, 8
  s_add_u32 s44, s44, s45
  s_add_u32 s44, s44, s46
  s_add_u32 s44, s44, s79
  s_and_b32 s81, s81, 1
  s_lshl_b32 s81, s81, 4
  s_add_u32 s44, s44, s81
  v_mov_b32 v30, s44
  s_xor_b32 s45, s45, 1024
  s_add_u32 s46, s46, s45
  v_and_b32 v31, 1, v0
  v_lshl_add_u32 v31, v31, 4, s46
  v_bfe_u32 v23, v0, 1, 2
  v_mad_u32_u24 v23, v23, 4, v24
  v_add_u32 v32, 0, v23
  v_and_b32 v32, 3, v32
  v_lshl_add_u32 v35, v32, 8, v31
  v_add_u32 v32, 1, v23
  v_and_b32 v32, 3, v32
  v_lshl_add_u32 v36, v32, 8, v31
  v_add_u32 v32, 2, v23
  v_and_b32 v32, 3, v32
  v_lshl_add_u32 v37, v32, 8, v31
  v_add_u32 v32, 3, v23
  v_and_b32 v32, 3, v32
  v_lshl_add_u32 v38, v32, 8, v31
  s_mov_b32 s78, 0xfefefeff
  v_mov_b32 v52, 0
  v_mov_b32 v53, 0
  v_mov_b32 v54, 0
  v_mov_b32 v55, 0
  v_mov_b32 v56, 0
  v_mov_b32 v57, 0
  v_mov_b32 v58, 0
  v_mov_b32 v59, 0
  v_mov_b32 v46, 0
  v_mov_b32 v47, 0
  s_mov_b32 s90, 3
  s_mov_b32 s91, 0
  s_mov_b32 s69, 0
  s_mov_b32 s95, 0
  buffer_load_dwordx4 v[104:107], v3, s[32:35], s80 offen offset:512 nt
  v_mov_b32_dpp v16, v17 row_newbcast:1 row_mask:0xf bank_mask:0xf
  s_add_u32 m0, s101, 3072
  v_mad_u64_u32 v[50:51], s[64:65], v16, s100, v[48:49]
  s_waitcnt vmcnt(8)
  global_load_lds_dwordx4 v[50:51], off offset:0
  s_waitcnt vmcnt(8)
  buffer_load_dwordx4 v[108:111], v4, s[32:35], 0 offen offset:0 nt
  s_add_u32 m0, s101, 3968
  s_waitcnt vmcnt(8)
  global_load_lds_dwordx4 v[50:51], off offset:128
  s_waitcnt vmcnt(8)
  buffer_load_dwordx4 v[112:115], v4, s[32:35], 0 offen offset:256 nt
  s_mov_b32 s47, 1
  ds_read_b32 v14, v15 offset:16
L_q0:
  s_waitcnt lgkmcnt(0)
  v_readfirstlane_b32 s46, v14
  s_cmp_ge_u32 s46, s47
  s_cbranch_scc1 L_q0_ok
  s_cmp_eq_u32 s94, 0
  s_cbranch_scc1 L_q0_ok
  s_sub_u32 s94, s94, 1
  ds_read_b32 v14, v15 offset:16
  s_branch L_q0
L_q0_ok:
  ds_read_b128 v[60:63], v12 offset:512
  ds_read_b128 v[72:75], v12 offset:1280
  ds_read_b128 v[64:67], v12 offset:768
  ds_read_b128 v[76:79], v12 offset:1536
  ds_read_b128 v[68:71], v12 offset:1024
  ds_read_b128 v[80:83], v12 offset:1792
  s_add_u32 m0, s101, 4864
  s_waitcnt vmcnt(8)
  global_load_lds_dwordx4 v[50:51], off offset:256
  s_waitcnt vmcnt(7)
  ds_read_b64 v[132:133], v39 offset:0
  ds_read_b64 v[138:139], v40 offset:1024
  ds_read_b64 v[134:135], v39 offset:1024
  ds_read_b64 v[140:141], v41 offset:0
  ds_read_b64 v[136:137], v39 offset:2048
  ds_read_b64 v[142:143], v40 offset:0
  buffer_load_dwordx4 v[116:119], v4, s[32:35], 0 offen offset:512 nt
L_it0:
  s_mov_b32 s47, 2
  ds_read_b32 v14, v15 offset:16
L_q10:
  s_waitcnt lgkmcnt(0)
  v_readfirstlane_b32 s46, v14
  s_cmp_ge_u32 s46, s47
  s_cbranch_scc1 L_q10_ok
  s_cmp_eq_u32 s94, 0
  s_cbranch_scc1 L_q10_ok
  s_sub_u32 s94, s94, 1
  ds_read_b32 v14, v15 offset:16
  s_branch L_q10
L_q10_ok:
  v_dot2_f32_bf16 v24, v132, v60, 0
  v_dot2_f32_bf16 v25, v132, v61, 0
  v_dot2_f32_bf16 v26, v133, v62, 0
  v_dot2_f32_bf16 v27, v133, v63, 0
  v_dot2_f32_bf16 v24, v138, v72, v24
  v_dot2_f32_bf16 v25, v138, v73, v25
  v_dot2_f32_bf16 v26, v139, v74, v26
  v_dot2_f32_bf16 v27, v139, v75, v27
  v_cvt_f32_i32 v84, v84
  v_cvt_f32_i32 v85, v85
  v_cvt_f32_i32 v86, v86
  v_cvt_f32_i32 v87, v87
  ds_read_b128 v[60:63], v12 offset:2560
  ds_read_b128 v[72:75], v12 offset:3328
  v_pk_mul_f32 v[22:23], v[84:85], v[24:25]
  v_pk_add_f32 v[20:21], v[24:25], v[26:27]
  v_pk_fma_f32 v[22:23], v[86:87], v[26:27], v[22:23]
  v_mov_b32_dpp v16, v17 row_newbcast:2 row_mask:0xf bank_mask:0xf
  s_add_u32 m0, s101, 6144
  v_mad_u64_u32 v[50:51], s[64:65], v16, s100, v[48:49]
  global_load_lds_dwordx4 v[50:51], off offset:0
  s_waitcnt vmcnt(8)
  buffer_load_dwordx4 v[120:123], v4, s[32:35], s80 offen offset:0 nt
  v_dot2_f32_bf16 v24, v134, v64, 0
  v_dot2_f32_bf16 v25, v134, v65, 0
  v_dot2_f32_bf16 v26, v135, v66, 0
  v_dot2_f32_bf16 v27, v135, v67, 0
  v_dot2_f32_bf16 v24, v140, v76, v24
  v_dot2_f32_bf16 v25, v140, v77, v25
  v_dot2_f32_bf16 v26, v141, v78, v26
  v_dot2_f32_bf16 v27, v141, v79, v27
  v_cvt_f32_i32 v88, v88
  v_cvt_f32_i32 v89, v89
  v_cvt_f32_i32 v90, v90
  v_cvt_f32_i32 v91, v91
  ds_read_b128 v[64:67], v12 offset:2816
  ds_read_b128 v[76:79], v12 offset:3584
  v_pk_fma_f32 v[22:23], v[88:89], v[24:25], v[22:23]
  v_pk_add_f32 v[20:21], v[20:21], v[24:25]
  v_pk_fma_f32 v[22:23], v[90:91], v[26:27], v[22:23]
  v_pk_add_f32 v[20:21], v[20:21], v[26:27]
  s_waitcnt vmcnt(8)
  buffer_load_dwordx4 v[124:127], v4, s[32:35], s80 offen offset:256 nt
  v_dot2_f32_bf16 v24, v136, v68, 0
  v_dot2_f32_bf16 v25, v136, v69, 0
  v_dot2_f32_bf16 v26, v137, v70, 0
  v_dot2_f32_bf16 v27, v137, v71, 0
  v_dot2_f32_bf16 v24, v142, v80, v24
  v_dot2_f32_bf16 v25, v142, v81, v25
  v_dot2_f32_bf16 v26, v143, v82, v26
  v_dot2_f32_bf16 v27, v143, v83, v27
  v_cvt_f32_i32 v92, v92
  v_cvt_f32_i32 v93, v93
  v_cvt_f32_i32 v94, v94
  v_cvt_f32_i32 v95, v95
  ds_read_b128 v[68:71], v12 offset:3072
  ds_read_b128 v[80:83], v12 offset:3840
  v_pk_fma_f32 v[22:23], v[92:93], v[24:25], v[22:23]
  v_pk_add_f32 v[20:21], v[20:21], v[24:25]
  v_pk_fma_f32 v[22:23], v[94:95], v[26:27], v[22:23]
  v_pk_add_f32 v[20:21], v[20:21], v[26:27]
  v_add_f32 v22, v22, v23
  v_add_f32 v20, v20, v21
  s_add_u32 m0, s101, 7040
  s_waitcnt vmcnt(8)
  global_load_lds_dwordx4 v[50:51], off offset:128
  s_waitcnt vmcnt(8)
  buffer_load_dwordx4 v[128:131], v4, s[32:35], s80 offen offset:512 nt
  s_nop 1
  v_add_f32_dpp v22, v22, v22 row_ror:8 row_mask:0xf bank_mask:0x3
  v_add_f32_dpp v22, v20, v20 row_ror:8 row_mask:0xf bank_mask:0xc
  s_nop 1
  v_add_f32_dpp v22, v22, v22 row_half_mirror row_mask:0xf bank_mask:0xf
  s_nop 1
  v_add_f32_dpp v22, v22, v22 quad_perm:[2,3,0,1] row_mask:0xf bank_mask:0xf
  s_nop 1
  v_add_f32_dpp v22, v22, v22 quad_perm:[1,0,3,2] row_mask:0xf bank_mask:0xf
  v_cndmask_b32_e64 v18, v18, v22, s[48:49]
L_it1:
  s_waitcnt lgkmcnt(0)
  v_dot2_f32_bf16 v24, v132, v60, 0
  v_dot2_f32_bf16 v25, v132, v61, 0
  v_dot2_f32_bf16 v26, v133, v62, 0
  v_dot2_f32_bf16 v27, v133, v63, 0
  v_dot2_f32_bf16 v24, v138, v72, v24
  v_dot2_f32_bf16 v25, v138, v73, v25
  v_dot2_f32_bf16 v26, v139, v74, v26
  v_dot2_f32_bf16 v27, v139, v75, v27
  v_cvt_f32_i32 v96, v96
  v_cvt_f32_i32 v97, v97
  v_cvt_f32_i32 v98, v98
  v_cvt_f32_i32 v99, v99
  ds_read_b128 v[60:63], v12 offset:512
  ds_read_b128 v[72:75], v12 offset:1280
  v_pk_mul_f32 v[22:23], v[96:97], v[24:25]
  v_pk_add_f32 v[20:21], v[24:25], v[26:27]
  v_pk_fma_f32 v[22:23], v[98:99], v[26:27], v[22:23]
  s_waitcnt vmcnt(8)
  buffer_load_dwordx4 v[84:87], v5, s[32:35], 0 offen offset:0 nt
  v_dot2_f32_bf16 v24, v134, v64, 0
  v_dot2_f32_bf16 v25, v134, v65, 0
  v_dot2_f32_bf16 v26, v135, v66, 0
  v_dot2_f32_bf16 v27, v135, v67, 0
  v_dot2_f32_bf16 v24, v140, v76, v24
  v_dot2_f32_bf16 v25, v140, v77, v25
  v_dot2_f32_bf16 v26, v141, v78, v26
  v_dot2_f32_bf16 v27, v141, v79, v27
  v_cvt_f32_i32 v100, v100
  v_cvt_f32_i32 v101, v101
  v_cvt_f32_i32 v102, v102
  v_cvt_f32_i32 v103, v103
  ds_read_b128 v[64:67], v12 offset:768
  ds_read_b128 v[76:79], v12 offset:1536
  v_pk_fma_f32 v[22:23], v[100:101], v[24:25], v[22:23]
  v_pk_add_f32 v[20:21], v[20:21], v[24:25]
  v_pk_fma_f32 v[22:23], v[102:103], v[26:27], v[22:23]
  v_pk_add_f32 v[20:21], v[20:21], v[26:27]
  s_add_u32 m0, s101, 7936
  s_waitcnt vmcnt(8)
  global_load_lds_dwordx4 v[50:51], off offset:256
  s_waitcnt vmcnt(8)
  buffer_load_dwordx4 v[88:91], v5, s[32:35], 0 offen offset:256 nt
  ds_read_b64 v[144:145], v39 offset:3072
  ds_read_b64 v[150:151], v40 offset:4096
  ds_read_b64 v[146:147], v39 offset:4096
  ds_read_b64 v[152:153], v41 offset:3072
  ds_read_b64 v[148:149], v39 offset:5120
  ds_read_b64 v[154:155], v40 offset:3072
  v_dot2_f32_bf16 v24, v136, v68, 0
  v_dot2_f32_bf16 v25, v136, v69, 0
  v_dot2_f32_bf16 v26, v137, v70, 0
  v_dot2_f32_bf16 v27, v137, v71, 0
  v_dot2_f32_bf16 v24, v142, v80, v24
  v_dot2_f32_bf16 v25, v142, v81, v25
  v_dot2_f32_bf16 v26, v143, v82, v26
  v_dot2_f32_bf16 v27, v143, v83, v27
  v_cvt_f32_i32 v104, v104
  v_cvt_f32_i32 v105, v105
  v_cvt_f32_i32 v106, v106
  v_cvt_f32_i32 v107, v107
  ds_read_b128 v[68:71], v12 offset:1024
  ds_read_b128 v[80:83], v12 offset:1792
  v_pk_fma_f32 v[22:23], v[104:105], v[24:25], v[22:23]
  v_pk_add_f32 v[20:21], v[20:21], v[24:25]
  v_pk_fma_f32 v[22:23], v[106:107], v[26:27], v[22:23]
  v_pk_add_f32 v[20:21], v[20:21], v[26:27]
  v_add_f32 v22, v22, v23
  v_add_f32 v20, v20, v21
  s_waitcnt vmcnt(8)
  buffer_load_dwordx4 v[92:95], v5, s[32:35], 0 offen offset:512 nt
  s_nop 1
  v_add_f32_dpp v22, v22, v22 row_ror:8 row_mask:0xf bank_mask:0x3
  v_add_f32_dpp v22, v20, v20 row_ror:8 row_mask:0xf bank_mask:0xc
  s_nop 1
  v_add_f32_dpp v22, v22, v22 row_half_mirror row_mask:0xf bank_mask:0xf
  s_nop 1
  v_add_f32_dpp v22, v22, v22 quad_perm:[2,3,0,1] row_mask:0xf bank_mask:0xf
  s_nop 1
  v_add_f32_dpp v22, v22, v22 quad_perm:[1,0,3,2] row_mask:0xf bank_mask:0xf
  v_cndmask_b32_e64 v42, v42, v22, s[48:49]
L_it2:
  s_waitcnt lgkmcnt(0)
  v_dot2_f32_bf16 v24, v144, v60, 0
  v_dot2_f32_bf16 v25, v144, v61, 0
  v_dot2_f32_bf16 v26, v145, v62, 0
  v_dot2_f32_bf16 v27, v145, v63, 0
  v_dot2_f32_bf16 v24, v150, v72, v24
  v_dot2_f32_bf16 v25, v150, v73, v25
  v_dot2_f32_bf16 v26, v151, v74, v26
  v_dot2_f32_bf16 v27, v151, v75, v27
  v_cvt_f32_i32 v108, v108
  v_cvt_f32_i32 v109, v109
  v_cvt_f32_i32 v110, v110
  v_cvt_f32_i32 v111, v111
  ds_read_b128 v[60:63], v12 offset:2560
  ds_read_b128 v[72:75], v12 offset:3328
  v_pk_mul_f32 v[22:23], v[108:109], v[24:25]
  v_pk_add_f32 v[20:21], v[24:25], v[26:27]
  v_pk_fma_f32 v[22:23], v[110:111], v[26:27], v[22:23]
  v_mov_b32_dpp v16, v17 row_newbcast:3 row_mask:0xf bank_mask:0xf
  s_add_u32 m0, s101, 9216
  v_mad_u64_u32 v[50:51], s[64:65], v16, s100, v[48:49]
  s_waitcnt vmcnt(8)
  global_load_lds_dwordx4 v[50:51], off offset:0
  s_waitcnt vmcnt(8)
  buffer_load_dwordx4 v[96:99], v5, s[32:35], s80 offen offset:0 nt
  v_dot2_f32_bf16 v24, v146, v64, 0
  v_dot2_f32_bf16 v25, v146, v65, 0
  v_dot2_f32_bf16 v26, v147, v66, 0
  v_dot2_f32_bf16 v27, v147, v67, 0
  v_dot2_f32_bf16 v24, v152, v76, v24
  v_dot2_f32_bf16 v25, v152, v77, v25
  v_dot2_f32_bf16 v26, v153, v78, v26
  v_dot2_f32_bf16 v27, v153, v79, v27
  v_cvt_f32_i32 v112, v112
  v_cvt_f32_i32 v113, v113
  v_cvt_f32_i32 v114, v114
  v_cvt_f32_i32 v115, v115
  ds_read_b128 v[64:67], v12 offset:2816
  ds_read_b128 v[76:79], v12 offset:3584
  v_pk_fma_f32 v[22:23], v[112:113], v[24:25], v[22:23]
  v_pk_add_f32 v[20:21], v[20:21], v[24:25]
  v_pk_fma_f32 v[22:23], v[114:115], v[26:27], v[22:23]
  v_pk_add_f32 v[20:21], v[20:21], v[26:27]
  s_waitcnt vmcnt(8)
  buffer_load_dwordx4 v[100:103], v5, s[32:35], s80 offen offset:256 nt
  v_dot2_f32_bf16 v24, v148, v68, 0
  v_dot2_f32_bf16 v25, v148, v69, 0
  v_dot2_f32_bf16 v26, v149, v70, 0
  v_dot2_f32_bf16 v27, v149, v71, 0
  v_dot2_f32_bf16 v24, v154, v80, v24
  v_dot2_f32_bf16 v25, v154, v81, v25
  v_dot2_f32_bf16 v26, v155, v82, v26
  v_dot2_f32_bf16 v27, v155, v83, v27
  v_cvt_f32_i32 v116, v116
  v_cvt_f32_i32 v117, v117
  v_cvt_f32_i32 v118, v118
  v_cvt_f32_i32 v119, v119
  ds_read_b128 v[68:71], v12 offset:3072
  ds_read_b128 v[80:83], v12 offset:3840
  v_pk_fma_f32 v[22:23], v[116:117], v[24:25], v[22:23]
  v_pk_add_f32 v[20:21], v[20:21], v[24:25]
  v_pk_fma_f32 v[22:23], v[118:119], v[26:27], v[22:23]
  v_pk_add_f32 v[20:21], v[20:21], v[26:27]
  v_add_f32 v22, v22, v23
  v_add_f32 v20, v20, v21
  s_add_u32 m0, s101, 10112
  s_waitcnt vmcnt(8)
  global_load_lds_dwordx4 v[50:51], off offset:128
  s_waitcnt vmcnt(8)
  buffer_load_dwordx4 v[104:107], v5, s[32:35], s80 offen offset:512 nt
  s_nop 1
  v_add_f32_dpp v22, v22, v22 row_ror:8 row_mask:0xf bank_mask:0x3
  v_add_f32_dpp v22, v20, v20 row_ror:8 row_mask:0xf bank_mask:0xc
  s_nop 1
  v_add_f32_dpp v22, v22, v22 row_half_mirror row_mask:0xf bank_mask:0xf
  s_nop 1
  v_add_f32_dpp v22, v22, v22 quad_perm:[2,3,0,1] row_mask:0xf bank_mask:0xf
  s_nop 1
  v_add_f32_dpp v22, v22, v22 quad_perm:[1,0,3,2] row_mask:0xf bank_mask:0xf
  v_cndmask_b32_e64 v18, v18, v22, s[50:51]
L_it3:
  s_waitcnt lgkmcnt(0)
  s_mov_b64 exec, 1
  global_load_dwordx2 v[46:47], v34, s[30:31] sc1
  s_mov_b64 exec, -1
  s_add_u32 s44, s78, 0x03030303
  v_msad_u8 v32, s78, v56, 0
  v_msad_u8 v33, s44, v56, 0
  v_msad_u8 v32, s78, v57, v32
  v_msad_u8 v33, s44, v57, v33
  v_msad_u8 v32, s78, v58, v32
  v_msad_u8 v33, s44, v58, v33
  v_sub_u32 v32, v32, v33
  v_mov_b32 v31, s90
  s_add_u32 s78, s78, 0x01010101
  v_readlane_b32 s66, v32, 0
  v_readlane_b32 s67, v32, 1
  s_mov_b64 exec, 1
  global_store_byte v30, v31, s[30:31]
  s_mov_b64 exec, 3
  global_load_dwordx3 v[56:58], v38, s[30:31] sc1
  s_mov_b64 exec, -1
  s_add_u32 s69, s66, s67
  s_add_u32 s44, s69, s95
  s_mov_b32 s95, s69
  s_ashr_i32 s69, s44, 1
  s_add_u32 s69, s69, s91
  s_cmp_lt_u32 s90, 5
  s_cselect_b32 s69, 0, s69
  s_add_u32 s90, s90, 1
  v_dot2_f32_bf16 v24, v144, v60, 0
  v_dot2_f32_bf16 v25, v144, v61, 0
  v_dot2_f32_bf16 v26, v145, v62, 0
  v_dot2_f32_bf16 v27, v145, v63, 0
  v_dot2_f32_bf16 v24, v150, v72, v24
  v_dot2_f32_bf16 v25, v150, v73, v25
  v_dot2_f32_bf16 v26, v151, v74, v26
  v_dot2_f32_bf16 v27, v151, v75, v27
  v_cvt_f32_i32 v120, v120
  v_cvt_f32_i32 v121, v121
  v_cvt_f32_i32 v122, v122
  v_cvt_f32_i32 v123, v123
  ds_read_b128 v[60:63], v12 offset:512
  ds_read_b128 v[72:75], v12 offset:1280
  v_pk_mul_f32 v[22:23], v[120:121], v[24:25]
  v_pk_add_f32 v[20:21], v[24:25], v[26:27]
  v_pk_fma_f32 v[22:23], v[122:123], v[26:27], v[22:23]
  s_cmp_gt_i32 s69, -10
  s_cbranch_scc1 L_p2
  s_waitcnt vmcnt(7)
L_p2:
  s_waitcnt vmcnt(9)
  buffer_load_dwordx4 v[108:111], v6, s[32:35], 0 offen offset:0 nt
  v_dot2_f32_bf16 v24, v146, v64, 0
  v_dot2_f32_bf16 v25, v146, v65, 0
  v_dot2_f32_bf16 v26, v147, v66, 0
  v_dot2_f32_bf16 v27, v147, v67, 0
  v_dot2_f32_bf16 v24, v152, v76, v24
  v_dot2_f32_bf16 v25, v152, v77, v25
  v_dot2_f32_bf16 v26, v153, v78, v26
  v_dot2_f32_bf16 v27, v153, v79, v27
  v_cvt_f32_i32 v124, v124
  v_cvt_f32_i32 v125, v125
  v_cvt_f32_i32 v126, v126
  v_cvt_f32_i32 v127, v127
  ds_read_b128 v[64:67], v12 offset:768
  ds_read_b128 v[76:79], v12 offset:1536
  v_pk_fma_f32 v[22:23], v[124:125], v[24:25], v[22:23]
  v_pk_add_f32 v[20:21], v[20:21], v[24:25]
  v_pk_fma_f32 v[22:23], v[126:127], v[26:27], v[22:23]
  v_pk_add_f32 v[20:21], v[20:21], v[26:27]
  s_add_u32 m0, s101, 11008
  s_nop 0
  global_load_lds_dwordx4 v[50:51], off offset:256
  s_cmp_gt_i32 s69, 4
  s_cbranch_scc1 L_p3
  s_waitcnt vmcnt(9)
L_p3:
  s_waitcnt vmcnt(11)
  buffer_load_dwordx4 v[112:115], v6, s[32:35], 0 offen offset:256 nt
  ds_read_b64 v[156:157], v39 offset:6144
  ds_read_b64 v[162:163], v40 offset:7168
  ds_read_b64 v[158:159], v39 offset:7168
  ds_read_b64 v[164:165], v41 offset:6144
  ds_read_b64 v[160:161], v39 offset:8192
  ds_read_b64 v[166:167], v40 offset:6144
  v_dot2_f32_bf16 v24, v148, v68, 0
  v_dot2_f32_bf16 v25, v148, v69, 0
  v_dot2_f32_bf16 v26, v149, v70, 0
  v_dot2_f32_bf16 v27, v149, v71, 0
  v_dot2_f32_bf16 v24, v154, v80, v24
  v_dot2_f32_bf16 v25, v154, v81, v25
  v_dot2_f32_bf16 v26, v155, v82, v26
  v_dot2_f32_bf16 v27, v155, v83, v27
  v_cvt_f32_i32 v128, v128
  v_cvt_f32_i32 v129, v129
  v_cvt_f32_i32 v130, v130
  v_cvt_f32_i32 v131, v131
  ds_read_b128 v[68:71], v12 offset:1024
  ds_read_b128 v[80:83], v12 offset:1792
  v_pk_fma_f32 v[22:23], v[128:129], v[24:25], v[22:23]
  v_pk_add_f32 v[20:21], v[20:21], v[24:25]
  v_pk_fma_f32 v[22:23], v[130:131], v[26:27], v[22:23]
  v_pk_add_f32 v[20:21], v[20:21], v[26:27]
  v_add_f32 v22, v22, v23
  v_add_f32 v20, v20, v21
  s_cmp_lt_i32 s69, -25
  s_cbranch_scc0 L_t4
  s_waitcnt vmcnt(9)
L_t4:
  s_cmp_gt_i32 s69, 12
  s_cbranch_scc1 L_p5
  s_waitcnt vmcnt(10)
L_p5:
  s_waitcnt vmcnt(12)
  buffer_load_dwordx4 v[116:119], v6, s[32:35], 0 offen offset:512 nt
  s_nop 1
  v_add_f32_dpp v22, v22, v22 row_ror:8 row_mask:0xf bank_mask:0x3
  v_add_f32_dpp v22, v20, v20 row_ror:8 row_mask:0xf bank_mask:0xc
  s_nop 1
  v_add_f32_dpp v22, v22, v22 row_half_mirror row_mask:0xf bank_mask:0xf
  s_nop 1
  v_add_f32_dpp v22, v22, v22 quad_perm:[2,3,0,1] row_mask:0xf bank_mask:0xf
  s_nop 1
  v_add_f32_dpp v22, v22, v22 quad_perm:[1,0,3,2] row_mask:0xf bank_mask:0xf
  v_cndmask_b32_e64 v42, v42, v22, s[50:51]
L_it4:
  s_waitcnt lgkmcnt(0)
  s_add_u32 s44, s78, 0x03030303
  v_msad_u8 v32, s78, v52, 0
  v_msad_u8 v33, s44, v52, 0
  v_msad_u8 v32, s78, v53, v32
  v_msad_u8 v33, s44, v53, v33
  v_msad_u8 v32, s78, v54, v32
  v_msad_u8 v33, s44, v54, v33
  v_sub_u32 v32, v32, v33
  v_mov_b32 v31, s90
  s_add_u32 s78, s78, 0x01010101
  v_readlane_b32 s66, v32, 0
  v_readlane_b32 s67, v32, 1
  s_mov_b64 exec, 1
  global_store_byte v30, v31, s[30:31]
  s_mov_b64 exec, 3
  global_load_dwordx3 v[52:54], v35, s[30:31] sc1
  s_mov_b64 exec, -1
  s_add_u32 s69, s66, s67
  s_add_u32 s44, s69, s95
  s_mov_b32 s95, s69
  s_ashr_i32 s69, s44, 1
  s_add_u32 s69, s69, s91
  s_cmp_lt_u32 s90, 5
  s_cselect_b32 s69, 0, s69
  s_add_u32 s90, s90, 1
  v_dot2_f32_bf16 v24, v156, v60, 0
  v_dot2_f32_bf16 v25, v156, v61, 0
  v_dot2_f32_bf16 v26, v157, v62, 0
  v_dot2_f32_bf16 v27, v157, v63, 0
  v_dot2_f32_bf16 v24, v162, v72, v24
  v_dot2_f32_bf16 v25, v162, v73, v25
  v_dot2_f32_bf16 v26, v163, v74, v26
  v_dot2_f32_bf16 v27, v163, v75, v27
  v_cvt_f32_i32 v84, v84
  v_cvt_f32_i32 v85, v85
  v_cvt_f32_i32 v86, v86
  v_cvt_f32_i32 v87, v87
  ds_read_b128 v[60:63], v12 offset:2560
  ds_read_b128 v[72:75], v12 offset:3328
  v_pk_mul_f32 v[22:23], v[84:85], v[24:25]
  v_pk_add_f32 v[20:21], v[24:25], v[26:27]
  v_pk_fma_f32 v[22:23], v[86:87], v[26:27], v[22:23]
  v_mov_b32_dpp v16, v17 row_newbcast:4 row_mask:0xf bank_mask:0xf
  s_add_u32 m0, s101, 12288
  v_mad_u64_u32 v[50:51], s[64:65], v16, s100, v[48:49]
  global_load_lds_dwordx4 v[50:51], off offset:0
  s_cmp_gt_i32 s69, -10
  s_cbranch_scc1 L_p6
  s_waitcnt vmcnt(7)
L_p6:
  s_waitcnt vmcnt(11)
  buffer_load_dwordx4 v[120:123], v6, s[32:35], s80 offen offset:0 nt
  v_dot2_f32_bf16 v24, v158, v64, 0
  v_dot2_f32_bf16 v25, v158, v65, 0
  v_dot2_f32_bf16 v26, v159, v66, 0
  v_dot2_f32_bf16 v27, v159, v67, 0
  v_dot2_f32_bf16 v24, v164, v76, v24
  v_dot2_f32_bf16 v25, v164, v77, v25
  v_dot2_f32_bf16 v26, v165, v78, v26
  v_dot2_f32_bf16 v27, v165, v79, v27
  v_cvt_f32_i32 v88, v88
  v_cvt_f32_i32 v89, v89
  v_cvt_f32_i32 v90, v90
  v_cvt_f32_i32 v91, v91
  ds_read_b128 v[64:67], v12 offset:2816
  ds_read_b128 v[76:79], v12 offset:3584
  v_pk_fma_f32 v[22:23], v[88:89], v[24:25], v[22:23]
  v_pk_add_f32 v[20:21], v[20:21], v[24:25]
  v_pk_fma_f32 v[22:23], v[90:91], v[26:27], v[22:23]
  v_pk_add_f32 v[20:21], v[20:21], v[26:27]
  s_cmp_gt_i32 s69, 4
  s_cbranch_scc1 L_p7
  s_waitcnt vmcnt(8)
L_p7:
  s_waitcnt vmcnt(12)
  buffer_load_dwordx4 v[124:127], v6, s[32:35], s80 offen offset:256 nt
  v_dot2_f32_bf16 v24, v160, v68, 0
  v_dot2_f32_bf16 v25, v160, v69, 0
  v_dot2_f32_bf16 v26, v161, v70, 0
  v_dot2_f32_bf16 v27, v161, v71, 0
  v_dot2_f32_bf16 v24, v166, v80, v24
  v_dot2_f32_bf16 v25, v166, v81, v25
  v_dot2_f32_bf16 v26, v167, v82, v26
  v_dot2_f32_bf16 v27, v167, v83, v27
  v_cvt_f32_i32 v92, v92
  v_cvt_f32_i32 v93, v93
  v_cvt_f32_i32 v94, v94
  v_cvt_f32_i32 v95, v95
  ds_read_b128 v[68:71], v12 offset:3072
  ds_read_b128 v[80:83], v12 offset:3840
  v_pk_fma_f32 v[22:23], v[92:93], v[24:25], v[22:23]
  v_pk_add_f32 v[20:21], v[20:21], v[24:25]
  v_pk_fma_f32 v[22:23], v[94:95], v[26:27], v[22:23]
  v_pk_add_f32 v[20:21], v[20:21], v[26:27]
  v_add_f32 v22, v22, v23
  v_add_f32 v20, v20, v21
  s_add_u32 m0, s101, 13184
  s_nop 0
  global_load_lds_dwordx4 v[50:51], off offset:128
  s_cmp_lt_i32 s69, -25
  s_cbranch_scc0 L_t8
  s_waitcnt vmcnt(8)
L_t8:
  s_cmp_gt_i32 s69, 12
  s_cbranch_scc1 L_p9
  s_waitcnt vmcnt(10)
L_p9:
  s_waitcnt vmcnt(14)
  buffer_load_dwordx4 v[128:131], v6, s[32:35], s80 offen offset:512 nt
  s_nop 1
  v_add_f32_dpp v22, v22, v22 row_ror:8 row_mask:0xf bank_mask:0x3
  v_add_f32_dpp v22, v20, v20 row_ror:8 row_mask:0xf bank_mask:0xc
  s_nop 1
  v_add_f32_dpp v22, v22, v22 row_half_mirror row_mask:0xf bank_mask:0xf
  s_nop 1
  v_add_f32_dpp v22, v22, v22 quad_perm:[2,3,0,1] row_mask:0xf bank_mask:0xf
  s_nop 1
  v_add_f32_dpp v22, v22, v22 quad_perm:[1,0,3,2] row_mask:0xf bank_mask:0xf
  v_cndmask_b32_e64 v18, v18, v22, s[52:53]
L_it5:
  s_waitcnt lgkmcnt(0)
  s_waitcnt vmcnt(10)
  v_add_u32 v32, v46, v47
  s_nop 0
  v_readfirstlane_b32 s91, v32
  s_add_u32 s44, s78, 0x03030303
  v_msad_u8 v32, s78, v56, 0
  v_msad_u8 v33, s44, v56, 0
  v_msad_u8 v32, s78, v57, v32
  v_msad_u8 v33, s44, v57, v33
  v_msad_u8 v32, s78, v58, v32
  v_msad_u8 v33, s44, v58, v33
  v_sub_u32 v32, v32, v33
  v_mov_b32 v31, s90
  s_add_u32 s78, s78, 0x01010101
  v_readlane_b32 s66, v32, 0
  v_readlane_b32 s67, v32, 1
  s_mov_b64 exec, 1
  global_store_byte v30, v31, s[30:31]
  s_mov_b64 exec, 3
  global_load_dwordx3 v[56:58], v36, s[30:31] sc1
  s_mov_b64 exec, -1
  s_add_u32 s69, s66, s67
  s_add_u32 s44, s69, s95
  s_mov_b32 s95, s69
  s_ashr_i32 s69, s44, 1
  s_add_u32 s69, s69, s91
  s_cmp_lt_u32 s90, 5
  s_cselect_b32 s69, 0, s69
  s_add_u32 s90, s90, 1
  v_dot2_f32_bf16 v24, v156, v60, 0
  v_dot2_f32_bf16 v25, v156, v61, 0
  v_dot2_f32_bf16 v26, v157, v62, 0
  v_dot2_f32_bf16 v27, v157, v63, 0
  v_dot2_f32_bf16 v24, v162, v72, v24
  v_dot2_f32_bf16 v25, v162, v73, v25
  v_dot2_f32_bf16 v26, v163, v74, v26
  v_dot2_f32_bf16 v27, v163, v75, v27
  v_cvt_f32_i32 v96, v96
  v_cvt_f32_i32 v97, v97
  v_cvt_f32_i32 v98, v98
  v_cvt_f32_i32 v99, v99
  ds_read_b128 v[60:63], v12 offset:512
  ds_read_b128 v[72:75], v12 offset:1280
  v_pk_mul_f32 v[22:23], v[96:97], v[24:25]
  v_pk_add_f32 v[20:21], v[24:25], v[26:27]
  v_pk_fma_f32 v[22:23], v[98:99], v[26:27], v[22:23]
  s_cmp_gt_i32 s69, -10
  s_cbranch_scc1 L_p10
  s_waitcnt vmcnt(6)
L_p10:
  s_waitcnt vmcnt(10)
  buffer_load_dwordx4 v[84:87], v7, s[32:35], 0 offen offset:0 nt
  v_dot2_f32_bf16 v24, v158, v64, 0
  v_dot2_f32_bf16 v25, v158, v65, 0
  v_dot2_f32_bf16 v26, v159, v66, 0
  v_dot2_f32_bf16 v27, v159, v67, 0
  v_dot2_f32_bf16 v24, v164, v76, v24
  v_dot2_f32_bf16 v25, v164, v77, v25
  v_dot2_f32_bf16 v26, v165, v78, v26
  v_dot2_f32_bf16 v27, v165, v79, v27
  v_cvt_f32_i32 v100, v100
  v_cvt_f32_i32 v101, v101
  v_cvt_f32_i32 v102, v102
  v_cvt_f32_i32 v103, v103
  ds_read_b128 v[64:67], v12 offset:768
  ds_read_b128 v[76:79], v12 offset:1536
  v_pk_fma_f32 v[22:23], v[100:101], v[24:25], v[22:23]
  v_pk_add_f32 v[20:21], v[20:21], v[24:25]
  v_pk_fma_f32 v[22:23], v[102:103], v[26:27], v[22:23]
  v_pk_add_f32 v[20:21], v[20:21], v[26:27]
  s_add_u32 m0, s101, 14080
  s_nop 0
  global_load_lds_dwordx4 v[50:51], off offset:256
  s_cmp_gt_i32 s69, 4
  s_cbranch_scc1 L_p11
  s_waitcnt vmcnt(8)
L_p11:
  s_waitcnt vmcnt(12)
  buffer_load_dwordx4 v[88:91], v7, s[32:35], 0 offen offset:256 nt
  s_waitcnt vmcnt(12)
  ds_read_b64 v[168:169], v39 offset:9216
  ds_read_b64 v[174:175], v40 offset:10240
  ds_read_b64 v[170:171], v39 offset:10240
  ds_read_b64 v[176:177], v41 offset:9216
  ds_read_b64 v[172:173], v39 offset:11264
  ds_read_b64 v[178:179], v40 offset:9216
  v_dot2_f32_bf16 v24, v160, v68, 0
  v_dot2_f32_bf16 v25, v160, v69, 0
  v_dot2_f32_bf16 v26, v161, v70, 0
  v_dot2_f32_bf16 v27, v161, v71, 0
  v_dot2_f32_bf16 v24, v166, v80, v24
  v_dot2_f32_bf16 v25, v166, v81, v25
  v_dot2_f32_bf16 v26, v167, v82, v26
  v_dot2_f32_bf16 v27, v167, v83, v27
  v_cvt_f32_i32 v104, v104
  v_cvt_f32_i32 v105, v105
  v_cvt_f32_i32 v106, v106
  v_cvt_f32_i32 v107, v107
  ds_read_b128 v[68:71], v12 offset:1024
  ds_read_b128 v[80:83], v12 offset:1792
  v_pk_fma_f32 v[22:23], v[104:105], v[24:25], v[22:23]
  v_pk_add_f32 v[20:21], v[20:21], v[24:25]
  v_pk_fma_f32 v[22:23], v[106:107], v[26:27], v[22:23]
  v_pk_add_f32 v[20:21], v[20:21], v[26:27]
  v_add_f32 v22, v22, v23
  v_add_f32 v20, v20, v21
  s_cmp_lt_i32 s69, -25
  s_cbranch_scc0 L_t12
  s_waitcnt vmcnt(8)
L_t12:
  s_cmp_gt_i32 s69, 12
  s_cbranch_scc1 L_p13
  s_waitcnt vmcnt(9)
L_p13:
  s_waitcnt vmcnt(13)
  buffer_load_dwordx4 v[92:95], v7, s[32:35], 0 offen offset:512 nt
  s_nop 1
  v_add_f32_dpp v22, v22, v22 row_ror:8 row_mask:0xf bank_mask:0x3
  v_add_f32_dpp v22, v20, v20 row_ror:8 row_mask:0xf bank_mask:0xc
  s_nop 1
  v_add_f32_dpp v22, v22, v22 row_half_mirror row_mask:0xf bank_mask:0xf
  s_nop 1
  v_add_f32_dpp v22, v22, v22 quad_perm:[2,3,0,1] row_mask:0xf bank_mask:0xf
  s_nop 1
  v_add_f32_dpp v22, v22, v22 quad_perm:[1,0,3,2] row_mask:0xf bank_mask:0xf
  v_cndmask_b32_e64 v42, v42, v22, s[52:53]
L_it6:
  s_waitcnt lgkmcnt(0)
  s_waitcnt vmcnt(10)
  s_add_u32 s44, s78, 0x03030303
  v_msad_u8 v32, s78, v52, 0
  v_msad_u8 v33, s44, v52, 0
  v_msad_u8 v32, s78, v53, v32
  v_msad_u8 v33, s44, v53, v33
  v_msad_u8 v32, s78, v54, v32
  v_msad_u8 v33, s44, v54, v33
  v_sub_u32 v32, v32, v33
  v_mov_b32 v31, s90
  s_add_u32 s78, s78, 0x01010101
  v_readlane_b32 s66, v32, 0
  v_readlane_b32 s67, v32, 1
  s_mov_b64 exec, 1
  global_store_byte v30, v31, s[30:31]
  s_mov_b64 exec, 3
  global_load_dwordx3 v[52:54], v37, s[30:31] sc1
  s_mov_b64 exec, -1
  s_add_u32 s69, s66, s67
  s_add_u32 s44, s69, s95
  s_mov_b32 s95, s69
  s_ashr_i32 s69, s44, 1
  s_add_u32 s69, s69, s91
  s_cmp_lt_u32 s90, 5
  s_cselect_b32 s69, 0, s69
  s_add_u32 s90, s90, 1
  v_dot2_f32_bf16 v24, v168, v60, 0
  v_dot2_f32_bf16 v25, v168, v61, 0
  v_dot2_f32_bf16 v26, v169, v62, 0
  v_dot2_f32_bf16 v27, v169, v63, 0
  v_dot2_f32_bf16 v24, v174, v72, v24
  v_dot2_f32_bf16 v25, v174, v73, v25
  v_dot2_f32_bf16 v26, v175, v74, v26
  v_dot2_f32_bf16 v27, v175, v75, v27
  v_cvt_f32_i32 v108, v108
  v_cvt_f32_i32 v109, v109
  v_cvt_f32_i32 v110, v110
  v_cvt_f32_i32 v111, v111
  ds_read_b128 v[60:63], v12 offset:2560
  ds_read_b128 v[72:75], v12 offset:3328
  v_pk_mul_f32 v[22:23], v[108:109], v[24:25]
  v_pk_add_f32 v[20:21], v[24:25], v[26:27]
  v_pk_fma_f32 v[22:23], v[110:111], v[26:27], v[22:23]
  v_mov_b32_dpp v16, v17 row_newbcast:5 row_mask:0xf bank_mask:0xf
  s_add_u32 m0, s101, 15360
  v_mad_u64_u32 v[50:51], s[64:65], v16, s100, v[48:49]
  global_load_lds_dwordx4 v[50:51], off offset:0
  s_cmp_gt_i32 s69, -10
  s_cbranch_scc1 L_p14
  s_waitcnt vmcnt(7)
L_p14:
  s_waitcnt vmcnt(10)
  buffer_load_dwordx4 v[96:99], v7, s[32:35], s80 offen offset:0 nt
  v_dot2_f32_bf16 v24, v170, v64, 0
  v_dot2_f32_bf16 v25, v170, v65, 0
  v_dot2_f32_bf16 v26, v171, v66, 0
  v_dot2_f32_bf16 v27, v171, v67, 0
  v_dot2_f32_bf16 v24, v176, v76, v24
  v_dot2_f32_bf16 v25, v176, v77, v25
  v_dot2_f32_bf16 v26, v177, v78, v26
  v_dot2_f32_bf16 v27, v177, v79, v27
  v_cvt_f32_i32 v112, v112
  v_cvt_f32_i32 v113, v113
  v_cvt_f32_i32 v114, v114
  v_cvt_f32_i32 v115, v115
  ds_read_b128 v[64:67], v12 offset:2816
  ds_read_b128 v[76:79], v12 offset:3584
  v_pk_fma_f32 v[22:23], v[112:113], v[24:25], v[22:23]
  v_pk_add_f32 v[20:21], v[20:21], v[24:25]
  v_pk_fma_f32 v[22:23], v[114:115], v[26:27], v[22:23]
  v_pk_add_f32 v[20:21], v[20:21], v[26:27]
  s_cmp_gt_i32 s69, 4
  s_cbranch_scc1 L_p15
  s_waitcnt vmcnt(8)
L_p15:
  s_waitcnt vmcnt(11)
  buffer_load_dwordx4 v[100:103], v7, s[32:35], s80 offen offset:256 nt
  v_dot2_f32_bf16 v24, v172, v68, 0
  v_dot2_f32_bf16 v25, v172, v69, 0
  v_dot2_f32_bf16 v26, v173, v70, 0
  v_dot2_f32_bf16 v27, v173, v71, 0
  v_dot2_f32_bf16 v24, v178, v80, v24
  v_dot2_f32_bf16 v25, v178, v81, v25
  v_dot2_f32_bf16 v26, v179, v82, v26
  v_dot2_f32_bf16 v27, v179, v83, v27
  v_cvt_f32_i32 v116, v116
  v_cvt_f32_i32 v117, v117
  v_cvt_f32_i32 v118, v118
  v_cvt_f32_i32 v119, v119
  ds_read_b128 v[68:71], v12 offset:3072
  ds_read_b128 v[80:83], v12 offset:3840
  v_pk_fma_f32 v[22:23], v[116:117], v[24:25], v[22:23]
  v_pk_add_f32 v[20:21], v[20:21], v[24:25]
  v_pk_fma_f32 v[22:23], v[118:119], v[26:27], v[22:23]
  v_pk_add_f32 v[20:21], v[20:21], v[26:27]
  v_add_f32 v22, v22, v23
  v_add_f32 v20, v20, v21
  s_add_u32 m0, s101, 16256
  s_nop 0
  global_load_lds_dwordx4 v[50:51], off offset:128
  s_cmp_lt_i32 s69, -25
  s_cbranch_scc0 L_t16
  s_waitcnt vmcnt(8)
L_t16:
  s_cmp_gt_i32 s69, 12
  s_cbranch_scc1 L_p17
  s_waitcnt vmcnt(10)
L_p17:
  s_waitcnt vmcnt(13)
  buffer_load_dwordx4 v[104:107], v7, s[32:35], s80 offen offset:512 nt
  s_nop 1
  v_add_f32_dpp v22, v22, v22 row_ror:8 row_mask:0xf bank_mask:0x3
  v_add_f32_dpp v22, v20, v20 row_ror:8 row_mask:0xf bank_mask:0xc
  s_nop 1
  v_add_f32_dpp v22, v22, v22 row_half_mirror row_mask:0xf bank_mask:0xf
  s_nop 1
  v_add_f32_dpp v22, v22, v22 quad_perm:[2,3,0,1] row_mask:0xf bank_mask:0xf
  s_nop 1
  v_add_f32_dpp v22, v22, v22 quad_perm:[1,0,3,2] row_mask:0xf bank_mask:0xf
  v_cndmask_b32_e64 v18, v18, v22, s[54:55]
L_it7:
  s_waitcnt lgkmcnt(0)
  s_waitcnt vmcnt(10)
  s_add_u32 s44, s78, 0x03030303
  v_msad_u8 v32, s78, v56, 0
  v_msad_u8 v33, s44, v56, 0
  v_msad_u8 v32, s78, v57, v32
  v_msad_u8 v33, s44, v57, v33
  v_msad_u8 v32, s78, v58, v32
  v_msad_u8 v33, s44, v58, v33
  v_sub_u32 v32, v32, v33
  v_mov_b32 v31, s90
  s_add_u32 s78, s78, 0x01010101
  v_readlane_b32 s66, v32, 0
  v_readlane_b32 s67, v32, 1
  s_mov_b64 exec, 1
  global_store_byte v30, v31, s[30:31]
  s_mov_b64 exec, 3
  global_load_dwordx3 v[56:58], v38, s[30:31] sc1
  s_mov_b64 exec, -1
  s_add_u32 s69, s66, s67
  s_add_u32 s44, s69, s95
  s_mov_b32 s95, s69
  s_ashr_i32 s69, s44, 1
  s_add_u32 s69, s69, s91
  s_cmp_lt_u32 s90, 5
  s_cselect_b32 s69, 0, s69
  s_add_u32 s90, s90, 1
  v_dot2_f32_bf16 v24, v168, v60, 0
  v_dot2_f32_bf16 v25, v168, v61, 0
  v_dot2_f32_bf16 v26, v169, v62, 0
  v_dot2_f32_bf16 v27, v169, v63, 0
  v_dot2_f32_bf16 v24, v174, v72, v24
  v_dot2_f32_bf16 v25, v174, v73, v25
  v_dot2_f32_bf16 v26, v175, v74, v26
  v_dot2_f32_bf16 v27, v175, v75, v27
  v_cvt_f32_i32 v120, v120
  v_cvt_f32_i32 v121, v121
  v_cvt_f32_i32 v122, v122
  v_cvt_f32_i32 v123, v123
  ds_read_b128 v[60:63], v12 offset:512
  ds_read_b128 v[72:75], v12 offset:1280
  v_pk_mul_f32 v[22:23], v[120:121], v[24:25]
  v_pk_add_f32 v[20:21], v[24:25], v[26:27]
  v_pk_fma_f32 v[22:23], v[122:123], v[26:27], v[22:23]
  s_cmp_gt_i32 s69, -10
  s_cbranch_scc1 L_p18
  s_waitcnt vmcnt(6)
L_p18:
  s_waitcnt vmcnt(10)
  buffer_load_dwordx4 v[108:111], v8, s[32:35], 0 offen offset:0 nt
  v_dot2_f32_bf16 v24, v170, v64, 0
  v_dot2_f32_bf16 v25, v170, v65, 0
  v_dot2_f32_bf16 v26, v171, v66, 0
  v_dot2_f32_bf16 v27, v171, v67, 0
  v_dot2_f32_bf16 v24, v176, v76, v24
  v_dot2_f32_bf16 v25, v176, v77, v25
  v_dot2_f32_bf16 v26, v177, v78, v26
  v_dot2_f32_bf16 v27, v177, v79, v27
  v_cvt_f32_i32 v124, v124
  v_cvt_f32_i32 v125, v125
  v_cvt_f32_i32 v126, v126
  v_cvt_f32_i32 v127, v127
  ds_read_b128 v[64:67], v12 offset:768
  ds_read_b128 v[76:79], v12 offset:1536
  v_pk_fma_f32 v[22:23], v[124:125], v[24:25], v[22:23]
  v_pk_add_f32 v[20:21], v[20:21], v[24:25]
  v_pk_fma_f32 v[22:23], v[126:127], v[26:27], v[22:23]
  v_pk_add_f32 v[20:21], v[20:21], v[26:27]
  s_add_u32 m0, s101, 17152
  s_nop 0
  global_load_lds_dwordx4 v[50:51], off offset:256
  s_cmp_gt_i32 s69, 4
  s_cbranch_scc1 L_p19
  s_waitcnt vmcnt(8)
L_p19:
  s_waitcnt vmcnt(12)
  buffer_load_dwordx4 v[112:115], v8, s[32:35], 0 offen offset:256 nt
  s_waitcnt vmcnt(12)
  ds_read_b64 v[180:181], v39 offset:12288
  ds_read_b64 v[186:187], v40 offset:13312
  ds_read_b64 v[182:183], v39 offset:13312
  ds_read_b64 v[188:189], v41 offset:12288
  ds_read_b64 v[184:185], v39 offset:14336
  ds_read_b64 v[190:191], v40 offset:12288
  v_dot2_f32_bf16 v24, v172, v68, 0
  v_dot2_f32_bf16 v25, v172, v69, 0
  v_dot2_f32_bf16 v26, v173, v70, 0
  v_dot2_f32_bf16 v27, v173, v71, 0
  v_dot2_f32_bf16 v24, v178, v80, v24
  v_dot2_f32_bf16 v25, v178, v81, v25
  v_dot2_f32_bf16 v26, v179, v82, v26
  v_dot2_f32_bf16 v27, v179, v83, v27
  v_cvt_f32_i32 v128, v128
  v_cvt_f32_i32 v129, v129
  v_cvt_f32_i32 v130, v130
  v_cvt_f32_i32 v131, v131
  ds_read_b128 v[68:71], v12 offset:1024
  ds_read_b128 v[80:83], v12 offset:1792
  v_pk_fma_f32 v[22:23], v[128:129], v[24:25], v[22:23]
  v_pk_add_f32 v[20:21], v[20:21], v[24:25]
  v_pk_fma_f32 v[22:23], v[130:131], v[26:27], v[22:23]
  v_pk_add_f32 v[20:21], v[20:21], v[26:27]
  v_add_f32 v22, v22, v23
  v_add_f32 v20, v20, v21
  s_cmp_lt_i32 s69, -25
  s_cbranch_scc0 L_t20
  s_waitcnt vmcnt(8)
L_t20:
  s_cmp_gt_i32 s69, 12
  s_cbranch_scc1 L_p21
  s_waitcnt vmcnt(9)
L_p21:
  s_waitcnt vmcnt(13)
  buffer_load_dwordx4 v[116:119], v8, s[32:35], 0 offen offset:512 nt
  s_nop 1
  v_add_f32_dpp v22, v22, v22 row_ror:8 row_mask:0xf bank_mask:0x3
  v_add_f32_dpp v22, v20, v20 row_ror:8 row_mask:0xf bank_mask:0xc
  s_nop 1
  v_add_f32_dpp v22, v22, v22 row_half_mirror row_mask:0xf bank_mask:0xf
  s_nop 1
  v_add_f32_dpp v22, v22, v22 quad_perm:[2,3,0,1] row_mask:0xf bank_mask:0xf
  s_nop 1
  v_add_f32_dpp v22, v22, v22 quad_perm:[1,0,3,2] row_mask:0xf bank_mask:0xf
  v_cndmask_b32_e64 v42, v42, v22, s[54:55]
  v_mov_b32 v31, 1
  ds_write_b32 v29, v31 offset:0
L_it8:
  s_waitcnt lgkmcnt(0)
  s_waitcnt vmcnt(10)
  s_add_u32 s44, s78, 0x03030303
  v_msad_u8 v32, s78, v52, 0
  v_msad_u8 v33, s44, v52, 0
  v_msad_u8 v32, s78, v53, v32
  v_msad_u8 v33, s44, v53, v33
  v_msad_u8 v32, s78, v54, v32
  v_msad_u8 v33, s44, v54, v33
  v_sub_u32 v32, v32, v33
  v_mov_b32 v31, s90
  s_add_u32 s78, s78, 0x01010101
  v_readlane_b32 s66, v32, 0
  v_readlane_b32 s67, v32, 1
  s_mov_b64 exec, 1
  global_store_byte v30, v31, s[30:31]
  s_mov_b64 exec, 3
  global_load_dwordx3 v[52:54], v35, s[30:31] sc1
  s_mov_b64 exec, -1
  s_add_u32 s69, s66, s67
  s_add_u32 s44, s69, s95
  s_mov_b32 s95, s69
  s_ashr_i32 s69, s44, 1
  s_add_u32 s69, s69, s91
  s_cmp_lt_u32 s90, 5
  s_cselect_b32 s69, 0, s69
  s_add_u32 s90, s90, 1
  v_dot2_f32_bf16 v24, v180, v60, 0
  v_dot2_f32_bf16 v25, v180, v61, 0
  v_dot2_f32_bf16 v26, v181, v62, 0
  v_dot2_f32_bf16 v27, v181, v63, 0
  v_dot2_f32_bf16 v24, v186, v72, v24
  v_dot2_f32_bf16 v25, v186, v73, v25
  v_dot2_f32_bf16 v26, v187, v74, v26
  v_dot2_f32_bf16 v27, v187, v75, v27
  v_cvt_f32_i32 v84, v84
  v_cvt_f32_i32 v85, v85
  v_cvt_f32_i32 v86, v86
  v_cvt_f32_i32 v87, v87
  ds_read_b128 v[60:63], v12 offset:2560
  ds_read_b128 v[72:75], v12 offset:3328
  v_pk_mul_f32 v[22:23], v[84:85], v[24:25]
  v_pk_add_f32 v[20:21], v[24:25], v[26:27]
  v_pk_fma_f32 v[22:23], v[86:87], v[26:27], v[22:23]
  v_mov_b32_dpp v16, v17 row_newbcast:6 row_mask:0xf bank_mask:0xf
  s_add_u32 m0, s101, 18432
  v_mad_u64_u32 v[50:51], s[64:65], v16, s100, v[48:49]
  global_load_lds_dwordx4 v[50:51], off offset:0
  s_cmp_gt_i32 s69, -10
  s_cbranch_scc1 L_p22
  s_waitcnt vmcnt(7)
L_p22:
  s_waitcnt vmcnt(10)
  buffer_load_dwordx4 v[120:123], v8, s[32:35], s80 offen offset:0 nt
  v_dot2_f32_bf16 v24, v182, v64, 0
  v_dot2_f32_bf16 v25, v182, v65, 0
  v_dot2_f32_bf16 v26, v183, v66, 0
  v_dot2_f32_bf16 v27, v183, v67, 0
  v_dot2_f32_bf16 v24, v188, v76, v24
  v_dot2_f32_bf16 v25, v188, v77, v25
  v_dot2_f32_bf16 v26, v189, v78, v26
  v_dot2_f32_bf16 v27, v189, v79, v27
  v_cvt_f32_i32 v88, v88
  v_cvt_f32_i32 v89, v89
  v_cvt_f32_i32 v90, v90
  v_cvt_f32_i32 v91, v91
  ds_read_b128 v[64:67], v12 offset:2816
  ds_read_b128 v[76:79], v12 offset:3584
  v_pk_fma_f32 v[22:23], v[88:89], v[24:25], v[22:23]
  v_pk_add_f32 v[20:21], v[20:21], v[24:25]
  v_pk_fma_f32 v[22:23], v[90:91], v[26:27], v[22:23]
  v_pk_add_f32 v[20:21], v[20:21], v[26:27]
  s_cmp_gt_i32 s69, 4
  s_cbranch_scc1 L_p23
  s_waitcnt vmcnt(8)
L_p23:
  s_waitcnt vmcnt(11)
  buffer_load_dwordx4 v[124:127], v8, s[32:35], s80 offen offset:256 nt
  v_dot2_f32_bf16 v24, v184, v68, 0
  v_dot2_f32_bf16 v25, v184, v69, 0
  v_dot2_f32_bf16 v26, v185, v70, 0
  v_dot2_f32_bf16 v27, v185, v71, 0
  v_dot2_f32_bf16 v24, v190, v80, v24
  v_dot2_f32_bf16 v25, v190, v81, v25
  v_dot2_f32_bf16 v26, v191, v82, v26
  v_dot2_f32_bf16 v27, v191, v83, v27
  v_cvt_f32_i32 v92, v92
  v_cvt_f32_i32 v93, v93
  v_cvt_f32_i32 v94, v94
  v_cvt_f32_i32 v95, v95
  ds_read_b128 v[68:71], v12 offset:3072
  ds_read_b128 v[80:83], v12 offset:3840
  v_pk_fma_f32 v[22:23], v[92:93], v[24:25], v[22:23]
  v_pk_add_f32 v[20:21], v[20:21], v[24:25]
  v_pk_fma_f32 v[22:23], v[94:95], v[26:27], v[22:23]
  v_pk_add_f32 v[20:21], v[20:21], v[26:27]
  v_add_f32 v22, v22, v23
  v_add_f32 v20, v20, v21
  s_add_u32 m0, s101, 19328
  s_nop 0
  global_load_lds_dwordx4 v[50:51], off offset:128
  s_cmp_lt_i32 s69, -25
  s_cbranch_scc0 L_t24
  s_waitcnt vmcnt(8)
L_t24:
  s_cmp_gt_i32 s69, 12
  s_cbranch_scc1 L_p25
  s_waitcnt vmcnt(10)
L_p25:
  s_waitcnt vmcnt(13)
  buffer_load_dwordx4 v[128:131], v8, s[32:35], s80 offen offset:512 nt
  s_nop 1
  v_add_f32_dpp v22, v22, v22 row_ror:8 row_mask:0xf bank_mask:0x3
  v_add_f32_dpp v22, v20, v20 row_ror:8 row_mask:0xf bank_mask:0xc
  s_nop 1
  v_add_f32_dpp v22, v22, v22 row_half_mirror row_mask:0xf bank_mask:0xf
  s_nop 1
  v_add_f32_dpp v22, v22, v22 quad_perm:[2,3,0,1] row_mask:0xf bank_mask:0xf
  s_nop 1
  v_add_f32_dpp v22, v22, v22 quad_perm:[1,0,3,2] row_mask:0xf bank_mask:0xf
  v_cndmask_b32_e64 v18, v18, v22, s[56:57]
L_it9:
  s_waitcnt lgkmcnt(0)
  s_waitcnt vmcnt(10)
  s_add_u32 s44, s78, 0x03030303
  v_msad_u8 v32, s78, v56, 0
  v_msad_u8 v33, s44, v56, 0
  v_msad_u8 v32, s78, v57, v32
  v_msad_u8 v33, s44, v57, v33
  v_msad_u8 v32, s78, v58, v32
  v_msad_u8 v33, s44, v58, v33
  v_sub_u32 v32, v32, v33
  v_mov_b32 v31, s90
  s_add_u32 s78, s78, 0x01010101
  v_readlane_b32 s66, v32, 0
  v_readlane_b32 s67, v32, 1
  s_mov_b64 exec, 1
  global_store_byte v30, v31, s[30:31]
  s_mov_b64 exec, 3
  global_load_dwordx3 v[56:58], v36, s[30:31] sc1
  s_mov_b64 exec, -1
  s_add_u32 s69, s66, s67
  s_add_u32 s44, s69, s95
  s_mov_b32 s95, s69
  s_ashr_i32 s69, s44, 1
  s_add_u32 s69, s69, s91
  s_cmp_lt_u32 s90, 5
  s_cselect_b32 s69, 0, s69
  s_add_u32 s90, s90, 1
  v_dot2_f32_bf16 v24, v180, v60, 0
  v_dot2_f32_bf16 v25, v180, v61, 0
  v_dot2_f32_bf16 v26, v181, v62, 0
  v_dot2_f32_bf16 v27, v181, v63, 0
  v_dot2_f32_bf16 v24, v186, v72, v24
  v_dot2_f32_bf16 v25, v186, v73, v25
  v_dot2_f32_bf16 v26, v187, v74, v26
  v_dot2_f32_bf16 v27, v187, v75, v27
  v_cvt_f32_i32 v96, v96
  v_cvt_f32_i32 v97, v97
  v_cvt_f32_i32 v98, v98
  v_cvt_f32_i32 v99, v99
  ds_read_b128 v[60:63], v12 offset:512
  ds_read_b128 v[72:75], v12 offset:1280
  v_pk_mul_f32 v[22:23], v[96:97], v[24:25]
  v_pk_add_f32 v[20:21], v[24:25], v[26:27]
  v_pk_fma_f32 v[22:23], v[98:99], v[26:27], v[22:23]
  s_cmp_gt_i32 s69, -10
  s_cbranch_scc1 L_p26
  s_waitcnt vmcnt(6)
L_p26:
  s_waitcnt vmcnt(10)
  buffer_load_dwordx4 v[84:87], v9, s[32:35], 0 offen offset:0 nt
  v_dot2_f32_bf16 v24, v182, v64, 0
  v_dot2_f32_bf16 v25, v182, v65, 0
  v_dot2_f32_bf16 v26, v183, v66, 0
  v_dot2_f32_bf16 v27, v183, v67, 0
  v_dot2_f32_bf16 v24, v188, v76, v24
  v_dot2_f32_bf16 v25, v188, v77, v25
  v_dot2_f32_bf16 v26, v189, v78, v26
  v_dot2_f32_bf16 v27, v189, v79, v27
  v_cvt_f32_i32 v100, v100
  v_cvt_f32_i32 v101, v101
  v_cvt_f32_i32 v102, v102
  v_cvt_f32_i32 v103, v103
  ds_read_b128 v[64:67], v12 offset:768
  ds_read_b128 v[76:79], v12 offset:1536
  v_pk_fma_f32 v[22:23], v[100:101], v[24:25], v[22:23]
  v_pk_add_f32 v[20:21], v[20:21], v[24:25]
  v_pk_fma_f32 v[22:23], v[102:103], v[26:27], v[22:23]
  v_pk_add_f32 v[20:21], v[20:21], v[26:27]
  s_add_u32 m0, s101, 20224
  s_nop 0
  global_load_lds_dwordx4 v[50:51], off offset:256
  s_cmp_gt_i32 s69, 4
  s_cbranch_scc1 L_p27
  s_waitcnt vmcnt(8)
L_p27:
  s_waitcnt vmcnt(12)
  buffer_load_dwordx4 v[88:91], v9, s[32:35], 0 offen offset:256 nt
  s_waitcnt vmcnt(12)
  ds_read_b64 v[192:193], v39 offset:15360
  ds_read_b64 v[198:199], v40 offset:16384
  ds_read_b64 v[194:195], v39 offset:16384
  ds_read_b64 v[200:201], v41 offset:15360
  ds_read_b64 v[196:197], v39 offset:17408
  ds_read_b64 v[202:203], v40 offset:15360
  v_dot2_f32_bf16 v24, v184, v68, 0
  v_dot2_f32_bf16 v25, v184, v69, 0
  v_dot2_f32_bf16 v26, v185, v70, 0
  v_dot2_f32_bf16 v27, v185, v71, 0
  v_dot2_f32_bf16 v24, v190, v80, v24
  v_dot2_f32_bf16 v25, v190, v81, v25
  v_dot2_f32_bf16 v26, v191, v82, v26
  v_dot2_f32_bf16 v27, v191, v83, v27
  v_cvt_f32_i32 v104, v104
  v_cvt_f32_i32 v105, v105
  v_cvt_f32_i32 v106, v106
  v_cvt_f32_i32 v107, v107
  ds_read_b128 v[68:71], v12 offset:1024
  ds_read_b128 v[80:83], v12 offset:1792
  v_pk_fma_f32 v[22:23], v[104:105], v[24:25], v[22:23]
  v_pk_add_f32 v[20:21], v[20:21], v[24:25]
  v_pk_fma_f32 v[22:23], v[106:107], v[26:27], v[22:23]
  v_pk_add_f32 v[20:21], v[20:21], v[26:27]
  v_add_f32 v22, v22, v23
  v_add_f32 v20, v20, v21
  s_cmp_lt_i32 s69, -25
  s_cbranch_scc0 L_t28
  s_waitcnt vmcnt(8)
L_t28:
  s_cmp_gt_i32 s69, 12
  s_cbranch_scc1 L_p29
  s_waitcnt vmcnt(9)
L_p29:
  s_waitcnt vmcnt(13)
  buffer_load_dwordx4 v[92:95], v9, s[32:35], 0 offen offset:512 nt
  s_nop 1
  v_add_f32_dpp v22, v22, v22 row_ror:8 row_mask:0xf bank_mask:0x3
  v_add_f32_dpp v22, v20, v20 row_ror:8 row_mask:0xf bank_mask:0xc
  s_nop 1
  v_add_f32_dpp v22, v22, v22 row_half_mirror row_mask:0xf bank_mask:0xf
  s_nop 1
  v_add_f32_dpp v22, v22, v22 quad_perm:[2,3,0,1] row_mask:0xf bank_mask:0xf
  s_nop 1
  v_add_f32_dpp v22, v22, v22 quad_perm:[1,0,3,2] row_mask:0xf bank_mask:0xf
  v_cndmask_b32_e64 v42, v42, v22, s[56:57]
L_it10:
  s_waitcnt lgkmcnt(0)
  s_waitcnt vmcnt(10)
  s_add_u32 s44, s78, 0x03030303
  v_msad_u8 v32, s78, v52, 0
  v_msad_u8 v33, s44, v52, 0
  v_msad_u8 v32, s78, v53, v32
  v_msad_u8 v33, s44, v53, v33
  v_msad_u8 v32, s78, v54, v32
  v_msad_u8 v33, s44, v54, v33
  v_sub_u32 v32, v32, v33
  v_mov_b32 v31, s90
  s_add_u32 s78, s78, 0x01010101
  v_readlane_b32 s66, v32, 0
  v_readlane_b32 s67, v32, 1
  s_mov_b64 exec, 1
  global_store_byte v30, v31, s[30:31]
  s_mov_b64 exec, 3
  global_load_dwordx3 v[52:54], v37, s[30:31] sc1
  s_mov_b64 exec, -1
  s_add_u32 s69, s66, s67
  s_add_u32 s44, s69, s95
  s_mov_b32 s95, s69
  s_ashr_i32 s69, s44, 1
  s_add_u32 s69, s69, s91
  s_cmp_lt_u32 s90, 5
  s_cselect_b32 s69, 0, s69
  s_add_u32 s90, s90, 1
  v_dot2_f32_bf16 v24, v192, v60, 0
  v_dot2_f32_bf16 v25, v192, v61, 0
  v_dot2_f32_bf16 v26, v193, v62, 0
  v_dot2_f32_bf16 v27, v193, v63, 0
  v_dot2_f32_bf16 v24, v198, v72, v24
  v_dot2_f32_bf16 v25, v198, v73, v25
  v_dot2_f32_bf16 v26, v199, v74, v26
  v_dot2_f32_bf16 v27, v199, v75, v27
  v_cvt_f32_i32 v108, v108
  v_cvt_f32_i32 v109, v109
  v_cvt_f32_i32 v110, v110
  v_cvt_f32_i32 v111, v111
  ds_read_b128 v[60:63], v12 offset:2560
  ds_read_b128 v[72:75], v12 offset:3328
  v_pk_mul_f32 v[22:23], v[108:109], v[24:25]
  v_pk_add_f32 v[20:21], v[24:25], v[26:27]
  v_pk_fma_f32 v[22:23], v[110:111], v[26:27], v[22:23]
  v_mov_b32_dpp v16, v17 row_newbcast:7 row_mask:0xf bank_mask:0xf
  s_add_u32 m0, s101, 21504
  v_mad_u64_u32 v[50:51], s[64:65], v16, s100, v[48:49]
  global_load_lds_dwordx4 v[50:51], off offset:0
  s_cmp_gt_i32 s69, -10
  s_cbranch_scc1 L_p30
  s_waitcnt vmcnt(7)
L_p30:
  s_waitcnt vmcnt(10)
  buffer_load_dwordx4 v[96:99], v9, s[32:35], s80 offen offset:0 nt
  v_dot2_f32_bf16 v24, v194, v64, 0
  v_dot2_f32_bf16 v25, v194, v65, 0
  v_dot2_f32_bf16 v26, v195, v66, 0
  v_dot2_f32_bf16 v27, v195, v67, 0
  v_dot2_f32_bf16 v24, v200, v76, v24
  v_dot2_f32_bf16 v25, v200, v77, v25
  v_dot2_f32_bf16 v26, v201, v78, v26
  v_dot2_f32_bf16 v27, v201, v79, v27
  v_cvt_f32_i32 v112, v112
  v_cvt_f32_i32 v113, v113
  v_cvt_f32_i32 v114, v114
  v_cvt_f32_i32 v115, v115
  ds_read_b128 v[64:67], v12 offset:2816
  ds_read_b128 v[76:79], v12 offset:3584
  v_pk_fma_f32 v[22:23], v[112:113], v[24:25], v[22:23]
  v_pk_add_f32 v[20:21], v[20:21], v[24:25]
  v_pk_fma_f32 v[22:23], v[114:115], v[26:27], v[22:23]
  v_pk_add_f32 v[20:21], v[20:21], v[26:27]
  s_cmp_gt_i32 s69, 4
  s_cbranch_scc1 L_p31
  s_waitcnt vmcnt(8)
L_p31:
  s_waitcnt vmcnt(11)
  buffer_load_dwordx4 v[100:103], v9, s[32:35], s80 offen offset:256 nt
  v_dot2_f32_bf16 v24, v196, v68, 0
  v_dot2_f32_bf16 v25, v196, v69, 0
  v_dot2_f32_bf16 v26, v197, v70, 0
  v_dot2_f32_bf16 v27, v197, v71, 0
  v_dot2_f32_bf16 v24, v202, v80, v24
  v_dot2_f32_bf16 v25, v202, v81, v25
  v_dot2_f32_bf16 v26, v203, v82, v26
  v_dot2_f32_bf16 v27, v203, v83, v27
  v_cvt_f32_i32 v116, v116
  v_cvt_f32_i32 v117, v117
  v_cvt_f32_i32 v118, v118
  v_cvt_f32_i32 v119, v119
  ds_read_b128 v[68:71], v12 offset:3072
  ds_read_b128 v[80:83], v12 offset:3840
  v_pk_fma_f32 v[22:23], v[116:117], v[24:25], v[22:23]
  v_pk_add_f32 v[20:21], v[20:21], v[24:25]
  v_pk_fma_f32 v[22:23], v[118:119], v[26:27], v[22:23]
  v_pk_add_f32 v[20:21], v[20:21], v[26:27]
  v_add_f32 v22, v22, v23
  v_add_f32 v20, v20, v21
  s_add_u32 m0, s101, 22400
  s_nop 0
  global_load_lds_dwordx4 v[50:51], off offset:128
  s_cmp_lt_i32 s69, -25
  s_cbranch_scc0 L_t32
  s_waitcnt vmcnt(8)
L_t32:
  s_cmp_gt_i32 s69, 12
  s_cbranch_scc1 L_p33
  s_waitcnt vmcnt(10)
L_p33:
  s_waitcnt vmcnt(13)
  buffer_load_dwordx4 v[104:107], v9, s[32:35], s80 offen offset:512 nt
  s_nop 1
  v_add_f32_dpp v22, v22, v22 row_ror:8 row_mask:0xf bank_mask:0x3
  v_add_f32_dpp v22, v20, v20 row_ror:8 row_mask:0xf bank_mask:0xc
  s_nop 1
  v_add_f32_dpp v22, v22, v22 row_half_mirror row_mask:0xf bank_mask:0xf
  s_nop 1
  v_add_f32_dpp v22, v22, v22 quad_perm:[2,3,0,1] row_mask:0xf bank_mask:0xf
  s_nop 1
  v_add_f32_dpp v22, v22, v22 quad_perm:[1,0,3,2] row_mask:0xf bank_mask:0xf
  v_cndmask_b32_e64 v18, v18, v22, s[58:59]
L_it11:
  s_waitcnt lgkmcnt(0)
  s_mov_b64 exec, 1
  global_load_dwordx2 v[46:47], v34, s[30:31] sc1
  s_mov_b64 exec, -1
  s_waitcnt vmcnt(11)
  s_add_u32 s44, s78, 0x03030303
  v_msad_u8 v32, s78, v56, 0
  v_msad_u8 v33, s44, v56, 0
  v_msad_u8 v32, s78, v57, v32
  v_msad_u8 v33, s44, v57, v33
  v_msad_u8 v32, s78, v58, v32
  v_msad_u8 v33, s44, v58, v33
  v_sub_u32 v32, v32, v33
  v_mov_b32 v31, s90
  s_add_u32 s78, s78, 0x01010101
  v_readlane_b32 s66, v32, 0
  v_readlane_b32 s67, v32, 1
  s_mov_b64 exec, 1
  global_store_byte v30, v31, s[30:31]
  s_mov_b64 exec, 3
  global_load_dwordx3 v[56:58], v38, s[30:31] sc1
  s_mov_b64 exec, -1
  s_add_u32 s69, s66, s67
  s_add_u32 s44, s69, s95
  s_mov_b32 s95, s69
  s_ashr_i32 s69, s44, 1
  s_add_u32 s69, s69, s91
  s_cmp_lt_u32 s90, 5
  s_cselect_b32 s69, 0, s69
  s_add_u32 s90, s90, 1
  v_dot2_f32_bf16 v24, v192, v60, 0
  v_dot2_f32_bf16 v25, v192, v61, 0
  v_dot2_f32_bf16 v26, v193, v62, 0
  v_dot2_f32_bf16 v27, v193, v63, 0
  v_dot2_f32_bf16 v24, v198, v72, v24
  v_dot2_f32_bf16 v25, v198, v73, v25
  v_dot2_f32_bf16 v26, v199, v74, v26
  v_dot2_f32_bf16 v27, v199, v75, v27
  v_cvt_f32_i32 v120, v120
  v_cvt_f32_i32 v121, v121
  v_cvt_f32_i32 v122, v122
  v_cvt_f32_i32 v123, v123
  ds_read_b128 v[60:63], v12 offset:512
  ds_read_b128 v[72:75], v12 offset:1280
  v_pk_mul_f32 v[22:23], v[120:121], v[24:25]
  v_pk_add_f32 v[20:21], v[24:25], v[26:27]
  v_pk_fma_f32 v[22:23], v[122:123], v[26:27], v[22:23]
  s_cmp_gt_i32 s69, -10
  s_cbranch_scc1 L_p34
  s_waitcnt vmcnt(7)
L_p34:
  s_waitcnt vmcnt(11)
  buffer_load_dwordx4 v[108:111], v10, s[32:35], 0 offen offset:0 nt
  v_dot2_f32_bf16 v24, v194, v64, 0
  v_dot2_f32_bf16 v25, v194, v65, 0
  v_dot2_f32_bf16 v26, v195, v66, 0
  v_dot2_f32_bf16 v27, v195, v67, 0
  v_dot2_f32_bf16 v24, v200, v76, v24
  v_dot2_f32_bf16 v25, v200, v77, v25
  v_dot2_f32_bf16 v26, v201, v78, v26
  v_dot2_f32_bf16 v27, v201, v79, v27
  v_cvt_f32_i32 v124, v124
  v_cvt_f32_i32 v125, v125
  v_cvt_f32_i32 v126, v126
  v_cvt_f32_i32 v127, v127
  ds_read_b128 v[64:67], v12 offset:768
  ds_read_b128 v[76:79], v12 offset:1536
  v_pk_fma_f32 v[22:23], v[124:125], v[24:25], v[22:23]
  v_pk_add_f32 v[20:21], v[20:21], v[24:25]
  v_pk_fma_f32 v[22:23], v[126:127], v[26:27], v[22:23]
  v_pk_add_f32 v[20:21], v[20:21], v[26:27]
  s_add_u32 m0, s101, 23296
  s_nop 0
  global_load_lds_dwordx4 v[50:51], off offset:256
  s_cmp_gt_i32 s69, 4
  s_cbranch_scc1 L_p35
  s_waitcnt vmcnt(9)
L_p35:
  s_waitcnt vmcnt(13)
  buffer_load_dwordx4 v[112:115], v10, s[32:35], 0 offen offset:256 nt
  s_waitcnt vmcnt(13)
  ds_read_b64 v[204:205], v39 offset:18432
  ds_read_b64 v[210:211], v40 offset:19456
  ds_read_b64 v[206:207], v39 offset:19456
  ds_read_b64 v[212:213], v41 offset:18432
  ds_read_b64 v[208:209], v39 offset:20480
  ds_read_b64 v[214:215], v40 offset:18432
  v_dot2_f32_bf16 v24, v196, v68, 0
  v_dot2_f32_bf16 v25, v196, v69, 0
  v_dot2_f32_bf16 v26, v197, v70, 0
  v_dot2_f32_bf16 v27, v197, v71, 0
  v_dot2_f32_bf16 v24, v202, v80, v24
  v_dot2_f32_bf16 v25, v202, v81, v25
  v_dot2_f32_bf16 v26, v203, v82, v26
  v_dot2_f32_bf16 v27, v203, v83, v27
  v_cvt_f32_i32 v128, v128
  v_cvt_f32_i32 v129, v129
  v_cvt_f32_i32 v130, v130
  v_cvt_f32_i32 v131, v131
  ds_read_b128 v[68:71], v12 offset:1024
  ds_read_b128 v[80:83], v12 offset:1792
  v_pk_fma_f32 v[22:23], v[128:129], v[24:25], v[22:23]
  v_pk_add_f32 v[20:21], v[20:21], v[24:25]
  v_pk_fma_f32 v[22:23], v[130:131], v[26:27], v[22:23]
  v_pk_add_f32 v[20:21], v[20:21], v[26:27]
  v_add_f32 v22, v22, v23
  v_add_f32 v20, v20, v21
  s_cmp_lt_i32 s69, -25
  s_cbranch_scc0 L_t36
  s_waitcnt vmcnt(9)
L_t36:
  s_cmp_gt_i32 s69, 12
  s_cbranch_scc1 L_p37
  s_waitcnt vmcnt(10)
L_p37:
  s_waitcnt vmcnt(14)
  buffer_load_dwordx4 v[116:119], v10, s[32:35], 0 offen offset:512 nt
  s_nop 1
  v_add_f32_dpp v22, v22, v22 row_ror:8 row_mask:0xf bank_mask:0x3
  v_add_f32_dpp v22, v20, v20 row_ror:8 row_mask:0xf bank_mask:0xc
  s_nop 1
  v_add_f32_dpp v22, v22, v22 row_half_mirror row_mask:0xf bank_mask:0xf
  s_nop 1
  v_add_f32_dpp v22, v22, v22 quad_perm:[2,3,0,1] row_mask:0xf bank_mask:0xf
  s_nop 1
  v_add_f32_dpp v22, v22, v22 quad_perm:[1,0,3,2] row_mask:0xf bank_mask:0xf
  v_cndmask_b32_e64 v42, v42, v22, s[58:59]
L_it12:
  s_waitcnt lgkmcnt(0)
  s_waitcnt vmcnt(11)
  s_add_u32 s44, s78, 0x03030303
  v_msad_u8 v32, s78, v52, 0
  v_msad_u8 v33, s44, v52, 0
  v_msad_u8 v32, s78, v53, v32
  v_msad_u8 v33, s44, v53, v33
  v_msad_u8 v32, s78, v54, v32
  v_msad_u8 v33, s44, v54, v33
  v_sub_u32 v32, v32, v33
  v_mov_b32 v31, s90
  s_add_u32 s78, s78, 0x01010101
  v_readlane_b32 s66, v32, 0
  v_readlane_b32 s67, v32, 1
  s_mov_b64 exec, 1
  global_store_byte v30, v31, s[30:31]
  s_mov_b64 exec, 3
  global_load_dwordx3 v[52:54], v35, s[30:31] sc1
  s_mov_b64 exec, -1
  s_add_u32 s69, s66, s67
  s_add_u32 s44, s69, s95
  s_mov_b32 s95, s69
  s_ashr_i32 s69, s44, 1
  s_add_u32 s69, s69, s91
  s_cmp_lt_u32 s90, 5
  s_cselect_b32 s69, 0, s69
  s_add_u32 s90, s90, 1
  v_dot2_f32_bf16 v24, v204, v60, 0
  v_dot2_f32_bf16 v25, v204, v61, 0
  v_dot2_f32_bf16 v26, v205, v62, 0
  v_dot2_f32_bf16 v27, v205, v63, 0
  v_dot2_f32_bf16 v24, v210, v72, v24
  v_dot2_f32_bf16 v25, v210, v73, v25
  v_dot2_f32_bf16 v26, v211, v74, v26
  v_dot2_f32_bf16 v27, v211, v75, v27
  v_cvt_f32_i32 v84, v84
  v_cvt_f32_i32 v85, v85
  v_cvt_f32_i32 v86, v86
  v_cvt_f32_i32 v87, v87
  ds_read_b128 v[60:63], v12 offset:2560
  ds_read_b128 v[72:75], v12 offset:3328
  v_pk_mul_f32 v[22:23], v[84:85], v[24:25]
  v_pk_add_f32 v[20:21], v[24:25], v[26:27]
  v_pk_fma_f32 v[22:23], v[86:87], v[26:27], v[22:23]
  s_cmp_gt_i32 s69, -10
  s_cbranch_scc1 L_p38
  s_waitcnt vmcnt(6)
L_p38:
  s_waitcnt vmcnt(10)
  buffer_load_dwordx4 v[120:123], v10, s[32:35], s80 offen offset:0 nt
  v_dot2_f32_bf16 v24, v206, v64, 0
  v_dot2_f32_bf16 v25, v206, v65, 0
  v_dot2_f32_bf16 v26, v207, v66, 0
  v_dot2_f32_bf16 v27, v207, v67, 0
  v_dot2_f32_bf16 v24, v212, v76, v24
  v_dot2_f32_bf16 v25, v212, v77, v25
  v_dot2_f32_bf16 v26, v213, v78, v26
  v_dot2_f32_bf16 v27, v213, v79, v27
  v_cvt_f32_i32 v88, v88
  v_cvt_f32_i32 v89, v89
  v_cvt_f32_i32 v90, v90
  v_cvt_f32_i32 v91, v91
  ds_read_b128 v[64:67], v12 offset:2816
  ds_read_b128 v[76:79], v12 offset:3584
  v_pk_fma_f32 v[22:23], v[88:89], v[24:25], v[22:23]
  v_pk_add_f32 v[20:21], v[20:21], v[24:25]
  v_pk_fma_f32 v[22:23], v[90:91], v[26:27], v[22:23]
  v_pk_add_f32 v[20:21], v[20:21], v[26:27]
  s_cmp_gt_i32 s69, 4
  s_cbranch_scc1 L_p39
  s_waitcnt vmcnt(7)
L_p39:
  s_waitcnt vmcnt(11)
  buffer_load_dwordx4 v[124:127], v10, s[32:35], s80 offen offset:256 nt
  v_dot2_f32_bf16 v24, v208, v68, 0
  v_dot2_f32_bf16 v25, v208, v69, 0
  v_dot2_f32_bf16 v26, v209, v70, 0
  v_dot2_f32_bf16 v27, v209, v71, 0
  v_dot2_f32_bf16 v24, v214, v80, v24
  v_dot2_f32_bf16 v25, v214, v81, v25
  v_dot2_f32_bf16 v26, v215, v82, v26
  v_dot2_f32_bf16 v27, v215, v83, v27
  v_cvt_f32_i32 v92, v92
  v_cvt_f32_i32 v93, v93
  v_cvt_f32_i32 v94, v94
  v_cvt_f32_i32 v95, v95
  ds_read_b128 v[68:71], v12 offset:3072
  ds_read_b128 v[80:83], v12 offset:3840
  v_pk_fma_f32 v[22:23], v[92:93], v[24:25], v[22:23]
  v_pk_add_f32 v[20:21], v[20:21], v[24:25]
  v_pk_fma_f32 v[22:23], v[94:95], v[26:27], v[22:23]
  v_pk_add_f32 v[20:21], v[20:21], v[26:27]
  v_add_f32 v22, v22, v23
  v_add_f32 v20, v20, v21
  s_cmp_lt_i32 s69, -25
  s_cbranch_scc0 L_t40
  s_waitcnt vmcnt(6)
L_t40:
  s_cmp_gt_i32 s69, 12
  s_cbranch_scc1 L_p41
  s_waitcnt vmcnt(8)
L_p41:
  s_waitcnt vmcnt(12)
  buffer_load_dwordx4 v[128:131], v10, s[32:35], s80 offen offset:512 nt
  s_nop 1
  v_add_f32_dpp v22, v22, v22 row_ror:8 row_mask:0xf bank_mask:0x3
  v_add_f32_dpp v22, v20, v20 row_ror:8 row_mask:0xf bank_mask:0xc
  s_nop 1
  v_add_f32_dpp v22, v22, v22 row_half_mirror row_mask:0xf bank_mask:0xf
  s_nop 1
  v_add_f32_dpp v22, v22, v22 quad_perm:[2,3,0,1] row_mask:0xf bank_mask:0xf
  s_nop 1
  v_add_f32_dpp v22, v22, v22 quad_perm:[1,0,3,2] row_mask:0xf bank_mask:0xf
  v_cndmask_b32_e64 v18, v18, v22, s[60:61]
L_it13:
  s_waitcnt lgkmcnt(0)
  s_waitcnt vmcnt(8)
  v_add_u32 v32, v46, v47
  s_nop 0
  v_readfirstlane_b32 s91, v32
  s_add_u32 s44, s78, 0x03030303
  v_msad_u8 v32, s78, v56, 0
  v_msad_u8 v33, s44, v56, 0
  v_msad_u8 v32, s78, v57, v32
  v_msad_u8 v33, s44, v57, v33
  v_msad_u8 v32, s78, v58, v32
  v_msad_u8 v33, s44, v58, v33
  v_sub_u32 v32, v32, v33
  v_mov_b32 v31, s90
  s_add_u32 s78, s78, 0x01010101
  v_readlane_b32 s66, v32, 0
  v_readlane_b32 s67, v32, 1
  s_mov_b64 exec, 1
  global_store_byte v30, v31, s[30:31]
  s_mov_b64 exec, 3
  global_load_dwordx3 v[56:58], v36, s[30:31] sc1
  s_mov_b64 exec, -1
  s_add_u32 s69, s66, s67
  s_add_u32 s44, s69, s95
  s_mov_b32 s95, s69
  s_ashr_i32 s69, s44, 1
  s_add_u32 s69, s69, s91
  s_cmp_lt_u32 s90, 5
  s_cselect_b32 s69, 0, s69
  s_add_u32 s90, s90, 1
  v_dot2_f32_bf16 v24, v204, v60, 0
  v_dot2_f32_bf16 v25, v204, v61, 0
  v_dot2_f32_bf16 v26, v205, v62, 0
  v_dot2_f32_bf16 v27, v205, v63, 0
  v_dot2_f32_bf16 v24, v210, v72, v24
  v_dot2_f32_bf16 v25, v210, v73, v25
  v_dot2_f32_bf16 v26, v211, v74, v26
  v_dot2_f32_bf16 v27, v211, v75, v27
  v_cvt_f32_i32 v96, v96
  v_cvt_f32_i32 v97, v97
  v_cvt_f32_i32 v98, v98
  v_cvt_f32_i32 v99, v99
  ds_read_b128 v[60:63], v12 offset:512
  ds_read_b128 v[72:75], v12 offset:1280
  v_pk_mul_f32 v[22:23], v[96:97], v[24:25]
  v_pk_add_f32 v[20:21], v[24:25], v[26:27]
  v_pk_fma_f32 v[22:23], v[98:99], v[26:27], v[22:23]
  s_cmp_gt_i32 s69, -10
  s_cbranch_scc1 L_p42
  s_waitcnt vmcnt(5)
L_p42:
  s_waitcnt vmcnt(8)
  buffer_load_dwordx4 v[84:87], v3, s[32:35], s3 offen offset:0 nt
  v_dot2_f32_bf16 v24, v206, v64, 0
  v_dot2_f32_bf16 v25, v206, v65, 0
  v_dot2_f32_bf16 v26, v207, v66, 0
  v_dot2_f32_bf16 v27, v207, v67, 0
  v_dot2_f32_bf16 v24, v212, v76, v24
  v_dot2_f32_bf16 v25, v212, v77, v25
  v_dot2_f32_bf16 v26, v213, v78, v26
  v_dot2_f32_bf16 v27, v213, v79, v27
  v_cvt_f32_i32 v100, v100
  v_cvt_f32_i32 v101, v101
  v_cvt_f32_i32 v102, v102
  v_cvt_f32_i32 v103, v103
  ds_read_b128 v[64:67], v12 offset:768
  ds_read_b128 v[76:79], v12 offset:1536
  v_pk_fma_f32 v[22:23], v[100:101], v[24:25], v[22:23]
  v_pk_add_f32 v[20:21], v[20:21], v[24:25]
  v_pk_fma_f32 v[22:23], v[102:103], v[26:27], v[22:23]
  v_pk_add_f32 v[20:21], v[20:21], v[26:27]
  s_cmp_gt_i32 s69, 4
  s_cbranch_scc1 L_p43
  s_waitcnt vmcnt(6)
L_p43:
  s_waitcnt vmcnt(9)
  buffer_load_dwordx4 v[88:91], v3, s[32:35], s3 offen offset:256 nt
  s_waitcnt vmcnt(9)
  ds_read_b64 v[216:217], v39 offset:21504
  ds_read_b64 v[222:223], v40 offset:22528
  ds_read_b64 v[218:219], v39 offset:22528
  ds_read_b64 v[224:225], v41 offset:21504
  ds_read_b64 v[220:221], v39 offset:23552
  ds_read_b64 v[226:227], v40 offset:21504
  v_dot2_f32_bf16 v24, v208, v68, 0
  v_dot2_f32_bf16 v25, v208, v69, 0
  v_dot2_f32_bf16 v26, v209, v70, 0
  v_dot2_f32_bf16 v27, v209, v71, 0
  v_dot2_f32_bf16 v24, v214, v80, v24
  v_dot2_f32_bf16 v25, v214, v81, v25
  v_dot2_f32_bf16 v26, v215, v82, v26
  v_dot2_f32_bf16 v27, v215, v83, v27
  v_cvt_f32_i32 v104, v104
  v_cvt_f32_i32 v105, v105
  v_cvt_f32_i32 v106, v106
  v_cvt_f32_i32 v107, v107
  ds_read_b128 v[68:71], v12 offset:1024
  ds_read_b128 v[80:83], v12 offset:1792
  v_pk_fma_f32 v[22:23], v[104:105], v[24:25], v[22:23]
  v_pk_add_f32 v[20:21], v[20:21], v[24:25]
  v_pk_fma_f32 v[22:23], v[106:107], v[26:27], v[22:23]
  v_pk_add_f32 v[20:21], v[20:21], v[26:27]
  v_add_f32 v22, v22, v23
  v_add_f32 v20, v20, v21
  s_cmp_lt_i32 s69, -25
  s_cbranch_scc0 L_t44
  s_waitcnt vmcnt(6)
L_t44:
  s_cmp_gt_i32 s69, 12
  s_cbranch_scc1 L_p45
  s_waitcnt vmcnt(7)
L_p45:
  s_waitcnt vmcnt(10)
  buffer_load_dwordx4 v[92:95], v3, s[32:35], s3 offen offset:512 nt
  s_nop 1
  v_add_f32_dpp v22, v22, v22 row_ror:8 row_mask:0xf bank_mask:0x3
  v_add_f32_dpp v22, v20, v20 row_ror:8 row_mask:0xf bank_mask:0xc
  s_nop 1
  v_add_f32_dpp v22, v22, v22 row_half_mirror row_mask:0xf bank_mask:0xf
  s_nop 1
  v_add_f32_dpp v22, v22, v22 quad_perm:[2,3,0,1] row_mask:0xf bank_mask:0xf
  s_nop 1
  v_add_f32_dpp v22, v22, v22 quad_perm:[1,0,3,2] row_mask:0xf bank_mask:0xf
  v_cndmask_b32_e64 v42, v42, v22, s[60:61]
L_it14:
  s_waitcnt lgkmcnt(0)
  ds_read_b32 v14, v15 offset:16
  s_waitcnt vmcnt(7)
  s_add_u32 s44, s78, 0x03030303
  v_msad_u8 v32, s78, v52, 0
  v_msad_u8 v33, s44, v52, 0
  v_msad_u8 v32, s78, v53, v32
  v_msad_u8 v33, s44, v53, v33
  v_msad_u8 v32, s78, v54, v32
  v_msad_u8 v33, s44, v54, v33
  v_sub_u32 v32, v32, v33
  v_mov_b32 v31, s90
  s_add_u32 s78, s78, 0x01010101
  v_readlane_b32 s66, v32, 0
  v_readlane_b32 s67, v32, 1
  s_mov_b64 exec, 1
  global_store_byte v30, v31, s[30:31]
  s_mov_b64 exec, 3
  global_load_dwordx3 v[52:54], v37, s[30:31] sc1
  s_mov_b64 exec, -1
  s_add_u32 s69, s66, s67
  s_add_u32 s44, s69, s95
  s_mov_b32 s95, s69
  s_ashr_i32 s69, s44, 1
  s_add_u32 s69, s69, s91
  s_cmp_lt_u32 s90, 5
  s_cselect_b32 s69, 0, s69
  s_add_u32 s90, s90, 1
  v_dot2_f32_bf16 v24, v216, v60, 0
  v_dot2_f32_bf16 v25, v216, v61, 0
  v_dot2_f32_bf16 v26, v217, v62, 0
  v_dot2_f32_bf16 v27, v217, v63, 0
  v_dot2_f32_bf16 v24, v222, v72, v24
  v_dot2_f32_bf16 v25, v222, v73, v25
  v_dot2_f32_bf16 v26, v223, v74, v26
  v_dot2_f32_bf16 v27, v223, v75, v27
  v_cvt_f32_i32 v108, v108
  v_cvt_f32_i32 v109, v109
  v_cvt_f32_i32 v110, v110
  v_cvt_f32_i32 v111, v111
  ds_read_b128 v[60:63], v12 offset:2560
  ds_read_b128 v[72:75], v12 offset:3328
  v_pk_mul_f32 v[22:23], v[108:109], v[24:25]
  v_pk_add_f32 v[20:21], v[24:25], v[26:27]
  v_pk_fma_f32 v[22:23], v[110:111], v[26:27], v[22:23]
  s_cmp_gt_i32 s69, -10
  s_cbranch_scc1 L_p46
  s_waitcnt vmcnt(5)
L_p46:
  s_waitcnt vmcnt(8)
  buffer_load_dwordx4 v[96:99], v4, s[32:35], s3 offen offset:0 nt
  v_dot2_f32_bf16 v24, v218, v64, 0
  v_dot2_f32_bf16 v25, v218, v65, 0
  v_dot2_f32_bf16 v26, v219, v66, 0
  v_dot2_f32_bf16 v27, v219, v67, 0
  v_dot2_f32_bf16 v24, v224, v76, v24
  v_dot2_f32_bf16 v25, v224, v77, v25
  v_dot2_f32_bf16 v26, v225, v78, v26
  v_dot2_f32_bf16 v27, v225, v79, v27
  v_cvt_f32_i32 v112, v112
  v_cvt_f32_i32 v113, v113
  v_cvt_f32_i32 v114, v114
  v_cvt_f32_i32 v115, v115
  ds_read_b128 v[64:67], v12 offset:2816
  ds_read_b128 v[76:79], v12 offset:3584
  v_pk_fma_f32 v[22:23], v[112:113], v[24:25], v[22:23]
  v_pk_add_f32 v[20:21], v[20:21], v[24:25]
  v_pk_fma_f32 v[22:23], v[114:115], v[26:27], v[22:23]
  v_pk_add_f32 v[20:21], v[20:21], v[26:27]
  s_cmp_gt_i32 s69, 4
  s_cbranch_scc1 L_p47
  s_waitcnt vmcnt(6)
L_p47:
  s_waitcnt vmcnt(9)
  buffer_load_dwordx4 v[100:103], v4, s[32:35], s3 offen offset:256 nt
  v_dot2_f32_bf16 v24, v220, v68, 0
  v_dot2_f32_bf16 v25, v220, v69, 0
  v_dot2_f32_bf16 v26, v221, v70, 0
  v_dot2_f32_bf16 v27, v221, v71, 0
  v_dot2_f32_bf16 v24, v226, v80, v24
  v_dot2_f32_bf16 v25, v226, v81, v25
  v_dot2_f32_bf16 v26, v227, v82, v26
  v_dot2_f32_bf16 v27, v227, v83, v27
  v_cvt_f32_i32 v116, v116
  v_cvt_f32_i32 v117, v117
  v_cvt_f32_i32 v118, v118
  v_cvt_f32_i32 v119, v119
  ds_read_b128 v[68:71], v12 offset:3072
  ds_read_b128 v[80:83], v12 offset:3840
  v_pk_fma_f32 v[22:23], v[116:117], v[24:25], v[22:23]
  v_pk_add_f32 v[20:21], v[20:21], v[24:25]
  v_pk_fma_f32 v[22:23], v[118:119], v[26:27], v[22:23]
  v_pk_add_f32 v[20:21], v[20:21], v[26:27]
  v_add_f32 v22, v22, v23
  v_add_f32 v20, v20, v21
  s_cmp_lt_i32 s69, -25
  s_cbranch_scc0 L_t48
  s_waitcnt vmcnt(6)
L_t48:
  s_cmp_gt_i32 s69, 12
  s_cbranch_scc1 L_p49
  s_waitcnt vmcnt(7)
L_p49:
  s_waitcnt vmcnt(10)
  buffer_load_dwordx4 v[104:107], v4, s[32:35], s3 offen offset:512 nt
  s_nop 1
  v_add_f32_dpp v22, v22, v22 row_ror:8 row_mask:0xf bank_mask:0x3
  v_add_f32_dpp v22, v20, v20 row_ror:8 row_mask:0xf bank_mask:0xc
  s_nop 1
  v_add_f32_dpp v22, v22, v22 row_half_mirror row_mask:0xf bank_mask:0xf
  s_nop 1
  v_add_f32_dpp v22, v22, v22 quad_perm:[2,3,0,1] row_mask:0xf bank_mask:0xf
  s_nop 1
  v_add_f32_dpp v22, v22, v22 quad_perm:[1,0,3,2] row_mask:0xf bank_mask:0xf
  v_cndmask_b32_e64 v18, v18, v22, s[62:63]
L_it15:
  s_mov_b32 s47, 3
L_q115:
  s_waitcnt lgkmcnt(0)
  v_readfirstlane_b32 s46, v14
  s_cmp_ge_u32 s46, s47
  s_cbranch_scc1 L_q115_ok
  s_cmp_eq_u32 s94, 0
  s_cbranch_scc1 L_q115_ok
  s_sub_u32 s94, s94, 1
  ds_read_b32 v14, v15 offset:16
  s_branch L_q115
L_q115_ok:
  s_waitcnt vmcnt(7)
  s_add_u32 s44, s78, 0x03030303
  v_msad_u8 v32, s78, v56, 0
  v_msad_u8 v33, s44, v56, 0
  v_msad_u8 v32, s78, v57, v32
  v_msad_u8 v33, s44, v57, v33
  v_msad_u8 v32, s78, v58, v32
  v_msad_u8 v33, s44, v58, v33
  v_sub_u32 v32, v32, v33
  v_mov_b32 v31, s90
  s_add_u32 s78, s78, 0x01010101
  v_readlane_b32 s66, v32, 0
  v_readlane_b32 s67, v32, 1
  s_mov_b64 exec, 1
  global_store_byte v30, v31, s[30:31]
  s_mov_b64 exec, 3
  global_load_dwordx3 v[56:58], v38, s[30:31] sc1
  s_mov_b64 exec, -1
  s_add_u32 s69, s66, s67
  s_add_u32 s44, s69, s95
  s_mov_b32 s95, s69
  s_ashr_i32 s69, s44, 1
  s_add_u32 s69, s69, s91
  s_cmp_lt_u32 s90, 5
  s_cselect_b32 s69, 0, s69
  s_add_u32 s90, s90, 1
  v_dot2_f32_bf16 v24, v216, v60, 0
  v_dot2_f32_bf16 v25, v216, v61, 0
  v_dot2_f32_bf16 v26, v217, v62, 0
  v_dot2_f32_bf16 v27, v217, v63, 0
  v_dot2_f32_bf16 v24, v222, v72, v24
  v_dot2_f32_bf16 v25, v222, v73, v25
  v_dot2_f32_bf16 v26, v223, v74, v26
  v_dot2_f32_bf16 v27, v223, v75, v27
  v_cvt_f32_i32 v120, v120
  v_cvt_f32_i32 v121, v121
  v_cvt_f32_i32 v122, v122
  v_cvt_f32_i32 v123, v123
  ds_read_b128 v[60:63], v12 offset:4608
  ds_read_b128 v[72:75], v12 offset:5376
  v_pk_mul_f32 v[22:23], v[120:121], v[24:25]
  v_pk_add_f32 v[20:21], v[24:25], v[26:27]
  v_pk_fma_f32 v[22:23], v[122:123], v[26:27], v[22:23]
  s_cmp_gt_i32 s69, -10
  s_cbranch_scc1 L_p50
  s_waitcnt vmcnt(5)
L_p50:
  s_waitcnt vmcnt(8)
  buffer_load_dwordx4 v[108:111], v5, s[32:35], s3 offen offset:0 nt
  v_dot2_f32_bf16 v24, v218, v64, 0
  v_dot2_f32_bf16 v25, v218, v65, 0
  v_dot2_f32_bf16 v26, v219, v66, 0
  v_dot2_f32_bf16 v27, v219, v67, 0
  v_dot2_f32_bf16 v24, v224, v76, v24
  v_dot2_f32_bf16 v25, v224, v77, v25
  v_dot2_f32_bf16 v26, v225, v78, v26
  v_dot2_f32_bf16 v27, v225, v79, v27
  v_cvt_f32_i32 v124, v124
  v_cvt_f32_i32 v125, v125
  v_cvt_f32_i32 v126, v126
  v_cvt_f32_i32 v127, v127
  ds_read_b128 v[64:67], v12 offset:4864
  ds_read_b128 v[76:79], v12 offset:5632
  v_pk_fma_f32 v[22:23], v[124:125], v[24:25], v[22:23]
  v_pk_add_f32 v[20:21], v[20:21], v[24:25]
  v_pk_fma_f32 v[22:23], v[126:127], v[26:27], v[22:23]
  v_pk_add_f32 v[20:21], v[20:21], v[26:27]
  s_cmp_gt_i32 s69, 4
  s_cbranch_scc1 L_p51
  s_waitcnt vmcnt(6)
L_p51:
  s_waitcnt vmcnt(9)
  buffer_load_dwordx4 v[112:115], v5, s[32:35], s3 offen offset:256 nt
  v_dot2_f32_bf16 v24, v220, v68, 0
  v_dot2_f32_bf16 v25, v220, v69, 0
  v_dot2_f32_bf16 v26, v221, v70, 0
  v_dot2_f32_bf16 v27, v221, v71, 0
  v_dot2_f32_bf16 v24, v226, v80, v24
  v_dot2_f32_bf16 v25, v226, v81, v25
  v_dot2_f32_bf16 v26, v227, v82, v26
  v_dot2_f32_bf16 v27, v227, v83, v27
  v_cvt_f32_i32 v128, v128
  v_cvt_f32_i32 v129, v129
  v_cvt_f32_i32 v130, v130
  v_cvt_f32_i32 v131, v131
  ds_read_b128 v[68:71], v12 offset:5120
  ds_read_b128 v[80:83], v12 offset:5888
  v_pk_fma_f32 v[22:23], v[128:129], v[24:25], v[22:23]
  v_pk_add_f32 v[20:21], v[20:21], v[24:25]
  v_pk_fma_f32 v[22:23], v[130:131], v[26:27], v[22:23]
  v_pk_add_f32 v[20:21], v[20:21], v[26:27]
  v_add_f32 v22, v22, v23
  v_add_f32 v20, v20, v21
  s_cmp_lt_i32 s69, -25
  s_cbranch_scc0 L_t52
  s_waitcnt vmcnt(6)
L_t52:
  s_cmp_gt_i32 s69, 12
  s_cbranch_scc1 L_p53
  s_waitcnt vmcnt(7)
L_p53:
  s_waitcnt vmcnt(10)
  buffer_load_dwordx4 v[116:119], v5, s[32:35], s3 offen offset:512 nt
  s_nop 1
  v_add_f32_dpp v22, v22, v22 row_ror:8 row_mask:0xf bank_mask:0x3
  v_add_f32_dpp v22, v20, v20 row_ror:8 row_mask:0xf bank_mask:0xc
  s_nop 1
  v_add_f32_dpp v22, v22, v22 row_half_mirror row_mask:0xf bank_mask:0xf
  s_nop 1
  v_add_f32_dpp v22, v22, v22 quad_perm:[2,3,0,1] row_mask:0xf bank_mask:0xf
  s_nop 1
  v_add_f32_dpp v22, v22, v22 quad_perm:[1,0,3,2] row_mask:0xf bank_mask:0xf
  v_cndmask_b32_e64 v42, v42, v22, s[62:63]
  v_mov_b32 v31, 2
  ds_write_b32 v11, v18 offset:0
  ds_write_b32 v11, v42 offset:512
  ds_write_b32 v29, v31 offset:0
  v_add_u32 v11, 1024, v11
  v_add_u32 v12, 4096, v12
  s_mov_b32 s43, 2
  s_mov_b32 s34, 1572864
  s_add_u32 s32, s32, s3
  s_addc_u32 s33, s33, 0
  s_mov_b32 s68, 3
  s_lshl_b32 s44, s68, 2
  s_lshr_b64 s[64:65], s[96:97], s44
  s_and_b32 s64, s64, 15
  s_lshl4_add_u32 s68, s68, s64
  s_mul_i32 s44, s68, 1572864
  s_add_u32 s36, s6, s44
  s_addc_u32 s37, s7, 0
.p2align 6
L_k:
  s_add_u32 s44, s43, 2
  s_min_u32 s47, s44, 16
  v_add_u32 v12, 2048, v12
  v_and_b32 v12, 0x1fff, v12
  s_waitcnt lgkmcnt(0)
  s_waitcnt vmcnt(8)
  s_add_u32 s44, s78, 0x03030303
  v_msad_u8 v32, s78, v52, 0
  v_msad_u8 v33, s44, v52, 0
  v_msad_u8 v32, s78, v53, v32
  v_msad_u8 v33, s44, v53, v33
  v_msad_u8 v32, s78, v54, v32
  v_msad_u8 v33, s44, v54, v33
  v_sub_u32 v32, v32, v33
  v_mov_b32 v31, s90
  s_add_u32 s78, s78, 0x01010101
  v_readlane_b32 s66, v32, 0
  v_readlane_b32 s67, v32, 1
  s_mov_b64 exec, 1
  global_store_byte v30, v31, s[30:31]
  s_mov_b64 exec, 3
  global_load_dwordx3 v[52:54], v35, s[30:31] sc1
  s_mov_b64 exec, -1
  s_add_u32 s69, s66, s67
  s_add_u32 s44, s69, s95
  s_mov_b32 s95, s69
  s_ashr_i32 s69, s44, 1
  s_add_u32 s69, s69, s91
  s_cmp_lt_u32 s90, 5
  s_cselect_b32 s69, 0, s69
  s_add_u32 s90, s90, 1
  v_dot2_f32_bf16 v24, v132, v60, 0
  v_dot2_f32_bf16 v25, v132, v61, 0
  v_dot2_f32_bf16 v26, v133, v62, 0
  v_dot2_f32_bf16 v27, v133, v63, 0
  v_dot2_f32_bf16 v24, v138, v72, v24
  v_dot2_f32_bf16 v25, v138, v73, v25
  v_dot2_f32_bf16 v26, v139, v74, v26
  v_dot2_f32_bf16 v27, v139, v75, v27
  v_cvt_f32_i32 v84, v84
  v_cvt_f32_i32 v85, v85
  v_cvt_f32_i32 v86, v86
  v_cvt_f32_i32 v87, v87
  v_pk_mul_f32 v[22:23], v[84:85], v[24:25]
  v_pk_add_f32 v[20:21], v[24:25], v[26:27]
  v_pk_fma_f32 v[22:23], v[86:87], v[26:27], v[22:23]
  s_cmp_gt_i32 s69, -10
  s_cbranch_scc1 L_p54
  s_waitcnt vmcnt(5)
L_p54:
  s_waitcnt vmcnt(8)
  buffer_load_dwordx4 v[120:123], v6, s[32:35], 0 offen offset:0 nt
  v_dot2_f32_bf16 v24, v134, v64, 0
  v_dot2_f32_bf16 v25, v134, v65, 0
  v_dot2_f32_bf16 v26, v135, v66, 0
  v_dot2_f32_bf16 v27, v135, v67, 0
  v_dot2_f32_bf16 v24, v140, v76, v24
  v_dot2_f32_bf16 v25, v140, v77, v25
  v_dot2_f32_bf16 v26, v141, v78, v26
  v_dot2_f32_bf16 v27, v141, v79, v27
  v_cvt_f32_i32 v88, v88
  v_cvt_f32_i32 v89, v89
  v_cvt_f32_i32 v90, v90
  v_cvt_f32_i32 v91, v91
  v_pk_fma_f32 v[22:23], v[88:89], v[24:25], v[22:23]
  v_pk_add_f32 v[20:21], v[20:21], v[24:25]
  v_pk_fma_f32 v[22:23], v[90:91], v[26:27], v[22:23]
  v_pk_add_f32 v[20:21], v[20:21], v[26:27]
  s_cmp_gt_i32 s69, 4
  s_cbranch_scc1 L_p55
  s_waitcnt vmcnt(6)
L_p55:
  s_waitcnt vmcnt(9)
  buffer_load_dwordx4 v[124:127], v6, s[32:35], 0 offen offset:256 nt
  v_dot2_f32_bf16 v24, v136, v68, 0
  v_dot2_f32_bf16 v25, v136, v69, 0
  v_dot2_f32_bf16 v26, v137, v70, 0
  v_dot2_f32_bf16 v27, v137, v71, 0
  v_dot2_f32_bf16 v24, v142, v80, v24
  v_dot2_f32_bf16 v25, v142, v81, v25
  v_dot2_f32_bf16 v26, v143, v82, v26
  v_dot2_f32_bf16 v27, v143, v83, v27
  v_cvt_f32_i32 v92, v92
  v_cvt_f32_i32 v93, v93
  v_cvt_f32_i32 v94, v94
  v_cvt_f32_i32 v95, v95
  v_pk_fma_f32 v[22:23], v[92:93], v[24:25], v[22:23]
  v_pk_add_f32 v[20:21], v[20:21], v[24:25]
  v_pk_fma_f32 v[22:23], v[94:95], v[26:27], v[22:23]
  v_pk_add_f32 v[20:21], v[20:21], v[26:27]
  v_add_f32 v22, v22, v23
  v_add_f32 v20, v20, v21
  s_cmp_lt_i32 s69, -25
  s_cbranch_scc0 L_t56
  s_waitcnt vmcnt(6)
L_t56:
  s_cmp_gt_i32 s69, 12
  s_cbranch_scc1 L_p57
  s_waitcnt vmcnt(7)
L_p57:
  s_waitcnt vmcnt(10)
  buffer_load_dwordx4 v[128:131], v6, s[32:35], 0 offen offset:512 nt
  v_add_f32_dpp v22, v22, v22 row_ror:8 row_mask:0xf bank_mask:0x3
  v_add_f32_dpp v22, v20, v20 row_ror:8 row_mask:0xf bank_mask:0xc
  s_nop 1
  v_add_f32_dpp v22, v22, v22 row_half_mirror row_mask:0xf bank_mask:0xf
  s_nop 1
  v_add_f32_dpp v22, v22, v22 quad_perm:[2,3,0,1] row_mask:0xf bank_mask:0xf
  s_nop 1
  v_add_f32_dpp v22, v22, v22 quad_perm:[1,0,3,2] row_mask:0xf bank_mask:0xf
  v_cndmask_b32_e64 v18, v18, v22, s[48:49]
  s_waitcnt vmcnt(8)
  s_add_u32 s44, s78, 0x03030303
  v_msad_u8 v32, s78, v56, 0
  v_msad_u8 v33, s44, v56, 0
  v_msad_u8 v32, s78, v57, v32
  v_msad_u8 v33, s44, v57, v33
  v_msad_u8 v32, s78, v58, v32
  v_msad_u8 v33, s44, v58, v33
  v_sub_u32 v32, v32, v33
  v_mov_b32 v31, s90
  s_add_u32 s78, s78, 0x01010101
  v_readlane_b32 s66, v32, 0
  v_readlane_b32 s67, v32, 1
  s_mov_b64 exec, 1
  global_store_byte v30, v31, s[30:31]
  s_mov_b64 exec, 3
  global_load_dwordx3 v[56:58], v36, s[30:31] sc1
  s_mov_b64 exec, -1
  s_add_u32 s69, s66, s67
  s_add_u32 s44, s69, s95
  s_mov_b32 s95, s69
  s_ashr_i32 s69, s44, 1
  s_add_u32 s69, s69, s91
  s_cmp_lt_u32 s90, 5
  s_cselect_b32 s69, 0, s69
  s_add_u32 s90, s90, 1
  v_dot2_f32_bf16 v24, v144, v60, 0
  v_dot2_f32_bf16 v25, v144, v61, 0
  v_dot2_f32_bf16 v26, v145, v62, 0
  v_dot2_f32_bf16 v27, v145, v63, 0
  v_dot2_f32_bf16 v24, v150, v72, v24
  v_dot2_f32_bf16 v25, v150, v73, v25
  v_dot2_f32_bf16 v26, v151, v74, v26
  v_dot2_f32_bf16 v27, v151, v75, v27
  v_cvt_f32_i32 v96, v96
  v_cvt_f32_i32 v97, v97
  v_cvt_f32_i32 v98, v98
  v_cvt_f32_i32 v99, v99
  v_pk_mul_f32 v[22:23], v[96:97], v[24:25]
  v_pk_add_f32 v[20:21], v[24:25], v[26:27]
  v_pk_fma_f32 v[22:23], v[98:99], v[26:27], v[22:23]
  s_cmp_gt_i32 s69, -10
  s_cbranch_scc1 L_p58
  s_waitcnt vmcnt(5)
L_p58:
  s_waitcnt vmcnt(8)
  buffer_load_dwordx4 v[84:87], v7, s[32:35], 0 offen offset:0 nt
  v_dot2_f32_bf16 v24, v146, v64, 0
  v_dot2_f32_bf16 v25, v146, v65, 0
  v_dot2_f32_bf16 v26, v147, v66, 0
  v_dot2_f32_bf16 v27, v147, v67, 0
  v_dot2_f32_bf16 v24, v152, v76, v24
  v_dot2_f32_bf16 v25, v152, v77, v25
  v_dot2_f32_bf16 v26, v153, v78, v26
  v_dot2_f32_bf16 v27, v153, v79, v27
  v_cvt_f32_i32 v100, v100
  v_cvt_f32_i32 v101, v101
  v_cvt_f32_i32 v102, v102
  v_cvt_f32_i32 v103, v103
  v_pk_fma_f32 v[22:23], v[100:101], v[24:25], v[22:23]
  v_pk_add_f32 v[20:21], v[20:21], v[24:25]
  v_pk_fma_f32 v[22:23], v[102:103], v[26:27], v[22:23]
  v_pk_add_f32 v[20:21], v[20:21], v[26:27]
  s_cmp_gt_i32 s69, 4
  s_cbranch_scc1 L_p59
  s_waitcnt vmcnt(6)
L_p59:
  s_waitcnt vmcnt(9)
  buffer_load_dwordx4 v[88:91], v7, s[32:35], 0 offen offset:256 nt
  v_dot2_f32_bf16 v24, v148, v68, 0
  v_dot2_f32_bf16 v25, v148, v69, 0
  v_dot2_f32_bf16 v26, v149, v70, 0
  v_dot2_f32_bf16 v27, v149, v71, 0
  v_dot2_f32_bf16 v24, v154, v80, v24
  v_dot2_f32_bf16 v25, v154, v81, v25
  v_dot2_f32_bf16 v26, v155, v82, v26
  v_dot2_f32_bf16 v27, v155, v83, v27
  v_cvt_f32_i32 v104, v104
  v_cvt_f32_i32 v105, v105
  v_cvt_f32_i32 v106, v106
  v_cvt_f32_i32 v107, v107
  v_pk_fma_f32 v[22:23], v[104:105], v[24:25], v[22:23]
  v_pk_add_f32 v[20:21], v[20:21], v[24:25]
  v_pk_fma_f32 v[22:23], v[106:107], v[26:27], v[22:23]
  v_pk_add_f32 v[20:21], v[20:21], v[26:27]
  v_add_f32 v22, v22, v23
  v_add_f32 v20, v20, v21
  s_cmp_lt_i32 s69, -25
  s_cbranch_scc0 L_t60
  s_waitcnt vmcnt(6)
L_t60:
  s_cmp_gt_i32 s69, 12
  s_cbranch_scc1 L_p61
  s_waitcnt vmcnt(7)
L_p61:
  s_waitcnt vmcnt(10)
  buffer_load_dwordx4 v[92:95], v7, s[32:35], 0 offen offset:512 nt
  v_add_f32_dpp v22, v22, v22 row_ror:8 row_mask:0xf bank_mask:0x3
  v_add_f32_dpp v22, v20, v20 row_ror:8 row_mask:0xf bank_mask:0xc
  s_nop 1
  v_add_f32_dpp v22, v22, v22 row_half_mirror row_mask:0xf bank_mask:0xf
  s_nop 1
  v_add_f32_dpp v22, v22, v22 quad_perm:[2,3,0,1] row_mask:0xf bank_mask:0xf
  s_nop 1
  v_add_f32_dpp v22, v22, v22 quad_perm:[1,0,3,2] row_mask:0xf bank_mask:0xf
  v_cndmask_b32_e64 v18, v18, v22, s[50:51]
  s_waitcnt vmcnt(8)
  s_add_u32 s44, s78, 0x03030303
  v_msad_u8 v32, s78, v52, 0
  v_msad_u8 v33, s44, v52, 0
  v_msad_u8 v32, s78, v53, v32
  v_msad_u8 v33, s44, v53, v33
  v_msad_u8 v32, s78, v54, v32
  v_msad_u8 v33, s44, v54, v33
  v_sub_u32 v32, v32, v33
  v_mov_b32 v31, s90
  s_add_u32 s78, s78, 0x01010101
  v_readlane_b32 s66, v32, 0
  v_readlane_b32 s67, v32, 1
  s_mov_b64 exec, 1
  global_store_byte v30, v31, s[30:31]
  s_mov_b64 exec, 3
  global_load_dwordx3 v[52:54], v37, s[30:31] sc1
  s_mov_b64 exec, -1
  s_add_u32 s69, s66, s67
  s_add_u32 s44, s69, s95
  s_mov_b32 s95, s69
  s_ashr_i32 s69, s44, 1
  s_add_u32 s69, s69, s91
  s_cmp_lt_u32 s90, 5
  s_cselect_b32 s69, 0, s69
  s_add_u32 s90, s90, 1
  v_dot2_f32_bf16 v24, v156, v60, 0
  v_dot2_f32_bf16 v25, v156, v61, 0
  v_dot2_f32_bf16 v26, v157, v62, 0
  v_dot2_f32_bf16 v27, v157, v63, 0
  v_dot2_f32_bf16 v24, v162, v72, v24
  v_dot2_f32_bf16 v25, v162, v73, v25
  v_dot2_f32_bf16 v26, v163, v74, v26
  v_dot2_f32_bf16 v27, v163, v75, v27
  v_cvt_f32_i32 v108, v108
  v_cvt_f32_i32 v109, v109
  v_cvt_f32_i32 v110, v110
  v_cvt_f32_i32 v111, v111
  v_pk_mul_f32 v[22:23], v[108:109], v[24:25]
  v_pk_add_f32 v[20:21], v[24:25], v[26:27]
  v_pk_fma_f32 v[22:23], v[110:111], v[26:27], v[22:23]
  s_cmp_gt_i32 s69, -10
  s_cbranch_scc1 L_p62
  s_waitcnt vmcnt(5)
L_p62:
  s_waitcnt vmcnt(8)
  buffer_load_dwordx4 v[96:99], v8, s[32:35], 0 offen offset:0 nt
  v_dot2_f32_bf16 v24, v158, v64, 0
  v_dot2_f32_bf16 v25, v158, v65, 0
  v_dot2_f32_bf16 v26, v159, v66, 0
  v_dot2_f32_bf16 v27, v159, v67, 0
  v_dot2_f32_bf16 v24, v164, v76, v24
  v_dot2_f32_bf16 v25, v164, v77, v25
  v_dot2_f32_bf16 v26, v165, v78, v26
  v_dot2_f32_bf16 v27, v165, v79, v27
  v_cvt_f32_i32 v112, v112
  v_cvt_f32_i32 v113, v113
  v_cvt_f32_i32 v114, v114
  v_cvt_f32_i32 v115, v115
  v_pk_fma_f32 v[22:23], v[112:113], v[24:25], v[22:23]
  v_pk_add_f32 v[20:21], v[20:21], v[24:25]
  v_pk_fma_f32 v[22:23], v[114:115], v[26:27], v[22:23]
  v_pk_add_f32 v[20:21], v[20:21], v[26:27]
  s_cmp_gt_i32 s69, 4
  s_cbranch_scc1 L_p63
  s_waitcnt vmcnt(6)
L_p63:
  s_waitcnt vmcnt(9)
  buffer_load_dwordx4 v[100:103], v8, s[32:35], 0 offen offset:256 nt
  v_dot2_f32_bf16 v24, v160, v68, 0
  v_dot2_f32_bf16 v25, v160, v69, 0
  v_dot2_f32_bf16 v26, v161, v70, 0
  v_dot2_f32_bf16 v27, v161, v71, 0
  v_dot2_f32_bf16 v24, v166, v80, v24
  v_dot2_f32_bf16 v25, v166, v81, v25
  v_dot2_f32_bf16 v26, v167, v82, v26
  v_dot2_f32_bf16 v27, v167, v83, v27
  v_cvt_f32_i32 v116, v116
  v_cvt_f32_i32 v117, v117
  v_cvt_f32_i32 v118, v118
  v_cvt_f32_i32 v119, v119
  v_pk_fma_f32 v[22:23], v[116:117], v[24:25], v[22:23]
  v_pk_add_f32 v[20:21], v[20:21], v[24:25]
  v_pk_fma_f32 v[22:23], v[118:119], v[26:27], v[22:23]
  v_pk_add_f32 v[20:21], v[20:21], v[26:27]
  v_add_f32 v22, v22, v23
  v_add_f32 v20, v20, v21
  s_cmp_lt_i32 s69, -25
  s_cbranch_scc0 L_t64
  s_waitcnt vmcnt(6)
L_t64:
  s_cmp_gt_i32 s69, 12
  s_cbranch_scc1 L_p65
  s_waitcnt vmcnt(7)
L_p65:
  s_waitcnt vmcnt(10)
  buffer_load_dwordx4 v[104:107], v8, s[32:35], 0 offen offset:512 nt
  v_add_f32_dpp v22, v22, v22 row_ror:8 row_mask:0xf bank_mask:0x3
  v_add_f32_dpp v22, v20, v20 row_ror:8 row_mask:0xf bank_mask:0xc
  s_nop 1
  v_add_f32_dpp v22, v22, v22 row_half_mirror row_mask:0xf bank_mask:0xf
  s_nop 1
  v_add_f32_dpp v22, v22, v22 quad_perm:[2,3,0,1] row_mask:0xf bank_mask:0xf
  s_nop 1
  v_add_f32_dpp v22, v22, v22 quad_perm:[1,0,3,2] row_mask:0xf bank_mask:0xf
  v_cndmask_b32_e64 v18, v18, v22, s[52:53]
  s_mov_b64 exec, 1
  global_load_dwordx2 v[46:47], v34, s[30:31] sc1
  s_mov_b64 exec, -1
  s_waitcnt vmcnt(9)
  s_add_u32 s44, s78, 0x03030303
  v_msad_u8 v32, s78, v56, 0
  v_msad_u8 v33, s44, v56, 0
  v_msad_u8 v32, s78, v57, v32
  v_msad_u8 v33, s44, v57, v33
  v_msad_u8 v32, s78, v58, v32
  v_msad_u8 v33, s44, v58, v33
  v_sub_u32 v32, v32, v33
  v_mov_b32 v31, s90
  s_add_u32 s78, s78, 0x01010101
  v_readlane_b32 s66, v32, 0
  v_readlane_b32 s67, v32, 1
  s_mov_b64 exec, 1
  global_store_byte v30, v31, s[30:31]
  s_mov_b64 exec, 3
  global_load_dwordx3 v[56:58], v38, s[30:31] sc1
  s_mov_b64 exec, -1
  s_add_u32 s69, s66, s67
  s_add_u32 s44, s69, s95
  s_mov_b32 s95, s69
  s_ashr_i32 s69, s44, 1
  s_add_u32 s69, s69, s91
  s_cmp_lt_u32 s90, 5
  s_cselect_b32 s69, 0, s69
  s_add_u32 s90, s90, 1
  v_dot2_f32_bf16 v24, v168, v60, 0
  v_dot2_f32_bf16 v25, v168, v61, 0
  v_dot2_f32_bf16 v26, v169, v62, 0
  v_dot2_f32_bf16 v27, v169, v63, 0
  v_dot2_f32_bf16 v24, v174, v72, v24
  v_dot2_f32_bf16 v25, v174, v73, v25
  v_dot2_f32_bf16 v26, v175, v74, v26
  v_dot2_f32_bf16 v27, v175, v75, v27
  v_cvt_f32_i32 v120, v120
  v_cvt_f32_i32 v121, v121
  v_cvt_f32_i32 v122, v122
  v_cvt_f32_i32 v123, v123
  v_pk_mul_f32 v[22:23], v[120:121], v[24:25]
  v_pk_add_f32 v[20:21], v[24:25], v[26:27]
  v_pk_fma_f32 v[22:23], v[122:123], v[26:27], v[22:23]
  s_cmp_gt_i32 s69, -10
  s_cbranch_scc1 L_p66
  s_waitcnt vmcnt(6)
L_p66:
  s_waitcnt vmcnt(9)
  buffer_load_dwordx4 v[108:111], v9, s[32:35], 0 offen offset:0 nt
  v_dot2_f32_bf16 v24, v170, v64, 0
  v_dot2_f32_bf16 v25, v170, v65, 0
  v_dot2_f32_bf16 v26, v171, v66, 0
  v_dot2_f32_bf16 v27, v171, v67, 0
  v_dot2_f32_bf16 v24, v176, v76, v24
  v_dot2_f32_bf16 v25, v176, v77, v25
  v_dot2_f32_bf16 v26, v177, v78, v26
  v_dot2_f32_bf16 v27, v177, v79, v27
  v_cvt_f32_i32 v124, v124
  v_cvt_f32_i32 v125, v125
  v_cvt_f32_i32 v126, v126
  v_cvt_f32_i32 v127, v127
  v_pk_fma_f32 v[22:23], v[124:125], v[24:25], v[22:23]
  v_pk_add_f32 v[20:21], v[20:21], v[24:25]
  v_pk_fma_f32 v[22:23], v[126:127], v[26:27], v[22:23]
  v_pk_add_f32 v[20:21], v[20:21], v[26:27]
  s_cmp_gt_i32 s69, 4
  s_cbranch_scc1 L_p67
  s_waitcnt vmcnt(7)
L_p67:
  s_waitcnt vmcnt(10)
  buffer_load_dwordx4 v[112:115], v9, s[32:35], 0 offen offset:256 nt
  v_dot2_f32_bf16 v24, v172, v68, 0
  v_dot2_f32_bf16 v25, v172, v69, 0
  v_dot2_f32_bf16 v26, v173, v70, 0
  v_dot2_f32_bf16 v27, v173, v71, 0
  v_dot2_f32_bf16 v24, v178, v80, v24
  v_dot2_f32_bf16 v25, v178, v81, v25
  v_dot2_f32_bf16 v26, v179, v82, v26
  v_dot2_f32_bf16 v27, v179, v83, v27
  v_cvt_f32_i32 v128, v128
  v_cvt_f32_i32 v129, v129
  v_cvt_f32_i32 v130, v130
  v_cvt_f32_i32 v131, v131
  v_pk_fma_f32 v[22:23], v[128:129], v[24:25], v[22:23]
  v_pk_add_f32 v[20:21], v[20:21], v[24:25]
  v_pk_fma_f32 v[22:23], v[130:131], v[26:27], v[22:23]
  v_pk_add_f32 v[20:21], v[20:21], v[26:27]
  v_add_f32 v22, v22, v23
  v_add_f32 v20, v20, v21
  s_cmp_lt_i32 s69, -25
  s_cbranch_scc0 L_t68
  s_waitcnt vmcnt(7)
L_t68:
  s_cmp_gt_i32 s69, 12
  s_cbranch_scc1 L_p69
  s_waitcnt vmcnt(8)
L_p69:
  s_waitcnt vmcnt(11)
  buffer_load_dwordx4 v[116:119], v9, s[32:35], 0 offen offset:512 nt
  v_add_f32_dpp v22, v22, v22 row_ror:8 row_mask:0xf bank_mask:0x3
  v_add_f32_dpp v22, v20, v20 row_ror:8 row_mask:0xf bank_mask:0xc
  s_nop 1
  v_add_f32_dpp v22, v22, v22 row_half_mirror row_mask:0xf bank_mask:0xf
  s_nop 1
  v_add_f32_dpp v22, v22, v22 quad_perm:[2,3,0,1] row_mask:0xf bank_mask:0xf
  s_nop 1
  v_add_f32_dpp v22, v22, v22 quad_perm:[1,0,3,2] row_mask:0xf bank_mask:0xf
  v_cndmask_b32_e64 v18, v18, v22, s[54:55]
  s_waitcnt vmcnt(9)
  s_add_u32 s44, s78, 0x03030303
  v_msad_u8 v32, s78, v52, 0
  v_msad_u8 v33, s44, v52, 0
  v_msad_u8 v32, s78, v53, v32
  v_msad_u8 v33, s44, v53, v33
  v_msad_u8 v32, s78, v54, v32
  v_msad_u8 v33, s44, v54, v33
  v_sub_u32 v32, v32, v33
  v_mov_b32 v31, s90
  s_add_u32 s78, s78, 0x01010101
  v_readlane_b32 s66, v32, 0
  v_readlane_b32 s67, v32, 1
  s_mov_b64 exec, 1
  global_store_byte v30, v31, s[30:31]
  s_mov_b64 exec, 3
  global_load_dwordx3 v[52:54], v35, s[30:31] sc1
  s_mov_b64 exec, -1
  s_add_u32 s69, s66, s67
  s_add_u32 s44, s69, s95
  s_mov_b32 s95, s69
  s_ashr_i32 s69, s44, 1
  s_add_u32 s69, s69, s91
  s_cmp_lt_u32 s90, 5
  s_cselect_b32 s69, 0, s69
  s_add_u32 s90, s90, 1
  v_dot2_f32_bf16 v24, v180, v60, 0
  v_dot2_f32_bf16 v25, v180, v61, 0
  v_dot2_f32_bf16 v26, v181, v62, 0
  v_dot2_f32_bf16 v27, v181, v63, 0
  v_dot2_f32_bf16 v24, v186, v72, v24
  v_dot2_f32_bf16 v25, v186, v73, v25
  v_dot2_f32_bf16 v26, v187, v74, v26
  v_dot2_f32_bf16 v27, v187, v75, v27
  v_cvt_f32_i32 v84, v84
  v_cvt_f32_i32 v85, v85
  v_cvt_f32_i32 v86, v86
  v_cvt_f32_i32 v87, v87
  v_pk_mul_f32 v[22:23], v[84:85], v[24:25]
  v_pk_add_f32 v[20:21], v[24:25], v[26:27]
  v_pk_fma_f32 v[22:23], v[86:87], v[26:27], v[22:23]
  s_cmp_gt_i32 s69, -10
  s_cbranch_scc1 L_p70
  s_waitcnt vmcnt(5)
L_p70:
  s_waitcnt vmcnt(9)
  buffer_load_dwordx4 v[120:123], v10, s[32:35], 0 offen offset:0 nt
  v_dot2_f32_bf16 v24, v182, v64, 0
  v_dot2_f32_bf16 v25, v182, v65, 0
  v_dot2_f32_bf16 v26, v183, v66, 0
  v_dot2_f32_bf16 v27, v183, v67, 0
  v_dot2_f32_bf16 v24, v188, v76, v24
  v_dot2_f32_bf16 v25, v188, v77, v25
  v_dot2_f32_bf16 v26, v189, v78, v26
  v_dot2_f32_bf16 v27, v189, v79, v27
  v_cvt_f32_i32 v88, v88
  v_cvt_f32_i32 v89, v89
  v_cvt_f32_i32 v90, v90
  v_cvt_f32_i32 v91, v91
  v_pk_fma_f32 v[22:23], v[88:89], v[24:25], v[22:23]
  v_pk_add_f32 v[20:21], v[20:21], v[24:25]
  v_pk_fma_f32 v[22:23], v[90:91], v[26:27], v[22:23]
  v_pk_add_f32 v[20:21], v[20:21], v[26:27]
  s_cmp_gt_i32 s69, 4
  s_cbranch_scc1 L_p71
  s_waitcnt vmcnt(6)
L_p71:
  s_waitcnt vmcnt(10)
  buffer_load_dwordx4 v[124:127], v10, s[32:35], 0 offen offset:256 nt
  v_dot2_f32_bf16 v24, v184, v68, 0
  v_dot2_f32_bf16 v25, v184, v69, 0
  v_dot2_f32_bf16 v26, v185, v70, 0
  v_dot2_f32_bf16 v27, v185, v71, 0
  v_dot2_f32_bf16 v24, v190, v80, v24
  v_dot2_f32_bf16 v25, v190, v81, v25
  v_dot2_f32_bf16 v26, v191, v82, v26
  v_dot2_f32_bf16 v27, v191, v83, v27
  v_cvt_f32_i32 v92, v92
  v_cvt_f32_i32 v93, v93
  v_cvt_f32_i32 v94, v94
  v_cvt_f32_i32 v95, v95
  v_pk_fma_f32 v[22:23], v[92:93], v[24:25], v[22:23]
  v_pk_add_f32 v[20:21], v[20:21], v[24:25]
  v_pk_fma_f32 v[22:23], v[94:95], v[26:27], v[22:23]
  v_pk_add_f32 v[20:21], v[20:21], v[26:27]
  v_add_f32 v22, v22, v23
  v_add_f32 v20, v20, v21
  s_cmp_lt_i32 s69, -25
  s_cbranch_scc0 L_t72
  s_waitcnt vmcnt(6)
L_t72:
  s_cmp_gt_i32 s69, 12
  s_cbranch_scc1 L_p73
  s_waitcnt vmcnt(7)
L_p73:
  s_waitcnt vmcnt(11)
  buffer_load_dwordx4 v[128:131], v10, s[32:35], 0 offen offset:512 nt
  v_add_f32_dpp v22, v22, v22 row_ror:8 row_mask:0xf bank_mask:0x3
  v_add_f32_dpp v22, v20, v20 row_ror:8 row_mask:0xf bank_mask:0xc
  s_nop 1
  v_add_f32_dpp v22, v22, v22 row_half_mirror row_mask:0xf bank_mask:0xf
  s_nop 1
  v_add_f32_dpp v22, v22, v22 quad_perm:[2,3,0,1] row_mask:0xf bank_mask:0xf
  s_nop 1
  v_add_f32_dpp v22, v22, v22 quad_perm:[1,0,3,2] row_mask:0xf bank_mask:0xf
  v_cndmask_b32_e64 v18, v18, v22, s[56:57]
  s_waitcnt vmcnt(8)
  v_add_u32 v32, v46, v47
  s_nop 0
  v_readfirstlane_b32 s91, v32
  s_add_u32 s44, s78, 0x03030303
  v_msad_u8 v32, s78, v56, 0
  v_msad_u8 v33, s44, v56, 0
  v_msad_u8 v32, s78, v57, v32
  v_msad_u8 v33, s44, v57, v33
  v_msad_u8 v32, s78, v58, v32
  v_msad_u8 v33, s44, v58, v33
  v_sub_u32 v32, v32, v33
  v_mov_b32 v31, s90
  s_add_u32 s78, s78, 0x01010101
  v_readlane_b32 s66, v32, 0
  v_readlane_b32 s67, v32, 1
  s_mov_b64 exec, 1
  global_store_byte v30, v31, s[30:31]
  s_mov_b64 exec, 3
  global_load_dwordx3 v[56:58], v36, s[30:31] sc1
  s_mov_b64 exec, -1
  s_add_u32 s69, s66, s67
  s_add_u32 s44, s69, s95
  s_mov_b32 s95, s69
  s_ashr_i32 s69, s44, 1
  s_add_u32 s69, s69, s91
  s_cmp_lt_u32 s90, 5
  s_cselect_b32 s69, 0, s69
  s_add_u32 s90, s90, 1
  v_dot2_f32_bf16 v24, v192, v60, 0
  v_dot2_f32_bf16 v25, v192, v61, 0
  v_dot2_f32_bf16 v26, v193, v62, 0
  v_dot2_f32_bf16 v27, v193, v63, 0
  v_dot2_f32_bf16 v24, v198, v72, v24
  v_dot2_f32_bf16 v25, v198, v73, v25
  v_dot2_f32_bf16 v26, v199, v74, v26
  v_dot2_f32_bf16 v27, v199, v75, v27
  v_cvt_f32_i32 v96, v96
  v_cvt_f32_i32 v97, v97
  v_cvt_f32_i32 v98, v98
  v_cvt_f32_i32 v99, v99
  v_pk_mul_f32 v[22:23], v[96:97], v[24:25]
  v_pk_add_f32 v[20:21], v[24:25], v[26:27]
  v_pk_fma_f32 v[22:23], v[98:99], v[26:27], v[22:23]
  s_cmp_gt_i32 s69, -10
  s_cbranch_scc1 L_p74
  s_waitcnt vmcnt(5)
L_p74:
  s_waitcnt vmcnt(8)
  buffer_load_dwordx4 v[84:87], v3, s[36:39], 0 offen offset:0 nt
  v_dot2_f32_bf16 v24, v194, v64, 0
  v_dot2_f32_bf16 v25, v194, v65, 0
  v_dot2_f32_bf16 v26, v195, v66, 0
  v_dot2_f32_bf16 v27, v195, v67, 0
  v_dot2_f32_bf16 v24, v200, v76, v24
  v_dot2_f32_bf16 v25, v200, v77, v25
  v_dot2_f32_bf16 v26, v201, v78, v26
  v_dot2_f32_bf16 v27, v201, v79, v27
  v_cvt_f32_i32 v100, v100
  v_cvt_f32_i32 v101, v101
  v_cvt_f32_i32 v102, v102
  v_cvt_f32_i32 v103, v103
  v_pk_fma_f32 v[22:23], v[100:101], v[24:25], v[22:23]
  v_pk_add_f32 v[20:21], v[20:21], v[24:25]
  v_pk_fma_f32 v[22:23], v[102:103], v[26:27], v[22:23]
  v_pk_add_f32 v[20:21], v[20:21], v[26:27]
  s_cmp_gt_i32 s69, 4
  s_cbranch_scc1 L_p75
  s_waitcnt vmcnt(6)
L_p75:
  s_waitcnt vmcnt(9)
  buffer_load_dwordx4 v[88:91], v3, s[36:39], 0 offen offset:256 nt
  v_dot2_f32_bf16 v24, v196, v68, 0
  v_dot2_f32_bf16 v25, v196, v69, 0
  v_dot2_f32_bf16 v26, v197, v70, 0
  v_dot2_f32_bf16 v27, v197, v71, 0
  v_dot2_f32_bf16 v24, v202, v80, v24
  v_dot2_f32_bf16 v25, v202, v81, v25
  v_dot2_f32_bf16 v26, v203, v82, v26
  v_dot2_f32_bf16 v27, v203, v83, v27
  v_cvt_f32_i32 v104, v104
  v_cvt_f32_i32 v105, v105
  v_cvt_f32_i32 v106, v106
  v_cvt_f32_i32 v107, v107
  v_pk_fma_f32 v[22:23], v[104:105], v[24:25], v[22:23]
  v_pk_add_f32 v[20:21], v[20:21], v[24:25]
  v_pk_fma_f32 v[22:23], v[106:107], v[26:27], v[22:23]
  v_pk_add_f32 v[20:21], v[20:21], v[26:27]
  v_add_f32 v22, v22, v23
  v_add_f32 v20, v20, v21
  s_cmp_lt_i32 s69, -25
  s_cbranch_scc0 L_t76
  s_waitcnt vmcnt(6)
L_t76:
  s_cmp_gt_i32 s69, 12
  s_cbranch_scc1 L_p77
  s_waitcnt vmcnt(7)
L_p77:
  s_waitcnt vmcnt(10)
  buffer_load_dwordx4 v[92:95], v3, s[36:39], 0 offen offset:512 nt
  v_add_f32_dpp v22, v22, v22 row_ror:8 row_mask:0xf bank_mask:0x3
  v_add_f32_dpp v22, v20, v20 row_ror:8 row_mask:0xf bank_mask:0xc
  s_nop 1
  v_add_f32_dpp v22, v22, v22 row_half_mirror row_mask:0xf bank_mask:0xf
  s_nop 1
  v_add_f32_dpp v22, v22, v22 quad_perm:[2,3,0,1] row_mask:0xf bank_mask:0xf
  s_nop 1
  v_add_f32_dpp v22, v22, v22 quad_perm:[1,0,3,2] row_mask:0xf bank_mask:0xf
  v_cndmask_b32_e64 v18, v18, v22, s[58:59]
  ds_read_b32 v14, v15 offset:16
  s_waitcnt vmcnt(8)
  s_add_u32 s44, s78, 0x03030303
  v_msad_u8 v32, s78, v52, 0
  v_msad_u8 v33, s44, v52, 0
  v_msad_u8 v32, s78, v53, v32
  v_msad_u8 v33, s44, v53, v33
  v_msad_u8 v32, s78, v54, v32
  v_msad_u8 v33, s44, v54, v33
  v_sub_u32 v32, v32, v33
  v_mov_b32 v31, s90
  s_add_u32 s78, s78, 0x01010101
  v_readlane_b32 s66, v32, 0
  v_readlane_b32 s67, v32, 1
  s_mov_b64 exec, 1
  global_store_byte v30, v31, s[30:31]
  s_mov_b64 exec, 3
  global_load_dwordx3 v[52:54], v37, s[30:31] sc1
  s_mov_b64 exec, -1
  s_add_u32 s69, s66, s67
  s_add_u32 s44, s69, s95
  s_mov_b32 s95, s69
  s_ashr_i32 s69, s44, 1
  s_add_u32 s69, s69, s91
  s_cmp_lt_u32 s90, 5
  s_cselect_b32 s69, 0, s69
  s_add_u32 s90, s90, 1
  v_dot2_f32_bf16 v24, v204, v60, 0
  v_dot2_f32_bf16 v25, v204, v61, 0
  v_dot2_f32_bf16 v26, v205, v62, 0
  v_dot2_f32_bf16 v27, v205, v63, 0
  v_dot2_f32_bf16 v24, v210, v72, v24
  v_dot2_f32_bf16 v25, v210, v73, v25
  v_dot2_f32_bf16 v26, v211, v74, v26
  v_dot2_f32_bf16 v27, v211, v75, v27
  v_cvt_f32_i32 v108, v108
  v_cvt_f32_i32 v109, v109
  v_cvt_f32_i32 v110, v110
  v_cvt_f32_i32 v111, v111
  v_pk_mul_f32 v[22:23], v[108:109], v[24:25]
  v_pk_add_f32 v[20:21], v[24:25], v[26:27]
  v_pk_fma_f32 v[22:23], v[110:111], v[26:27], v[22:23]
  s_cmp_gt_i32 s69, -10
  s_cbranch_scc1 L_p78
  s_waitcnt vmcnt(5)
L_p78:
  s_waitcnt vmcnt(8)
  buffer_load_dwordx4 v[96:99], v4, s[36:39], 0 offen offset:0 nt
  v_dot2_f32_bf16 v24, v206, v64, 0
  v_dot2_f32_bf16 v25, v206, v65, 0
  v_dot2_f32_bf16 v26, v207, v66, 0
  v_dot2_f32_bf16 v27, v207, v67, 0
  v_dot2_f32_bf16 v24, v212, v76, v24
  v_dot2_f32_bf16 v25, v212, v77, v25
  v_dot2_f32_bf16 v26, v213, v78, v26
  v_dot2_f32_bf16 v27, v213, v79, v27
  v_cvt_f32_i32 v112, v112
  v_cvt_f32_i32 v113, v113
  v_cvt_f32_i32 v114, v114
  v_cvt_f32_i32 v115, v115
  v_pk_fma_f32 v[22:23], v[112:113], v[24:25], v[22:23]
  v_pk_add_f32 v[20:21], v[20:21], v[24:25]
  v_pk_fma_f32 v[22:23], v[114:115], v[26:27], v[22:23]
  v_pk_add_f32 v[20:21], v[20:21], v[26:27]
  s_cmp_gt_i32 s69, 4
  s_cbranch_scc1 L_p79
  s_waitcnt vmcnt(6)
L_p79:
  s_waitcnt vmcnt(9)
  buffer_load_dwordx4 v[100:103], v4, s[36:39], 0 offen offset:256 nt
  v_dot2_f32_bf16 v24, v208, v68, 0
  v_dot2_f32_bf16 v25, v208, v69, 0
  v_dot2_f32_bf16 v26, v209, v70, 0
  v_dot2_f32_bf16 v27, v209, v71, 0
  v_dot2_f32_bf16 v24, v214, v80, v24
  v_dot2_f32_bf16 v25, v214, v81, v25
  v_dot2_f32_bf16 v26, v215, v82, v26
  v_dot2_f32_bf16 v27, v215, v83, v27
  v_cvt_f32_i32 v116, v116
  v_cvt_f32_i32 v117, v117
  v_cvt_f32_i32 v118, v118
  v_cvt_f32_i32 v119, v119
  v_pk_fma_f32 v[22:23], v[116:117], v[24:25], v[22:23]
  v_pk_add_f32 v[20:21], v[20:21], v[24:25]
  v_pk_fma_f32 v[22:23], v[118:119], v[26:27], v[22:23]
  v_pk_add_f32 v[20:21], v[20:21], v[26:27]
  v_add_f32 v22, v22, v23
  v_add_f32 v20, v20, v21
  s_cmp_lt_i32 s69, -25
  s_cbranch_scc0 L_t80
  s_waitcnt vmcnt(6)
L_t80:
  s_cmp_gt_i32 s69, 12
  s_cbranch_scc1 L_p81
  s_waitcnt vmcnt(7)
L_p81:
  s_waitcnt vmcnt(10)
  buffer_load_dwordx4 v[104:107], v4, s[36:39], 0 offen offset:512 nt
  v_add_f32_dpp v22, v22, v22 row_ror:8 row_mask:0xf bank_mask:0x3
  v_add_f32_dpp v22, v20, v20 row_ror:8 row_mask:0xf bank_mask:0xc
  s_nop 1
  v_add_f32_dpp v22, v22, v22 row_half_mirror row_mask:0xf bank_mask:0xf
  s_nop 1
  v_add_f32_dpp v22, v22, v22 quad_perm:[2,3,0,1] row_mask:0xf bank_mask:0xf
  s_nop 1
  v_add_f32_dpp v22, v22, v22 quad_perm:[1,0,3,2] row_mask:0xf bank_mask:0xf
  v_cndmask_b32_e64 v18, v18, v22, s[60:61]
L_qn:
  s_waitcnt lgkmcnt(0)
  v_readfirstlane_b32 s46, v14
  s_cmp_ge_u32 s46, s47
  s_cbranch_scc1 L_qn_ok
  s_cmp_eq_u32 s94, 0
  s_cbranch_scc1 L_qn_ok
  s_sub_u32 s94, s94, 1
  ds_read_b32 v14, v15 offset:16
  s_branch L_qn
L_qn_ok:
  s_waitcnt vmcnt(8)
  s_add_u32 s44, s78, 0x03030303
  v_msad_u8 v32, s78, v56, 0
  v_msad_u8 v33, s44, v56, 0
  v_msad_u8 v32, s78, v57, v32
  v_msad_u8 v33, s44, v57, v33
  v_msad_u8 v32, s78, v58, v32
  v_msad_u8 v33, s44, v58, v33
  v_sub_u32 v32, v32, v33
  v_mov_b32 v31, s90
  s_add_u32 s78, s78, 0x01010101
  v_readlane_b32 s66, v32, 0
  v_readlane_b32 s67, v32, 1
  s_mov_b64 exec, 1
  global_store_byte v30, v31, s[30:31]
  s_mov_b64 exec, 3
  global_load_dwordx3 v[56:58], v38, s[30:31] sc1
  s_mov_b64 exec, -1
  s_add_u32 s69, s66, s67
  s_add_u32 s44, s69, s95
  s_mov_b32 s95, s69
  s_ashr_i32 s69, s44, 1
  s_add_u32 s69, s69, s91
  s_cmp_lt_u32 s90, 5
  s_cselect_b32 s69, 0, s69
  s_add_u32 s90, s90, 1
  v_dot2_f32_bf16 v24, v216, v60, 0
  v_dot2_f32_bf16 v25, v216, v61, 0
  v_dot2_f32_bf16 v26, v217, v62, 0
  v_dot2_f32_bf16 v27, v217, v63, 0
  v_dot2_f32_bf16 v24, v222, v72, v24
  v_dot2_f32_bf16 v25, v222, v73, v25
  v_dot2_f32_bf16 v26, v223, v74, v26
  v_dot2_f32_bf16 v27, v223, v75, v27
  v_cvt_f32_i32 v120, v120
  v_cvt_f32_i32 v121, v121
  v_cvt_f32_i32 v122, v122
  v_cvt_f32_i32 v123, v123
  ds_read_b128 v[60:63], v12 offset:512
  ds_read_b128 v[72:75], v12 offset:1280
  v_pk_mul_f32 v[22:23], v[120:121], v[24:25]
  v_pk_add_f32 v[20:21], v[24:25], v[26:27]
  v_pk_fma_f32 v[22:23], v[122:123], v[26:27], v[22:23]
  s_cmp_gt_i32 s69, -10
  s_cbranch_scc1 L_p82
  s_waitcnt vmcnt(5)
L_p82:
  s_waitcnt vmcnt(8)
  buffer_load_dwordx4 v[108:111], v5, s[36:39], 0 offen offset:0 nt
  v_dot2_f32_bf16 v24, v218, v64, 0
  v_dot2_f32_bf16 v25, v218, v65, 0
  v_dot2_f32_bf16 v26, v219, v66, 0
  v_dot2_f32_bf16 v27, v219, v67, 0
  v_dot2_f32_bf16 v24, v224, v76, v24
  v_dot2_f32_bf16 v25, v224, v77, v25
  v_dot2_f32_bf16 v26, v225, v78, v26
  v_dot2_f32_bf16 v27, v225, v79, v27
  v_cvt_f32_i32 v124, v124
  v_cvt_f32_i32 v125, v125
  v_cvt_f32_i32 v126, v126
  v_cvt_f32_i32 v127, v127
  ds_read_b128 v[64:67], v12 offset:768
  ds_read_b128 v[76:79], v12 offset:1536
  v_pk_fma_f32 v[22:23], v[124:125], v[24:25], v[22:23]
  v_pk_add_f32 v[20:21], v[20:21], v[24:25]
  v_pk_fma_f32 v[22:23], v[126:127], v[26:27], v[22:23]
  v_pk_add_f32 v[20:21], v[20:21], v[26:27]
  s_cmp_gt_i32 s69, 4
  s_cbranch_scc1 L_p83
  s_waitcnt vmcnt(6)
L_p83:
  s_waitcnt vmcnt(9)
  buffer_load_dwordx4 v[112:115], v5, s[36:39], 0 offen offset:256 nt
  v_dot2_f32_bf16 v24, v220, v68, 0
  v_dot2_f32_bf16 v25, v220, v69, 0
  v_dot2_f32_bf16 v26, v221, v70, 0
  v_dot2_f32_bf16 v27, v221, v71, 0
  v_dot2_f32_bf16 v24, v226, v80, v24
  v_dot2_f32_bf16 v25, v226, v81, v25
  v_dot2_f32_bf16 v26, v227, v82, v26
  v_dot2_f32_bf16 v27, v227, v83, v27
  v_cvt_f32_i32 v128, v128
  v_cvt_f32_i32 v129, v129
  v_cvt_f32_i32 v130, v130
  v_cvt_f32_i32 v131, v131
  ds_read_b128 v[68:71], v12 offset:1024
  ds_read_b128 v[80:83], v12 offset:1792
  v_pk_fma_f32 v[22:23], v[128:129], v[24:25], v[22:23]
  v_pk_add_f32 v[20:21], v[20:21], v[24:25]
  v_pk_fma_f32 v[22:23], v[130:131], v[26:27], v[22:23]
  v_pk_add_f32 v[20:21], v[20:21], v[26:27]
  v_add_f32 v22, v22, v23
  v_add_f32 v20, v20, v21
  s_cmp_lt_i32 s69, -25
  s_cbranch_scc0 L_t84
  s_waitcnt vmcnt(6)
L_t84:
  s_cmp_gt_i32 s69, 12
  s_cbranch_scc1 L_p85
  s_waitcnt vmcnt(7)
L_p85:
  s_waitcnt vmcnt(10)
  buffer_load_dwordx4 v[116:119], v5, s[36:39], 0 offen offset:512 nt
  v_add_f32_dpp v22, v22, v22 row_ror:8 row_mask:0xf bank_mask:0x3
  v_add_f32_dpp v22, v20, v20 row_ror:8 row_mask:0xf bank_mask:0xc
  s_nop 1
  v_add_f32_dpp v22, v22, v22 row_half_mirror row_mask:0xf bank_mask:0xf
  s_nop 1
  v_add_f32_dpp v22, v22, v22 quad_perm:[2,3,0,1] row_mask:0xf bank_mask:0xf
  s_nop 1
  v_add_f32_dpp v22, v22, v22 quad_perm:[1,0,3,2] row_mask:0xf bank_mask:0xf
  v_cndmask_b32_e64 v18, v18, v22, s[62:63]
  s_add_u32 s43, s43, 1
  v_mov_b32 v14, s43
  ds_write_b32 v11, v18
  ds_write_b32 v29, v14 offset:0
  v_add_u32 v11, 512, v11
  s_mov_b64 s[32:33], s[36:37]
  s_add_u32 s68, s43, 1
  s_sub_u32 s45, s68, 16
  s_lshl_b32 s46, s45, 2
  s_lshr_b64 s[64:65], s[92:93], s46
  s_and_b32 s46, s64, 15
  s_cmp_lt_u32 s68, 16
  s_cselect_b32 s68, s68, s46
  s_cselect_b32 s70, s6, s12
  s_cselect_b32 s71, s7, s13
  s_lshl_b32 s44, s68, 2
  s_lshr_b64 s[64:65], s[96:97], s44
  s_and_b32 s64, s64, 15
  s_lshl4_add_u32 s68, s68, s64
  s_mul_i32 s44, s68, 1572864
  s_add_u32 s36, s70, s44
  s_addc_u32 s37, s71, 0
  s_cmp_lt_u32 s43, 16
  s_cbranch_scc1 L_k
L_vpre:
  v_subrev_u32 v18, 8192, v11
  s_mov_b64 vcc, 0
  s_mov_b32 s43, 0
  s_lshl_b32 s68, s43, 2
  s_lshr_b64 s[64:65], s[92:93], s68
  s_and_b32 s68, s64, 15
  s_add_u32 s47, s68, 1
  ds_read_b32 v14, v15 offset:20
L_a0:
  s_waitcnt lgkmcnt(0)
  v_readfirstlane_b32 s46, v14
  s_cmp_ge_u32 s46, s47
  s_cbranch_scc1 L_a0_ok
  s_cmp_eq_u32 s94, 0
  s_cbranch_scc1 L_a0_ok
  s_sub_u32 s94, s94, 1
  ds_read_b32 v14, v15 offset:20
  s_branch L_a0
L_a0_ok:
  v_lshl_add_u32 v11, s68, 9, v18
  ds_read_b32 v16, v11
.p2align 6
L_v:
  s_add_u32 s45, s43, 1
  s_min_u32 s45, s45, 15
  s_lshl_b32 s68, s45, 2
  s_lshr_b64 s[64:65], s[92:93], s68
  s_and_b32 s68, s64, 15
  s_add_u32 s47, s68, 1
  v_lshl_add_u32 v11, s68, 9, v18
  s_waitcnt lgkmcnt(0)
  v_mov_b32_dpp v20, v16 row_newbcast:0 row_mask:0xf bank_mask:0xf
  s_waitcnt vmcnt(8)
  s_add_u32 s44, s78, 0x03030303
  v_msad_u8 v32, s78, v52, 0
  v_msad_u8 v33, s44, v52, 0
  v_msad_u8 v32, s78, v53, v32
  v_msad_u8 v33, s44, v53, v33
  v_msad_u8 v32, s78, v54, v32
  v_msad_u8 v33, s44, v54, v33
  v_sub_u32 v32, v32, v33
  v_mov_b32 v31, s90
  s_add_u32 s78, s78, 0x01010101
  v_readlane_b32 s66, v32, 0
  v_readlane_b32 s67, v32, 1
  s_mov_b64 exec, 1
  global_store_byte v30, v31, s[30:31]
  s_mov_b64 exec, 3
  global_load_dwordx3 v[52:54], v35, s[30:31] sc1
  s_mov_b64 exec, -1
  s_add_u32 s69, s66, s67
  s_add_u32 s44, s69, s95
  s_mov_b32 s95, s69
  s_ashr_i32 s69, s44, 1
  s_add_u32 s69, s69, s91
  s_cmp_lt_u32 s90, 5
  s_cselect_b32 s69, 0, s69
  s_add_u32 s90, s90, 1
  v_cvt_f32_i32 v84, v84
  v_cvt_f32_i32 v85, v85
  v_cvt_f32_i32 v86, v86
  v_cvt_f32_i32 v87, v87
  v_pk_mul_f32 v[60:61], v[84:85], v[20:21] op_sel_hi:[1,0]
  v_pk_mul_f32 v[62:63], v[86:87], v[20:21] op_sel_hi:[1,0]
  s_cmp_gt_i32 s69, -7
  s_cbranch_scc1 L_p86
  s_waitcnt vmcnt(5)
L_p86:
  s_waitcnt vmcnt(8)
  buffer_load_dwordx4 v[120:123], v6, s[32:35], 0 offen offset:0 nt
  v_cvt_f32_i32 v88, v88
  v_cvt_f32_i32 v89, v89
  v_cvt_f32_i32 v90, v90
  v_cvt_f32_i32 v91, v91
  v_pk_mul_f32 v[64:65], v[88:89], v[20:21] op_sel_hi:[1,0]
  v_pk_mul_f32 v[66:67], v[90:91], v[20:21] op_sel_hi:[1,0]
  s_cmp_gt_i32 s69, 7
  s_cbranch_scc1 L_p87
  s_waitcnt vmcnt(6)
L_p87:
  s_waitcnt vmcnt(9)
  buffer_load_dwordx4 v[124:127], v6, s[32:35], 0 offen offset:256 nt
  v_cvt_f32_i32 v92, v92
  v_cvt_f32_i32 v93, v93
  v_cvt_f32_i32 v94, v94
  v_cvt_f32_i32 v95, v95
  v_pk_mul_f32 v[68:69], v[92:93], v[20:21] op_sel_hi:[1,0]
  v_pk_mul_f32 v[70:71], v[94:95], v[20:21] op_sel_hi:[1,0]
  s_cmp_lt_i32 s69, -25
  s_cbranch_scc0 L_t88
  s_waitcnt vmcnt(6)
L_t88:
  s_cmp_gt_i32 s69, 15
  s_cbranch_scc1 L_p89
  s_waitcnt vmcnt(7)
L_p89:
  s_waitcnt vmcnt(10)
  buffer_load_dwordx4 v[128:131], v6, s[32:35], 0 offen offset:512 nt
  v_mov_b32_dpp v20, v16 row_newbcast:1 row_mask:0xf bank_mask:0xf
  s_waitcnt vmcnt(8)
  s_add_u32 s44, s78, 0x03030303
  v_msad_u8 v32, s78, v56, 0
  v_msad_u8 v33, s44, v56, 0
  v_msad_u8 v32, s78, v57, v32
  v_msad_u8 v33, s44, v57, v33
  v_msad_u8 v32, s78, v58, v32
  v_msad_u8 v33, s44, v58, v33
  v_sub_u32 v32, v32, v33
  v_mov_b32 v31, s90
  s_add_u32 s78, s78, 0x01010101
  v_readlane_b32 s66, v32, 0
  v_readlane_b32 s67, v32, 1
  s_mov_b64 exec, 1
  global_store_byte v30, v31, s[30:31]
  s_mov_b64 exec, 3
  global_load_dwordx3 v[56:58], v36, s[30:31] sc1
  s_mov_b64 exec, -1
  s_add_u32 s69, s66, s67
  s_add_u32 s44, s69, s95
  s_mov_b32 s95, s69
  s_ashr_i32 s69, s44, 1
  s_add_u32 s69, s69, s91
  s_cmp_lt_u32 s90, 5
  s_cselect_b32 s69, 0, s69
  s_add_u32 s90, s90, 1
  v_cvt_f32_i32 v96, v96
  v_cvt_f32_i32 v97, v97
  v_cvt_f32_i32 v98, v98
  v_cvt_f32_i32 v99, v99
  v_pk_fma_f32 v[60:61], v[96:97], v[20:21], v[60:61] op_sel_hi:[1,0,1]
  v_pk_fma_f32 v[62:63], v[98:99], v[20:21], v[62:63] op_sel_hi:[1,0,1]
  s_cmp_gt_i32 s69, -7
  s_cbranch_scc1 L_p90
  s_waitcnt vmcnt(5)
L_p90:
  s_waitcnt vmcnt(8)
  buffer_load_dwordx4 v[84:87], v7, s[32:35], 0 offen offset:0 nt
  v_cvt_f32_i32 v100, v100
  v_cvt_f32_i32 v101, v101
  v_cvt_f32_i32 v102, v102
  v_cvt_f32_i32 v103, v103
  v_pk_fma_f32 v[64:65], v[100:101], v[20:21], v[64:65] op_sel_hi:[1,0,1]
  v_pk_fma_f32 v[66:67], v[102:103], v[20:21], v[66:67] op_sel_hi:[1,0,1]
  s_cmp_gt_i32 s69, 7
  s_cbranch_scc1 L_p91
  s_waitcnt vmcnt(6)
L_p91:
  s_waitcnt vmcnt(9)
  buffer_load_dwordx4 v[88:91], v7, s[32:35], 0 offen offset:256 nt
  v_cvt_f32_i32 v104, v104
  v_cvt_f32_i32 v105, v105
  v_cvt_f32_i32 v106, v106
  v_cvt_f32_i32 v107, v107
  v_pk_fma_f32 v[68:69], v[104:105], v[20:21], v[68:69] op_sel_hi:[1,0,1]
  v_pk_fma_f32 v[70:71], v[106:107], v[20:21], v[70:71] op_sel_hi:[1,0,1]
  s_cmp_lt_i32 s69, -25
  s_cbranch_scc0 L_t92
  s_waitcnt vmcnt(6)
L_t92:
  s_cmp_gt_i32 s69, 15
  s_cbranch_scc1 L_p93
  s_waitcnt vmcnt(7)
L_p93:
  s_waitcnt vmcnt(10)
  buffer_load_dwordx4 v[92:95], v7, s[32:35], 0 offen offset:512 nt
  v_mov_b32_dpp v20, v16 row_newbcast:2 row_mask:0xf bank_mask:0xf
  s_waitcnt vmcnt(8)
  s_add_u32 s44, s78, 0x03030303
  v_msad_u8 v32, s78, v52, 0
  v_msad_u8 v33, s44, v52, 0
  v_msad_u8 v32, s78, v53, v32
  v_msad_u8 v33, s44, v53, v33
  v_msad_u8 v32, s78, v54, v32
  v_msad_u8 v33, s44, v54, v33
  v_sub_u32 v32, v32, v33
  v_mov_b32 v31, s90
  s_add_u32 s78, s78, 0x01010101
  v_readlane_b32 s66, v32, 0
  v_readlane_b32 s67, v32, 1
  s_mov_b64 exec, 1
  global_store_byte v30, v31, s[30:31]
  s_mov_b64 exec, 3
  global_load_dwordx3 v[52:54], v37, s[30:31] sc1
  s_mov_b64 exec, -1
  s_add_u32 s69, s66, s67
  s_add_u32 s44, s69, s95
  s_mov_b32 s95, s69
  s_ashr_i32 s69, s44, 1
  s_add_u32 s69, s69, s91
  s_cmp_lt_u32 s90, 5
  s_cselect_b32 s69, 0, s69
  s_add_u32 s90, s90, 1
  v_cvt_f32_i32 v108, v108
  v_cvt_f32_i32 v109, v109
  v_cvt_f32_i32 v110, v110
  v_cvt_f32_i32 v111, v111
  v_pk_fma_f32 v[60:61], v[108:109], v[20:21], v[60:61] op_sel_hi:[1,0,1]
  v_pk_fma_f32 v[62:63], v[110:111], v[20:21], v[62:63] op_sel_hi:[1,0,1]
  s_cmp_gt_i32 s69, -7
  s_cbranch_scc1 L_p94
  s_waitcnt vmcnt(5)
L_p94:
  s_waitcnt vmcnt(8)
  buffer_load_dwordx4 v[96:99], v8, s[32:35], 0 offen offset:0 nt
  v_cvt_f32_i32 v112, v112
  v_cvt_f32_i32 v113, v113
  v_cvt_f32_i32 v114, v114
  v_cvt_f32_i32 v115, v115
  v_pk_fma_f32 v[64:65], v[112:113], v[20:21], v[64:65] op_sel_hi:[1,0,1]
  v_pk_fma_f32 v[66:67], v[114:115], v[20:21], v[66:67] op_sel_hi:[1,0,1]
  s_cmp_gt_i32 s69, 7
  s_cbranch_scc1 L_p95
  s_waitcnt vmcnt(6)
L_p95:
  s_waitcnt vmcnt(9)
  buffer_load_dwordx4 v[100:103], v8, s[32:35], 0 offen offset:256 nt
  v_cvt_f32_i32 v116, v116
  v_cvt_f32_i32 v117, v117
  v_cvt_f32_i32 v118, v118
  v_cvt_f32_i32 v119, v119
  v_pk_fma_f32 v[68:69], v[116:117], v[20:21], v[68:69] op_sel_hi:[1,0,1]
  v_pk_fma_f32 v[70:71], v[118:119], v[20:21], v[70:71] op_sel_hi:[1,0,1]
  s_cmp_lt_i32 s69, -25
  s_cbranch_scc0 L_t96
  s_waitcnt vmcnt(6)
L_t96:
  s_cmp_gt_i32 s69, 15
  s_cbranch_scc1 L_p97
  s_waitcnt vmcnt(7)
L_p97:
  s_waitcnt vmcnt(10)
  buffer_load_dwordx4 v[104:107], v8, s[32:35], 0 offen offset:512 nt
  v_mov_b32_dpp v20, v16 row_newbcast:3 row_mask:0xf bank_mask:0xf
  s_mov_b64 exec, 1
  global_load_dwordx2 v[46:47], v34, s[30:31] sc1
  s_mov_b64 exec, -1
  s_waitcnt vmcnt(9)
  s_add_u32 s44, s78, 0x03030303
  v_msad_u8 v32, s78, v56, 0
  v_msad_u8 v33, s44, v56, 0
  v_msad_u8 v32, s78, v57, v32
  v_msad_u8 v33, s44, v57, v33
  v_msad_u8 v32, s78, v58, v32
  v_msad_u8 v33, s44, v58, v33
  v_sub_u32 v32, v32, v33
  v_mov_b32 v31, s90
  s_add_u32 s78, s78, 0x01010101
  v_readlane_b32 s66, v32, 0
  v_readlane_b32 s67, v32, 1
  s_mov_b64 exec, 1
  global_store_byte v30, v31, s[30:31]
  s_mov_b64 exec, 3
  global_load_dwordx3 v[56:58], v38, s[30:31] sc1
  s_mov_b64 exec, -1
  s_add_u32 s69, s66, s67
  s_add_u32 s44, s69, s95
  s_mov_b32 s95, s69
  s_ashr_i32 s69, s44, 1
  s_add_u32 s69, s69, s91
  s_cmp_lt_u32 s90, 5
  s_cselect_b32 s69, 0, s69
  s_add_u32 s90, s90, 1
  v_cvt_f32_i32 v120, v120
  v_cvt_f32_i32 v121, v121
  v_cvt_f32_i32 v122, v122
  v_cvt_f32_i32 v123, v123
  v_pk_fma_f32 v[60:61], v[120:121], v[20:21], v[60:61] op_sel_hi:[1,0,1]
  v_pk_fma_f32 v[62:63], v[122:123], v[20:21], v[62:63] op_sel_hi:[1,0,1]
  s_cmp_gt_i32 s69, -7
  s_cbranch_scc1 L_p98
  s_waitcnt vmcnt(6)
L_p98:
  s_waitcnt vmcnt(9)
  buffer_load_dwordx4 v[108:111], v9, s[32:35], 0 offen offset:0 nt
  v_cvt_f32_i32 v124, v124
  v_cvt_f32_i32 v125, v125
  v_cvt_f32_i32 v126, v126
  v_cvt_f32_i32 v127, v127
  v_pk_fma_f32 v[64:65], v[124:125], v[20:21], v[64:65] op_sel_hi:[1,0,1]
  v_pk_fma_f32 v[66:67], v[126:127], v[20:21], v[66:67] op_sel_hi:[1,0,1]
  s_cmp_gt_i32 s69, 7
  s_cbranch_scc1 L_p99
  s_waitcnt vmcnt(7)
L_p99:
  s_waitcnt vmcnt(10)
  buffer_load_dwordx4 v[112:115], v9, s[32:35], 0 offen offset:256 nt
  v_cvt_f32_i32 v128, v128
  v_cvt_f32_i32 v129, v129
  v_cvt_f32_i32 v130, v130
  v_cvt_f32_i32 v131, v131
  v_pk_fma_f32 v[68:69], v[128:129], v[20:21], v[68:69] op_sel_hi:[1,0,1]
  v_pk_fma_f32 v[70:71], v[130:131], v[20:21], v[70:71] op_sel_hi:[1,0,1]
  s_cmp_lt_i32 s69, -25
  s_cbranch_scc0 L_t100
  s_waitcnt vmcnt(7)
L_t100:
  s_cmp_gt_i32 s69, 15
  s_cbranch_scc1 L_p101
  s_waitcnt vmcnt(8)
L_p101:
  s_waitcnt vmcnt(11)
  buffer_load_dwordx4 v[116:119], v9, s[32:35], 0 offen offset:512 nt
  v_mov_b32_dpp v20, v16 row_newbcast:4 row_mask:0xf bank_mask:0xf
  s_waitcnt vmcnt(9)
  s_add_u32 s44, s78, 0x03030303
  v_msad_u8 v32, s78, v52, 0
  v_msad_u8 v33, s44, v52, 0
  v_msad_u8 v32, s78, v53, v32
  v_msad_u8 v33, s44, v53, v33
  v_msad_u8 v32, s78, v54, v32
  v_msad_u8 v33, s44, v54, v33
  v_sub_u32 v32, v32, v33
  v_mov_b32 v31, s90
  s_add_u32 s78, s78, 0x01010101
  v_readlane_b32 s66, v32, 0
  v_readlane_b32 s67, v32, 1
  s_mov_b64 exec, 1
  global_store_byte v30, v31, s[30:31]
  s_mov_b64 exec, 3
  global_load_dwordx3 v[52:54], v35, s[30:31] sc1
  s_mov_b64 exec, -1
  s_add_u32 s69, s66, s67
  s_add_u32 s44, s69, s95
  s_mov_b32 s95, s69
  s_ashr_i32 s69, s44, 1
  s_add_u32 s69, s69, s91
  s_cmp_lt_u32 s90, 5
  s_cselect_b32 s69, 0, s69
  s_add_u32 s90, s90, 1
  v_cvt_f32_i32 v84, v84
  v_cvt_f32_i32 v85, v85
  v_cvt_f32_i32 v86, v86
  v_cvt_f32_i32 v87, v87
  v_pk_fma_f32 v[60:61], v[84:85], v[20:21], v[60:61] op_sel_hi:[1,0,1]
  v_pk_fma_f32 v[62:63], v[86:87], v[20:21], v[62:63] op_sel_hi:[1,0,1]
  s_cmp_gt_i32 s69, -7
  s_cbranch_scc1 L_p102
  s_waitcnt vmcnt(5)
L_p102:
  s_waitcnt vmcnt(9)
  buffer_load_dwordx4 v[120:123], v10, s[32:35], 0 offen offset:0 nt
  v_cvt_f32_i32 v88, v88
  v_cvt_f32_i32 v89, v89
  v_cvt_f32_i32 v90, v90
  v_cvt_f32_i32 v91, v91
  v_pk_fma_f32 v[64:65], v[88:89], v[20:21], v[64:65] op_sel_hi:[1,0,1]
  v_pk_fma_f32 v[66:67], v[90:91], v[20:21], v[66:67] op_sel_hi:[1,0,1]
  s_cmp_gt_i32 s69, 7
  s_cbranch_scc1 L_p103
  s_waitcnt vmcnt(6)
L_p103:
  s_waitcnt vmcnt(10)
  buffer_load_dwordx4 v[124:127], v10, s[32:35], 0 offen offset:256 nt
  v_cvt_f32_i32 v92, v92
  v_cvt_f32_i32 v93, v93
  v_cvt_f32_i32 v94, v94
  v_cvt_f32_i32 v95, v95
  v_pk_fma_f32 v[68:69], v[92:93], v[20:21], v[68:69] op_sel_hi:[1,0,1]
  v_pk_fma_f32 v[70:71], v[94:95], v[20:21], v[70:71] op_sel_hi:[1,0,1]
  s_cmp_lt_i32 s69, -25
  s_cbranch_scc0 L_t104
  s_waitcnt vmcnt(6)
L_t104:
  s_cmp_gt_i32 s69, 15
  s_cbranch_scc1 L_p105
  s_waitcnt vmcnt(7)
L_p105:
  s_waitcnt vmcnt(11)
  buffer_load_dwordx4 v[128:131], v10, s[32:35], 0 offen offset:512 nt
  v_mov_b32_dpp v20, v16 row_newbcast:5 row_mask:0xf bank_mask:0xf
  ds_read_b32 v14, v15 offset:20
  s_cbranch_vccz L_in
  s_waitcnt vmcnt(11)
L_in:
  s_cbranch_vccnz L_c15
  s_waitcnt vmcnt(8)
  v_add_u32 v32, v46, v47
  s_nop 0
  v_readfirstlane_b32 s91, v32
  s_add_u32 s44, s78, 0x03030303
  v_msad_u8 v32, s78, v56, 0
  v_msad_u8 v33, s44, v56, 0
  v_msad_u8 v32, s78, v57, v32
  v_msad_u8 v33, s44, v57, v33
  v_msad_u8 v32, s78, v58, v32
  v_msad_u8 v33, s44, v58, v33
  v_sub_u32 v32, v32, v33
  v_mov_b32 v31, s90
  s_add_u32 s78, s78, 0x01010101
  v_readlane_b32 s66, v32, 0
  v_readlane_b32 s67, v32, 1
  s_mov_b64 exec, 1
  global_store_byte v30, v31, s[30:31]
  s_mov_b64 exec, 3
  global_load_dwordx3 v[56:58], v36, s[30:31] sc1
  s_mov_b64 exec, -1
  s_add_u32 s69, s66, s67
  s_add_u32 s44, s69, s95
  s_mov_b32 s95, s69
  s_ashr_i32 s69, s44, 1
  s_add_u32 s69, s69, s91
  s_cmp_lt_u32 s90, 5
  s_cselect_b32 s69, 0, s69
  s_add_u32 s90, s90, 1
L_c15:
  v_cvt_f32_i32 v96, v96
  v_cvt_f32_i32 v97, v97
  v_cvt_f32_i32 v98, v98
  v_cvt_f32_i32 v99, v99
  v_pk_fma_f32 v[60:61], v[96:97], v[20:21], v[60:61] op_sel_hi:[1,0,1]
  v_pk_fma_f32 v[62:63], v[98:99], v[20:21], v[62:63] op_sel_hi:[1,0,1]
  s_cbranch_vccz L_f15
  s_waitcnt vmcnt(10)
  s_branch L_g15
L_f15:
  s_cmp_gt_i32 s69, -7
  s_cbranch_scc1 L_p106
  s_waitcnt vmcnt(5)
L_p106:
  s_waitcnt vmcnt(8)
  buffer_load_dwordx4 v[84:87], v3, s[36:39], 0 offen offset:0 nt
L_g15:
  v_cvt_f32_i32 v100, v100
  v_cvt_f32_i32 v101, v101
  v_cvt_f32_i32 v102, v102
  v_cvt_f32_i32 v103, v103
  v_pk_fma_f32 v[64:65], v[100:101], v[20:21], v[64:65] op_sel_hi:[1,0,1]
  v_pk_fma_f32 v[66:67], v[102:103], v[20:21], v[66:67] op_sel_hi:[1,0,1]
  s_cbranch_vccz L_f16
  s_waitcnt vmcnt(9)
  s_branch L_g16
L_f16:
  s_cmp_gt_i32 s69, 7
  s_cbranch_scc1 L_p107
  s_waitcnt vmcnt(6)
L_p107:
  s_waitcnt vmcnt(9)
  buffer_load_dwordx4 v[88:91], v3, s[36:39], 0 offen offset:256 nt
L_g16:
  v_cvt_f32_i32 v104, v104
  v_cvt_f32_i32 v105, v105
  v_cvt_f32_i32 v106, v106
  v_cvt_f32_i32 v107, v107
  v_pk_fma_f32 v[68:69], v[104:105], v[20:21], v[68:69] op_sel_hi:[1,0,1]
  v_pk_fma_f32 v[70:71], v[106:107], v[20:21], v[70:71] op_sel_hi:[1,0,1]
  s_cbranch_vccz L_f17
  s_waitcnt vmcnt(6)
  s_branch L_g17
L_f17:
  s_cmp_lt_i32 s69, -25
  s_cbranch_scc0 L_t108
  s_waitcnt vmcnt(6)
L_t108:
  s_cmp_gt_i32 s69, 15
  s_cbranch_scc1 L_p109
  s_waitcnt vmcnt(7)
L_p109:
  s_waitcnt vmcnt(10)
  buffer_load_dwordx4 v[92:95], v3, s[36:39], 0 offen offset:512 nt
L_g17:
  v_mov_b32_dpp v20, v16 row_newbcast:6 row_mask:0xf bank_mask:0xf
L_an:
  s_waitcnt lgkmcnt(0)
  v_readfirstlane_b32 s46, v14
  s_cmp_ge_u32 s46, s47
  s_cbranch_scc1 L_an_ok
  s_cmp_eq_u32 s94, 0
  s_cbranch_scc1 L_an_ok
  s_sub_u32 s94, s94, 1
  ds_read_b32 v14, v15 offset:20
  s_branch L_an
L_an_ok:
  ds_read_b32 v17, v11
  s_cbranch_vccnz L_c18
  s_waitcnt vmcnt(8)
  s_add_u32 s44, s78, 0x03030303
  v_msad_u8 v32, s78, v52, 0
  v_msad_u8 v33, s44, v52, 0
  v_msad_u8 v32, s78, v53, v32
  v_msad_u8 v33, s44, v53, v33
  v_msad_u8 v32, s78, v54, v32
  v_msad_u8 v33, s44, v54, v33
  v_sub_u32 v32, v32, v33
  v_mov_b32 v31, s90
  s_add_u32 s78, s78, 0x01010101
  v_readlane_b32 s66, v32, 0
  v_readlane_b32 s67, v32, 1
  s_mov_b64 exec, 1
  global_store_byte v30, v31, s[30:31]
  s_mov_b64 exec, 3
  global_load_dwordx3 v[52:54], v37, s[30:31] sc1
  s_mov_b64 exec, -1
  s_add_u32 s69, s66, s67
  s_add_u32 s44, s69, s95
  s_mov_b32 s95, s69
  s_ashr_i32 s69, s44, 1
  s_add_u32 s69, s69, s91
  s_cmp_lt_u32 s90, 5
  s_cselect_b32 s69, 0, s69
  s_add_u32 s90, s90, 1
L_c18:
  v_cvt_f32_i32 v108, v108
  v_cvt_f32_i32 v109, v109
  v_cvt_f32_i32 v110, v110
  v_cvt_f32_i32 v111, v111
  v_pk_fma_f32 v[60:61], v[108:109], v[20:21], v[60:61] op_sel_hi:[1,0,1]
  v_pk_fma_f32 v[62:63], v[110:111], v[20:21], v[62:63] op_sel_hi:[1,0,1]
  s_cbranch_vccz L_f18
  s_waitcnt vmcnt(5)
  s_branch L_g18
L_f18:
  s_cmp_gt_i32 s69, -7
  s_cbranch_scc1 L_p110
  s_waitcnt vmcnt(5)
L_p110:
  s_waitcnt vmcnt(8)
  buffer_load_dwordx4 v[96:99], v4, s[36:39], 0 offen offset:0 nt
L_g18:
  v_cvt_f32_i32 v112, v112
  v_cvt_f32_i32 v113, v113
  v_cvt_f32_i32 v114, v114
  v_cvt_f32_i32 v115, v115
  v_pk_fma_f32 v[64:65], v[112:113], v[20:21], v[64:65] op_sel_hi:[1,0,1]
  v_pk_fma_f32 v[66:67], v[114:115], v[20:21], v[66:67] op_sel_hi:[1,0,1]
  s_cbranch_vccz L_f19
  s_waitcnt vmcnt(4)
  s_branch L_g19
L_f19:
  s_cmp_gt_i32 s69, 7
  s_cbranch_scc1 L_p111
  s_waitcnt vmcnt(6)
L_p111:
  s_waitcnt vmcnt(9)
  buffer_load_dwordx4 v[100:103], v4, s[36:39], 0 offen offset:256 nt
L_g19:
  v_cvt_f32_i32 v116, v116
  v_cvt_f32_i32 v117, v117
  v_cvt_f32_i32 v118, v118
  v_cvt_f32_i32 v119, v119
  v_pk_fma_f32 v[68:69], v[116:117], v[20:21], v[68:69] op_sel_hi:[1,0,1]
  v_pk_fma_f32 v[70:71], v[118:119], v[20:21], v[70:71] op_sel_hi:[1,0,1]
  s_cbranch_vccz L_f20
  s_waitcnt vmcnt(2)
  s_branch L_g20
L_f20:
  s_cmp_lt_i32 s69, -25
  s_cbranch_scc0 L_t112
  s_waitcnt vmcnt(6)
L_t112:
  s_cmp_gt_i32 s69, 15
  s_cbranch_scc1 L_p113
  s_waitcnt vmcnt(7)
L_p113:
  s_waitcnt vmcnt(10)
  buffer_load_dwordx4 v[104:107], v4, s[36:39], 0 offen offset:512 nt
L_g20:
  v_mov_b32_dpp v20, v16 row_newbcast:7 row_mask:0xf bank_mask:0xf
  v_mov_b32 v32, s43
  ds_write_b32 v15, v32 offset:24
  s_cbranch_vccnz L_c21
  s_waitcnt vmcnt(8)
  s_add_u32 s44, s78, 0x03030303
  v_msad_u8 v32, s78, v56, 0
  v_msad_u8 v33, s44, v56, 0
  v_msad_u8 v32, s78, v57, v32
  v_msad_u8 v33, s44, v57, v33
  v_msad_u8 v32, s78, v58, v32
  v_msad_u8 v33, s44, v58, v33
  v_sub_u32 v32, v32, v33
  v_mov_b32 v31, s90
  s_add_u32 s78, s78, 0x01010101
  v_readlane_b32 s66, v32, 0
  v_readlane_b32 s67, v32, 1
  s_mov_b64 exec, 1
  global_store_byte v30, v31, s[30:31]
  s_mov_b64 exec, 3
  global_load_dwordx3 v[56:58], v38, s[30:31] sc1
  s_mov_b64 exec, -1
  s_add_u32 s69, s66, s67
  s_add_u32 s44, s69, s95
  s_mov_b32 s95, s69
  s_ashr_i32 s69, s44, 1
  s_add_u32 s69, s69, s91
  s_cmp_lt_u32 s90, 5
  s_cselect_b32 s69, 0, s69
  s_add_u32 s90, s90, 1
L_c21:
  v_cvt_f32_i32 v120, v120
  v_cvt_f32_i32 v121, v121
  v_cvt_f32_i32 v122, v122
  v_cvt_f32_i32 v123, v123
  v_pk_fma_f32 v[60:61], v[120:121], v[20:21], v[60:61] op_sel_hi:[1,0,1]
  v_pk_fma_f32 v[62:63], v[122:123], v[20:21], v[62:63] op_sel_hi:[1,0,1]
  s_cbranch_vccz L_f21
  s_waitcnt vmcnt(1)
  s_branch L_g21
L_f21:
  s_cmp_gt_i32 s69, -7
  s_cbranch_scc1 L_p114
  s_waitcnt vmcnt(5)
L_p114:
  s_waitcnt vmcnt(8)
  buffer_load_dwordx4 v[108:111], v5, s[36:39], 0 offen offset:0 nt
L_g21:
  v_cvt_f32_i32 v124, v124
  v_cvt_f32_i32 v125, v125
  v_cvt_f32_i32 v126, v126
  v_cvt_f32_i32 v127, v127
  v_pk_fma_f32 v[64:65], v[124:125], v[20:21], v[64:65] op_sel_hi:[1,0,1]
  v_pk_fma_f32 v[66:67], v[126:127], v[20:21], v[66:67] op_sel_hi:[1,0,1]
  s_cbranch_vccz L_f22
  s_waitcnt vmcnt(0)
  s_branch L_g22
L_f22:
  s_cmp_gt_i32 s69, 7
  s_cbranch_scc1 L_p115
  s_waitcnt vmcnt(6)
L_p115:
  s_waitcnt vmcnt(9)
  buffer_load_dwordx4 v[112:115], v5, s[36:39], 0 offen offset:256 nt
L_g22:
  v_cvt_f32_i32 v128, v128
  v_cvt_f32_i32 v129, v129
  v_cvt_f32_i32 v130, v130
  v_cvt_f32_i32 v131, v131
  v_pk_fma_f32 v[68:69], v[128:129], v[20:21], v[68:69] op_sel_hi:[1,0,1]
  v_pk_fma_f32 v[70:71], v[130:131], v[20:21], v[70:71] op_sel_hi:[1,0,1]
  s_cbranch_vccz L_f23
  s_branch L_g23
L_f23:
  s_cmp_lt_i32 s69, -25
  s_cbranch_scc0 L_t116
  s_waitcnt vmcnt(6)
L_t116:
  s_cmp_gt_i32 s69, 15
  s_cbranch_scc1 L_p117
  s_waitcnt vmcnt(7)
L_p117:
  s_waitcnt vmcnt(10)
  buffer_load_dwordx4 v[116:119], v5, s[36:39], 0 offen offset:512 nt
L_g23:
  s_add_u32 s43, s43, 1
  v_permlane32_swap_b32 v60, v62
  v_permlane32_swap_b32 v61, v63
  v_permlane32_swap_b32 v64, v66
  v_permlane32_swap_b32 v65, v67
  v_permlane32_swap_b32 v68, v70
  v_permlane32_swap_b32 v69, v71
  v_add_f32 v60, v60, v62
  v_add_f32 v61, v61, v63
  v_add_f32 v64, v64, v66
  v_add_f32 v65, v65, v67
  v_add_f32 v68, v68, v70
  v_add_f32 v69, v69, v71
  s_add_u32 s44, s43, 16
  s_cmp_eq_u32 s43, 15
  s_cselect_b64 vcc, -1, 0
  v_mov_b32 v14, s44
  v_permlane16_swap_b32 v60, v61
  v_permlane16_swap_b32 v64, v65
  v_permlane16_swap_b32 v68, v69
  v_add_f32 v60, v60, v61
  v_add_f32 v64, v64, v65
  v_add_f32 v68, v68, v69
  s_waitcnt lgkmcnt(0)
  ds_write_b32 v13, v60 offset:0
  ds_write_b32 v13, v64 offset:256
  ds_write_b32 v13, v68 offset:512
  s_cmp_eq_u32 s43, 16
  s_cbranch_scc1 L_vend
  ds_write_b32 v29, v14 offset:0
  v_mov_b32 v16, v17
  v_add_u32 v13, 3072, v13
  s_mov_b64 s[32:33], s[36:37]
  s_add_u32 s45, s43, 1
  s_min_u32 s45, s45, 15
  s_lshl_b32 s68, s45, 2
  s_lshr_b64 s[64:65], s[92:93], s68
  s_and_b32 s68, s64, 15
  s_lshl_b32 s44, s68, 2
  s_lshr_b64 s[64:65], s[96:97], s44
  s_and_b32 s64, s64, 15
  s_lshl4_add_u32 s68, s68, s64
  s_mul_i32 s44, s68, 1572864
  s_add_u32 s36, s12, s44
  s_addc_u32 s37, s13, 0
  s_branch L_v
L_vend:
  s_waitcnt lgkmcnt(0)
  s_barrier
  s_endpgm
L_helper:
  s_add_u32 s68, s42, 32
  s_mul_i32 s44, s68, 384
  s_add_u32 s32, s4, s44
  s_addc_u32 s33, s5, 0
  global_load_dwordx2 v[68:69], v26, s[32:33]
  global_load_dwordx2 v[70:71], v27, s[32:33]
  s_setprio 0
  s_load_dwordx4 s[28:31], s[0:1], 96
  s_getpc_b64 s[82:83]
L_pc118:
  s_lshl_b32 s44, s2, 6
  s_add_u32 s44, s44, L_order-L_pc118
  s_add_u32 s82, s82, s44
  s_addc_u32 s83, s83, 0
  s_load_dwordx2 s[92:93], s[82:83], 0
  s_load_dwordx2 s[96:97], s[82:83], 8
  s_mov_b32 s94, 4000000
  s_and_b32 s41, s2, 7
  s_lshl_b32 s41, s41, 1
  s_bitcmp1_b32 s2, 3
  s_addc_u32 s41, s41, 0
  s_load_dword s3, s[82:83], 24
  s_load_dwordx2 s[98:99], s[82:83], 16
  s_waitcnt lgkmcnt(0)
  v_min_u32 v22, 2, v20
  v_lshlrev_b32 v23, 3, v22
  v_bfe_u32 v23, s99, v23, 8
  v_mul_u32_u24 v36, 4352, v23
  v_add_u32 v36, 7340032, v36
  v_and_b32 v23, 15, v23
  v_lshlrev_b32 v37, 4, v23
  v_lshl_add_u32 v22, v22, 4, s42
  v_mul_u32_u24 v45, 4352, v22
  v_add_u32 v45, 7340032, v45
  s_getreg_b32 s81, hwreg(HW_REG_HW_ID, 13, 2)
  s_getreg_b32 s79, hwreg(HW_REG_HW_ID, 8, 4)
  s_getreg_b32 s46, hwreg(HW_REG_XCC_ID, 0, 3)
  s_mul_i32 s46, s46, 4352
  s_add_u32 s46, s46, 8126464
  v_lshrrev_b32 v22, 1, v20
  v_lshl_add_u32 v42, v22, 8, s46
  v_and_b32 v22, 1, v20
  v_lshl_add_u32 v42, v22, 4, v42
  s_and_b32 s45, s81, 2
  s_lshl_b32 s44, s45, 9
  s_add_u32 s44, s44, s46
  v_add_u32 v44, s44, v20
  s_lshl_b32 s45, s45, 1
  s_add_u32 s46, s46, s45
  s_add_u32 s46, s46, 2048
  v_mov_b32 v43, s46
  v_mul_u32_u24 v39, 384, v20
  v_add_u32 v39, 7864320, v39
  v_mov_b32 v40, 0
  v_mov_b32 v41, 0
  s_mov_b32 s95, 0
  s_mov_b32 s90, 0
  s_mov_b32 s80, 0
  s_mov_b64 exec, 0x3ffff
  global_store_dwordx4 v42, v[48:51], s[30:31]
  s_mov_b64 exec, -1
  v_lshrrev_b32 v22, 5, v20
  v_bfe_u32 v23, v20, 3, 2
  v_and_b32 v24, 7, v20
  v_lshl_add_u32 v33, v24, 2, v22
  v_lshl_add_u32 v33, v33, 2, v23
  s_and_b32 s44, s41, 1
  v_add_u32 v23, s44, v33
  v_cmp_le_u32 vcc, 43, v23
  s_add_u32 s45, s44, 42
  v_mov_b32 v24, s45
  v_cndmask_b32 v24, 0, v24, vcc
  v_cmp_le_u32 vcc, 86, v23
  v_add_u32 v22, v33, v24
  s_sub_u32 s45, 43, s44
  v_mov_b32 v24, s45
  v_cndmask_b32 v24, 0, v24, vcc
  s_mul_i32 s44, s44, 43
  s_lshr_b32 s45, s41, 1
  s_lshl_b32 s45, s45, 8
  s_add_u32 s44, s44, s45
  v_add3_u32 v22, v22, v24, s44
  v_and_b32 v33, 255, v22
  v_lshlrev_b32 v33, 1, v33
  v_lshrrev_b32 v22, 5, v20
  v_add_u32 v22, 2, v22
  v_bfe_u32 v23, v20, 3, 2
  v_and_b32 v24, 7, v20
  v_lshl_add_u32 v34, v24, 2, v22
  v_lshl_add_u32 v34, v34, 2, v23
  s_and_b32 s44, s41, 1
  v_add_u32 v23, s44, v34
  v_cmp_le_u32 vcc, 43, v23
  s_add_u32 s45, s44, 42
  v_mov_b32 v24, s45
  v_cndmask_b32 v24, 0, v24, vcc
  v_cmp_le_u32 vcc, 86, v23
  v_add_u32 v22, v34, v24
  s_sub_u32 s45, 43, s44
  v_mov_b32 v24, s45
  v_cndmask_b32 v24, 0, v24, vcc
  s_mul_i32 s44, s44, 43
  s_lshr_b32 s45, s41, 1
  s_lshl_b32 s45, s45, 8
  s_add_u32 s44, s44, s45
  v_add3_u32 v22, v22, v24, s44
  v_and_b32 v34, 255, v22
  v_lshlrev_b32 v34, 1, v34
  v_lshlrev_b32 v46, 2, v20
  v_mov_b32 v47, 112768
  v_mov_b32 v51, -1
  v_mov_b32 v60, 0
  v_mov_b32 v61, 0
  v_mov_b32 v62, 0
  v_mov_b32 v63, 0
  v_mov_b32 v64, 0
  v_mov_b32 v65, 0
  v_mov_b32 v66, 0
  v_mov_b32 v67, 0
  s_and_b32 s45, s2, 7
  s_lshl_b32 s45, s45, 9
  v_and_b32 v22, 31, v20
  v_lshl_add_u32 v22, v22, 4, s45
  v_lshrrev_b32 v23, 5, v20
  v_lshl_add_u32 v22, v23, 16, v22
  v_lshlrev_b32 v23, 2, v23
  s_lshr_b32 s44, s96, 0
  v_bfe_u32 v24, s44, v23, 4
  v_lshl_add_u32 v188, v24, 12, v22
  v_add_u32 v22, 0x20000, v22
  s_lshr_b32 s44, s96, 8
  v_bfe_u32 v24, s44, v23, 4
  v_lshl_add_u32 v189, v24, 12, v22
  v_add_u32 v22, 0x20000, v22
  s_lshr_b32 s44, s96, 16
  v_bfe_u32 v24, s44, v23, 4
  v_lshl_add_u32 v190, v24, 12, v22
  v_add_u32 v22, 0x20000, v22
  s_lshr_b32 s44, s96, 24
  v_bfe_u32 v24, s44, v23, 4
  v_lshl_add_u32 v191, v24, 12, v22
  v_add_u32 v22, 0x20000, v22
  s_lshr_b32 s44, s97, 0
  v_bfe_u32 v24, s44, v23, 4
  v_lshl_add_u32 v192, v24, 12, v22
  v_add_u32 v22, 0x20000, v22
  s_lshr_b32 s44, s97, 8
  v_bfe_u32 v24, s44, v23, 4
  v_lshl_add_u32 v193, v24, 12, v22
  v_add_u32 v22, 0x20000, v22
  s_lshr_b32 s44, s97, 16
  v_bfe_u32 v24, s44, v23, 4
  v_lshl_add_u32 v194, v24, 12, v22
  v_add_u32 v22, 0x20000, v22
  s_lshr_b32 s44, s97, 24
  v_bfe_u32 v24, s44, v23, 4
  v_lshl_add_u32 v195, v24, 12, v22
  s_mov_b32 s69, 0
  s_movk_i32 m0, 8704
  s_branch L_hq_nl
L_hk:
  s_sub_u32 s47, s43, 1
L_hsw:
  ds_read_b128 v[104:107], v15 offset:0
  s_waitcnt lgkmcnt(0)
  v_min_u32 v104, v104, v105
  v_min3_u32 v104, v104, v106, v107
  s_nop 0
  v_readfirstlane_b32 s46, v104
  s_cmp_ge_u32 s46, s47
  s_cbranch_scc1 L_hsw_ok
  s_cmp_eq_u32 s94, 0
  s_cbranch_scc1 L_hsw_ok
  s_sub_u32 s94, s94, 1
  s_sleep 1
  s_branch L_hsw
L_hsw_ok:
  s_bitcmp1_b32 s80, s47
  s_cbranch_scc0 L_fas
  s_lshl_b64 exec, 1, s47
  s_mul_i32 s44, s47, 384
  s_add_u32 s44, s44, 7864320
  s_mov_b32 s78, 1
  s_atomic_add s78, s[30:31], s44 glc
  s_mov_b64 exec, -1
L_fas:
  s_cmp_lt_u32 s43, 5
  s_cbranch_scc1 L_hs_done
  s_add_u32 s68, s69, 2
  s_min_u32 s68, s68, s47
L_hs:
  ds_read_u16_d16_hi v60, v33 offset:8704
  ds_read_u16_d16_hi v61, v34 offset:8704
  ds_read_u16_d16_hi v62, v33 offset:16896
  ds_read_u16_d16_hi v63, v34 offset:16896
  ds_read_u16_d16_hi v64, v33 offset:25088
  ds_read_u16_d16_hi v65, v34 offset:25088
  ds_read_u16_d16_hi v66, v33 offset:33280
  ds_read_u16_d16_hi v67, v34 offset:33280
  ds_read_b32 v72, v46 offset:41472
  ds_read_b32 v73, v46 offset:41728
  ds_read_b32 v74, v46 offset:49664
  ds_read_b32 v75, v46 offset:49920
  s_add_u32 s69, s69, 1
  s_waitcnt lgkmcnt(0)
  v_fma_f32 v72, -v62, v74, v72
  v_fma_f32 v73, -v63, v75, v73
  v_mul_f32 v74, s67, v60
  v_mul_f32 v75, s67, v61
  v_mul_f32 v72, v72, v74
  v_mul_f32 v73, v73, v75
  v_max_f32 v48, v72, v73
  s_nop 1
  v_max_f32_dpp v48, v48, v48 row_ror:8 row_mask:0xf bank_mask:0xf
  s_nop 1
  v_max_f32_dpp v48, v48, v48 row_ror:4 row_mask:0xf bank_mask:0xf
  s_nop 1
  v_max_f32_dpp v48, v48, v48 row_ror:2 row_mask:0xf bank_mask:0xf
  s_nop 1
  v_max_f32_dpp v48, v48, v48 row_ror:1 row_mask:0xf bank_mask:0xf
  v_mov_b32 v22, v48
  s_nop 1
  v_permlane16_swap_b32 v48, v22
  v_max_f32 v48, v48, v22
  v_mov_b32 v22, v48
  s_nop 1
  v_permlane32_swap_b32 v48, v22
  v_max_f32 v48, v48, v22
  v_sub_f32 v72, v72, v48
  v_sub_f32 v73, v73, v48
  v_exp_f32 v72, v72
  v_exp_f32 v73, v73
  s_nop 0
  v_add_f32 v49, v72, v73
  v_mul_f32 v72, v72, v64
  v_mul_f32 v73, v73, v65
  v_mul_f32 v50, v72, v66
  v_fmac_f32 v50, v73, v67
  ds_write_b32 v46, v72 offset:41472
  ds_write_b32 v46, v73 offset:41728
  s_nop 1
  v_add_f32_dpp v49, v49, v49 row_ror:8 row_mask:0xf bank_mask:0xf
  s_nop 1
  v_add_f32_dpp v49, v49, v49 row_ror:4 row_mask:0xf bank_mask:0xf
  s_nop 1
  v_add_f32_dpp v49, v49, v49 row_ror:2 row_mask:0xf bank_mask:0xf
  s_nop 1
  v_add_f32_dpp v49, v49, v49 row_ror:1 row_mask:0xf bank_mask:0xf
  v_mov_b32 v22, v49
  s_nop 1
  v_permlane16_swap_b32 v49, v22
  v_add_f32 v49, v49, v22
  v_mov_b32 v22, v49
  s_nop 1
  v_permlane32_swap_b32 v49, v22
  v_add_f32 v49, v49, v22
  s_nop 1
  v_add_f32_dpp v50, v50, v50 row_ror:8 row_mask:0xf bank_mask:0xf
  s_nop 1
  v_add_f32_dpp v50, v50, v50 row_ror:4 row_mask:0xf bank_mask:0xf
  s_nop 1
  v_add_f32_dpp v50, v50, v50 row_ror:2 row_mask:0xf bank_mask:0xf
  s_nop 1
  v_add_f32_dpp v50, v50, v50 row_ror:1 row_mask:0xf bank_mask:0xf
  v_mov_b32 v22, v50
  s_nop 1
  v_permlane16_swap_b32 v50, v22
  v_add_f32 v50, v50, v22
  v_mov_b32 v22, v50
  s_nop 1
  v_permlane32_swap_b32 v50, v22
  v_add_f32 v50, v50, v22
  v_mov_b32 v22, s69
  ds_write_b128 v47, v[48:51]
  ds_write_b32 v15, v22 offset:20
  v_add_u32 v46, 512, v46
  v_add_u32 v47, 16, v47
  v_add_u32 v33, 512, v33
  v_add_u32 v34, 512, v34
  s_cmp_lt_u32 s69, s68
  s_cbranch_scc1 L_hs
L_hs_done:
  s_bitcmp1_b32 s80, s47
  s_cbranch_scc0 L_fbs
  s_waitcnt vmcnt(0) lgkmcnt(0)
  v_sub_u32 v42, s78, v40
  s_nop 0
  v_readlane_b32 s46, v42, s47
  s_min_u32 s46, s46, 15
  s_lshl_b32 s46, s46, 1
  s_sub_u32 s46, s46, 15
  s_cmp_le_u32 s47, 0
  s_cselect_b32 s44, 9, 7
  s_mul_i32 s46, s46, s44
  s_add_u32 s46, s46, s95
  s_add_u32 s46, s46, 8
  s_ashr_i32 s46, s46, 4
  v_mov_b32 v42, s46
  s_mov_b64 exec, 1
  global_store_dword v43, v42, s[30:31]
  s_mov_b64 exec, -1
L_fbs:
  s_cmp_eq_u32 s47, 1
  s_cbranch_scc0 L_el
  s_bitcmp0_b32 s81, 0
  s_cbranch_scc0 L_el
  s_mov_b64 exec, 0xffff
  global_load_ubyte v42, v44, s[30:31] sc1
  s_waitcnt vmcnt(0)
  v_cmp_ne_u32 s[64:65], 0, v42
  s_lshr_b32 s44, s64, s79
  s_bcnt1_i32_b32 s44, s44
  s_sub_u32 s45, s44, 1
  s_cmp_lt_u32 s45, 7
  s_cbranch_scc0 L_el
  s_lshl_b32 s80, 0x10204081, s45
  s_and_b32 s80, s80, 0x7d555554
  s_mov_b32 exec_lo, s80
  global_load_dword v40, v39, s[30:31] sc1
  s_cmp_eq_u32 s44, 4
  s_cbranch_scc0 L_el
  s_mov_b64 exec, -1
  s_getpc_b64 s[64:65]
L_pc2:
  s_sub_u32 s64, s64, L_pc2-L_vpre
  s_subb_u32 s65, s65, 0
  v_lshlrev_b32 v42, 7, v20
  global_load_dword v112, v42, s[64:65]
  v_add_u32 v42, L_order-L_vpre-8192, v42
  global_load_dword v113, v42, s[64:65]
L_el:
  s_mov_b64 exec, -1
L_hq:
  s_add_u32 s43, s43, 1
  s_cmp_gt_u32 s43, 16
  s_cbranch_scc1 L_hq_skip
  s_waitcnt vmcnt(0)
  v_lshlrev_b32 v76, 16, v68
  v_and_b32 v77, s66, v68
  v_lshlrev_b32 v78, 16, v69
  v_and_b32 v79, s66, v69
  v_lshlrev_b32 v80, 16, v70
  v_and_b32 v81, s66, v70
  v_lshlrev_b32 v82, 16, v71
  v_and_b32 v83, s66, v71
  v_mul_f32 v76, v76, v52
  v_mul_f32 v77, v77, v53
  v_mul_f32 v78, v78, v54
  v_mul_f32 v79, v79, v55
  v_mul_f32 v80, v80, v56
  v_mul_f32 v81, v81, v57
  v_mul_f32 v82, v82, v58
  v_mul_f32 v83, v83, v59
  v_cvt_pk_bf16_f32 v84, v76, v80
  v_cvt_pk_bf16_f32 v85, v77, v81
  v_cvt_pk_bf16_f32 v86, v78, v82
  v_cvt_pk_bf16_f32 v87, v79, v83
  v_lshlrev_b32 v76, 16, v84
  v_and_b32 v80, s66, v84
  v_lshlrev_b32 v77, 16, v85
  v_and_b32 v81, s66, v85
  v_lshlrev_b32 v78, 16, v86
  v_and_b32 v82, s66, v86
  v_lshlrev_b32 v79, 16, v87
  v_and_b32 v83, s66, v87
  v_fma_f32 v76, v80, v30, v76
  v_fma_f32 v77, v81, v30, v77
  v_fma_f32 v78, v82, v30, v78
  v_fma_f32 v79, v83, v30, v79
  v_cvt_pk_bf16_f32 v84, v76, v77
  v_cvt_pk_bf16_f32 v85, v78, v79
  v_xor_b32 v86, v31, v84
  v_xor_b32 v87, v31, v85
  v_and_b32 v76, 0xffff, v84
  v_and_b32 v77, s66, v84
  v_and_b32 v78, 0xffff, v85
  v_and_b32 v79, s66, v85
  v_and_b32 v80, 0xffff, v86
  v_and_b32 v81, s66, v86
  v_and_b32 v82, 0xffff, v87
  v_and_b32 v83, s66, v87
  v_mov_b32 v22, s43
  ds_write_b128 v28, v[76:79] offset:512
  ds_write_b128 v29, v[80:83] offset:1280
  ds_write_b32 v15, v22 offset:16
  v_add_u32 v28, 2048, v28
  v_add_u32 v29, 2048, v29
  v_and_b32 v28, 0x1fff, v28
  v_and_b32 v29, 0x1fff, v29
  s_cmp_eq_u32 s43, 16
  s_cbranch_scc1 L_hq_nl
  s_lshl_b32 s44, s43, 2
  s_lshr_b64 s[64:65], s[96:97], s44
  s_and_b32 s64, s64, 15
  s_lshl4_add_u32 s68, s43, s64
  s_mul_i32 s44, s68, 384
  s_add_u32 s32, s4, s44
  s_addc_u32 s33, s5, 0
  global_load_dwordx2 v[68:69], v26, s[32:33]
  global_load_dwordx2 v[70:71], v27, s[32:33]
L_hq_nl:
  s_sub_u32 s44, s43, 4
  s_cmp_lt_u32 s44, 2
  s_cbranch_scc0 L_sc_done
  global_load_lds_dwordx4 v188, s[8:9]
  s_addk_i32 m0, 1024
  s_waitcnt vmcnt(3)
  global_load_lds_dwordx4 v189, s[8:9]
  s_addk_i32 m0, 1024
  s_waitcnt vmcnt(3)
  global_load_lds_dwordx4 v190, s[8:9]
  s_addk_i32 m0, 1024
  s_waitcnt vmcnt(3)
  global_load_lds_dwordx4 v191, s[8:9]
  s_addk_i32 m0, 1024
  s_waitcnt vmcnt(3)
  global_load_lds_dwordx4 v192, s[8:9]
  s_addk_i32 m0, 1024
  s_waitcnt vmcnt(3)
  global_load_lds_dwordx4 v193, s[8:9]
  s_addk_i32 m0, 1024
  s_waitcnt vmcnt(3)
  global_load_lds_dwordx4 v194, s[8:9]
  s_addk_i32 m0, 1024
  s_waitcnt vmcnt(3)
  global_load_lds_dwordx4 v195, s[8:9]
  s_addk_i32 m0, 1024
  s_mov_b64 s[8:9], s[10:11]
  s_mov_b64 s[10:11], s[14:15]
  s_mov_b64 s[14:15], s[16:17]
  s_waitcnt vmcnt(3)
  global_load_lds_dwordx4 v188, s[8:9]
  s_addk_i32 m0, 1024
  s_waitcnt vmcnt(3)
  global_load_lds_dwordx4 v189, s[8:9]
  s_addk_i32 m0, 1024
  s_waitcnt vmcnt(3)
  global_load_lds_dwordx4 v190, s[8:9]
  s_addk_i32 m0, 1024
  s_waitcnt vmcnt(3)
  global_load_lds_dwordx4 v191, s[8:9]
  s_addk_i32 m0, 1024
  s_waitcnt vmcnt(3)
  global_load_lds_dwordx4 v192, s[8:9]
  s_addk_i32 m0, 1024
  s_waitcnt vmcnt(3)
  global_load_lds_dwordx4 v193, s[8:9]
  s_addk_i32 m0, 1024
  s_waitcnt vmcnt(3)
  global_load_lds_dwordx4 v194, s[8:9]
  s_addk_i32 m0, 1024
  s_waitcnt vmcnt(3)
  global_load_lds_dwordx4 v195, s[8:9]
  s_addk_i32 m0, 1024
  s_mov_b64 s[8:9], s[10:11]
  s_mov_b64 s[10:11], s[14:15]
  s_mov_b64 s[14:15], s[16:17]
  s_cmp_eq_u32 s43, 5
  s_cbranch_scc0 L_sc_done
  s_waitcnt vmcnt(0)
L_sc_done:
  s_cmp_eq_u32 s43, 16
  s_cbranch_scc0 L_hq_skip
  s_cmp_eq_u32 s3, 0
  s_cbranch_scc0 L_hq_skip
  s_mov_b64 exec, 7
  global_store_dword v45, v15, s[30:31] sc1
  s_waitcnt vmcnt(0)
  s_mov_b64 exec, 1
  global_store_dword v37, v38, s[28:29] sc1
  s_mov_b64 exec, -1
L_hq_skip:
  s_waitcnt lgkmcnt(0)
  s_cmp_lt_u32 s43, 18
  s_cbranch_scc1 L_hk
  v_and_b32 v24, 15, v20
  v_lshlrev_b32 v24, 1, v24
  global_load_ushort v25, v24, s[82:83] offset:32
  s_mov_b32 s43, 0
  v_min_u32 v28, 23, v20
  v_lshlrev_b32 v28, 4, v28
  v_lshlrev_b32 v22, 1, v28
  v_add_u32 v22, 57856, v22
  v_add_u32 v28, 107008, v28
  v_lshlrev_b32 v32, 4, v20
  v_add_u32 v30, 107008, v32
  v_cmp_gt_u32 vcc, 24, v20
  v_lshrrev_b32 v21, 1, v35
  s_mul_i32 s44, s98, 384
  s_add_u32 s26, s26, s44
  s_addc_u32 s27, s27, 0
  v_mov_b32 v31, s2
  v_mul_u32_u24 v31, 6144, v31
  v_add_u32 v31, 8388608, v31
  v_add_u32 v23, 0, v32
  v_add_u32 v188, v23, v31
  v_add_u32 v23, 1024, v32
  v_add_u32 v189, v23, v31
  v_add_u32 v23, 2048, v32
  v_add_u32 v190, v23, v31
  v_add_u32 v23, 3072, v32
  v_add_u32 v191, v23, v31
  v_add_u32 v23, 4096, v32
  v_add_u32 v192, v23, v31
  v_add_u32 v23, 5120, v32
  v_add_u32 v193, v23, v31
  s_mov_b32 s45, 14
  s_lshl_b32 s68, s45, 2
  s_lshr_b64 s[64:65], s[92:93], s68
  s_and_b32 s68, s64, 15
  v_lshl_add_u32 v23, s68, 4, v32
  v_cndmask_b32 v23, v23, v32, vcc
  v_add_u32 v23, 5376, v23
  v_add_u32 v168, v23, v31
  s_waitcnt vmcnt(0)
  v_lshrrev_b32 v31, 4, v25
  v_mul_u32_u24 v31, 6144, v31
  v_add_u32 v31, 8388608, v31
  v_and_b32 v25, 15, v25
  v_mul_u32_u24 v25, 384, v25
  s_lshl4_add_u32 s44, s3, 5760
  v_mov_b32 v23, s44
  v_add_u32 v187, v23, v31
  v_add_u32_dpp v23, v25, v21 row_newbcast:0 row_mask:0xf bank_mask:0xf
  v_mov_b32_dpp v29, v31 row_newbcast:0 row_mask:0xf bank_mask:0xf
  v_add_u32 v172, v23, v29
  v_add_u32_dpp v23, v25, v21 row_newbcast:1 row_mask:0xf bank_mask:0xf
  v_mov_b32_dpp v29, v31 row_newbcast:1 row_mask:0xf bank_mask:0xf
  v_add_u32 v173, v23, v29
  v_add_u32_dpp v23, v25, v21 row_newbcast:2 row_mask:0xf bank_mask:0xf
  v_mov_b32_dpp v29, v31 row_newbcast:2 row_mask:0xf bank_mask:0xf
  v_add_u32 v174, v23, v29
  v_add_u32_dpp v23, v25, v21 row_newbcast:3 row_mask:0xf bank_mask:0xf
  v_mov_b32_dpp v29, v31 row_newbcast:3 row_mask:0xf bank_mask:0xf
  v_add_u32 v175, v23, v29
  v_add_u32_dpp v23, v25, v21 row_newbcast:4 row_mask:0xf bank_mask:0xf
  v_mov_b32_dpp v29, v31 row_newbcast:4 row_mask:0xf bank_mask:0xf
  v_add_u32 v176, v23, v29
  v_add_u32_dpp v23, v25, v21 row_newbcast:5 row_mask:0xf bank_mask:0xf
  v_mov_b32_dpp v29, v31 row_newbcast:5 row_mask:0xf bank_mask:0xf
  v_add_u32 v177, v23, v29
  v_add_u32_dpp v23, v25, v21 row_newbcast:6 row_mask:0xf bank_mask:0xf
  v_mov_b32_dpp v29, v31 row_newbcast:6 row_mask:0xf bank_mask:0xf
  v_add_u32 v178, v23, v29
  v_add_u32_dpp v23, v25, v21 row_newbcast:7 row_mask:0xf bank_mask:0xf
  v_mov_b32_dpp v29, v31 row_newbcast:7 row_mask:0xf bank_mask:0xf
  v_add_u32 v179, v23, v29
  v_add_u32_dpp v23, v25, v21 row_newbcast:8 row_mask:0xf bank_mask:0xf
  v_mov_b32_dpp v29, v31 row_newbcast:8 row_mask:0xf bank_mask:0xf
  v_add_u32 v180, v23, v29
  v_add_u32_dpp v23, v25, v21 row_newbcast:9 row_mask:0xf bank_mask:0xf
  v_mov_b32_dpp v29, v31 row_newbcast:9 row_mask:0xf bank_mask:0xf
  v_add_u32 v181, v23, v29
  v_add_u32_dpp v23, v25, v21 row_newbcast:10 row_mask:0xf bank_mask:0xf
  v_mov_b32_dpp v29, v31 row_newbcast:10 row_mask:0xf bank_mask:0xf
  v_add_u32 v182, v23, v29
  v_add_u32_dpp v23, v25, v21 row_newbcast:11 row_mask:0xf bank_mask:0xf
  v_mov_b32_dpp v29, v31 row_newbcast:11 row_mask:0xf bank_mask:0xf
  v_add_u32 v183, v23, v29
  v_add_u32_dpp v23, v25, v21 row_newbcast:12 row_mask:0xf bank_mask:0xf
  v_mov_b32_dpp v29, v31 row_newbcast:12 row_mask:0xf bank_mask:0xf
  v_add_u32 v184, v23, v29
  v_add_u32_dpp v23, v25, v21 row_newbcast:13 row_mask:0xf bank_mask:0xf
  v_mov_b32_dpp v29, v31 row_newbcast:13 row_mask:0xf bank_mask:0xf
  v_add_u32 v185, v23, v29
  v_add_u32_dpp v23, v25, v21 row_newbcast:14 row_mask:0xf bank_mask:0xf
  v_mov_b32_dpp v29, v31 row_newbcast:14 row_mask:0xf bank_mask:0xf
  v_add_u32 v186, v23, v29
  v_mov_b32 v108, -1
  v_mov_b32 v109, -1
  v_mov_b32 v110, -1
  v_mov_b32 v111, -1
  s_lshl4_add_u32 s44, s3, 112768
  v_mov_b32 v23, s44
  ds_write_b128 v28, v[108:111] offset:5376
  ds_write_b32 v23, v38 offset:12
L_hp:
  s_min_u32 s44, s3, 13
  s_cmp_eq_u32 s44, s43
  s_cbranch_scc0 L_hc_ok
L_hc:
  global_load_dword v104, v37, s[28:29] sc1
  s_waitcnt vmcnt(0)
  v_cmp_ne_u32 s[64:65], 1, v104
  s_cmp_eq_u64 s[64:65], 0
  s_cbranch_scc1 L_hc_ok
  s_cmp_eq_u32 s94, 0
  s_cbranch_scc1 L_hc_ok
  s_sub_u32 s94, s94, 1
  s_sleep 64
  s_branch L_hc
L_hc_ok:
  s_lshl_b32 s68, s43, 2
  s_lshr_b64 s[64:65], s[92:93], s68
  s_and_b32 s68, s64, 15
  s_lshl4_add_u32 s44, s68, 112768
  v_mov_b32 v23, s44
  s_cmp_eq_u32 s43, 14
  s_cbranch_scc0 L_hp_mid
  ds_read_b128 v[144:147], v30 offset:0
  ds_read_b128 v[148:151], v30 offset:1024
  ds_read_b128 v[152:155], v30 offset:2048
  ds_read_b128 v[156:159], v30 offset:3072
  ds_read_b128 v[160:163], v30 offset:4096
  ds_read_b128 v[164:167], v30 offset:5120
L_hm:
  ds_read_b32 v104, v15 offset:24
  s_waitcnt lgkmcnt(0)
  v_readfirstlane_b32 s46, v104
  s_cmp_ge_u32 s46, 14
  s_cbranch_scc1 L_hm_ok
  s_cmp_eq_u32 s94, 0
  s_cbranch_scc1 L_hm_ok
  s_sub_u32 s94, s94, 1
  s_sleep 1
  s_branch L_hm
L_hm_ok:
  global_store_dwordx4 v188, v[144:147], s[30:31] sc1
  global_store_dwordx4 v189, v[148:151], s[30:31] sc1
  global_store_dwordx4 v190, v[152:155], s[30:31] sc1
  global_store_dwordx4 v191, v[156:159], s[30:31] sc1
  global_store_dwordx4 v192, v[160:163], s[30:31] sc1
  s_mov_b32 exec_hi, 0xffffff
  global_store_dwordx4 v193, v[164:167], s[30:31] sc1
  s_mov_b64 exec, 7
  s_waitcnt vmcnt(0)
  global_atomic_add v36, v38, s[30:31] sc1
  s_mov_b64 exec, -1
L_hp_mid:
  s_add_u32 s43, s43, 1
  s_add_u32 s47, s43, 16
L_hpw:
  ds_read_b128 v[104:107], v15 offset:0
  s_waitcnt lgkmcnt(0)
  v_min_u32 v104, v104, v105
  v_min3_u32 v104, v104, v106, v107
  s_nop 0
  v_readfirstlane_b32 s46, v104
  s_cmp_ge_u32 s46, s47
  s_cbranch_scc1 L_hpw_ok
  s_cmp_eq_u32 s94, 0
  s_cbranch_scc1 L_hpw_ok
  s_sub_u32 s94, s94, 1
  s_sleep 1
  s_branch L_hpw
L_hpw_ok:
  s_bitcmp1_b32 s80, s47
  s_cbranch_scc0 L_fap
  s_lshl_b64 exec, 1, s47
  s_mul_i32 s44, s47, 384
  s_add_u32 s44, s44, 7864320
  s_mov_b32 s78, 1
  s_atomic_add s78, s[30:31], s44 glc
  s_mov_b64 exec, -1
L_fap:
  ds_read_b128 v[72:75], v22 offset:0
  ds_read_b128 v[76:79], v22 offset:16
  ds_read_b128 v[80:83], v22 offset:768
  ds_read_b128 v[84:87], v22 offset:784
  ds_read_b128 v[88:91], v22 offset:1536
  ds_read_b128 v[92:95], v22 offset:1552
  ds_read_b128 v[96:99], v22 offset:2304
  ds_read_b128 v[100:103], v22 offset:2320
  ds_read_b128 v[48:51], v23
  s_waitcnt lgkmcnt(0)
  v_pk_add_f32 v[72:73], v[72:73], v[80:81]
  v_pk_add_f32 v[88:89], v[88:89], v[96:97]
  v_pk_add_f32 v[74:75], v[74:75], v[82:83]
  v_pk_add_f32 v[90:91], v[90:91], v[98:99]
  v_pk_add_f32 v[76:77], v[76:77], v[84:85]
  v_pk_add_f32 v[92:93], v[92:93], v[100:101]
  v_pk_add_f32 v[78:79], v[78:79], v[86:87]
  v_pk_add_f32 v[94:95], v[94:95], v[102:103]
  v_pk_add_f32 v[72:73], v[72:73], v[88:89]
  v_pk_add_f32 v[74:75], v[74:75], v[90:91]
  v_pk_add_f32 v[76:77], v[76:77], v[92:93]
  v_pk_add_f32 v[78:79], v[78:79], v[94:95]
  v_pk_add_f32 v[72:73], v[72:73], v[50:51] op_sel_hi:[1,0] neg_lo:[0,1] neg_hi:[0,1]
  v_pk_add_f32 v[74:75], v[74:75], v[50:51] op_sel_hi:[1,0] neg_lo:[0,1] neg_hi:[0,1]
  v_pk_add_f32 v[76:77], v[76:77], v[50:51] op_sel_hi:[1,0] neg_lo:[0,1] neg_hi:[0,1]
  v_pk_add_f32 v[78:79], v[78:79], v[50:51] op_sel_hi:[1,0] neg_lo:[0,1] neg_hi:[0,1]
  v_max3_f32 v25, |v72|, |v73|, |v74|
  v_max3_f32 v25, v25, |v75|, |v76|
  v_max3_f32 v25, v25, |v77|, |v78|
  v_max_f32_e64 v25, v25, |v79|
  s_nop 1
  v_max_f32_dpp v25, v25, v25 row_ror:8 row_mask:0xf bank_mask:0xf
  s_nop 1
  v_max_f32_dpp v25, v25, v25 row_ror:4 row_mask:0xf bank_mask:0xf
  s_nop 1
  v_max_f32_dpp v25, v25, v25 row_ror:2 row_mask:0xf bank_mask:0xf
  s_nop 1
  v_max_f32_dpp v25, v25, v25 row_ror:1 row_mask:0xf bank_mask:0xf
  v_mov_b32 v29, v25
  s_nop 1
  v_permlane16_swap_b32 v25, v29
  v_max_f32 v25, v25, v29
  v_mov_b32 v29, v25
  s_nop 1
  v_permlane32_swap_b32 v25, v29
  v_max_f32 v25, v25, v29
  v_frexp_exp_i32_f32 v25, v25
  v_sub_u32 v29, 14, v25
  v_add_u32 v51, 242, v25
  v_ldexp_f32 v72, v72, v29
  v_ldexp_f32 v73, v73, v29
  v_ldexp_f32 v74, v74, v29
  v_ldexp_f32 v75, v75, v29
  v_ldexp_f32 v76, v76, v29
  v_ldexp_f32 v77, v77, v29
  v_ldexp_f32 v78, v78, v29
  v_ldexp_f32 v79, v79, v29
  v_cvt_pk_f16_f32 v108, v72, v73
  v_cvt_pk_f16_f32 v109, v74, v75
  v_cvt_pk_f16_f32 v110, v76, v77
  v_cvt_pk_f16_f32 v111, v78, v79
  v_min_u32 v108, -2, v108
  v_min_u32 v109, -2, v109
  v_min_u32 v110, -2, v110
  v_min_u32 v111, -2, v111
  s_cmp_eq_u32 s43, 15
  s_cbranch_scc1 L_hp_last
  ds_write_b32 v23, v51 offset:12
  v_add_u32 v22, 3072, v22
  ds_write_b128 v28, v[108:111]
  v_add_u32 v28, 384, v28
  s_bitcmp1_b32 s80, s47
  s_cbranch_scc0 L_fbp
  s_waitcnt vmcnt(0) lgkmcnt(0)
  v_sub_u32 v42, s78, v40
  s_nop 0
  v_readlane_b32 s46, v42, s47
  s_min_u32 s46, s46, 15
  s_lshl_b32 s46, s46, 1
  s_sub_u32 s46, s46, 15
  s_cmp_le_u32 s47, 0
  s_cselect_b32 s44, 9, 7
  s_mul_i32 s46, s46, s44
  s_add_u32 s46, s46, s95
  s_add_u32 s46, s46, 8
  s_ashr_i32 s46, s46, 4
  v_mov_b32 v42, s46
  s_mov_b64 exec, 1
  global_store_dword v43, v42, s[30:31]
  s_mov_b64 exec, -1
L_fbp:
  s_branch L_hp
L_hp_last:
  v_cndmask_b32 v108, v48, v108, vcc
  v_cndmask_b32 v109, v49, v109, vcc
  v_cndmask_b32 v110, v50, v110, vcc
  v_cndmask_b32 v111, v51, v111, vcc
  s_mov_b64 exec, 0x1ffffff
  global_store_dwordx4 v168, v[108:111], s[30:31] sc1
  s_mov_b64 exec, 1
L_hw:
  global_atomic_add v68, v36, v15, s[30:31] sc0 sc1
  s_waitcnt vmcnt(0)
  v_readfirstlane_b32 s46, v68
  s_cmp_ge_u32 s46, 16
  s_cbranch_scc1 L_hw_ok
  s_cmp_eq_u32 s94, 0
  s_cbranch_scc1 L_hw_ok
  s_sub_u32 s94, s94, 1
  s_branch L_hw
L_hw_ok:
  s_mov_b64 exec, -1
L_hg:
  global_load_dwordx4 v[52:55], v187, s[30:31] sc1
  global_load_dwordx2 v[112:113], v172, s[30:31] sc1
  global_load_dwordx2 v[114:115], v173, s[30:31] sc1
  global_load_dwordx2 v[116:117], v174, s[30:31] sc1
  global_load_dwordx2 v[118:119], v175, s[30:31] sc1
  global_load_dwordx2 v[120:121], v176, s[30:31] sc1
  global_load_dwordx2 v[122:123], v177, s[30:31] sc1
  global_load_dwordx2 v[124:125], v178, s[30:31] sc1
  global_load_dwordx2 v[126:127], v179, s[30:31] sc1
  global_load_dwordx2 v[128:129], v180, s[30:31] sc1
  global_load_dwordx2 v[130:131], v181, s[30:31] sc1
  global_load_dwordx2 v[132:133], v182, s[30:31] sc1
  global_load_dwordx2 v[134:135], v183, s[30:31] sc1
  global_load_dwordx2 v[136:137], v184, s[30:31] sc1
  global_load_dwordx2 v[138:139], v185, s[30:31] sc1
  global_load_dwordx2 v[140:141], v186, s[30:31] sc1
  s_waitcnt vmcnt(0)
  v_mov_b32 v24, v55
  v_max3_u32 v24, v24, v112, v113
  v_max3_u32 v24, v24, v114, v115
  v_max3_u32 v24, v24, v116, v117
  v_max3_u32 v24, v24, v118, v119
  v_max3_u32 v24, v24, v120, v121
  v_max3_u32 v24, v24, v122, v123
  v_max3_u32 v24, v24, v124, v125
  v_max3_u32 v24, v24, v126, v127
  v_max3_u32 v24, v24, v128, v129
  v_max3_u32 v24, v24, v130, v131
  v_max3_u32 v24, v24, v132, v133
  v_max3_u32 v24, v24, v134, v135
  v_max3_u32 v24, v24, v136, v137
  v_max3_u32 v24, v24, v138, v139
  v_max3_u32 v24, v24, v140, v141
  v_cmp_eq_u32 s[64:65], -1, v24
  s_cmp_eq_u64 s[64:65], 0
  s_cbranch_scc1 L_hg_ok
  s_cmp_eq_u32 s94, 0
  s_cbranch_scc1 L_hg_ok
  s_sub_u32 s94, s94, 1
  s_branch L_hg
L_hg_ok:
  v_add_u32 v22, 103936, v35
  v_mov_b32 v24, v52
  s_nop 1
  v_max_f32_dpp v24, v24, v24 row_ror:8 row_mask:0xf bank_mask:0xf
  s_nop 1
  v_max_f32_dpp v24, v24, v24 row_ror:4 row_mask:0xf bank_mask:0xf
  s_nop 1
  v_max_f32_dpp v24, v24, v24 row_ror:2 row_mask:0xf bank_mask:0xf
  s_nop 1
  v_max_f32_dpp v24, v24, v24 row_ror:1 row_mask:0xf bank_mask:0xf
  v_sub_f32 v24, v52, v24
  v_exp_f32 v24, v24
  v_subrev_u32 v55, 256, v55
  v_mul_f32 v25, v24, v53
  s_nop 1
  v_add_f32_dpp v25, v25, v25 row_ror:8 row_mask:0xf bank_mask:0xf
  s_nop 1
  v_add_f32_dpp v25, v25, v25 row_ror:4 row_mask:0xf bank_mask:0xf
  s_nop 1
  v_add_f32_dpp v25, v25, v25 row_ror:2 row_mask:0xf bank_mask:0xf
  s_nop 1
  v_add_f32_dpp v25, v25, v25 row_ror:1 row_mask:0xf bank_mask:0xf
  v_rcp_f32 v25, v25
  s_nop 0
  v_mul_f32 v24, v24, v25
  v_ldexp_f32 v25, v24, v55
  v_mul_f32_e64 v54, v24, -v54
  v_readlane_b32 s63, v24, 15
  v_readlane_b32 s44, v54, 15
  v_readlane_b32 s48, v25, 0
  v_readlane_b32 s49, v25, 1
  v_readlane_b32 s50, v25, 2
  v_readlane_b32 s51, v25, 3
  v_readlane_b32 s52, v25, 4
  v_readlane_b32 s53, v25, 5
  v_readlane_b32 s54, v25, 6
  v_readlane_b32 s55, v25, 7
  v_readlane_b32 s56, v25, 8
  v_readlane_b32 s57, v25, 9
  v_readlane_b32 s58, v25, 10
  v_readlane_b32 s59, v25, 11
  v_readlane_b32 s60, v25, 12
  v_readlane_b32 s61, v25, 13
  v_readlane_b32 s62, v25, 14
  v_mov_b32 v108, s44
  v_mov_b32 v109, s44
  v_mov_b32 v110, s44
  v_mov_b32 v111, s44
  v_fma_mix_f32 v108, v112, s48, v108 op_sel:[0,0,0] op_sel_hi:[1,0,0]
  v_fma_mix_f32 v109, v112, s48, v109 op_sel:[1,0,0] op_sel_hi:[1,0,0]
  v_fma_mix_f32 v110, v113, s48, v110 op_sel:[0,0,0] op_sel_hi:[1,0,0]
  v_fma_mix_f32 v111, v113, s48, v111 op_sel:[1,0,0] op_sel_hi:[1,0,0]
  v_fma_mix_f32 v108, v114, s49, v108 op_sel:[0,0,0] op_sel_hi:[1,0,0]
  v_fma_mix_f32 v109, v114, s49, v109 op_sel:[1,0,0] op_sel_hi:[1,0,0]
  v_fma_mix_f32 v110, v115, s49, v110 op_sel:[0,0,0] op_sel_hi:[1,0,0]
  v_fma_mix_f32 v111, v115, s49, v111 op_sel:[1,0,0] op_sel_hi:[1,0,0]
  v_fma_mix_f32 v108, v116, s50, v108 op_sel:[0,0,0] op_sel_hi:[1,0,0]
  v_fma_mix_f32 v109, v116, s50, v109 op_sel:[1,0,0] op_sel_hi:[1,0,0]
  v_fma_mix_f32 v110, v117, s50, v110 op_sel:[0,0,0] op_sel_hi:[1,0,0]
  v_fma_mix_f32 v111, v117, s50, v111 op_sel:[1,0,0] op_sel_hi:[1,0,0]
  v_fma_mix_f32 v108, v118, s51, v108 op_sel:[0,0,0] op_sel_hi:[1,0,0]
  v_fma_mix_f32 v109, v118, s51, v109 op_sel:[1,0,0] op_sel_hi:[1,0,0]
  v_fma_mix_f32 v110, v119, s51, v110 op_sel:[0,0,0] op_sel_hi:[1,0,0]
  v_fma_mix_f32 v111, v119, s51, v111 op_sel:[1,0,0] op_sel_hi:[1,0,0]
  v_fma_mix_f32 v108, v120, s52, v108 op_sel:[0,0,0] op_sel_hi:[1,0,0]
  v_fma_mix_f32 v109, v120, s52, v109 op_sel:[1,0,0] op_sel_hi:[1,0,0]
  v_fma_mix_f32 v110, v121, s52, v110 op_sel:[0,0,0] op_sel_hi:[1,0,0]
  v_fma_mix_f32 v111, v121, s52, v111 op_sel:[1,0,0] op_sel_hi:[1,0,0]
  v_fma_mix_f32 v108, v122, s53, v108 op_sel:[0,0,0] op_sel_hi:[1,0,0]
  v_fma_mix_f32 v109, v122, s53, v109 op_sel:[1,0,0] op_sel_hi:[1,0,0]
  v_fma_mix_f32 v110, v123, s53, v110 op_sel:[0,0,0] op_sel_hi:[1,0,0]
  v_fma_mix_f32 v111, v123, s53, v111 op_sel:[1,0,0] op_sel_hi:[1,0,0]
  v_fma_mix_f32 v108, v124, s54, v108 op_sel:[0,0,0] op_sel_hi:[1,0,0]
  v_fma_mix_f32 v109, v124, s54, v109 op_sel:[1,0,0] op_sel_hi:[1,0,0]
  v_fma_mix_f32 v110, v125, s54, v110 op_sel:[0,0,0] op_sel_hi:[1,0,0]
  v_fma_mix_f32 v111, v125, s54, v111 op_sel:[1,0,0] op_sel_hi:[1,0,0]
  v_fma_mix_f32 v108, v126, s55, v108 op_sel:[0,0,0] op_sel_hi:[1,0,0]
  v_fma_mix_f32 v109, v126, s55, v109 op_sel:[1,0,0] op_sel_hi:[1,0,0]
  v_fma_mix_f32 v110, v127, s55, v110 op_sel:[0,0,0] op_sel_hi:[1,0,0]
  v_fma_mix_f32 v111, v127, s55, v111 op_sel:[1,0,0] op_sel_hi:[1,0,0]
  v_fma_mix_f32 v108, v128, s56, v108 op_sel:[0,0,0] op_sel_hi:[1,0,0]
  v_fma_mix_f32 v109, v128, s56, v109 op_sel:[1,0,0] op_sel_hi:[1,0,0]
  v_fma_mix_f32 v110, v129, s56, v110 op_sel:[0,0,0] op_sel_hi:[1,0,0]
  v_fma_mix_f32 v111, v129, s56, v111 op_sel:[1,0,0] op_sel_hi:[1,0,0]
  v_fma_mix_f32 v108, v130, s57, v108 op_sel:[0,0,0] op_sel_hi:[1,0,0]
  v_fma_mix_f32 v109, v130, s57, v109 op_sel:[1,0,0] op_sel_hi:[1,0,0]
  v_fma_mix_f32 v110, v131, s57, v110 op_sel:[0,0,0] op_sel_hi:[1,0,0]
  v_fma_mix_f32 v111, v131, s57, v111 op_sel:[1,0,0] op_sel_hi:[1,0,0]
  v_fma_mix_f32 v108, v132, s58, v108 op_sel:[0,0,0] op_sel_hi:[1,0,0]
  v_fma_mix_f32 v109, v132, s58, v109 op_sel:[1,0,0] op_sel_hi:[1,0,0]
  v_fma_mix_f32 v110, v133, s58, v110 op_sel:[0,0,0] op_sel_hi:[1,0,0]
  v_fma_mix_f32 v111, v133, s58, v111 op_sel:[1,0,0] op_sel_hi:[1,0,0]
  v_fma_mix_f32 v108, v134, s59, v108 op_sel:[0,0,0] op_sel_hi:[1,0,0]
  v_fma_mix_f32 v109, v134, s59, v109 op_sel:[1,0,0] op_sel_hi:[1,0,0]
  v_fma_mix_f32 v110, v135, s59, v110 op_sel:[0,0,0] op_sel_hi:[1,0,0]
  v_fma_mix_f32 v111, v135, s59, v111 op_sel:[1,0,0] op_sel_hi:[1,0,0]
  v_fma_mix_f32 v108, v136, s60, v108 op_sel:[0,0,0] op_sel_hi:[1,0,0]
  v_fma_mix_f32 v109, v136, s60, v109 op_sel:[1,0,0] op_sel_hi:[1,0,0]
  v_fma_mix_f32 v110, v137, s60, v110 op_sel:[0,0,0] op_sel_hi:[1,0,0]
  v_fma_mix_f32 v111, v137, s60, v111 op_sel:[1,0,0] op_sel_hi:[1,0,0]
  v_fma_mix_f32 v108, v138, s61, v108 op_sel:[0,0,0] op_sel_hi:[1,0,0]
  v_fma_mix_f32 v109, v138, s61, v109 op_sel:[1,0,0] op_sel_hi:[1,0,0]
  v_fma_mix_f32 v110, v139, s61, v110 op_sel:[0,0,0] op_sel_hi:[1,0,0]
  v_fma_mix_f32 v111, v139, s61, v111 op_sel:[1,0,0] op_sel_hi:[1,0,0]
  v_fma_mix_f32 v108, v140, s62, v108 op_sel:[0,0,0] op_sel_hi:[1,0,0]
  v_fma_mix_f32 v109, v140, s62, v109 op_sel:[1,0,0] op_sel_hi:[1,0,0]
  v_fma_mix_f32 v110, v141, s62, v110 op_sel:[0,0,0] op_sel_hi:[1,0,0]
  v_fma_mix_f32 v111, v141, s62, v111 op_sel:[1,0,0] op_sel_hi:[1,0,0]
  s_mov_b32 exec_hi, 0xffff
  s_barrier
  ds_read_b128 v[72:75], v22 offset:0
  ds_read_b128 v[76:79], v22 offset:768
  ds_read_b128 v[80:83], v22 offset:1536
  ds_read_b128 v[84:87], v22 offset:2304
  s_waitcnt lgkmcnt(3)
  v_fmac_f32 v108, s63, v72
  v_fmac_f32 v109, s63, v73
  v_fmac_f32 v110, s63, v74
  v_fmac_f32 v111, s63, v75
  s_waitcnt lgkmcnt(2)
  v_fmac_f32 v108, s63, v76
  v_fmac_f32 v109, s63, v77
  v_fmac_f32 v110, s63, v78
  v_fmac_f32 v111, s63, v79
  s_waitcnt lgkmcnt(1)
  v_fmac_f32 v108, s63, v80
  v_fmac_f32 v109, s63, v81
  v_fmac_f32 v110, s63, v82
  v_fmac_f32 v111, s63, v83
  s_waitcnt lgkmcnt(0)
  v_fmac_f32 v108, s63, v84
  v_fmac_f32 v109, s63, v85
  v_fmac_f32 v110, s63, v86
  v_fmac_f32 v111, s63, v87
  v_cvt_pk_bf16_f32 v108, v108, v109
  v_cvt_pk_bf16_f32 v109, v110, v111
  global_store_dwordx2 v21, v[108:109], s[26:27]
L_end:
  s_endpgm
.p2align 6
.type L_order,@object
L_order:
  .long 0x76a43510, 0x2fedcb98, 0x200000, 0x500, 0x20, 0x251200, 0x2, 0x0
  .long 0x220012, 0x420032, 0x620052, 0x820072, 0xa20092, 0xc200b2, 0xe200d2, 0xf00f2
  .long 0x56a43210, 0x7fedcb98, 0xe00000, 0x0, 0x70, 0x201e00, 0x7, 0x0
  .long 0x270007, 0x470037, 0x670057, 0x870077, 0xa70097, 0xc700b7, 0xe700d7, 0x1f00f7
  .long 0x76543210, 0xafedcb98, 0xd00000, 0xf00, 0xaf, 0x1d002f, 0xa, 0x0
  .long 0xab004c, 0x37a00ce, 0x53b03fe, 0x80c05bc, 0xa1e088b, 0xd5e0a9b, 0xddc0d6b, 0x2f0ded
  .long 0x75a43210, 0x6fedcb98, 0x500000, 0x400, 0x60, 0x241500, 0x6, 0x0
  .long 0x160006, 0x460026, 0x660056, 0x860076, 0xa60096, 0xc600b6, 0xe600d6, 0x3f00f6
  .long 0x76543210, 0xdfeacb98, 0x900000, 0xf00, 0xd0, 0x2f1900, 0xd, 0x0
  .long 0x1c000c, 0x3c002c, 0x6c005c, 0x8c007c, 0xac009c, 0xcc00bc, 0xec00dc, 0x4f00fc
  .long 0x76543210, 0xefadcb98, 0x800000, 0xc00, 0xe0, 0x2c1800, 0xe, 0x0
  .long 0x1d000d, 0x3d002d, 0x6d004d, 0x8d007d, 0xad009d, 0xcd00bd, 0xed00dd, 0x5f00fd
  .long 0x76a45210, 0x3fedcb98, 0x300000, 0x700, 0x30, 0x271300, 0x3, 0x0
  .long 0x130003, 0x330023, 0x530043, 0x830073, 0xa30093, 0xc300b3, 0xe300d3, 0x6f00f3
  .long 0x76a43210, 0x5fedcb98, 0x400000, 0x400, 0x54, 0x240014, 0x5, 0x0
  .long 0x1c000f1, 0x6840602, 0xa340840, 0xae00ab2, 0xc630bd2, 0xe230e12, 0xe940e51, 0x7f0ea0
  .long 0x76a53210, 0x4fedcb98, 0x200000, 0x500, 0x40, 0x251200, 0x4, 0x0
  .long 0x140004, 0x340024, 0x540044, 0x740064, 0xa40094, 0xc400b4, 0xe400d4, 0x8f00f4
  .long 0x76a43210, 0x8fedcb95, 0xe00000, 0x0, 0x80, 0x201e00, 0x8, 0x0
  .long 0x180008, 0x380028, 0x580048, 0x780068, 0xa80088, 0xc800b8, 0xe800d8, 0x9f00f8
  .long 0x76543210, 0xcfedab98, 0xd00000, 0xf00, 0xc0, 0x2f1d00, 0xc, 0x0
  .long 0x1b000b, 0x3b002b, 0x5b004b, 0x7b006b, 0x9b008b, 0xcb00bb, 0xeb00db, 0xaf00fb
  .long 0x76a43210, 0x9fedcb58, 0x500000, 0x400, 0x90, 0x241500, 0x9, 0x0
  .long 0x190009, 0x390029, 0x590049, 0x790069, 0x990089, 0xc900a9, 0xe900d9, 0xbf00f9
  .long 0x76543210, 0xfaedcb98, 0x900000, 0xf00, 0xf0, 0x2f1900, 0xf, 0x0
  .long 0x1e000e, 0x3e002e, 0x5e004e, 0x7e006e, 0x9e008e, 0xbe00ae, 0xee00de, 0xcf00fe
  .long 0x76543210, 0xbfedca98, 0x800000, 0xc00, 0xb0, 0x2c1800, 0xb, 0x0
  .long 0x1a000a, 0x3a002a, 0x5a004a, 0x7a006a, 0x9a008a, 0xba00aa, 0xea00ca, 0xdf00fa
  .long 0x76a43215, 0xfedcb98, 0x300000, 0x700, 0x0, 0x271300, 0x0, 0x0
  .long 0x100000, 0x300020, 0x500040, 0x700060, 0x900080, 0xb000a0, 0xd000c0, 0xef00f0
  .long 0x76a43250, 0x1fedcb98, 0x400000, 0x400, 0x10, 0x241400, 0x1, 0x0
  .long 0x110001, 0x310021, 0x510041, 0x710061, 0x910081, 0xb100a1, 0xd100c1, 0xff00e1
  .long 0x76543210, 0xefadcb98, 0x11b11111, 0x11111e11, 0xe1, 0x2e1b01, 0xe, 0x0
  .long 0x12d011d, 0x14d013d, 0x16d015d, 0x18d017d, 0x1ad019d, 0x1cd01bd, 0x1ed01dd, 0x10f01fd
  .long 0x76543210, 0x8fedcb9a, 0x11c11111, 0x11111911, 0x81, 0x291c01, 0x8, 0x0
  .long 0x1280108, 0x1480138, 0x1680158, 0x1880178, 0x1a80198, 0x1c801b8, 0x1e801d8, 0x11f01f8
  .long 0x76a43210, 0x9fedcb58, 0x11911111, 0x11111711, 0x91, 0x271901, 0x9, 0x0
  .long 0x1190109, 0x1490139, 0x1690159, 0x1890179, 0x1a90199, 0x1c901b9, 0x1e901d9, 0x12f01f9
  .long 0x76543210, 0xfaedcb98, 0x11911111, 0x11111d11, 0xf1, 0x2d1901, 0xf, 0x0
  .long 0x11e010e, 0x14e012e, 0x16e015e, 0x18e017e, 0x1ae019e, 0x1ce01be, 0x1ee01de, 0x13f01fe
  .long 0x76543210, 0xcfedab98, 0x11a11111, 0x11111d11, 0xc1, 0x2d1a01, 0xc, 0x0
  .long 0x11b010b, 0x13b012b, 0x16b015b, 0x18b017b, 0x1ab019b, 0x1cb01bb, 0x1eb01db, 0x14f01fb
  .long 0x76a45210, 0x3fedcb98, 0x11311111, 0x11111511, 0x31, 0x251301, 0x3, 0x0
  .long 0x1130103, 0x1330123, 0x1630143, 0x1830173, 0x1a30193, 0x1c301b3, 0x1e301d3, 0x15f01f3
  .long 0xa6543210, 0x7fedcb98, 0x11911111, 0x11111511, 0x71, 0x251901, 0x7, 0x0
  .long 0x1170107, 0x1370127, 0x1570147, 0x1870177, 0x1a70197, 0x1c701b7, 0x1e701d7, 0x16f01f7
  .long 0x76a43510, 0x2fedcb98, 0x11011111, 0x11111211, 0x21, 0x221001, 0x2, 0x0
  .long 0x1120102, 0x1320122, 0x1520142, 0x1820162, 0x1a20192, 0x1c201b2, 0x1e201d2, 0x17f01f2
  .long 0x76543210, 0xbfedca98, 0x11b11111, 0x11111e11, 0xb1, 0x2e1b01, 0xb, 0x0
  .long 0x11a010a, 0x13a012a, 0x15a014a, 0x17a016a, 0x1aa019a, 0x1ca01ba, 0x1ea01da, 0x18f01fa
  .long 0x7a543210, 0x6fedcb98, 0x11c11111, 0x11111911, 0x61, 0x291c01, 0x6, 0x0
  .long 0x1160106, 0x1360126, 0x1560146, 0x1760166, 0x1a60186, 0x1c601b6, 0x1e601d6, 0x19f01f6
  .long 0x76a43210, 0x5fedcb98, 0x11911111, 0x11111711, 0x59, 0x270119, 0x5, 0x0
  .long 0xc50045, 0x1350129, 0x1b50165, 0x25601e5, 0xd1502d7, 0xe050d95, 0xf750e85, 0x1af0ff5
  .long 0x76543210, 0xdfeacb98, 0x11911111, 0x11111d11, 0xd1, 0x2d1901, 0xd, 0x0
  .long 0x11c010c, 0x13c012c, 0x15c014c, 0x17c016c, 0x19c018c, 0x1cc01ac, 0x1ec01dc, 0x1bf01fc
  .long 0x76a43215, 0xfedcb98, 0x11411111, 0x11111211, 0x1, 0x221401, 0x0, 0x0
  .long 0x1100100, 0x1300120, 0x1500140, 0x1700160, 0x1900180, 0x1b001a0, 0x1e001d0, 0x1cf01f0
  .long 0x76a43250, 0x1fedcb98, 0x11311111, 0x11111511, 0x11, 0x251301, 0x1, 0x0
  .long 0x1110101, 0x1310121, 0x1510141, 0x1710161, 0x1910181, 0x1b101a1, 0x1e101c1, 0x1df01f1
  .long 0x76543210, 0xafedcb98, 0x11911111, 0x11111511, 0xa5, 0x190125, 0xa, 0x0
  .long 0x850005, 0x1670155, 0x42501d5, 0x91504a5, 0x9950975, 0xc4509f5, 0xe350cc5, 0x1ef0eb5
  .long 0x76a53210, 0x4fedcb98, 0x11011111, 0x11111211, 0x41, 0x221001, 0x4, 0x0
  .long 0x1140104, 0x1340124, 0x1540144, 0x1740164, 0x1940184, 0x1b401a4, 0x1d401c4, 0x1ff01e4
  .long 0x76a45210, 0x3fedcb98, 0x22122222, 0x22222322, 0x32, 0x231102, 0x3, 0x0
  .long 0x2230213, 0x2430233, 0x2630253, 0x2830273, 0x2a30293, 0x2c302b3, 0x2e302d3, 0x20f02f3
  .long 0x76a43210, 0x5fedcb98, 0x22f22222, 0x22222622, 0x5f, 0x26021f, 0x5, 0x0
  .long 0x2990235, 0x40502b5, 0x5250485, 0x66505a5, 0x74506e5, 0x7c50779, 0xf5507f7, 0x21f0fd5
  .long 0x76543210, 0xafedcb98, 0x22822222, 0x22222622, 0xa6, 0x180226, 0xa, 0x0
  .long 0x2550215, 0x2a80295, 0x60502d5, 0x6450635, 0x6b50685, 0x77506c5, 0xb6507f5, 0x22f0be5
  .long 0x76543210, 0xfaedcb98, 0x22f22222, 0x22222c22, 0xf2, 0x2c1f02, 0xf, 0x0
  .long 0x21e020e, 0x24e022e, 0x26e025e, 0x28e027e, 0x2ae029e, 0x2ce02be, 0x2ee02de, 0x23f02fe
  .long 0x76a43510, 0x2fedcb98, 0x22022222, 0x22222122, 0x22, 0x211002, 0x2, 0x0
  .long 0x2120202, 0x2320222, 0x2620252, 0x2820272, 0x2a20292, 0x2c202b2, 0x2e202d2, 0x24f02f2
  .long 0x75a43210, 0x6fedcb98, 0x22922222, 0x22222622, 0x62, 0x261902, 0x6, 0x0
  .long 0x2160206, 0x2360226, 0x2660246, 0x2860276, 0x2a60296, 0x2c602b6, 0x2e602d6, 0x25f02f6
  .long 0x76543210, 0xdfeacb98, 0x22a22222, 0x22222e22, 0xd2, 0x2e1a02, 0xd, 0x0
  .long 0x21c020c, 0x23c022c, 0x25c024c, 0x28c027c, 0x2ac029c, 0x2cc02bc, 0x2ec02dc, 0x26f02fc
  .long 0x76a43250, 0x1fedcb98, 0x22122222, 0x22222922, 0x12, 0x291102, 0x1, 0x0
  .long 0x2110201, 0x2310221, 0x2510241, 0x2810261, 0x2a10291, 0x2c102b1, 0x2e102d1, 0x27f02f1
  .long 0x76a43215, 0xfedcb98, 0x22122222, 0x22222322, 0x2, 0x231102, 0x0, 0x0
  .long 0x2100200, 0x2300220, 0x2500240, 0x2700260, 0x2a00290, 0x2c002b0, 0x2e002d0, 0x28f02f0
  .long 0x76a43210, 0x9fedcb58, 0x22f22222, 0x22222622, 0x92, 0x261f02, 0x9, 0x0
  .long 0x2190209, 0x2390229, 0x2590249, 0x2790269, 0x2a90289, 0x2c902b9, 0x2e902d9, 0x29f02f9
  .long 0x76543210, 0x8fedcb9a, 0x22822222, 0x22222622, 0x82, 0x261802, 0x8, 0x0
  .long 0x2180208, 0x2380228, 0x2580248, 0x2780268, 0x2980288, 0x2c802b8, 0x2e802d8, 0x2af02f8
  .long 0x76543210, 0xbfedca98, 0x22f22222, 0x22222c22, 0xb2, 0x2c1f02, 0xb, 0x0
  .long 0x21a020a, 0x23a022a, 0x25a024a, 0x27a026a, 0x29a028a, 0x2ca02aa, 0x2ea02da, 0x2bf02fa
  .long 0x76a53210, 0x4fedcb98, 0x22022222, 0x22222122, 0x42, 0x211002, 0x4, 0x0
  .long 0x2140204, 0x2340224, 0x2540244, 0x2740264, 0x2940284, 0x2b402a4, 0x2e402d4, 0x2cf02f4
  .long 0x56a43210, 0x7fedcb98, 0x22922222, 0x22222622, 0x72, 0x261902, 0x7, 0x0
  .long 0x2170207, 0x2370227, 0x2570247, 0x2770267, 0x2970287, 0x2b702a7, 0x2e702c7, 0x2df02f7
  .long 0x76543210, 0xefadcb98, 0x22a22222, 0x22222e22, 0xe2, 0x2e1a02, 0xe, 0x0
  .long 0x21d020d, 0x23d022d, 0x25d024d, 0x27d026d, 0x29d028d, 0x2bd02ad, 0x2dd02cd, 0x2ef02fd
  .long 0x76543210, 0xcfedab98, 0x22b22222, 0x22222c22, 0xc2, 0x2c1b02, 0xc, 0x0
  .long 0x21b020b, 0x23b022b, 0x25b024b, 0x27b026b, 0x29b028b, 0x2bb02ab, 0x2db02cb, 0x2ff02eb
  .long 0xa6543210, 0x7fedcb98, 0x33633333, 0x33333933, 0x73, 0x291603, 0x7, 0x0
  .long 0x3270317, 0x3470337, 0x3670357, 0x3870377, 0x3a70397, 0x3c703b7, 0x3e703d7, 0x30f03f7
  .long 0x76543210, 0xdfeacb98, 0x33a33333, 0x33333e33, 0xd3, 0x2e1a03, 0xd, 0x0
  .long 0x32c030c, 0x34c033c, 0x36c035c, 0x38c037c, 0x3ac039c, 0x3cc03bc, 0x3ec03dc, 0x31f03fc
  .long 0x76a43510, 0x2fedcb98, 0x33133333, 0x33333433, 0x23, 0x241103, 0x2, 0x0
  .long 0x3120302, 0x3420332, 0x3620352, 0x3820372, 0x3a20392, 0x3c203b2, 0x3e203d2, 0x32f03f2
  .long 0x76543210, 0xcfedab98, 0x33e33333, 0x33333e33, 0xc3, 0x2e1e03, 0xc, 0x0
  .long 0x31b030b, 0x34b032b, 0x36b035b, 0x38b037b, 0x3ab039b, 0x3cb03bb, 0x3eb03db, 0x33f03fb
  .long 0x76a43210, 0x5fedcb98, 0x33333333, 0x33333333, 0x53, 0x230313, 0x5, 0x0
  .long 0xe00063, 0x1d10153, 0x81103c0, 0x9240893, 0x9a00931, 0xb7409b2, 0xd040bf1, 0x34f0d80
  .long 0x75a43210, 0x6fedcb98, 0x33d33333, 0x33333833, 0x63, 0x281d03, 0x6, 0x0
  .long 0x3160306, 0x3360326, 0x3660346, 0x3860376, 0x3a60396, 0x3c603b6, 0x3e603d6, 0x35f03f6
  .long 0x76a53210, 0x4fedcb98, 0x33033333, 0x33333033, 0x43, 0x201003, 0x4, 0x0
  .long 0x3140304, 0x3340324, 0x3540344, 0x3840374, 0x3a40394, 0x3c403b4, 0x3e403d4, 0x36f03f4
  .long 0x76543210, 0xbfedca98, 0x33833333, 0x33333f33, 0xb3, 0x2f1803, 0xb, 0x0
  .long 0x31a030a, 0x33a032a, 0x35a034a, 0x38a036a, 0x3aa039a, 0x3ca03ba, 0x3ea03da, 0x37f03fa
  .long 0x76543210, 0x8fedcb9a, 0x33633333, 0x33333933, 0x83, 0x291603, 0x8, 0x0
  .long 0x3180308, 0x3380328, 0x3580348, 0x3780368, 0x3a80398, 0x3c803b8, 0x3e803d8, 0x38f03f8
  .long 0x76543210, 0xafedcb98, 0x33a33333, 0x33333e33, 0xae, 0x1a032e, 0xa, 0x0
  .long 0x18a010d, 0x2ed026c, 0x33b031c, 0x67b03bd, 0x72d06fe, 0x94e07ab, 0xf5c09cc, 0x39f0fdb
  .long 0x76a45210, 0x3fedcb98, 0x33133333, 0x33333433, 0x33, 0x241103, 0x3, 0x0
  .long 0x3130303, 0x3330323, 0x3530343, 0x3730363, 0x3930383, 0x3c303b3, 0x3e303d3, 0x3af03f3
  .long 0x76543210, 0xefadcb98, 0x33e33333, 0x33333e33, 0xe3, 0x2e1e03, 0xe, 0x0
  .long 0x31d030d, 0x33d032d, 0x35d034d, 0x37d036d, 0x39d038d, 0x3cd03ad, 0x3ed03dd, 0x3bf03fd
  .long 0x76a43215, 0xfedcb98, 0x33333333, 0x33333333, 0x3, 0x231303, 0x0, 0x0
  .long 0x3100300, 0x3300320, 0x3500340, 0x3700360, 0x3900380, 0x3b003a0, 0x3e003d0, 0x3cf03f0
  .long 0x76a43210, 0x9fedcb58, 0x33d33333, 0x33333833, 0x93, 0x281d03, 0x9, 0x0
  .long 0x3190309, 0x3390329, 0x3590349, 0x3790369, 0x3990389, 0x3b903a9, 0x3e903c9, 0x3df03f9
  .long 0x76a43250, 0x1fedcb98, 0x33033333, 0x33333033, 0x13, 0x201003, 0x1, 0x0
  .long 0x3110301, 0x3310321, 0x3510341, 0x3710361, 0x3910381, 0x3b103a1, 0x3d103c1, 0x3ef03f1
  .long 0x76543210, 0xfaedcb98, 0x33833333, 0x33333f33, 0xf3, 0x2f1803, 0xf, 0x0
  .long 0x31e030e, 0x33e032e, 0x35e034e, 0x37e036e, 0x39e038e, 0x3be03ae, 0x3de03ce, 0x3ff03ee
  .long 0x7a543210, 0x6fedcb98, 0x44f44444, 0x44444044, 0x64, 0x201f04, 0x6, 0x0
  .long 0x4260416, 0x4460436, 0x4660456, 0x4860476, 0x4a60496, 0x4c604b6, 0x4e604d6, 0x40f04f6
  .long 0x76a53210, 0x4fedcb98, 0x44144444, 0x44444344, 0x44, 0x231104, 0x4, 0x0
  .long 0x4240404, 0x4440434, 0x4640454, 0x4840474, 0x4a40494, 0x4c404b4, 0x4e404d4, 0x41f04f4
  .long 0x76a45210, 0x3fedcb98, 0x44244444, 0x44444544, 0x34, 0x251204, 0x3, 0x0
  .long 0x4130403, 0x4430433, 0x4630453, 0x4830473, 0x4a30493, 0x4c304b3, 0x4e304d3, 0x42f04f3
  .long 0x76a43250, 0x1fedcb98, 0x44144444, 0x44444344, 0x14, 0x231104, 0x1, 0x0
  .long 0x4110401, 0x4410421, 0x4610451, 0x4810471, 0x4a10491, 0x4c104b1, 0x4e104d1, 0x43f04f1
  .long 0x76543210, 0xefadcb98, 0x44744444, 0x44444c44, 0xe4, 0x2c1704, 0xe, 0x0
  .long 0x41d040d, 0x43d042d, 0x46d045d, 0x48d047d, 0x4ad049d, 0x4cd04bd, 0x4ed04dd, 0x44f04fd
  .long 0x76543210, 0xafedcb98, 0x44644444, 0x44444b44, 0xab, 0x16042b, 0xa, 0x0
  .long 0x52e04db, 0x70e05aa, 0xa6d078c, 0xbbe0b3b, 0xc9c0c1a, 0xe4b0ceb, 0xf7a0ecc, 0x45f0ffd
  .long 0xa6543210, 0x7fedcb98, 0x44744444, 0x44444344, 0x74, 0x231704, 0x7, 0x0
  .long 0x4170407, 0x4370427, 0x4570447, 0x4870477, 0x4a70497, 0x4c704b7, 0x4e704d7, 0x46f04f7
  .long 0x76543210, 0xbfedca98, 0x44644444, 0x44444d44, 0xb4, 0x2d1604, 0xb, 0x0
  .long 0x41a040a, 0x43a042a, 0x45a044a, 0x48a046a, 0x4aa049a, 0x4ca04ba, 0x4ea04da, 0x47f04fa
  .long 0x76543210, 0x8fedcb9a, 0x44f44444, 0x44444044, 0x84, 0x201f04, 0x8, 0x0
  .long 0x4180408, 0x4380428, 0x4580448, 0x4780468, 0x4a80498, 0x4c804b8, 0x4e804d8, 0x48f04f8
  .long 0x76a43210, 0x5fedcb98, 0x44144444, 0x44444344, 0x51, 0x230411, 0x5, 0x0
  .long 0x2710203, 0x3220280, 0x41403a3, 0x4b00431, 0xb6005f4, 0xc510be3, 0xd410cd2, 0x49f0dc3
  .long 0x76a43510, 0x2fedcb98, 0x44244444, 0x44444544, 0x24, 0x251204, 0x2, 0x0
  .long 0x4120402, 0x4320422, 0x4520442, 0x4720462, 0x4920482, 0x4c204b2, 0x4e204d2, 0x4af04f2
  .long 0x76a43215, 0xfedcb98, 0x44144444, 0x44444344, 0x4, 0x231104, 0x0, 0x0
  .long 0x4100400, 0x4300420, 0x4500440, 0x4700460, 0x4900480, 0x4c004a0, 0x4e004d0, 0x4bf04f0
  .long 0x76543210, 0xfaedcb98, 0x44744444, 0x44444c44, 0xf4, 0x2c1704, 0xf, 0x0
  .long 0x41e040e, 0x43e042e, 0x45e044e, 0x47e046e, 0x49e048e, 0x4be04ae, 0x4ee04de, 0x4cf04fe
  .long 0x76543210, 0xcfedab98, 0x44644444, 0x44444b44, 0xc4, 0x2b1604, 0xc, 0x0
  .long 0x41b040b, 0x43b042b, 0x45b044b, 0x47b046b, 0x49b048b, 0x4bb04ab, 0x4eb04cb, 0x4df04fb
  .long 0x76543210, 0x9fedcba8, 0x44744444, 0x44444344, 0x94, 0x231704, 0x9, 0x0
  .long 0x4190409, 0x4390429, 0x4590449, 0x4790469, 0x4990489, 0x4b904a9, 0x4d904c9, 0x4ef04f9
  .long 0x76543210, 0xdfeacb98, 0x44644444, 0x44444d44, 0xd4, 0x2d1604, 0xd, 0x0
  .long 0x41c040c, 0x43c042c, 0x45c044c, 0x47c046c, 0x49c048c, 0x4bc04ac, 0x4dc04cc, 0x4ff04ec
  .long 0x76a43510, 0x2fedcb98, 0x55055555, 0x55555155, 0x25, 0x211005, 0x2, 0x0
  .long 0x5220512, 0x5420532, 0x5620552, 0x5820572, 0x5a20592, 0x5c205b2, 0x5e205d2, 0x50f05f2
  .long 0x76a43210, 0x5fedcb98, 0x55b55555, 0x55555755, 0x5b, 0x27051b, 0x5, 0x0
  .long 0x1850105, 0x53502f5, 0x5980575, 0x72505b5, 0x95507a5, 0xe4509d5, 0xf650ec5, 0x51f0fe5
  .long 0x76543210, 0xfaedcb98, 0x55f55555, 0x55555b55, 0xf5, 0x2b1f05, 0xf, 0x0
  .long 0x51e050e, 0x54e053e, 0x56e055e, 0x58e057e, 0x5ae059e, 0x5ce05be, 0x5ee05de, 0x52f05fe
  .long 0x76543210, 0xcfedab98, 0x55b55555, 0x55555f55, 0xc5, 0x2f1b05, 0xc, 0x0
  .long 0x51b050b, 0x54b052b, 0x56b055b, 0x58b057b, 0x5ab059b, 0x5cb05bb, 0x5eb05db, 0x53f05fb
  .long 0x76543210, 0x9fedcba8, 0x55855555, 0x55555955, 0x95, 0x291805, 0x9, 0x0
  .long 0x5190509, 0x5390529, 0x5690559, 0x5890579, 0x5a90599, 0x5c905b9, 0x5e905d9, 0x54f05f9
  .long 0x76543210, 0xafedcb98, 0x55a55555, 0x55555755, 0xa7, 0x1a0527, 0xa, 0x0
  .long 0xe50065, 0x1a50125, 0x5950515, 0x87505d6, 0xc3808f5, 0xf050cb9, 0xf850f46, 0x55f0fc8
  .long 0x76a43250, 0x1fedcb98, 0x55255555, 0x55555455, 0x15, 0x241205, 0x1, 0x0
  .long 0x5110501, 0x5310521, 0x5510541, 0x5810571, 0x5a10591, 0x5c105b1, 0x5e105d1, 0x56f05f1
  .long 0x76543210, 0xefadcb98, 0x55b55555, 0x55555c55, 0xe5, 0x2c1b05, 0xe, 0x0
  .long 0x51d050d, 0x53d052d, 0x55d054d, 0x58d056d, 0x5ad059d, 0x5cd05bd, 0x5ed05dd, 0x57f05fd
  .long 0x76a45210, 0x3fedcb98, 0x55055555, 0x55555155, 0x35, 0x211005, 0x3, 0x0
  .long 0x5130503, 0x5330523, 0x5530543, 0x5730563, 0x5a30593, 0x5c305b3, 0x5e305d3, 0x58f05f3
  .long 0x76a43210, 0x8fedcb95, 0x55b55555, 0x55555755, 0x85, 0x271b05, 0x8, 0x0
  .long 0x5180508, 0x5380528, 0x5580548, 0x5780568, 0x5a80588, 0x5c805b8, 0x5e805d8, 0x59f05f8
  .long 0x76543210, 0xbfedca98, 0x55f55555, 0x55555b55, 0xb5, 0x2b1f05, 0xb, 0x0
  .long 0x51a050a, 0x53a052a, 0x55a054a, 0x57a056a, 0x59a058a, 0x5ca05ba, 0x5ea05da, 0x5af05fa
  .long 0x76543210, 0xdfeacb98, 0x55b55555, 0x55555f55, 0xd5, 0x2f1b05, 0xd, 0x0
  .long 0x51c050c, 0x53c052c, 0x55c054c, 0x57c056c, 0x59c058c, 0x5cc05ac, 0x5ec05dc, 0x5bf05fc
  .long 0xa6543210, 0x7fedcb98, 0x55855555, 0x55555955, 0x75, 0x291805, 0x7, 0x0
  .long 0x5170507, 0x5370527, 0x5570547, 0x5770567, 0x5970587, 0x5b705a7, 0x5e705d7, 0x5cf05f7
  .long 0x7a543210, 0x6fedcb98, 0x55a55555, 0x55555755, 0x65, 0x271a05, 0x6, 0x0
  .long 0x5160506, 0x5360526, 0x5560546, 0x5760566, 0x5960586, 0x5b605a6, 0x5e605c6, 0x5df05f6
  .long 0x76a43215, 0xfedcb98, 0x55255555, 0x55555455, 0x5, 0x241205, 0x0, 0x0
  .long 0x5100500, 0x5300520, 0x5500540, 0x5700560, 0x5900580, 0x5b005a0, 0x5d005c0, 0x5ef05f0
  .long 0x76a53210, 0x4fedcb98, 0x55155555, 0x55555955, 0x45, 0x291105, 0x4, 0x0
  .long 0x5140504, 0x5340524, 0x5540544, 0x5740564, 0x5940584, 0x5b405a4, 0x5d405c4, 0x5ff05e4
  .long 0x76a43510, 0x2fedcb98, 0x66466666, 0x66666666, 0x26, 0x261406, 0x2, 0x0
  .long 0x6220612, 0x6420632, 0x6620652, 0x6820672, 0x6a20692, 0x6c206b2, 0x6e206d2, 0x60f06f2
  .long 0x76543210, 0xefadcb98, 0x66666666, 0x66666c66, 0xe6, 0x2c1606, 0xe, 0x0
  .long 0x62d060d, 0x64d063d, 0x66d065d, 0x68d067d, 0x6ad069d, 0x6cd06bd, 0x6ed06dd, 0x61f06fd
  .long 0xa6543210, 0x7fedcb98, 0x66c66666, 0x66666166, 0x76, 0x211c06, 0x7, 0x0
  .long 0x6170607, 0x6470637, 0x6670657, 0x6870677, 0x6a70697, 0x6c706b7, 0x6e706d7, 0x62f06f7
  .long 0x76a43250, 0x1fedcb98, 0x66066666, 0x66666666, 0x16, 0x261006, 0x1, 0x0
  .long 0x6110601, 0x6410621, 0x6610651, 0x6810671, 0x6a10691, 0x6c106b1, 0x6e106d1, 0x63f06f1
  .long 0x75a43210, 0x6fedcb98, 0x66e66666, 0x66666666, 0x66, 0x261e06, 0x6, 0x0
  .long 0x6160606, 0x6360626, 0x6660656, 0x6860676, 0x6a60696, 0x6c606b6, 0x6e606d6, 0x64f06f6
  .long 0x76a45210, 0x3fedcb98, 0x66066666, 0x66666066, 0x36, 0x201006, 0x3, 0x0
  .long 0x6130603, 0x6330623, 0x6630643, 0x6830673, 0x6a30693, 0x6c306b3, 0x6e306d3, 0x65f06f3
  .long 0x76543210, 0xafedcb98, 0x66f66666, 0x66666d66, 0xad, 0x1f062d, 0xa, 0x0
  .long 0x14b013e, 0x47a01bc, 0x6ec04fc, 0x8ae082a, 0xa0c08cd, 0xb1d0a8a, 0xb9a0b5c, 0x66f0edd
  .long 0x76543210, 0xcfedab98, 0x66566666, 0x66666e66, 0xc6, 0x2e1506, 0xc, 0x0
  .long 0x61b060b, 0x63b062b, 0x65b064b, 0x68b066b, 0x6ab069b, 0x6cb06bb, 0x6eb06db, 0x67f06fb
  .long 0x76a53210, 0x4fedcb98, 0x66466666, 0x66666666, 0x46, 0x261406, 0x4, 0x0
  .long 0x6140604, 0x6340624, 0x6540644, 0x6740664, 0x6a40694, 0x6c406b4, 0x6e406d4, 0x68f06f4
  .long 0x76543210, 0xbfedca98, 0x66666666, 0x66666c66, 0xb6, 0x2c1606, 0xb, 0x0
  .long 0x61a060a, 0x63a062a, 0x65a064a, 0x67a066a, 0x6aa068a, 0x6ca06ba, 0x6ea06da, 0x69f06fa
  .long 0x76543210, 0x9fedcba8, 0x66c66666, 0x66666166, 0x96, 0x211c06, 0x9, 0x0
  .long 0x6190609, 0x6390629, 0x6590649, 0x6790669, 0x6990689, 0x6c906b9, 0x6e906d9, 0x6af06f9
  .long 0x76a43210, 0x5fedcb98, 0x66066666, 0x66666666, 0x50, 0x260610, 0x5, 0x0
  .long 0x1f40172, 0x2c40242, 0x3e10364, 0x5830502, 0x6530631, 0x71006d0, 0xda20792, 0x6bf0f20
  .long 0x76a43210, 0x8fedcb95, 0x66e66666, 0x66666666, 0x86, 0x261e06, 0x8, 0x0
  .long 0x6180608, 0x6380628, 0x6580648, 0x6780668, 0x6980688, 0x6b806a8, 0x6e806d8, 0x6cf06f8
  .long 0x76a43215, 0xfedcb98, 0x66066666, 0x66666066, 0x6, 0x201006, 0x0, 0x0
  .long 0x6100600, 0x6300620, 0x6500640, 0x6700660, 0x6900680, 0x6b006a0, 0x6e006c0, 0x6df06f0
  .long 0x76543210, 0xdfeacb98, 0x66f66666, 0x66666d66, 0xd6, 0x2d1f06, 0xd, 0x0
  .long 0x61c060c, 0x63c062c, 0x65c064c, 0x67c066c, 0x69c068c, 0x6bc06ac, 0x6dc06cc, 0x6ef06fc
  .long 0x76543210, 0xfaedcb98, 0x66566666, 0x66666e66, 0xf6, 0x2e1506, 0xf, 0x0
  .long 0x61e060e, 0x63e062e, 0x65e064e, 0x67e066e, 0x69e068e, 0x6be06ae, 0x6de06ce, 0x6ff06ee
  .long 0x76543210, 0xfaedcb98, 0x77877777, 0x77777b77, 0xf7, 0x2b1807, 0xf, 0x0
  .long 0x72e071e, 0x74e073e, 0x76e075e, 0x78e077e, 0x7ae079e, 0x7ce07be, 0x7ee07de, 0x70f07fe
  .long 0x76a43215, 0xfedcb98, 0x77077777, 0x77777877, 0x7, 0x281007, 0x0, 0x0
  .long 0x7200700, 0x7400730, 0x7600750, 0x7800770, 0x7a00790, 0x7c007b0, 0x7e007d0, 0x71f07f0
  .long 0x76543210, 0xefadcb98, 0x77b77777, 0x77777e77, 0xe7, 0x2e1b07, 0xe, 0x0
  .long 0x71d070d, 0x74d073d, 0x76d075d, 0x78d077d, 0x7ad079d, 0x7cd07bd, 0x7ed07dd, 0x72f07fd
  .long 0x76a53210, 0x4fedcb98, 0x77277777, 0x77777177, 0x47, 0x211207, 0x4, 0x0
  .long 0x7140704, 0x7440724, 0x7640754, 0x7840774, 0x7a40794, 0x7c407b4, 0x7e407d4, 0x73f07f4
  .long 0x7a543210, 0x6fedcb98, 0x77f77777, 0x77777a77, 0x67, 0x2a1f07, 0x6, 0x0
  .long 0x7160706, 0x7360726, 0x7660756, 0x7860776, 0x7a60796, 0x7c607b6, 0x7e607d6, 0x74f07f6
  .long 0x76a45210, 0x3fedcb98, 0x77277777, 0x77777277, 0x37, 0x221207, 0x3, 0x0
  .long 0x7130703, 0x7330723, 0x7630743, 0x7830773, 0x7a30793, 0x7c307b3, 0x7e307d3, 0x75f07f3
  .long 0x76543210, 0xbfedca98, 0x77677777, 0x77777c77, 0xb7, 0x2c1607, 0xb, 0x0
  .long 0x71a070a, 0x73a072a, 0x75a074a, 0x78a077a, 0x7aa079a, 0x7ca07ba, 0x7ea07da, 0x76f07fa
  .long 0x76a43210, 0x9fedcb58, 0x77f77777, 0x77777677, 0x97, 0x261f07, 0x9, 0x0
  .long 0x7190709, 0x7390729, 0x7590749, 0x7890769, 0x7a90799, 0x7c907b9, 0x7e907d9, 0x77f07f9
  .long 0x76543210, 0xdfeacb98, 0x77877777, 0x77777b77, 0xd7, 0x2b1807, 0xd, 0x0
  .long 0x71c070c, 0x73c072c, 0x75c074c, 0x77c076c, 0x7ac079c, 0x7cc07bc, 0x7ec07dc, 0x78f07fc
  .long 0x76a43510, 0x2fedcb98, 0x77077777, 0x77777877, 0x27, 0x281007, 0x2, 0x0
  .long 0x7120702, 0x7320722, 0x7520742, 0x7720762, 0x7a20782, 0x7c207b2, 0x7e207d2, 0x79f07f2
  .long 0x76543210, 0xcfedab98, 0x77b77777, 0x77777e77, 0xc7, 0x2e1b07, 0xc, 0x0
  .long 0x71b070b, 0x73b072b, 0x75b074b, 0x77b076b, 0x79b078b, 0x7cb07bb, 0x7eb07db, 0x7af07fb
  .long 0x76a43250, 0x1fedcb98, 0x77277777, 0x77777177, 0x17, 0x211207, 0x1, 0x0
  .long 0x7110701, 0x7310721, 0x7510741, 0x7710761, 0x7910781, 0x7c107a1, 0x7e107d1, 0x7bf07f1
  .long 0x76543210, 0x8fedcb9a, 0x77f77777, 0x77777a77, 0x87, 0x2a1f07, 0x8, 0x0
  .long 0x7180708, 0x7380728, 0x7580748, 0x7780768, 0x7980788, 0x7b807a8, 0x7e807d8, 0x7cf07f8
  .long 0x76a43210, 0x5fedcb98, 0x77277777, 0x77777277, 0x52, 0x220712, 0x5, 0x0
  .long 0x840002, 0x4a20423, 0x5e00561, 0x7530734, 0x87407b1, 0xc4408f2, 0xf120cc0, 0x7df0f93
  .long 0x76543210, 0xafedcb98, 0x77677777, 0x77777c77, 0xac, 0x16072c, 0xa, 0x0
  .long 0xda005d, 0x2ba023e, 0x44d02fb, 0x57d04ce, 0x69a061d, 0xc0d076a, 0xd2a0c8e, 0x7ef0fae
  .long 0x56a43210, 0x7fedcb98, 0x77f77777, 0x77777677, 0x77, 0x261f07, 0x7, 0x0
  .long 0x7170707, 0x7370727, 0x7570747, 0x7770767, 0x7970787, 0x7b707a7, 0x7d707c7, 0x7ff07e7
  .long 0x76543210, 0xdfeacb98, 0x88788888, 0x88888f88, 0xd8, 0x2f1708, 0xd, 0x0
  .long 0x82c081c, 0x84c083c, 0x86c085c, 0x88c087c, 0x8ac089c, 0x8cc08bc, 0x8ec08dc, 0x80f08fc
  .long 0x76a43250, 0x1fedcb98, 0x88388888, 0x88888188, 0x18, 0x211308, 0x1, 0x0
  .long 0x8210801, 0x8410831, 0x8610851, 0x8810871, 0x8a10891, 0x8c108b1, 0x8e108d1, 0x81f08f1
  .long 0x76543210, 0xbfedca98, 0x88788888, 0x88888d88, 0xb8, 0x2d1708, 0xb, 0x0
  .long 0x81a080a, 0x84a083a, 0x86a085a, 0x88a087a, 0x8aa089a, 0x8ca08ba, 0x8ea08da, 0x82f08fa
  .long 0x76543210, 0xafedcb98, 0x88788888, 0x88888288, 0xa2, 0x170822, 0xa, 0x0
  .long 0x1c50175, 0x75501f5, 0x84507d5, 0x8b70865, 0x92508e5, 0xd0509a5, 0xe150d85, 0x83f0e95
  .long 0x76a43215, 0xfedcb98, 0x88488888, 0x88888288, 0x8, 0x221408, 0x0, 0x0
  .long 0x8100800, 0x8300820, 0x8600850, 0x8800870, 0x8a00890, 0x8c008b0, 0x8e008d0, 0x84f08f0
  .long 0x76a43210, 0x9fedcb58, 0x88788888, 0x88888188, 0x98, 0x211708, 0x9, 0x0
  .long 0x8190809, 0x8390829, 0x8690849, 0x8890879, 0x8a90899, 0x8c908b9, 0x8e908d9, 0x85f08f9
  .long 0x75a43210, 0x6fedcb98, 0x88d88888, 0x88888288, 0x68, 0x221d08, 0x6, 0x0
  .long 0x8160806, 0x8360826, 0x8560846, 0x8860876, 0x8a60896, 0x8c608b6, 0x8e608d6, 0x86f08f6
  .long 0x76a53210, 0x4fedcb98, 0x88288888, 0x88888788, 0x48, 0x271208, 0x4, 0x0
  .long 0x8140804, 0x8340824, 0x8540844, 0x8840864, 0x8a40894, 0x8c408b4, 0x8e408d4, 0x87f08f4
  .long 0x76543210, 0xcfedab98, 0x88788888, 0x88888f88, 0xc8, 0x2f1708, 0xc, 0x0
  .long 0x81b080b, 0x83b082b, 0x85b084b, 0x87b086b, 0x8ab089b, 0x8cb08bb, 0x8eb08db, 0x88f08fb
  .long 0x76a45210, 0x3fedcb98, 0x88388888, 0x88888188, 0x38, 0x211308, 0x3, 0x0
  .long 0x8130803, 0x8330823, 0x8530843, 0x8730863, 0x8a30883, 0x8c308b3, 0x8e308d3, 0x89f08f3
  .long 0x76543210, 0xfaedcb98, 0x88788888, 0x88888d88, 0xf8, 0x2d1708, 0xf, 0x0
  .long 0x81e080e, 0x83e082e, 0x85e084e, 0x87e086e, 0x89e088e, 0x8ce08be, 0x8ee08de, 0x8af08fe
  .long 0xa6543210, 0x7fedcb98, 0x88788888, 0x88888288, 0x78, 0x221708, 0x7, 0x0
  .long 0x8170807, 0x8370827, 0x8570847, 0x8770867, 0x8970887, 0x8c708a7, 0x8e708d7, 0x8bf08f7
  .long 0x76543210, 0xefadcb98, 0x88a88888, 0x88888d88, 0xe8, 0x2d1a08, 0xe, 0x0
  .long 0x81d080d, 0x83d082d, 0x85d084d, 0x87d086d, 0x89d088d, 0x8bd08ad, 0x8ed08dd, 0x8cf08fd
  .long 0x76a43210, 0x5fedcb98, 0x88788888, 0x88888188, 0x57, 0x210817, 0x5, 0x0
  .long 0x4650445, 0x4e504c5, 0x8250805, 0x8590835, 0x8a50885, 0xc1508b5, 0xc950c75, 0x8df0cf5
  .long 0x76a43210, 0x8fedcb95, 0x88d88888, 0x88888288, 0x88, 0x221d08, 0x8, 0x0
  .long 0x8180808, 0x8380828, 0x8580848, 0x8780868, 0x8980888, 0x8b808a8, 0x8d808c8, 0x8ef08f8
  .long 0x76a43510, 0x2fedcb98, 0x88288888, 0x88888788, 0x28, 0x271208, 0x2, 0x0
  .long 0x8120802, 0x8320822, 0x8520842, 0x8720862, 0x8920882, 0x8b208a2, 0x8d208c2, 0x8ff08e2
  .long 0x76a43210, 0x9fedcb58, 0x99a99999, 0x99999899, 0x99, 0x281a09, 0x9, 0x0
  .long 0x9290919, 0x9490939, 0x9690959, 0x9890979, 0x9a90999, 0x9c909b9, 0x9e909d9, 0x90f09f9
  .long 0x76a43210, 0x5fedcb98, 0x99599999, 0x99999599, 0x55, 0x250915, 0x5, 0x0
  .long 0xb90036, 0x6f50675, 0xa210993, 0xaa30a65, 0xce50b55, 0xf040ed5, 0xf810f45, 0x91f0fc5
  .long 0x76a53210, 0x4fedcb98, 0x99399999, 0x99999299, 0x49, 0x221309, 0x4, 0x0
  .long 0x9140904, 0x9440934, 0x9640954, 0x9840974, 0x9a40994, 0x9c409b4, 0x9e409d4, 0x92f09f4
  .long 0x76a43250, 0x1fedcb98, 0x99399999, 0x99999999, 0x19, 0x291309, 0x1, 0x0
  .long 0x9110901, 0x9410921, 0x9610951, 0x9810971, 0x9a10991, 0x9c109b1, 0x9e109d1, 0x93f09f1
  .long 0x76543210, 0xfaedcb98, 0x99c99999, 0x99999e99, 0xf9, 0x2e1c09, 0xf, 0x0
  .long 0x91e090e, 0x93e092e, 0x96e095e, 0x98e097e, 0x9ae099e, 0x9ce09be, 0x9ee09de, 0x94f09fe
  .long 0x76543210, 0xefadcb98, 0x99b99999, 0x99999a99, 0xe9, 0x2a1b09, 0xe, 0x0
  .long 0x91d090d, 0x93d092d, 0x96d094d, 0x98d097d, 0x9ad099d, 0x9cd09bd, 0x9ed09dd, 0x95f09fd
  .long 0x76543210, 0xcfedab98, 0x99899999, 0x99999a99, 0xc9, 0x2a1809, 0xc, 0x0
  .long 0x91b090b, 0x93b092b, 0x95b094b, 0x98b097b, 0x9ab099b, 0x9cb09bb, 0x9eb09db, 0x96f09fb
  .long 0x56a43210, 0x7fedcb98, 0x99e99999, 0x99999599, 0x79, 0x251e09, 0x7, 0x0
  .long 0x9170907, 0x9370927, 0x9570947, 0x9870967, 0x9a70997, 0x9c709b7, 0x9e709d7, 0x97f09f7
  .long 0x75a43210, 0x6fedcb98, 0x99a99999, 0x99999899, 0x69, 0x281a09, 0x6, 0x0
  .long 0x9160906, 0x9360926, 0x9560946, 0x9760966, 0x9a60996, 0x9c609b6, 0x9e609d6, 0x98f09f6
  .long 0x76a45210, 0x3fedcb98, 0x99599999, 0x99999599, 0x39, 0x251509, 0x3, 0x0
  .long 0x9130903, 0x9330923, 0x9530943, 0x9730963, 0x9a30983, 0x9c309b3, 0x9e309d3, 0x99f09f3
  .long 0x76a43215, 0xfedcb98, 0x99399999, 0x99999299, 0x9, 0x221309, 0x0, 0x0
  .long 0x9100900, 0x9300920, 0x9500940, 0x9700960, 0x9900980, 0x9c009b0, 0x9e009d0, 0x9af09f0
  .long 0x76a43510, 0x2fedcb98, 0x99399999, 0x99999999, 0x29, 0x291309, 0x2, 0x0
  .long 0x9120902, 0x9320922, 0x9520942, 0x9720962, 0x9920982, 0x9c209a2, 0x9e209d2, 0x9bf09f2
  .long 0x76543210, 0xdfeacb98, 0x99c99999, 0x99999e99, 0xd9, 0x2e1c09, 0xd, 0x0
  .long 0x91c090c, 0x93c092c, 0x95c094c, 0x97c096c, 0x99c098c, 0x9bc09ac, 0x9ec09dc, 0x9cf09fc
  .long 0x76543210, 0xbfedca98, 0x99b99999, 0x99999a99, 0xb9, 0x2a1b09, 0xb, 0x0
  .long 0x91a090a, 0x93a092a, 0x95a094a, 0x97a096a, 0x99a098a, 0x9ba09aa, 0x9ea09ca, 0x9df09fa
  .long 0x76543210, 0xafedcb98, 0x99899999, 0x99999a99, 0xaa, 0x18092a, 0xa, 0x0
  .long 0x7c80746, 0x96b095d, 0xa2509da, 0xaa50a35, 0xb050ab5, 0xd190b85, 0xe7e0d97, 0x9ef0efa
  .long 0x76a43210, 0x8fedcb95, 0x99e99999, 0x99999599, 0x89, 0x251e09, 0x8, 0x0
  .long 0x9180908, 0x9380928, 0x9580948, 0x9780968, 0x9980988, 0x9b809a8, 0x9d809c8, 0x9ff09e8
  .long 0x76543210, 0xdfeacb98, 0xaadaaaaa, 0xaaaaadaa, 0xda, 0x2d1d0a, 0xd, 0x0
  .long 0xa2c0a1c, 0xa4c0a3c, 0xa6c0a5c, 0xa8c0a7c, 0xaac0a9c, 0xacc0abc, 0xaec0adc, 0xa0f0afc
  .long 0x76543210, 0xfaedcb98, 0xaa8aaaaa, 0xaaaaafaa, 0xfa, 0x2f180a, 0xf, 0x0
  .long 0xa2e0a0e, 0xa4e0a3e, 0xa6e0a5e, 0xa8e0a7e, 0xaae0a9e, 0xace0abe, 0xaee0ade, 0xa1f0afe
  .long 0x76a43250, 0x1fedcb98, 0xaa5aaaaa, 0xaaaaaaaa, 0x1a, 0x2a150a, 0x1, 0x0
  .long 0xa110a01, 0xa410a31, 0xa610a51, 0xa810a71, 0xaa10a91, 0xac10ab1, 0xae10ad1, 0xa2f0af1
  .long 0x76a53210, 0x4fedcb98, 0xaa4aaaaa, 0xaaaaaaaa, 0x4a, 0x2a140a, 0x4, 0x0
  .long 0xa140a04, 0xa440a24, 0xa640a54, 0xa840a74, 0xaa40a94, 0xac40ab4, 0xae40ad4, 0xa3f0af4
  .long 0x75a43210, 0x6fedcb98, 0xaadaaaaa, 0xaaaaa8aa, 0x6a, 0x281d0a, 0x6, 0x0
  .long 0xa160a06, 0xa360a26, 0xa660a56, 0xa860a76, 0xaa60a96, 0xac60ab6, 0xae60ad6, 0xa4f0af6
  .long 0x76543210, 0xafedcb98, 0xaaeaaaaa, 0xaaaaa9aa, 0xa9, 0x1e0a29, 0xa, 0x0
  .long 0x1960118, 0x3070275, 0x5490388, 0x5f505c7, 0x9b50935, 0xc250ad7, 0xe650ca5, 0xa5f0ee5
  .long 0x76543210, 0xefadcb98, 0xaa5aaaaa, 0xaaaaabaa, 0xea, 0x2b150a, 0xe, 0x0
  .long 0xa1d0a0d, 0xa3d0a2d, 0xa5d0a4d, 0xa8d0a7d, 0xaad0a9d, 0xacd0abd, 0xaed0add, 0xa6f0afd
  .long 0x76a43210, 0x8fedcb95, 0xaadaaaaa, 0xaaaaa3aa, 0x8a, 0x231d0a, 0x8, 0x0
  .long 0xa180a08, 0xa380a28, 0xa580a48, 0xa880a68, 0xaa80a98, 0xac80ab8, 0xae80ad8, 0xa7f0af8
  .long 0x76543210, 0xbfedca98, 0xaadaaaaa, 0xaaaaadaa, 0xba, 0x2d1d0a, 0xb, 0x0
  .long 0xa1a0a0a, 0xa3a0a2a, 0xa5a0a4a, 0xa7a0a6a, 0xaaa0a9a, 0xaca0aba, 0xaea0ada, 0xa8f0afa
  .long 0x76543210, 0xcfedab98, 0xaa8aaaaa, 0xaaaaafaa, 0xca, 0x2f180a, 0xc, 0x0
  .long 0xa1b0a0b, 0xa3b0a2b, 0xa5b0a4b, 0xa7b0a6b, 0xaab0a8b, 0xacb0abb, 0xaeb0adb, 0xa9f0afb
  .long 0x76a45210, 0x3fedcb98, 0xaa5aaaaa, 0xaaaaaaaa, 0x3a, 0x2a150a, 0x3, 0x0
  .long 0xa130a03, 0xa330a23, 0xa530a43, 0xa730a63, 0xa930a83, 0xac30ab3, 0xae30ad3, 0xaaf0af3
  .long 0x76a43510, 0x2fedcb98, 0xaa4aaaaa, 0xaaaaaaaa, 0x2a, 0x2a140a, 0x2, 0x0
  .long 0xa120a02, 0xa320a22, 0xa520a42, 0xa720a62, 0xa920a82, 0xac20aa2, 0xae20ad2, 0xabf0af2
  .long 0x76a43210, 0x5fedcb98, 0xaadaaaaa, 0xaaaaa8aa, 0x5d, 0x280a1d, 0x5, 0x0
  .long 0xa50025, 0x3d90356, 0x8e80866, 0xa460a05, 0xa850a78, 0xb150af9, 0xb950b35, 0xacf0bb5
  .long 0xa6543210, 0x7fedcb98, 0xaaeaaaaa, 0xaaaaa9aa, 0x7a, 0x291e0a, 0x7, 0x0
  .long 0xa170a07, 0xa370a27, 0xa570a47, 0xa770a67, 0xa970a87, 0xab70aa7, 0xae70ac7, 0xadf0af7
  .long 0x76a43215, 0xfedcb98, 0xaa4aaaaa, 0xaaaaa1aa, 0xa, 0x21140a, 0x0, 0x0
  .long 0xa100a00, 0xa300a20, 0xa500a40, 0xa700a60, 0xa900a80, 0xab00aa0, 0xad00ac0, 0xaef0af0
  .long 0x76a43210, 0x9fedcb58, 0xaadaaaaa, 0xaaaaa3aa, 0x9a, 0x231d0a, 0x9, 0x0
  .long 0xa190a09, 0xa390a29, 0xa590a49, 0xa790a69, 0xa990a89, 0xab90aa9, 0xad90ac9, 0xaff0ae9
  .long 0x76a43210, 0x5fedcb98, 0xbbebbbbb, 0xbbbbbabb, 0x5e, 0x2a0b1e, 0x5, 0x0
  .long 0x980017, 0x3b50335, 0x6c80646, 0x9f80977, 0xad50a55, 0xd250b86, 0xee60e69, 0xb0f0fa5
  .long 0x76543210, 0xefadcb98, 0xbbdbbbbb, 0xbbbbbdbb, 0xeb, 0x2d1d0b, 0xe, 0x0
  .long 0xb2d0b0d, 0xb4d0b3d, 0xb6d0b5d, 0xb8d0b7d, 0xbad0b9d, 0xbcd0bbd, 0xbed0bdd, 0xb1f0bfd
  .long 0x76543210, 0xafedcb98, 0xbb6bbbbb, 0xbbbbb3bb, 0xa3, 0x160b23, 0xa, 0x0
  .long 0x2850205, 0x3c50345, 0x4350415, 0x4950467, 0x4e904b5, 0xaf50a75, 0xbd50ba9, 0xb2f0e55
  .long 0x76543210, 0xcfedab98, 0xbbdbbbbb, 0xbbbbbbbb, 0xcb, 0x2b1d0b, 0xc, 0x0
  .long 0xb1b0b0b, 0xb4b0b2b, 0xb6b0b5b, 0xb8b0b7b, 0xbab0b9b, 0xbcb0bbb, 0xbeb0bdb, 0xb3f0bfb
  .long 0xa6543210, 0x7fedcb98, 0xbb6bbbbb, 0xbbbbb0bb, 0x7b, 0x20160b, 0x7, 0x0
  .long 0xb170b07, 0xb370b27, 0xb670b57, 0xb870b77, 0xba70b97, 0xbc70bb7, 0xbe70bd7, 0xb4f0bf7
  .long 0x76543210, 0xdfeacb98, 0xbb5bbbbb, 0xbbbbbdbb, 0xdb, 0x2d150b, 0xd, 0x0
  .long 0xb1c0b0c, 0xb3c0b2c, 0xb6c0b4c, 0xb8c0b7c, 0xbac0b9c, 0xbcc0bbc, 0xbec0bdc, 0xb5f0bfc
  .long 0x76a43215, 0xfedcb98, 0xbb1bbbbb, 0xbbbbb6bb, 0xb, 0x26110b, 0x0, 0x0
  .long 0xb100b00, 0xb300b20, 0xb500b40, 0xb800b70, 0xba00b90, 0xbc00bb0, 0xbe00bd0, 0xb6f0bf0
  .long 0x76a53210, 0x4fedcb98, 0xbb3bbbbb, 0xbbbbb8bb, 0x4b, 0x28130b, 0x4, 0x0
  .long 0xb140b04, 0xb340b24, 0xb540b44, 0xb840b64, 0xba40b94, 0xbc40bb4, 0xbe40bd4, 0xb7f0bf4
  .long 0x75a43210, 0x6fedcb98, 0xbbebbbbb, 0xbbbbbabb, 0x6b, 0x2a1e0b, 0x6, 0x0
  .long 0xb160b06, 0xb360b26, 0xb560b46, 0xb760b66, 0xba60b96, 0xbc60bb6, 0xbe60bd6, 0xb8f0bf6
  .long 0x76543210, 0xbfedca98, 0xbbdbbbbb, 0xbbbbbdbb, 0xbb, 0x2d1d0b, 0xb, 0x0
  .long 0xb1a0b0a, 0xb3a0b2a, 0xb5a0b4a, 0xb7a0b6a, 0xbaa0b8a, 0xbca0bba, 0xbea0bda, 0xb9f0bfa
  .long 0x76543210, 0x9fedcba8, 0xbb6bbbbb, 0xbbbbb3bb, 0x9b, 0x23160b, 0x9, 0x0
  .long 0xb190b09, 0xb390b29, 0xb590b49, 0xb790b69, 0xb990b89, 0xbc90bb9, 0xbe90bd9, 0xbaf0bf9
  .long 0x76543210, 0xfaedcb98, 0xbbdbbbbb, 0xbbbbbbbb, 0xfb, 0x2b1d0b, 0xf, 0x0
  .long 0xb1e0b0e, 0xb3e0b2e, 0xb5e0b4e, 0xb7e0b6e, 0xb9e0b8e, 0xbce0bae, 0xbee0bde, 0xbbf0bfe
  .long 0x76543210, 0x8fedcb9a, 0xbb6bbbbb, 0xbbbbb0bb, 0x8b, 0x20160b, 0x8, 0x0
  .long 0xb180b08, 0xb380b28, 0xb580b48, 0xb780b68, 0xb980b88, 0xbb80ba8, 0xbe80bd8, 0xbcf0bf8
  .long 0x76a43510, 0x2fedcb98, 0xbb4bbbbb, 0xbbbbb3bb, 0x2b, 0x23140b, 0x2, 0x0
  .long 0xb120b02, 0xb320b22, 0xb520b42, 0xb720b62, 0xb920b82, 0xbb20ba2, 0xbe20bc2, 0xbdf0bf2
  .long 0x76a45210, 0x3fedcb98, 0xbb1bbbbb, 0xbbbbb6bb, 0x3b, 0x26110b, 0x3, 0x0
  .long 0xb130b03, 0xb330b23, 0xb530b43, 0xb730b63, 0xb930b83, 0xbb30ba3, 0xbd30bc3, 0xbef0bf3
  .long 0x76a43250, 0x1fedcb98, 0xbb3bbbbb, 0xbbbbb8bb, 0x1b, 0x28130b, 0x1, 0x0
  .long 0xb110b01, 0xb310b21, 0xb510b41, 0xb710b61, 0xb910b81, 0xbb10ba1, 0xbd10bc1, 0xbff0be1
  .long 0x76543210, 0xefadcb98, 0xcccccccc, 0xcccccccc, 0xec, 0x2c1c0c, 0xe, 0x0
  .long 0xc2d0c1d, 0xc4d0c3d, 0xc6d0c5d, 0xc8d0c7d, 0xcad0c9d, 0xccd0cbd, 0xced0cdd, 0xc0f0cfd
  .long 0x76543210, 0xbfedca98, 0xcc7ccccc, 0xcccccbcc, 0xbc, 0x2b170c, 0xb, 0x0
  .long 0xc2a0c0a, 0xc4a0c3a, 0xc6a0c5a, 0xc8a0c7a, 0xcaa0c9a, 0xcca0cba, 0xcea0cda, 0xc1f0cfa
  .long 0x76a43210, 0x5fedcb98, 0xccaccccc, 0xccccc9cc, 0x5a, 0x290c1a, 0x5, 0x0
  .long 0x2650145, 0x31502e5, 0x5550395, 0x8c505d5, 0x9860909, 0xca70c35, 0xe750cb5, 0xc2f0ef5
  .long 0x76543210, 0x8fedcb9a, 0xccaccccc, 0xccccc7cc, 0x8c, 0x271a0c, 0x8, 0x0
  .long 0xc180c08, 0xc480c28, 0xc680c58, 0xc880c78, 0xca80c98, 0xcc80cb8, 0xce80cd8, 0xc3f0cf8
  .long 0x76a53210, 0x4fedcb98, 0xcc2ccccc, 0xccccc5cc, 0x4c, 0x25120c, 0x4, 0x0
  .long 0xc140c04, 0xc340c24, 0xc640c54, 0xc840c74, 0xca40c94, 0xcc40cb4, 0xce40cd4, 0xc4f0cf4
  .long 0x76a43250, 0x1fedcb98, 0xcc1ccccc, 0xccccc4cc, 0x1c, 0x24110c, 0x1, 0x0
  .long 0xc110c01, 0xc310c21, 0xc610c41, 0xc810c71, 0xca10c91, 0xcc10cb1, 0xce10cd1, 0xc5f0cf1
  .long 0x76a45210, 0x3fedcb98, 0xcc4ccccc, 0xccccc1cc, 0x3c, 0x21140c, 0x3, 0x0
  .long 0xc130c03, 0xc330c23, 0xc530c43, 0xc830c73, 0xca30c93, 0xcc30cb3, 0xce30cd3, 0xc6f0cf3
  .long 0x7a543210, 0x6fedcb98, 0xcc7ccccc, 0xccccc0cc, 0x6c, 0x20170c, 0x6, 0x0
  .long 0xc160c06, 0xc360c26, 0xc560c46, 0xc860c66, 0xca60c96, 0xcc60cb6, 0xce60cd6, 0xc7f0cf6
  .long 0x76543210, 0xfaedcb98, 0xcccccccc, 0xcccccccc, 0xfc, 0x2c1c0c, 0xf, 0x0
  .long 0xc1e0c0e, 0xc3e0c2e, 0xc5e0c4e, 0xc7e0c6e, 0xcae0c9e, 0xcce0cbe, 0xcee0cde, 0xc8f0cfe
  .long 0x76543210, 0xdfeacb98, 0xcc7ccccc, 0xcccccbcc, 0xdc, 0x2b170c, 0xd, 0x0
  .long 0xc1c0c0c, 0xc3c0c2c, 0xc5c0c4c, 0xc7c0c6c, 0xcac0c8c, 0xccc0cbc, 0xcec0cdc, 0xc9f0cfc
  .long 0x56a43210, 0x7fedcb98, 0xccaccccc, 0xccccc9cc, 0x7c, 0x291a0c, 0x7, 0x0
  .long 0xc170c07, 0xc370c27, 0xc570c47, 0xc770c67, 0xc970c87, 0xcc70cb7, 0xce70cd7, 0xcaf0cf7
  .long 0x76543210, 0x9fedcba8, 0xccaccccc, 0xccccc7cc, 0x9c, 0x271a0c, 0x9, 0x0
  .long 0xc190c09, 0xc390c29, 0xc590c49, 0xc790c69, 0xc990c89, 0xcc90ca9, 0xce90cd9, 0xcbf0cf9
  .long 0x76a43215, 0xfedcb98, 0xcc2ccccc, 0xccccc5cc, 0xc, 0x25120c, 0x0, 0x0
  .long 0xc100c00, 0xc300c20, 0xc500c40, 0xc700c60, 0xc900c80, 0xcb00ca0, 0xce00cd0, 0xccf0cf0
  .long 0x76a43510, 0x2fedcb98, 0xcc1ccccc, 0xccccc4cc, 0x2c, 0x24110c, 0x2, 0x0
  .long 0xc120c02, 0xc320c22, 0xc520c42, 0xc720c62, 0xc920c82, 0xcb20ca2, 0xce20cc2, 0xcdf0cf2
  .long 0x76543210, 0xcfedab98, 0xcc5ccccc, 0xcccccbcc, 0xcc, 0x2b150c, 0xc, 0x0
  .long 0xc1b0c0b, 0xc3b0c2b, 0xc5b0c4b, 0xc7b0c6b, 0xc9b0c8b, 0xcbb0cab, 0xcdb0ccb, 0xcef0cfb
  .long 0x76543210, 0xafedcb98, 0xcc7ccccc, 0xccccc0cc, 0xa0, 0x170c20, 0xa, 0x0
  .long 0x950015, 0x3e50365, 0x4880406, 0x6d50655, 0xbc80b47, 0xe250c76, 0xf350ea5, 0xcff0fb5
  .long 0x76a53210, 0x4fedcb98, 0xdd3ddddd, 0xddddd2dd, 0x4d, 0x22130d, 0x4, 0x0
  .long 0xd240d14, 0xd440d34, 0xd640d54, 0xd840d74, 0xda40d94, 0xdc40db4, 0xde40dd4, 0xd0f0df4
  .long 0x76543210, 0x9fedcba8, 0xdd9ddddd, 0xdddddadd, 0x9d, 0x2a190d, 0x9, 0x0
  .long 0xd290d09, 0xd490d39, 0xd690d59, 0xd890d79, 0xda90d99, 0xdc90db9, 0xde90dd9, 0xd1f0df9
  .long 0x76543210, 0xbfedca98, 0xddeddddd, 0xdddddcdd, 0xbd, 0x2c1e0d, 0xb, 0x0
  .long 0xd1a0d0a, 0xd4a0d3a, 0xd6a0d5a, 0xd8a0d7a, 0xdaa0d9a, 0xdca0dba, 0xdea0dda, 0xd2f0dfa
  .long 0x75a43210, 0x6fedcb98, 0xdd8ddddd, 0xddddd8dd, 0x6d, 0x28180d, 0x6, 0x0
  .long 0xd160d06, 0xd460d26, 0xd660d56, 0xd860d76, 0xda60d96, 0xdc60db6, 0xde60dd6, 0xd3f0df6
  .long 0x76a43250, 0x1fedcb98, 0xdd1ddddd, 0xddddd4dd, 0x1d, 0x24110d, 0x1, 0x0
  .long 0xd110d01, 0xd310d21, 0xd610d51, 0xd810d71, 0xda10d91, 0xdc10db1, 0xde10dd1, 0xd4f0df1
  .long 0x76543210, 0xfaedcb98, 0xddcddddd, 0xdddddfdd, 0xfd, 0x2f1c0d, 0xf, 0x0
  .long 0xd1e0d0e, 0xd3e0d2e, 0xd6e0d4e, 0xd8e0d7e, 0xdae0d9e, 0xdce0dbe, 0xdee0dde, 0xd5f0dfe
  .long 0x76543210, 0xcfedab98, 0xddcddddd, 0xdddddfdd, 0xcd, 0x2f1c0d, 0xc, 0x0
  .long 0xd1b0d0b, 0xd3b0d2b, 0xd5b0d4b, 0xd8b0d7b, 0xdab0d9b, 0xdcb0dbb, 0xdeb0ddb, 0xd6f0dfb
  .long 0x76543210, 0x8fedcb9a, 0xddcddddd, 0xddddd1dd, 0x8d, 0x211c0d, 0x8, 0x0
  .long 0xd180d08, 0xd380d28, 0xd580d48, 0xd880d68, 0xda80d98, 0xdc80db8, 0xde80dd8, 0xd7f0df8
  .long 0x76a43215, 0xfedcb98, 0xdd3ddddd, 0xddddd2dd, 0xd, 0x22130d, 0x0, 0x0
  .long 0xd100d00, 0xd300d20, 0xd500d40, 0xd700d60, 0xda00d90, 0xdc00db0, 0xde00dd0, 0xd8f0df0
  .long 0xa6543210, 0x7fedcb98, 0xdd9ddddd, 0xdddddadd, 0x7d, 0x2a190d, 0x7, 0x0
  .long 0xd170d07, 0xd370d27, 0xd570d47, 0xd770d67, 0xda70d87, 0xdc70db7, 0xde70dd7, 0xd9f0df7
  .long 0x76a43510, 0x2fedcb98, 0xdd0ddddd, 0xddddd8dd, 0x2d, 0x28100d, 0x2, 0x0
  .long 0xd120d02, 0xd320d22, 0xd520d42, 0xd720d62, 0xd920d82, 0xdc20db2, 0xde20dd2, 0xdaf0df2
  .long 0x76a43210, 0x5fedcb98, 0xdd8ddddd, 0xddddd8dd, 0x58, 0x280d18, 0x5, 0x0
  .long 0xd50055, 0x2a50225, 0x3f50375, 0x5c50545, 0x7850705, 0x9e50965, 0xa950a15, 0xdbf0d36
  .long 0x76a45210, 0x3fedcb98, 0xdd1ddddd, 0xddddd4dd, 0x3d, 0x24110d, 0x3, 0x0
  .long 0xd130d03, 0xd330d23, 0xd530d43, 0xd730d63, 0xd930d83, 0xdb30da3, 0xde30dd3, 0xdcf0df3
  .long 0x76543210, 0xdfeacb98, 0xddcddddd, 0xdddddfdd, 0xdd, 0x2f1c0d, 0xd, 0x0
  .long 0xd1c0d0c, 0xd3c0d2c, 0xd5c0d4c, 0xd7c0d6c, 0xd9c0d8c, 0xdbc0dac, 0xdec0dcc, 0xddf0dfc
  .long 0x76543210, 0xefadcb98, 0xddcddddd, 0xdddddfdd, 0xed, 0x2f1c0d, 0xe, 0x0
  .long 0xd1d0d0d, 0xd3d0d2d, 0xd5d0d4d, 0xd7d0d6d, 0xd9d0d8d, 0xdbd0dad, 0xddd0dcd, 0xdef0dfd
  .long 0x76543210, 0xafedcb98, 0xddcddddd, 0xddddd1dd, 0xa1, 0x1c0d21, 0xa, 0x0
  .long 0x2c50245, 0x5850505, 0x6a90627, 0x7b50735, 0x8550815, 0x8d50895, 0xc650ae5, 0xdff0d78
  .long 0x76543210, 0xafedcb98, 0xee9eeeee, 0xeeeee4ee, 0xa4, 0x190e24, 0xa, 0x0
  .long 0x750035, 0xf500b5, 0x3a50325, 0x5e50565, 0xcd50c55, 0xdc50d45, 0xf150e87, 0xe0f0f95
  .long 0x76a43510, 0x2fedcb98, 0xee4eeeee, 0xeeeee2ee, 0x2e, 0x22140e, 0x2, 0x0
  .long 0xe220e02, 0xe420e32, 0xe620e52, 0xe820e72, 0xea20e92, 0xec20eb2, 0xee20ed2, 0xe1f0ef2
  .long 0x76a45210, 0x3fedcb98, 0xee4eeeee, 0xeeeee0ee, 0x3e, 0x20140e, 0x3, 0x0
  .long 0xe130e03, 0xe430e33, 0xe630e53, 0xe830e73, 0xea30e93, 0xec30eb3, 0xee30ed3, 0xe2f0ef3
  .long 0x76a43210, 0x8fedcb95, 0xeeceeeee, 0xeeeee5ee, 0x8e, 0x251c0e, 0x8, 0x0
  .long 0xe180e08, 0xe480e28, 0xe680e58, 0xe880e78, 0xea80e98, 0xec80eb8, 0xee80ed8, 0xe3f0ef8
  .long 0x76543210, 0xcfedab98, 0xeebeeeee, 0xeeeeebee, 0xce, 0x2b1b0e, 0xc, 0x0
  .long 0xe1b0e0b, 0xe3b0e2b, 0xe6b0e5b, 0xe8b0e7b, 0xeab0e9b, 0xecb0ebb, 0xeeb0edb, 0xe4f0efb
  .long 0x76a43250, 0x1fedcb98, 0xee4eeeee, 0xeeeee3ee, 0x1e, 0x23140e, 0x1, 0x0
  .long 0xe110e01, 0xe310e21, 0xe610e41, 0xe810e71, 0xea10e91, 0xec10eb1, 0xee10ed1, 0xe5f0ef1
  .long 0x76a43210, 0x9fedcb58, 0xeeeeeeee, 0xeeeee9ee, 0x9e, 0x291e0e, 0x9, 0x0
  .long 0xe190e09, 0xe390e29, 0xe590e49, 0xe890e79, 0xea90e99, 0xec90eb9, 0xee90ed9, 0xe6f0ef9
  .long 0x76543210, 0xfaedcb98, 0xeeaeeeee, 0xeeeeeaee, 0xfe, 0x2a1a0e, 0xf, 0x0
  .long 0xe1e0e0e, 0xe3e0e2e, 0xe5e0e4e, 0xe8e0e6e, 0xeae0e9e, 0xece0ebe, 0xeee0ede, 0xe7f0efe
  .long 0xa6543210, 0x7fedcb98, 0xee9eeeee, 0xeeeee4ee, 0x7e, 0x24190e, 0x7, 0x0
  .long 0xe170e07, 0xe370e27, 0xe570e47, 0xe770e67, 0xea70e97, 0xec70eb7, 0xee70ed7, 0xe8f0ef7
  .long 0x76a53210, 0x4fedcb98, 0xee4eeeee, 0xeeeee2ee, 0x4e, 0x22140e, 0x4, 0x0
  .long 0xe140e04, 0xe340e24, 0xe540e44, 0xe740e64, 0xea40e84, 0xec40eb4, 0xee40ed4, 0xe9f0ef4
  .long 0x76a43215, 0xfedcb98, 0xee4eeeee, 0xeeeee0ee, 0xe, 0x20140e, 0x0, 0x0
  .long 0xe100e00, 0xe300e20, 0xe500e40, 0xe700e60, 0xe900e80, 0xec00eb0, 0xee00ed0, 0xeaf0ef0
  .long 0x76a43210, 0x5fedcb98, 0xeeceeeee, 0xeeeee5ee, 0x5c, 0x250e1c, 0x5, 0x0
  .long 0x1950115, 0x6a50625, 0x9c50945, 0xc850c05, 0xd650d55, 0xdd50d75, 0xdf50de5, 0xebf0e38
  .long 0x76543210, 0xdfeacb98, 0xeebeeeee, 0xeeeeebee, 0xde, 0x2b1b0e, 0xd, 0x0
  .long 0xe1c0e0c, 0xe3c0e2c, 0xe5c0e4c, 0xe7c0e6c, 0xe9c0e8c, 0xebc0eac, 0xeec0edc, 0xecf0efc
  .long 0x76543210, 0xefadcb98, 0xee5eeeee, 0xeeeeedee, 0xee, 0x2d150e, 0xe, 0x0
  .long 0xe1d0e0d, 0xe3d0e2d, 0xe5d0e4d, 0xe7d0e6d, 0xe9d0e8d, 0xebd0ead, 0xeed0ecd, 0xedf0efd
  .long 0x75a43210, 0x6fedcb98, 0xeeeeeeee, 0xeeeee9ee, 0x6e, 0x291e0e, 0x6, 0x0
  .long 0xe160e06, 0xe360e26, 0xe560e46, 0xe760e66, 0xe960e86, 0xeb60ea6, 0xed60ec6, 0xeef0ef6
  .long 0x76543210, 0xbfedca98, 0xeeaeeeee, 0xeeeeeaee, 0xbe, 0x2a1a0e, 0xb, 0x0
  .long 0xe1a0e0a, 0xe3a0e2a, 0xe5a0e4a, 0xe7a0e6a, 0xe9a0e8a, 0xeba0eaa, 0xeda0eca, 0xeff0eea
  .long 0x76a53210, 0x4fedcb98, 0xff5fffff, 0xfffff7ff, 0x4f, 0x27150f, 0x4, 0x0
  .long 0xf240f14, 0xf440f34, 0xf640f54, 0xf840f74, 0xfa40f94, 0xfc40fb4, 0xfe40fd4, 0xf0f0ff4
  .long 0x76a43510, 0x2fedcb98, 0xff2fffff, 0xfffff4ff, 0x2f, 0x24120f, 0x2, 0x0
  .long 0xf220f02, 0xf420f32, 0xf620f52, 0xf820f72, 0xfa20f92, 0xfc20fb2, 0xfe20fd2, 0xf1f0ff2
  .long 0x76a43215, 0xfedcb98, 0xff0fffff, 0xfffff8ff, 0xf, 0x28100f, 0x0, 0x0
  .long 0xf100f00, 0xf400f30, 0xf600f50, 0xf800f70, 0xfa00f90, 0xfc00fb0, 0xfe00fd0, 0xf2f0ff0
  .long 0x76a43210, 0x9fedcb58, 0xff6fffff, 0xfffff0ff, 0x9f, 0x20160f, 0x9, 0x0
  .long 0xf190f09, 0xf490f29, 0xf690f59, 0xf890f79, 0xfa90f99, 0xfc90fb9, 0xfe90fd9, 0xf3f0ff9
  .long 0x7a543210, 0x6fedcb98, 0xff5fffff, 0xfffff7ff, 0x6f, 0x27150f, 0x6, 0x0
  .long 0xf160f06, 0xf360f26, 0xf660f56, 0xf860f76, 0xfa60f96, 0xfc60fb6, 0xfe60fd6, 0xf4f0ff6
  .long 0x76543210, 0xdfeacb98, 0xffffffff, 0xfffffeff, 0xdf, 0x2e1f0f, 0xd, 0x0
  .long 0xf1c0f0c, 0xf3c0f2c, 0xf6c0f4c, 0xf8c0f7c, 0xfac0f9c, 0xfcc0fbc, 0xfec0fdc, 0xf5f0ffc
  .long 0xa6543210, 0x7fedcb98, 0xffbfffff, 0xfffff8ff, 0x7f, 0x281b0f, 0x7, 0x0
  .long 0xf170f07, 0xf370f27, 0xf570f47, 0xf870f77, 0xfa70f97, 0xfc70fb7, 0xfe70fd7, 0xf6f0ff7
  .long 0x76543210, 0xbfedca98, 0xff9fffff, 0xfffffbff, 0xbf, 0x2b190f, 0xb, 0x0
  .long 0xf1a0f0a, 0xf3a0f2a, 0xf5a0f4a, 0xf8a0f6a, 0xfaa0f9a, 0xfca0fba, 0xfea0fda, 0xf7f0ffa
  .long 0x76a43250, 0x1fedcb98, 0xff5fffff, 0xfffff7ff, 0x1f, 0x27150f, 0x1, 0x0
  .long 0xf110f01, 0xf310f21, 0xf510f41, 0xf710f61, 0xfa10f91, 0xfc10fb1, 0xfe10fd1, 0xf8f0ff1
  .long 0x76a45210, 0x3fedcb98, 0xff2fffff, 0xfffff4ff, 0x3f, 0x24120f, 0x3, 0x0
  .long 0xf130f03, 0xf330f23, 0xf530f43, 0xf730f63, 0xfa30f83, 0xfc30fb3, 0xfe30fd3, 0xf9f0ff3
  .long 0x76543210, 0xfaedcb98, 0xffefffff, 0xfffffcff, 0xff, 0x2c1e0f, 0xf, 0x0
  .long 0xf1e0f0e, 0xf3e0f2e, 0xf5e0f4e, 0xf7e0f6e, 0xf9e0f8e, 0xfce0fbe, 0xfee0fde, 0xfaf0ffe
  .long 0x76a43210, 0x5fedcb98, 0xff6fffff, 0xfffff0ff, 0x56, 0x200f16, 0x5, 0x0
  .long 0x3850305, 0x4750455, 0x4f504d5, 0x6950615, 0x7e50765, 0xb450b25, 0xbc50ba5, 0xfbf0f39
  .long 0x76543210, 0x8fedcb9a, 0xff5fffff, 0xfffff7ff, 0x8f, 0x27150f, 0x8, 0x0
  .long 0xf180f08, 0xf380f28, 0xf580f48, 0xf780f68, 0xf980f88, 0xfb80fa8, 0xfe80fd8, 0xfcf0ff8
  .long 0x76543210, 0xcfedab98, 0xffffffff, 0xfffffeff, 0xcf, 0x2e1f0f, 0xc, 0x0
  .long 0xf1b0f0b, 0xf3b0f2b, 0xf5b0f4b, 0xf7b0f6b, 0xf9b0f8b, 0xfbb0fab, 0xfeb0fcb, 0xfdf0ffb
  .long 0x76543210, 0xafedcb98, 0xffbfffff, 0xfffff8ff, 0xa8, 0x1b0f28, 0xa, 0x0
  .long 0x3d50355, 0x7950715, 0x9850905, 0xac50a45, 0xbf50b75, 0xda50d35, 0xf250db5, 0xfef0f67
  .long 0x76543210, 0xefadcb98, 0xff9fffff, 0xfffffbff, 0xef, 0x2b190f, 0xe, 0x0
  .long 0xf1d0f0d, 0xf3d0f2d, 0xf5d0f4d, 0xf7d0f6d, 0xf9d0f8d, 0xfbd0fad, 0xfdd0fcd, 0xfff0fed
.section .rodata,"a"
.p2align 6
.amdhsa_kernel standalone__kv_cache_quant_pre_rope_vs_post_rope__sampling_kernel
  .amdhsa_next_free_vgpr 228
  .amdhsa_next_free_sgpr 102
  .amdhsa_accum_offset 228
  .amdhsa_group_segment_fixed_size 0
  .amdhsa_kernarg_size 112
  .amdhsa_user_sgpr_count 2
  .amdhsa_user_sgpr_kernarg_segment_ptr 1
  .amdhsa_system_sgpr_workgroup_id_x 1
.end_amdhsa_kernel
```

```asm
; @launch grid=(256,1,1) block=(320,1,1) lds=162304
.amdgcn_target "amdgcn-amd-amdhsa--gfx950"
.text
.globl standalone__kv_cache_quant_pre_rope_vs_post_rope__sampling_kernel
.p2align 12
.type L_pad,@object
L_pad:
.fill 832, 4, 0xbf810000
.p2align 8
.type standalone__kv_cache_quant_pre_rope_vs_post_rope__sampling_kernel,@function
standalone__kv_cache_quant_pre_rope_vs_post_rope__sampling_kernel:
  s_cmpk_ge_u32 s2, 0x100
  s_cbranch_scc1 L_end
  s_load_dwordx16 s[4:19], s[0:1], 0
  s_load_dwordx8 s[20:27], s[0:1], 64
  v_readfirstlane_b32 s40, v0
  s_lshr_b32 s42, s2, 4
  s_cmp_lg_u32 s40, 0
  s_cbranch_scc1 L_s0
  s_setprio 3
  s_getpc_b64 s[64:65]
  s_and_b32 s44, s2, 24
  v_and_b32 v20, 63, v0
  v_lshl_add_u32 v1, v20, 5, s44
  v_lshlrev_b32 v1, 4, v1
  global_load_dword v2, v1, s[64:65] offset:1024
  v_min_u32 v21, 47, v20
  v_add_u32 v22, 24, v21
  v_subrev_u32 v23, 24, v21
  v_min_u32 v27, v22, v23
  s_mul_i32 s44, s42, 48
  v_add_lshl_u32 v22, v21, s44, 3
  v_add_lshl_u32 v23, v27, s44, 3
  v_lshlrev_b32 v26, 3, v21
  s_and_b32 s44, s2, 7
  s_lshr_b32 s45, s2, 3
  s_mul_i32 s68, s44, 96
  s_add_u32 s68, s68, s45
  v_and_b32 v3, 15, v21
  v_lshl_add_u32 v3, s68, 4, v3
  v_and_b32 v4, 48, v21
  v_lshl_add_u32 v3, v4, 5, v3
  v_lshlrev_b32 v3, 6, v3
  s_and_b32 s68, s45, 3
  s_lshl4_add_u32 s44, s68, s44
  s_lshr_b32 s45, s45, 2
  s_lshl_b32 s45, s45, 8
  s_add_u32 s44, s44, s45
  v_and_b32 v4, 7, v20
  v_lshl_add_u32 v4, s44, 3, v4
  v_and_b32 v5, 24, v20
  v_lshl_add_u32 v4, v5, 6, v4
  v_and_b32 v5, 32, v20
  v_lshl_add_u32 v4, v5, 1, v4
  v_lshlrev_b32 v4, 6, v4
  s_waitcnt lgkmcnt(0)
  global_load_dwordx2 v[108:109], v22, s[4:5]
  global_load_dwordx2 v[110:111], v23, s[4:5]
  global_load_dwordx2 v[104:105], v26, s[18:19]
  global_load_dwordx2 v[106:107], v26, s[20:21]
  v_lshlrev_b32 v27, 3, v27
  s_add_u32 s68, s42, 16
  s_mul_i32 s44, s68, 384
  s_add_u32 s32, s4, s44
  s_addc_u32 s33, s5, 0
  global_load_dwordx2 v[68:69], v26, s[32:33]
  global_load_dwordx2 v[70:71], v27, s[32:33]
  global_load_dword v5, v3, s[22:23]
  global_load_dword v6, v3, s[24:25]
  global_load_dword v7, v4, s[8:9]
  global_load_dword v8, v4, s[10:11]
  global_load_dword v9, v4, s[14:15]
  global_load_dword v10, v4, s[16:17]
  v_mov_b32 v14, 0
  v_cmp_gt_u32 vcc, 24, v21
  v_mov_b32 v48, 0
  v_mov_b32 v49, 0
  v_mov_b32 v50, 0
  v_mov_b32 v51, 0
  ds_write_b128 v14, v[48:51] offset:0
  ds_write_b128 v14, v[48:51] offset:16
  s_waitcnt lgkmcnt(0)
  s_barrier
  s_mov_b32 s66, 0xffff0000
  s_mov_b32 s67, 0x3dd53b95
  v_cndmask_b32_e64 v30, 1.0, -1.0, vcc
  v_lshlrev_b32 v35, 4, v21
  v_mov_b32 v28, v35
  v_lshlrev_b32 v29, 1, v27
  v_mov_b32 v22, 0x80008000
  v_cndmask_b32 v31, v14, v22, vcc
  v_mov_b32 v38, 1
  s_mov_b32 s43, 1
  s_waitcnt vmcnt(8)
  v_lshlrev_b32 v52, 16, v104
  v_and_b32 v53, s66, v104
  v_lshlrev_b32 v54, 16, v105
  v_and_b32 v55, s66, v105
  v_lshlrev_b32 v56, 16, v106
  v_and_b32 v57, s66, v106
  v_lshlrev_b32 v58, 16, v107
  v_and_b32 v59, s66, v107
L_hr:
  v_lshlrev_b32 v76, 16, v108
  v_and_b32 v77, s66, v108
  v_lshlrev_b32 v78, 16, v109
  v_and_b32 v79, s66, v109
  v_lshlrev_b32 v80, 16, v110
  v_and_b32 v81, s66, v110
  v_lshlrev_b32 v82, 16, v111
  v_and_b32 v83, s66, v111
  v_mul_f32 v76, v76, v52
  v_mul_f32 v77, v77, v53
  v_mul_f32 v78, v78, v54
  v_mul_f32 v79, v79, v55
  v_mul_f32 v80, v80, v56
  v_mul_f32 v81, v81, v57
  v_mul_f32 v82, v82, v58
  v_mul_f32 v83, v83, v59
  v_cvt_pk_bf16_f32 v84, v76, v80
  v_cvt_pk_bf16_f32 v85, v77, v81
  v_cvt_pk_bf16_f32 v86, v78, v82
  v_cvt_pk_bf16_f32 v87, v79, v83
  v_lshlrev_b32 v76, 16, v84
  v_and_b32 v80, s66, v84
  v_lshlrev_b32 v77, 16, v85
  v_and_b32 v81, s66, v85
  v_lshlrev_b32 v78, 16, v86
  v_and_b32 v82, s66, v86
  v_lshlrev_b32 v79, 16, v87
  v_and_b32 v83, s66, v87
  v_fma_f32 v76, v80, v30, v76
  v_fma_f32 v77, v81, v30, v77
  v_fma_f32 v78, v82, v30, v78
  v_fma_f32 v79, v83, v30, v79
  v_cvt_pk_bf16_f32 v84, v76, v77
  v_cvt_pk_bf16_f32 v85, v78, v79
  v_xor_b32 v86, v31, v84
  v_xor_b32 v87, v31, v85
  v_mov_b32 v22, s43
  ds_write_b16 v28, v84 offset:512
  ds_write_b16_d16_hi v28, v84 offset:516
  ds_write_b16 v28, v85 offset:520
  ds_write_b16_d16_hi v28, v85 offset:524
  ds_write_b16 v29, v86 offset:514
  ds_write_b16_d16_hi v29, v86 offset:518
  ds_write_b16 v29, v87 offset:522
  ds_write_b16_d16_hi v29, v87 offset:526
  ds_write_b32 v14, v22 offset:16
  v_add_u32 v28, 1024, v28
  v_add_u32 v29, 1024, v29
  v_and_b32 v28, 0xfff, v28
  v_and_b32 v29, 0xfff, v29
  s_cmp_eq_u32 s43, 2
  s_cbranch_scc1 L_helper
  s_mov_b32 s43, 2
  s_waitcnt vmcnt(6) lgkmcnt(0)
  v_mov_b32 v108, v68
  v_mov_b32 v109, v69
  v_mov_b32 v110, v70
  v_mov_b32 v111, v71
  s_branch L_hr
L_s0:
  v_subrev_u32 v0, 64, v0
  s_sub_u32 s40, s40, 64
  s_and_b32 s44, s2, 7
  s_lshl_b32 s44, s44, 8
  s_bfe_u32 s41, s2, 0x10003
  s_mul_i32 s45, s41, 43
  s_add_u32 s44, s44, s45
  s_mulk_i32 s44, 768
  v_lshl_add_u32 v212, v0, 4, s44
  v_add_u32 v213, 4096, v212
  v_add_u32 v214, 8192, v212
  v_add_u32 v215, 12288, v212
  v_add_u32 v216, 16384, v212
  v_add_u32 v217, 20480, v212
  v_add_u32 v218, 24576, v212
  s_lshr_b32 s40, s40, 6
  v_lshrrev_b32 v25, 4, v0
  v_and_b32 v24, 15, v0
  v_mul_u32_u24 v20, 11, v25
  v_lshrrev_b32 v20, 5, v20
  v_mad_i32_i24 v20, v20, -3, v25
  v_lshlrev_b32 v21, 4, v24
  v_lshl_add_u32 v15, v20, 8, v21
  v_add_u32 v20, 256, v15
  v_subrev_u32 v21, 512, v15
  v_min_u32 v16, v20, v21
  v_add_u32 v20, 512, v15
  v_subrev_u32 v21, 256, v15
  v_min_u32 v17, v20, v21
  v_cmp_gt_u32 vcc, 8, v24
  v_lshlrev_b32 v23, 3, v24
  v_lshrrev_b32 v22, 1, v15
  v_add3_u32 v20, v22, v23, 64
  v_subrev_u32 v21, 384, v20
  v_min_u32 v20, v20, v21
  v_sub_u32 v20, v20, v22
  v_cndmask_b32 v240, v20, v23, vcc
  v_lshrrev_b32 v22, 1, v16
  v_add3_u32 v20, v22, v23, 64
  v_subrev_u32 v21, 384, v20
  v_min_u32 v20, v20, v21
  v_sub_u32 v20, v20, v22
  v_cndmask_b32 v241, v20, v23, vcc
  v_lshrrev_b32 v22, 1, v17
  v_add3_u32 v20, v22, v23, 64
  v_subrev_u32 v21, 384, v20
  v_min_u32 v20, v20, v21
  v_sub_u32 v20, v20, v22
  v_cndmask_b32 v242, v20, v23, vcc
  s_mul_i32 s100, s40, 24576
  s_add_u32 s100, s100, 64000
  s_mul_i32 s44, s42, 1572864
  s_mov_b32 s34, 51904512
  s_mov_b32 s35, 0x20000
  s_mov_b32 s80, 25165824
  s_mov_b32 s3, 50331648
  s_waitcnt lgkmcnt(0)
  s_add_u32 s32, s6, s44
  s_addc_u32 s33, s7, 0
  v_mov_b32 v21, s22
  v_mov_b32 v28, s24
  v_cndmask_b32 v28, v28, v21, vcc
  v_mov_b32 v21, s23
  v_mov_b32 v29, s25
  v_cndmask_b32 v29, v29, v21, vcc
  s_add_u32 m0, s100, 0
  v_lshrrev_b32 v10, 1, v212
  v_add_u32 v10, v10, v240
  v_mad_u64_u32 v[30:31], s[64:65], v10, 1, v[28:29]
  global_load_lds_dwordx4 v[30:31], off
  buffer_load_dwordx4 v[68:71], v212, s[32:35], 0 offen nt
  buffer_load_dwordx4 v[72:75], v213, s[32:35], 0 offen nt
  s_add_u32 m0, s100, 1024
  v_lshrrev_b32 v10, 1, v213
  v_add_u32 v10, v10, v241
  v_mad_u64_u32 v[30:31], s[64:65], v10, 1, v[28:29]
  global_load_lds_dwordx4 v[30:31], off
  buffer_load_dwordx4 v[76:79], v214, s[32:35], 0 offen nt
  buffer_load_dwordx4 v[80:83], v212, s[32:35], s80 offen nt
  s_add_u32 m0, s100, 2048
  v_lshrrev_b32 v10, 1, v214
  v_add_u32 v10, v10, v242
  v_mad_u64_u32 v[30:31], s[64:65], v10, 1, v[28:29]
  global_load_lds_dwordx4 v[30:31], off
  buffer_load_dwordx4 v[84:87], v213, s[32:35], s80 offen nt
  s_barrier
  s_load_dwordx4 s[28:31], s[0:1], 96
  s_getpc_b64 s[82:83]
L_pc1:
  s_lshl_b32 s44, s2, 6
  s_add_u32 s44, s44, L_order-L_pc1
  s_add_u32 s82, s82, s44
  s_addc_u32 s83, s83, 0
  s_load_dwordx2 s[92:93], s[82:83], 0
  s_load_dwordx2 s[96:97], s[82:83], 8
  s_mov_b32 s94, 4000000
  s_mul_i32 s44, s41, 768
  s_add_u32 s44, s44, 32256
  v_add_u32 v20, s44, v212
  v_add_u32 v21, 65280, v212
  s_mul_i32 s45, s41, 3
  v_add_u32 v22, s45, v25
  v_cmp_ge_u32 s[48:49], v22, 17
  v_cmp_ge_u32 s[50:51], v22, 1
  v_cmp_ge_u32 s[52:53], v22, 18
  v_cmp_ge_u32 s[54:55], v22, 2
  v_add_u32 v235, 94208, v21
  v_add_u32 v234, 90112, v21
  v_add_u32 v233, 86016, v21
  v_add_u32 v232, 81920, v21
  v_add_u32 v231, 77824, v21
  v_add_u32 v230, 73728, v21
  v_add_u32 v229, 69632, v21
  v_cndmask_b32_e64 v228, v20, v21, s[54:55]
  v_add_u32 v228, 65536, v228
  v_cndmask_b32_e64 v227, v20, v21, s[52:53]
  v_add_u32 v227, 61440, v227
  v_add_u32 v226, 57344, v20
  v_add_u32 v225, 53248, v20
  v_add_u32 v224, 49152, v20
  v_add_u32 v223, 45056, v20
  v_add_u32 v222, 40960, v20
  v_add_u32 v221, 36864, v20
  v_cndmask_b32_e64 v220, v212, v20, s[50:51]
  v_add_u32 v220, 32768, v220
  v_cndmask_b32_e64 v219, v212, v20, s[48:49]
  v_add_u32 v219, 28672, v219
  v_lshrrev_b32 v22, 6, v0
  v_bfe_u32 v23, v0, 4, 2
  v_mov_b32 v14, 0
  v_and_b32 v20, 3, v0
  v_lshl_add_u32 v1, v20, 5, v25
  v_and_b32 v20, 4, v0
  v_lshl_add_u32 v1, v20, 2, v1
  v_and_b32 v20, 8, v0
  v_mad_u32_u24 v1, v20, 48, v1
  v_lshlrev_b32 v1, 2, v1
  v_add_u32 v1, 45568, v1
  v_lshl_add_u32 v21, v24, 2, v23
  v_mul_u32_u24 v20, 192, v22
  v_add_lshl_u32 v3, v20, v21, 2
  v_add_u32 v3, 64000, v3
  v_lshlrev_b32 v6, 2, v22
  v_mov_b32 v32, 0
  v_mov_b32 v34, 0
  v_mov_b32 v33, 0
  v_mov_b32 v35, 0
  s_mov_b32 s48, 0x11111111
  s_mov_b32 s49, s48
  s_mov_b32 s50, 0x22222222
  s_mov_b32 s51, s50
  s_mov_b32 s52, 0x44444444
  s_mov_b32 s53, s52
  s_mov_b32 s54, 0x88888888
  s_mov_b32 s55, s54
  s_mov_b32 s56, 0x05040100
  s_mov_b32 s57, 0x07060302
  s_mov_b32 s38, 1572864
  s_mov_b32 s39, 0x20000
  v_lshlrev_b32 v21, 8, v23
  v_add_u32 v21, s100, v21
  v_lshl_add_u32 v12, v24, 3, v21
  s_getreg_b32 s81, hwreg(HW_REG_HW_ID, 13, 2)
  s_getreg_b32 s79, hwreg(HW_REG_HW_ID, 8, 4)
  s_getreg_b32 s46, hwreg(HW_REG_XCC_ID, 0, 3)
  s_mul_i32 s46, s46, 4352
  s_add_u32 s46, s46, 8126464
  s_add_u32 s44, s46, 2048
  v_mov_b32 v11, s44
  s_and_b32 s45, s81, 2
  s_lshl_b32 s45, s45, 9
  s_lshl_b32 s44, s40, 8
  s_add_u32 s44, s44, s45
  s_add_u32 s44, s44, s46
  s_add_u32 s44, s44, s79
  s_and_b32 s81, s81, 1
  s_lshl_b32 s81, s81, 4
  s_add_u32 s44, s44, s81
  v_mov_b32 v7, s44
  s_xor_b32 s45, s45, 1024
  s_add_u32 s46, s46, s45
  v_and_b32 v8, 1, v0
  v_lshl_add_u32 v8, v8, 4, s46
  v_bfe_u32 v21, v0, 1, 2
  v_mad_u32_u24 v21, v21, 4, v22
  v_add_u32 v9, 0, v21
  v_and_b32 v9, 3, v9
  v_lshl_add_u32 v236, v9, 8, v8
  v_add_u32 v9, 1, v21
  v_and_b32 v9, 3, v9
  v_lshl_add_u32 v237, v9, 8, v8
  v_add_u32 v9, 2, v21
  v_and_b32 v9, 3, v9
  v_lshl_add_u32 v238, v9, 8, v8
  v_add_u32 v9, 3, v21
  v_and_b32 v9, 3, v9
  v_lshl_add_u32 v239, v9, 8, v8
  s_mov_b32 s78, 0xfefefeff
  v_mov_b32 v36, 0
  v_mov_b32 v37, 0
  v_mov_b32 v38, 0
  v_mov_b32 v39, 0
  v_mov_b32 v40, 0
  v_mov_b32 v41, 0
  v_mov_b32 v42, 0
  v_mov_b32 v43, 0
  v_mov_b32 v26, 0
  v_mov_b32 v27, 0
  s_mov_b32 s90, 3
  s_getreg_b32 s58, hwreg(HW_REG_XCC_ID, 0, 1)
  s_mul_i32 s58, s58, -6
  s_add_u32 s58, s58, 3
  s_mov_b32 s91, s58
  s_mov_b32 s69, 0
  s_mov_b32 s95, 0
  buffer_load_dwordx4 v[88:91], v214, s[32:35], s80 offen nt
  s_add_u32 m0, s100, 3072
  v_lshrrev_b32 v10, 1, v215
  v_add_u32 v10, v10, v240
  v_mad_u64_u32 v[30:31], s[64:65], v10, 1, v[28:29]
  s_waitcnt vmcnt(8)
  global_load_lds_dwordx4 v[30:31], off
  s_waitcnt vmcnt(8)
  buffer_load_dwordx4 v[92:95], v215, s[32:35], 0 offen nt
  s_add_u32 m0, s100, 4096
  v_lshrrev_b32 v10, 1, v216
  v_add_u32 v10, v10, v241
  v_mad_u64_u32 v[30:31], s[64:65], v10, 1, v[28:29]
  s_waitcnt vmcnt(8)
  global_load_lds_dwordx4 v[30:31], off
  s_waitcnt vmcnt(8)
  buffer_load_dwordx4 v[96:99], v216, s[32:35], 0 offen nt
  s_mov_b32 s47, 1
  ds_read_b32 v4, v14 offset:16
L_q0:
  s_waitcnt lgkmcnt(0)
  v_readfirstlane_b32 s46, v4
  s_cmp_ge_u32 s46, s47
  s_cbranch_scc1 L_q0_ok
  s_cmp_eq_u32 s94, 0
  s_cbranch_scc1 L_q0_ok
  s_sub_u32 s94, s94, 1
  ds_read_b32 v4, v14 offset:16
  s_branch L_q0
L_q0_ok:
  ds_read_b128 v[44:47], v15 offset:512
  ds_read_b128 v[48:51], v16 offset:512
  ds_read_b128 v[52:55], v17 offset:512
  s_add_u32 m0, s100, 5120
  v_lshrrev_b32 v10, 1, v217
  v_add_u32 v10, v10, v242
  v_mad_u64_u32 v[30:31], s[64:65], v10, 1, v[28:29]
  s_waitcnt vmcnt(8)
  global_load_lds_dwordx4 v[30:31], off
  s_waitcnt vmcnt(7)
  ds_read_b64 v[116:117], v12 offset:0
  ds_read_b64 v[118:119], v12 offset:128
  ds_read_b64 v[120:121], v12 offset:1024
  ds_read_b64 v[122:123], v12 offset:1152
  ds_read_b64 v[124:125], v12 offset:2048
  ds_read_b64 v[126:127], v12 offset:2176
  buffer_load_dwordx4 v[100:103], v217, s[32:35], 0 offen nt
L_it0:
  s_mov_b32 s47, 2
  ds_read_b32 v4, v14 offset:16
L_q10:
  s_waitcnt lgkmcnt(0)
  v_readfirstlane_b32 s46, v4
  s_cmp_ge_u32 s46, s47
  s_cbranch_scc1 L_q10_ok
  s_cmp_eq_u32 s94, 0
  s_cbranch_scc1 L_q10_ok
  s_sub_u32 s94, s94, 1
  ds_read_b32 v4, v14 offset:16
  s_branch L_q10
L_q10_ok:
  ds_read_b128 v[56:59], v15 offset:1536
  ds_read_b128 v[60:63], v16 offset:1536
  ds_read_b128 v[64:67], v17 offset:1536
  v_perm_b32 v13, v118, v116, s56
  v_perm_b32 v118, v118, v116, s57
  v_perm_b32 v116, v119, v117, s56
  v_perm_b32 v119, v119, v117, s57
  v_dot2_f32_bf16 v22, v13, v44, 0
  v_dot2_f32_bf16 v23, v118, v45, 0
  v_dot2_f32_bf16 v24, v116, v46, 0
  v_dot2_f32_bf16 v25, v119, v47, 0
  v_cvt_f32_i32 v68, v68
  v_cvt_f32_i32 v69, v69
  v_cvt_f32_i32 v70, v70
  v_cvt_f32_i32 v71, v71
  v_pk_mul_f32 v[20:21], v[68:69], v[22:23]
  v_pk_add_f32 v[18:19], v[22:23], v[24:25]
  v_pk_fma_f32 v[20:21], v[70:71], v[24:25], v[20:21]
  v_add_f32 v18, v18, v19
  v_add_f32 v20, v20, v21
  s_add_u32 m0, s100, 6144
  v_lshrrev_b32 v10, 1, v218
  v_add_u32 v10, v10, v240
  v_mad_u64_u32 v[30:31], s[64:65], v10, 1, v[28:29]
  global_load_lds_dwordx4 v[30:31], off
  s_waitcnt vmcnt(8)
  buffer_load_dwordx4 v[104:107], v215, s[32:35], s80 offen nt
  v_add_f32_dpp v34, v18, v18 row_ror:8 row_mask:0xf bank_mask:0xc
  v_add_f32_dpp v34, v20, v20 row_ror:8 row_mask:0xf bank_mask:0x3
  v_perm_b32 v117, v122, v120, s56
  v_perm_b32 v122, v122, v120, s57
  v_perm_b32 v120, v123, v121, s56
  v_perm_b32 v123, v123, v121, s57
  v_dot2_f32_bf16 v22, v117, v48, 0
  v_dot2_f32_bf16 v23, v122, v49, 0
  v_dot2_f32_bf16 v24, v120, v50, 0
  v_dot2_f32_bf16 v25, v123, v51, 0
  v_cvt_f32_i32 v72, v72
  v_cvt_f32_i32 v73, v73
  v_cvt_f32_i32 v74, v74
  v_cvt_f32_i32 v75, v75
  v_pk_mul_f32 v[20:21], v[72:73], v[22:23]
  v_pk_add_f32 v[18:19], v[22:23], v[24:25]
  v_pk_fma_f32 v[20:21], v[74:75], v[24:25], v[20:21]
  v_add_f32 v18, v18, v19
  v_add_f32 v20, v20, v21
  s_waitcnt vmcnt(8)
  buffer_load_dwordx4 v[108:111], v216, s[32:35], s80 offen nt
  v_add_f32_dpp v21, v18, v18 row_ror:8 row_mask:0xf bank_mask:0xc
  v_add_f32_dpp v21, v20, v20 row_ror:8 row_mask:0xf bank_mask:0x3
  v_add_f32_dpp v20, v34, v34 row_half_mirror row_mask:0xf bank_mask:0x5
  s_nop 0
  v_add_f32_dpp v20, v21, v21 row_half_mirror row_mask:0xf bank_mask:0xa
  s_nop 1
  v_add_f32_dpp v20, v20, v20 quad_perm:[2,3,0,1] row_mask:0xf bank_mask:0xf
  s_nop 1
  v_add_f32_dpp v20, v20, v20 quad_perm:[1,0,3,2] row_mask:0xf bank_mask:0xf
  v_cndmask_b32_e64 v32, v32, v20, s[48:49]
  v_perm_b32 v121, v126, v124, s56
  v_perm_b32 v126, v126, v124, s57
  v_perm_b32 v124, v127, v125, s56
  v_perm_b32 v127, v127, v125, s57
  v_dot2_f32_bf16 v22, v121, v52, 0
  v_dot2_f32_bf16 v23, v126, v53, 0
  v_dot2_f32_bf16 v24, v124, v54, 0
  v_dot2_f32_bf16 v25, v127, v55, 0
  v_cvt_f32_i32 v76, v76
  v_cvt_f32_i32 v77, v77
  v_cvt_f32_i32 v78, v78
  v_cvt_f32_i32 v79, v79
  v_pk_mul_f32 v[20:21], v[76:77], v[22:23]
  v_pk_add_f32 v[18:19], v[22:23], v[24:25]
  v_pk_fma_f32 v[20:21], v[78:79], v[24:25], v[20:21]
  v_add_f32 v18, v18, v19
  v_add_f32 v20, v20, v21
  s_add_u32 m0, s100, 7168
  v_lshrrev_b32 v10, 1, v219
  v_add_u32 v10, v10, v241
  v_mad_u64_u32 v[30:31], s[64:65], v10, 1, v[28:29]
  s_waitcnt vmcnt(8)
  global_load_lds_dwordx4 v[30:31], off
  s_waitcnt vmcnt(8)
  buffer_load_dwordx4 v[112:115], v217, s[32:35], s80 offen nt
  v_add_f32_dpp v34, v18, v18 row_ror:8 row_mask:0xf bank_mask:0xc
  v_add_f32_dpp v34, v20, v20 row_ror:8 row_mask:0xf bank_mask:0x3
L_it1:
  s_waitcnt lgkmcnt(0)
  v_dot2_f32_bf16 v22, v13, v56, 0
  v_dot2_f32_bf16 v23, v118, v57, 0
  v_dot2_f32_bf16 v24, v116, v58, 0
  v_dot2_f32_bf16 v25, v119, v59, 0
  v_cvt_f32_i32 v80, v80
  v_cvt_f32_i32 v81, v81
  v_cvt_f32_i32 v82, v82
  v_cvt_f32_i32 v83, v83
  v_pk_mul_f32 v[20:21], v[80:81], v[22:23]
  v_pk_add_f32 v[18:19], v[22:23], v[24:25]
  v_pk_fma_f32 v[20:21], v[82:83], v[24:25], v[20:21]
  v_add_f32 v18, v18, v19
  v_add_f32 v20, v20, v21
  s_waitcnt vmcnt(8)
  buffer_load_dwordx4 v[68:71], v218, s[32:35], 0 offen nt
  v_add_f32_dpp v35, v18, v18 row_ror:8 row_mask:0xf bank_mask:0xc
  v_add_f32_dpp v35, v20, v20 row_ror:8 row_mask:0xf bank_mask:0x3
  v_dot2_f32_bf16 v22, v117, v60, 0
  v_dot2_f32_bf16 v23, v122, v61, 0
  v_dot2_f32_bf16 v24, v120, v62, 0
  v_dot2_f32_bf16 v25, v123, v63, 0
  v_cvt_f32_i32 v84, v84
  v_cvt_f32_i32 v85, v85
  v_cvt_f32_i32 v86, v86
  v_cvt_f32_i32 v87, v87
  v_pk_mul_f32 v[20:21], v[84:85], v[22:23]
  v_pk_add_f32 v[18:19], v[22:23], v[24:25]
  v_pk_fma_f32 v[20:21], v[86:87], v[24:25], v[20:21]
  v_add_f32 v18, v18, v19
  v_add_f32 v20, v20, v21
  s_add_u32 m0, s100, 8192
  v_lshrrev_b32 v10, 1, v220
  v_add_u32 v10, v10, v242
  v_mad_u64_u32 v[30:31], s[64:65], v10, 1, v[28:29]
  s_waitcnt vmcnt(8)
  global_load_lds_dwordx4 v[30:31], off
  s_waitcnt vmcnt(8)
  buffer_load_dwordx4 v[72:75], v219, s[32:35], 0 offen nt
  v_add_f32_dpp v21, v18, v18 row_ror:8 row_mask:0xf bank_mask:0xc
  v_add_f32_dpp v21, v20, v20 row_ror:8 row_mask:0xf bank_mask:0x3
  v_add_f32_dpp v20, v35, v35 row_half_mirror row_mask:0xf bank_mask:0x5
  s_nop 0
  v_add_f32_dpp v20, v21, v21 row_half_mirror row_mask:0xf bank_mask:0xa
  s_nop 1
  v_add_f32_dpp v20, v20, v20 quad_perm:[2,3,0,1] row_mask:0xf bank_mask:0xf
  s_nop 1
  v_add_f32_dpp v20, v20, v20 quad_perm:[1,0,3,2] row_mask:0xf bank_mask:0xf
  v_cndmask_b32_e64 v33, v33, v20, s[48:49]
  ds_read_b64 v[128:129], v12 offset:3072
  ds_read_b64 v[130:131], v12 offset:3200
  ds_read_b64 v[132:133], v12 offset:4096
  ds_read_b64 v[134:135], v12 offset:4224
  ds_read_b64 v[136:137], v12 offset:5120
  ds_read_b64 v[138:139], v12 offset:5248
  v_dot2_f32_bf16 v22, v121, v64, 0
  v_dot2_f32_bf16 v23, v126, v65, 0
  v_dot2_f32_bf16 v24, v124, v66, 0
  v_dot2_f32_bf16 v25, v127, v67, 0
  v_cvt_f32_i32 v88, v88
  v_cvt_f32_i32 v89, v89
  v_cvt_f32_i32 v90, v90
  v_cvt_f32_i32 v91, v91
  v_pk_mul_f32 v[20:21], v[88:89], v[22:23]
  v_pk_add_f32 v[18:19], v[22:23], v[24:25]
  v_pk_fma_f32 v[20:21], v[90:91], v[24:25], v[20:21]
  v_add_f32 v18, v18, v19
  v_add_f32 v20, v20, v21
  s_waitcnt vmcnt(8)
  buffer_load_dwordx4 v[76:79], v220, s[32:35], 0 offen nt
  v_add_f32_dpp v35, v18, v18 row_ror:8 row_mask:0xf bank_mask:0xc
  v_add_f32_dpp v35, v20, v20 row_ror:8 row_mask:0xf bank_mask:0x3
L_it2:
  s_waitcnt lgkmcnt(0)
  v_perm_b32 v125, v130, v128, s56
  v_perm_b32 v130, v130, v128, s57
  v_perm_b32 v128, v131, v129, s56
  v_perm_b32 v131, v131, v129, s57
  v_dot2_f32_bf16 v22, v125, v44, 0
  v_dot2_f32_bf16 v23, v130, v45, 0
  v_dot2_f32_bf16 v24, v128, v46, 0
  v_dot2_f32_bf16 v25, v131, v47, 0
  v_cvt_f32_i32 v92, v92
  v_cvt_f32_i32 v93, v93
  v_cvt_f32_i32 v94, v94
  v_cvt_f32_i32 v95, v95
  v_pk_mul_f32 v[20:21], v[92:93], v[22:23]
  v_pk_add_f32 v[18:19], v[22:23], v[24:25]
  v_pk_fma_f32 v[20:21], v[94:95], v[24:25], v[20:21]
  v_add_f32 v18, v18, v19
  v_add_f32 v20, v20, v21
  s_add_u32 m0, s100, 9216
  v_lshrrev_b32 v10, 1, v221
  v_add_u32 v10, v10, v240
  v_mad_u64_u32 v[30:31], s[64:65], v10, 1, v[28:29]
  s_waitcnt vmcnt(8)
  global_load_lds_dwordx4 v[30:31], off
  s_waitcnt vmcnt(8)
  buffer_load_dwordx4 v[80:83], v218, s[32:35], s80 offen nt
  v_add_f32_dpp v21, v18, v18 row_ror:8 row_mask:0xf bank_mask:0xc
  v_add_f32_dpp v21, v20, v20 row_ror:8 row_mask:0xf bank_mask:0x3
  v_add_f32_dpp v20, v34, v34 row_half_mirror row_mask:0xf bank_mask:0x5
  s_nop 0
  v_add_f32_dpp v20, v21, v21 row_half_mirror row_mask:0xf bank_mask:0xa
  s_nop 1
  v_add_f32_dpp v20, v20, v20 quad_perm:[2,3,0,1] row_mask:0xf bank_mask:0xf
  s_nop 1
  v_add_f32_dpp v20, v20, v20 quad_perm:[1,0,3,2] row_mask:0xf bank_mask:0xf
  v_cndmask_b32_e64 v32, v32, v20, s[50:51]
  v_perm_b32 v129, v134, v132, s56
  v_perm_b32 v134, v134, v132, s57
  v_perm_b32 v132, v135, v133, s56
  v_perm_b32 v135, v135, v133, s57
  v_dot2_f32_bf16 v22, v129, v48, 0
  v_dot2_f32_bf16 v23, v134, v49, 0
  v_dot2_f32_bf16 v24, v132, v50, 0
  v_dot2_f32_bf16 v25, v135, v51, 0
  v_cvt_f32_i32 v96, v96
  v_cvt_f32_i32 v97, v97
  v_cvt_f32_i32 v98, v98
  v_cvt_f32_i32 v99, v99
  v_pk_mul_f32 v[20:21], v[96:97], v[22:23]
  v_pk_add_f32 v[18:19], v[22:23], v[24:25]
  v_pk_fma_f32 v[20:21], v[98:99], v[24:25], v[20:21]
  v_add_f32 v18, v18, v19
  v_add_f32 v20, v20, v21
  s_waitcnt vmcnt(8)
  buffer_load_dwordx4 v[84:87], v219, s[32:35], s80 offen nt
  v_add_f32_dpp v34, v18, v18 row_ror:8 row_mask:0xf bank_mask:0xc
  v_add_f32_dpp v34, v20, v20 row_ror:8 row_mask:0xf bank_mask:0x3
  v_perm_b32 v133, v138, v136, s56
  v_perm_b32 v138, v138, v136, s57
  v_perm_b32 v136, v139, v137, s56
  v_perm_b32 v139, v139, v137, s57
  v_dot2_f32_bf16 v22, v133, v52, 0
  v_dot2_f32_bf16 v23, v138, v53, 0
  v_dot2_f32_bf16 v24, v136, v54, 0
  v_dot2_f32_bf16 v25, v139, v55, 0
  v_cvt_f32_i32 v100, v100
  v_cvt_f32_i32 v101, v101
  v_cvt_f32_i32 v102, v102
  v_cvt_f32_i32 v103, v103
  v_pk_mul_f32 v[20:21], v[100:101], v[22:23]
  v_pk_add_f32 v[18:19], v[22:23], v[24:25]
  v_pk_fma_f32 v[20:21], v[102:103], v[24:25], v[20:21]
  v_add_f32 v18, v18, v19
  v_add_f32 v20, v20, v21
  s_add_u32 m0, s100, 10240
  v_lshrrev_b32 v10, 1, v222
  v_add_u32 v10, v10, v241
  v_mad_u64_u32 v[30:31], s[64:65], v10, 1, v[28:29]
  s_waitcnt vmcnt(8)
  global_load_lds_dwordx4 v[30:31], off
  s_waitcnt vmcnt(8)
  buffer_load_dwordx4 v[88:91], v220, s[32:35], s80 offen nt
  v_add_f32_dpp v21, v18, v18 row_ror:8 row_mask:0xf bank_mask:0xc
  v_add_f32_dpp v21, v20, v20 row_ror:8 row_mask:0xf bank_mask:0x3
  v_add_f32_dpp v20, v34, v34 row_half_mirror row_mask:0xf bank_mask:0x5
  s_nop 0
  v_add_f32_dpp v20, v21, v21 row_half_mirror row_mask:0xf bank_mask:0xa
  s_nop 1
  v_add_f32_dpp v20, v20, v20 quad_perm:[2,3,0,1] row_mask:0xf bank_mask:0xf
  s_nop 1
  v_add_f32_dpp v20, v20, v20 quad_perm:[1,0,3,2] row_mask:0xf bank_mask:0xf
  v_cndmask_b32_e64 v32, v32, v20, s[52:53]
L_it3:
  s_waitcnt lgkmcnt(0)
  s_add_u32 s44, s78, 0x03030303
  v_msad_u8 v9, s78, v40, 0
  v_msad_u8 v10, s44, v40, 0
  v_msad_u8 v9, s78, v41, v9
  v_msad_u8 v10, s44, v41, v10
  v_msad_u8 v9, s78, v42, v9
  v_msad_u8 v10, s44, v42, v10
  v_sub_u32 v9, v9, v10
  v_mov_b32 v8, s90
  s_add_u32 s78, s78, 0x01010101
  v_readlane_b32 s66, v9, 0
  v_readlane_b32 s67, v9, 1
  s_mov_b64 exec, 1
  global_store_byte v7, v8, s[30:31]
  s_mov_b64 exec, 3
  global_load_dwordx3 v[40:42], v239, s[30:31] sc1
  s_mov_b64 exec, -1
  s_add_u32 s69, s66, s67
  s_add_u32 s44, s69, s95
  s_mov_b32 s95, s69
  s_ashr_i32 s69, s44, 1
  s_add_u32 s69, s69, s91
  s_cmp_lt_u32 s90, 5
  s_cselect_b32 s69, 0, s69
  s_add_u32 s90, s90, 1
  v_dot2_f32_bf16 v22, v125, v56, 0
  v_dot2_f32_bf16 v23, v130, v57, 0
  v_dot2_f32_bf16 v24, v128, v58, 0
  v_dot2_f32_bf16 v25, v131, v59, 0
  v_cvt_f32_i32 v104, v104
  v_cvt_f32_i32 v105, v105
  v_cvt_f32_i32 v106, v106
  v_cvt_f32_i32 v107, v107
  v_pk_mul_f32 v[20:21], v[104:105], v[22:23]
  v_pk_add_f32 v[18:19], v[22:23], v[24:25]
  v_pk_fma_f32 v[20:21], v[106:107], v[24:25], v[20:21]
  v_add_f32 v18, v18, v19
  v_add_f32 v20, v20, v21
  s_cmp_gt_i32 s69, -13
  s_cbranch_scc1 L_p2
  s_waitcnt vmcnt(6)
L_p2:
  s_waitcnt vmcnt(8)
  buffer_load_dwordx4 v[92:95], v221, s[32:35], 0 offen nt
  v_add_f32_dpp v21, v18, v18 row_ror:8 row_mask:0xf bank_mask:0xc
  v_add_f32_dpp v21, v20, v20 row_ror:8 row_mask:0xf bank_mask:0x3
  v_add_f32_dpp v20, v35, v35 row_half_mirror row_mask:0xf bank_mask:0x5
  s_nop 0
  v_add_f32_dpp v20, v21, v21 row_half_mirror row_mask:0xf bank_mask:0xa
  s_nop 1
  v_add_f32_dpp v20, v20, v20 quad_perm:[2,3,0,1] row_mask:0xf bank_mask:0xf
  s_nop 1
  v_add_f32_dpp v20, v20, v20 quad_perm:[1,0,3,2] row_mask:0xf bank_mask:0xf
  v_cndmask_b32_e64 v33, v33, v20, s[50:51]
  v_dot2_f32_bf16 v22, v129, v60, 0
  v_dot2_f32_bf16 v23, v134, v61, 0
  v_dot2_f32_bf16 v24, v132, v62, 0
  v_dot2_f32_bf16 v25, v135, v63, 0
  v_cvt_f32_i32 v108, v108
  v_cvt_f32_i32 v109, v109
  v_cvt_f32_i32 v110, v110
  v_cvt_f32_i32 v111, v111
  v_pk_mul_f32 v[20:21], v[108:109], v[22:23]
  v_pk_add_f32 v[18:19], v[22:23], v[24:25]
  v_pk_fma_f32 v[20:21], v[110:111], v[24:25], v[20:21]
  v_add_f32 v18, v18, v19
  v_add_f32 v20, v20, v21
  s_add_u32 m0, s100, 11264
  v_lshrrev_b32 v10, 1, v223
  v_add_u32 v10, v10, v242
  v_mad_u64_u32 v[30:31], s[64:65], v10, 1, v[28:29]
  global_load_lds_dwordx4 v[30:31], off
  s_cmp_gt_i32 s69, 2
  s_cbranch_scc1 L_p3
  s_waitcnt vmcnt(8)
L_p3:
  s_waitcnt vmcnt(10)
  buffer_load_dwordx4 v[96:99], v222, s[32:35], 0 offen nt
  v_add_f32_dpp v35, v18, v18 row_ror:8 row_mask:0xf bank_mask:0xc
  v_add_f32_dpp v35, v20, v20 row_ror:8 row_mask:0xf bank_mask:0x3
  ds_read_b64 v[140:141], v12 offset:6144
  ds_read_b64 v[142:143], v12 offset:6272
  ds_read_b64 v[144:145], v12 offset:7168
  ds_read_b64 v[146:147], v12 offset:7296
  ds_read_b64 v[148:149], v12 offset:8192
  ds_read_b64 v[150:151], v12 offset:8320
  v_dot2_f32_bf16 v22, v133, v64, 0
  v_dot2_f32_bf16 v23, v138, v65, 0
  v_dot2_f32_bf16 v24, v136, v66, 0
  v_dot2_f32_bf16 v25, v139, v67, 0
  v_cvt_f32_i32 v112, v112
  v_cvt_f32_i32 v113, v113
  v_cvt_f32_i32 v114, v114
  v_cvt_f32_i32 v115, v115
  v_pk_mul_f32 v[20:21], v[112:113], v[22:23]
  v_pk_add_f32 v[18:19], v[22:23], v[24:25]
  v_pk_fma_f32 v[20:21], v[114:115], v[24:25], v[20:21]
  v_add_f32 v18, v18, v19
  v_add_f32 v20, v20, v21
  s_cmp_lt_i32 s69, -25
  s_cbranch_scc0 L_t4
  s_waitcnt vmcnt(8)
L_t4:
  s_cmp_gt_i32 s69, 9
  s_cbranch_scc1 L_p5
  s_waitcnt vmcnt(9)
L_p5:
  s_waitcnt vmcnt(11)
  buffer_load_dwordx4 v[100:103], v223, s[32:35], 0 offen nt
  v_add_f32_dpp v21, v18, v18 row_ror:8 row_mask:0xf bank_mask:0xc
  v_add_f32_dpp v21, v20, v20 row_ror:8 row_mask:0xf bank_mask:0x3
  v_add_f32_dpp v20, v35, v35 row_half_mirror row_mask:0xf bank_mask:0x5
  s_nop 0
  v_add_f32_dpp v20, v21, v21 row_half_mirror row_mask:0xf bank_mask:0xa
  s_nop 1
  v_add_f32_dpp v20, v20, v20 quad_perm:[2,3,0,1] row_mask:0xf bank_mask:0xf
  s_nop 1
  v_add_f32_dpp v20, v20, v20 quad_perm:[1,0,3,2] row_mask:0xf bank_mask:0xf
  v_cndmask_b32_e64 v33, v33, v20, s[52:53]
L_it4:
  s_waitcnt lgkmcnt(0)
  s_add_u32 s44, s78, 0x03030303
  v_msad_u8 v9, s78, v36, 0
  v_msad_u8 v10, s44, v36, 0
  v_msad_u8 v9, s78, v37, v9
  v_msad_u8 v10, s44, v37, v10
  v_msad_u8 v9, s78, v38, v9
  v_msad_u8 v10, s44, v38, v10
  v_sub_u32 v9, v9, v10
  v_mov_b32 v8, s90
  s_add_u32 s78, s78, 0x01010101
  v_readlane_b32 s66, v9, 0
  v_readlane_b32 s67, v9, 1
  s_mov_b64 exec, 1
  global_store_byte v7, v8, s[30:31]
  s_mov_b64 exec, 3
  global_load_dwordx3 v[36:38], v236, s[30:31] sc1
  s_mov_b64 exec, -1
  s_add_u32 s69, s66, s67
  s_add_u32 s44, s69, s95
  s_mov_b32 s95, s69
  s_ashr_i32 s69, s44, 1
  s_add_u32 s69, s69, s91
  s_cmp_lt_u32 s90, 5
  s_cselect_b32 s69, 0, s69
  s_add_u32 s90, s90, 1
  v_perm_b32 v137, v142, v140, s56
  v_perm_b32 v142, v142, v140, s57
  v_perm_b32 v140, v143, v141, s56
  v_perm_b32 v143, v143, v141, s57
  v_dot2_f32_bf16 v22, v137, v44, 0
  v_dot2_f32_bf16 v23, v142, v45, 0
  v_dot2_f32_bf16 v24, v140, v46, 0
  v_dot2_f32_bf16 v25, v143, v47, 0
  v_cvt_f32_i32 v68, v68
  v_cvt_f32_i32 v69, v69
  v_cvt_f32_i32 v70, v70
  v_cvt_f32_i32 v71, v71
  v_pk_mul_f32 v[20:21], v[68:69], v[22:23]
  v_pk_add_f32 v[18:19], v[22:23], v[24:25]
  v_pk_fma_f32 v[20:21], v[70:71], v[24:25], v[20:21]
  v_add_f32 v18, v18, v19
  v_add_f32 v20, v20, v21
  s_add_u32 m0, s100, 12288
  v_lshrrev_b32 v10, 1, v224
  v_add_u32 v10, v10, v240
  v_mad_u64_u32 v[30:31], s[64:65], v10, 1, v[28:29]
  global_load_lds_dwordx4 v[30:31], off
  s_cmp_gt_i32 s69, -13
  s_cbranch_scc1 L_p6
  s_waitcnt vmcnt(7)
L_p6:
  s_waitcnt vmcnt(10)
  buffer_load_dwordx4 v[104:107], v221, s[32:35], s80 offen nt
  v_add_f32_dpp v34, v18, v18 row_ror:8 row_mask:0xf bank_mask:0xc
  v_add_f32_dpp v34, v20, v20 row_ror:8 row_mask:0xf bank_mask:0x3
  v_perm_b32 v141, v146, v144, s56
  v_perm_b32 v146, v146, v144, s57
  v_perm_b32 v144, v147, v145, s56
  v_perm_b32 v147, v147, v145, s57
  v_dot2_f32_bf16 v22, v141, v48, 0
  v_dot2_f32_bf16 v23, v146, v49, 0
  v_dot2_f32_bf16 v24, v144, v50, 0
  v_dot2_f32_bf16 v25, v147, v51, 0
  v_cvt_f32_i32 v72, v72
  v_cvt_f32_i32 v73, v73
  v_cvt_f32_i32 v74, v74
  v_cvt_f32_i32 v75, v75
  v_pk_mul_f32 v[20:21], v[72:73], v[22:23]
  v_pk_add_f32 v[18:19], v[22:23], v[24:25]
  v_pk_fma_f32 v[20:21], v[74:75], v[24:25], v[20:21]
  v_add_f32 v18, v18, v19
  v_add_f32 v20, v20, v21
  s_cmp_gt_i32 s69, 2
  s_cbranch_scc1 L_p7
  s_waitcnt vmcnt(8)
L_p7:
  s_waitcnt vmcnt(11)
  buffer_load_dwordx4 v[108:111], v222, s[32:35], s80 offen nt
  v_add_f32_dpp v21, v18, v18 row_ror:8 row_mask:0xf bank_mask:0xc
  v_add_f32_dpp v21, v20, v20 row_ror:8 row_mask:0xf bank_mask:0x3
  v_add_f32_dpp v20, v34, v34 row_half_mirror row_mask:0xf bank_mask:0x5
  s_nop 0
  v_add_f32_dpp v20, v21, v21 row_half_mirror row_mask:0xf bank_mask:0xa
  s_nop 1
  v_add_f32_dpp v20, v20, v20 quad_perm:[2,3,0,1] row_mask:0xf bank_mask:0xf
  s_nop 1
  v_add_f32_dpp v20, v20, v20 quad_perm:[1,0,3,2] row_mask:0xf bank_mask:0xf
  v_cndmask_b32_e64 v32, v32, v20, s[54:55]
  ds_write_b32 v1, v32 offset:0
  v_perm_b32 v145, v150, v148, s56
  v_perm_b32 v150, v150, v148, s57
  v_perm_b32 v148, v151, v149, s56
  v_perm_b32 v151, v151, v149, s57
  v_dot2_f32_bf16 v22, v145, v52, 0
  v_dot2_f32_bf16 v23, v150, v53, 0
  v_dot2_f32_bf16 v24, v148, v54, 0
  v_dot2_f32_bf16 v25, v151, v55, 0
  v_cvt_f32_i32 v76, v76
  v_cvt_f32_i32 v77, v77
  v_cvt_f32_i32 v78, v78
  v_cvt_f32_i32 v79, v79
  v_pk_mul_f32 v[20:21], v[76:77], v[22:23]
  v_pk_add_f32 v[18:19], v[22:23], v[24:25]
  v_pk_fma_f32 v[20:21], v[78:79], v[24:25], v[20:21]
  v_add_f32 v18, v18, v19
  v_add_f32 v20, v20, v21
  s_add_u32 m0, s100, 13312
  v_lshrrev_b32 v10, 1, v225
  v_add_u32 v10, v10, v241
  v_mad_u64_u32 v[30:31], s[64:65], v10, 1, v[28:29]
  global_load_lds_dwordx4 v[30:31], off
  s_cmp_lt_i32 s69, -25
  s_cbranch_scc0 L_t8
  s_waitcnt vmcnt(8)
L_t8:
  s_cmp_gt_i32 s69, 9
  s_cbranch_scc1 L_p9
  s_waitcnt vmcnt(10)
L_p9:
  s_waitcnt vmcnt(13)
  buffer_load_dwordx4 v[112:115], v223, s[32:35], s80 offen nt
  v_add_f32_dpp v34, v18, v18 row_ror:8 row_mask:0xf bank_mask:0xc
  v_add_f32_dpp v34, v20, v20 row_ror:8 row_mask:0xf bank_mask:0x3
L_it5:
  s_waitcnt lgkmcnt(0)
  s_mov_b64 exec, 1
  global_load_dwordx2 v[26:27], v11, s[30:31] sc1
  s_mov_b64 exec, -1
  s_waitcnt vmcnt(11)
  s_add_u32 s44, s78, 0x03030303
  v_msad_u8 v9, s78, v40, 0
  v_msad_u8 v10, s44, v40, 0
  v_msad_u8 v9, s78, v41, v9
  v_msad_u8 v10, s44, v41, v10
  v_msad_u8 v9, s78, v42, v9
  v_msad_u8 v10, s44, v42, v10
  v_sub_u32 v9, v9, v10
  v_mov_b32 v8, s90
  s_add_u32 s78, s78, 0x01010101
  v_readlane_b32 s66, v9, 0
  v_readlane_b32 s67, v9, 1
  s_mov_b64 exec, 1
  global_store_byte v7, v8, s[30:31]
  s_mov_b64 exec, 3
  global_load_dwordx3 v[40:42], v237, s[30:31] sc1
  s_mov_b64 exec, -1
  s_add_u32 s69, s66, s67
  s_add_u32 s44, s69, s95
  s_mov_b32 s95, s69
  s_ashr_i32 s69, s44, 1
  s_add_u32 s69, s69, s91
  s_cmp_lt_u32 s90, 5
  s_cselect_b32 s69, 0, s69
  s_add_u32 s90, s90, 1
  v_dot2_f32_bf16 v22, v137, v56, 0
  v_dot2_f32_bf16 v23, v142, v57, 0
  v_dot2_f32_bf16 v24, v140, v58, 0
  v_dot2_f32_bf16 v25, v143, v59, 0
  v_cvt_f32_i32 v80, v80
  v_cvt_f32_i32 v81, v81
  v_cvt_f32_i32 v82, v82
  v_cvt_f32_i32 v83, v83
  v_pk_mul_f32 v[20:21], v[80:81], v[22:23]
  v_pk_add_f32 v[18:19], v[22:23], v[24:25]
  v_pk_fma_f32 v[20:21], v[82:83], v[24:25], v[20:21]
  v_add_f32 v18, v18, v19
  v_add_f32 v20, v20, v21
  s_cmp_gt_i32 s69, -13
  s_cbranch_scc1 L_p10
  s_waitcnt vmcnt(7)
L_p10:
  s_waitcnt vmcnt(11)
  buffer_load_dwordx4 v[68:71], v224, s[32:35], 0 offen nt
  v_add_f32_dpp v35, v18, v18 row_ror:8 row_mask:0xf bank_mask:0xc
  v_add_f32_dpp v35, v20, v20 row_ror:8 row_mask:0xf bank_mask:0x3
  v_dot2_f32_bf16 v22, v141, v60, 0
  v_dot2_f32_bf16 v23, v146, v61, 0
  v_dot2_f32_bf16 v24, v144, v62, 0
  v_dot2_f32_bf16 v25, v147, v63, 0
  v_cvt_f32_i32 v84, v84
  v_cvt_f32_i32 v85, v85
  v_cvt_f32_i32 v86, v86
  v_cvt_f32_i32 v87, v87
  v_pk_mul_f32 v[20:21], v[84:85], v[22:23]
  v_pk_add_f32 v[18:19], v[22:23], v[24:25]
  v_pk_fma_f32 v[20:21], v[86:87], v[24:25], v[20:21]
  v_add_f32 v18, v18, v19
  v_add_f32 v20, v20, v21
  s_add_u32 m0, s100, 14336
  v_lshrrev_b32 v10, 1, v226
  v_add_u32 v10, v10, v242
  v_mad_u64_u32 v[30:31], s[64:65], v10, 1, v[28:29]
  global_load_lds_dwordx4 v[30:31], off
  s_cmp_gt_i32 s69, 2
  s_cbranch_scc1 L_p11
  s_waitcnt vmcnt(9)
L_p11:
  s_waitcnt vmcnt(13)
  buffer_load_dwordx4 v[72:75], v225, s[32:35], 0 offen nt
  v_add_f32_dpp v21, v18, v18 row_ror:8 row_mask:0xf bank_mask:0xc
  v_add_f32_dpp v21, v20, v20 row_ror:8 row_mask:0xf bank_mask:0x3
  v_add_f32_dpp v20, v35, v35 row_half_mirror row_mask:0xf bank_mask:0x5
  s_nop 0
  v_add_f32_dpp v20, v21, v21 row_half_mirror row_mask:0xf bank_mask:0xa
  s_nop 1
  v_add_f32_dpp v20, v20, v20 quad_perm:[2,3,0,1] row_mask:0xf bank_mask:0xf
  s_nop 1
  v_add_f32_dpp v20, v20, v20 quad_perm:[1,0,3,2] row_mask:0xf bank_mask:0xf
  v_cndmask_b32_e64 v33, v33, v20, s[54:55]
  ds_write_b32 v1, v33 offset:3072
  s_waitcnt vmcnt(13)
  ds_read_b64 v[152:153], v12 offset:9216
  ds_read_b64 v[154:155], v12 offset:9344
  ds_read_b64 v[156:157], v12 offset:10240
  ds_read_b64 v[158:159], v12 offset:10368
  ds_read_b64 v[160:161], v12 offset:11264
  ds_read_b64 v[162:163], v12 offset:11392
  v_dot2_f32_bf16 v22, v145, v64, 0
  v_dot2_f32_bf16 v23, v150, v65, 0
  v_dot2_f32_bf16 v24, v148, v66, 0
  v_dot2_f32_bf16 v25, v151, v67, 0
  v_cvt_f32_i32 v88, v88
  v_cvt_f32_i32 v89, v89
  v_cvt_f32_i32 v90, v90
  v_cvt_f32_i32 v91, v91
  v_pk_mul_f32 v[20:21], v[88:89], v[22:23]
  v_pk_add_f32 v[18:19], v[22:23], v[24:25]
  v_pk_fma_f32 v[20:21], v[90:91], v[24:25], v[20:21]
  v_add_f32 v18, v18, v19
  v_add_f32 v20, v20, v21
  s_cmp_lt_i32 s69, -25
  s_cbranch_scc0 L_t12
  s_waitcnt vmcnt(9)
L_t12:
  s_cmp_gt_i32 s69, 9
  s_cbranch_scc1 L_p13
  s_waitcnt vmcnt(10)
L_p13:
  s_waitcnt vmcnt(14)
  buffer_load_dwordx4 v[76:79], v226, s[32:35], 0 offen nt
  v_add_f32_dpp v35, v18, v18 row_ror:8 row_mask:0xf bank_mask:0xc
  v_add_f32_dpp v35, v20, v20 row_ror:8 row_mask:0xf bank_mask:0x3
L_it6:
  s_waitcnt lgkmcnt(0)
  s_waitcnt vmcnt(11)
  s_add_u32 s44, s78, 0x03030303
  v_msad_u8 v9, s78, v36, 0
  v_msad_u8 v10, s44, v36, 0
  v_msad_u8 v9, s78, v37, v9
  v_msad_u8 v10, s44, v37, v10
  v_msad_u8 v9, s78, v38, v9
  v_msad_u8 v10, s44, v38, v10
  v_sub_u32 v9, v9, v10
  v_mov_b32 v8, s90
  s_add_u32 s78, s78, 0x01010101
  v_readlane_b32 s66, v9, 0
  v_readlane_b32 s67, v9, 1
  s_mov_b64 exec, 1
  global_store_byte v7, v8, s[30:31]
  s_mov_b64 exec, 3
  global_load_dwordx3 v[36:38], v238, s[30:31] sc1
  s_mov_b64 exec, -1
  s_add_u32 s69, s66, s67
  s_add_u32 s44, s69, s95
  s_mov_b32 s95, s69
  s_ashr_i32 s69, s44, 1
  s_add_u32 s69, s69, s91
  s_cmp_lt_u32 s90, 5
  s_cselect_b32 s69, 0, s69
  s_add_u32 s90, s90, 1
  v_perm_b32 v149, v154, v152, s56
  v_perm_b32 v154, v154, v152, s57
  v_perm_b32 v152, v155, v153, s56
  v_perm_b32 v155, v155, v153, s57
  v_dot2_f32_bf16 v22, v149, v44, 0
  v_dot2_f32_bf16 v23, v154, v45, 0
  v_dot2_f32_bf16 v24, v152, v46, 0
  v_dot2_f32_bf16 v25, v155, v47, 0
  v_cvt_f32_i32 v92, v92
  v_cvt_f32_i32 v93, v93
  v_cvt_f32_i32 v94, v94
  v_cvt_f32_i32 v95, v95
  v_pk_mul_f32 v[20:21], v[92:93], v[22:23]
  v_pk_add_f32 v[18:19], v[22:23], v[24:25]
  v_pk_fma_f32 v[20:21], v[94:95], v[24:25], v[20:21]
  v_add_f32 v18, v18, v19
  v_add_f32 v20, v20, v21
  s_add_u32 m0, s100, 15360
  v_lshrrev_b32 v10, 1, v227
  v_add_u32 v10, v10, v240
  v_mad_u64_u32 v[30:31], s[64:65], v10, 1, v[28:29]
  global_load_lds_dwordx4 v[30:31], off
  s_cmp_gt_i32 s69, -13
  s_cbranch_scc1 L_p14
  s_waitcnt vmcnt(7)
L_p14:
  s_waitcnt vmcnt(11)
  buffer_load_dwordx4 v[80:83], v224, s[32:35], s80 offen nt
  v_add_f32_dpp v21, v18, v18 row_ror:8 row_mask:0xf bank_mask:0xc
  v_add_f32_dpp v21, v20, v20 row_ror:8 row_mask:0xf bank_mask:0x3
  v_add_f32_dpp v20, v34, v34 row_half_mirror row_mask:0xf bank_mask:0x5
  s_nop 0
  v_add_f32_dpp v20, v21, v21 row_half_mirror row_mask:0xf bank_mask:0xa
  s_nop 1
  v_add_f32_dpp v20, v20, v20 quad_perm:[2,3,0,1] row_mask:0xf bank_mask:0xf
  s_nop 1
  v_add_f32_dpp v20, v20, v20 quad_perm:[1,0,3,2] row_mask:0xf bank_mask:0xf
  v_cndmask_b32_e64 v32, v32, v20, s[48:49]
  v_perm_b32 v153, v158, v156, s56
  v_perm_b32 v158, v158, v156, s57
  v_perm_b32 v156, v159, v157, s56
  v_perm_b32 v159, v159, v157, s57
  v_dot2_f32_bf16 v22, v153, v48, 0
  v_dot2_f32_bf16 v23, v158, v49, 0
  v_dot2_f32_bf16 v24, v156, v50, 0
  v_dot2_f32_bf16 v25, v159, v51, 0
  v_cvt_f32_i32 v96, v96
  v_cvt_f32_i32 v97, v97
  v_cvt_f32_i32 v98, v98
  v_cvt_f32_i32 v99, v99
  v_pk_mul_f32 v[20:21], v[96:97], v[22:23]
  v_pk_add_f32 v[18:19], v[22:23], v[24:25]
  v_pk_fma_f32 v[20:21], v[98:99], v[24:25], v[20:21]
  v_add_f32 v18, v18, v19
  v_add_f32 v20, v20, v21
  s_cmp_gt_i32 s69, 2
  s_cbranch_scc1 L_p15
  s_waitcnt vmcnt(8)
L_p15:
  s_waitcnt vmcnt(12)
  buffer_load_dwordx4 v[84:87], v225, s[32:35], s80 offen nt
  v_add_f32_dpp v34, v18, v18 row_ror:8 row_mask:0xf bank_mask:0xc
  v_add_f32_dpp v34, v20, v20 row_ror:8 row_mask:0xf bank_mask:0x3
  v_perm_b32 v157, v162, v160, s56
  v_perm_b32 v162, v162, v160, s57
  v_perm_b32 v160, v163, v161, s56
  v_perm_b32 v163, v163, v161, s57
  v_dot2_f32_bf16 v22, v157, v52, 0
  v_dot2_f32_bf16 v23, v162, v53, 0
  v_dot2_f32_bf16 v24, v160, v54, 0
  v_dot2_f32_bf16 v25, v163, v55, 0
  v_cvt_f32_i32 v100, v100
  v_cvt_f32_i32 v101, v101
  v_cvt_f32_i32 v102, v102
  v_cvt_f32_i32 v103, v103
  v_pk_mul_f32 v[20:21], v[100:101], v[22:23]
  v_pk_add_f32 v[18:19], v[22:23], v[24:25]
  v_pk_fma_f32 v[20:21], v[102:103], v[24:25], v[20:21]
  v_add_f32 v18, v18, v19
  v_add_f32 v20, v20, v21
  s_add_u32 m0, s100, 16384
  v_lshrrev_b32 v10, 1, v228
  v_add_u32 v10, v10, v241
  v_mad_u64_u32 v[30:31], s[64:65], v10, 1, v[28:29]
  global_load_lds_dwordx4 v[30:31], off
  s_cmp_lt_i32 s69, -25
  s_cbranch_scc0 L_t16
  s_waitcnt vmcnt(8)
L_t16:
  s_cmp_gt_i32 s69, 9
  s_cbranch_scc1 L_p17
  s_waitcnt vmcnt(10)
L_p17:
  s_waitcnt vmcnt(14)
  buffer_load_dwordx4 v[88:91], v226, s[32:35], s80 offen nt
  v_add_f32_dpp v21, v18, v18 row_ror:8 row_mask:0xf bank_mask:0xc
  v_add_f32_dpp v21, v20, v20 row_ror:8 row_mask:0xf bank_mask:0x3
  v_add_f32_dpp v20, v34, v34 row_half_mirror row_mask:0xf bank_mask:0x5
  s_nop 0
  v_add_f32_dpp v20, v21, v21 row_half_mirror row_mask:0xf bank_mask:0xa
  s_nop 1
  v_add_f32_dpp v20, v20, v20 quad_perm:[2,3,0,1] row_mask:0xf bank_mask:0xf
  s_nop 1
  v_add_f32_dpp v20, v20, v20 quad_perm:[1,0,3,2] row_mask:0xf bank_mask:0xf
  v_cndmask_b32_e64 v32, v32, v20, s[50:51]
L_it7:
  s_waitcnt lgkmcnt(0)
  s_waitcnt vmcnt(10)
  v_add3_u32 v9, v26, v27, s58
  s_nop 0
  v_readfirstlane_b32 s91, v9
  s_add_u32 s44, s78, 0x03030303
  v_msad_u8 v9, s78, v40, 0
  v_msad_u8 v10, s44, v40, 0
  v_msad_u8 v9, s78, v41, v9
  v_msad_u8 v10, s44, v41, v10
  v_msad_u8 v9, s78, v42, v9
  v_msad_u8 v10, s44, v42, v10
  v_sub_u32 v9, v9, v10
  v_mov_b32 v8, s90
  s_add_u32 s78, s78, 0x01010101
  v_readlane_b32 s66, v9, 0
  v_readlane_b32 s67, v9, 1
  s_mov_b64 exec, 1
  global_store_byte v7, v8, s[30:31]
  s_mov_b64 exec, 3
  global_load_dwordx3 v[40:42], v239, s[30:31] sc1
  s_mov_b64 exec, -1
  s_add_u32 s69, s66, s67
  s_add_u32 s44, s69, s95
  s_mov_b32 s95, s69
  s_ashr_i32 s69, s44, 1
  s_add_u32 s69, s69, s91
  s_cmp_lt_u32 s90, 5
  s_cselect_b32 s69, 0, s69
  s_add_u32 s90, s90, 1
  v_dot2_f32_bf16 v22, v149, v56, 0
  v_dot2_f32_bf16 v23, v154, v57, 0
  v_dot2_f32_bf16 v24, v152, v58, 0
  v_dot2_f32_bf16 v25, v155, v59, 0
  v_cvt_f32_i32 v104, v104
  v_cvt_f32_i32 v105, v105
  v_cvt_f32_i32 v106, v106
  v_cvt_f32_i32 v107, v107
  v_pk_mul_f32 v[20:21], v[104:105], v[22:23]
  v_pk_add_f32 v[18:19], v[22:23], v[24:25]
  v_pk_fma_f32 v[20:21], v[106:107], v[24:25], v[20:21]
  v_add_f32 v18, v18, v19
  v_add_f32 v20, v20, v21
  s_cmp_gt_i32 s69, -13
  s_cbranch_scc1 L_p18
  s_waitcnt vmcnt(6)
L_p18:
  s_waitcnt vmcnt(10)
  buffer_load_dwordx4 v[92:95], v227, s[32:35], 0 offen nt
  v_add_f32_dpp v21, v18, v18 row_ror:8 row_mask:0xf bank_mask:0xc
  v_add_f32_dpp v21, v20, v20 row_ror:8 row_mask:0xf bank_mask:0x3
  v_add_f32_dpp v20, v35, v35 row_half_mirror row_mask:0xf bank_mask:0x5
  s_nop 0
  v_add_f32_dpp v20, v21, v21 row_half_mirror row_mask:0xf bank_mask:0xa
  s_nop 1
  v_add_f32_dpp v20, v20, v20 quad_perm:[2,3,0,1] row_mask:0xf bank_mask:0xf
  s_nop 1
  v_add_f32_dpp v20, v20, v20 quad_perm:[1,0,3,2] row_mask:0xf bank_mask:0xf
  v_cndmask_b32_e64 v33, v33, v20, s[48:49]
  v_dot2_f32_bf16 v22, v153, v60, 0
  v_dot2_f32_bf16 v23, v158, v61, 0
  v_dot2_f32_bf16 v24, v156, v62, 0
  v_dot2_f32_bf16 v25, v159, v63, 0
  v_cvt_f32_i32 v108, v108
  v_cvt_f32_i32 v109, v109
  v_cvt_f32_i32 v110, v110
  v_cvt_f32_i32 v111, v111
  v_pk_mul_f32 v[20:21], v[108:109], v[22:23]
  v_pk_add_f32 v[18:19], v[22:23], v[24:25]
  v_pk_fma_f32 v[20:21], v[110:111], v[24:25], v[20:21]
  v_add_f32 v18, v18, v19
  v_add_f32 v20, v20, v21
  s_add_u32 m0, s100, 17408
  v_lshrrev_b32 v10, 1, v229
  v_add_u32 v10, v10, v242
  v_mad_u64_u32 v[30:31], s[64:65], v10, 1, v[28:29]
  global_load_lds_dwordx4 v[30:31], off
  s_cmp_gt_i32 s69, 2
  s_cbranch_scc1 L_p19
  s_waitcnt vmcnt(8)
L_p19:
  s_waitcnt vmcnt(12)
  buffer_load_dwordx4 v[96:99], v228, s[32:35], 0 offen nt
  v_add_f32_dpp v35, v18, v18 row_ror:8 row_mask:0xf bank_mask:0xc
  v_add_f32_dpp v35, v20, v20 row_ror:8 row_mask:0xf bank_mask:0x3
  s_waitcnt vmcnt(12)
  ds_read_b64 v[164:165], v12 offset:12288
  ds_read_b64 v[166:167], v12 offset:12416
  ds_read_b64 v[168:169], v12 offset:13312
  ds_read_b64 v[170:171], v12 offset:13440
  ds_read_b64 v[172:173], v12 offset:14336
  ds_read_b64 v[174:175], v12 offset:14464
  v_dot2_f32_bf16 v22, v157, v64, 0
  v_dot2_f32_bf16 v23, v162, v65, 0
  v_dot2_f32_bf16 v24, v160, v66, 0
  v_dot2_f32_bf16 v25, v163, v67, 0
  v_cvt_f32_i32 v112, v112
  v_cvt_f32_i32 v113, v113
  v_cvt_f32_i32 v114, v114
  v_cvt_f32_i32 v115, v115
  v_pk_mul_f32 v[20:21], v[112:113], v[22:23]
  v_pk_add_f32 v[18:19], v[22:23], v[24:25]
  v_pk_fma_f32 v[20:21], v[114:115], v[24:25], v[20:21]
  v_add_f32 v18, v18, v19
  v_add_f32 v20, v20, v21
  s_cmp_lt_i32 s69, -25
  s_cbranch_scc0 L_t20
  s_waitcnt vmcnt(8)
L_t20:
  s_cmp_gt_i32 s69, 9
  s_cbranch_scc1 L_p21
  s_waitcnt vmcnt(9)
L_p21:
  s_waitcnt vmcnt(13)
  buffer_load_dwordx4 v[100:103], v229, s[32:35], 0 offen nt
  v_add_f32_dpp v21, v18, v18 row_ror:8 row_mask:0xf bank_mask:0xc
  v_add_f32_dpp v21, v20, v20 row_ror:8 row_mask:0xf bank_mask:0x3
  v_add_f32_dpp v20, v35, v35 row_half_mirror row_mask:0xf bank_mask:0x5
  s_nop 0
  v_add_f32_dpp v20, v21, v21 row_half_mirror row_mask:0xf bank_mask:0xa
  s_nop 1
  v_add_f32_dpp v20, v20, v20 quad_perm:[2,3,0,1] row_mask:0xf bank_mask:0xf
  s_nop 1
  v_add_f32_dpp v20, v20, v20 quad_perm:[1,0,3,2] row_mask:0xf bank_mask:0xf
  v_cndmask_b32_e64 v33, v33, v20, s[50:51]
  v_mov_b32 v8, 1
  ds_write_b32 v6, v8 offset:0
L_it8:
  s_waitcnt lgkmcnt(0)
  s_waitcnt vmcnt(10)
  s_add_u32 s44, s78, 0x03030303
  v_msad_u8 v9, s78, v36, 0
  v_msad_u8 v10, s44, v36, 0
  v_msad_u8 v9, s78, v37, v9
  v_msad_u8 v10, s44, v37, v10
  v_msad_u8 v9, s78, v38, v9
  v_msad_u8 v10, s44, v38, v10
  v_sub_u32 v9, v9, v10
  v_mov_b32 v8, s90
  s_add_u32 s78, s78, 0x01010101
  v_readlane_b32 s66, v9, 0
  v_readlane_b32 s67, v9, 1
  s_mov_b64 exec, 1
  global_store_byte v7, v8, s[30:31]
  s_mov_b64 exec, 3
  global_load_dwordx3 v[36:38], v236, s[30:31] sc1
  s_mov_b64 exec, -1
  s_add_u32 s69, s66, s67
  s_add_u32 s44, s69, s95
  s_mov_b32 s95, s69
  s_ashr_i32 s69, s44, 1
  s_add_u32 s69, s69, s91
  s_cmp_lt_u32 s90, 5
  s_cselect_b32 s69, 0, s69
  s_add_u32 s90, s90, 1
  v_perm_b32 v161, v166, v164, s56
  v_perm_b32 v166, v166, v164, s57
  v_perm_b32 v164, v167, v165, s56
  v_perm_b32 v167, v167, v165, s57
  v_dot2_f32_bf16 v22, v161, v44, 0
  v_dot2_f32_bf16 v23, v166, v45, 0
  v_dot2_f32_bf16 v24, v164, v46, 0
  v_dot2_f32_bf16 v25, v167, v47, 0
  v_cvt_f32_i32 v68, v68
  v_cvt_f32_i32 v69, v69
  v_cvt_f32_i32 v70, v70
  v_cvt_f32_i32 v71, v71
  v_pk_mul_f32 v[20:21], v[68:69], v[22:23]
  v_pk_add_f32 v[18:19], v[22:23], v[24:25]
  v_pk_fma_f32 v[20:21], v[70:71], v[24:25], v[20:21]
  v_add_f32 v18, v18, v19
  v_add_f32 v20, v20, v21
  s_add_u32 m0, s100, 18432
  v_lshrrev_b32 v10, 1, v230
  v_add_u32 v10, v10, v240
  v_mad_u64_u32 v[30:31], s[64:65], v10, 1, v[28:29]
  global_load_lds_dwordx4 v[30:31], off
  s_cmp_gt_i32 s69, -13
  s_cbranch_scc1 L_p22
  s_waitcnt vmcnt(7)
L_p22:
  s_waitcnt vmcnt(10)
  buffer_load_dwordx4 v[104:107], v227, s[32:35], s80 offen nt
  v_add_f32_dpp v34, v18, v18 row_ror:8 row_mask:0xf bank_mask:0xc
  v_add_f32_dpp v34, v20, v20 row_ror:8 row_mask:0xf bank_mask:0x3
  v_perm_b32 v165, v170, v168, s56
  v_perm_b32 v170, v170, v168, s57
  v_perm_b32 v168, v171, v169, s56
  v_perm_b32 v171, v171, v169, s57
  v_dot2_f32_bf16 v22, v165, v48, 0
  v_dot2_f32_bf16 v23, v170, v49, 0
  v_dot2_f32_bf16 v24, v168, v50, 0
  v_dot2_f32_bf16 v25, v171, v51, 0
  v_cvt_f32_i32 v72, v72
  v_cvt_f32_i32 v73, v73
  v_cvt_f32_i32 v74, v74
  v_cvt_f32_i32 v75, v75
  v_pk_mul_f32 v[20:21], v[72:73], v[22:23]
  v_pk_add_f32 v[18:19], v[22:23], v[24:25]
  v_pk_fma_f32 v[20:21], v[74:75], v[24:25], v[20:21]
  v_add_f32 v18, v18, v19
  v_add_f32 v20, v20, v21
  s_cmp_gt_i32 s69, 2
  s_cbranch_scc1 L_p23
  s_waitcnt vmcnt(8)
L_p23:
  s_waitcnt vmcnt(11)
  buffer_load_dwordx4 v[108:111], v228, s[32:35], s80 offen nt
  v_add_f32_dpp v21, v18, v18 row_ror:8 row_mask:0xf bank_mask:0xc
  v_add_f32_dpp v21, v20, v20 row_ror:8 row_mask:0xf bank_mask:0x3
  v_add_f32_dpp v20, v34, v34 row_half_mirror row_mask:0xf bank_mask:0x5
  s_nop 0
  v_add_f32_dpp v20, v21, v21 row_half_mirror row_mask:0xf bank_mask:0xa
  s_nop 1
  v_add_f32_dpp v20, v20, v20 quad_perm:[2,3,0,1] row_mask:0xf bank_mask:0xf
  s_nop 1
  v_add_f32_dpp v20, v20, v20 quad_perm:[1,0,3,2] row_mask:0xf bank_mask:0xf
  v_cndmask_b32_e64 v32, v32, v20, s[52:53]
  v_perm_b32 v169, v174, v172, s56
  v_perm_b32 v174, v174, v172, s57
  v_perm_b32 v172, v175, v173, s56
  v_perm_b32 v175, v175, v173, s57
  v_dot2_f32_bf16 v22, v169, v52, 0
  v_dot2_f32_bf16 v23, v174, v53, 0
  v_dot2_f32_bf16 v24, v172, v54, 0
  v_dot2_f32_bf16 v25, v175, v55, 0
  v_cvt_f32_i32 v76, v76
  v_cvt_f32_i32 v77, v77
  v_cvt_f32_i32 v78, v78
  v_cvt_f32_i32 v79, v79
  v_pk_mul_f32 v[20:21], v[76:77], v[22:23]
  v_pk_add_f32 v[18:19], v[22:23], v[24:25]
  v_pk_fma_f32 v[20:21], v[78:79], v[24:25], v[20:21]
  v_add_f32 v18, v18, v19
  v_add_f32 v20, v20, v21
  s_add_u32 m0, s100, 19456
  v_lshrrev_b32 v10, 1, v231
  v_add_u32 v10, v10, v241
  v_mad_u64_u32 v[30:31], s[64:65], v10, 1, v[28:29]
  global_load_lds_dwordx4 v[30:31], off
  s_cmp_lt_i32 s69, -25
  s_cbranch_scc0 L_t24
  s_waitcnt vmcnt(8)
L_t24:
  s_cmp_gt_i32 s69, 9
  s_cbranch_scc1 L_p25
  s_waitcnt vmcnt(10)
L_p25:
  s_waitcnt vmcnt(13)
  buffer_load_dwordx4 v[112:115], v229, s[32:35], s80 offen nt
  v_add_f32_dpp v34, v18, v18 row_ror:8 row_mask:0xf bank_mask:0xc
  v_add_f32_dpp v34, v20, v20 row_ror:8 row_mask:0xf bank_mask:0x3
L_it9:
  s_waitcnt lgkmcnt(0)
  s_waitcnt vmcnt(10)
  s_add_u32 s44, s78, 0x03030303
  v_msad_u8 v9, s78, v40, 0
  v_msad_u8 v10, s44, v40, 0
  v_msad_u8 v9, s78, v41, v9
  v_msad_u8 v10, s44, v41, v10
  v_msad_u8 v9, s78, v42, v9
  v_msad_u8 v10, s44, v42, v10
  v_sub_u32 v9, v9, v10
  v_mov_b32 v8, s90
  s_add_u32 s78, s78, 0x01010101
  v_readlane_b32 s66, v9, 0
  v_readlane_b32 s67, v9, 1
  s_mov_b64 exec, 1
  global_store_byte v7, v8, s[30:31]
  s_mov_b64 exec, 3
  global_load_dwordx3 v[40:42], v237, s[30:31] sc1
  s_mov_b64 exec, -1
  s_add_u32 s69, s66, s67
  s_add_u32 s44, s69, s95
  s_mov_b32 s95, s69
  s_ashr_i32 s69, s44, 1
  s_add_u32 s69, s69, s91
  s_cmp_lt_u32 s90, 5
  s_cselect_b32 s69, 0, s69
  s_add_u32 s90, s90, 1
  v_dot2_f32_bf16 v22, v161, v56, 0
  v_dot2_f32_bf16 v23, v166, v57, 0
  v_dot2_f32_bf16 v24, v164, v58, 0
  v_dot2_f32_bf16 v25, v167, v59, 0
  v_cvt_f32_i32 v80, v80
  v_cvt_f32_i32 v81, v81
  v_cvt_f32_i32 v82, v82
  v_cvt_f32_i32 v83, v83
  v_pk_mul_f32 v[20:21], v[80:81], v[22:23]
  v_pk_add_f32 v[18:19], v[22:23], v[24:25]
  v_pk_fma_f32 v[20:21], v[82:83], v[24:25], v[20:21]
  v_add_f32 v18, v18, v19
  v_add_f32 v20, v20, v21
  s_cmp_gt_i32 s69, -13
  s_cbranch_scc1 L_p26
  s_waitcnt vmcnt(6)
L_p26:
  s_waitcnt vmcnt(10)
  buffer_load_dwordx4 v[68:71], v230, s[32:35], 0 offen nt
  v_add_f32_dpp v35, v18, v18 row_ror:8 row_mask:0xf bank_mask:0xc
  v_add_f32_dpp v35, v20, v20 row_ror:8 row_mask:0xf bank_mask:0x3
  v_dot2_f32_bf16 v22, v165, v60, 0
  v_dot2_f32_bf16 v23, v170, v61, 0
  v_dot2_f32_bf16 v24, v168, v62, 0
  v_dot2_f32_bf16 v25, v171, v63, 0
  v_cvt_f32_i32 v84, v84
  v_cvt_f32_i32 v85, v85
  v_cvt_f32_i32 v86, v86
  v_cvt_f32_i32 v87, v87
  v_pk_mul_f32 v[20:21], v[84:85], v[22:23]
  v_pk_add_f32 v[18:19], v[22:23], v[24:25]
  v_pk_fma_f32 v[20:21], v[86:87], v[24:25], v[20:21]
  v_add_f32 v18, v18, v19
  v_add_f32 v20, v20, v21
  s_add_u32 m0, s100, 20480
  v_lshrrev_b32 v10, 1, v232
  v_add_u32 v10, v10, v242
  v_mad_u64_u32 v[30:31], s[64:65], v10, 1, v[28:29]
  global_load_lds_dwordx4 v[30:31], off
  s_cmp_gt_i32 s69, 2
  s_cbranch_scc1 L_p27
  s_waitcnt vmcnt(8)
L_p27:
  s_waitcnt vmcnt(12)
  buffer_load_dwordx4 v[72:75], v231, s[32:35], 0 offen nt
  v_add_f32_dpp v21, v18, v18 row_ror:8 row_mask:0xf bank_mask:0xc
  v_add_f32_dpp v21, v20, v20 row_ror:8 row_mask:0xf bank_mask:0x3
  v_add_f32_dpp v20, v35, v35 row_half_mirror row_mask:0xf bank_mask:0x5
  s_nop 0
  v_add_f32_dpp v20, v21, v21 row_half_mirror row_mask:0xf bank_mask:0xa
  s_nop 1
  v_add_f32_dpp v20, v20, v20 quad_perm:[2,3,0,1] row_mask:0xf bank_mask:0xf
  s_nop 1
  v_add_f32_dpp v20, v20, v20 quad_perm:[1,0,3,2] row_mask:0xf bank_mask:0xf
  v_cndmask_b32_e64 v33, v33, v20, s[52:53]
  s_waitcnt vmcnt(12)
  ds_read_b64 v[176:177], v12 offset:15360
  ds_read_b64 v[178:179], v12 offset:15488
  ds_read_b64 v[180:181], v12 offset:16384
  ds_read_b64 v[182:183], v12 offset:16512
  ds_read_b64 v[184:185], v12 offset:17408
  ds_read_b64 v[186:187], v12 offset:17536
  v_dot2_f32_bf16 v22, v169, v64, 0
  v_dot2_f32_bf16 v23, v174, v65, 0
  v_dot2_f32_bf16 v24, v172, v66, 0
  v_dot2_f32_bf16 v25, v175, v67, 0
  v_cvt_f32_i32 v88, v88
  v_cvt_f32_i32 v89, v89
  v_cvt_f32_i32 v90, v90
  v_cvt_f32_i32 v91, v91
  v_pk_mul_f32 v[20:21], v[88:89], v[22:23]
  v_pk_add_f32 v[18:19], v[22:23], v[24:25]
  v_pk_fma_f32 v[20:21], v[90:91], v[24:25], v[20:21]
  v_add_f32 v18, v18, v19
  v_add_f32 v20, v20, v21
  s_cmp_lt_i32 s69, -25
  s_cbranch_scc0 L_t28
  s_waitcnt vmcnt(8)
L_t28:
  s_cmp_gt_i32 s69, 9
  s_cbranch_scc1 L_p29
  s_waitcnt vmcnt(9)
L_p29:
  s_waitcnt vmcnt(13)
  buffer_load_dwordx4 v[76:79], v232, s[32:35], 0 offen nt
  v_add_f32_dpp v35, v18, v18 row_ror:8 row_mask:0xf bank_mask:0xc
  v_add_f32_dpp v35, v20, v20 row_ror:8 row_mask:0xf bank_mask:0x3
L_it10:
  s_waitcnt lgkmcnt(0)
  s_waitcnt vmcnt(10)
  s_add_u32 s44, s78, 0x03030303
  v_msad_u8 v9, s78, v36, 0
  v_msad_u8 v10, s44, v36, 0
  v_msad_u8 v9, s78, v37, v9
  v_msad_u8 v10, s44, v37, v10
  v_msad_u8 v9, s78, v38, v9
  v_msad_u8 v10, s44, v38, v10
  v_sub_u32 v9, v9, v10
  v_mov_b32 v8, s90
  s_add_u32 s78, s78, 0x01010101
  v_readlane_b32 s66, v9, 0
  v_readlane_b32 s67, v9, 1
  s_mov_b64 exec, 1
  global_store_byte v7, v8, s[30:31]
  s_mov_b64 exec, 3
  global_load_dwordx3 v[36:38], v238, s[30:31] sc1
  s_mov_b64 exec, -1
  s_add_u32 s69, s66, s67
  s_add_u32 s44, s69, s95
  s_mov_b32 s95, s69
  s_ashr_i32 s69, s44, 1
  s_add_u32 s69, s69, s91
  s_cmp_lt_u32 s90, 5
  s_cselect_b32 s69, 0, s69
  s_add_u32 s90, s90, 1
  v_perm_b32 v173, v178, v176, s56
  v_perm_b32 v178, v178, v176, s57
  v_perm_b32 v176, v179, v177, s56
  v_perm_b32 v179, v179, v177, s57
  v_dot2_f32_bf16 v22, v173, v44, 0
  v_dot2_f32_bf16 v23, v178, v45, 0
  v_dot2_f32_bf16 v24, v176, v46, 0
  v_dot2_f32_bf16 v25, v179, v47, 0
  v_cvt_f32_i32 v92, v92
  v_cvt_f32_i32 v93, v93
  v_cvt_f32_i32 v94, v94
  v_cvt_f32_i32 v95, v95
  v_pk_mul_f32 v[20:21], v[92:93], v[22:23]
  v_pk_add_f32 v[18:19], v[22:23], v[24:25]
  v_pk_fma_f32 v[20:21], v[94:95], v[24:25], v[20:21]
  v_add_f32 v18, v18, v19
  v_add_f32 v20, v20, v21
  s_add_u32 m0, s100, 21504
  v_lshrrev_b32 v10, 1, v233
  v_add_u32 v10, v10, v240
  v_mad_u64_u32 v[30:31], s[64:65], v10, 1, v[28:29]
  global_load_lds_dwordx4 v[30:31], off
  s_cmp_gt_i32 s69, -13
  s_cbranch_scc1 L_p30
  s_waitcnt vmcnt(7)
L_p30:
  s_waitcnt vmcnt(10)
  buffer_load_dwordx4 v[80:83], v230, s[32:35], s80 offen nt
  v_add_f32_dpp v21, v18, v18 row_ror:8 row_mask:0xf bank_mask:0xc
  v_add_f32_dpp v21, v20, v20 row_ror:8 row_mask:0xf bank_mask:0x3
  v_add_f32_dpp v20, v34, v34 row_half_mirror row_mask:0xf bank_mask:0x5
  s_nop 0
  v_add_f32_dpp v20, v21, v21 row_half_mirror row_mask:0xf bank_mask:0xa
  s_nop 1
  v_add_f32_dpp v20, v20, v20 quad_perm:[2,3,0,1] row_mask:0xf bank_mask:0xf
  s_nop 1
  v_add_f32_dpp v20, v20, v20 quad_perm:[1,0,3,2] row_mask:0xf bank_mask:0xf
  v_cndmask_b32_e64 v32, v32, v20, s[54:55]
  ds_write_b32 v1, v32 offset:512
  v_perm_b32 v177, v182, v180, s56
  v_perm_b32 v182, v182, v180, s57
  v_perm_b32 v180, v183, v181, s56
  v_perm_b32 v183, v183, v181, s57
  v_dot2_f32_bf16 v22, v177, v48, 0
  v_dot2_f32_bf16 v23, v182, v49, 0
  v_dot2_f32_bf16 v24, v180, v50, 0
  v_dot2_f32_bf16 v25, v183, v51, 0
  v_cvt_f32_i32 v96, v96
  v_cvt_f32_i32 v97, v97
  v_cvt_f32_i32 v98, v98
  v_cvt_f32_i32 v99, v99
  v_pk_mul_f32 v[20:21], v[96:97], v[22:23]
  v_pk_add_f32 v[18:19], v[22:23], v[24:25]
  v_pk_fma_f32 v[20:21], v[98:99], v[24:25], v[20:21]
  v_add_f32 v18, v18, v19
  v_add_f32 v20, v20, v21
  s_cmp_gt_i32 s69, 2
  s_cbranch_scc1 L_p31
  s_waitcnt vmcnt(8)
L_p31:
  s_waitcnt vmcnt(11)
  buffer_load_dwordx4 v[84:87], v231, s[32:35], s80 offen nt
  v_add_f32_dpp v34, v18, v18 row_ror:8 row_mask:0xf bank_mask:0xc
  v_add_f32_dpp v34, v20, v20 row_ror:8 row_mask:0xf bank_mask:0x3
  v_perm_b32 v181, v186, v184, s56
  v_perm_b32 v186, v186, v184, s57
  v_perm_b32 v184, v187, v185, s56
  v_perm_b32 v187, v187, v185, s57
  v_dot2_f32_bf16 v22, v181, v52, 0
  v_dot2_f32_bf16 v23, v186, v53, 0
  v_dot2_f32_bf16 v24, v184, v54, 0
  v_dot2_f32_bf16 v25, v187, v55, 0
  v_cvt_f32_i32 v100, v100
  v_cvt_f32_i32 v101, v101
  v_cvt_f32_i32 v102, v102
  v_cvt_f32_i32 v103, v103
  v_pk_mul_f32 v[20:21], v[100:101], v[22:23]
  v_pk_add_f32 v[18:19], v[22:23], v[24:25]
  v_pk_fma_f32 v[20:21], v[102:103], v[24:25], v[20:21]
  v_add_f32 v18, v18, v19
  v_add_f32 v20, v20, v21
  s_add_u32 m0, s100, 22528
  v_lshrrev_b32 v10, 1, v234
  v_add_u32 v10, v10, v241
  v_mad_u64_u32 v[30:31], s[64:65], v10, 1, v[28:29]
  global_load_lds_dwordx4 v[30:31], off
  s_cmp_lt_i32 s69, -25
  s_cbranch_scc0 L_t32
  s_waitcnt vmcnt(8)
L_t32:
  s_cmp_gt_i32 s69, 9
  s_cbranch_scc1 L_p33
  s_waitcnt vmcnt(10)
L_p33:
  s_waitcnt vmcnt(13)
  buffer_load_dwordx4 v[88:91], v232, s[32:35], s80 offen nt
  v_add_f32_dpp v21, v18, v18 row_ror:8 row_mask:0xf bank_mask:0xc
  v_add_f32_dpp v21, v20, v20 row_ror:8 row_mask:0xf bank_mask:0x3
  v_add_f32_dpp v20, v34, v34 row_half_mirror row_mask:0xf bank_mask:0x5
  s_nop 0
  v_add_f32_dpp v20, v21, v21 row_half_mirror row_mask:0xf bank_mask:0xa
  s_nop 1
  v_add_f32_dpp v20, v20, v20 quad_perm:[2,3,0,1] row_mask:0xf bank_mask:0xf
  s_nop 1
  v_add_f32_dpp v20, v20, v20 quad_perm:[1,0,3,2] row_mask:0xf bank_mask:0xf
  v_cndmask_b32_e64 v32, v32, v20, s[48:49]
L_it11:
  s_waitcnt lgkmcnt(0)
  s_waitcnt vmcnt(10)
  s_add_u32 s44, s78, 0x03030303
  v_msad_u8 v9, s78, v40, 0
  v_msad_u8 v10, s44, v40, 0
  v_msad_u8 v9, s78, v41, v9
  v_msad_u8 v10, s44, v41, v10
  v_msad_u8 v9, s78, v42, v9
  v_msad_u8 v10, s44, v42, v10
  v_sub_u32 v9, v9, v10
  v_mov_b32 v8, s90
  s_add_u32 s78, s78, 0x01010101
  v_readlane_b32 s66, v9, 0
  v_readlane_b32 s67, v9, 1
  s_mov_b64 exec, 1
  global_store_byte v7, v8, s[30:31]
  s_mov_b64 exec, 3
  global_load_dwordx3 v[40:42], v239, s[30:31] sc1
  s_mov_b64 exec, -1
  s_add_u32 s69, s66, s67
  s_add_u32 s44, s69, s95
  s_mov_b32 s95, s69
  s_ashr_i32 s69, s44, 1
  s_add_u32 s69, s69, s91
  s_cmp_lt_u32 s90, 5
  s_cselect_b32 s69, 0, s69
  s_add_u32 s90, s90, 1
  v_dot2_f32_bf16 v22, v173, v56, 0
  v_dot2_f32_bf16 v23, v178, v57, 0
  v_dot2_f32_bf16 v24, v176, v58, 0
  v_dot2_f32_bf16 v25, v179, v59, 0
  v_cvt_f32_i32 v104, v104
  v_cvt_f32_i32 v105, v105
  v_cvt_f32_i32 v106, v106
  v_cvt_f32_i32 v107, v107
  v_pk_mul_f32 v[20:21], v[104:105], v[22:23]
  v_pk_add_f32 v[18:19], v[22:23], v[24:25]
  v_pk_fma_f32 v[20:21], v[106:107], v[24:25], v[20:21]
  v_add_f32 v18, v18, v19
  v_add_f32 v20, v20, v21
  s_cmp_gt_i32 s69, -13
  s_cbranch_scc1 L_p34
  s_waitcnt vmcnt(6)
L_p34:
  s_waitcnt vmcnt(10)
  buffer_load_dwordx4 v[92:95], v233, s[32:35], 0 offen nt
  v_add_f32_dpp v21, v18, v18 row_ror:8 row_mask:0xf bank_mask:0xc
  v_add_f32_dpp v21, v20, v20 row_ror:8 row_mask:0xf bank_mask:0x3
  v_add_f32_dpp v20, v35, v35 row_half_mirror row_mask:0xf bank_mask:0x5
  s_nop 0
  v_add_f32_dpp v20, v21, v21 row_half_mirror row_mask:0xf bank_mask:0xa
  s_nop 1
  v_add_f32_dpp v20, v20, v20 quad_perm:[2,3,0,1] row_mask:0xf bank_mask:0xf
  s_nop 1
  v_add_f32_dpp v20, v20, v20 quad_perm:[1,0,3,2] row_mask:0xf bank_mask:0xf
  v_cndmask_b32_e64 v33, v33, v20, s[54:55]
  ds_write_b32 v1, v33 offset:3584
  v_dot2_f32_bf16 v22, v177, v60, 0
  v_dot2_f32_bf16 v23, v182, v61, 0
  v_dot2_f32_bf16 v24, v180, v62, 0
  v_dot2_f32_bf16 v25, v183, v63, 0
  v_cvt_f32_i32 v108, v108
  v_cvt_f32_i32 v109, v109
  v_cvt_f32_i32 v110, v110
  v_cvt_f32_i32 v111, v111
  v_pk_mul_f32 v[20:21], v[108:109], v[22:23]
  v_pk_add_f32 v[18:19], v[22:23], v[24:25]
  v_pk_fma_f32 v[20:21], v[110:111], v[24:25], v[20:21]
  v_add_f32 v18, v18, v19
  v_add_f32 v20, v20, v21
  s_add_u32 m0, s100, 23552
  v_lshrrev_b32 v10, 1, v235
  v_add_u32 v10, v10, v242
  v_mad_u64_u32 v[30:31], s[64:65], v10, 1, v[28:29]
  global_load_lds_dwordx4 v[30:31], off
  s_cmp_gt_i32 s69, 2
  s_cbranch_scc1 L_p35
  s_waitcnt vmcnt(8)
L_p35:
  s_waitcnt vmcnt(12)
  buffer_load_dwordx4 v[96:99], v234, s[32:35], 0 offen nt
  v_add_f32_dpp v35, v18, v18 row_ror:8 row_mask:0xf bank_mask:0xc
  v_add_f32_dpp v35, v20, v20 row_ror:8 row_mask:0xf bank_mask:0x3
  s_waitcnt vmcnt(12)
  ds_read_b64 v[188:189], v12 offset:18432
  ds_read_b64 v[190:191], v12 offset:18560
  ds_read_b64 v[192:193], v12 offset:19456
  ds_read_b64 v[194:195], v12 offset:19584
  ds_read_b64 v[196:197], v12 offset:20480
  ds_read_b64 v[198:199], v12 offset:20608
  v_dot2_f32_bf16 v22, v181, v64, 0
  v_dot2_f32_bf16 v23, v186, v65, 0
  v_dot2_f32_bf16 v24, v184, v66, 0
  v_dot2_f32_bf16 v25, v187, v67, 0
  v_cvt_f32_i32 v112, v112
  v_cvt_f32_i32 v113, v113
  v_cvt_f32_i32 v114, v114
  v_cvt_f32_i32 v115, v115
  v_pk_mul_f32 v[20:21], v[112:113], v[22:23]
  v_pk_add_f32 v[18:19], v[22:23], v[24:25]
  v_pk_fma_f32 v[20:21], v[114:115], v[24:25], v[20:21]
  v_add_f32 v18, v18, v19
  v_add_f32 v20, v20, v21
  s_cmp_lt_i32 s69, -25
  s_cbranch_scc0 L_t36
  s_waitcnt vmcnt(8)
L_t36:
  s_cmp_gt_i32 s69, 9
  s_cbranch_scc1 L_p37
  s_waitcnt vmcnt(9)
L_p37:
  s_waitcnt vmcnt(13)
  buffer_load_dwordx4 v[100:103], v235, s[32:35], 0 offen nt
  v_add_f32_dpp v21, v18, v18 row_ror:8 row_mask:0xf bank_mask:0xc
  v_add_f32_dpp v21, v20, v20 row_ror:8 row_mask:0xf bank_mask:0x3
  v_add_f32_dpp v20, v35, v35 row_half_mirror row_mask:0xf bank_mask:0x5
  s_nop 0
  v_add_f32_dpp v20, v21, v21 row_half_mirror row_mask:0xf bank_mask:0xa
  s_nop 1
  v_add_f32_dpp v20, v20, v20 quad_perm:[2,3,0,1] row_mask:0xf bank_mask:0xf
  s_nop 1
  v_add_f32_dpp v20, v20, v20 quad_perm:[1,0,3,2] row_mask:0xf bank_mask:0xf
  v_cndmask_b32_e64 v33, v33, v20, s[48:49]
L_it12:
  s_waitcnt lgkmcnt(0)
  s_waitcnt vmcnt(10)
  s_add_u32 s44, s78, 0x03030303
  v_msad_u8 v9, s78, v36, 0
  v_msad_u8 v10, s44, v36, 0
  v_msad_u8 v9, s78, v37, v9
  v_msad_u8 v10, s44, v37, v10
  v_msad_u8 v9, s78, v38, v9
  v_msad_u8 v10, s44, v38, v10
  v_sub_u32 v9, v9, v10
  v_mov_b32 v8, s90
  s_add_u32 s78, s78, 0x01010101
  v_readlane_b32 s66, v9, 0
  v_readlane_b32 s67, v9, 1
  s_mov_b64 exec, 1
  global_store_byte v7, v8, s[30:31]
  s_mov_b64 exec, 3
  global_load_dwordx3 v[36:38], v236, s[30:31] sc1
  s_mov_b64 exec, -1
  s_add_u32 s69, s66, s67
  s_add_u32 s44, s69, s95
  s_mov_b32 s95, s69
  s_ashr_i32 s69, s44, 1
  s_add_u32 s69, s69, s91
  s_cmp_lt_u32 s90, 5
  s_cselect_b32 s69, 0, s69
  s_add_u32 s90, s90, 1
  v_perm_b32 v185, v190, v188, s56
  v_perm_b32 v190, v190, v188, s57
  v_perm_b32 v188, v191, v189, s56
  v_perm_b32 v191, v191, v189, s57
  v_dot2_f32_bf16 v22, v185, v44, 0
  v_dot2_f32_bf16 v23, v190, v45, 0
  v_dot2_f32_bf16 v24, v188, v46, 0
  v_dot2_f32_bf16 v25, v191, v47, 0
  v_cvt_f32_i32 v68, v68
  v_cvt_f32_i32 v69, v69
  v_cvt_f32_i32 v70, v70
  v_cvt_f32_i32 v71, v71
  v_pk_mul_f32 v[20:21], v[68:69], v[22:23]
  v_pk_add_f32 v[18:19], v[22:23], v[24:25]
  v_pk_fma_f32 v[20:21], v[70:71], v[24:25], v[20:21]
  v_add_f32 v18, v18, v19
  v_add_f32 v20, v20, v21
  s_cmp_gt_i32 s69, -13
  s_cbranch_scc1 L_p38
  s_waitcnt vmcnt(6)
L_p38:
  s_waitcnt vmcnt(9)
  buffer_load_dwordx4 v[104:107], v233, s[32:35], s80 offen nt
  v_add_f32_dpp v34, v18, v18 row_ror:8 row_mask:0xf bank_mask:0xc
  v_add_f32_dpp v34, v20, v20 row_ror:8 row_mask:0xf bank_mask:0x3
  v_perm_b32 v189, v194, v192, s56
  v_perm_b32 v194, v194, v192, s57
  v_perm_b32 v192, v195, v193, s56
  v_perm_b32 v195, v195, v193, s57
  v_dot2_f32_bf16 v22, v189, v48, 0
  v_dot2_f32_bf16 v23, v194, v49, 0
  v_dot2_f32_bf16 v24, v192, v50, 0
  v_dot2_f32_bf16 v25, v195, v51, 0
  v_cvt_f32_i32 v72, v72
  v_cvt_f32_i32 v73, v73
  v_cvt_f32_i32 v74, v74
  v_cvt_f32_i32 v75, v75
  v_pk_mul_f32 v[20:21], v[72:73], v[22:23]
  v_pk_add_f32 v[18:19], v[22:23], v[24:25]
  v_pk_fma_f32 v[20:21], v[74:75], v[24:25], v[20:21]
  v_add_f32 v18, v18, v19
  v_add_f32 v20, v20, v21
  s_cmp_gt_i32 s69, 2
  s_cbranch_scc1 L_p39
  s_waitcnt vmcnt(7)
L_p39:
  s_waitcnt vmcnt(10)
  buffer_load_dwordx4 v[108:111], v234, s[32:35], s80 offen nt
  v_add_f32_dpp v21, v18, v18 row_ror:8 row_mask:0xf bank_mask:0xc
  v_add_f32_dpp v21, v20, v20 row_ror:8 row_mask:0xf bank_mask:0x3
  v_add_f32_dpp v20, v34, v34 row_half_mirror row_mask:0xf bank_mask:0x5
  s_nop 0
  v_add_f32_dpp v20, v21, v21 row_half_mirror row_mask:0xf bank_mask:0xa
  s_nop 1
  v_add_f32_dpp v20, v20, v20 quad_perm:[2,3,0,1] row_mask:0xf bank_mask:0xf
  s_nop 1
  v_add_f32_dpp v20, v20, v20 quad_perm:[1,0,3,2] row_mask:0xf bank_mask:0xf
  v_cndmask_b32_e64 v32, v32, v20, s[50:51]
  v_perm_b32 v193, v198, v196, s56
  v_perm_b32 v198, v198, v196, s57
  v_perm_b32 v196, v199, v197, s56
  v_perm_b32 v199, v199, v197, s57
  v_dot2_f32_bf16 v22, v193, v52, 0
  v_dot2_f32_bf16 v23, v198, v53, 0
  v_dot2_f32_bf16 v24, v196, v54, 0
  v_dot2_f32_bf16 v25, v199, v55, 0
  v_cvt_f32_i32 v76, v76
  v_cvt_f32_i32 v77, v77
  v_cvt_f32_i32 v78, v78
  v_cvt_f32_i32 v79, v79
  v_pk_mul_f32 v[20:21], v[76:77], v[22:23]
  v_pk_add_f32 v[18:19], v[22:23], v[24:25]
  v_pk_fma_f32 v[20:21], v[78:79], v[24:25], v[20:21]
  v_add_f32 v18, v18, v19
  v_add_f32 v20, v20, v21
  s_cmp_lt_i32 s69, -25
  s_cbranch_scc0 L_t40
  s_waitcnt vmcnt(6)
L_t40:
  s_cmp_gt_i32 s69, 9
  s_cbranch_scc1 L_p41
  s_waitcnt vmcnt(8)
L_p41:
  s_waitcnt vmcnt(11)
  buffer_load_dwordx4 v[112:115], v235, s[32:35], s80 offen nt
  v_add_f32_dpp v34, v18, v18 row_ror:8 row_mask:0xf bank_mask:0xc
  v_add_f32_dpp v34, v20, v20 row_ror:8 row_mask:0xf bank_mask:0x3
L_it13:
  s_waitcnt lgkmcnt(0)
  s_mov_b64 exec, 1
  global_load_dwordx2 v[26:27], v11, s[30:31] sc1
  s_mov_b64 exec, -1
  s_waitcnt vmcnt(9)
  s_add_u32 s44, s78, 0x03030303
  v_msad_u8 v9, s78, v40, 0
  v_msad_u8 v10, s44, v40, 0
  v_msad_u8 v9, s78, v41, v9
  v_msad_u8 v10, s44, v41, v10
  v_msad_u8 v9, s78, v42, v9
  v_msad_u8 v10, s44, v42, v10
  v_sub_u32 v9, v9, v10
  v_mov_b32 v8, s90
  s_add_u32 s78, s78, 0x01010101
  v_readlane_b32 s66, v9, 0
  v_readlane_b32 s67, v9, 1
  s_mov_b64 exec, 1
  global_store_byte v7, v8, s[30:31]
  s_mov_b64 exec, 3
  global_load_dwordx3 v[40:42], v237, s[30:31] sc1
  s_mov_b64 exec, -1
  s_add_u32 s69, s66, s67
  s_add_u32 s44, s69, s95
  s_mov_b32 s95, s69
  s_ashr_i32 s69, s44, 1
  s_add_u32 s69, s69, s91
  s_cmp_lt_u32 s90, 5
  s_cselect_b32 s69, 0, s69
  s_add_u32 s90, s90, 1
  v_dot2_f32_bf16 v22, v185, v56, 0
  v_dot2_f32_bf16 v23, v190, v57, 0
  v_dot2_f32_bf16 v24, v188, v58, 0
  v_dot2_f32_bf16 v25, v191, v59, 0
  v_cvt_f32_i32 v80, v80
  v_cvt_f32_i32 v81, v81
  v_cvt_f32_i32 v82, v82
  v_cvt_f32_i32 v83, v83
  v_pk_mul_f32 v[20:21], v[80:81], v[22:23]
  v_pk_add_f32 v[18:19], v[22:23], v[24:25]
  v_pk_fma_f32 v[20:21], v[82:83], v[24:25], v[20:21]
  v_add_f32 v18, v18, v19
  v_add_f32 v20, v20, v21
  s_cmp_gt_i32 s69, -13
  s_cbranch_scc1 L_p42
  s_waitcnt vmcnt(6)
L_p42:
  s_waitcnt vmcnt(9)
  buffer_load_dwordx4 v[68:71], v212, s[32:35], s3 offen nt
  v_add_f32_dpp v35, v18, v18 row_ror:8 row_mask:0xf bank_mask:0xc
  v_add_f32_dpp v35, v20, v20 row_ror:8 row_mask:0xf bank_mask:0x3
  v_dot2_f32_bf16 v22, v189, v60, 0
  v_dot2_f32_bf16 v23, v194, v61, 0
  v_dot2_f32_bf16 v24, v192, v62, 0
  v_dot2_f32_bf16 v25, v195, v63, 0
  v_cvt_f32_i32 v84, v84
  v_cvt_f32_i32 v85, v85
  v_cvt_f32_i32 v86, v86
  v_cvt_f32_i32 v87, v87
  v_pk_mul_f32 v[20:21], v[84:85], v[22:23]
  v_pk_add_f32 v[18:19], v[22:23], v[24:25]
  v_pk_fma_f32 v[20:21], v[86:87], v[24:25], v[20:21]
  v_add_f32 v18, v18, v19
  v_add_f32 v20, v20, v21
  s_cmp_gt_i32 s69, 2
  s_cbranch_scc1 L_p43
  s_waitcnt vmcnt(7)
L_p43:
  s_waitcnt vmcnt(10)
  buffer_load_dwordx4 v[72:75], v213, s[32:35], s3 offen nt
  v_add_f32_dpp v21, v18, v18 row_ror:8 row_mask:0xf bank_mask:0xc
  v_add_f32_dpp v21, v20, v20 row_ror:8 row_mask:0xf bank_mask:0x3
  v_add_f32_dpp v20, v35, v35 row_half_mirror row_mask:0xf bank_mask:0x5
  s_nop 0
  v_add_f32_dpp v20, v21, v21 row_half_mirror row_mask:0xf bank_mask:0xa
  s_nop 1
  v_add_f32_dpp v20, v20, v20 quad_perm:[2,3,0,1] row_mask:0xf bank_mask:0xf
  s_nop 1
  v_add_f32_dpp v20, v20, v20 quad_perm:[1,0,3,2] row_mask:0xf bank_mask:0xf
  v_cndmask_b32_e64 v33, v33, v20, s[50:51]
  s_waitcnt vmcnt(10)
  ds_read_b64 v[200:201], v12 offset:21504
  ds_read_b64 v[202:203], v12 offset:21632
  ds_read_b64 v[204:205], v12 offset:22528
  ds_read_b64 v[206:207], v12 offset:22656
  ds_read_b64 v[208:209], v12 offset:23552
  ds_read_b64 v[210:211], v12 offset:23680
  v_dot2_f32_bf16 v22, v193, v64, 0
  v_dot2_f32_bf16 v23, v198, v65, 0
  v_dot2_f32_bf16 v24, v196, v66, 0
  v_dot2_f32_bf16 v25, v199, v67, 0
  v_cvt_f32_i32 v88, v88
  v_cvt_f32_i32 v89, v89
  v_cvt_f32_i32 v90, v90
  v_cvt_f32_i32 v91, v91
  v_pk_mul_f32 v[20:21], v[88:89], v[22:23]
  v_pk_add_f32 v[18:19], v[22:23], v[24:25]
  v_pk_fma_f32 v[20:21], v[90:91], v[24:25], v[20:21]
  v_add_f32 v18, v18, v19
  v_add_f32 v20, v20, v21
  s_cmp_lt_i32 s69, -25
  s_cbranch_scc0 L_t44
  s_waitcnt vmcnt(7)
L_t44:
  s_cmp_gt_i32 s69, 9
  s_cbranch_scc1 L_p45
  s_waitcnt vmcnt(8)
L_p45:
  s_waitcnt vmcnt(11)
  buffer_load_dwordx4 v[76:79], v214, s[32:35], s3 offen nt
  v_add_f32_dpp v35, v18, v18 row_ror:8 row_mask:0xf bank_mask:0xc
  v_add_f32_dpp v35, v20, v20 row_ror:8 row_mask:0xf bank_mask:0x3
L_it14:
  s_waitcnt lgkmcnt(0)
  ds_read_b32 v4, v14 offset:16
  s_waitcnt vmcnt(8)
  s_add_u32 s44, s78, 0x03030303
  v_msad_u8 v9, s78, v36, 0
  v_msad_u8 v10, s44, v36, 0
  v_msad_u8 v9, s78, v37, v9
  v_msad_u8 v10, s44, v37, v10
  v_msad_u8 v9, s78, v38, v9
  v_msad_u8 v10, s44, v38, v10
  v_sub_u32 v9, v9, v10
  v_mov_b32 v8, s90
  s_add_u32 s78, s78, 0x01010101
  v_readlane_b32 s66, v9, 0
  v_readlane_b32 s67, v9, 1
  s_mov_b64 exec, 1
  global_store_byte v7, v8, s[30:31]
  s_mov_b64 exec, 3
  global_load_dwordx3 v[36:38], v238, s[30:31] sc1
  s_mov_b64 exec, -1
  s_add_u32 s69, s66, s67
  s_add_u32 s44, s69, s95
  s_mov_b32 s95, s69
  s_ashr_i32 s69, s44, 1
  s_add_u32 s69, s69, s91
  s_cmp_lt_u32 s90, 5
  s_cselect_b32 s69, 0, s69
  s_add_u32 s90, s90, 1
  v_perm_b32 v197, v202, v200, s56
  v_perm_b32 v202, v202, v200, s57
  v_perm_b32 v200, v203, v201, s56
  v_perm_b32 v203, v203, v201, s57
  v_dot2_f32_bf16 v22, v197, v44, 0
  v_dot2_f32_bf16 v23, v202, v45, 0
  v_dot2_f32_bf16 v24, v200, v46, 0
  v_dot2_f32_bf16 v25, v203, v47, 0
  v_cvt_f32_i32 v92, v92
  v_cvt_f32_i32 v93, v93
  v_cvt_f32_i32 v94, v94
  v_cvt_f32_i32 v95, v95
  v_pk_mul_f32 v[20:21], v[92:93], v[22:23]
  v_pk_add_f32 v[18:19], v[22:23], v[24:25]
  v_pk_fma_f32 v[20:21], v[94:95], v[24:25], v[20:21]
  v_add_f32 v18, v18, v19
  v_add_f32 v20, v20, v21
  s_cmp_gt_i32 s69, -13
  s_cbranch_scc1 L_p46
  s_waitcnt vmcnt(5)
L_p46:
  s_waitcnt vmcnt(9)
  buffer_load_dwordx4 v[80:83], v215, s[32:35], s3 offen nt
  v_add_f32_dpp v21, v18, v18 row_ror:8 row_mask:0xf bank_mask:0xc
  v_add_f32_dpp v21, v20, v20 row_ror:8 row_mask:0xf bank_mask:0x3
  v_add_f32_dpp v20, v34, v34 row_half_mirror row_mask:0xf bank_mask:0x5
  s_nop 0
  v_add_f32_dpp v20, v21, v21 row_half_mirror row_mask:0xf bank_mask:0xa
  s_nop 1
  v_add_f32_dpp v20, v20, v20 quad_perm:[2,3,0,1] row_mask:0xf bank_mask:0xf
  s_nop 1
  v_add_f32_dpp v20, v20, v20 quad_perm:[1,0,3,2] row_mask:0xf bank_mask:0xf
  v_cndmask_b32_e64 v32, v32, v20, s[52:53]
  v_perm_b32 v201, v206, v204, s56
  v_perm_b32 v206, v206, v204, s57
  v_perm_b32 v204, v207, v205, s56
  v_perm_b32 v207, v207, v205, s57
  v_dot2_f32_bf16 v22, v201, v48, 0
  v_dot2_f32_bf16 v23, v206, v49, 0
  v_dot2_f32_bf16 v24, v204, v50, 0
  v_dot2_f32_bf16 v25, v207, v51, 0
  v_cvt_f32_i32 v96, v96
  v_cvt_f32_i32 v97, v97
  v_cvt_f32_i32 v98, v98
  v_cvt_f32_i32 v99, v99
  v_pk_mul_f32 v[20:21], v[96:97], v[22:23]
  v_pk_add_f32 v[18:19], v[22:23], v[24:25]
  v_pk_fma_f32 v[20:21], v[98:99], v[24:25], v[20:21]
  v_add_f32 v18, v18, v19
  v_add_f32 v20, v20, v21
  s_cmp_gt_i32 s69, 2
  s_cbranch_scc1 L_p47
  s_waitcnt vmcnt(6)
L_p47:
  s_waitcnt vmcnt(10)
  buffer_load_dwordx4 v[84:87], v216, s[32:35], s3 offen nt
  v_add_f32_dpp v34, v18, v18 row_ror:8 row_mask:0xf bank_mask:0xc
  v_add_f32_dpp v34, v20, v20 row_ror:8 row_mask:0xf bank_mask:0x3
  v_perm_b32 v205, v210, v208, s56
  v_perm_b32 v210, v210, v208, s57
  v_perm_b32 v208, v211, v209, s56
  v_perm_b32 v211, v211, v209, s57
  v_dot2_f32_bf16 v22, v205, v52, 0
  v_dot2_f32_bf16 v23, v210, v53, 0
  v_dot2_f32_bf16 v24, v208, v54, 0
  v_dot2_f32_bf16 v25, v211, v55, 0
  v_cvt_f32_i32 v100, v100
  v_cvt_f32_i32 v101, v101
  v_cvt_f32_i32 v102, v102
  v_cvt_f32_i32 v103, v103
  v_pk_mul_f32 v[20:21], v[100:101], v[22:23]
  v_pk_add_f32 v[18:19], v[22:23], v[24:25]
  v_pk_fma_f32 v[20:21], v[102:103], v[24:25], v[20:21]
  v_add_f32 v18, v18, v19
  v_add_f32 v20, v20, v21
  s_cmp_lt_i32 s69, -25
  s_cbranch_scc0 L_t48
  s_waitcnt vmcnt(6)
L_t48:
  s_cmp_gt_i32 s69, 9
  s_cbranch_scc1 L_p49
  s_waitcnt vmcnt(7)
L_p49:
  s_waitcnt vmcnt(11)
  buffer_load_dwordx4 v[88:91], v217, s[32:35], s3 offen nt
  v_add_f32_dpp v21, v18, v18 row_ror:8 row_mask:0xf bank_mask:0xc
  v_add_f32_dpp v21, v20, v20 row_ror:8 row_mask:0xf bank_mask:0x3
  v_add_f32_dpp v20, v34, v34 row_half_mirror row_mask:0xf bank_mask:0x5
  s_nop 0
  v_add_f32_dpp v20, v21, v21 row_half_mirror row_mask:0xf bank_mask:0xa
  s_nop 1
  v_add_f32_dpp v20, v20, v20 quad_perm:[2,3,0,1] row_mask:0xf bank_mask:0xf
  s_nop 1
  v_add_f32_dpp v20, v20, v20 quad_perm:[1,0,3,2] row_mask:0xf bank_mask:0xf
  v_cndmask_b32_e64 v32, v32, v20, s[54:55]
  ds_write_b32 v1, v32 offset:1024
L_it15:
  s_mov_b32 s47, 3
L_q115:
  s_waitcnt lgkmcnt(0)
  v_readfirstlane_b32 s46, v4
  s_cmp_ge_u32 s46, s47
  s_cbranch_scc1 L_q115_ok
  s_cmp_eq_u32 s94, 0
  s_cbranch_scc1 L_q115_ok
  s_sub_u32 s94, s94, 1
  ds_read_b32 v4, v14 offset:16
  s_branch L_q115
L_q115_ok:
  s_waitcnt vmcnt(7)
  v_add3_u32 v9, v26, v27, s58
  s_nop 0
  v_readfirstlane_b32 s91, v9
  s_add_u32 s44, s78, 0x03030303
  v_msad_u8 v9, s78, v40, 0
  v_msad_u8 v10, s44, v40, 0
  v_msad_u8 v9, s78, v41, v9
  v_msad_u8 v10, s44, v41, v10
  v_msad_u8 v9, s78, v42, v9
  v_msad_u8 v10, s44, v42, v10
  v_sub_u32 v9, v9, v10
  v_mov_b32 v8, s90
  s_add_u32 s78, s78, 0x01010101
  v_readlane_b32 s66, v9, 0
  v_readlane_b32 s67, v9, 1
  s_mov_b64 exec, 1
  global_store_byte v7, v8, s[30:31]
  s_mov_b64 exec, 3
  global_load_dwordx3 v[40:42], v239, s[30:31] sc1
  s_mov_b64 exec, -1
  s_add_u32 s69, s66, s67
  s_add_u32 s44, s69, s95
  s_mov_b32 s95, s69
  s_ashr_i32 s69, s44, 1
  s_add_u32 s69, s69, s91
  s_cmp_lt_u32 s90, 5
  s_cselect_b32 s69, 0, s69
  s_add_u32 s90, s90, 1
  v_dot2_f32_bf16 v22, v197, v56, 0
  v_dot2_f32_bf16 v23, v202, v57, 0
  v_dot2_f32_bf16 v24, v200, v58, 0
  v_dot2_f32_bf16 v25, v203, v59, 0
  v_cvt_f32_i32 v104, v104
  v_cvt_f32_i32 v105, v105
  v_cvt_f32_i32 v106, v106
  v_cvt_f32_i32 v107, v107
  ds_read_b128 v[44:47], v15 offset:2560
  v_pk_mul_f32 v[20:21], v[104:105], v[22:23]
  v_pk_add_f32 v[18:19], v[22:23], v[24:25]
  v_pk_fma_f32 v[20:21], v[106:107], v[24:25], v[20:21]
  v_add_f32 v18, v18, v19
  v_add_f32 v20, v20, v21
  s_cmp_gt_i32 s69, -13
  s_cbranch_scc1 L_p50
  s_waitcnt vmcnt(5)
L_p50:
  s_waitcnt vmcnt(8)
  buffer_load_dwordx4 v[92:95], v218, s[32:35], s3 offen nt
  v_add_f32_dpp v21, v18, v18 row_ror:8 row_mask:0xf bank_mask:0xc
  v_add_f32_dpp v21, v20, v20 row_ror:8 row_mask:0xf bank_mask:0x3
  v_add_f32_dpp v20, v35, v35 row_half_mirror row_mask:0xf bank_mask:0x5
  s_nop 0
  v_add_f32_dpp v20, v21, v21 row_half_mirror row_mask:0xf bank_mask:0xa
  s_nop 1
  v_add_f32_dpp v20, v20, v20 quad_perm:[2,3,0,1] row_mask:0xf bank_mask:0xf
  s_nop 1
  v_add_f32_dpp v20, v20, v20 quad_perm:[1,0,3,2] row_mask:0xf bank_mask:0xf
  v_cndmask_b32_e64 v33, v33, v20, s[52:53]
  v_dot2_f32_bf16 v22, v201, v60, 0
  v_dot2_f32_bf16 v23, v206, v61, 0
  v_dot2_f32_bf16 v24, v204, v62, 0
  v_dot2_f32_bf16 v25, v207, v63, 0
  v_cvt_f32_i32 v108, v108
  v_cvt_f32_i32 v109, v109
  v_cvt_f32_i32 v110, v110
  v_cvt_f32_i32 v111, v111
  ds_read_b128 v[48:51], v16 offset:2560
  v_pk_mul_f32 v[20:21], v[108:109], v[22:23]
  v_pk_add_f32 v[18:19], v[22:23], v[24:25]
  v_pk_fma_f32 v[20:21], v[110:111], v[24:25], v[20:21]
  v_add_f32 v18, v18, v19
  v_add_f32 v20, v20, v21
  s_cmp_gt_i32 s69, 2
  s_cbranch_scc1 L_p51
  s_waitcnt vmcnt(6)
L_p51:
  s_waitcnt vmcnt(9)
  buffer_load_dwordx4 v[96:99], v219, s[32:35], s3 offen nt
  v_add_f32_dpp v35, v18, v18 row_ror:8 row_mask:0xf bank_mask:0xc
  v_add_f32_dpp v35, v20, v20 row_ror:8 row_mask:0xf bank_mask:0x3
  v_dot2_f32_bf16 v22, v205, v64, 0
  v_dot2_f32_bf16 v23, v210, v65, 0
  v_dot2_f32_bf16 v24, v208, v66, 0
  v_dot2_f32_bf16 v25, v211, v67, 0
  v_cvt_f32_i32 v112, v112
  v_cvt_f32_i32 v113, v113
  v_cvt_f32_i32 v114, v114
  v_cvt_f32_i32 v115, v115
  ds_read_b128 v[52:55], v17 offset:2560
  v_pk_mul_f32 v[20:21], v[112:113], v[22:23]
  v_pk_add_f32 v[18:19], v[22:23], v[24:25]
  v_pk_fma_f32 v[20:21], v[114:115], v[24:25], v[20:21]
  v_add_f32 v18, v18, v19
  v_add_f32 v20, v20, v21
  s_cmp_lt_i32 s69, -25
  s_cbranch_scc0 L_t52
  s_waitcnt vmcnt(6)
L_t52:
  s_cmp_gt_i32 s69, 9
  s_cbranch_scc1 L_p53
  s_waitcnt vmcnt(7)
L_p53:
  s_waitcnt vmcnt(10)
  buffer_load_dwordx4 v[100:103], v220, s[32:35], s3 offen nt
  v_add_f32_dpp v21, v18, v18 row_ror:8 row_mask:0xf bank_mask:0xc
  v_add_f32_dpp v21, v20, v20 row_ror:8 row_mask:0xf bank_mask:0x3
  v_add_f32_dpp v20, v35, v35 row_half_mirror row_mask:0xf bank_mask:0x5
  s_nop 0
  v_add_f32_dpp v20, v21, v21 row_half_mirror row_mask:0xf bank_mask:0xa
  s_nop 1
  v_add_f32_dpp v20, v20, v20 quad_perm:[2,3,0,1] row_mask:0xf bank_mask:0xf
  s_nop 1
  v_add_f32_dpp v20, v20, v20 quad_perm:[1,0,3,2] row_mask:0xf bank_mask:0xf
  v_cndmask_b32_e64 v33, v33, v20, s[54:55]
  ds_write_b32 v1, v33 offset:4096
  v_mov_b32 v8, 2
  ds_write_b32 v6, v8 offset:0
  v_add_u32 v15, 2048, v15
  v_add_u32 v16, 2048, v16
  v_add_u32 v17, 2048, v17
  s_mov_b32 s43, 2
  s_movk_i32 s101, 6144
  s_mov_b32 s34, 1572864
  s_add_u32 s32, s32, s3
  s_addc_u32 s33, s33, 0
  s_mov_b32 s68, 3
  s_lshl_b32 s44, s68, 2
  s_lshr_b64 s[64:65], s[96:97], s44
  s_and_b32 s64, s64, 15
  s_lshl4_add_u32 s68, s68, s64
  s_mul_i32 s44, s68, 1572864
  s_add_u32 s36, s6, s44
  s_addc_u32 s37, s7, 0
.p2align 6
L_k:
  s_add_u32 s44, s43, 2
  s_min_u32 s47, s44, 16
  v_add_u32 v15, 1024, v15
  v_and_b32 v15, 0xfff, v15
  v_add_u32 v16, 1024, v16
  v_and_b32 v16, 0xfff, v16
  v_add_u32 v17, 1024, v17
  v_and_b32 v17, 0xfff, v17
  v_add_u32 v2, s101, v1
  s_addk_i32 s101, 3072
  s_cmpk_eq_u32 s101, 18432
  s_cselect_b32 s101, 0, s101
  s_waitcnt lgkmcnt(0)
  s_waitcnt vmcnt(8)
  s_add_u32 s44, s78, 0x03030303
  v_msad_u8 v9, s78, v36, 0
  v_msad_u8 v10, s44, v36, 0
  v_msad_u8 v9, s78, v37, v9
  v_msad_u8 v10, s44, v37, v10
  v_msad_u8 v9, s78, v38, v9
  v_msad_u8 v10, s44, v38, v10
  v_sub_u32 v9, v9, v10
  v_mov_b32 v8, s90
  s_add_u32 s78, s78, 0x01010101
  v_readlane_b32 s66, v9, 0
  v_readlane_b32 s67, v9, 1
  s_mov_b64 exec, 1
  global_store_byte v7, v8, s[30:31]
  s_mov_b64 exec, 3
  global_load_dwordx3 v[36:38], v236, s[30:31] sc1
  s_mov_b64 exec, -1
  s_add_u32 s69, s66, s67
  s_add_u32 s44, s69, s95
  s_mov_b32 s95, s69
  s_ashr_i32 s69, s44, 1
  s_add_u32 s69, s69, s91
  s_cmp_lt_u32 s90, 5
  s_cselect_b32 s69, 0, s69
  s_add_u32 s90, s90, 1
  v_dot2_f32_bf16 v22, v13, v44, 0
  v_dot2_f32_bf16 v23, v118, v45, 0
  v_dot2_f32_bf16 v24, v116, v46, 0
  v_dot2_f32_bf16 v25, v119, v47, 0
  v_cvt_f32_i32 v68, v68
  v_cvt_f32_i32 v69, v69
  v_cvt_f32_i32 v70, v70
  v_cvt_f32_i32 v71, v71
  v_pk_mul_f32 v[20:21], v[68:69], v[22:23]
  v_pk_add_f32 v[18:19], v[22:23], v[24:25]
  v_pk_fma_f32 v[20:21], v[70:71], v[24:25], v[20:21]
  v_add_f32 v18, v18, v19
  v_add_f32 v20, v20, v21
  s_cmp_gt_i32 s69, -13
  s_cbranch_scc1 L_p54
  s_waitcnt vmcnt(5)
L_p54:
  s_waitcnt vmcnt(8)
  buffer_load_dwordx4 v[104:107], v221, s[32:35], 0 offen nt
  v_add_f32_dpp v34, v18, v18 row_ror:8 row_mask:0xf bank_mask:0xc
  v_add_f32_dpp v34, v20, v20 row_ror:8 row_mask:0xf bank_mask:0x3
  v_dot2_f32_bf16 v22, v117, v48, 0
  v_dot2_f32_bf16 v23, v122, v49, 0
  v_dot2_f32_bf16 v24, v120, v50, 0
  v_dot2_f32_bf16 v25, v123, v51, 0
  v_cvt_f32_i32 v72, v72
  v_cvt_f32_i32 v73, v73
  v_cvt_f32_i32 v74, v74
  v_cvt_f32_i32 v75, v75
  v_pk_mul_f32 v[20:21], v[72:73], v[22:23]
  v_pk_add_f32 v[18:19], v[22:23], v[24:25]
  v_pk_fma_f32 v[20:21], v[74:75], v[24:25], v[20:21]
  v_add_f32 v18, v18, v19
  v_add_f32 v20, v20, v21
  s_cmp_gt_i32 s69, 2
  s_cbranch_scc1 L_p55
  s_waitcnt vmcnt(6)
L_p55:
  s_waitcnt vmcnt(9)
  buffer_load_dwordx4 v[108:111], v222, s[32:35], 0 offen nt
  v_add_f32_dpp v21, v18, v18 row_ror:8 row_mask:0xf bank_mask:0xc
  v_add_f32_dpp v21, v20, v20 row_ror:8 row_mask:0xf bank_mask:0x3
  v_add_f32_dpp v20, v34, v34 row_half_mirror row_mask:0xf bank_mask:0x5
  s_nop 0
  v_add_f32_dpp v20, v21, v21 row_half_mirror row_mask:0xf bank_mask:0xa
  s_nop 1
  v_add_f32_dpp v20, v20, v20 quad_perm:[2,3,0,1] row_mask:0xf bank_mask:0xf
  s_nop 1
  v_add_f32_dpp v20, v20, v20 quad_perm:[1,0,3,2] row_mask:0xf bank_mask:0xf
  v_cndmask_b32_e64 v32, v32, v20, s[48:49]
  v_dot2_f32_bf16 v22, v121, v52, 0
  v_dot2_f32_bf16 v23, v126, v53, 0
  v_dot2_f32_bf16 v24, v124, v54, 0
  v_dot2_f32_bf16 v25, v127, v55, 0
  v_cvt_f32_i32 v76, v76
  v_cvt_f32_i32 v77, v77
  v_cvt_f32_i32 v78, v78
  v_cvt_f32_i32 v79, v79
  v_pk_mul_f32 v[20:21], v[76:77], v[22:23]
  v_pk_add_f32 v[18:19], v[22:23], v[24:25]
  v_pk_fma_f32 v[20:21], v[78:79], v[24:25], v[20:21]
  v_add_f32 v18, v18, v19
  v_add_f32 v20, v20, v21
  s_cmp_lt_i32 s69, -25
  s_cbranch_scc0 L_t56
  s_waitcnt vmcnt(6)
L_t56:
  s_cmp_gt_i32 s69, 9
  s_cbranch_scc1 L_p57
  s_waitcnt vmcnt(7)
L_p57:
  s_waitcnt vmcnt(10)
  buffer_load_dwordx4 v[112:115], v223, s[32:35], 0 offen nt
  v_add_f32_dpp v34, v18, v18 row_ror:8 row_mask:0xf bank_mask:0xc
  v_add_f32_dpp v34, v20, v20 row_ror:8 row_mask:0xf bank_mask:0x3
  s_waitcnt vmcnt(8)
  s_add_u32 s44, s78, 0x03030303
  v_msad_u8 v9, s78, v40, 0
  v_msad_u8 v10, s44, v40, 0
  v_msad_u8 v9, s78, v41, v9
  v_msad_u8 v10, s44, v41, v10
  v_msad_u8 v9, s78, v42, v9
  v_msad_u8 v10, s44, v42, v10
  v_sub_u32 v9, v9, v10
  v_mov_b32 v8, s90
  s_add_u32 s78, s78, 0x01010101
  v_readlane_b32 s66, v9, 0
  v_readlane_b32 s67, v9, 1
  s_mov_b64 exec, 1
  global_store_byte v7, v8, s[30:31]
  s_mov_b64 exec, 3
  global_load_dwordx3 v[40:42], v237, s[30:31] sc1
  s_mov_b64 exec, -1
  s_add_u32 s69, s66, s67
  s_add_u32 s44, s69, s95
  s_mov_b32 s95, s69
  s_ashr_i32 s69, s44, 1
  s_add_u32 s69, s69, s91
  s_cmp_lt_u32 s90, 5
  s_cselect_b32 s69, 0, s69
  s_add_u32 s90, s90, 1
  v_dot2_f32_bf16 v22, v125, v44, 0
  v_dot2_f32_bf16 v23, v130, v45, 0
  v_dot2_f32_bf16 v24, v128, v46, 0
  v_dot2_f32_bf16 v25, v131, v47, 0
  v_cvt_f32_i32 v80, v80
  v_cvt_f32_i32 v81, v81
  v_cvt_f32_i32 v82, v82
  v_cvt_f32_i32 v83, v83
  v_pk_mul_f32 v[20:21], v[80:81], v[22:23]
  v_pk_add_f32 v[18:19], v[22:23], v[24:25]
  v_pk_fma_f32 v[20:21], v[82:83], v[24:25], v[20:21]
  v_add_f32 v18, v18, v19
  v_add_f32 v20, v20, v21
  s_cmp_gt_i32 s69, -13
  s_cbranch_scc1 L_p58
  s_waitcnt vmcnt(5)
L_p58:
  s_waitcnt vmcnt(8)
  buffer_load_dwordx4 v[68:71], v224, s[32:35], 0 offen nt
  v_add_f32_dpp v21, v18, v18 row_ror:8 row_mask:0xf bank_mask:0xc
  v_add_f32_dpp v21, v20, v20 row_ror:8 row_mask:0xf bank_mask:0x3
  v_add_f32_dpp v20, v34, v34 row_half_mirror row_mask:0xf bank_mask:0x5
  s_nop 0
  v_add_f32_dpp v20, v21, v21 row_half_mirror row_mask:0xf bank_mask:0xa
  s_nop 1
  v_add_f32_dpp v20, v20, v20 quad_perm:[2,3,0,1] row_mask:0xf bank_mask:0xf
  s_nop 1
  v_add_f32_dpp v20, v20, v20 quad_perm:[1,0,3,2] row_mask:0xf bank_mask:0xf
  v_cndmask_b32_e64 v32, v32, v20, s[50:51]
  v_dot2_f32_bf16 v22, v129, v48, 0
  v_dot2_f32_bf16 v23, v134, v49, 0
  v_dot2_f32_bf16 v24, v132, v50, 0
  v_dot2_f32_bf16 v25, v135, v51, 0
  v_cvt_f32_i32 v84, v84
  v_cvt_f32_i32 v85, v85
  v_cvt_f32_i32 v86, v86
  v_cvt_f32_i32 v87, v87
  v_pk_mul_f32 v[20:21], v[84:85], v[22:23]
  v_pk_add_f32 v[18:19], v[22:23], v[24:25]
  v_pk_fma_f32 v[20:21], v[86:87], v[24:25], v[20:21]
  v_add_f32 v18, v18, v19
  v_add_f32 v20, v20, v21
  s_cmp_gt_i32 s69, 2
  s_cbranch_scc1 L_p59
  s_waitcnt vmcnt(6)
L_p59:
  s_waitcnt vmcnt(9)
  buffer_load_dwordx4 v[72:75], v225, s[32:35], 0 offen nt
  v_add_f32_dpp v34, v18, v18 row_ror:8 row_mask:0xf bank_mask:0xc
  v_add_f32_dpp v34, v20, v20 row_ror:8 row_mask:0xf bank_mask:0x3
  v_dot2_f32_bf16 v22, v133, v52, 0
  v_dot2_f32_bf16 v23, v138, v53, 0
  v_dot2_f32_bf16 v24, v136, v54, 0
  v_dot2_f32_bf16 v25, v139, v55, 0
  v_cvt_f32_i32 v88, v88
  v_cvt_f32_i32 v89, v89
  v_cvt_f32_i32 v90, v90
  v_cvt_f32_i32 v91, v91
  v_pk_mul_f32 v[20:21], v[88:89], v[22:23]
  v_pk_add_f32 v[18:19], v[22:23], v[24:25]
  v_pk_fma_f32 v[20:21], v[90:91], v[24:25], v[20:21]
  v_add_f32 v18, v18, v19
  v_add_f32 v20, v20, v21
  s_cmp_lt_i32 s69, -25
  s_cbranch_scc0 L_t60
  s_waitcnt vmcnt(6)
L_t60:
  s_cmp_gt_i32 s69, 9
  s_cbranch_scc1 L_p61
  s_waitcnt vmcnt(7)
L_p61:
  s_waitcnt vmcnt(10)
  buffer_load_dwordx4 v[76:79], v226, s[32:35], 0 offen nt
  v_add_f32_dpp v21, v18, v18 row_ror:8 row_mask:0xf bank_mask:0xc
  v_add_f32_dpp v21, v20, v20 row_ror:8 row_mask:0xf bank_mask:0x3
  v_add_f32_dpp v20, v34, v34 row_half_mirror row_mask:0xf bank_mask:0x5
  s_nop 0
  v_add_f32_dpp v20, v21, v21 row_half_mirror row_mask:0xf bank_mask:0xa
  s_nop 1
  v_add_f32_dpp v20, v20, v20 quad_perm:[2,3,0,1] row_mask:0xf bank_mask:0xf
  s_nop 1
  v_add_f32_dpp v20, v20, v20 quad_perm:[1,0,3,2] row_mask:0xf bank_mask:0xf
  v_cndmask_b32_e64 v32, v32, v20, s[52:53]
  s_waitcnt vmcnt(8)
  s_add_u32 s44, s78, 0x03030303
  v_msad_u8 v9, s78, v36, 0
  v_msad_u8 v10, s44, v36, 0
  v_msad_u8 v9, s78, v37, v9
  v_msad_u8 v10, s44, v37, v10
  v_msad_u8 v9, s78, v38, v9
  v_msad_u8 v10, s44, v38, v10
  v_sub_u32 v9, v9, v10
  v_mov_b32 v8, s90
  s_add_u32 s78, s78, 0x01010101
  v_readlane_b32 s66, v9, 0
  v_readlane_b32 s67, v9, 1
  s_mov_b64 exec, 1
  global_store_byte v7, v8, s[30:31]
  s_mov_b64 exec, 3
  global_load_dwordx3 v[36:38], v238, s[30:31] sc1
  s_mov_b64 exec, -1
  s_add_u32 s69, s66, s67
  s_add_u32 s44, s69, s95
  s_mov_b32 s95, s69
  s_ashr_i32 s69, s44, 1
  s_add_u32 s69, s69, s91
  s_cmp_lt_u32 s90, 5
  s_cselect_b32 s69, 0, s69
  s_add_u32 s90, s90, 1
  v_dot2_f32_bf16 v22, v137, v44, 0
  v_dot2_f32_bf16 v23, v142, v45, 0
  v_dot2_f32_bf16 v24, v140, v46, 0
  v_dot2_f32_bf16 v25, v143, v47, 0
  v_cvt_f32_i32 v92, v92
  v_cvt_f32_i32 v93, v93
  v_cvt_f32_i32 v94, v94
  v_cvt_f32_i32 v95, v95
  v_pk_mul_f32 v[20:21], v[92:93], v[22:23]
  v_pk_add_f32 v[18:19], v[22:23], v[24:25]
  v_pk_fma_f32 v[20:21], v[94:95], v[24:25], v[20:21]
  v_add_f32 v18, v18, v19
  v_add_f32 v20, v20, v21
  s_cmp_gt_i32 s69, -13
  s_cbranch_scc1 L_p62
  s_waitcnt vmcnt(5)
L_p62:
  s_waitcnt vmcnt(8)
  buffer_load_dwordx4 v[80:83], v227, s[32:35], 0 offen nt
  v_add_f32_dpp v34, v18, v18 row_ror:8 row_mask:0xf bank_mask:0xc
  v_add_f32_dpp v34, v20, v20 row_ror:8 row_mask:0xf bank_mask:0x3
  v_dot2_f32_bf16 v22, v141, v48, 0
  v_dot2_f32_bf16 v23, v146, v49, 0
  v_dot2_f32_bf16 v24, v144, v50, 0
  v_dot2_f32_bf16 v25, v147, v51, 0
  v_cvt_f32_i32 v96, v96
  v_cvt_f32_i32 v97, v97
  v_cvt_f32_i32 v98, v98
  v_cvt_f32_i32 v99, v99
  v_pk_mul_f32 v[20:21], v[96:97], v[22:23]
  v_pk_add_f32 v[18:19], v[22:23], v[24:25]
  v_pk_fma_f32 v[20:21], v[98:99], v[24:25], v[20:21]
  v_add_f32 v18, v18, v19
  v_add_f32 v20, v20, v21
  s_cmp_gt_i32 s69, 2
  s_cbranch_scc1 L_p63
  s_waitcnt vmcnt(6)
L_p63:
  s_waitcnt vmcnt(9)
  buffer_load_dwordx4 v[84:87], v228, s[32:35], 0 offen nt
  v_add_f32_dpp v21, v18, v18 row_ror:8 row_mask:0xf bank_mask:0xc
  v_add_f32_dpp v21, v20, v20 row_ror:8 row_mask:0xf bank_mask:0x3
  v_add_f32_dpp v20, v34, v34 row_half_mirror row_mask:0xf bank_mask:0x5
  s_nop 0
  v_add_f32_dpp v20, v21, v21 row_half_mirror row_mask:0xf bank_mask:0xa
  s_nop 1
  v_add_f32_dpp v20, v20, v20 quad_perm:[2,3,0,1] row_mask:0xf bank_mask:0xf
  s_nop 1
  v_add_f32_dpp v20, v20, v20 quad_perm:[1,0,3,2] row_mask:0xf bank_mask:0xf
  v_cndmask_b32_e64 v32, v32, v20, s[54:55]
  ds_write_b32 v2, v32 offset:0
  v_dot2_f32_bf16 v22, v145, v52, 0
  v_dot2_f32_bf16 v23, v150, v53, 0
  v_dot2_f32_bf16 v24, v148, v54, 0
  v_dot2_f32_bf16 v25, v151, v55, 0
  v_cvt_f32_i32 v100, v100
  v_cvt_f32_i32 v101, v101
  v_cvt_f32_i32 v102, v102
  v_cvt_f32_i32 v103, v103
  v_pk_mul_f32 v[20:21], v[100:101], v[22:23]
  v_pk_add_f32 v[18:19], v[22:23], v[24:25]
  v_pk_fma_f32 v[20:21], v[102:103], v[24:25], v[20:21]
  v_add_f32 v18, v18, v19
  v_add_f32 v20, v20, v21
  s_cmp_lt_i32 s69, -25
  s_cbranch_scc0 L_t64
  s_waitcnt vmcnt(6)
L_t64:
  s_cmp_gt_i32 s69, 9
  s_cbranch_scc1 L_p65
  s_waitcnt vmcnt(7)
L_p65:
  s_waitcnt vmcnt(10)
  buffer_load_dwordx4 v[88:91], v229, s[32:35], 0 offen nt
  v_add_f32_dpp v34, v18, v18 row_ror:8 row_mask:0xf bank_mask:0xc
  v_add_f32_dpp v34, v20, v20 row_ror:8 row_mask:0xf bank_mask:0x3
  s_waitcnt vmcnt(8)
  s_add_u32 s44, s78, 0x03030303
  v_msad_u8 v9, s78, v40, 0
  v_msad_u8 v10, s44, v40, 0
  v_msad_u8 v9, s78, v41, v9
  v_msad_u8 v10, s44, v41, v10
  v_msad_u8 v9, s78, v42, v9
  v_msad_u8 v10, s44, v42, v10
  v_sub_u32 v9, v9, v10
  v_mov_b32 v8, s90
  s_add_u32 s78, s78, 0x01010101
  v_readlane_b32 s66, v9, 0
  v_readlane_b32 s67, v9, 1
  s_mov_b64 exec, 1
  global_store_byte v7, v8, s[30:31]
  s_mov_b64 exec, 3
  global_load_dwordx3 v[40:42], v239, s[30:31] sc1
  s_mov_b64 exec, -1
  s_add_u32 s69, s66, s67
  s_add_u32 s44, s69, s95
  s_mov_b32 s95, s69
  s_ashr_i32 s69, s44, 1
  s_add_u32 s69, s69, s91
  s_cmp_lt_u32 s90, 5
  s_cselect_b32 s69, 0, s69
  s_add_u32 s90, s90, 1
  v_dot2_f32_bf16 v22, v149, v44, 0
  v_dot2_f32_bf16 v23, v154, v45, 0
  v_dot2_f32_bf16 v24, v152, v46, 0
  v_dot2_f32_bf16 v25, v155, v47, 0
  v_cvt_f32_i32 v104, v104
  v_cvt_f32_i32 v105, v105
  v_cvt_f32_i32 v106, v106
  v_cvt_f32_i32 v107, v107
  v_pk_mul_f32 v[20:21], v[104:105], v[22:23]
  v_pk_add_f32 v[18:19], v[22:23], v[24:25]
  v_pk_fma_f32 v[20:21], v[106:107], v[24:25], v[20:21]
  v_add_f32 v18, v18, v19
  v_add_f32 v20, v20, v21
  s_cmp_gt_i32 s69, -13
  s_cbranch_scc1 L_p66
  s_waitcnt vmcnt(5)
L_p66:
  s_waitcnt vmcnt(8)
  buffer_load_dwordx4 v[92:95], v230, s[32:35], 0 offen nt
  v_add_f32_dpp v21, v18, v18 row_ror:8 row_mask:0xf bank_mask:0xc
  v_add_f32_dpp v21, v20, v20 row_ror:8 row_mask:0xf bank_mask:0x3
  v_add_f32_dpp v20, v34, v34 row_half_mirror row_mask:0xf bank_mask:0x5
  s_nop 0
  v_add_f32_dpp v20, v21, v21 row_half_mirror row_mask:0xf bank_mask:0xa
  s_nop 1
  v_add_f32_dpp v20, v20, v20 quad_perm:[2,3,0,1] row_mask:0xf bank_mask:0xf
  s_nop 1
  v_add_f32_dpp v20, v20, v20 quad_perm:[1,0,3,2] row_mask:0xf bank_mask:0xf
  v_cndmask_b32_e64 v32, v32, v20, s[48:49]
  v_dot2_f32_bf16 v22, v153, v48, 0
  v_dot2_f32_bf16 v23, v158, v49, 0
  v_dot2_f32_bf16 v24, v156, v50, 0
  v_dot2_f32_bf16 v25, v159, v51, 0
  v_cvt_f32_i32 v108, v108
  v_cvt_f32_i32 v109, v109
  v_cvt_f32_i32 v110, v110
  v_cvt_f32_i32 v111, v111
  v_pk_mul_f32 v[20:21], v[108:109], v[22:23]
  v_pk_add_f32 v[18:19], v[22:23], v[24:25]
  v_pk_fma_f32 v[20:21], v[110:111], v[24:25], v[20:21]
  v_add_f32 v18, v18, v19
  v_add_f32 v20, v20, v21
  s_cmp_gt_i32 s69, 2
  s_cbranch_scc1 L_p67
  s_waitcnt vmcnt(6)
L_p67:
  s_waitcnt vmcnt(9)
  buffer_load_dwordx4 v[96:99], v231, s[32:35], 0 offen nt
  v_add_f32_dpp v34, v18, v18 row_ror:8 row_mask:0xf bank_mask:0xc
  v_add_f32_dpp v34, v20, v20 row_ror:8 row_mask:0xf bank_mask:0x3
  v_dot2_f32_bf16 v22, v157, v52, 0
  v_dot2_f32_bf16 v23, v162, v53, 0
  v_dot2_f32_bf16 v24, v160, v54, 0
  v_dot2_f32_bf16 v25, v163, v55, 0
  v_cvt_f32_i32 v112, v112
  v_cvt_f32_i32 v113, v113
  v_cvt_f32_i32 v114, v114
  v_cvt_f32_i32 v115, v115
  v_pk_mul_f32 v[20:21], v[112:113], v[22:23]
  v_pk_add_f32 v[18:19], v[22:23], v[24:25]
  v_pk_fma_f32 v[20:21], v[114:115], v[24:25], v[20:21]
  v_add_f32 v18, v18, v19
  v_add_f32 v20, v20, v21
  s_cmp_lt_i32 s69, -25
  s_cbranch_scc0 L_t68
  s_waitcnt vmcnt(6)
L_t68:
  s_cmp_gt_i32 s69, 9
  s_cbranch_scc1 L_p69
  s_waitcnt vmcnt(7)
L_p69:
  s_waitcnt vmcnt(10)
  buffer_load_dwordx4 v[100:103], v232, s[32:35], 0 offen nt
  v_add_f32_dpp v21, v18, v18 row_ror:8 row_mask:0xf bank_mask:0xc
  v_add_f32_dpp v21, v20, v20 row_ror:8 row_mask:0xf bank_mask:0x3
  v_add_f32_dpp v20, v34, v34 row_half_mirror row_mask:0xf bank_mask:0x5
  s_nop 0
  v_add_f32_dpp v20, v21, v21 row_half_mirror row_mask:0xf bank_mask:0xa
  s_nop 1
  v_add_f32_dpp v20, v20, v20 quad_perm:[2,3,0,1] row_mask:0xf bank_mask:0xf
  s_nop 1
  v_add_f32_dpp v20, v20, v20 quad_perm:[1,0,3,2] row_mask:0xf bank_mask:0xf
  v_cndmask_b32_e64 v32, v32, v20, s[50:51]
  s_waitcnt vmcnt(8)
  s_add_u32 s44, s78, 0x03030303
  v_msad_u8 v9, s78, v36, 0
  v_msad_u8 v10, s44, v36, 0
  v_msad_u8 v9, s78, v37, v9
  v_msad_u8 v10, s44, v37, v10
  v_msad_u8 v9, s78, v38, v9
  v_msad_u8 v10, s44, v38, v10
  v_sub_u32 v9, v9, v10
  v_mov_b32 v8, s90
  s_add_u32 s78, s78, 0x01010101
  v_readlane_b32 s66, v9, 0
  v_readlane_b32 s67, v9, 1
  s_mov_b64 exec, 1
  global_store_byte v7, v8, s[30:31]
  s_mov_b64 exec, 3
  global_load_dwordx3 v[36:38], v236, s[30:31] sc1
  s_mov_b64 exec, -1
  s_add_u32 s69, s66, s67
  s_add_u32 s44, s69, s95
  s_mov_b32 s95, s69
  s_ashr_i32 s69, s44, 1
  s_add_u32 s69, s69, s91
  s_cmp_lt_u32 s90, 5
  s_cselect_b32 s69, 0, s69
  s_add_u32 s90, s90, 1
  v_dot2_f32_bf16 v22, v161, v44, 0
  v_dot2_f32_bf16 v23, v166, v45, 0
  v_dot2_f32_bf16 v24, v164, v46, 0
  v_dot2_f32_bf16 v25, v167, v47, 0
  v_cvt_f32_i32 v68, v68
  v_cvt_f32_i32 v69, v69
  v_cvt_f32_i32 v70, v70
  v_cvt_f32_i32 v71, v71
  v_pk_mul_f32 v[20:21], v[68:69], v[22:23]
  v_pk_add_f32 v[18:19], v[22:23], v[24:25]
  v_pk_fma_f32 v[20:21], v[70:71], v[24:25], v[20:21]
  v_add_f32 v18, v18, v19
  v_add_f32 v20, v20, v21
  s_cmp_gt_i32 s69, -13
  s_cbranch_scc1 L_p70
  s_waitcnt vmcnt(5)
L_p70:
  s_waitcnt vmcnt(8)
  buffer_load_dwordx4 v[104:107], v233, s[32:35], 0 offen nt
  v_add_f32_dpp v34, v18, v18 row_ror:8 row_mask:0xf bank_mask:0xc
  v_add_f32_dpp v34, v20, v20 row_ror:8 row_mask:0xf bank_mask:0x3
  v_dot2_f32_bf16 v22, v165, v48, 0
  v_dot2_f32_bf16 v23, v170, v49, 0
  v_dot2_f32_bf16 v24, v168, v50, 0
  v_dot2_f32_bf16 v25, v171, v51, 0
  v_cvt_f32_i32 v72, v72
  v_cvt_f32_i32 v73, v73
  v_cvt_f32_i32 v74, v74
  v_cvt_f32_i32 v75, v75
  v_pk_mul_f32 v[20:21], v[72:73], v[22:23]
  v_pk_add_f32 v[18:19], v[22:23], v[24:25]
  v_pk_fma_f32 v[20:21], v[74:75], v[24:25], v[20:21]
  v_add_f32 v18, v18, v19
  v_add_f32 v20, v20, v21
  s_cmp_gt_i32 s69, 2
  s_cbranch_scc1 L_p71
  s_waitcnt vmcnt(6)
L_p71:
  s_waitcnt vmcnt(9)
  buffer_load_dwordx4 v[108:111], v234, s[32:35], 0 offen nt
  v_add_f32_dpp v21, v18, v18 row_ror:8 row_mask:0xf bank_mask:0xc
  v_add_f32_dpp v21, v20, v20 row_ror:8 row_mask:0xf bank_mask:0x3
  v_add_f32_dpp v20, v34, v34 row_half_mirror row_mask:0xf bank_mask:0x5
  s_nop 0
  v_add_f32_dpp v20, v21, v21 row_half_mirror row_mask:0xf bank_mask:0xa
  s_nop 1
  v_add_f32_dpp v20, v20, v20 quad_perm:[2,3,0,1] row_mask:0xf bank_mask:0xf
  s_nop 1
  v_add_f32_dpp v20, v20, v20 quad_perm:[1,0,3,2] row_mask:0xf bank_mask:0xf
  v_cndmask_b32_e64 v32, v32, v20, s[52:53]
  v_dot2_f32_bf16 v22, v169, v52, 0
  v_dot2_f32_bf16 v23, v174, v53, 0
  v_dot2_f32_bf16 v24, v172, v54, 0
  v_dot2_f32_bf16 v25, v175, v55, 0
  v_cvt_f32_i32 v76, v76
  v_cvt_f32_i32 v77, v77
  v_cvt_f32_i32 v78, v78
  v_cvt_f32_i32 v79, v79
  v_pk_mul_f32 v[20:21], v[76:77], v[22:23]
  v_pk_add_f32 v[18:19], v[22:23], v[24:25]
  v_pk_fma_f32 v[20:21], v[78:79], v[24:25], v[20:21]
  v_add_f32 v18, v18, v19
  v_add_f32 v20, v20, v21
  s_cmp_lt_i32 s69, -25
  s_cbranch_scc0 L_t72
  s_waitcnt vmcnt(6)
L_t72:
  s_cmp_gt_i32 s69, 9
  s_cbranch_scc1 L_p73
  s_waitcnt vmcnt(7)
L_p73:
  s_waitcnt vmcnt(10)
  buffer_load_dwordx4 v[112:115], v235, s[32:35], 0 offen nt
  v_add_f32_dpp v34, v18, v18 row_ror:8 row_mask:0xf bank_mask:0xc
  v_add_f32_dpp v34, v20, v20 row_ror:8 row_mask:0xf bank_mask:0x3
  s_mov_b64 exec, 1
  global_load_dwordx2 v[26:27], v11, s[30:31] sc1
  s_mov_b64 exec, -1
  s_waitcnt vmcnt(9)
  s_add_u32 s44, s78, 0x03030303
  v_msad_u8 v9, s78, v40, 0
  v_msad_u8 v10, s44, v40, 0
  v_msad_u8 v9, s78, v41, v9
  v_msad_u8 v10, s44, v41, v10
  v_msad_u8 v9, s78, v42, v9
  v_msad_u8 v10, s44, v42, v10
  v_sub_u32 v9, v9, v10
  v_mov_b32 v8, s90
  s_add_u32 s78, s78, 0x01010101
  v_readlane_b32 s66, v9, 0
  v_readlane_b32 s67, v9, 1
  s_mov_b64 exec, 1
  global_store_byte v7, v8, s[30:31]
  s_mov_b64 exec, 3
  global_load_dwordx3 v[40:42], v237, s[30:31] sc1
  s_mov_b64 exec, -1
  s_add_u32 s69, s66, s67
  s_add_u32 s44, s69, s95
  s_mov_b32 s95, s69
  s_ashr_i32 s69, s44, 1
  s_add_u32 s69, s69, s91
  s_cmp_lt_u32 s90, 5
  s_cselect_b32 s69, 0, s69
  s_add_u32 s90, s90, 1
  v_dot2_f32_bf16 v22, v173, v44, 0
  v_dot2_f32_bf16 v23, v178, v45, 0
  v_dot2_f32_bf16 v24, v176, v46, 0
  v_dot2_f32_bf16 v25, v179, v47, 0
  v_cvt_f32_i32 v80, v80
  v_cvt_f32_i32 v81, v81
  v_cvt_f32_i32 v82, v82
  v_cvt_f32_i32 v83, v83
  v_pk_mul_f32 v[20:21], v[80:81], v[22:23]
  v_pk_add_f32 v[18:19], v[22:23], v[24:25]
  v_pk_fma_f32 v[20:21], v[82:83], v[24:25], v[20:21]
  v_add_f32 v18, v18, v19
  v_add_f32 v20, v20, v21
  s_cmp_gt_i32 s69, -13
  s_cbranch_scc1 L_p74
  s_waitcnt vmcnt(6)
L_p74:
  s_waitcnt vmcnt(9)
  buffer_load_dwordx4 v[68:71], v212, s[36:39], 0 offen nt
  v_add_f32_dpp v21, v18, v18 row_ror:8 row_mask:0xf bank_mask:0xc
  v_add_f32_dpp v21, v20, v20 row_ror:8 row_mask:0xf bank_mask:0x3
  v_add_f32_dpp v20, v34, v34 row_half_mirror row_mask:0xf bank_mask:0x5
  s_nop 0
  v_add_f32_dpp v20, v21, v21 row_half_mirror row_mask:0xf bank_mask:0xa
  s_nop 1
  v_add_f32_dpp v20, v20, v20 quad_perm:[2,3,0,1] row_mask:0xf bank_mask:0xf
  s_nop 1
  v_add_f32_dpp v20, v20, v20 quad_perm:[1,0,3,2] row_mask:0xf bank_mask:0xf
  v_cndmask_b32_e64 v32, v32, v20, s[54:55]
  ds_write_b32 v2, v32 offset:512
  v_dot2_f32_bf16 v22, v177, v48, 0
  v_dot2_f32_bf16 v23, v182, v49, 0
  v_dot2_f32_bf16 v24, v180, v50, 0
  v_dot2_f32_bf16 v25, v183, v51, 0
  v_cvt_f32_i32 v84, v84
  v_cvt_f32_i32 v85, v85
  v_cvt_f32_i32 v86, v86
  v_cvt_f32_i32 v87, v87
  v_pk_mul_f32 v[20:21], v[84:85], v[22:23]
  v_pk_add_f32 v[18:19], v[22:23], v[24:25]
  v_pk_fma_f32 v[20:21], v[86:87], v[24:25], v[20:21]
  v_add_f32 v18, v18, v19
  v_add_f32 v20, v20, v21
  s_cmp_gt_i32 s69, 2
  s_cbranch_scc1 L_p75
  s_waitcnt vmcnt(7)
L_p75:
  s_waitcnt vmcnt(10)
  buffer_load_dwordx4 v[72:75], v213, s[36:39], 0 offen nt
  v_add_f32_dpp v34, v18, v18 row_ror:8 row_mask:0xf bank_mask:0xc
  v_add_f32_dpp v34, v20, v20 row_ror:8 row_mask:0xf bank_mask:0x3
  v_dot2_f32_bf16 v22, v181, v52, 0
  v_dot2_f32_bf16 v23, v186, v53, 0
  v_dot2_f32_bf16 v24, v184, v54, 0
  v_dot2_f32_bf16 v25, v187, v55, 0
  v_cvt_f32_i32 v88, v88
  v_cvt_f32_i32 v89, v89
  v_cvt_f32_i32 v90, v90
  v_cvt_f32_i32 v91, v91
  v_pk_mul_f32 v[20:21], v[88:89], v[22:23]
  v_pk_add_f32 v[18:19], v[22:23], v[24:25]
  v_pk_fma_f32 v[20:21], v[90:91], v[24:25], v[20:21]
  v_add_f32 v18, v18, v19
  v_add_f32 v20, v20, v21
  s_cmp_lt_i32 s69, -25
  s_cbranch_scc0 L_t76
  s_waitcnt vmcnt(7)
L_t76:
  s_cmp_gt_i32 s69, 9
  s_cbranch_scc1 L_p77
  s_waitcnt vmcnt(8)
L_p77:
  s_waitcnt vmcnt(11)
  buffer_load_dwordx4 v[76:79], v214, s[36:39], 0 offen nt
  v_add_f32_dpp v21, v18, v18 row_ror:8 row_mask:0xf bank_mask:0xc
  v_add_f32_dpp v21, v20, v20 row_ror:8 row_mask:0xf bank_mask:0x3
  v_add_f32_dpp v20, v34, v34 row_half_mirror row_mask:0xf bank_mask:0x5
  s_nop 0
  v_add_f32_dpp v20, v21, v21 row_half_mirror row_mask:0xf bank_mask:0xa
  s_nop 1
  v_add_f32_dpp v20, v20, v20 quad_perm:[2,3,0,1] row_mask:0xf bank_mask:0xf
  s_nop 1
  v_add_f32_dpp v20, v20, v20 quad_perm:[1,0,3,2] row_mask:0xf bank_mask:0xf
  v_cndmask_b32_e64 v32, v32, v20, s[48:49]
  ds_read_b32 v4, v14 offset:16
  s_waitcnt vmcnt(9)
  s_add_u32 s44, s78, 0x03030303
  v_msad_u8 v9, s78, v36, 0
  v_msad_u8 v10, s44, v36, 0
  v_msad_u8 v9, s78, v37, v9
  v_msad_u8 v10, s44, v37, v10
  v_msad_u8 v9, s78, v38, v9
  v_msad_u8 v10, s44, v38, v10
  v_sub_u32 v9, v9, v10
  v_mov_b32 v8, s90
  s_add_u32 s78, s78, 0x01010101
  v_readlane_b32 s66, v9, 0
  v_readlane_b32 s67, v9, 1
  s_mov_b64 exec, 1
  global_store_byte v7, v8, s[30:31]
  s_mov_b64 exec, 3
  global_load_dwordx3 v[36:38], v238, s[30:31] sc1
  s_mov_b64 exec, -1
  s_add_u32 s69, s66, s67
  s_add_u32 s44, s69, s95
  s_mov_b32 s95, s69
  s_ashr_i32 s69, s44, 1
  s_add_u32 s69, s69, s91
  s_cmp_lt_u32 s90, 5
  s_cselect_b32 s69, 0, s69
  s_add_u32 s90, s90, 1
  v_dot2_f32_bf16 v22, v185, v44, 0
  v_dot2_f32_bf16 v23, v190, v45, 0
  v_dot2_f32_bf16 v24, v188, v46, 0
  v_dot2_f32_bf16 v25, v191, v47, 0
  v_cvt_f32_i32 v92, v92
  v_cvt_f32_i32 v93, v93
  v_cvt_f32_i32 v94, v94
  v_cvt_f32_i32 v95, v95
  v_pk_mul_f32 v[20:21], v[92:93], v[22:23]
  v_pk_add_f32 v[18:19], v[22:23], v[24:25]
  v_pk_fma_f32 v[20:21], v[94:95], v[24:25], v[20:21]
  v_add_f32 v18, v18, v19
  v_add_f32 v20, v20, v21
  s_cmp_gt_i32 s69, -13
  s_cbranch_scc1 L_p78
  s_waitcnt vmcnt(5)
L_p78:
  s_waitcnt vmcnt(9)
  buffer_load_dwordx4 v[80:83], v215, s[36:39], 0 offen nt
  v_add_f32_dpp v34, v18, v18 row_ror:8 row_mask:0xf bank_mask:0xc
  v_add_f32_dpp v34, v20, v20 row_ror:8 row_mask:0xf bank_mask:0x3
  v_dot2_f32_bf16 v22, v189, v48, 0
  v_dot2_f32_bf16 v23, v194, v49, 0
  v_dot2_f32_bf16 v24, v192, v50, 0
  v_dot2_f32_bf16 v25, v195, v51, 0
  v_cvt_f32_i32 v96, v96
  v_cvt_f32_i32 v97, v97
  v_cvt_f32_i32 v98, v98
  v_cvt_f32_i32 v99, v99
  v_pk_mul_f32 v[20:21], v[96:97], v[22:23]
  v_pk_add_f32 v[18:19], v[22:23], v[24:25]
  v_pk_fma_f32 v[20:21], v[98:99], v[24:25], v[20:21]
  v_add_f32 v18, v18, v19
  v_add_f32 v20, v20, v21
  s_cmp_gt_i32 s69, 2
  s_cbranch_scc1 L_p79
  s_waitcnt vmcnt(6)
L_p79:
  s_waitcnt vmcnt(10)
  buffer_load_dwordx4 v[84:87], v216, s[36:39], 0 offen nt
  v_add_f32_dpp v21, v18, v18 row_ror:8 row_mask:0xf bank_mask:0xc
  v_add_f32_dpp v21, v20, v20 row_ror:8 row_mask:0xf bank_mask:0x3
  v_add_f32_dpp v20, v34, v34 row_half_mirror row_mask:0xf bank_mask:0x5
  s_nop 0
  v_add_f32_dpp v20, v21, v21 row_half_mirror row_mask:0xf bank_mask:0xa
  s_nop 1
  v_add_f32_dpp v20, v20, v20 quad_perm:[2,3,0,1] row_mask:0xf bank_mask:0xf
  s_nop 1
  v_add_f32_dpp v20, v20, v20 quad_perm:[1,0,3,2] row_mask:0xf bank_mask:0xf
  v_cndmask_b32_e64 v32, v32, v20, s[50:51]
  v_dot2_f32_bf16 v22, v193, v52, 0
  v_dot2_f32_bf16 v23, v198, v53, 0
  v_dot2_f32_bf16 v24, v196, v54, 0
  v_dot2_f32_bf16 v25, v199, v55, 0
  v_cvt_f32_i32 v100, v100
  v_cvt_f32_i32 v101, v101
  v_cvt_f32_i32 v102, v102
  v_cvt_f32_i32 v103, v103
  v_pk_mul_f32 v[20:21], v[100:101], v[22:23]
  v_pk_add_f32 v[18:19], v[22:23], v[24:25]
  v_pk_fma_f32 v[20:21], v[102:103], v[24:25], v[20:21]
  v_add_f32 v18, v18, v19
  v_add_f32 v20, v20, v21
  s_cmp_lt_i32 s69, -25
  s_cbranch_scc0 L_t80
  s_waitcnt vmcnt(6)
L_t80:
  s_cmp_gt_i32 s69, 9
  s_cbranch_scc1 L_p81
  s_waitcnt vmcnt(7)
L_p81:
  s_waitcnt vmcnt(11)
  buffer_load_dwordx4 v[88:91], v217, s[36:39], 0 offen nt
  v_add_f32_dpp v34, v18, v18 row_ror:8 row_mask:0xf bank_mask:0xc
  v_add_f32_dpp v34, v20, v20 row_ror:8 row_mask:0xf bank_mask:0x3
L_qn:
  s_waitcnt lgkmcnt(0)
  v_readfirstlane_b32 s46, v4
  s_cmp_ge_u32 s46, s47
  s_cbranch_scc1 L_qn_ok
  s_cmp_eq_u32 s94, 0
  s_cbranch_scc1 L_qn_ok
  s_sub_u32 s94, s94, 1
  ds_read_b32 v4, v14 offset:16
  s_branch L_qn
L_qn_ok:
  s_waitcnt vmcnt(8)
  v_add3_u32 v9, v26, v27, s58
  s_nop 0
  v_readfirstlane_b32 s91, v9
  s_add_u32 s44, s78, 0x03030303
  v_msad_u8 v9, s78, v40, 0
  v_msad_u8 v10, s44, v40, 0
  v_msad_u8 v9, s78, v41, v9
  v_msad_u8 v10, s44, v41, v10
  v_msad_u8 v9, s78, v42, v9
  v_msad_u8 v10, s44, v42, v10
  v_sub_u32 v9, v9, v10
  v_mov_b32 v8, s90
  s_add_u32 s78, s78, 0x01010101
  v_readlane_b32 s66, v9, 0
  v_readlane_b32 s67, v9, 1
  s_mov_b64 exec, 1
  global_store_byte v7, v8, s[30:31]
  s_mov_b64 exec, 3
  global_load_dwordx3 v[40:42], v239, s[30:31] sc1
  s_mov_b64 exec, -1
  s_add_u32 s69, s66, s67
  s_add_u32 s44, s69, s95
  s_mov_b32 s95, s69
  s_ashr_i32 s69, s44, 1
  s_add_u32 s69, s69, s91
  s_cmp_lt_u32 s90, 5
  s_cselect_b32 s69, 0, s69
  s_add_u32 s90, s90, 1
  v_dot2_f32_bf16 v22, v197, v44, 0
  v_dot2_f32_bf16 v23, v202, v45, 0
  v_dot2_f32_bf16 v24, v200, v46, 0
  v_dot2_f32_bf16 v25, v203, v47, 0
  v_cvt_f32_i32 v104, v104
  v_cvt_f32_i32 v105, v105
  v_cvt_f32_i32 v106, v106
  v_cvt_f32_i32 v107, v107
  ds_read_b128 v[44:47], v15 offset:512
  v_pk_mul_f32 v[20:21], v[104:105], v[22:23]
  v_pk_add_f32 v[18:19], v[22:23], v[24:25]
  v_pk_fma_f32 v[20:21], v[106:107], v[24:25], v[20:21]
  v_add_f32 v18, v18, v19
  v_add_f32 v20, v20, v21
  s_cmp_gt_i32 s69, -13
  s_cbranch_scc1 L_p82
  s_waitcnt vmcnt(5)
L_p82:
  s_waitcnt vmcnt(8)
  buffer_load_dwordx4 v[92:95], v218, s[36:39], 0 offen nt
  v_add_f32_dpp v21, v18, v18 row_ror:8 row_mask:0xf bank_mask:0xc
  v_add_f32_dpp v21, v20, v20 row_ror:8 row_mask:0xf bank_mask:0x3
  v_add_f32_dpp v20, v34, v34 row_half_mirror row_mask:0xf bank_mask:0x5
  s_nop 0
  v_add_f32_dpp v20, v21, v21 row_half_mirror row_mask:0xf bank_mask:0xa
  s_nop 1
  v_add_f32_dpp v20, v20, v20 quad_perm:[2,3,0,1] row_mask:0xf bank_mask:0xf
  s_nop 1
  v_add_f32_dpp v20, v20, v20 quad_perm:[1,0,3,2] row_mask:0xf bank_mask:0xf
  v_cndmask_b32_e64 v32, v32, v20, s[52:53]
  v_dot2_f32_bf16 v22, v201, v48, 0
  v_dot2_f32_bf16 v23, v206, v49, 0
  v_dot2_f32_bf16 v24, v204, v50, 0
  v_dot2_f32_bf16 v25, v207, v51, 0
  v_cvt_f32_i32 v108, v108
  v_cvt_f32_i32 v109, v109
  v_cvt_f32_i32 v110, v110
  v_cvt_f32_i32 v111, v111
  ds_read_b128 v[48:51], v16 offset:512
  v_pk_mul_f32 v[20:21], v[108:109], v[22:23]
  v_pk_add_f32 v[18:19], v[22:23], v[24:25]
  v_pk_fma_f32 v[20:21], v[110:111], v[24:25], v[20:21]
  v_add_f32 v18, v18, v19
  v_add_f32 v20, v20, v21
  s_cmp_gt_i32 s69, 2
  s_cbranch_scc1 L_p83
  s_waitcnt vmcnt(6)
L_p83:
  s_waitcnt vmcnt(9)
  buffer_load_dwordx4 v[96:99], v219, s[36:39], 0 offen nt
  v_add_f32_dpp v34, v18, v18 row_ror:8 row_mask:0xf bank_mask:0xc
  v_add_f32_dpp v34, v20, v20 row_ror:8 row_mask:0xf bank_mask:0x3
  v_dot2_f32_bf16 v22, v205, v52, 0
  v_dot2_f32_bf16 v23, v210, v53, 0
  v_dot2_f32_bf16 v24, v208, v54, 0
  v_dot2_f32_bf16 v25, v211, v55, 0
  v_cvt_f32_i32 v112, v112
  v_cvt_f32_i32 v113, v113
  v_cvt_f32_i32 v114, v114
  v_cvt_f32_i32 v115, v115
  ds_read_b128 v[52:55], v17 offset:512
  v_pk_mul_f32 v[20:21], v[112:113], v[22:23]
  v_pk_add_f32 v[18:19], v[22:23], v[24:25]
  v_pk_fma_f32 v[20:21], v[114:115], v[24:25], v[20:21]
  v_add_f32 v18, v18, v19
  v_add_f32 v20, v20, v21
  s_cmp_lt_i32 s69, -25
  s_cbranch_scc0 L_t84
  s_waitcnt vmcnt(6)
L_t84:
  s_cmp_gt_i32 s69, 9
  s_cbranch_scc1 L_p85
  s_waitcnt vmcnt(7)
L_p85:
  s_waitcnt vmcnt(10)
  buffer_load_dwordx4 v[100:103], v220, s[36:39], 0 offen nt
  v_add_f32_dpp v21, v18, v18 row_ror:8 row_mask:0xf bank_mask:0xc
  v_add_f32_dpp v21, v20, v20 row_ror:8 row_mask:0xf bank_mask:0x3
  v_add_f32_dpp v20, v34, v34 row_half_mirror row_mask:0xf bank_mask:0x5
  s_nop 0
  v_add_f32_dpp v20, v21, v21 row_half_mirror row_mask:0xf bank_mask:0xa
  s_nop 1
  v_add_f32_dpp v20, v20, v20 quad_perm:[2,3,0,1] row_mask:0xf bank_mask:0xf
  s_nop 1
  v_add_f32_dpp v20, v20, v20 quad_perm:[1,0,3,2] row_mask:0xf bank_mask:0xf
  v_cndmask_b32_e64 v32, v32, v20, s[54:55]
  ds_write_b32 v2, v32 offset:1024
  s_add_u32 s43, s43, 1
  v_mov_b32 v4, s43
  ds_write_b32 v6, v4 offset:0
  s_mov_b64 s[32:33], s[36:37]
  s_add_u32 s68, s43, 1
  s_sub_u32 s45, s68, 16
  s_lshl_b32 s46, s45, 2
  s_lshr_b64 s[64:65], s[92:93], s46
  s_and_b32 s46, s64, 15
  s_cmp_lt_u32 s68, 16
  s_cselect_b32 s68, s68, s46
  s_cselect_b32 s70, s6, s12
  s_cselect_b32 s71, s7, s13
  s_lshl_b32 s44, s68, 2
  s_lshr_b64 s[64:65], s[96:97], s44
  s_and_b32 s64, s64, 15
  s_lshl4_add_u32 s68, s68, s64
  s_mul_i32 s44, s68, 1572864
  s_add_u32 s36, s70, s44
  s_addc_u32 s37, s71, 0
  s_cmp_lt_u32 s43, 16
  s_cbranch_scc1 L_k
L_vpre:
  v_lshrrev_b32 v116, 4, v0
  v_and_b32 v119, 15, v0
  v_and_or_b32 v120, v0, 7, 16
  v_lshl_add_u32 v119, v119, 4, v116
  v_mul_u32_u24 v119, 683, v119
  v_lshrrev_b32 v119, 11, v119
  v_lshlrev_b32 v119, 2, v119
  v_lshl_add_u32 v120, v120, 4, v116
  v_mul_u32_u24 v120, 683, v120
  v_lshrrev_b32 v120, 11, v120
  v_lshlrev_b32 v120, 2, v120
  s_mov_b64 vcc, 0
  s_mov_b32 s43, 0
  s_lshl_b32 s68, s43, 2
  s_lshr_b64 s[64:65], s[92:93], s68
  s_and_b32 s68, s64, 15
  s_add_u32 s47, s68, 1
  ds_read_b32 v4, v14 offset:20
L_a0:
  s_waitcnt lgkmcnt(0)
  v_readfirstlane_b32 s46, v4
  s_cmp_ge_u32 s46, s47
  s_cbranch_scc1 L_a0_ok
  s_cmp_eq_u32 s94, 0
  s_cbranch_scc1 L_a0_ok
  s_sub_u32 s94, s94, 1
  ds_read_b32 v4, v14 offset:20
  s_branch L_a0
L_a0_ok:
  v_lshl_add_u32 v121, s68, 9, v119
  v_lshl_add_u32 v122, s68, 9, v120
  ds_read_b32 v116, v121 offset:37376
  ds_read_b32 v117, v122 offset:37376
.p2align 6
L_v:
  s_add_u32 s45, s43, 1
  s_min_u32 s45, s45, 15
  s_lshl_b32 s68, s45, 2
  s_lshr_b64 s[64:65], s[92:93], s68
  s_and_b32 s68, s64, 15
  s_add_u32 s47, s68, 1
  v_lshl_add_u32 v121, s68, 9, v119
  v_lshl_add_u32 v122, s68, 9, v120
  s_waitcnt lgkmcnt(0)
  s_waitcnt vmcnt(8)
  s_add_u32 s44, s78, 0x03030303
  v_msad_u8 v9, s78, v36, 0
  v_msad_u8 v10, s44, v36, 0
  v_msad_u8 v9, s78, v37, v9
  v_msad_u8 v10, s44, v37, v10
  v_msad_u8 v9, s78, v38, v9
  v_msad_u8 v10, s44, v38, v10
  v_sub_u32 v9, v9, v10
  v_mov_b32 v8, s90
  s_add_u32 s78, s78, 0x01010101
  v_readlane_b32 s66, v9, 0
  v_readlane_b32 s67, v9, 1
  s_mov_b64 exec, 1
  global_store_byte v7, v8, s[30:31]
  s_mov_b64 exec, 3
  global_load_dwordx3 v[36:38], v236, s[30:31] sc1
  s_mov_b64 exec, -1
  s_add_u32 s69, s66, s67
  s_add_u32 s44, s69, s95
  s_mov_b32 s95, s69
  s_ashr_i32 s69, s44, 1
  s_add_u32 s69, s69, s91
  s_cmp_lt_u32 s90, 5
  s_cselect_b32 s69, 0, s69
  s_add_u32 s90, s90, 1
  v_mov_b32_dpp v18, v116 row_newbcast:0 row_mask:0xf bank_mask:0xf
  v_cvt_f32_i32 v68, v68
  v_cvt_f32_i32 v69, v69
  v_cvt_f32_i32 v70, v70
  v_cvt_f32_i32 v71, v71
  v_pk_mul_f32 v[44:45], v[68:69], v[18:19] op_sel_hi:[1,0]
  v_pk_mul_f32 v[46:47], v[70:71], v[18:19] op_sel_hi:[1,0]
  s_cmp_gt_i32 s69, -10
  s_cbranch_scc1 L_p86
  s_waitcnt vmcnt(5)
L_p86:
  s_waitcnt vmcnt(8)
  buffer_load_dwordx4 v[104:107], v221, s[32:35], 0 offen nt
  v_mov_b32_dpp v18, v116 row_newbcast:1 row_mask:0xf bank_mask:0xf
  v_cvt_f32_i32 v72, v72
  v_cvt_f32_i32 v73, v73
  v_cvt_f32_i32 v74, v74
  v_cvt_f32_i32 v75, v75
  v_pk_mul_f32 v[48:49], v[72:73], v[18:19] op_sel_hi:[1,0]
  v_pk_mul_f32 v[50:51], v[74:75], v[18:19] op_sel_hi:[1,0]
  s_cmp_gt_i32 s69, 5
  s_cbranch_scc1 L_p87
  s_waitcnt vmcnt(6)
L_p87:
  s_waitcnt vmcnt(9)
  buffer_load_dwordx4 v[108:111], v222, s[32:35], 0 offen nt
  v_mov_b32_dpp v18, v116 row_newbcast:2 row_mask:0xf bank_mask:0xf
  v_cvt_f32_i32 v76, v76
  v_cvt_f32_i32 v77, v77
  v_cvt_f32_i32 v78, v78
  v_cvt_f32_i32 v79, v79
  v_pk_mul_f32 v[52:53], v[76:77], v[18:19] op_sel_hi:[1,0]
  v_pk_mul_f32 v[54:55], v[78:79], v[18:19] op_sel_hi:[1,0]
  s_cmp_lt_i32 s69, -25
  s_cbranch_scc0 L_t88
  s_waitcnt vmcnt(6)
L_t88:
  s_cmp_gt_i32 s69, 12
  s_cbranch_scc1 L_p89
  s_waitcnt vmcnt(7)
L_p89:
  s_waitcnt vmcnt(10)
  buffer_load_dwordx4 v[112:115], v223, s[32:35], 0 offen nt
  s_waitcnt vmcnt(8)
  s_add_u32 s44, s78, 0x03030303
  v_msad_u8 v9, s78, v40, 0
  v_msad_u8 v10, s44, v40, 0
  v_msad_u8 v9, s78, v41, v9
  v_msad_u8 v10, s44, v41, v10
  v_msad_u8 v9, s78, v42, v9
  v_msad_u8 v10, s44, v42, v10
  v_sub_u32 v9, v9, v10
  v_mov_b32 v8, s90
  s_add_u32 s78, s78, 0x01010101
  v_readlane_b32 s66, v9, 0
  v_readlane_b32 s67, v9, 1
  s_mov_b64 exec, 1
  global_store_byte v7, v8, s[30:31]
  s_mov_b64 exec, 3
  global_load_dwordx3 v[40:42], v237, s[30:31] sc1
  s_mov_b64 exec, -1
  s_add_u32 s69, s66, s67
  s_add_u32 s44, s69, s95
  s_mov_b32 s95, s69
  s_ashr_i32 s69, s44, 1
  s_add_u32 s69, s69, s91
  s_cmp_lt_u32 s90, 5
  s_cselect_b32 s69, 0, s69
  s_add_u32 s90, s90, 1
  v_mov_b32_dpp v18, v116 row_newbcast:3 row_mask:0xf bank_mask:0xf
  v_cvt_f32_i32 v80, v80
  v_cvt_f32_i32 v81, v81
  v_cvt_f32_i32 v82, v82
  v_cvt_f32_i32 v83, v83
  v_pk_fma_f32 v[44:45], v[80:81], v[18:19], v[44:45] op_sel_hi:[1,0,1]
  v_pk_fma_f32 v[46:47], v[82:83], v[18:19], v[46:47] op_sel_hi:[1,0,1]
  s_cmp_gt_i32 s69, -10
  s_cbranch_scc1 L_p90
  s_waitcnt vmcnt(5)
L_p90:
  s_waitcnt vmcnt(8)
  buffer_load_dwordx4 v[68:71], v224, s[32:35], 0 offen nt
  v_mov_b32_dpp v18, v116 row_newbcast:4 row_mask:0xf bank_mask:0xf
  v_cvt_f32_i32 v84, v84
  v_cvt_f32_i32 v85, v85
  v_cvt_f32_i32 v86, v86
  v_cvt_f32_i32 v87, v87
  v_pk_fma_f32 v[48:49], v[84:85], v[18:19], v[48:49] op_sel_hi:[1,0,1]
  v_pk_fma_f32 v[50:51], v[86:87], v[18:19], v[50:51] op_sel_hi:[1,0,1]
  s_cmp_gt_i32 s69, 5
  s_cbranch_scc1 L_p91
  s_waitcnt vmcnt(6)
L_p91:
  s_waitcnt vmcnt(9)
  buffer_load_dwordx4 v[72:75], v225, s[32:35], 0 offen nt
  v_mov_b32_dpp v18, v116 row_newbcast:5 row_mask:0xf bank_mask:0xf
  v_cvt_f32_i32 v88, v88
  v_cvt_f32_i32 v89, v89
  v_cvt_f32_i32 v90, v90
  v_cvt_f32_i32 v91, v91
  v_pk_fma_f32 v[52:53], v[88:89], v[18:19], v[52:53] op_sel_hi:[1,0,1]
  v_pk_fma_f32 v[54:55], v[90:91], v[18:19], v[54:55] op_sel_hi:[1,0,1]
  s_cmp_lt_i32 s69, -25
  s_cbranch_scc0 L_t92
  s_waitcnt vmcnt(6)
L_t92:
  s_cmp_gt_i32 s69, 12
  s_cbranch_scc1 L_p93
  s_waitcnt vmcnt(7)
L_p93:
  s_waitcnt vmcnt(10)
  buffer_load_dwordx4 v[76:79], v226, s[32:35], 0 offen nt
  s_waitcnt vmcnt(8)
  s_add_u32 s44, s78, 0x03030303
  v_msad_u8 v9, s78, v36, 0
  v_msad_u8 v10, s44, v36, 0
  v_msad_u8 v9, s78, v37, v9
  v_msad_u8 v10, s44, v37, v10
  v_msad_u8 v9, s78, v38, v9
  v_msad_u8 v10, s44, v38, v10
  v_sub_u32 v9, v9, v10
  v_mov_b32 v8, s90
  s_add_u32 s78, s78, 0x01010101
  v_readlane_b32 s66, v9, 0
  v_readlane_b32 s67, v9, 1
  s_mov_b64 exec, 1
  global_store_byte v7, v8, s[30:31]
  s_mov_b64 exec, 3
  global_load_dwordx3 v[36:38], v238, s[30:31] sc1
  s_mov_b64 exec, -1
  s_add_u32 s69, s66, s67
  s_add_u32 s44, s69, s95
  s_mov_b32 s95, s69
  s_ashr_i32 s69, s44, 1
  s_add_u32 s69, s69, s91
  s_cmp_lt_u32 s90, 5
  s_cselect_b32 s69, 0, s69
  s_add_u32 s90, s90, 1
  v_mov_b32_dpp v18, v116 row_newbcast:6 row_mask:0xf bank_mask:0xf
  v_cvt_f32_i32 v92, v92
  v_cvt_f32_i32 v93, v93
  v_cvt_f32_i32 v94, v94
  v_cvt_f32_i32 v95, v95
  v_pk_fma_f32 v[44:45], v[92:93], v[18:19], v[44:45] op_sel_hi:[1,0,1]
  v_pk_fma_f32 v[46:47], v[94:95], v[18:19], v[46:47] op_sel_hi:[1,0,1]
  s_cmp_gt_i32 s69, -10
  s_cbranch_scc1 L_p94
  s_waitcnt vmcnt(5)
L_p94:
  s_waitcnt vmcnt(8)
  buffer_load_dwordx4 v[80:83], v227, s[32:35], 0 offen nt
  v_mov_b32_dpp v18, v116 row_newbcast:7 row_mask:0xf bank_mask:0xf
  v_cvt_f32_i32 v96, v96
  v_cvt_f32_i32 v97, v97
  v_cvt_f32_i32 v98, v98
  v_cvt_f32_i32 v99, v99
  v_pk_fma_f32 v[48:49], v[96:97], v[18:19], v[48:49] op_sel_hi:[1,0,1]
  v_pk_fma_f32 v[50:51], v[98:99], v[18:19], v[50:51] op_sel_hi:[1,0,1]
  s_cmp_gt_i32 s69, 5
  s_cbranch_scc1 L_p95
  s_waitcnt vmcnt(6)
L_p95:
  s_waitcnt vmcnt(9)
  buffer_load_dwordx4 v[84:87], v228, s[32:35], 0 offen nt
  v_mov_b32_dpp v18, v116 row_newbcast:8 row_mask:0xf bank_mask:0xf
  v_cvt_f32_i32 v100, v100
  v_cvt_f32_i32 v101, v101
  v_cvt_f32_i32 v102, v102
  v_cvt_f32_i32 v103, v103
  v_pk_fma_f32 v[52:53], v[100:101], v[18:19], v[52:53] op_sel_hi:[1,0,1]
  v_pk_fma_f32 v[54:55], v[102:103], v[18:19], v[54:55] op_sel_hi:[1,0,1]
  s_cmp_lt_i32 s69, -25
  s_cbranch_scc0 L_t96
  s_waitcnt vmcnt(6)
L_t96:
  s_cmp_gt_i32 s69, 12
  s_cbranch_scc1 L_p97
  s_waitcnt vmcnt(7)
L_p97:
  s_waitcnt vmcnt(10)
  buffer_load_dwordx4 v[88:91], v229, s[32:35], 0 offen nt
  s_waitcnt vmcnt(8)
  s_add_u32 s44, s78, 0x03030303
  v_msad_u8 v9, s78, v40, 0
  v_msad_u8 v10, s44, v40, 0
  v_msad_u8 v9, s78, v41, v9
  v_msad_u8 v10, s44, v41, v10
  v_msad_u8 v9, s78, v42, v9
  v_msad_u8 v10, s44, v42, v10
  v_sub_u32 v9, v9, v10
  v_mov_b32 v8, s90
  s_add_u32 s78, s78, 0x01010101
  v_readlane_b32 s66, v9, 0
  v_readlane_b32 s67, v9, 1
  s_mov_b64 exec, 1
  global_store_byte v7, v8, s[30:31]
  s_mov_b64 exec, 3
  global_load_dwordx3 v[40:42], v239, s[30:31] sc1
  s_mov_b64 exec, -1
  s_add_u32 s69, s66, s67
  s_add_u32 s44, s69, s95
  s_mov_b32 s95, s69
  s_ashr_i32 s69, s44, 1
  s_add_u32 s69, s69, s91
  s_cmp_lt_u32 s90, 5
  s_cselect_b32 s69, 0, s69
  s_add_u32 s90, s90, 1
  v_mov_b32_dpp v18, v116 row_newbcast:9 row_mask:0xf bank_mask:0xf
  v_cvt_f32_i32 v104, v104
  v_cvt_f32_i32 v105, v105
  v_cvt_f32_i32 v106, v106
  v_cvt_f32_i32 v107, v107
  v_pk_fma_f32 v[44:45], v[104:105], v[18:19], v[44:45] op_sel_hi:[1,0,1]
  v_pk_fma_f32 v[46:47], v[106:107], v[18:19], v[46:47] op_sel_hi:[1,0,1]
  s_cmp_gt_i32 s69, -10
  s_cbranch_scc1 L_p98
  s_waitcnt vmcnt(5)
L_p98:
  s_waitcnt vmcnt(8)
  buffer_load_dwordx4 v[92:95], v230, s[32:35], 0 offen nt
  v_mov_b32_dpp v18, v116 row_newbcast:10 row_mask:0xf bank_mask:0xf
  v_cvt_f32_i32 v108, v108
  v_cvt_f32_i32 v109, v109
  v_cvt_f32_i32 v110, v110
  v_cvt_f32_i32 v111, v111
  v_pk_fma_f32 v[48:49], v[108:109], v[18:19], v[48:49] op_sel_hi:[1,0,1]
  v_pk_fma_f32 v[50:51], v[110:111], v[18:19], v[50:51] op_sel_hi:[1,0,1]
  s_cmp_gt_i32 s69, 5
  s_cbranch_scc1 L_p99
  s_waitcnt vmcnt(6)
L_p99:
  s_waitcnt vmcnt(9)
  buffer_load_dwordx4 v[96:99], v231, s[32:35], 0 offen nt
  v_mov_b32_dpp v18, v116 row_newbcast:11 row_mask:0xf bank_mask:0xf
  v_cvt_f32_i32 v112, v112
  v_cvt_f32_i32 v113, v113
  v_cvt_f32_i32 v114, v114
  v_cvt_f32_i32 v115, v115
  v_pk_fma_f32 v[52:53], v[112:113], v[18:19], v[52:53] op_sel_hi:[1,0,1]
  v_pk_fma_f32 v[54:55], v[114:115], v[18:19], v[54:55] op_sel_hi:[1,0,1]
  s_cmp_lt_i32 s69, -25
  s_cbranch_scc0 L_t100
  s_waitcnt vmcnt(6)
L_t100:
  s_cmp_gt_i32 s69, 12
  s_cbranch_scc1 L_p101
  s_waitcnt vmcnt(7)
L_p101:
  s_waitcnt vmcnt(10)
  buffer_load_dwordx4 v[100:103], v232, s[32:35], 0 offen nt
  s_waitcnt vmcnt(8)
  s_add_u32 s44, s78, 0x03030303
  v_msad_u8 v9, s78, v36, 0
  v_msad_u8 v10, s44, v36, 0
  v_msad_u8 v9, s78, v37, v9
  v_msad_u8 v10, s44, v37, v10
  v_msad_u8 v9, s78, v38, v9
  v_msad_u8 v10, s44, v38, v10
  v_sub_u32 v9, v9, v10
  v_mov_b32 v8, s90
  s_add_u32 s78, s78, 0x01010101
  v_readlane_b32 s66, v9, 0
  v_readlane_b32 s67, v9, 1
  s_mov_b64 exec, 1
  global_store_byte v7, v8, s[30:31]
  s_mov_b64 exec, 3
  global_load_dwordx3 v[36:38], v236, s[30:31] sc1
  s_mov_b64 exec, -1
  s_add_u32 s69, s66, s67
  s_add_u32 s44, s69, s95
  s_mov_b32 s95, s69
  s_ashr_i32 s69, s44, 1
  s_add_u32 s69, s69, s91
  s_cmp_lt_u32 s90, 5
  s_cselect_b32 s69, 0, s69
  s_add_u32 s90, s90, 1
  v_mov_b32_dpp v18, v116 row_newbcast:12 row_mask:0xf bank_mask:0xf
  v_cvt_f32_i32 v68, v68
  v_cvt_f32_i32 v69, v69
  v_cvt_f32_i32 v70, v70
  v_cvt_f32_i32 v71, v71
  v_pk_fma_f32 v[44:45], v[68:69], v[18:19], v[44:45] op_sel_hi:[1,0,1]
  v_pk_fma_f32 v[46:47], v[70:71], v[18:19], v[46:47] op_sel_hi:[1,0,1]
  s_cmp_gt_i32 s69, -10
  s_cbranch_scc1 L_p102
  s_waitcnt vmcnt(5)
L_p102:
  s_waitcnt vmcnt(8)
  buffer_load_dwordx4 v[104:107], v233, s[32:35], 0 offen nt
  v_mov_b32_dpp v18, v116 row_newbcast:13 row_mask:0xf bank_mask:0xf
  v_cvt_f32_i32 v72, v72
  v_cvt_f32_i32 v73, v73
  v_cvt_f32_i32 v74, v74
  v_cvt_f32_i32 v75, v75
  v_pk_fma_f32 v[48:49], v[72:73], v[18:19], v[48:49] op_sel_hi:[1,0,1]
  v_pk_fma_f32 v[50:51], v[74:75], v[18:19], v[50:51] op_sel_hi:[1,0,1]
  s_cmp_gt_i32 s69, 5
  s_cbranch_scc1 L_p103
  s_waitcnt vmcnt(6)
L_p103:
  s_waitcnt vmcnt(9)
  buffer_load_dwordx4 v[108:111], v234, s[32:35], 0 offen nt
  v_mov_b32_dpp v18, v116 row_newbcast:14 row_mask:0xf bank_mask:0xf
  v_cvt_f32_i32 v76, v76
  v_cvt_f32_i32 v77, v77
  v_cvt_f32_i32 v78, v78
  v_cvt_f32_i32 v79, v79
  v_pk_fma_f32 v[52:53], v[76:77], v[18:19], v[52:53] op_sel_hi:[1,0,1]
  v_pk_fma_f32 v[54:55], v[78:79], v[18:19], v[54:55] op_sel_hi:[1,0,1]
  s_cmp_lt_i32 s69, -25
  s_cbranch_scc0 L_t104
  s_waitcnt vmcnt(6)
L_t104:
  s_cmp_gt_i32 s69, 12
  s_cbranch_scc1 L_p105
  s_waitcnt vmcnt(7)
L_p105:
  s_waitcnt vmcnt(10)
  buffer_load_dwordx4 v[112:115], v235, s[32:35], 0 offen nt
  ds_read_b32 v4, v14 offset:20
  s_cbranch_vccz L_in
  s_waitcnt vmcnt(10)
L_in:
  s_cbranch_vccnz L_c15
  s_mov_b64 exec, 1
  global_load_dwordx2 v[26:27], v11, s[30:31] sc1
  s_mov_b64 exec, -1
  s_waitcnt vmcnt(9)
  s_add_u32 s44, s78, 0x03030303
  v_msad_u8 v9, s78, v40, 0
  v_msad_u8 v10, s44, v40, 0
  v_msad_u8 v9, s78, v41, v9
  v_msad_u8 v10, s44, v41, v10
  v_msad_u8 v9, s78, v42, v9
  v_msad_u8 v10, s44, v42, v10
  v_sub_u32 v9, v9, v10
  v_mov_b32 v8, s90
  s_add_u32 s78, s78, 0x01010101
  v_readlane_b32 s66, v9, 0
  v_readlane_b32 s67, v9, 1
  s_mov_b64 exec, 1
  global_store_byte v7, v8, s[30:31]
  s_mov_b64 exec, 3
  global_load_dwordx3 v[40:42], v237, s[30:31] sc1
  s_mov_b64 exec, -1
  s_add_u32 s69, s66, s67
  s_add_u32 s44, s69, s95
  s_mov_b32 s95, s69
  s_ashr_i32 s69, s44, 1
  s_add_u32 s69, s69, s91
  s_cmp_lt_u32 s90, 5
  s_cselect_b32 s69, 0, s69
  s_add_u32 s90, s90, 1
L_c15:
  v_mov_b32_dpp v18, v116 row_newbcast:15 row_mask:0xf bank_mask:0xf
  v_cvt_f32_i32 v80, v80
  v_cvt_f32_i32 v81, v81
  v_cvt_f32_i32 v82, v82
  v_cvt_f32_i32 v83, v83
  v_pk_fma_f32 v[44:45], v[80:81], v[18:19], v[44:45] op_sel_hi:[1,0,1]
  v_pk_fma_f32 v[46:47], v[82:83], v[18:19], v[46:47] op_sel_hi:[1,0,1]
  s_cbranch_vccz L_f15
  s_waitcnt vmcnt(9)
  s_branch L_g15
L_f15:
  s_cmp_gt_i32 s69, -10
  s_cbranch_scc1 L_p106
  s_waitcnt vmcnt(6)
L_p106:
  s_waitcnt vmcnt(9)
  buffer_load_dwordx4 v[68:71], v212, s[36:39], 0 offen nt
L_g15:
  v_mov_b32_dpp v18, v117 row_newbcast:0 row_mask:0xf bank_mask:0xf
  v_cvt_f32_i32 v84, v84
  v_cvt_f32_i32 v85, v85
  v_cvt_f32_i32 v86, v86
  v_cvt_f32_i32 v87, v87
  v_pk_fma_f32 v[48:49], v[84:85], v[18:19], v[48:49] op_sel_hi:[1,0,1]
  v_pk_fma_f32 v[50:51], v[86:87], v[18:19], v[50:51] op_sel_hi:[1,0,1]
  s_cbranch_vccz L_f16
  s_waitcnt vmcnt(8)
  s_branch L_g16
L_f16:
  s_cmp_gt_i32 s69, 5
  s_cbranch_scc1 L_p107
  s_waitcnt vmcnt(7)
L_p107:
  s_waitcnt vmcnt(10)
  buffer_load_dwordx4 v[72:75], v213, s[36:39], 0 offen nt
L_g16:
  v_mov_b32_dpp v18, v117 row_newbcast:1 row_mask:0xf bank_mask:0xf
  v_cvt_f32_i32 v88, v88
  v_cvt_f32_i32 v89, v89
  v_cvt_f32_i32 v90, v90
  v_cvt_f32_i32 v91, v91
  v_pk_fma_f32 v[52:53], v[88:89], v[18:19], v[52:53] op_sel_hi:[1,0,1]
  v_pk_fma_f32 v[54:55], v[90:91], v[18:19], v[54:55] op_sel_hi:[1,0,1]
  s_cbranch_vccz L_f17
  s_waitcnt vmcnt(6)
  s_branch L_g17
L_f17:
  s_cmp_lt_i32 s69, -25
  s_cbranch_scc0 L_t108
  s_waitcnt vmcnt(7)
L_t108:
  s_cmp_gt_i32 s69, 12
  s_cbranch_scc1 L_p109
  s_waitcnt vmcnt(8)
L_p109:
  s_waitcnt vmcnt(11)
  buffer_load_dwordx4 v[76:79], v214, s[36:39], 0 offen nt
L_g17:
  v_mov_b32 v9, s43
  ds_write_b32 v14, v9 offset:24
L_an:
  s_waitcnt lgkmcnt(0)
  v_readfirstlane_b32 s46, v4
  s_cmp_ge_u32 s46, s47
  s_cbranch_scc1 L_an_ok
  s_cmp_eq_u32 s94, 0
  s_cbranch_scc1 L_an_ok
  s_sub_u32 s94, s94, 1
  ds_read_b32 v4, v14 offset:20
  s_branch L_an
L_an_ok:
  ds_read_b32 v116, v121 offset:37376
  ds_read_b32 v118, v122 offset:37376
  s_cbranch_vccnz L_c18
  s_waitcnt vmcnt(9)
  s_add_u32 s44, s78, 0x03030303
  v_msad_u8 v9, s78, v36, 0
  v_msad_u8 v10, s44, v36, 0
  v_msad_u8 v9, s78, v37, v9
  v_msad_u8 v10, s44, v37, v10
  v_msad_u8 v9, s78, v38, v9
  v_msad_u8 v10, s44, v38, v10
  v_sub_u32 v9, v9, v10
  v_mov_b32 v8, s90
  s_add_u32 s78, s78, 0x01010101
  v_readlane_b32 s66, v9, 0
  v_readlane_b32 s67, v9, 1
  s_mov_b64 exec, 1
  global_store_byte v7, v8, s[30:31]
  s_mov_b64 exec, 3
  global_load_dwordx3 v[36:38], v238, s[30:31] sc1
  s_mov_b64 exec, -1
  s_add_u32 s69, s66, s67
  s_add_u32 s44, s69, s95
  s_mov_b32 s95, s69
  s_ashr_i32 s69, s44, 1
  s_add_u32 s69, s69, s91
  s_cmp_lt_u32 s90, 5
  s_cselect_b32 s69, 0, s69
  s_add_u32 s90, s90, 1
L_c18:
  v_mov_b32_dpp v18, v117 row_newbcast:2 row_mask:0xf bank_mask:0xf
  v_cvt_f32_i32 v92, v92
  v_cvt_f32_i32 v93, v93
  v_cvt_f32_i32 v94, v94
  v_cvt_f32_i32 v95, v95
  v_pk_fma_f32 v[44:45], v[92:93], v[18:19], v[44:45] op_sel_hi:[1,0,1]
  v_pk_fma_f32 v[46:47], v[94:95], v[18:19], v[46:47] op_sel_hi:[1,0,1]
  s_cbranch_vccz L_f18
  s_waitcnt vmcnt(5)
  s_branch L_g18
L_f18:
  s_cmp_gt_i32 s69, -10
  s_cbranch_scc1 L_p110
  s_waitcnt vmcnt(5)
L_p110:
  s_waitcnt vmcnt(9)
  buffer_load_dwordx4 v[80:83], v215, s[36:39], 0 offen nt
L_g18:
  v_mov_b32_dpp v18, v117 row_newbcast:3 row_mask:0xf bank_mask:0xf
  v_cvt_f32_i32 v96, v96
  v_cvt_f32_i32 v97, v97
  v_cvt_f32_i32 v98, v98
  v_cvt_f32_i32 v99, v99
  v_pk_fma_f32 v[48:49], v[96:97], v[18:19], v[48:49] op_sel_hi:[1,0,1]
  v_pk_fma_f32 v[50:51], v[98:99], v[18:19], v[50:51] op_sel_hi:[1,0,1]
  s_cbranch_vccz L_f19
  s_waitcnt vmcnt(4)
  s_branch L_g19
L_f19:
  s_cmp_gt_i32 s69, 5
  s_cbranch_scc1 L_p111
  s_waitcnt vmcnt(6)
L_p111:
  s_waitcnt vmcnt(10)
  buffer_load_dwordx4 v[84:87], v216, s[36:39], 0 offen nt
L_g19:
  v_mov_b32_dpp v18, v117 row_newbcast:4 row_mask:0xf bank_mask:0xf
  v_cvt_f32_i32 v100, v100
  v_cvt_f32_i32 v101, v101
  v_cvt_f32_i32 v102, v102
  v_cvt_f32_i32 v103, v103
  v_pk_fma_f32 v[52:53], v[100:101], v[18:19], v[52:53] op_sel_hi:[1,0,1]
  v_pk_fma_f32 v[54:55], v[102:103], v[18:19], v[54:55] op_sel_hi:[1,0,1]
  s_cbranch_vccz L_f20
  s_waitcnt vmcnt(2)
  s_branch L_g20
L_f20:
  s_cmp_lt_i32 s69, -25
  s_cbranch_scc0 L_t112
  s_waitcnt vmcnt(6)
L_t112:
  s_cmp_gt_i32 s69, 12
  s_cbranch_scc1 L_p113
  s_waitcnt vmcnt(7)
L_p113:
  s_waitcnt vmcnt(11)
  buffer_load_dwordx4 v[88:91], v217, s[36:39], 0 offen nt
L_g20:
  s_cbranch_vccnz L_c21
  s_waitcnt vmcnt(8)
  v_add3_u32 v9, v26, v27, s58
  s_nop 0
  v_readfirstlane_b32 s91, v9
  s_add_u32 s44, s78, 0x03030303
  v_msad_u8 v9, s78, v40, 0
  v_msad_u8 v10, s44, v40, 0
  v_msad_u8 v9, s78, v41, v9
  v_msad_u8 v10, s44, v41, v10
  v_msad_u8 v9, s78, v42, v9
  v_msad_u8 v10, s44, v42, v10
  v_sub_u32 v9, v9, v10
  v_mov_b32 v8, s90
  s_add_u32 s78, s78, 0x01010101
  v_readlane_b32 s66, v9, 0
  v_readlane_b32 s67, v9, 1
  s_mov_b64 exec, 1
  global_store_byte v7, v8, s[30:31]
  s_mov_b64 exec, 3
  global_load_dwordx3 v[40:42], v239, s[30:31] sc1
  s_mov_b64 exec, -1
  s_add_u32 s69, s66, s67
  s_add_u32 s44, s69, s95
  s_mov_b32 s95, s69
  s_ashr_i32 s69, s44, 1
  s_add_u32 s69, s69, s91
  s_cmp_lt_u32 s90, 5
  s_cselect_b32 s69, 0, s69
  s_add_u32 s90, s90, 1
L_c21:
  v_mov_b32_dpp v18, v117 row_newbcast:5 row_mask:0xf bank_mask:0xf
  v_cvt_f32_i32 v104, v104
  v_cvt_f32_i32 v105, v105
  v_cvt_f32_i32 v106, v106
  v_cvt_f32_i32 v107, v107
  v_pk_fma_f32 v[44:45], v[104:105], v[18:19], v[44:45] op_sel_hi:[1,0,1]
  v_pk_fma_f32 v[46:47], v[106:107], v[18:19], v[46:47] op_sel_hi:[1,0,1]
  s_cbranch_vccz L_f21
  s_waitcnt vmcnt(1)
  s_branch L_g21
L_f21:
  s_cmp_gt_i32 s69, -10
  s_cbranch_scc1 L_p114
  s_waitcnt vmcnt(5)
L_p114:
  s_waitcnt vmcnt(8)
  buffer_load_dwordx4 v[92:95], v218, s[36:39], 0 offen nt
L_g21:
  v_mov_b32_dpp v18, v117 row_newbcast:6 row_mask:0xf bank_mask:0xf
  v_cvt_f32_i32 v108, v108
  v_cvt_f32_i32 v109, v109
  v_cvt_f32_i32 v110, v110
  v_cvt_f32_i32 v111, v111
  v_pk_fma_f32 v[48:49], v[108:109], v[18:19], v[48:49] op_sel_hi:[1,0,1]
  v_pk_fma_f32 v[50:51], v[110:111], v[18:19], v[50:51] op_sel_hi:[1,0,1]
  s_cbranch_vccz L_f22
  s_waitcnt vmcnt(0)
  s_branch L_g22
L_f22:
  s_cmp_gt_i32 s69, 5
  s_cbranch_scc1 L_p115
  s_waitcnt vmcnt(6)
L_p115:
  s_waitcnt vmcnt(9)
  buffer_load_dwordx4 v[96:99], v219, s[36:39], 0 offen nt
L_g22:
  v_mov_b32_dpp v18, v117 row_newbcast:7 row_mask:0xf bank_mask:0xf
  v_cvt_f32_i32 v112, v112
  v_cvt_f32_i32 v113, v113
  v_cvt_f32_i32 v114, v114
  v_cvt_f32_i32 v115, v115
  v_pk_fma_f32 v[52:53], v[112:113], v[18:19], v[52:53] op_sel_hi:[1,0,1]
  v_pk_fma_f32 v[54:55], v[114:115], v[18:19], v[54:55] op_sel_hi:[1,0,1]
  s_cbranch_vccz L_f23
  s_branch L_g23
L_f23:
  s_cmp_lt_i32 s69, -25
  s_cbranch_scc0 L_t116
  s_waitcnt vmcnt(6)
L_t116:
  s_cmp_gt_i32 s69, 12
  s_cbranch_scc1 L_p117
  s_waitcnt vmcnt(7)
L_p117:
  s_waitcnt vmcnt(10)
  buffer_load_dwordx4 v[100:103], v220, s[36:39], 0 offen nt
L_g23:
  s_add_u32 s43, s43, 1
  v_permlane32_swap_b32 v44, v46
  v_permlane32_swap_b32 v45, v47
  v_permlane32_swap_b32 v48, v50
  v_permlane32_swap_b32 v49, v51
  v_permlane32_swap_b32 v52, v54
  v_permlane32_swap_b32 v53, v55
  v_add_f32 v44, v44, v50
  v_add_f32 v45, v45, v51
  v_add_f32 v48, v48, v54
  v_add_f32 v49, v49, v55
  v_add_f32 v52, v52, v46
  v_add_f32 v53, v53, v47
  s_add_u32 s44, s43, 16
  s_cmp_eq_u32 s43, 15
  s_cselect_b64 vcc, -1, 0
  v_mov_b32 v4, s44
  v_permlane16_swap_b32 v44, v45
  v_permlane16_swap_b32 v48, v49
  v_permlane16_swap_b32 v52, v53
  v_add_f32 v44, v44, v53
  v_add_f32 v48, v48, v45
  v_add_f32 v52, v52, v49
  s_waitcnt lgkmcnt(0)
  ds_write_b32 v3, v44 offset:0
  ds_write_b32 v3, v48 offset:256
  ds_write_b32 v3, v52 offset:512
  s_cmp_eq_u32 s43, 16
  s_cbranch_scc1 L_vend
  ds_write_b32 v6, v4 offset:0
  v_mov_b32 v117, v118
  v_add_u32 v3, 3072, v3
  s_mov_b64 s[32:33], s[36:37]
  s_add_u32 s45, s43, 1
  s_min_u32 s45, s45, 15
  s_lshl_b32 s68, s45, 2
  s_lshr_b64 s[64:65], s[92:93], s68
  s_and_b32 s68, s64, 15
  s_lshl_b32 s44, s68, 2
  s_lshr_b64 s[64:65], s[96:97], s44
  s_and_b32 s64, s64, 15
  s_lshl4_add_u32 s68, s68, s64
  s_mul_i32 s44, s68, 1572864
  s_add_u32 s36, s12, s44
  s_addc_u32 s37, s13, 0
  s_branch L_v
L_vend:
  s_waitcnt lgkmcnt(0)
  s_barrier
  s_endpgm
L_helper:
  s_add_u32 s68, s42, 32
  s_mul_i32 s44, s68, 384
  s_add_u32 s32, s4, s44
  s_addc_u32 s33, s5, 0
  global_load_dwordx2 v[68:69], v26, s[32:33]
  global_load_dwordx2 v[70:71], v27, s[32:33]
  s_setprio 0
  s_load_dwordx4 s[28:31], s[0:1], 96
  s_getpc_b64 s[82:83]
L_pc118:
  s_lshl_b32 s44, s2, 6
  s_add_u32 s44, s44, L_order-L_pc118
  s_add_u32 s82, s82, s44
  s_addc_u32 s83, s83, 0
  s_load_dwordx2 s[92:93], s[82:83], 0
  s_load_dwordx2 s[96:97], s[82:83], 8
  s_mov_b32 s94, 4000000
  s_and_b32 s41, s2, 7
  s_lshl_b32 s41, s41, 1
  s_bitcmp1_b32 s2, 3
  s_addc_u32 s41, s41, 0
  s_load_dword s3, s[82:83], 24
  s_load_dwordx2 s[98:99], s[82:83], 16
  s_waitcnt lgkmcnt(0)
  v_min_u32 v22, 2, v20
  v_lshlrev_b32 v23, 3, v22
  v_bfe_u32 v23, s99, v23, 8
  v_mul_u32_u24 v36, 4352, v23
  v_add_u32 v36, 7340032, v36
  v_and_b32 v23, 15, v23
  v_lshlrev_b32 v37, 4, v23
  v_lshl_add_u32 v22, v22, 4, s42
  v_mul_u32_u24 v45, 4352, v22
  v_add_u32 v45, 7340032, v45
  s_getreg_b32 s81, hwreg(HW_REG_HW_ID, 13, 2)
  s_getreg_b32 s79, hwreg(HW_REG_HW_ID, 8, 4)
  s_getreg_b32 s46, hwreg(HW_REG_XCC_ID, 0, 3)
  s_mul_i32 s46, s46, 4352
  s_add_u32 s46, s46, 8126464
  v_lshrrev_b32 v22, 1, v20
  v_lshl_add_u32 v42, v22, 8, s46
  v_and_b32 v22, 1, v20
  v_lshl_add_u32 v42, v22, 4, v42
  s_and_b32 s45, s81, 2
  s_lshl_b32 s44, s45, 9
  s_add_u32 s44, s44, s46
  v_add_u32 v44, s44, v20
  s_lshl_b32 s45, s45, 1
  s_add_u32 s46, s46, s45
  s_add_u32 s46, s46, 2048
  v_mov_b32 v43, s46
  v_mul_u32_u24 v39, 384, v20
  v_add_u32 v39, 7864320, v39
  v_mov_b32 v40, 0
  v_mov_b32 v41, 0
  s_mov_b32 s95, 0
  s_mov_b32 s90, 0
  s_mov_b32 s80, 0
  s_mov_b64 exec, 0x3ffff
  global_store_dwordx4 v42, v[48:51], s[30:31]
  s_mov_b64 exec, -1
  v_add_u32 v33, 0, v20
  s_and_b32 s44, s41, 1
  v_add_u32 v23, s44, v33
  v_cmp_le_u32 vcc, 43, v23
  s_add_u32 s45, s44, 42
  v_mov_b32 v24, s45
  v_cndmask_b32 v24, 0, v24, vcc
  v_cmp_le_u32 vcc, 86, v23
  v_add_u32 v22, v33, v24
  s_sub_u32 s45, 43, s44
  v_mov_b32 v24, s45
  v_cndmask_b32 v24, 0, v24, vcc
  s_mul_i32 s44, s44, 43
  s_lshr_b32 s45, s41, 1
  s_lshl_b32 s45, s45, 8
  s_add_u32 s44, s44, s45
  v_add3_u32 v22, v22, v24, s44
  v_and_b32 v33, 255, v22
  v_lshlrev_b32 v33, 1, v33
  v_add_u32 v34, 64, v20
  s_and_b32 s44, s41, 1
  v_add_u32 v23, s44, v34
  v_cmp_le_u32 vcc, 43, v23
  s_add_u32 s45, s44, 42
  v_mov_b32 v24, s45
  v_cndmask_b32 v24, 0, v24, vcc
  v_cmp_le_u32 vcc, 86, v23
  v_add_u32 v22, v34, v24
  s_sub_u32 s45, 43, s44
  v_mov_b32 v24, s45
  v_cndmask_b32 v24, 0, v24, vcc
  s_mul_i32 s44, s44, 43
  s_lshr_b32 s45, s41, 1
  s_lshl_b32 s45, s45, 8
  s_add_u32 s44, s44, s45
  v_add3_u32 v22, v22, v24, s44
  v_and_b32 v34, 255, v22
  v_lshlrev_b32 v34, 1, v34
  v_lshlrev_b32 v46, 2, v20
  v_mul_u32_u24 v199, 12, v20
  v_add_u32 v199, 45568, v199
  s_mov_b32 s101, 0
  v_mov_b32 v47, 118912
  v_mov_b32 v51, -1
  v_mov_b32 v60, 0
  v_mov_b32 v61, 0
  v_mov_b32 v62, 0
  v_mov_b32 v63, 0
  v_mov_b32 v64, 0
  v_mov_b32 v65, 0
  v_mov_b32 v66, 0
  v_mov_b32 v67, 0
  s_and_b32 s45, s2, 7
  s_lshl_b32 s45, s45, 9
  v_and_b32 v22, 31, v20
  v_lshl_add_u32 v22, v22, 4, s45
  v_lshrrev_b32 v23, 5, v20
  v_lshl_add_u32 v22, v23, 16, v22
  v_lshlrev_b32 v23, 2, v23
  s_lshr_b32 s44, s96, 0
  v_bfe_u32 v24, s44, v23, 4
  v_lshl_add_u32 v188, v24, 12, v22
  v_add_u32 v22, 0x20000, v22
  s_lshr_b32 s44, s96, 8
  v_bfe_u32 v24, s44, v23, 4
  v_lshl_add_u32 v189, v24, 12, v22
  v_add_u32 v22, 0x20000, v22
  s_lshr_b32 s44, s96, 16
  v_bfe_u32 v24, s44, v23, 4
  v_lshl_add_u32 v190, v24, 12, v22
  v_add_u32 v22, 0x20000, v22
  s_lshr_b32 s44, s96, 24
  v_bfe_u32 v24, s44, v23, 4
  v_lshl_add_u32 v191, v24, 12, v22
  v_add_u32 v22, 0x20000, v22
  s_lshr_b32 s44, s97, 0
  v_bfe_u32 v24, s44, v23, 4
  v_lshl_add_u32 v192, v24, 12, v22
  v_add_u32 v22, 0x20000, v22
  s_lshr_b32 s44, s97, 8
  v_bfe_u32 v24, s44, v23, 4
  v_lshl_add_u32 v193, v24, 12, v22
  v_add_u32 v22, 0x20000, v22
  s_lshr_b32 s44, s97, 16
  v_bfe_u32 v24, s44, v23, 4
  v_lshl_add_u32 v194, v24, 12, v22
  v_add_u32 v22, 0x20000, v22
  s_lshr_b32 s44, s97, 24
  v_bfe_u32 v24, s44, v23, 4
  v_lshl_add_u32 v195, v24, 12, v22
  s_mov_b32 s69, 0
  s_movk_i32 m0, 4608
  s_branch L_hq_nl
L_hk:
  s_sub_u32 s47, s43, 1
L_hsw:
  ds_read_b128 v[104:107], v14 offset:0
  s_waitcnt lgkmcnt(0)
  v_min_u32 v104, v104, v105
  v_min3_u32 v104, v104, v106, v107
  s_nop 0
  v_readfirstlane_b32 s46, v104
  s_cmp_ge_u32 s46, s47
  s_cbranch_scc1 L_hsw_ok
  s_cmp_eq_u32 s94, 0
  s_cbranch_scc1 L_hsw_ok
  s_sub_u32 s94, s94, 1
  s_sleep 1
  s_branch L_hsw
L_hsw_ok:
  s_bitcmp1_b32 s80, s47
  s_cbranch_scc0 L_fas
  s_lshl_b64 exec, 1, s47
  s_mul_i32 s44, s47, 384
  s_add_u32 s44, s44, 7864320
  s_mov_b32 s78, 1
  s_atomic_add s78, s[30:31], s44 glc
  s_mov_b64 exec, -1
L_fas:
  s_cmp_lt_u32 s43, 5
  s_cbranch_scc1 L_hs_done
  s_add_u32 s68, s69, 2
  s_min_u32 s68, s68, s47
L_hs:
  ds_read_u16_d16_hi v60, v33 offset:4608
  ds_read_u16_d16_hi v61, v34 offset:4608
  ds_read_u16_d16_hi v62, v33 offset:12800
  ds_read_u16_d16_hi v63, v34 offset:12800
  ds_read_u16_d16_hi v64, v33 offset:20992
  ds_read_u16_d16_hi v65, v34 offset:20992
  ds_read_u16_d16_hi v66, v33 offset:29184
  ds_read_u16_d16_hi v67, v34 offset:29184
  v_add_u32 v200, s101, v199
  v_add_u32 v201, 1536, v200
  s_addk_i32 s101, 3072
  s_cmpk_eq_u32 s101, 18432
  s_cselect_b32 s101, 0, s101
  s_add_u32 s69, s69, 1
  s_waitcnt lgkmcnt(4)
  ds_read2_b32 v[76:77], v200 offset0:0 offset1:1
  ds_read_b32 v72, v200 offset:8
  ds_read2_b32 v[78:79], v200 offset0:192 offset1:193
  ds_read_b32 v73, v200 offset:776
  ds_read2_b32 v[80:81], v201 offset0:0 offset1:1
  ds_read_b32 v74, v201 offset:8
  ds_read2_b32 v[82:83], v201 offset0:192 offset1:193
  ds_read_b32 v75, v201 offset:776
  s_waitcnt lgkmcnt(0)
  v_add_f32 v76, v76, v77
  v_add_f32 v78, v78, v79
  v_add_f32 v80, v80, v81
  v_add_f32 v82, v82, v83
  v_add_f32 v72, v72, v76
  v_add_f32 v73, v73, v78
  v_add_f32 v74, v74, v80
  v_add_f32 v75, v75, v82
  v_fma_f32 v72, -v62, v74, v72
  v_fma_f32 v73, -v63, v75, v73
  v_mul_f32 v74, s67, v60
  v_mul_f32 v75, s67, v61
  v_mul_f32 v72, v72, v74
  v_mul_f32 v73, v73, v75
  v_max_f32 v48, v72, v73
  s_nop 1
  v_max_f32_dpp v48, v48, v48 row_ror:8 row_mask:0xf bank_mask:0xf
  s_nop 1
  v_max_f32_dpp v48, v48, v48 row_ror:4 row_mask:0xf bank_mask:0xf
  s_nop 1
  v_max_f32_dpp v48, v48, v48 row_ror:2 row_mask:0xf bank_mask:0xf
  s_nop 1
  v_max_f32_dpp v48, v48, v48 row_ror:1 row_mask:0xf bank_mask:0xf
  v_mov_b32 v22, v48
  s_nop 1
  v_permlane16_swap_b32 v48, v22
  v_max_f32 v48, v48, v22
  v_mov_b32 v22, v48
  s_nop 1
  v_permlane32_swap_b32 v48, v22
  v_max_f32 v48, v48, v22
  v_sub_f32 v72, v72, v48
  v_sub_f32 v73, v73, v48
  v_exp_f32 v72, v72
  v_exp_f32 v73, v73
  s_nop 0
  v_add_f32 v49, v72, v73
  v_mul_f32 v72, v72, v64
  v_mul_f32 v73, v73, v65
  v_mul_f32 v50, v72, v66
  v_fmac_f32 v50, v73, v67
  ds_write_b32 v46, v72 offset:37376
  ds_write_b32 v46, v73 offset:37632
  s_nop 1
  v_add_f32_dpp v49, v49, v49 row_ror:8 row_mask:0xf bank_mask:0xf
  s_nop 1
  v_add_f32_dpp v49, v49, v49 row_ror:4 row_mask:0xf bank_mask:0xf
  s_nop 1
  v_add_f32_dpp v49, v49, v49 row_ror:2 row_mask:0xf bank_mask:0xf
  s_nop 1
  v_add_f32_dpp v49, v49, v49 row_ror:1 row_mask:0xf bank_mask:0xf
  v_mov_b32 v22, v49
  s_nop 1
  v_permlane16_swap_b32 v49, v22
  v_add_f32 v49, v49, v22
  v_mov_b32 v22, v49
  s_nop 1
  v_permlane32_swap_b32 v49, v22
  v_add_f32 v49, v49, v22
  s_nop 1
  v_add_f32_dpp v50, v50, v50 row_ror:8 row_mask:0xf bank_mask:0xf
  s_nop 1
  v_add_f32_dpp v50, v50, v50 row_ror:4 row_mask:0xf bank_mask:0xf
  s_nop 1
  v_add_f32_dpp v50, v50, v50 row_ror:2 row_mask:0xf bank_mask:0xf
  s_nop 1
  v_add_f32_dpp v50, v50, v50 row_ror:1 row_mask:0xf bank_mask:0xf
  v_mov_b32 v22, v50
  s_nop 1
  v_permlane16_swap_b32 v50, v22
  v_add_f32 v50, v50, v22
  v_mov_b32 v22, v50
  s_nop 1
  v_permlane32_swap_b32 v50, v22
  v_add_f32 v50, v50, v22
  v_mov_b32 v22, s69
  ds_write_b128 v47, v[48:51]
  ds_write_b32 v14, v22 offset:20
  v_add_u32 v46, 512, v46
  v_add_u32 v47, 16, v47
  v_add_u32 v33, 512, v33
  v_add_u32 v34, 512, v34
  s_cmp_lt_u32 s69, s68
  s_cbranch_scc1 L_hs
L_hs_done:
  s_bitcmp1_b32 s80, s47
  s_cbranch_scc0 L_fbs
  s_waitcnt vmcnt(0) lgkmcnt(0)
  v_sub_u32 v42, s78, v40
  s_nop 0
  v_readlane_b32 s46, v42, s47
  s_min_u32 s46, s46, 15
  s_lshl_b32 s46, s46, 1
  s_sub_u32 s46, s46, 15
  s_cmp_le_u32 s47, 0
  s_cselect_b32 s44, 9, 6
  s_mul_i32 s46, s46, s44
  s_add_u32 s46, s46, s95
  s_add_u32 s46, s46, 8
  s_ashr_i32 s46, s46, 4
  v_mov_b32 v42, s46
  s_mov_b64 exec, 1
  global_store_dword v43, v42, s[30:31]
  s_mov_b64 exec, -1
L_fbs:
  s_cmp_eq_u32 s47, 1
  s_cbranch_scc0 L_el
  s_bitcmp0_b32 s81, 0
  s_cbranch_scc0 L_el
  s_mov_b64 exec, 0xffff
  global_load_ubyte v42, v44, s[30:31] sc1
  s_waitcnt vmcnt(0)
  v_cmp_ne_u32 s[64:65], 0, v42
  s_lshr_b32 s44, s64, s79
  s_bcnt1_i32_b32 s44, s44
  s_sub_u32 s45, s44, 1
  s_cmp_lt_u32 s45, 7
  s_cbranch_scc0 L_el
  s_lshl_b32 s80, 0x10204081, s45
  s_and_b32 s80, s80, 0x7ffffffc
  s_mov_b32 exec_lo, s80
  global_load_dword v40, v39, s[30:31] sc1
  s_cmp_eq_u32 s44, 4
  s_cbranch_scc0 L_el
  s_mov_b64 exec, -1
  s_getpc_b64 s[64:65]
L_pc2:
  s_sub_u32 s64, s64, L_pc2-L_vpre
  s_subb_u32 s65, s65, 0
  v_lshlrev_b32 v42, 7, v20
  global_load_dword v112, v42, s[64:65]
  v_add_u32 v42, L_order-L_vpre-8192, v42
  global_load_dword v113, v42, s[64:65]
L_el:
  s_mov_b64 exec, -1
L_hq:
  s_add_u32 s43, s43, 1
  s_cmp_gt_u32 s43, 16
  s_cbranch_scc1 L_hq_skip
  s_waitcnt vmcnt(0)
  v_lshlrev_b32 v76, 16, v68
  v_and_b32 v77, s66, v68
  v_lshlrev_b32 v78, 16, v69
  v_and_b32 v79, s66, v69
  v_lshlrev_b32 v80, 16, v70
  v_and_b32 v81, s66, v70
  v_lshlrev_b32 v82, 16, v71
  v_and_b32 v83, s66, v71
  v_mul_f32 v76, v76, v52
  v_mul_f32 v77, v77, v53
  v_mul_f32 v78, v78, v54
  v_mul_f32 v79, v79, v55
  v_mul_f32 v80, v80, v56
  v_mul_f32 v81, v81, v57
  v_mul_f32 v82, v82, v58
  v_mul_f32 v83, v83, v59
  v_cvt_pk_bf16_f32 v84, v76, v80
  v_cvt_pk_bf16_f32 v85, v77, v81
  v_cvt_pk_bf16_f32 v86, v78, v82
  v_cvt_pk_bf16_f32 v87, v79, v83
  v_lshlrev_b32 v76, 16, v84
  v_and_b32 v80, s66, v84
  v_lshlrev_b32 v77, 16, v85
  v_and_b32 v81, s66, v85
  v_lshlrev_b32 v78, 16, v86
  v_and_b32 v82, s66, v86
  v_lshlrev_b32 v79, 16, v87
  v_and_b32 v83, s66, v87
  v_fma_f32 v76, v80, v30, v76
  v_fma_f32 v77, v81, v30, v77
  v_fma_f32 v78, v82, v30, v78
  v_fma_f32 v79, v83, v30, v79
  v_cvt_pk_bf16_f32 v84, v76, v77
  v_cvt_pk_bf16_f32 v85, v78, v79
  v_xor_b32 v86, v31, v84
  v_xor_b32 v87, v31, v85
  v_mov_b32 v22, s43
  ds_write_b16 v28, v84 offset:512
  ds_write_b16_d16_hi v28, v84 offset:516
  ds_write_b16 v28, v85 offset:520
  ds_write_b16_d16_hi v28, v85 offset:524
  ds_write_b16 v29, v86 offset:514
  ds_write_b16_d16_hi v29, v86 offset:518
  ds_write_b16 v29, v87 offset:522
  ds_write_b16_d16_hi v29, v87 offset:526
  ds_write_b32 v14, v22 offset:16
  v_add_u32 v28, 1024, v28
  v_add_u32 v29, 1024, v29
  v_and_b32 v28, 0xfff, v28
  v_and_b32 v29, 0xfff, v29
  s_cmp_eq_u32 s43, 16
  s_cbranch_scc1 L_hq_nl
  s_lshl_b32 s44, s43, 2
  s_lshr_b64 s[64:65], s[96:97], s44
  s_and_b32 s64, s64, 15
  s_lshl4_add_u32 s68, s43, s64
  s_mul_i32 s44, s68, 384
  s_add_u32 s32, s4, s44
  s_addc_u32 s33, s5, 0
  global_load_dwordx2 v[68:69], v26, s[32:33]
  global_load_dwordx2 v[70:71], v27, s[32:33]
L_hq_nl:
  s_sub_u32 s44, s43, 4
  s_cmp_lt_u32 s44, 2
  s_cbranch_scc0 L_sc_done
  global_load_lds_dwordx4 v188, s[8:9]
  s_addk_i32 m0, 1024
  s_waitcnt vmcnt(3)
  global_load_lds_dwordx4 v189, s[8:9]
  s_addk_i32 m0, 1024
  s_waitcnt vmcnt(3)
  global_load_lds_dwordx4 v190, s[8:9]
  s_addk_i32 m0, 1024
  s_waitcnt vmcnt(3)
  global_load_lds_dwordx4 v191, s[8:9]
  s_addk_i32 m0, 1024
  s_waitcnt vmcnt(3)
  global_load_lds_dwordx4 v192, s[8:9]
  s_addk_i32 m0, 1024
  s_waitcnt vmcnt(3)
  global_load_lds_dwordx4 v193, s[8:9]
  s_addk_i32 m0, 1024
  s_waitcnt vmcnt(3)
  global_load_lds_dwordx4 v194, s[8:9]
  s_addk_i32 m0, 1024
  s_waitcnt vmcnt(3)
  global_load_lds_dwordx4 v195, s[8:9]
  s_addk_i32 m0, 1024
  s_mov_b64 s[8:9], s[10:11]
  s_mov_b64 s[10:11], s[14:15]
  s_mov_b64 s[14:15], s[16:17]
  s_waitcnt vmcnt(3)
  global_load_lds_dwordx4 v188, s[8:9]
  s_addk_i32 m0, 1024
  s_waitcnt vmcnt(3)
  global_load_lds_dwordx4 v189, s[8:9]
  s_addk_i32 m0, 1024
  s_waitcnt vmcnt(3)
  global_load_lds_dwordx4 v190, s[8:9]
  s_addk_i32 m0, 1024
  s_waitcnt vmcnt(3)
  global_load_lds_dwordx4 v191, s[8:9]
  s_addk_i32 m0, 1024
  s_waitcnt vmcnt(3)
  global_load_lds_dwordx4 v192, s[8:9]
  s_addk_i32 m0, 1024
  s_waitcnt vmcnt(3)
  global_load_lds_dwordx4 v193, s[8:9]
  s_addk_i32 m0, 1024
  s_waitcnt vmcnt(3)
  global_load_lds_dwordx4 v194, s[8:9]
  s_addk_i32 m0, 1024
  s_waitcnt vmcnt(3)
  global_load_lds_dwordx4 v195, s[8:9]
  s_addk_i32 m0, 1024
  s_mov_b64 s[8:9], s[10:11]
  s_mov_b64 s[10:11], s[14:15]
  s_mov_b64 s[14:15], s[16:17]
  s_cmp_eq_u32 s43, 5
  s_cbranch_scc0 L_sc_done
  s_waitcnt vmcnt(0)
L_sc_done:
  s_cmp_eq_u32 s43, 16
  s_cbranch_scc0 L_hq_skip
  s_cmp_eq_u32 s3, 0
  s_cbranch_scc0 L_hq_skip
  s_mov_b64 exec, 7
  global_store_dword v45, v14, s[30:31] sc1
  s_waitcnt vmcnt(0)
  s_mov_b64 exec, 1
  global_store_dword v37, v38, s[28:29] sc1
  s_mov_b64 exec, -1
L_hq_skip:
  s_waitcnt lgkmcnt(0)
  s_cmp_lt_u32 s43, 18
  s_cbranch_scc1 L_hk
  v_and_b32 v24, 15, v20
  v_lshlrev_b32 v24, 1, v24
  global_load_ushort v25, v24, s[82:83] offset:32
  s_mov_b32 s43, 0
  v_min_u32 v28, 23, v20
  v_lshlrev_b32 v28, 4, v28
  v_lshlrev_b32 v22, 1, v28
  v_subrev_u32 v196, 256, v22
  v_add_u32 v197, 512, v22
  v_min_u32 v197, v196, v197
  v_add_u32 v197, 64000, v197
  v_subrev_u32 v196, 512, v22
  v_add_u32 v198, 256, v22
  v_min_u32 v198, v196, v198
  v_add_u32 v198, 64000, v198
  v_add_u32 v196, 64000, v22
  v_add_u32 v28, 113152, v28
  v_lshlrev_b32 v32, 4, v20
  v_add_u32 v30, 113152, v32
  v_cmp_gt_u32 vcc, 24, v20
  v_lshrrev_b32 v21, 1, v35
  s_mul_i32 s44, s98, 384
  s_add_u32 s26, s26, s44
  s_addc_u32 s27, s27, 0
  v_mov_b32 v31, s2
  v_mul_u32_u24 v31, 6144, v31
  v_add_u32 v31, 8388608, v31
  v_add_u32 v23, 0, v32
  v_add_u32 v188, v23, v31
  v_add_u32 v23, 1024, v32
  v_add_u32 v189, v23, v31
  v_add_u32 v23, 2048, v32
  v_add_u32 v190, v23, v31
  v_add_u32 v23, 3072, v32
  v_add_u32 v191, v23, v31
  v_add_u32 v23, 4096, v32
  v_add_u32 v192, v23, v31
  v_add_u32 v23, 5120, v32
  v_add_u32 v193, v23, v31
  s_mov_b32 s45, 14
  s_lshl_b32 s68, s45, 2
  s_lshr_b64 s[64:65], s[92:93], s68
  s_and_b32 s68, s64, 15
  v_lshl_add_u32 v23, s68, 4, v32
  v_cndmask_b32 v23, v23, v32, vcc
  v_add_u32 v23, 5376, v23
  v_add_u32 v168, v23, v31
  s_waitcnt vmcnt(0)
  v_lshrrev_b32 v31, 4, v25
  v_mul_u32_u24 v31, 6144, v31
  v_add_u32 v31, 8388608, v31
  v_and_b32 v25, 15, v25
  v_mul_u32_u24 v25, 384, v25
  s_lshl4_add_u32 s44, s3, 5760
  v_mov_b32 v23, s44
  v_add_u32 v187, v23, v31
  v_add_u32_dpp v23, v25, v21 row_newbcast:0 row_mask:0xf bank_mask:0xf
  v_mov_b32_dpp v29, v31 row_newbcast:0 row_mask:0xf bank_mask:0xf
  v_add_u32 v172, v23, v29
  v_add_u32_dpp v23, v25, v21 row_newbcast:1 row_mask:0xf bank_mask:0xf
  v_mov_b32_dpp v29, v31 row_newbcast:1 row_mask:0xf bank_mask:0xf
  v_add_u32 v173, v23, v29
  v_add_u32_dpp v23, v25, v21 row_newbcast:2 row_mask:0xf bank_mask:0xf
  v_mov_b32_dpp v29, v31 row_newbcast:2 row_mask:0xf bank_mask:0xf
  v_add_u32 v174, v23, v29
  v_add_u32_dpp v23, v25, v21 row_newbcast:3 row_mask:0xf bank_mask:0xf
  v_mov_b32_dpp v29, v31 row_newbcast:3 row_mask:0xf bank_mask:0xf
  v_add_u32 v175, v23, v29
  v_add_u32_dpp v23, v25, v21 row_newbcast:4 row_mask:0xf bank_mask:0xf
  v_mov_b32_dpp v29, v31 row_newbcast:4 row_mask:0xf bank_mask:0xf
  v_add_u32 v176, v23, v29
  v_add_u32_dpp v23, v25, v21 row_newbcast:5 row_mask:0xf bank_mask:0xf
  v_mov_b32_dpp v29, v31 row_newbcast:5 row_mask:0xf bank_mask:0xf
  v_add_u32 v177, v23, v29
  v_add_u32_dpp v23, v25, v21 row_newbcast:6 row_mask:0xf bank_mask:0xf
  v_mov_b32_dpp v29, v31 row_newbcast:6 row_mask:0xf bank_mask:0xf
  v_add_u32 v178, v23, v29
  v_add_u32_dpp v23, v25, v21 row_newbcast:7 row_mask:0xf bank_mask:0xf
  v_mov_b32_dpp v29, v31 row_newbcast:7 row_mask:0xf bank_mask:0xf
  v_add_u32 v179, v23, v29
  v_add_u32_dpp v23, v25, v21 row_newbcast:8 row_mask:0xf bank_mask:0xf
  v_mov_b32_dpp v29, v31 row_newbcast:8 row_mask:0xf bank_mask:0xf
  v_add_u32 v180, v23, v29
  v_add_u32_dpp v23, v25, v21 row_newbcast:9 row_mask:0xf bank_mask:0xf
  v_mov_b32_dpp v29, v31 row_newbcast:9 row_mask:0xf bank_mask:0xf
  v_add_u32 v181, v23, v29
  v_add_u32_dpp v23, v25, v21 row_newbcast:10 row_mask:0xf bank_mask:0xf
  v_mov_b32_dpp v29, v31 row_newbcast:10 row_mask:0xf bank_mask:0xf
  v_add_u32 v182, v23, v29
  v_add_u32_dpp v23, v25, v21 row_newbcast:11 row_mask:0xf bank_mask:0xf
  v_mov_b32_dpp v29, v31 row_newbcast:11 row_mask:0xf bank_mask:0xf
  v_add_u32 v183, v23, v29
  v_add_u32_dpp v23, v25, v21 row_newbcast:12 row_mask:0xf bank_mask:0xf
  v_mov_b32_dpp v29, v31 row_newbcast:12 row_mask:0xf bank_mask:0xf
  v_add_u32 v184, v23, v29
  v_add_u32_dpp v23, v25, v21 row_newbcast:13 row_mask:0xf bank_mask:0xf
  v_mov_b32_dpp v29, v31 row_newbcast:13 row_mask:0xf bank_mask:0xf
  v_add_u32 v185, v23, v29
  v_add_u32_dpp v23, v25, v21 row_newbcast:14 row_mask:0xf bank_mask:0xf
  v_mov_b32_dpp v29, v31 row_newbcast:14 row_mask:0xf bank_mask:0xf
  v_add_u32 v186, v23, v29
  v_mov_b32 v108, -1
  v_mov_b32 v109, -1
  v_mov_b32 v110, -1
  v_mov_b32 v111, -1
  s_lshl4_add_u32 s44, s3, 118912
  v_mov_b32 v23, s44
  ds_write_b128 v28, v[108:111] offset:5376
  ds_write_b32 v23, v38 offset:12
L_hp:
  s_min_u32 s44, s3, 13
  s_cmp_eq_u32 s44, s43
  s_cbranch_scc0 L_hc_ok
L_hc:
  global_load_dword v104, v37, s[28:29] sc1
  s_waitcnt vmcnt(0)
  v_cmp_ne_u32 s[64:65], 1, v104
  s_cmp_eq_u64 s[64:65], 0
  s_cbranch_scc1 L_hc_ok
  s_cmp_eq_u32 s94, 0
  s_cbranch_scc1 L_hc_ok
  s_sub_u32 s94, s94, 1
  s_sleep 64
  s_branch L_hc
L_hc_ok:
  s_lshl_b32 s68, s43, 2
  s_lshr_b64 s[64:65], s[92:93], s68
  s_and_b32 s68, s64, 15
  s_lshl4_add_u32 s44, s68, 118912
  v_mov_b32 v23, s44
  s_cmp_eq_u32 s43, 14
  s_cbranch_scc0 L_hp_mid
  ds_read_b128 v[144:147], v30 offset:0
  ds_read_b128 v[148:151], v30 offset:1024
  ds_read_b128 v[152:155], v30 offset:2048
  ds_read_b128 v[156:159], v30 offset:3072
  ds_read_b128 v[160:163], v30 offset:4096
  ds_read_b128 v[164:167], v30 offset:5120
L_hm:
  ds_read_b32 v104, v14 offset:24
  s_waitcnt lgkmcnt(0)
  v_readfirstlane_b32 s46, v104
  s_cmp_ge_u32 s46, 14
  s_cbranch_scc1 L_hm_ok
  s_cmp_eq_u32 s94, 0
  s_cbranch_scc1 L_hm_ok
  s_sub_u32 s94, s94, 1
  s_sleep 1
  s_branch L_hm
L_hm_ok:
  global_store_dwordx4 v188, v[144:147], s[30:31] sc1
  global_store_dwordx4 v189, v[148:151], s[30:31] sc1
  global_store_dwordx4 v190, v[152:155], s[30:31] sc1
  global_store_dwordx4 v191, v[156:159], s[30:31] sc1
  global_store_dwordx4 v192, v[160:163], s[30:31] sc1
  s_mov_b32 exec_hi, 0xffffff
  global_store_dwordx4 v193, v[164:167], s[30:31] sc1
  s_mov_b64 exec, 7
  s_waitcnt vmcnt(0)
  global_atomic_add v36, v38, s[30:31] sc1
  s_mov_b64 exec, -1
L_hp_mid:
  s_add_u32 s43, s43, 1
  s_add_u32 s47, s43, 16
L_hpw:
  ds_read_b128 v[104:107], v14 offset:0
  s_waitcnt lgkmcnt(0)
  v_min_u32 v104, v104, v105
  v_min3_u32 v104, v104, v106, v107
  s_nop 0
  v_readfirstlane_b32 s46, v104
  s_cmp_ge_u32 s46, s47
  s_cbranch_scc1 L_hpw_ok
  s_cmp_eq_u32 s94, 0
  s_cbranch_scc1 L_hpw_ok
  s_sub_u32 s94, s94, 1
  s_sleep 1
  s_branch L_hpw
L_hpw_ok:
  s_bitcmp1_b32 s80, s47
  s_cbranch_scc0 L_fap
  s_lshl_b64 exec, 1, s47
  s_mul_i32 s44, s47, 384
  s_add_u32 s44, s44, 7864320
  s_mov_b32 s78, 1
  s_atomic_add s78, s[30:31], s44 glc
  s_mov_b64 exec, -1
L_fap:
  ds_read_b128 v[72:75], v196 offset:0
  ds_read_b128 v[76:79], v196 offset:16
  ds_read_b128 v[80:83], v197 offset:768
  ds_read_b128 v[84:87], v197 offset:784
  ds_read_b128 v[88:91], v198 offset:1536
  ds_read_b128 v[92:95], v198 offset:1552
  ds_read_b128 v[96:99], v196 offset:2304
  ds_read_b128 v[100:103], v196 offset:2320
  ds_read_b128 v[48:51], v23
  s_waitcnt lgkmcnt(0)
  v_pk_add_f32 v[72:73], v[72:73], v[80:81]
  v_pk_add_f32 v[88:89], v[88:89], v[96:97]
  v_pk_add_f32 v[74:75], v[74:75], v[82:83]
  v_pk_add_f32 v[90:91], v[90:91], v[98:99]
  v_pk_add_f32 v[76:77], v[76:77], v[84:85]
  v_pk_add_f32 v[92:93], v[92:93], v[100:101]
  v_pk_add_f32 v[78:79], v[78:79], v[86:87]
  v_pk_add_f32 v[94:95], v[94:95], v[102:103]
  v_pk_add_f32 v[72:73], v[72:73], v[88:89]
  v_pk_add_f32 v[74:75], v[74:75], v[90:91]
  v_pk_add_f32 v[76:77], v[76:77], v[92:93]
  v_pk_add_f32 v[78:79], v[78:79], v[94:95]
  v_pk_add_f32 v[72:73], v[72:73], v[50:51] op_sel_hi:[1,0] neg_lo:[0,1] neg_hi:[0,1]
  v_pk_add_f32 v[74:75], v[74:75], v[50:51] op_sel_hi:[1,0] neg_lo:[0,1] neg_hi:[0,1]
  v_pk_add_f32 v[76:77], v[76:77], v[50:51] op_sel_hi:[1,0] neg_lo:[0,1] neg_hi:[0,1]
  v_pk_add_f32 v[78:79], v[78:79], v[50:51] op_sel_hi:[1,0] neg_lo:[0,1] neg_hi:[0,1]
  v_max3_f32 v25, |v72|, |v73|, |v74|
  v_max3_f32 v25, v25, |v75|, |v76|
  v_max3_f32 v25, v25, |v77|, |v78|
  v_max_f32_e64 v25, v25, |v79|
  s_nop 1
  v_max_f32_dpp v25, v25, v25 row_ror:8 row_mask:0xf bank_mask:0xf
  s_nop 1
  v_max_f32_dpp v25, v25, v25 row_ror:4 row_mask:0xf bank_mask:0xf
  s_nop 1
  v_max_f32_dpp v25, v25, v25 row_ror:2 row_mask:0xf bank_mask:0xf
  s_nop 1
  v_max_f32_dpp v25, v25, v25 row_ror:1 row_mask:0xf bank_mask:0xf
  v_mov_b32 v29, v25
  s_nop 1
  v_permlane16_swap_b32 v25, v29
  v_max_f32 v25, v25, v29
  v_mov_b32 v29, v25
  s_nop 1
  v_permlane32_swap_b32 v25, v29
  v_max_f32 v25, v25, v29
  v_frexp_exp_i32_f32 v25, v25
  v_sub_u32 v29, 14, v25
  v_add_u32 v51, 242, v25
  v_ldexp_f32 v72, v72, v29
  v_ldexp_f32 v73, v73, v29
  v_ldexp_f32 v74, v74, v29
  v_ldexp_f32 v75, v75, v29
  v_ldexp_f32 v76, v76, v29
  v_ldexp_f32 v77, v77, v29
  v_ldexp_f32 v78, v78, v29
  v_ldexp_f32 v79, v79, v29
  v_cvt_pk_f16_f32 v108, v72, v73
  v_cvt_pk_f16_f32 v109, v74, v75
  v_cvt_pk_f16_f32 v110, v76, v77
  v_cvt_pk_f16_f32 v111, v78, v79
  v_min_u32 v108, -2, v108
  v_min_u32 v109, -2, v109
  v_min_u32 v110, -2, v110
  v_min_u32 v111, -2, v111
  s_cmp_eq_u32 s43, 15
  s_cbranch_scc1 L_hp_last
  ds_write_b32 v23, v51 offset:12
  v_add_u32 v196, 3072, v196
  v_add_u32 v197, 3072, v197
  v_add_u32 v198, 3072, v198
  ds_write_b128 v28, v[108:111]
  v_add_u32 v28, 384, v28
  s_bitcmp1_b32 s80, s47
  s_cbranch_scc0 L_fbp
  s_waitcnt vmcnt(0) lgkmcnt(0)
  v_sub_u32 v42, s78, v40
  s_nop 0
  v_readlane_b32 s46, v42, s47
  s_min_u32 s46, s46, 15
  s_lshl_b32 s46, s46, 1
  s_sub_u32 s46, s46, 15
  s_cmp_le_u32 s47, 0
  s_cselect_b32 s44, 9, 6
  s_mul_i32 s46, s46, s44
  s_add_u32 s46, s46, s95
  s_add_u32 s46, s46, 8
  s_ashr_i32 s46, s46, 4
  v_mov_b32 v42, s46
  s_mov_b64 exec, 1
  global_store_dword v43, v42, s[30:31]
  s_mov_b64 exec, -1
L_fbp:
  s_branch L_hp
L_hp_last:
  v_cndmask_b32 v108, v48, v108, vcc
  v_cndmask_b32 v109, v49, v109, vcc
  v_cndmask_b32 v110, v50, v110, vcc
  v_cndmask_b32 v111, v51, v111, vcc
  s_mov_b64 exec, 0x1ffffff
  global_store_dwordx4 v168, v[108:111], s[30:31] sc1
  s_mov_b64 exec, 1
L_hw:
  global_atomic_add v68, v36, v14, s[30:31] sc0 sc1
  s_waitcnt vmcnt(0)
  v_readfirstlane_b32 s46, v68
  s_cmp_ge_u32 s46, 16
  s_cbranch_scc1 L_hw_ok
  s_cmp_eq_u32 s94, 0
  s_cbranch_scc1 L_hw_ok
  s_sub_u32 s94, s94, 1
  s_branch L_hw
L_hw_ok:
  s_mov_b64 exec, -1
L_hg:
  global_load_dwordx4 v[52:55], v187, s[30:31] sc1
  global_load_dwordx2 v[112:113], v172, s[30:31] sc1
  global_load_dwordx2 v[114:115], v173, s[30:31] sc1
  global_load_dwordx2 v[116:117], v174, s[30:31] sc1
  global_load_dwordx2 v[118:119], v175, s[30:31] sc1
  global_load_dwordx2 v[120:121], v176, s[30:31] sc1
  global_load_dwordx2 v[122:123], v177, s[30:31] sc1
  global_load_dwordx2 v[124:125], v178, s[30:31] sc1
  global_load_dwordx2 v[126:127], v179, s[30:31] sc1
  global_load_dwordx2 v[128:129], v180, s[30:31] sc1
  global_load_dwordx2 v[130:131], v181, s[30:31] sc1
  global_load_dwordx2 v[132:133], v182, s[30:31] sc1
  global_load_dwordx2 v[134:135], v183, s[30:31] sc1
  global_load_dwordx2 v[136:137], v184, s[30:31] sc1
  global_load_dwordx2 v[138:139], v185, s[30:31] sc1
  global_load_dwordx2 v[140:141], v186, s[30:31] sc1
  s_waitcnt vmcnt(0)
  v_mov_b32 v24, v55
  v_max3_u32 v24, v24, v112, v113
  v_max3_u32 v24, v24, v114, v115
  v_max3_u32 v24, v24, v116, v117
  v_max3_u32 v24, v24, v118, v119
  v_max3_u32 v24, v24, v120, v121
  v_max3_u32 v24, v24, v122, v123
  v_max3_u32 v24, v24, v124, v125
  v_max3_u32 v24, v24, v126, v127
  v_max3_u32 v24, v24, v128, v129
  v_max3_u32 v24, v24, v130, v131
  v_max3_u32 v24, v24, v132, v133
  v_max3_u32 v24, v24, v134, v135
  v_max3_u32 v24, v24, v136, v137
  v_max3_u32 v24, v24, v138, v139
  v_max3_u32 v24, v24, v140, v141
  v_cmp_eq_u32 s[64:65], -1, v24
  s_cmp_eq_u64 s[64:65], 0
  s_cbranch_scc1 L_hg_ok
  s_cmp_eq_u32 s94, 0
  s_cbranch_scc1 L_hg_ok
  s_sub_u32 s94, s94, 1
  s_branch L_hg
L_hg_ok:
  v_subrev_u32 v196, 256, v35
  v_add_u32 v197, 512, v35
  v_min_u32 v197, v196, v197
  v_add_u32 v197, 110080, v197
  v_subrev_u32 v196, 512, v35
  v_add_u32 v198, 256, v35
  v_min_u32 v198, v196, v198
  v_add_u32 v198, 110080, v198
  v_add_u32 v196, 110080, v35
  v_mov_b32 v24, v52
  s_nop 1
  v_max_f32_dpp v24, v24, v24 row_ror:8 row_mask:0xf bank_mask:0xf
  s_nop 1
  v_max_f32_dpp v24, v24, v24 row_ror:4 row_mask:0xf bank_mask:0xf
  s_nop 1
  v_max_f32_dpp v24, v24, v24 row_ror:2 row_mask:0xf bank_mask:0xf
  s_nop 1
  v_max_f32_dpp v24, v24, v24 row_ror:1 row_mask:0xf bank_mask:0xf
  v_sub_f32 v24, v52, v24
  v_exp_f32 v24, v24
  v_subrev_u32 v55, 256, v55
  v_mul_f32 v25, v24, v53
  s_nop 1
  v_add_f32_dpp v25, v25, v25 row_ror:8 row_mask:0xf bank_mask:0xf
  s_nop 1
  v_add_f32_dpp v25, v25, v25 row_ror:4 row_mask:0xf bank_mask:0xf
  s_nop 1
  v_add_f32_dpp v25, v25, v25 row_ror:2 row_mask:0xf bank_mask:0xf
  s_nop 1
  v_add_f32_dpp v25, v25, v25 row_ror:1 row_mask:0xf bank_mask:0xf
  v_rcp_f32 v25, v25
  s_nop 0
  v_mul_f32 v24, v24, v25
  v_ldexp_f32 v25, v24, v55
  v_mul_f32_e64 v54, v24, -v54
  v_readlane_b32 s63, v24, 15
  v_readlane_b32 s44, v54, 15
  v_readlane_b32 s48, v25, 0
  v_readlane_b32 s49, v25, 1
  v_readlane_b32 s50, v25, 2
  v_readlane_b32 s51, v25, 3
  v_readlane_b32 s52, v25, 4
  v_readlane_b32 s53, v25, 5
  v_readlane_b32 s54, v25, 6
  v_readlane_b32 s55, v25, 7
  v_readlane_b32 s56, v25, 8
  v_readlane_b32 s57, v25, 9
  v_readlane_b32 s58, v25, 10
  v_readlane_b32 s59, v25, 11
  v_readlane_b32 s60, v25, 12
  v_readlane_b32 s61, v25, 13
  v_readlane_b32 s62, v25, 14
  v_mov_b32 v108, s44
  v_mov_b32 v109, s44
  v_mov_b32 v110, s44
  v_mov_b32 v111, s44
  v_fma_mix_f32 v108, v112, s48, v108 op_sel:[0,0,0] op_sel_hi:[1,0,0]
  v_fma_mix_f32 v109, v112, s48, v109 op_sel:[1,0,0] op_sel_hi:[1,0,0]
  v_fma_mix_f32 v110, v113, s48, v110 op_sel:[0,0,0] op_sel_hi:[1,0,0]
  v_fma_mix_f32 v111, v113, s48, v111 op_sel:[1,0,0] op_sel_hi:[1,0,0]
  v_fma_mix_f32 v108, v114, s49, v108 op_sel:[0,0,0] op_sel_hi:[1,0,0]
  v_fma_mix_f32 v109, v114, s49, v109 op_sel:[1,0,0] op_sel_hi:[1,0,0]
  v_fma_mix_f32 v110, v115, s49, v110 op_sel:[0,0,0] op_sel_hi:[1,0,0]
  v_fma_mix_f32 v111, v115, s49, v111 op_sel:[1,0,0] op_sel_hi:[1,0,0]
  v_fma_mix_f32 v108, v116, s50, v108 op_sel:[0,0,0] op_sel_hi:[1,0,0]
  v_fma_mix_f32 v109, v116, s50, v109 op_sel:[1,0,0] op_sel_hi:[1,0,0]
  v_fma_mix_f32 v110, v117, s50, v110 op_sel:[0,0,0] op_sel_hi:[1,0,0]
  v_fma_mix_f32 v111, v117, s50, v111 op_sel:[1,0,0] op_sel_hi:[1,0,0]
  v_fma_mix_f32 v108, v118, s51, v108 op_sel:[0,0,0] op_sel_hi:[1,0,0]
  v_fma_mix_f32 v109, v118, s51, v109 op_sel:[1,0,0] op_sel_hi:[1,0,0]
  v_fma_mix_f32 v110, v119, s51, v110 op_sel:[0,0,0] op_sel_hi:[1,0,0]
  v_fma_mix_f32 v111, v119, s51, v111 op_sel:[1,0,0] op_sel_hi:[1,0,0]
  v_fma_mix_f32 v108, v120, s52, v108 op_sel:[0,0,0] op_sel_hi:[1,0,0]
  v_fma_mix_f32 v109, v120, s52, v109 op_sel:[1,0,0] op_sel_hi:[1,0,0]
  v_fma_mix_f32 v110, v121, s52, v110 op_sel:[0,0,0] op_sel_hi:[1,0,0]
  v_fma_mix_f32 v111, v121, s52, v111 op_sel:[1,0,0] op_sel_hi:[1,0,0]
  v_fma_mix_f32 v108, v122, s53, v108 op_sel:[0,0,0] op_sel_hi:[1,0,0]
  v_fma_mix_f32 v109, v122, s53, v109 op_sel:[1,0,0] op_sel_hi:[1,0,0]
  v_fma_mix_f32 v110, v123, s53, v110 op_sel:[0,0,0] op_sel_hi:[1,0,0]
  v_fma_mix_f32 v111, v123, s53, v111 op_sel:[1,0,0] op_sel_hi:[1,0,0]
  v_fma_mix_f32 v108, v124, s54, v108 op_sel:[0,0,0] op_sel_hi:[1,0,0]
  v_fma_mix_f32 v109, v124, s54, v109 op_sel:[1,0,0] op_sel_hi:[1,0,0]
  v_fma_mix_f32 v110, v125, s54, v110 op_sel:[0,0,0] op_sel_hi:[1,0,0]
  v_fma_mix_f32 v111, v125, s54, v111 op_sel:[1,0,0] op_sel_hi:[1,0,0]
  v_fma_mix_f32 v108, v126, s55, v108 op_sel:[0,0,0] op_sel_hi:[1,0,0]
  v_fma_mix_f32 v109, v126, s55, v109 op_sel:[1,0,0] op_sel_hi:[1,0,0]
  v_fma_mix_f32 v110, v127, s55, v110 op_sel:[0,0,0] op_sel_hi:[1,0,0]
  v_fma_mix_f32 v111, v127, s55, v111 op_sel:[1,0,0] op_sel_hi:[1,0,0]
  v_fma_mix_f32 v108, v128, s56, v108 op_sel:[0,0,0] op_sel_hi:[1,0,0]
  v_fma_mix_f32 v109, v128, s56, v109 op_sel:[1,0,0] op_sel_hi:[1,0,0]
  v_fma_mix_f32 v110, v129, s56, v110 op_sel:[0,0,0] op_sel_hi:[1,0,0]
  v_fma_mix_f32 v111, v129, s56, v111 op_sel:[1,0,0] op_sel_hi:[1,0,0]
  v_fma_mix_f32 v108, v130, s57, v108 op_sel:[0,0,0] op_sel_hi:[1,0,0]
  v_fma_mix_f32 v109, v130, s57, v109 op_sel:[1,0,0] op_sel_hi:[1,0,0]
  v_fma_mix_f32 v110, v131, s57, v110 op_sel:[0,0,0] op_sel_hi:[1,0,0]
  v_fma_mix_f32 v111, v131, s57, v111 op_sel:[1,0,0] op_sel_hi:[1,0,0]
  v_fma_mix_f32 v108, v132, s58, v108 op_sel:[0,0,0] op_sel_hi:[1,0,0]
  v_fma_mix_f32 v109, v132, s58, v109 op_sel:[1,0,0] op_sel_hi:[1,0,0]
  v_fma_mix_f32 v110, v133, s58, v110 op_sel:[0,0,0] op_sel_hi:[1,0,0]
  v_fma_mix_f32 v111, v133, s58, v111 op_sel:[1,0,0] op_sel_hi:[1,0,0]
  v_fma_mix_f32 v108, v134, s59, v108 op_sel:[0,0,0] op_sel_hi:[1,0,0]
  v_fma_mix_f32 v109, v134, s59, v109 op_sel:[1,0,0] op_sel_hi:[1,0,0]
  v_fma_mix_f32 v110, v135, s59, v110 op_sel:[0,0,0] op_sel_hi:[1,0,0]
  v_fma_mix_f32 v111, v135, s59, v111 op_sel:[1,0,0] op_sel_hi:[1,0,0]
  v_fma_mix_f32 v108, v136, s60, v108 op_sel:[0,0,0] op_sel_hi:[1,0,0]
  v_fma_mix_f32 v109, v136, s60, v109 op_sel:[1,0,0] op_sel_hi:[1,0,0]
  v_fma_mix_f32 v110, v137, s60, v110 op_sel:[0,0,0] op_sel_hi:[1,0,0]
  v_fma_mix_f32 v111, v137, s60, v111 op_sel:[1,0,0] op_sel_hi:[1,0,0]
  v_fma_mix_f32 v108, v138, s61, v108 op_sel:[0,0,0] op_sel_hi:[1,0,0]
  v_fma_mix_f32 v109, v138, s61, v109 op_sel:[1,0,0] op_sel_hi:[1,0,0]
  v_fma_mix_f32 v110, v139, s61, v110 op_sel:[0,0,0] op_sel_hi:[1,0,0]
  v_fma_mix_f32 v111, v139, s61, v111 op_sel:[1,0,0] op_sel_hi:[1,0,0]
  v_fma_mix_f32 v108, v140, s62, v108 op_sel:[0,0,0] op_sel_hi:[1,0,0]
  v_fma_mix_f32 v109, v140, s62, v109 op_sel:[1,0,0] op_sel_hi:[1,0,0]
  v_fma_mix_f32 v110, v141, s62, v110 op_sel:[0,0,0] op_sel_hi:[1,0,0]
  v_fma_mix_f32 v111, v141, s62, v111 op_sel:[1,0,0] op_sel_hi:[1,0,0]
  s_mov_b32 exec_hi, 0xffff
  s_barrier
  ds_read_b128 v[72:75], v196 offset:0
  ds_read_b128 v[76:79], v197 offset:768
  ds_read_b128 v[80:83], v198 offset:1536
  ds_read_b128 v[84:87], v196 offset:2304
  s_waitcnt lgkmcnt(3)
  v_fmac_f32 v108, s63, v72
  v_fmac_f32 v109, s63, v73
  v_fmac_f32 v110, s63, v74
  v_fmac_f32 v111, s63, v75
  s_waitcnt lgkmcnt(2)
  v_fmac_f32 v108, s63, v76
  v_fmac_f32 v109, s63, v77
  v_fmac_f32 v110, s63, v78
  v_fmac_f32 v111, s63, v79
  s_waitcnt lgkmcnt(1)
  v_fmac_f32 v108, s63, v80
  v_fmac_f32 v109, s63, v81
  v_fmac_f32 v110, s63, v82
  v_fmac_f32 v111, s63, v83
  s_waitcnt lgkmcnt(0)
  v_fmac_f32 v108, s63, v84
  v_fmac_f32 v109, s63, v85
  v_fmac_f32 v110, s63, v86
  v_fmac_f32 v111, s63, v87
  v_cvt_pk_bf16_f32 v108, v108, v109
  v_cvt_pk_bf16_f32 v109, v110, v111
  global_store_dwordx2 v21, v[108:109], s[26:27]
L_end:
  s_endpgm
.p2align 6
.type L_order,@object
L_order:
  .long 0x76afedcb, 0x24351098, 0x200000, 0x500, 0x20, 0x251200, 0x2, 0x0
  .long 0x2c001c, 0x4c003c, 0x6c005c, 0x8c007c, 0xac009c, 0xcc00bc, 0xec00dc, 0xf00fc
  .long 0x56afedcb, 0x74321098, 0xe00000, 0x0, 0x70, 0x201e00, 0x7, 0x0
  .long 0x270007, 0x470037, 0x670057, 0x870077, 0xa70097, 0xc700b7, 0xe700d7, 0x1f00f7
  .long 0x765fedcb, 0xa4321098, 0xd00000, 0xf00, 0xaf, 0x1d002f, 0xa, 0x0
  .long 0xa10042, 0x37000c4, 0x53103f4, 0x80205b2, 0xa140881, 0xd540a91, 0xdd20d61, 0x2f0de3
  .long 0x75afedcb, 0x64321098, 0x500000, 0x400, 0x60, 0x241500, 0x6, 0x0
  .long 0x160006, 0x460026, 0x660056, 0x860076, 0xa60096, 0xc600b6, 0xe600d6, 0x3f00f6
  .long 0x765feacb, 0xd4321098, 0x900000, 0xf00, 0xd0, 0x2f1900, 0xd, 0x0
  .long 0x120002, 0x320022, 0x620052, 0x820072, 0xa20092, 0xc200b2, 0xe200d2, 0x4f00f2
  .long 0x765fadcb, 0xe4321098, 0x800000, 0xc00, 0xe0, 0x2c1800, 0xe, 0x0
  .long 0x130003, 0x330023, 0x630043, 0x830073, 0xa30093, 0xc300b3, 0xe300d3, 0x5f00f3
  .long 0x76afedcb, 0x34521098, 0x300000, 0x700, 0x30, 0x271300, 0x3, 0x0
  .long 0x1d000d, 0x3d002d, 0x5d004d, 0x8d007d, 0xad009d, 0xcd00bd, 0xed00dd, 0x6f00fd
  .long 0x76afedcb, 0x54321098, 0x400000, 0x400, 0x54, 0x240014, 0x5, 0x0
  .long 0x1ca00fb, 0x68e060c, 0xa3e084a, 0xaea0abc, 0xc6d0bdc, 0xe2d0e1c, 0xe9e0e5b, 0x7f0eaa
  .long 0x76afedcb, 0x45321098, 0x200000, 0x500, 0x40, 0x251200, 0x4, 0x0
  .long 0x1e000e, 0x3e002e, 0x5e004e, 0x7e006e, 0xae009e, 0xce00be, 0xee00de, 0x8f00fe
  .long 0x76afedcb, 0x84321095, 0xe00000, 0x0, 0x80, 0x201e00, 0x8, 0x0
  .long 0x180008, 0x380028, 0x580048, 0x780068, 0xa80088, 0xc800b8, 0xe800d8, 0x9f00f8
  .long 0x765fedab, 0xc4321098, 0xd00000, 0xf00, 0xc0, 0x2f1d00, 0xc, 0x0
  .long 0x110001, 0x310021, 0x510041, 0x710061, 0x910081, 0xc100b1, 0xe100d1, 0xaf00f1
  .long 0x76afedcb, 0x94321058, 0x500000, 0x400, 0x90, 0x241500, 0x9, 0x0
  .long 0x190009, 0x390029, 0x590049, 0x790069, 0x990089, 0xc900a9, 0xe900d9, 0xbf00f9
  .long 0x765aedcb, 0xf4321098, 0x900000, 0xf00, 0xf0, 0x2f1900, 0xf, 0x0
  .long 0x140004, 0x340024, 0x540044, 0x740064, 0x940084, 0xb400a4, 0xe400d4, 0xcf00f4
  .long 0x765fedca, 0xb4321098, 0x800000, 0xc00, 0xb0, 0x2c1800, 0xb, 0x0
  .long 0x100000, 0x300020, 0x500040, 0x700060, 0x900080, 0xb000a0, 0xe000c0, 0xdf00f0
  .long 0x76afedcb, 0x4321598, 0x300000, 0x700, 0x0, 0x271300, 0x0, 0x0
  .long 0x1a000a, 0x3a002a, 0x5a004a, 0x7a006a, 0x9a008a, 0xba00aa, 0xda00ca, 0xef00fa
  .long 0x76afedcb, 0x14325098, 0x400000, 0x400, 0x10, 0x241400, 0x1, 0x0
  .long 0x1b000b, 0x3b002b, 0x5b004b, 0x7b006b, 0x9b008b, 0xbb00ab, 0xdb00cb, 0xff00eb
  .long 0x765fadcb, 0xe4321098, 0x11b11111, 0x11111e11, 0xe1, 0x2e1b01, 0xe, 0x0
  .long 0x1230113, 0x1430133, 0x1630153, 0x1830173, 0x1a30193, 0x1c301b3, 0x1e301d3, 0x10f01f3
  .long 0x765fedcb, 0x8432109a, 0x11c11111, 0x11111911, 0x81, 0x291c01, 0x8, 0x0
  .long 0x1280108, 0x1480138, 0x1680158, 0x1880178, 0x1a80198, 0x1c801b8, 0x1e801d8, 0x11f01f8
  .long 0x76afedcb, 0x94321058, 0x11911111, 0x11111711, 0x91, 0x271901, 0x9, 0x0
  .long 0x1190109, 0x1490139, 0x1690159, 0x1890179, 0x1a90199, 0x1c901b9, 0x1e901d9, 0x12f01f9
  .long 0x765aedcb, 0xf4321098, 0x11911111, 0x11111d11, 0xf1, 0x2d1901, 0xf, 0x0
  .long 0x1140104, 0x1440124, 0x1640154, 0x1840174, 0x1a40194, 0x1c401b4, 0x1e401d4, 0x13f01f4
  .long 0x765fedab, 0xc4321098, 0x11a11111, 0x11111d11, 0xc1, 0x2d1a01, 0xc, 0x0
  .long 0x1110101, 0x1310121, 0x1610151, 0x1810171, 0x1a10191, 0x1c101b1, 0x1e101d1, 0x14f01f1
  .long 0x76afedcb, 0x34521098, 0x11311111, 0x11111511, 0x31, 0x251301, 0x3, 0x0
  .long 0x11d010d, 0x13d012d, 0x16d014d, 0x18d017d, 0x1ad019d, 0x1cd01bd, 0x1ed01dd, 0x15f01fd
  .long 0xa65fedcb, 0x74321098, 0x11911111, 0x11111511, 0x71, 0x251901, 0x7, 0x0
  .long 0x1170107, 0x1370127, 0x1570147, 0x1870177, 0x1a70197, 0x1c701b7, 0x1e701d7, 0x16f01f7
  .long 0x76afedcb, 0x24351098, 0x11011111, 0x11111211, 0x21, 0x221001, 0x2, 0x0
  .long 0x11c010c, 0x13c012c, 0x15c014c, 0x18c016c, 0x1ac019c, 0x1cc01bc, 0x1ec01dc, 0x17f01fc
  .long 0x765fedca, 0xb4321098, 0x11b11111, 0x11111e11, 0xb1, 0x2e1b01, 0xb, 0x0
  .long 0x1100100, 0x1300120, 0x1500140, 0x1700160, 0x1a00190, 0x1c001b0, 0x1e001d0, 0x18f01f0
  .long 0x7a5fedcb, 0x64321098, 0x11c11111, 0x11111911, 0x61, 0x291c01, 0x6, 0x0
  .long 0x1160106, 0x1360126, 0x1560146, 0x1760166, 0x1a60186, 0x1c601b6, 0x1e601d6, 0x19f01f6
  .long 0x76afedcb, 0x54321098, 0x11911111, 0x11111711, 0x59, 0x270119, 0x5, 0x0
  .long 0xc50045, 0x1350129, 0x1b50165, 0x25601e5, 0xd1502d7, 0xe050d95, 0xf750e85, 0x1af0ff5
  .long 0x765feacb, 0xd4321098, 0x11911111, 0x11111d11, 0xd1, 0x2d1901, 0xd, 0x0
  .long 0x1120102, 0x1320122, 0x1520142, 0x1720162, 0x1920182, 0x1c201a2, 0x1e201d2, 0x1bf01f2
  .long 0x76afedcb, 0x4321598, 0x11411111, 0x11111211, 0x1, 0x221401, 0x0, 0x0
  .long 0x11a010a, 0x13a012a, 0x15a014a, 0x17a016a, 0x19a018a, 0x1ba01aa, 0x1ea01da, 0x1cf01fa
  .long 0x76afedcb, 0x14325098, 0x11311111, 0x11111511, 0x11, 0x251301, 0x1, 0x0
  .long 0x11b010b, 0x13b012b, 0x15b014b, 0x17b016b, 0x19b018b, 0x1bb01ab, 0x1eb01cb, 0x1df01fb
  .long 0x765fedcb, 0xa4321098, 0x11911111, 0x11111511, 0xa5, 0x190125, 0xa, 0x0
  .long 0x850005, 0x1670155, 0x42501d5, 0x91504a5, 0x9950975, 0xc4509f5, 0xe350cc5, 0x1ef0eb5
  .long 0x76afedcb, 0x45321098, 0x11011111, 0x11111211, 0x41, 0x221001, 0x4, 0x0
  .long 0x11e010e, 0x13e012e, 0x15e014e, 0x17e016e, 0x19e018e, 0x1be01ae, 0x1de01ce, 0x1ff01ee
  .long 0x76afedcb, 0x34521098, 0x22122222, 0x22222322, 0x32, 0x231102, 0x3, 0x0
  .long 0x22d021d, 0x24d023d, 0x26d025d, 0x28d027d, 0x2ad029d, 0x2cd02bd, 0x2ed02dd, 0x20f02fd
  .long 0x76afedcb, 0x54321098, 0x22f22222, 0x22222622, 0x5f, 0x26021f, 0x5, 0x0
  .long 0x2990235, 0x40502b5, 0x5250485, 0x66505a5, 0x74506e5, 0x7c50779, 0xf5507f7, 0x21f0fd5
  .long 0x765fedcb, 0xa4321098, 0x22822222, 0x22222622, 0xa6, 0x180226, 0xa, 0x0
  .long 0x2550215, 0x2a80295, 0x60502d5, 0x6450635, 0x6b50685, 0x77506c5, 0xb6507f5, 0x22f0be5
  .long 0x765aedcb, 0xf4321098, 0x22f22222, 0x22222c22, 0xf2, 0x2c1f02, 0xf, 0x0
  .long 0x2140204, 0x2440224, 0x2640254, 0x2840274, 0x2a40294, 0x2c402b4, 0x2e402d4, 0x23f02f4
  .long 0x76afedcb, 0x24351098, 0x22022222, 0x22222122, 0x22, 0x211002, 0x2, 0x0
  .long 0x21c020c, 0x23c022c, 0x26c025c, 0x28c027c, 0x2ac029c, 0x2cc02bc, 0x2ec02dc, 0x24f02fc
  .long 0x75afedcb, 0x64321098, 0x22922222, 0x22222622, 0x62, 0x261902, 0x6, 0x0
  .long 0x2160206, 0x2360226, 0x2660246, 0x2860276, 0x2a60296, 0x2c602b6, 0x2e602d6, 0x25f02f6
  .long 0x765feacb, 0xd4321098, 0x22a22222, 0x22222e22, 0xd2, 0x2e1a02, 0xd, 0x0
  .long 0x2120202, 0x2320222, 0x2520242, 0x2820272, 0x2a20292, 0x2c202b2, 0x2e202d2, 0x26f02f2
  .long 0x76afedcb, 0x14325098, 0x22122222, 0x22222922, 0x12, 0x291102, 0x1, 0x0
  .long 0x21b020b, 0x23b022b, 0x25b024b, 0x28b026b, 0x2ab029b, 0x2cb02bb, 0x2eb02db, 0x27f02fb
  .long 0x76afedcb, 0x4321598, 0x22122222, 0x22222322, 0x2, 0x231102, 0x0, 0x0
  .long 0x21a020a, 0x23a022a, 0x25a024a, 0x27a026a, 0x2aa029a, 0x2ca02ba, 0x2ea02da, 0x28f02fa
  .long 0x76afedcb, 0x94321058, 0x22f22222, 0x22222622, 0x92, 0x261f02, 0x9, 0x0
  .long 0x2190209, 0x2390229, 0x2590249, 0x2790269, 0x2a90289, 0x2c902b9, 0x2e902d9, 0x29f02f9
  .long 0x765fedcb, 0x8432109a, 0x22822222, 0x22222622, 0x82, 0x261802, 0x8, 0x0
  .long 0x2180208, 0x2380228, 0x2580248, 0x2780268, 0x2980288, 0x2c802b8, 0x2e802d8, 0x2af02f8
  .long 0x765fedca, 0xb4321098, 0x22f22222, 0x22222c22, 0xb2, 0x2c1f02, 0xb, 0x0
  .long 0x2100200, 0x2300220, 0x2500240, 0x2700260, 0x2900280, 0x2c002a0, 0x2e002d0, 0x2bf02f0
  .long 0x76afedcb, 0x45321098, 0x22022222, 0x22222122, 0x42, 0x211002, 0x4, 0x0
  .long 0x21e020e, 0x23e022e, 0x25e024e, 0x27e026e, 0x29e028e, 0x2be02ae, 0x2ee02de, 0x2cf02fe
  .long 0x56afedcb, 0x74321098, 0x22922222, 0x22222622, 0x72, 0x261902, 0x7, 0x0
  .long 0x2170207, 0x2370227, 0x2570247, 0x2770267, 0x2970287, 0x2b702a7, 0x2e702c7, 0x2df02f7
  .long 0x765fadcb, 0xe4321098, 0x22a22222, 0x22222e22, 0xe2, 0x2e1a02, 0xe, 0x0
  .long 0x2130203, 0x2330223, 0x2530243, 0x2730263, 0x2930283, 0x2b302a3, 0x2d302c3, 0x2ef02f3
  .long 0x765fedab, 0xc4321098, 0x22b22222, 0x22222c22, 0xc2, 0x2c1b02, 0xc, 0x0
  .long 0x2110201, 0x2310221, 0x2510241, 0x2710261, 0x2910281, 0x2b102a1, 0x2d102c1, 0x2ff02e1
  .long 0xa65fedcb, 0x74321098, 0x33633333, 0x33333933, 0x73, 0x291603, 0x7, 0x0
  .long 0x3270317, 0x3470337, 0x3670357, 0x3870377, 0x3a70397, 0x3c703b7, 0x3e703d7, 0x30f03f7
  .long 0x765feacb, 0xd4321098, 0x33a33333, 0x33333e33, 0xd3, 0x2e1a03, 0xd, 0x0
  .long 0x3220302, 0x3420332, 0x3620352, 0x3820372, 0x3a20392, 0x3c203b2, 0x3e203d2, 0x31f03f2
  .long 0x76afedcb, 0x24351098, 0x33133333, 0x33333433, 0x23, 0x241103, 0x2, 0x0
  .long 0x31c030c, 0x34c033c, 0x36c035c, 0x38c037c, 0x3ac039c, 0x3cc03bc, 0x3ec03dc, 0x32f03fc
  .long 0x765fedab, 0xc4321098, 0x33e33333, 0x33333e33, 0xc3, 0x2e1e03, 0xc, 0x0
  .long 0x3110301, 0x3410321, 0x3610351, 0x3810371, 0x3a10391, 0x3c103b1, 0x3e103d1, 0x33f03f1
  .long 0x76afedcb, 0x54321098, 0x33333333, 0x33333333, 0x53, 0x230313, 0x5, 0x0
  .long 0xea006d, 0x1db015d, 0x81b03ca, 0x92e089d, 0x9aa093b, 0xb7e09bc, 0xd0e0bfb, 0x34f0d8a
  .long 0x75afedcb, 0x64321098, 0x33d33333, 0x33333833, 0x63, 0x281d03, 0x6, 0x0
  .long 0x3160306, 0x3360326, 0x3660346, 0x3860376, 0x3a60396, 0x3c603b6, 0x3e603d6, 0x35f03f6
  .long 0x76afedcb, 0x45321098, 0x33033333, 0x33333033, 0x43, 0x201003, 0x4, 0x0
  .long 0x31e030e, 0x33e032e, 0x35e034e, 0x38e037e, 0x3ae039e, 0x3ce03be, 0x3ee03de, 0x36f03fe
  .long 0x765fedca, 0xb4321098, 0x33833333, 0x33333f33, 0xb3, 0x2f1803, 0xb, 0x0
  .long 0x3100300, 0x3300320, 0x3500340, 0x3800360, 0x3a00390, 0x3c003b0, 0x3e003d0, 0x37f03f0
  .long 0x765fedcb, 0x8432109a, 0x33633333, 0x33333933, 0x83, 0x291603, 0x8, 0x0
  .long 0x3180308, 0x3380328, 0x3580348, 0x3780368, 0x3a80398, 0x3c803b8, 0x3e803d8, 0x38f03f8
  .long 0x765fedcb, 0xa4321098, 0x33a33333, 0x33333e33, 0xae, 0x1a032e, 0xa, 0x0
  .long 0x1800103, 0x2e30262, 0x3310312, 0x67103b3, 0x72306f4, 0x94407a1, 0xf5209c2, 0x39f0fd1
  .long 0x76afedcb, 0x34521098, 0x33133333, 0x33333433, 0x33, 0x241103, 0x3, 0x0
  .long 0x31d030d, 0x33d032d, 0x35d034d, 0x37d036d, 0x39d038d, 0x3cd03bd, 0x3ed03dd, 0x3af03fd
  .long 0x765fadcb, 0xe4321098, 0x33e33333, 0x33333e33, 0xe3, 0x2e1e03, 0xe, 0x0
  .long 0x3130303, 0x3330323, 0x3530343, 0x3730363, 0x3930383, 0x3c303a3, 0x3e303d3, 0x3bf03f3
  .long 0x76afedcb, 0x4321598, 0x33333333, 0x33333333, 0x3, 0x231303, 0x0, 0x0
  .long 0x31a030a, 0x33a032a, 0x35a034a, 0x37a036a, 0x39a038a, 0x3ba03aa, 0x3ea03da, 0x3cf03fa
  .long 0x76afedcb, 0x94321058, 0x33d33333, 0x33333833, 0x93, 0x281d03, 0x9, 0x0
  .long 0x3190309, 0x3390329, 0x3590349, 0x3790369, 0x3990389, 0x3b903a9, 0x3e903c9, 0x3df03f9
  .long 0x76afedcb, 0x14325098, 0x33033333, 0x33333033, 0x13, 0x201003, 0x1, 0x0
  .long 0x31b030b, 0x33b032b, 0x35b034b, 0x37b036b, 0x39b038b, 0x3bb03ab, 0x3db03cb, 0x3ef03fb
  .long 0x765aedcb, 0xf4321098, 0x33833333, 0x33333f33, 0xf3, 0x2f1803, 0xf, 0x0
  .long 0x3140304, 0x3340324, 0x3540344, 0x3740364, 0x3940384, 0x3b403a4, 0x3d403c4, 0x3ff03e4
  .long 0x7a5fedcb, 0x64321098, 0x44f44444, 0x44444044, 0x64, 0x201f04, 0x6, 0x0
  .long 0x4260416, 0x4460436, 0x4660456, 0x4860476, 0x4a60496, 0x4c604b6, 0x4e604d6, 0x40f04f6
  .long 0x76afedcb, 0x45321098, 0x44144444, 0x44444344, 0x44, 0x231104, 0x4, 0x0
  .long 0x42e040e, 0x44e043e, 0x46e045e, 0x48e047e, 0x4ae049e, 0x4ce04be, 0x4ee04de, 0x41f04fe
  .long 0x76afedcb, 0x34521098, 0x44244444, 0x44444544, 0x34, 0x251204, 0x3, 0x0
  .long 0x41d040d, 0x44d043d, 0x46d045d, 0x48d047d, 0x4ad049d, 0x4cd04bd, 0x4ed04dd, 0x42f04fd
  .long 0x76afedcb, 0x14325098, 0x44144444, 0x44444344, 0x14, 0x231104, 0x1, 0x0
  .long 0x41b040b, 0x44b042b, 0x46b045b, 0x48b047b, 0x4ab049b, 0x4cb04bb, 0x4eb04db, 0x43f04fb
  .long 0x765fadcb, 0xe4321098, 0x44744444, 0x44444c44, 0xe4, 0x2c1704, 0xe, 0x0
  .long 0x4130403, 0x4330423, 0x4630453, 0x4830473, 0x4a30493, 0x4c304b3, 0x4e304d3, 0x44f04f3
  .long 0x765fedcb, 0xa4321098, 0x44644444, 0x44444b44, 0xab, 0x16042b, 0xa, 0x0
  .long 0x52404d1, 0x70405a0, 0xa630782, 0xbb40b31, 0xc920c10, 0xe410ce1, 0xf700ec2, 0x45f0ff3
  .long 0xa65fedcb, 0x74321098, 0x44744444, 0x44444344, 0x74, 0x231704, 0x7, 0x0
  .long 0x4170407, 0x4370427, 0x4570447, 0x4870477, 0x4a70497, 0x4c704b7, 0x4e704d7, 0x46f04f7
  .long 0x765fedca, 0xb4321098, 0x44644444, 0x44444d44, 0xb4, 0x2d1604, 0xb, 0x0
  .long 0x4100400, 0x4300420, 0x4500440, 0x4800460, 0x4a00490, 0x4c004b0, 0x4e004d0, 0x47f04f0
  .long 0x765fedcb, 0x8432109a, 0x44f44444, 0x44444044, 0x84, 0x201f04, 0x8, 0x0
  .long 0x4180408, 0x4380428, 0x4580448, 0x4780468, 0x4a80498, 0x4c804b8, 0x4e804d8, 0x48f04f8
  .long 0x76afedcb, 0x54321098, 0x44144444, 0x44444344, 0x51, 0x230411, 0x5, 0x0
  .long 0x27b020d, 0x32c028a, 0x41e03ad, 0x4ba043b, 0xb6a05fe, 0xc5b0bed, 0xd4b0cdc, 0x49f0dcd
  .long 0x76afedcb, 0x24351098, 0x44244444, 0x44444544, 0x24, 0x251204, 0x2, 0x0
  .long 0x41c040c, 0x43c042c, 0x45c044c, 0x47c046c, 0x49c048c, 0x4cc04bc, 0x4ec04dc, 0x4af04fc
  .long 0x76afedcb, 0x4321598, 0x44144444, 0x44444344, 0x4, 0x231104, 0x0, 0x0
  .long 0x41a040a, 0x43a042a, 0x45a044a, 0x47a046a, 0x49a048a, 0x4ca04aa, 0x4ea04da, 0x4bf04fa
  .long 0x765aedcb, 0xf4321098, 0x44744444, 0x44444c44, 0xf4, 0x2c1704, 0xf, 0x0
  .long 0x4140404, 0x4340424, 0x4540444, 0x4740464, 0x4940484, 0x4b404a4, 0x4e404d4, 0x4cf04f4
  .long 0x765fedab, 0xc4321098, 0x44644444, 0x44444b44, 0xc4, 0x2b1604, 0xc, 0x0
  .long 0x4110401, 0x4310421, 0x4510441, 0x4710461, 0x4910481, 0x4b104a1, 0x4e104c1, 0x4df04f1
  .long 0x765fedcb, 0x943210a8, 0x44744444, 0x44444344, 0x94, 0x231704, 0x9, 0x0
  .long 0x4190409, 0x4390429, 0x4590449, 0x4790469, 0x4990489, 0x4b904a9, 0x4d904c9, 0x4ef04f9
  .long 0x765feacb, 0xd4321098, 0x44644444, 0x44444d44, 0xd4, 0x2d1604, 0xd, 0x0
  .long 0x4120402, 0x4320422, 0x4520442, 0x4720462, 0x4920482, 0x4b204a2, 0x4d204c2, 0x4ff04e2
  .long 0x76afedcb, 0x24351098, 0x55055555, 0x55555155, 0x25, 0x211005, 0x2, 0x0
  .long 0x52c051c, 0x54c053c, 0x56c055c, 0x58c057c, 0x5ac059c, 0x5cc05bc, 0x5ec05dc, 0x50f05fc
  .long 0x76afedcb, 0x54321098, 0x55b55555, 0x55555755, 0x5b, 0x27051b, 0x5, 0x0
  .long 0x1850105, 0x53502f5, 0x5980575, 0x72505b5, 0x95507a5, 0xe4509d5, 0xf650ec5, 0x51f0fe5
  .long 0x765aedcb, 0xf4321098, 0x55f55555, 0x55555b55, 0xf5, 0x2b1f05, 0xf, 0x0
  .long 0x5140504, 0x5440534, 0x5640554, 0x5840574, 0x5a40594, 0x5c405b4, 0x5e405d4, 0x52f05f4
  .long 0x765fedab, 0xc4321098, 0x55b55555, 0x55555f55, 0xc5, 0x2f1b05, 0xc, 0x0
  .long 0x5110501, 0x5410521, 0x5610551, 0x5810571, 0x5a10591, 0x5c105b1, 0x5e105d1, 0x53f05f1
  .long 0x765fedcb, 0x943210a8, 0x55855555, 0x55555955, 0x95, 0x291805, 0x9, 0x0
  .long 0x5190509, 0x5390529, 0x5690559, 0x5890579, 0x5a90599, 0x5c905b9, 0x5e905d9, 0x54f05f9
  .long 0x765fedcb, 0xa4321098, 0x55a55555, 0x55555755, 0xa7, 0x1a0527, 0xa, 0x0
  .long 0xe50065, 0x1a50125, 0x5950515, 0x87505d6, 0xc3808f5, 0xf050cb9, 0xf850f46, 0x55f0fc8
  .long 0x76afedcb, 0x14325098, 0x55255555, 0x55555455, 0x15, 0x241205, 0x1, 0x0
  .long 0x51b050b, 0x53b052b, 0x55b054b, 0x58b057b, 0x5ab059b, 0x5cb05bb, 0x5eb05db, 0x56f05fb
  .long 0x765fadcb, 0xe4321098, 0x55b55555, 0x55555c55, 0xe5, 0x2c1b05, 0xe, 0x0
  .long 0x5130503, 0x5330523, 0x5530543, 0x5830563, 0x5a30593, 0x5c305b3, 0x5e305d3, 0x57f05f3
  .long 0x76afedcb, 0x34521098, 0x55055555, 0x55555155, 0x35, 0x211005, 0x3, 0x0
  .long 0x51d050d, 0x53d052d, 0x55d054d, 0x57d056d, 0x5ad059d, 0x5cd05bd, 0x5ed05dd, 0x58f05fd
  .long 0x76afedcb, 0x84321095, 0x55b55555, 0x55555755, 0x85, 0x271b05, 0x8, 0x0
  .long 0x5180508, 0x5380528, 0x5580548, 0x5780568, 0x5a80588, 0x5c805b8, 0x5e805d8, 0x59f05f8
  .long 0x765fedca, 0xb4321098, 0x55f55555, 0x55555b55, 0xb5, 0x2b1f05, 0xb, 0x0
  .long 0x5100500, 0x5300520, 0x5500540, 0x5700560, 0x5900580, 0x5c005b0, 0x5e005d0, 0x5af05f0
  .long 0x765feacb, 0xd4321098, 0x55b55555, 0x55555f55, 0xd5, 0x2f1b05, 0xd, 0x0
  .long 0x5120502, 0x5320522, 0x5520542, 0x5720562, 0x5920582, 0x5c205a2, 0x5e205d2, 0x5bf05f2
  .long 0xa65fedcb, 0x74321098, 0x55855555, 0x55555955, 0x75, 0x291805, 0x7, 0x0
  .long 0x5170507, 0x5370527, 0x5570547, 0x5770567, 0x5970587, 0x5b705a7, 0x5e705d7, 0x5cf05f7
  .long 0x7a5fedcb, 0x64321098, 0x55a55555, 0x55555755, 0x65, 0x271a05, 0x6, 0x0
  .long 0x5160506, 0x5360526, 0x5560546, 0x5760566, 0x5960586, 0x5b605a6, 0x5e605c6, 0x5df05f6
  .long 0x76afedcb, 0x4321598, 0x55255555, 0x55555455, 0x5, 0x241205, 0x0, 0x0
  .long 0x51a050a, 0x53a052a, 0x55a054a, 0x57a056a, 0x59a058a, 0x5ba05aa, 0x5da05ca, 0x5ef05fa
  .long 0x76afedcb, 0x45321098, 0x55155555, 0x55555955, 0x45, 0x291105, 0x4, 0x0
  .long 0x51e050e, 0x53e052e, 0x55e054e, 0x57e056e, 0x59e058e, 0x5be05ae, 0x5de05ce, 0x5ff05ee
  .long 0x76afedcb, 0x24351098, 0x66466666, 0x66666666, 0x26, 0x261406, 0x2, 0x0
  .long 0x62c061c, 0x64c063c, 0x66c065c, 0x68c067c, 0x6ac069c, 0x6cc06bc, 0x6ec06dc, 0x60f06fc
  .long 0x765fadcb, 0xe4321098, 0x66666666, 0x66666c66, 0xe6, 0x2c1606, 0xe, 0x0
  .long 0x6230603, 0x6430633, 0x6630653, 0x6830673, 0x6a30693, 0x6c306b3, 0x6e306d3, 0x61f06f3
  .long 0xa65fedcb, 0x74321098, 0x66c66666, 0x66666166, 0x76, 0x211c06, 0x7, 0x0
  .long 0x6170607, 0x6470637, 0x6670657, 0x6870677, 0x6a70697, 0x6c706b7, 0x6e706d7, 0x62f06f7
  .long 0x76afedcb, 0x14325098, 0x66066666, 0x66666666, 0x16, 0x261006, 0x1, 0x0
  .long 0x61b060b, 0x64b062b, 0x66b065b, 0x68b067b, 0x6ab069b, 0x6cb06bb, 0x6eb06db, 0x63f06fb
  .long 0x75afedcb, 0x64321098, 0x66e66666, 0x66666666, 0x66, 0x261e06, 0x6, 0x0
  .long 0x6160606, 0x6360626, 0x6660656, 0x6860676, 0x6a60696, 0x6c606b6, 0x6e606d6, 0x64f06f6
  .long 0x76afedcb, 0x34521098, 0x66066666, 0x66666066, 0x36, 0x201006, 0x3, 0x0
  .long 0x61d060d, 0x63d062d, 0x66d064d, 0x68d067d, 0x6ad069d, 0x6cd06bd, 0x6ed06dd, 0x65f06fd
  .long 0x765fedcb, 0xa4321098, 0x66f66666, 0x66666d66, 0xad, 0x1f062d, 0xa, 0x0
  .long 0x1410134, 0x47001b2, 0x6e204f2, 0x8a40820, 0xa0208c3, 0xb130a80, 0xb900b52, 0x66f0ed3
  .long 0x765fedab, 0xc4321098, 0x66566666, 0x66666e66, 0xc6, 0x2e1506, 0xc, 0x0
  .long 0x6110601, 0x6310621, 0x6510641, 0x6810661, 0x6a10691, 0x6c106b1, 0x6e106d1, 0x67f06f1
  .long 0x76afedcb, 0x45321098, 0x66466666, 0x66666666, 0x46, 0x261406, 0x4, 0x0
  .long 0x61e060e, 0x63e062e, 0x65e064e, 0x67e066e, 0x6ae069e, 0x6ce06be, 0x6ee06de, 0x68f06fe
  .long 0x765fedca, 0xb4321098, 0x66666666, 0x66666c66, 0xb6, 0x2c1606, 0xb, 0x0
  .long 0x6100600, 0x6300620, 0x6500640, 0x6700660, 0x6a00680, 0x6c006b0, 0x6e006d0, 0x69f06f0
  .long 0x765fedcb, 0x943210a8, 0x66c66666, 0x66666166, 0x96, 0x211c06, 0x9, 0x0
  .long 0x6190609, 0x6390629, 0x6590649, 0x6790669, 0x6990689, 0x6c906b9, 0x6e906d9, 0x6af06f9
  .long 0x76afedcb, 0x54321098, 0x66066666, 0x66666666, 0x50, 0x260610, 0x5, 0x0
  .long 0x1fe017c, 0x2ce024c, 0x3eb036e, 0x58d050c, 0x65d063b, 0x71a06da, 0xdac079c, 0x6bf0f2a
  .long 0x76afedcb, 0x84321095, 0x66e66666, 0x66666666, 0x86, 0x261e06, 0x8, 0x0
  .long 0x6180608, 0x6380628, 0x6580648, 0x6780668, 0x6980688, 0x6b806a8, 0x6e806d8, 0x6cf06f8
  .long 0x76afedcb, 0x4321598, 0x66066666, 0x66666066, 0x6, 0x201006, 0x0, 0x0
  .long 0x61a060a, 0x63a062a, 0x65a064a, 0x67a066a, 0x69a068a, 0x6ba06aa, 0x6ea06ca, 0x6df06fa
  .long 0x765feacb, 0xd4321098, 0x66f66666, 0x66666d66, 0xd6, 0x2d1f06, 0xd, 0x0
  .long 0x6120602, 0x6320622, 0x6520642, 0x6720662, 0x6920682, 0x6b206a2, 0x6d206c2, 0x6ef06f2
  .long 0x765aedcb, 0xf4321098, 0x66566666, 0x66666e66, 0xf6, 0x2e1506, 0xf, 0x0
  .long 0x6140604, 0x6340624, 0x6540644, 0x6740664, 0x6940684, 0x6b406a4, 0x6d406c4, 0x6ff06e4
  .long 0x765aedcb, 0xf4321098, 0x77877777, 0x77777b77, 0xf7, 0x2b1807, 0xf, 0x0
  .long 0x7240714, 0x7440734, 0x7640754, 0x7840774, 0x7a40794, 0x7c407b4, 0x7e407d4, 0x70f07f4
  .long 0x76afedcb, 0x4321598, 0x77077777, 0x77777877, 0x7, 0x281007, 0x0, 0x0
  .long 0x72a070a, 0x74a073a, 0x76a075a, 0x78a077a, 0x7aa079a, 0x7ca07ba, 0x7ea07da, 0x71f07fa
  .long 0x765fadcb, 0xe4321098, 0x77b77777, 0x77777e77, 0xe7, 0x2e1b07, 0xe, 0x0
  .long 0x7130703, 0x7430733, 0x7630753, 0x7830773, 0x7a30793, 0x7c307b3, 0x7e307d3, 0x72f07f3
  .long 0x76afedcb, 0x45321098, 0x77277777, 0x77777177, 0x47, 0x211207, 0x4, 0x0
  .long 0x71e070e, 0x74e072e, 0x76e075e, 0x78e077e, 0x7ae079e, 0x7ce07be, 0x7ee07de, 0x73f07fe
  .long 0x7a5fedcb, 0x64321098, 0x77f77777, 0x77777a77, 0x67, 0x2a1f07, 0x6, 0x0
  .long 0x7160706, 0x7360726, 0x7660756, 0x7860776, 0x7a60796, 0x7c607b6, 0x7e607d6, 0x74f07f6
  .long 0x76afedcb, 0x34521098, 0x77277777, 0x77777277, 0x37, 0x221207, 0x3, 0x0
  .long 0x71d070d, 0x73d072d, 0x76d074d, 0x78d077d, 0x7ad079d, 0x7cd07bd, 0x7ed07dd, 0x75f07fd
  .long 0x765fedca, 0xb4321098, 0x77677777, 0x77777c77, 0xb7, 0x2c1607, 0xb, 0x0
  .long 0x7100700, 0x7300720, 0x7500740, 0x7800770, 0x7a00790, 0x7c007b0, 0x7e007d0, 0x76f07f0
  .long 0x76afedcb, 0x94321058, 0x77f77777, 0x77777677, 0x97, 0x261f07, 0x9, 0x0
  .long 0x7190709, 0x7390729, 0x7590749, 0x7890769, 0x7a90799, 0x7c907b9, 0x7e907d9, 0x77f07f9
  .long 0x765feacb, 0xd4321098, 0x77877777, 0x77777b77, 0xd7, 0x2b1807, 0xd, 0x0
  .long 0x7120702, 0x7320722, 0x7520742, 0x7720762, 0x7a20792, 0x7c207b2, 0x7e207d2, 0x78f07f2
  .long 0x76afedcb, 0x24351098, 0x77077777, 0x77777877, 0x27, 0x281007, 0x2, 0x0
  .long 0x71c070c, 0x73c072c, 0x75c074c, 0x77c076c, 0x7ac078c, 0x7cc07bc, 0x7ec07dc, 0x79f07fc
  .long 0x765fedab, 0xc4321098, 0x77b77777, 0x77777e77, 0xc7, 0x2e1b07, 0xc, 0x0
  .long 0x7110701, 0x7310721, 0x7510741, 0x7710761, 0x7910781, 0x7c107b1, 0x7e107d1, 0x7af07f1
  .long 0x76afedcb, 0x14325098, 0x77277777, 0x77777177, 0x17, 0x211207, 0x1, 0x0
  .long 0x71b070b, 0x73b072b, 0x75b074b, 0x77b076b, 0x79b078b, 0x7cb07ab, 0x7eb07db, 0x7bf07fb
  .long 0x765fedcb, 0x8432109a, 0x77f77777, 0x77777a77, 0x87, 0x2a1f07, 0x8, 0x0
  .long 0x7180708, 0x7380728, 0x7580748, 0x7780768, 0x7980788, 0x7b807a8, 0x7e807d8, 0x7cf07f8
  .long 0x76afedcb, 0x54321098, 0x77277777, 0x77777277, 0x52, 0x220712, 0x5, 0x0
  .long 0x8e000c, 0x4ac042d, 0x5ea056b, 0x75d073e, 0x87e07bb, 0xc4e08fc, 0xf1c0cca, 0x7df0f9d
  .long 0x765fedcb, 0xa4321098, 0x77677777, 0x77777c77, 0xac, 0x16072c, 0xa, 0x0
  .long 0xd00053, 0x2b00234, 0x44302f1, 0x57304c4, 0x6900613, 0xc030760, 0xd200c84, 0x7ef0fa4
  .long 0x56afedcb, 0x74321098, 0x77f77777, 0x77777677, 0x77, 0x261f07, 0x7, 0x0
  .long 0x7170707, 0x7370727, 0x7570747, 0x7770767, 0x7970787, 0x7b707a7, 0x7d707c7, 0x7ff07e7
  .long 0x765feacb, 0xd4321098, 0x88788888, 0x88888f88, 0xd8, 0x2f1708, 0xd, 0x0
  .long 0x8220812, 0x8420832, 0x8620852, 0x8820872, 0x8a20892, 0x8c208b2, 0x8e208d2, 0x80f08f2
  .long 0x76afedcb, 0x14325098, 0x88388888, 0x88888188, 0x18, 0x211308, 0x1, 0x0
  .long 0x82b080b, 0x84b083b, 0x86b085b, 0x88b087b, 0x8ab089b, 0x8cb08bb, 0x8eb08db, 0x81f08fb
  .long 0x765fedca, 0xb4321098, 0x88788888, 0x88888d88, 0xb8, 0x2d1708, 0xb, 0x0
  .long 0x8100800, 0x8400830, 0x8600850, 0x8800870, 0x8a00890, 0x8c008b0, 0x8e008d0, 0x82f08f0
  .long 0x765fedcb, 0xa4321098, 0x88788888, 0x88888288, 0xa2, 0x170822, 0xa, 0x0
  .long 0x1c50175, 0x75501f5, 0x84507d5, 0x8b70865, 0x92508e5, 0xd0509a5, 0xe150d85, 0x83f0e95
  .long 0x76afedcb, 0x4321598, 0x88488888, 0x88888288, 0x8, 0x221408, 0x0, 0x0
  .long 0x81a080a, 0x83a082a, 0x86a085a, 0x88a087a, 0x8aa089a, 0x8ca08ba, 0x8ea08da, 0x84f08fa
  .long 0x76afedcb, 0x94321058, 0x88788888, 0x88888188, 0x98, 0x211708, 0x9, 0x0
  .long 0x8190809, 0x8390829, 0x8690849, 0x8890879, 0x8a90899, 0x8c908b9, 0x8e908d9, 0x85f08f9
  .long 0x75afedcb, 0x64321098, 0x88d88888, 0x88888288, 0x68, 0x221d08, 0x6, 0x0
  .long 0x8160806, 0x8360826, 0x8560846, 0x8860876, 0x8a60896, 0x8c608b6, 0x8e608d6, 0x86f08f6
  .long 0x76afedcb, 0x45321098, 0x88288888, 0x88888788, 0x48, 0x271208, 0x4, 0x0
  .long 0x81e080e, 0x83e082e, 0x85e084e, 0x88e086e, 0x8ae089e, 0x8ce08be, 0x8ee08de, 0x87f08fe
  .long 0x765fedab, 0xc4321098, 0x88788888, 0x88888f88, 0xc8, 0x2f1708, 0xc, 0x0
  .long 0x8110801, 0x8310821, 0x8510841, 0x8710861, 0x8a10891, 0x8c108b1, 0x8e108d1, 0x88f08f1
  .long 0x76afedcb, 0x34521098, 0x88388888, 0x88888188, 0x38, 0x211308, 0x3, 0x0
  .long 0x81d080d, 0x83d082d, 0x85d084d, 0x87d086d, 0x8ad088d, 0x8cd08bd, 0x8ed08dd, 0x89f08fd
  .long 0x765aedcb, 0xf4321098, 0x88788888, 0x88888d88, 0xf8, 0x2d1708, 0xf, 0x0
  .long 0x8140804, 0x8340824, 0x8540844, 0x8740864, 0x8940884, 0x8c408b4, 0x8e408d4, 0x8af08f4
  .long 0xa65fedcb, 0x74321098, 0x88788888, 0x88888288, 0x78, 0x221708, 0x7, 0x0
  .long 0x8170807, 0x8370827, 0x8570847, 0x8770867, 0x8970887, 0x8c708a7, 0x8e708d7, 0x8bf08f7
  .long 0x765fadcb, 0xe4321098, 0x88a88888, 0x88888d88, 0xe8, 0x2d1a08, 0xe, 0x0
  .long 0x8130803, 0x8330823, 0x8530843, 0x8730863, 0x8930883, 0x8b308a3, 0x8e308d3, 0x8cf08f3
  .long 0x76afedcb, 0x54321098, 0x88788888, 0x88888188, 0x57, 0x210817, 0x5, 0x0
  .long 0x4650445, 0x4e504c5, 0x8250805, 0x8590835, 0x8a50885, 0xc1508b5, 0xc950c75, 0x8df0cf5
  .long 0x76afedcb, 0x84321095, 0x88d88888, 0x88888288, 0x88, 0x221d08, 0x8, 0x0
  .long 0x8180808, 0x8380828, 0x8580848, 0x8780868, 0x8980888, 0x8b808a8, 0x8d808c8, 0x8ef08f8
  .long 0x76afedcb, 0x24351098, 0x88288888, 0x88888788, 0x28, 0x271208, 0x2, 0x0
  .long 0x81c080c, 0x83c082c, 0x85c084c, 0x87c086c, 0x89c088c, 0x8bc08ac, 0x8dc08cc, 0x8ff08ec
  .long 0x76afedcb, 0x94321058, 0x99a99999, 0x99999899, 0x99, 0x281a09, 0x9, 0x0
  .long 0x9290919, 0x9490939, 0x9690959, 0x9890979, 0x9a90999, 0x9c909b9, 0x9e909d9, 0x90f09f9
  .long 0x76afedcb, 0x54321098, 0x99599999, 0x99999599, 0x55, 0x250915, 0x5, 0x0
  .long 0xb90036, 0x6f50675, 0xa2b099d, 0xaad0a65, 0xce50b55, 0xf0e0ed5, 0xf8b0f45, 0x91f0fc5
  .long 0x76afedcb, 0x45321098, 0x99399999, 0x99999299, 0x49, 0x221309, 0x4, 0x0
  .long 0x91e090e, 0x94e093e, 0x96e095e, 0x98e097e, 0x9ae099e, 0x9ce09be, 0x9ee09de, 0x92f09fe
  .long 0x76afedcb, 0x14325098, 0x99399999, 0x99999999, 0x19, 0x291309, 0x1, 0x0
  .long 0x91b090b, 0x94b092b, 0x96b095b, 0x98b097b, 0x9ab099b, 0x9cb09bb, 0x9eb09db, 0x93f09fb
  .long 0x765aedcb, 0xf4321098, 0x99c99999, 0x99999e99, 0xf9, 0x2e1c09, 0xf, 0x0
  .long 0x9140904, 0x9340924, 0x9640954, 0x9840974, 0x9a40994, 0x9c409b4, 0x9e409d4, 0x94f09f4
  .long 0x765fadcb, 0xe4321098, 0x99b99999, 0x99999a99, 0xe9, 0x2a1b09, 0xe, 0x0
  .long 0x9130903, 0x9330923, 0x9630943, 0x9830973, 0x9a30993, 0x9c309b3, 0x9e309d3, 0x95f09f3
  .long 0x765fedab, 0xc4321098, 0x99899999, 0x99999a99, 0xc9, 0x2a1809, 0xc, 0x0
  .long 0x9110901, 0x9310921, 0x9510941, 0x9810971, 0x9a10991, 0x9c109b1, 0x9e109d1, 0x96f09f1
  .long 0x56afedcb, 0x74321098, 0x99e99999, 0x99999599, 0x79, 0x251e09, 0x7, 0x0
  .long 0x9170907, 0x9370927, 0x9570947, 0x9870967, 0x9a70997, 0x9c709b7, 0x9e709d7, 0x97f09f7
  .long 0x75afedcb, 0x64321098, 0x99a99999, 0x99999899, 0x69, 0x281a09, 0x6, 0x0
  .long 0x9160906, 0x9360926, 0x9560946, 0x9760966, 0x9a60996, 0x9c609b6, 0x9e609d6, 0x98f09f6
  .long 0x76afedcb, 0x34521098, 0x99599999, 0x99999599, 0x39, 0x251509, 0x3, 0x0
  .long 0x91d090d, 0x93d092d, 0x95d094d, 0x97d096d, 0x9ad098d, 0x9cd09bd, 0x9ed09dd, 0x99f09fd
  .long 0x76afedcb, 0x4321598, 0x99399999, 0x99999299, 0x9, 0x221309, 0x0, 0x0
  .long 0x91a090a, 0x93a092a, 0x95a094a, 0x97a096a, 0x99a098a, 0x9ca09ba, 0x9ea09da, 0x9af09fa
  .long 0x76afedcb, 0x24351098, 0x99399999, 0x99999999, 0x29, 0x291309, 0x2, 0x0
  .long 0x91c090c, 0x93c092c, 0x95c094c, 0x97c096c, 0x99c098c, 0x9cc09ac, 0x9ec09dc, 0x9bf09fc
  .long 0x765feacb, 0xd4321098, 0x99c99999, 0x99999e99, 0xd9, 0x2e1c09, 0xd, 0x0
  .long 0x9120902, 0x9320922, 0x9520942, 0x9720962, 0x9920982, 0x9b209a2, 0x9e209d2, 0x9cf09f2
  .long 0x765fedca, 0xb4321098, 0x99b99999, 0x99999a99, 0xb9, 0x2a1b09, 0xb, 0x0
  .long 0x9100900, 0x9300920, 0x9500940, 0x9700960, 0x9900980, 0x9b009a0, 0x9e009c0, 0x9df09f0
  .long 0x765fedcb, 0xa4321098, 0x99899999, 0x99999a99, 0xaa, 0x18092a, 0xa, 0x0
  .long 0x7c80746, 0x9610953, 0xa2509d0, 0xaa50a35, 0xb050ab5, 0xd190b85, 0xe740d97, 0x9ef0ef0
  .long 0x76afedcb, 0x84321095, 0x99e99999, 0x99999599, 0x89, 0x251e09, 0x8, 0x0
  .long 0x9180908, 0x9380928, 0x9580948, 0x9780968, 0x9980988, 0x9b809a8, 0x9d809c8, 0x9ff09e8
  .long 0x765feacb, 0xd4321098, 0xaadaaaaa, 0xaaaaadaa, 0xda, 0x2d1d0a, 0xd, 0x0
  .long 0xa220a12, 0xa420a32, 0xa620a52, 0xa820a72, 0xaa20a92, 0xac20ab2, 0xae20ad2, 0xa0f0af2
  .long 0x765aedcb, 0xf4321098, 0xaa8aaaaa, 0xaaaaafaa, 0xfa, 0x2f180a, 0xf, 0x0
  .long 0xa240a04, 0xa440a34, 0xa640a54, 0xa840a74, 0xaa40a94, 0xac40ab4, 0xae40ad4, 0xa1f0af4
  .long 0x76afedcb, 0x14325098, 0xaa5aaaaa, 0xaaaaaaaa, 0x1a, 0x2a150a, 0x1, 0x0
  .long 0xa1b0a0b, 0xa4b0a3b, 0xa6b0a5b, 0xa8b0a7b, 0xaab0a9b, 0xacb0abb, 0xaeb0adb, 0xa2f0afb
  .long 0x76afedcb, 0x45321098, 0xaa4aaaaa, 0xaaaaaaaa, 0x4a, 0x2a140a, 0x4, 0x0
  .long 0xa1e0a0e, 0xa4e0a2e, 0xa6e0a5e, 0xa8e0a7e, 0xaae0a9e, 0xace0abe, 0xaee0ade, 0xa3f0afe
  .long 0x75afedcb, 0x64321098, 0xaadaaaaa, 0xaaaaa8aa, 0x6a, 0x281d0a, 0x6, 0x0
  .long 0xa160a06, 0xa360a26, 0xa660a56, 0xa860a76, 0xaa60a96, 0xac60ab6, 0xae60ad6, 0xa4f0af6
  .long 0x765fedcb, 0xa4321098, 0xaaeaaaaa, 0xaaaaa9aa, 0xa9, 0x1e0a29, 0xa, 0x0
  .long 0x1960118, 0x3070275, 0x5490388, 0x5f505c7, 0x9b50935, 0xc250ad7, 0xe650ca5, 0xa5f0ee5
  .long 0x765fadcb, 0xe4321098, 0xaa5aaaaa, 0xaaaaabaa, 0xea, 0x2b150a, 0xe, 0x0
  .long 0xa130a03, 0xa330a23, 0xa530a43, 0xa830a73, 0xaa30a93, 0xac30ab3, 0xae30ad3, 0xa6f0af3
  .long 0x76afedcb, 0x84321095, 0xaadaaaaa, 0xaaaaa3aa, 0x8a, 0x231d0a, 0x8, 0x0
  .long 0xa180a08, 0xa380a28, 0xa580a48, 0xa880a68, 0xaa80a98, 0xac80ab8, 0xae80ad8, 0xa7f0af8
  .long 0x765fedca, 0xb4321098, 0xaadaaaaa, 0xaaaaadaa, 0xba, 0x2d1d0a, 0xb, 0x0
  .long 0xa100a00, 0xa300a20, 0xa500a40, 0xa700a60, 0xaa00a90, 0xac00ab0, 0xae00ad0, 0xa8f0af0
  .long 0x765fedab, 0xc4321098, 0xaa8aaaaa, 0xaaaaafaa, 0xca, 0x2f180a, 0xc, 0x0
  .long 0xa110a01, 0xa310a21, 0xa510a41, 0xa710a61, 0xaa10a81, 0xac10ab1, 0xae10ad1, 0xa9f0af1
  .long 0x76afedcb, 0x34521098, 0xaa5aaaaa, 0xaaaaaaaa, 0x3a, 0x2a150a, 0x3, 0x0
  .long 0xa1d0a0d, 0xa3d0a2d, 0xa5d0a4d, 0xa7d0a6d, 0xa9d0a8d, 0xacd0abd, 0xaed0add, 0xaaf0afd
  .long 0x76afedcb, 0x24351098, 0xaa4aaaaa, 0xaaaaaaaa, 0x2a, 0x2a140a, 0x2, 0x0
  .long 0xa1c0a0c, 0xa3c0a2c, 0xa5c0a4c, 0xa7c0a6c, 0xa9c0a8c, 0xacc0aac, 0xaec0adc, 0xabf0afc
  .long 0x76afedcb, 0x54321098, 0xaadaaaaa, 0xaaaaa8aa, 0x5d, 0x280a1d, 0x5, 0x0
  .long 0xa50025, 0x3d90356, 0x8e80866, 0xa460a05, 0xa850a78, 0xb150af9, 0xb950b35, 0xacf0bb5
  .long 0xa65fedcb, 0x74321098, 0xaaeaaaaa, 0xaaaaa9aa, 0x7a, 0x291e0a, 0x7, 0x0
  .long 0xa170a07, 0xa370a27, 0xa570a47, 0xa770a67, 0xa970a87, 0xab70aa7, 0xae70ac7, 0xadf0af7
  .long 0x76afedcb, 0x4321598, 0xaa4aaaaa, 0xaaaaa1aa, 0xa, 0x21140a, 0x0, 0x0
  .long 0xa1a0a0a, 0xa3a0a2a, 0xa5a0a4a, 0xa7a0a6a, 0xa9a0a8a, 0xaba0aaa, 0xada0aca, 0xaef0afa
  .long 0x76afedcb, 0x94321058, 0xaadaaaaa, 0xaaaaa3aa, 0x9a, 0x231d0a, 0x9, 0x0
  .long 0xa190a09, 0xa390a29, 0xa590a49, 0xa790a69, 0xa990a89, 0xab90aa9, 0xad90ac9, 0xaff0ae9
  .long 0x76afedcb, 0x54321098, 0xbbebbbbb, 0xbbbbbabb, 0x5e, 0x2a0b1e, 0x5, 0x0
  .long 0x980017, 0x3b50335, 0x6c80646, 0x9f80977, 0xad50a55, 0xd250b86, 0xee60e69, 0xb0f0fa5
  .long 0x765fadcb, 0xe4321098, 0xbbdbbbbb, 0xbbbbbdbb, 0xeb, 0x2d1d0b, 0xe, 0x0
  .long 0xb230b03, 0xb430b33, 0xb630b53, 0xb830b73, 0xba30b93, 0xbc30bb3, 0xbe30bd3, 0xb1f0bf3
  .long 0x765fedcb, 0xa4321098, 0xbb6bbbbb, 0xbbbbb3bb, 0xa3, 0x160b23, 0xa, 0x0
  .long 0x2850205, 0x3c50345, 0x4350415, 0x4950467, 0x4e904b5, 0xaf50a75, 0xbd50ba9, 0xb2f0e55
  .long 0x765fedab, 0xc4321098, 0xbbdbbbbb, 0xbbbbbbbb, 0xcb, 0x2b1d0b, 0xc, 0x0
  .long 0xb110b01, 0xb410b21, 0xb610b51, 0xb810b71, 0xba10b91, 0xbc10bb1, 0xbe10bd1, 0xb3f0bf1
  .long 0xa65fedcb, 0x74321098, 0xbb6bbbbb, 0xbbbbb0bb, 0x7b, 0x20160b, 0x7, 0x0
  .long 0xb170b07, 0xb370b27, 0xb670b57, 0xb870b77, 0xba70b97, 0xbc70bb7, 0xbe70bd7, 0xb4f0bf7
  .long 0x765feacb, 0xd4321098, 0xbb5bbbbb, 0xbbbbbdbb, 0xdb, 0x2d150b, 0xd, 0x0
  .long 0xb120b02, 0xb320b22, 0xb620b42, 0xb820b72, 0xba20b92, 0xbc20bb2, 0xbe20bd2, 0xb5f0bf2
  .long 0x76afedcb, 0x4321598, 0xbb1bbbbb, 0xbbbbb6bb, 0xb, 0x26110b, 0x0, 0x0
  .long 0xb1a0b0a, 0xb3a0b2a, 0xb5a0b4a, 0xb8a0b7a, 0xbaa0b9a, 0xbca0bba, 0xbea0bda, 0xb6f0bfa
  .long 0x76afedcb, 0x45321098, 0xbb3bbbbb, 0xbbbbb8bb, 0x4b, 0x28130b, 0x4, 0x0
  .long 0xb1e0b0e, 0xb3e0b2e, 0xb5e0b4e, 0xb8e0b6e, 0xbae0b9e, 0xbce0bbe, 0xbee0bde, 0xb7f0bfe
  .long 0x75afedcb, 0x64321098, 0xbbebbbbb, 0xbbbbbabb, 0x6b, 0x2a1e0b, 0x6, 0x0
  .long 0xb160b06, 0xb360b26, 0xb560b46, 0xb760b66, 0xba60b96, 0xbc60bb6, 0xbe60bd6, 0xb8f0bf6
  .long 0x765fedca, 0xb4321098, 0xbbdbbbbb, 0xbbbbbdbb, 0xbb, 0x2d1d0b, 0xb, 0x0
  .long 0xb100b00, 0xb300b20, 0xb500b40, 0xb700b60, 0xba00b80, 0xbc00bb0, 0xbe00bd0, 0xb9f0bf0
  .long 0x765fedcb, 0x943210a8, 0xbb6bbbbb, 0xbbbbb3bb, 0x9b, 0x23160b, 0x9, 0x0
  .long 0xb190b09, 0xb390b29, 0xb590b49, 0xb790b69, 0xb990b89, 0xbc90bb9, 0xbe90bd9, 0xbaf0bf9
  .long 0x765aedcb, 0xf4321098, 0xbbdbbbbb, 0xbbbbbbbb, 0xfb, 0x2b1d0b, 0xf, 0x0
  .long 0xb140b04, 0xb340b24, 0xb540b44, 0xb740b64, 0xb940b84, 0xbc40ba4, 0xbe40bd4, 0xbbf0bf4
  .long 0x765fedcb, 0x8432109a, 0xbb6bbbbb, 0xbbbbb0bb, 0x8b, 0x20160b, 0x8, 0x0
  .long 0xb180b08, 0xb380b28, 0xb580b48, 0xb780b68, 0xb980b88, 0xbb80ba8, 0xbe80bd8, 0xbcf0bf8
  .long 0x76afedcb, 0x24351098, 0xbb4bbbbb, 0xbbbbb3bb, 0x2b, 0x23140b, 0x2, 0x0
  .long 0xb1c0b0c, 0xb3c0b2c, 0xb5c0b4c, 0xb7c0b6c, 0xb9c0b8c, 0xbbc0bac, 0xbec0bcc, 0xbdf0bfc
  .long 0x76afedcb, 0x34521098, 0xbb1bbbbb, 0xbbbbb6bb, 0x3b, 0x26110b, 0x3, 0x0
  .long 0xb1d0b0d, 0xb3d0b2d, 0xb5d0b4d, 0xb7d0b6d, 0xb9d0b8d, 0xbbd0bad, 0xbdd0bcd, 0xbef0bfd
  .long 0x76afedcb, 0x14325098, 0xbb3bbbbb, 0xbbbbb8bb, 0x1b, 0x28130b, 0x1, 0x0
  .long 0xb1b0b0b, 0xb3b0b2b, 0xb5b0b4b, 0xb7b0b6b, 0xb9b0b8b, 0xbbb0bab, 0xbdb0bcb, 0xbff0beb
  .long 0x765fadcb, 0xe4321098, 0xcccccccc, 0xcccccccc, 0xec, 0x2c1c0c, 0xe, 0x0
  .long 0xc230c13, 0xc430c33, 0xc630c53, 0xc830c73, 0xca30c93, 0xcc30cb3, 0xce30cd3, 0xc0f0cf3
  .long 0x765fedca, 0xb4321098, 0xcc7ccccc, 0xcccccbcc, 0xbc, 0x2b170c, 0xb, 0x0
  .long 0xc200c00, 0xc400c30, 0xc600c50, 0xc800c70, 0xca00c90, 0xcc00cb0, 0xce00cd0, 0xc1f0cf0
  .long 0x76afedcb, 0x54321098, 0xccaccccc, 0xccccc9cc, 0x5a, 0x290c1a, 0x5, 0x0
  .long 0x2650145, 0x31502e5, 0x5550395, 0x8c505d5, 0x9860909, 0xca70c35, 0xe750cb5, 0xc2f0ef5
  .long 0x765fedcb, 0x8432109a, 0xccaccccc, 0xccccc7cc, 0x8c, 0x271a0c, 0x8, 0x0
  .long 0xc180c08, 0xc480c28, 0xc680c58, 0xc880c78, 0xca80c98, 0xcc80cb8, 0xce80cd8, 0xc3f0cf8
  .long 0x76afedcb, 0x45321098, 0xcc2ccccc, 0xccccc5cc, 0x4c, 0x25120c, 0x4, 0x0
  .long 0xc1e0c0e, 0xc3e0c2e, 0xc6e0c5e, 0xc8e0c7e, 0xcae0c9e, 0xcce0cbe, 0xcee0cde, 0xc4f0cfe
  .long 0x76afedcb, 0x14325098, 0xcc1ccccc, 0xccccc4cc, 0x1c, 0x24110c, 0x1, 0x0
  .long 0xc1b0c0b, 0xc3b0c2b, 0xc6b0c4b, 0xc8b0c7b, 0xcab0c9b, 0xccb0cbb, 0xceb0cdb, 0xc5f0cfb
  .long 0x76afedcb, 0x34521098, 0xcc4ccccc, 0xccccc1cc, 0x3c, 0x21140c, 0x3, 0x0
  .long 0xc1d0c0d, 0xc3d0c2d, 0xc5d0c4d, 0xc8d0c7d, 0xcad0c9d, 0xccd0cbd, 0xced0cdd, 0xc6f0cfd
  .long 0x7a5fedcb, 0x64321098, 0xcc7ccccc, 0xccccc0cc, 0x6c, 0x20170c, 0x6, 0x0
  .long 0xc160c06, 0xc360c26, 0xc560c46, 0xc860c66, 0xca60c96, 0xcc60cb6, 0xce60cd6, 0xc7f0cf6
  .long 0x765aedcb, 0xf4321098, 0xcccccccc, 0xcccccccc, 0xfc, 0x2c1c0c, 0xf, 0x0
  .long 0xc140c04, 0xc340c24, 0xc540c44, 0xc740c64, 0xca40c94, 0xcc40cb4, 0xce40cd4, 0xc8f0cf4
  .long 0x765feacb, 0xd4321098, 0xcc7ccccc, 0xcccccbcc, 0xdc, 0x2b170c, 0xd, 0x0
  .long 0xc120c02, 0xc320c22, 0xc520c42, 0xc720c62, 0xca20c82, 0xcc20cb2, 0xce20cd2, 0xc9f0cf2
  .long 0x56afedcb, 0x74321098, 0xccaccccc, 0xccccc9cc, 0x7c, 0x291a0c, 0x7, 0x0
  .long 0xc170c07, 0xc370c27, 0xc570c47, 0xc770c67, 0xc970c87, 0xcc70cb7, 0xce70cd7, 0xcaf0cf7
  .long 0x765fedcb, 0x943210a8, 0xccaccccc, 0xccccc7cc, 0x9c, 0x271a0c, 0x9, 0x0
  .long 0xc190c09, 0xc390c29, 0xc590c49, 0xc790c69, 0xc990c89, 0xcc90ca9, 0xce90cd9, 0xcbf0cf9
  .long 0x76afedcb, 0x4321598, 0xcc2ccccc, 0xccccc5cc, 0xc, 0x25120c, 0x0, 0x0
  .long 0xc1a0c0a, 0xc3a0c2a, 0xc5a0c4a, 0xc7a0c6a, 0xc9a0c8a, 0xcba0caa, 0xcea0cda, 0xccf0cfa
  .long 0x76afedcb, 0x24351098, 0xcc1ccccc, 0xccccc4cc, 0x2c, 0x24110c, 0x2, 0x0
  .long 0xc1c0c0c, 0xc3c0c2c, 0xc5c0c4c, 0xc7c0c6c, 0xc9c0c8c, 0xcbc0cac, 0xcec0ccc, 0xcdf0cfc
  .long 0x765fedab, 0xc4321098, 0xcc5ccccc, 0xcccccbcc, 0xcc, 0x2b150c, 0xc, 0x0
  .long 0xc110c01, 0xc310c21, 0xc510c41, 0xc710c61, 0xc910c81, 0xcb10ca1, 0xcd10cc1, 0xcef0cf1
  .long 0x765fedcb, 0xa4321098, 0xcc7ccccc, 0xccccc0cc, 0xa0, 0x170c20, 0xa, 0x0
  .long 0x950015, 0x3e50365, 0x4880406, 0x6d50655, 0xbc80b47, 0xe250c76, 0xf350ea5, 0xcff0fb5
  .long 0x76afedcb, 0x45321098, 0xdd3ddddd, 0xddddd2dd, 0x4d, 0x22130d, 0x4, 0x0
  .long 0xd2e0d1e, 0xd4e0d3e, 0xd6e0d5e, 0xd8e0d7e, 0xdae0d9e, 0xdce0dbe, 0xdee0dde, 0xd0f0dfe
  .long 0x765fedcb, 0x943210a8, 0xdd9ddddd, 0xdddddadd, 0x9d, 0x2a190d, 0x9, 0x0
  .long 0xd290d09, 0xd490d39, 0xd690d59, 0xd890d79, 0xda90d99, 0xdc90db9, 0xde90dd9, 0xd1f0df9
  .long 0x765fedca, 0xb4321098, 0xddeddddd, 0xdddddcdd, 0xbd, 0x2c1e0d, 0xb, 0x0
  .long 0xd100d00, 0xd400d30, 0xd600d50, 0xd800d70, 0xda00d90, 0xdc00db0, 0xde00dd0, 0xd2f0df0
  .long 0x75afedcb, 0x64321098, 0xdd8ddddd, 0xddddd8dd, 0x6d, 0x28180d, 0x6, 0x0
  .long 0xd160d06, 0xd460d26, 0xd660d56, 0xd860d76, 0xda60d96, 0xdc60db6, 0xde60dd6, 0xd3f0df6
  .long 0x76afedcb, 0x14325098, 0xdd1ddddd, 0xddddd4dd, 0x1d, 0x24110d, 0x1, 0x0
  .long 0xd1b0d0b, 0xd3b0d2b, 0xd6b0d5b, 0xd8b0d7b, 0xdab0d9b, 0xdcb0dbb, 0xdeb0ddb, 0xd4f0dfb
  .long 0x765aedcb, 0xf4321098, 0xddcddddd, 0xdddddfdd, 0xfd, 0x2f1c0d, 0xf, 0x0
  .long 0xd140d04, 0xd340d24, 0xd640d44, 0xd840d74, 0xda40d94, 0xdc40db4, 0xde40dd4, 0xd5f0df4
  .long 0x765fedab, 0xc4321098, 0xddcddddd, 0xdddddfdd, 0xcd, 0x2f1c0d, 0xc, 0x0
  .long 0xd110d01, 0xd310d21, 0xd510d41, 0xd810d71, 0xda10d91, 0xdc10db1, 0xde10dd1, 0xd6f0df1
  .long 0x765fedcb, 0x8432109a, 0xddcddddd, 0xddddd1dd, 0x8d, 0x211c0d, 0x8, 0x0
  .long 0xd180d08, 0xd380d28, 0xd580d48, 0xd880d68, 0xda80d98, 0xdc80db8, 0xde80dd8, 0xd7f0df8
  .long 0x76afedcb, 0x4321598, 0xdd3ddddd, 0xddddd2dd, 0xd, 0x22130d, 0x0, 0x0
  .long 0xd1a0d0a, 0xd3a0d2a, 0xd5a0d4a, 0xd7a0d6a, 0xdaa0d9a, 0xdca0dba, 0xdea0dda, 0xd8f0dfa
  .long 0xa65fedcb, 0x74321098, 0xdd9ddddd, 0xdddddadd, 0x7d, 0x2a190d, 0x7, 0x0
  .long 0xd170d07, 0xd370d27, 0xd570d47, 0xd770d67, 0xda70d87, 0xdc70db7, 0xde70dd7, 0xd9f0df7
  .long 0x76afedcb, 0x24351098, 0xdd0ddddd, 0xddddd8dd, 0x2d, 0x28100d, 0x2, 0x0
  .long 0xd1c0d0c, 0xd3c0d2c, 0xd5c0d4c, 0xd7c0d6c, 0xd9c0d8c, 0xdcc0dbc, 0xdec0ddc, 0xdaf0dfc
  .long 0x76afedcb, 0x54321098, 0xdd8ddddd, 0xddddd8dd, 0x58, 0x280d18, 0x5, 0x0
  .long 0xd50055, 0x2a50225, 0x3f50375, 0x5c50545, 0x7850705, 0x9e50965, 0xa950a15, 0xdbf0d36
  .long 0x76afedcb, 0x34521098, 0xdd1ddddd, 0xddddd4dd, 0x3d, 0x24110d, 0x3, 0x0
  .long 0xd1d0d0d, 0xd3d0d2d, 0xd5d0d4d, 0xd7d0d6d, 0xd9d0d8d, 0xdbd0dad, 0xded0ddd, 0xdcf0dfd
  .long 0x765feacb, 0xd4321098, 0xddcddddd, 0xdddddfdd, 0xdd, 0x2f1c0d, 0xd, 0x0
  .long 0xd120d02, 0xd320d22, 0xd520d42, 0xd720d62, 0xd920d82, 0xdb20da2, 0xde20dc2, 0xddf0df2
  .long 0x765fadcb, 0xe4321098, 0xddcddddd, 0xdddddfdd, 0xed, 0x2f1c0d, 0xe, 0x0
  .long 0xd130d03, 0xd330d23, 0xd530d43, 0xd730d63, 0xd930d83, 0xdb30da3, 0xdd30dc3, 0xdef0df3
  .long 0x765fedcb, 0xa4321098, 0xddcddddd, 0xddddd1dd, 0xa1, 0x1c0d21, 0xa, 0x0
  .long 0x2c50245, 0x5850505, 0x6a90627, 0x7b50735, 0x8550815, 0x8d50895, 0xc650ae5, 0xdff0d78
  .long 0x765fedcb, 0xa4321098, 0xee9eeeee, 0xeeeee4ee, 0xa4, 0x190e24, 0xa, 0x0
  .long 0x750035, 0xf500b5, 0x3a50325, 0x5e50565, 0xcd50c55, 0xdc50d45, 0xf150e87, 0xe0f0f95
  .long 0x76afedcb, 0x24351098, 0xee4eeeee, 0xeeeee2ee, 0x2e, 0x22140e, 0x2, 0x0
  .long 0xe2c0e0c, 0xe4c0e3c, 0xe6c0e5c, 0xe8c0e7c, 0xeac0e9c, 0xecc0ebc, 0xeec0edc, 0xe1f0efc
  .long 0x76afedcb, 0x34521098, 0xee4eeeee, 0xeeeee0ee, 0x3e, 0x20140e, 0x3, 0x0
  .long 0xe1d0e0d, 0xe4d0e3d, 0xe6d0e5d, 0xe8d0e7d, 0xead0e9d, 0xecd0ebd, 0xeed0edd, 0xe2f0efd
  .long 0x76afedcb, 0x84321095, 0xeeceeeee, 0xeeeee5ee, 0x8e, 0x251c0e, 0x8, 0x0
  .long 0xe180e08, 0xe480e28, 0xe680e58, 0xe880e78, 0xea80e98, 0xec80eb8, 0xee80ed8, 0xe3f0ef8
  .long 0x765fedab, 0xc4321098, 0xeebeeeee, 0xeeeeebee, 0xce, 0x2b1b0e, 0xc, 0x0
  .long 0xe110e01, 0xe310e21, 0xe610e51, 0xe810e71, 0xea10e91, 0xec10eb1, 0xee10ed1, 0xe4f0ef1
  .long 0x76afedcb, 0x14325098, 0xee4eeeee, 0xeeeee3ee, 0x1e, 0x23140e, 0x1, 0x0
  .long 0xe1b0e0b, 0xe3b0e2b, 0xe6b0e4b, 0xe8b0e7b, 0xeab0e9b, 0xecb0ebb, 0xeeb0edb, 0xe5f0efb
  .long 0x76afedcb, 0x94321058, 0xeeeeeeee, 0xeeeee9ee, 0x9e, 0x291e0e, 0x9, 0x0
  .long 0xe190e09, 0xe390e29, 0xe590e49, 0xe890e79, 0xea90e99, 0xec90eb9, 0xee90ed9, 0xe6f0ef9
  .long 0x765aedcb, 0xf4321098, 0xeeaeeeee, 0xeeeeeaee, 0xfe, 0x2a1a0e, 0xf, 0x0
  .long 0xe140e04, 0xe340e24, 0xe540e44, 0xe840e64, 0xea40e94, 0xec40eb4, 0xee40ed4, 0xe7f0ef4
  .long 0xa65fedcb, 0x74321098, 0xee9eeeee, 0xeeeee4ee, 0x7e, 0x24190e, 0x7, 0x0
  .long 0xe170e07, 0xe370e27, 0xe570e47, 0xe770e67, 0xea70e97, 0xec70eb7, 0xee70ed7, 0xe8f0ef7
  .long 0x76afedcb, 0x45321098, 0xee4eeeee, 0xeeeee2ee, 0x4e, 0x22140e, 0x4, 0x0
  .long 0xe1e0e0e, 0xe3e0e2e, 0xe5e0e4e, 0xe7e0e6e, 0xeae0e8e, 0xece0ebe, 0xeee0ede, 0xe9f0efe
  .long 0x76afedcb, 0x4321598, 0xee4eeeee, 0xeeeee0ee, 0xe, 0x20140e, 0x0, 0x0
  .long 0xe1a0e0a, 0xe3a0e2a, 0xe5a0e4a, 0xe7a0e6a, 0xe9a0e8a, 0xeca0eba, 0xeea0eda, 0xeaf0efa
  .long 0x76afedcb, 0x54321098, 0xeeceeeee, 0xeeeee5ee, 0x5c, 0x250e1c, 0x5, 0x0
  .long 0x1950115, 0x6a50625, 0x9c50945, 0xc850c05, 0xd650d55, 0xdd50d75, 0xdf50de5, 0xebf0e38
  .long 0x765feacb, 0xd4321098, 0xeebeeeee, 0xeeeeebee, 0xde, 0x2b1b0e, 0xd, 0x0
  .long 0xe120e02, 0xe320e22, 0xe520e42, 0xe720e62, 0xe920e82, 0xeb20ea2, 0xee20ed2, 0xecf0ef2
  .long 0x765fadcb, 0xe4321098, 0xee5eeeee, 0xeeeeedee, 0xee, 0x2d150e, 0xe, 0x0
  .long 0xe130e03, 0xe330e23, 0xe530e43, 0xe730e63, 0xe930e83, 0xeb30ea3, 0xee30ec3, 0xedf0ef3
  .long 0x75afedcb, 0x64321098, 0xeeeeeeee, 0xeeeee9ee, 0x6e, 0x291e0e, 0x6, 0x0
  .long 0xe160e06, 0xe360e26, 0xe560e46, 0xe760e66, 0xe960e86, 0xeb60ea6, 0xed60ec6, 0xeef0ef6
  .long 0x765fedca, 0xb4321098, 0xeeaeeeee, 0xeeeeeaee, 0xbe, 0x2a1a0e, 0xb, 0x0
  .long 0xe100e00, 0xe300e20, 0xe500e40, 0xe700e60, 0xe900e80, 0xeb00ea0, 0xed00ec0, 0xeff0ee0
  .long 0x76afedcb, 0x45321098, 0xff5fffff, 0xfffff7ff, 0x4f, 0x27150f, 0x4, 0x0
  .long 0xf2e0f1e, 0xf4e0f3e, 0xf6e0f5e, 0xf8e0f7e, 0xfae0f9e, 0xfce0fbe, 0xfee0fde, 0xf0f0ffe
  .long 0x76afedcb, 0x24351098, 0xff2fffff, 0xfffff4ff, 0x2f, 0x24120f, 0x2, 0x0
  .long 0xf2c0f0c, 0xf4c0f3c, 0xf6c0f5c, 0xf8c0f7c, 0xfac0f9c, 0xfcc0fbc, 0xfec0fdc, 0xf1f0ffc
  .long 0x76afedcb, 0x4321598, 0xff0fffff, 0xfffff8ff, 0xf, 0x28100f, 0x0, 0x0
  .long 0xf1a0f0a, 0xf4a0f3a, 0xf6a0f5a, 0xf8a0f7a, 0xfaa0f9a, 0xfca0fba, 0xfea0fda, 0xf2f0ffa
  .long 0x76afedcb, 0x94321058, 0xff6fffff, 0xfffff0ff, 0x9f, 0x20160f, 0x9, 0x0
  .long 0xf190f09, 0xf490f29, 0xf690f59, 0xf890f79, 0xfa90f99, 0xfc90fb9, 0xfe90fd9, 0xf3f0ff9
  .long 0x7a5fedcb, 0x64321098, 0xff5fffff, 0xfffff7ff, 0x6f, 0x27150f, 0x6, 0x0
  .long 0xf160f06, 0xf360f26, 0xf660f56, 0xf860f76, 0xfa60f96, 0xfc60fb6, 0xfe60fd6, 0xf4f0ff6
  .long 0x765feacb, 0xd4321098, 0xffffffff, 0xfffffeff, 0xdf, 0x2e1f0f, 0xd, 0x0
  .long 0xf120f02, 0xf320f22, 0xf620f42, 0xf820f72, 0xfa20f92, 0xfc20fb2, 0xfe20fd2, 0xf5f0ff2
  .long 0xa65fedcb, 0x74321098, 0xffbfffff, 0xfffff8ff, 0x7f, 0x281b0f, 0x7, 0x0
  .long 0xf170f07, 0xf370f27, 0xf570f47, 0xf870f77, 0xfa70f97, 0xfc70fb7, 0xfe70fd7, 0xf6f0ff7
  .long 0x765fedca, 0xb4321098, 0xff9fffff, 0xfffffbff, 0xbf, 0x2b190f, 0xb, 0x0
  .long 0xf100f00, 0xf300f20, 0xf500f40, 0xf800f60, 0xfa00f90, 0xfc00fb0, 0xfe00fd0, 0xf7f0ff0
  .long 0x76afedcb, 0x14325098, 0xff5fffff, 0xfffff7ff, 0x1f, 0x27150f, 0x1, 0x0
  .long 0xf1b0f0b, 0xf3b0f2b, 0xf5b0f4b, 0xf7b0f6b, 0xfab0f9b, 0xfcb0fbb, 0xfeb0fdb, 0xf8f0ffb
  .long 0x76afedcb, 0x34521098, 0xff2fffff, 0xfffff4ff, 0x3f, 0x24120f, 0x3, 0x0
  .long 0xf1d0f0d, 0xf3d0f2d, 0xf5d0f4d, 0xf7d0f6d, 0xfad0f8d, 0xfcd0fbd, 0xfed0fdd, 0xf9f0ffd
  .long 0x765aedcb, 0xf4321098, 0xffefffff, 0xfffffcff, 0xff, 0x2c1e0f, 0xf, 0x0
  .long 0xf140f04, 0xf340f24, 0xf540f44, 0xf740f64, 0xf940f84, 0xfc40fb4, 0xfe40fd4, 0xfaf0ff4
  .long 0x76afedcb, 0x54321098, 0xff6fffff, 0xfffff0ff, 0x56, 0x200f16, 0x5, 0x0
  .long 0x3850305, 0x4750455, 0x4f504d5, 0x6950615, 0x7e50765, 0xb450b25, 0xbc50ba5, 0xfbf0f39
  .long 0x765fedcb, 0x8432109a, 0xff5fffff, 0xfffff7ff, 0x8f, 0x27150f, 0x8, 0x0
  .long 0xf180f08, 0xf380f28, 0xf580f48, 0xf780f68, 0xf980f88, 0xfb80fa8, 0xfe80fd8, 0xfcf0ff8
  .long 0x765fedab, 0xc4321098, 0xffffffff, 0xfffffeff, 0xcf, 0x2e1f0f, 0xc, 0x0
  .long 0xf110f01, 0xf310f21, 0xf510f41, 0xf710f61, 0xf910f81, 0xfb10fa1, 0xfe10fc1, 0xfdf0ff1
  .long 0x765fedcb, 0xa4321098, 0xffbfffff, 0xfffff8ff, 0xa8, 0x1b0f28, 0xa, 0x0
  .long 0x3d50355, 0x7950715, 0x9850905, 0xac50a45, 0xbf50b75, 0xda50d35, 0xf250db5, 0xfef0f67
  .long 0x765fadcb, 0xe4321098, 0xff9fffff, 0xfffffbff, 0xef, 0x2b190f, 0xe, 0x0
  .long 0xf130f03, 0xf330f23, 0xf530f43, 0xf730f63, 0xf930f83, 0xfb30fa3, 0xfd30fc3, 0xfff0fe3
.section .rodata,"a"
.p2align 6
.amdhsa_kernel standalone__kv_cache_quant_pre_rope_vs_post_rope__sampling_kernel
  .amdhsa_next_free_vgpr 243
  .amdhsa_next_free_sgpr 102
  .amdhsa_accum_offset 244
  .amdhsa_group_segment_fixed_size 0
  .amdhsa_kernarg_size 112
  .amdhsa_user_sgpr_count 2
  .amdhsa_user_sgpr_kernarg_segment_ptr 1
  .amdhsa_system_sgpr_workgroup_id_x 1
.end_amdhsa_kernel
```

```asm
; @launch grid=(256,1,1) block=(320,1,1) lds=162304
.amdgcn_target "amdgcn-amd-amdhsa--gfx950"
.text
.globl standalone__kv_cache_quant_pre_rope_vs_post_rope__sampling_kernel
.p2align 12
.type L_pad,@object
L_pad:
.fill 832, 4, 0xbf810000
.p2align 8
.type standalone__kv_cache_quant_pre_rope_vs_post_rope__sampling_kernel,@function
standalone__kv_cache_quant_pre_rope_vs_post_rope__sampling_kernel:
  s_cmpk_ge_u32 s2, 0x100
  s_cbranch_scc1 L_end
  s_load_dwordx16 s[4:19], s[0:1], 0
  s_load_dwordx8 s[20:27], s[0:1], 64
  v_readfirstlane_b32 s40, v0
  s_lshr_b32 s42, s2, 4
  s_cmp_lg_u32 s40, 0
  s_cbranch_scc1 L_s0
  s_setprio 3
  s_getpc_b64 s[64:65]
L_pc0:
  s_and_b32 s44, s2, 56
  v_and_b32 v20, 63, v0
  v_lshl_add_u32 v1, v20, 6, s44
  v_lshlrev_b32 v1, 4, v1
  v_min_u32 v1, L_order_end-L_pc0-1028, v1
  s_bfm_b64 exec, 43, 0
  global_load_dword v2, v1, s[64:65] offset:1024
  s_mov_b64 exec, -1
  v_min_u32 v21, 47, v20
  v_add_u32 v22, 24, v21
  v_subrev_u32 v23, 24, v21
  v_min_u32 v27, v22, v23
  s_mul_i32 s44, s42, 48
  v_add_lshl_u32 v22, v21, s44, 3
  v_add_lshl_u32 v23, v27, s44, 3
  v_lshlrev_b32 v26, 3, v21
  s_and_b32 s44, s2, 7
  s_lshr_b32 s45, s2, 3
  s_mul_i32 s68, s44, 96
  s_add_u32 s68, s68, s45
  v_and_b32 v3, 15, v21
  v_lshl_add_u32 v3, s68, 4, v3
  v_and_b32 v4, 48, v21
  v_lshl_add_u32 v3, v4, 5, v3
  v_lshlrev_b32 v3, 6, v3
  s_mul_i32 s68, s44, 98304
  v_subrev_u32 v12, s68, v3
  s_and_b32 s68, s45, 3
  s_lshl4_add_u32 s44, s68, s44
  s_lshr_b32 s45, s45, 2
  s_lshl_b32 s45, s45, 8
  s_add_u32 s44, s44, s45
  v_and_b32 v4, 7, v20
  v_lshl_add_u32 v4, s44, 3, v4
  v_and_b32 v5, 24, v20
  v_lshl_add_u32 v4, v5, 6, v4
  v_and_b32 v5, 32, v20
  v_lshl_add_u32 v4, v5, 1, v4
  v_lshlrev_b32 v4, 6, v4
  s_waitcnt lgkmcnt(0)
  global_load_dwordx2 v[108:109], v22, s[4:5]
  global_load_dwordx2 v[110:111], v23, s[4:5]
  global_load_dwordx2 v[104:105], v26, s[18:19]
  global_load_dwordx2 v[106:107], v26, s[20:21]
  v_lshlrev_b32 v27, 3, v27
  s_add_u32 s68, s42, 16
  s_mul_i32 s44, s68, 384
  s_add_u32 s32, s4, s44
  s_addc_u32 s33, s5, 0
  global_load_dwordx2 v[68:69], v26, s[32:33]
  global_load_dwordx2 v[70:71], v27, s[32:33]
  global_load_dword v5, v3, s[22:23]
  global_load_dword v6, v3, s[24:25]
  global_load_dword v7, v4, s[8:9]
  global_load_dword v8, v4, s[10:11]
  global_load_dword v9, v4, s[14:15]
  global_load_dword v10, v4, s[16:17]
  global_load_dword v11, v12, s[4:5]
  v_mov_b32 v14, 0
  v_cmp_gt_u32 vcc, 24, v21
  v_mov_b32 v48, 0
  v_mov_b32 v49, 0
  v_mov_b32 v50, 0
  v_mov_b32 v51, 0
  ds_write_b128 v14, v[48:51] offset:0
  ds_write_b128 v14, v[48:51] offset:16
  s_waitcnt lgkmcnt(0)
  s_barrier
  s_mov_b32 s66, 0xffff0000
  s_mov_b32 s67, 0x3dd53b95
  v_cndmask_b32_e64 v30, 1.0, -1.0, vcc
  v_lshlrev_b32 v35, 4, v21
  v_mov_b32 v28, v35
  v_lshlrev_b32 v29, 1, v27
  v_mov_b32 v22, 0x80008000
  v_cndmask_b32 v31, v14, v22, vcc
  v_mov_b32 v38, 1
  s_mov_b32 s43, 1
  s_waitcnt vmcnt(9)
  v_lshlrev_b32 v52, 16, v104
  v_and_b32 v53, s66, v104
  v_lshlrev_b32 v54, 16, v105
  v_and_b32 v55, s66, v105
  v_lshlrev_b32 v56, 16, v106
  v_and_b32 v57, s66, v106
  v_lshlrev_b32 v58, 16, v107
  v_and_b32 v59, s66, v107
L_hr:
  v_lshlrev_b32 v76, 16, v108
  v_and_b32 v77, s66, v108
  v_lshlrev_b32 v78, 16, v109
  v_and_b32 v79, s66, v109
  v_lshlrev_b32 v80, 16, v110
  v_and_b32 v81, s66, v110
  v_lshlrev_b32 v82, 16, v111
  v_and_b32 v83, s66, v111
  v_mul_f32 v76, v76, v52
  v_mul_f32 v77, v77, v53
  v_mul_f32 v78, v78, v54
  v_mul_f32 v79, v79, v55
  v_mul_f32 v80, v80, v56
  v_mul_f32 v81, v81, v57
  v_mul_f32 v82, v82, v58
  v_mul_f32 v83, v83, v59
  v_cvt_pk_bf16_f32 v84, v76, v80
  v_cvt_pk_bf16_f32 v85, v77, v81
  v_cvt_pk_bf16_f32 v86, v78, v82
  v_cvt_pk_bf16_f32 v87, v79, v83
  v_lshlrev_b32 v76, 16, v84
  v_and_b32 v80, s66, v84
  v_lshlrev_b32 v77, 16, v85
  v_and_b32 v81, s66, v85
  v_lshlrev_b32 v78, 16, v86
  v_and_b32 v82, s66, v86
  v_lshlrev_b32 v79, 16, v87
  v_and_b32 v83, s66, v87
  v_fma_f32 v76, v80, v30, v76
  v_fma_f32 v77, v81, v30, v77
  v_fma_f32 v78, v82, v30, v78
  v_fma_f32 v79, v83, v30, v79
  v_cvt_pk_bf16_f32 v84, v76, v77
  v_cvt_pk_bf16_f32 v85, v78, v79
  v_xor_b32 v86, v31, v84
  v_xor_b32 v87, v31, v85
  v_mov_b32 v22, s43
  ds_write_b16 v28, v84 offset:512
  ds_write_b16_d16_hi v28, v84 offset:516
  ds_write_b16 v28, v85 offset:520
  ds_write_b16_d16_hi v28, v85 offset:524
  ds_write_b16 v29, v86 offset:514
  ds_write_b16_d16_hi v29, v86 offset:518
  ds_write_b16 v29, v87 offset:522
  ds_write_b16_d16_hi v29, v87 offset:526
  ds_write_b32 v14, v22 offset:16
  v_add_u32 v28, 1024, v28
  v_add_u32 v29, 1024, v29
  v_and_b32 v28, 0xfff, v28
  v_and_b32 v29, 0xfff, v29
  s_cmp_eq_u32 s43, 2
  s_cbranch_scc1 L_helper
  s_mov_b32 s43, 2
  s_waitcnt vmcnt(7) lgkmcnt(0)
  v_mov_b32 v108, v68
  v_mov_b32 v109, v69
  v_mov_b32 v110, v70
  v_mov_b32 v111, v71
  s_branch L_hr
L_s0:
  v_subrev_u32 v0, 64, v0
  s_sub_u32 s40, s40, 64
  s_and_b32 s44, s2, 7
  s_lshl_b32 s44, s44, 8
  s_bfe_u32 s41, s2, 0x10003
  s_mul_i32 s45, s41, 43
  s_add_u32 s44, s44, s45
  s_mulk_i32 s44, 768
  v_lshl_add_u32 v212, v0, 4, s44
  v_add_u32 v213, 4096, v212
  v_add_u32 v214, 8192, v212
  v_add_u32 v215, 12288, v212
  v_add_u32 v216, 16384, v212
  v_add_u32 v217, 20480, v212
  v_add_u32 v218, 24576, v212
  s_lshr_b32 s40, s40, 6
  v_lshrrev_b32 v25, 4, v0
  v_and_b32 v24, 15, v0
  v_mul_u32_u24 v20, 11, v25
  v_lshrrev_b32 v20, 5, v20
  v_mad_i32_i24 v20, v20, -3, v25
  v_lshlrev_b32 v21, 4, v24
  v_lshl_add_u32 v15, v20, 8, v21
  v_add_u32 v20, 256, v15
  v_subrev_u32 v21, 512, v15
  v_min_u32 v16, v20, v21
  v_add_u32 v20, 512, v15
  v_subrev_u32 v21, 256, v15
  v_min_u32 v17, v20, v21
  v_cmp_gt_u32 vcc, 8, v24
  v_lshlrev_b32 v23, 3, v24
  v_lshrrev_b32 v22, 1, v15
  v_add3_u32 v20, v22, v23, 64
  v_subrev_u32 v21, 384, v20
  v_min_u32 v20, v20, v21
  v_sub_u32 v20, v20, v22
  v_cndmask_b32 v240, v20, v23, vcc
  v_lshrrev_b32 v22, 1, v16
  v_add3_u32 v20, v22, v23, 64
  v_subrev_u32 v21, 384, v20
  v_min_u32 v20, v20, v21
  v_sub_u32 v20, v20, v22
  v_cndmask_b32 v241, v20, v23, vcc
  v_lshrrev_b32 v22, 1, v17
  v_add3_u32 v20, v22, v23, 64
  v_subrev_u32 v21, 384, v20
  v_min_u32 v20, v20, v21
  v_sub_u32 v20, v20, v22
  v_cndmask_b32 v242, v20, v23, vcc
  s_mul_i32 s100, s40, 24576
  s_add_u32 s100, s100, 64000
  s_mul_i32 s44, s42, 1572864
  s_mov_b32 s34, 51904512
  s_mov_b32 s35, 0x20000
  s_mov_b32 s80, 25165824
  s_mov_b32 s3, 50331648
  s_waitcnt lgkmcnt(0)
  s_add_u32 s32, s6, s44
  s_addc_u32 s33, s7, 0
  v_mov_b32 v21, s22
  v_mov_b32 v28, s24
  v_cndmask_b32 v28, v28, v21, vcc
  v_mov_b32 v21, s23
  v_mov_b32 v29, s25
  v_cndmask_b32 v29, v29, v21, vcc
  s_add_u32 m0, s100, 0
  v_lshrrev_b32 v10, 1, v212
  v_add_u32 v10, v10, v240
  v_mad_u64_u32 v[30:31], s[64:65], v10, 1, v[28:29]
  global_load_lds_dwordx4 v[30:31], off
  buffer_load_dwordx4 v[68:71], v212, s[32:35], 0 offen nt
  buffer_load_dwordx4 v[72:75], v213, s[32:35], 0 offen nt
  s_add_u32 m0, s100, 1024
  v_lshrrev_b32 v10, 1, v213
  v_add_u32 v10, v10, v241
  v_mad_u64_u32 v[30:31], s[64:65], v10, 1, v[28:29]
  global_load_lds_dwordx4 v[30:31], off
  buffer_load_dwordx4 v[76:79], v214, s[32:35], 0 offen nt
  buffer_load_dwordx4 v[80:83], v212, s[32:35], s80 offen nt
  s_add_u32 m0, s100, 2048
  v_lshrrev_b32 v10, 1, v214
  v_add_u32 v10, v10, v242
  v_mad_u64_u32 v[30:31], s[64:65], v10, 1, v[28:29]
  global_load_lds_dwordx4 v[30:31], off
  buffer_load_dwordx4 v[84:87], v213, s[32:35], s80 offen nt
  s_barrier
  s_load_dwordx4 s[28:31], s[0:1], 96
  s_getpc_b64 s[82:83]
L_pc1:
  s_lshl_b32 s44, s2, 6
  s_add_u32 s44, s44, L_order-L_pc1
  s_add_u32 s82, s82, s44
  s_addc_u32 s83, s83, 0
  s_load_dwordx2 s[92:93], s[82:83], 0
  s_load_dwordx2 s[96:97], s[82:83], 8
  s_mov_b32 s94, 4000000
  s_mul_i32 s44, s41, 768
  s_add_u32 s44, s44, 32256
  v_add_u32 v20, s44, v212
  v_add_u32 v21, 65280, v212
  s_mul_i32 s45, s41, 3
  v_add_u32 v22, s45, v25
  v_cmp_ge_u32 s[48:49], v22, 17
  v_cmp_ge_u32 s[50:51], v22, 1
  v_cmp_ge_u32 s[52:53], v22, 18
  v_cmp_ge_u32 s[54:55], v22, 2
  v_add_u32 v235, 94208, v21
  v_add_u32 v234, 90112, v21
  v_add_u32 v233, 86016, v21
  v_add_u32 v232, 81920, v21
  v_add_u32 v231, 77824, v21
  v_add_u32 v230, 73728, v21
  v_add_u32 v229, 69632, v21
  v_cndmask_b32_e64 v228, v20, v21, s[54:55]
  v_add_u32 v228, 65536, v228
  v_cndmask_b32_e64 v227, v20, v21, s[52:53]
  v_add_u32 v227, 61440, v227
  v_add_u32 v226, 57344, v20
  v_add_u32 v225, 53248, v20
  v_add_u32 v224, 49152, v20
  v_add_u32 v223, 45056, v20
  v_add_u32 v222, 40960, v20
  v_add_u32 v221, 36864, v20
  v_cndmask_b32_e64 v220, v212, v20, s[50:51]
  v_add_u32 v220, 32768, v220
  v_cndmask_b32_e64 v219, v212, v20, s[48:49]
  v_add_u32 v219, 28672, v219
  v_lshrrev_b32 v22, 6, v0
  v_bfe_u32 v23, v0, 4, 2
  v_mov_b32 v14, 0
  v_and_b32 v20, 3, v0
  v_lshl_add_u32 v1, v20, 5, v25
  v_and_b32 v20, 4, v0
  v_lshl_add_u32 v1, v20, 2, v1
  v_and_b32 v20, 8, v0
  v_mad_u32_u24 v1, v20, 48, v1
  v_lshlrev_b32 v1, 2, v1
  v_add_u32 v1, 45568, v1
  v_lshl_add_u32 v21, v24, 2, v23
  v_mul_u32_u24 v20, 192, v22
  v_add_lshl_u32 v3, v20, v21, 2
  v_add_u32 v3, 64000, v3
  v_lshlrev_b32 v6, 2, v22
  v_mov_b32 v32, 0
  v_mov_b32 v34, 0
  v_mov_b32 v33, 0
  v_mov_b32 v35, 0
  s_mov_b32 s48, 0x11111111
  s_mov_b32 s49, s48
  s_mov_b32 s50, 0x22222222
  s_mov_b32 s51, s50
  s_mov_b32 s52, 0x44444444
  s_mov_b32 s53, s52
  s_mov_b32 s54, 0x88888888
  s_mov_b32 s55, s54
  s_mov_b32 s56, 0x05040100
  s_mov_b32 s57, 0x07060302
  s_mov_b32 s38, 1572864
  s_mov_b32 s39, 0x20000
  v_lshlrev_b32 v21, 8, v23
  v_add_u32 v21, s100, v21
  v_lshl_add_u32 v12, v24, 3, v21
  s_getreg_b32 s81, hwreg(HW_REG_HW_ID, 13, 2)
  s_getreg_b32 s79, hwreg(HW_REG_HW_ID, 8, 4)
  s_getreg_b32 s46, hwreg(HW_REG_XCC_ID, 0, 3)
  s_mul_i32 s46, s46, 4352
  s_add_u32 s46, s46, 8126464
  s_add_u32 s44, s46, 2048
  v_mov_b32 v11, s44
  s_and_b32 s45, s81, 2
  s_lshl_b32 s45, s45, 9
  s_lshl_b32 s44, s40, 8
  s_add_u32 s44, s44, s45
  s_add_u32 s44, s44, s46
  s_add_u32 s44, s44, s79
  s_and_b32 s81, s81, 1
  s_lshl_b32 s81, s81, 4
  s_add_u32 s44, s44, s81
  v_mov_b32 v7, s44
  s_xor_b32 s45, s45, 1024
  s_add_u32 s46, s46, s45
  v_and_b32 v8, 1, v0
  v_lshl_add_u32 v8, v8, 4, s46
  v_bfe_u32 v21, v0, 1, 2
  v_mad_u32_u24 v21, v21, 4, v22
  v_add_u32 v9, 0, v21
  v_and_b32 v9, 3, v9
  v_lshl_add_u32 v236, v9, 8, v8
  v_add_u32 v9, 1, v21
  v_and_b32 v9, 3, v9
  v_lshl_add_u32 v237, v9, 8, v8
  v_add_u32 v9, 2, v21
  v_and_b32 v9, 3, v9
  v_lshl_add_u32 v238, v9, 8, v8
  v_add_u32 v9, 3, v21
  v_and_b32 v9, 3, v9
  v_lshl_add_u32 v239, v9, 8, v8
  s_mov_b32 s78, 0xfefefeff
  v_mov_b32 v36, 0
  v_mov_b32 v37, 0
  v_mov_b32 v38, 0
  v_mov_b32 v39, 0
  v_mov_b32 v40, 0
  v_mov_b32 v41, 0
  v_mov_b32 v42, 0
  v_mov_b32 v43, 0
  v_mov_b32 v26, 0
  v_mov_b32 v27, 0
  s_mov_b32 s90, 3
  s_getreg_b32 s58, hwreg(HW_REG_XCC_ID, 0, 1)
  s_mul_i32 s58, s58, -6
  s_add_u32 s58, s58, 3
  s_mov_b32 s91, s58
  s_mov_b32 s69, 0
  s_mov_b32 s95, 0
  buffer_load_dwordx4 v[88:91], v214, s[32:35], s80 offen nt
  s_add_u32 m0, s100, 3072
  v_lshrrev_b32 v10, 1, v215
  v_add_u32 v10, v10, v240
  v_mad_u64_u32 v[30:31], s[64:65], v10, 1, v[28:29]
  s_waitcnt vmcnt(8)
  global_load_lds_dwordx4 v[30:31], off
  s_waitcnt vmcnt(8)
  buffer_load_dwordx4 v[92:95], v215, s[32:35], 0 offen nt
  s_add_u32 m0, s100, 4096
  v_lshrrev_b32 v10, 1, v216
  v_add_u32 v10, v10, v241
  v_mad_u64_u32 v[30:31], s[64:65], v10, 1, v[28:29]
  s_waitcnt vmcnt(8)
  global_load_lds_dwordx4 v[30:31], off
  s_waitcnt vmcnt(8)
  buffer_load_dwordx4 v[96:99], v216, s[32:35], 0 offen nt
  s_mov_b32 s47, 1
  ds_read_b32 v4, v14 offset:16
L_fqz:
  s_waitcnt lgkmcnt(0)
  v_readfirstlane_b32 s46, v4
  s_cmp_ge_u32 s46, s47
  s_cbranch_scc1 L_fqz_ok
  s_cmp_eq_u32 s94, 0
  s_cbranch_scc1 L_fqz_ok
  s_sub_u32 s94, s94, 1
  ds_read_b32 v4, v14 offset:16
  s_branch L_fqz
L_fqz_ok:
  ds_read_b128 v[44:47], v15 offset:512
  ds_read_b128 v[48:51], v16 offset:512
  ds_read_b128 v[52:55], v17 offset:512
  s_add_u32 m0, s100, 5120
  v_lshrrev_b32 v10, 1, v217
  v_add_u32 v10, v10, v242
  v_mad_u64_u32 v[30:31], s[64:65], v10, 1, v[28:29]
  s_waitcnt vmcnt(8)
  global_load_lds_dwordx4 v[30:31], off
  s_waitcnt vmcnt(7)
  ds_read_b64 v[116:117], v12 offset:0
  ds_read_b64 v[118:119], v12 offset:128
  ds_read_b64 v[120:121], v12 offset:1024
  ds_read_b64 v[122:123], v12 offset:1152
  ds_read_b64 v[124:125], v12 offset:2048
  ds_read_b64 v[126:127], v12 offset:2176
  buffer_load_dwordx4 v[100:103], v217, s[32:35], 0 offen nt
L_it0:
  s_mov_b32 s47, 2
  ds_read_b32 v4, v14 offset:16
L_fq0:
  s_waitcnt lgkmcnt(0)
  v_readfirstlane_b32 s46, v4
  s_cmp_ge_u32 s46, s47
  s_cbranch_scc1 L_fq0_ok
  s_cmp_eq_u32 s94, 0
  s_cbranch_scc1 L_fq0_ok
  s_sub_u32 s94, s94, 1
  ds_read_b32 v4, v14 offset:16
  s_branch L_fq0
L_fq0_ok:
  ds_read_b128 v[56:59], v15 offset:1536
  ds_read_b128 v[60:63], v16 offset:1536
  ds_read_b128 v[64:67], v17 offset:1536
  v_perm_b32 v13, v118, v116, s56
  v_perm_b32 v118, v118, v116, s57
  v_perm_b32 v116, v119, v117, s56
  v_perm_b32 v119, v119, v117, s57
  v_dot2_f32_bf16 v22, v13, v44, 0
  v_dot2_f32_bf16 v23, v118, v45, 0
  v_dot2_f32_bf16 v24, v116, v46, 0
  v_dot2_f32_bf16 v25, v119, v47, 0
  v_cvt_f32_i32 v68, v68
  v_cvt_f32_i32 v69, v69
  v_cvt_f32_i32 v70, v70
  v_cvt_f32_i32 v71, v71
  v_pk_mul_f32 v[20:21], v[68:69], v[22:23]
  v_pk_add_f32 v[18:19], v[22:23], v[24:25]
  v_pk_fma_f32 v[20:21], v[70:71], v[24:25], v[20:21]
  v_add_f32 v18, v18, v19
  v_add_f32 v20, v20, v21
  s_add_u32 m0, s100, 6144
  v_lshrrev_b32 v10, 1, v218
  v_add_u32 v10, v10, v240
  v_mad_u64_u32 v[30:31], s[64:65], v10, 1, v[28:29]
  global_load_lds_dwordx4 v[30:31], off
  s_waitcnt vmcnt(8)
  buffer_load_dwordx4 v[104:107], v215, s[32:35], s80 offen nt
  v_add_f32_dpp v34, v18, v18 row_ror:8 row_mask:0xf bank_mask:0xc
  v_add_f32_dpp v34, v20, v20 row_ror:8 row_mask:0xf bank_mask:0x3
  v_perm_b32 v117, v122, v120, s56
  v_perm_b32 v122, v122, v120, s57
  v_perm_b32 v120, v123, v121, s56
  v_perm_b32 v123, v123, v121, s57
  v_dot2_f32_bf16 v22, v117, v48, 0
  v_dot2_f32_bf16 v23, v122, v49, 0
  v_dot2_f32_bf16 v24, v120, v50, 0
  v_dot2_f32_bf16 v25, v123, v51, 0
  v_cvt_f32_i32 v72, v72
  v_cvt_f32_i32 v73, v73
  v_cvt_f32_i32 v74, v74
  v_cvt_f32_i32 v75, v75
  v_pk_mul_f32 v[20:21], v[72:73], v[22:23]
  v_pk_add_f32 v[18:19], v[22:23], v[24:25]
  v_pk_fma_f32 v[20:21], v[74:75], v[24:25], v[20:21]
  v_add_f32 v18, v18, v19
  v_add_f32 v20, v20, v21
  s_waitcnt vmcnt(8)
  buffer_load_dwordx4 v[108:111], v216, s[32:35], s80 offen nt
  v_add_f32_dpp v21, v18, v18 row_ror:8 row_mask:0xf bank_mask:0xc
  v_add_f32_dpp v21, v20, v20 row_ror:8 row_mask:0xf bank_mask:0x3
  v_add_f32_dpp v20, v34, v34 row_half_mirror row_mask:0xf bank_mask:0x5
  s_nop 0
  v_add_f32_dpp v20, v21, v21 row_half_mirror row_mask:0xf bank_mask:0xa
  s_nop 1
  v_add_f32_dpp v20, v20, v20 quad_perm:[2,3,0,1] row_mask:0xf bank_mask:0xf
  s_nop 1
  v_add_f32_dpp v20, v20, v20 quad_perm:[1,0,3,2] row_mask:0xf bank_mask:0xf
  v_cndmask_b32_e64 v32, v32, v20, s[48:49]
  v_perm_b32 v121, v126, v124, s56
  v_perm_b32 v126, v126, v124, s57
  v_perm_b32 v124, v127, v125, s56
  v_perm_b32 v127, v127, v125, s57
  v_dot2_f32_bf16 v22, v121, v52, 0
  v_dot2_f32_bf16 v23, v126, v53, 0
  v_dot2_f32_bf16 v24, v124, v54, 0
  v_dot2_f32_bf16 v25, v127, v55, 0
  v_cvt_f32_i32 v76, v76
  v_cvt_f32_i32 v77, v77
  v_cvt_f32_i32 v78, v78
  v_cvt_f32_i32 v79, v79
  v_pk_mul_f32 v[20:21], v[76:77], v[22:23]
  v_pk_add_f32 v[18:19], v[22:23], v[24:25]
  v_pk_fma_f32 v[20:21], v[78:79], v[24:25], v[20:21]
  v_add_f32 v18, v18, v19
  v_add_f32 v20, v20, v21
  s_add_u32 m0, s100, 7168
  v_lshrrev_b32 v10, 1, v219
  v_add_u32 v10, v10, v241
  v_mad_u64_u32 v[30:31], s[64:65], v10, 1, v[28:29]
  s_waitcnt vmcnt(8)
  global_load_lds_dwordx4 v[30:31], off
  s_waitcnt vmcnt(8)
  buffer_load_dwordx4 v[112:115], v217, s[32:35], s80 offen nt
  v_add_f32_dpp v34, v18, v18 row_ror:8 row_mask:0xf bank_mask:0xc
  v_add_f32_dpp v34, v20, v20 row_ror:8 row_mask:0xf bank_mask:0x3
L_it1:
  s_waitcnt lgkmcnt(0)
  v_dot2_f32_bf16 v22, v13, v56, 0
  v_dot2_f32_bf16 v23, v118, v57, 0
  v_dot2_f32_bf16 v24, v116, v58, 0
  v_dot2_f32_bf16 v25, v119, v59, 0
  v_cvt_f32_i32 v80, v80
  v_cvt_f32_i32 v81, v81
  v_cvt_f32_i32 v82, v82
  v_cvt_f32_i32 v83, v83
  v_pk_mul_f32 v[20:21], v[80:81], v[22:23]
  v_pk_add_f32 v[18:19], v[22:23], v[24:25]
  v_pk_fma_f32 v[20:21], v[82:83], v[24:25], v[20:21]
  v_add_f32 v18, v18, v19
  v_add_f32 v20, v20, v21
  s_waitcnt vmcnt(8)
  buffer_load_dwordx4 v[68:71], v218, s[32:35], 0 offen nt
  v_add_f32_dpp v35, v18, v18 row_ror:8 row_mask:0xf bank_mask:0xc
  v_add_f32_dpp v35, v20, v20 row_ror:8 row_mask:0xf bank_mask:0x3
  v_dot2_f32_bf16 v22, v117, v60, 0
  v_dot2_f32_bf16 v23, v122, v61, 0
  v_dot2_f32_bf16 v24, v120, v62, 0
  v_dot2_f32_bf16 v25, v123, v63, 0
  v_cvt_f32_i32 v84, v84
  v_cvt_f32_i32 v85, v85
  v_cvt_f32_i32 v86, v86
  v_cvt_f32_i32 v87, v87
  v_pk_mul_f32 v[20:21], v[84:85], v[22:23]
  v_pk_add_f32 v[18:19], v[22:23], v[24:25]
  v_pk_fma_f32 v[20:21], v[86:87], v[24:25], v[20:21]
  v_add_f32 v18, v18, v19
  v_add_f32 v20, v20, v21
  s_add_u32 m0, s100, 8192
  v_lshrrev_b32 v10, 1, v220
  v_add_u32 v10, v10, v242
  v_mad_u64_u32 v[30:31], s[64:65], v10, 1, v[28:29]
  s_waitcnt vmcnt(8)
  global_load_lds_dwordx4 v[30:31], off
  s_waitcnt vmcnt(8)
  buffer_load_dwordx4 v[72:75], v219, s[32:35], 0 offen nt
  v_add_f32_dpp v21, v18, v18 row_ror:8 row_mask:0xf bank_mask:0xc
  v_add_f32_dpp v21, v20, v20 row_ror:8 row_mask:0xf bank_mask:0x3
  v_add_f32_dpp v20, v35, v35 row_half_mirror row_mask:0xf bank_mask:0x5
  s_nop 0
  v_add_f32_dpp v20, v21, v21 row_half_mirror row_mask:0xf bank_mask:0xa
  s_nop 1
  v_add_f32_dpp v20, v20, v20 quad_perm:[2,3,0,1] row_mask:0xf bank_mask:0xf
  s_nop 1
  v_add_f32_dpp v20, v20, v20 quad_perm:[1,0,3,2] row_mask:0xf bank_mask:0xf
  v_cndmask_b32_e64 v33, v33, v20, s[48:49]
  ds_read_b64 v[128:129], v12 offset:3072
  ds_read_b64 v[130:131], v12 offset:3200
  ds_read_b64 v[132:133], v12 offset:4096
  ds_read_b64 v[134:135], v12 offset:4224
  ds_read_b64 v[136:137], v12 offset:5120
  ds_read_b64 v[138:139], v12 offset:5248
  v_dot2_f32_bf16 v22, v121, v64, 0
  v_dot2_f32_bf16 v23, v126, v65, 0
  v_dot2_f32_bf16 v24, v124, v66, 0
  v_dot2_f32_bf16 v25, v127, v67, 0
  v_cvt_f32_i32 v88, v88
  v_cvt_f32_i32 v89, v89
  v_cvt_f32_i32 v90, v90
  v_cvt_f32_i32 v91, v91
  v_pk_mul_f32 v[20:21], v[88:89], v[22:23]
  v_pk_add_f32 v[18:19], v[22:23], v[24:25]
  v_pk_fma_f32 v[20:21], v[90:91], v[24:25], v[20:21]
  v_add_f32 v18, v18, v19
  v_add_f32 v20, v20, v21
  s_waitcnt vmcnt(8)
  buffer_load_dwordx4 v[76:79], v220, s[32:35], 0 offen nt
  v_add_f32_dpp v35, v18, v18 row_ror:8 row_mask:0xf bank_mask:0xc
  v_add_f32_dpp v35, v20, v20 row_ror:8 row_mask:0xf bank_mask:0x3
L_it2:
  s_waitcnt lgkmcnt(0)
  v_perm_b32 v125, v130, v128, s56
  v_perm_b32 v130, v130, v128, s57
  v_perm_b32 v128, v131, v129, s56
  v_perm_b32 v131, v131, v129, s57
  v_dot2_f32_bf16 v22, v125, v44, 0
  v_dot2_f32_bf16 v23, v130, v45, 0
  v_dot2_f32_bf16 v24, v128, v46, 0
  v_dot2_f32_bf16 v25, v131, v47, 0
  v_cvt_f32_i32 v92, v92
  v_cvt_f32_i32 v93, v93
  v_cvt_f32_i32 v94, v94
  v_cvt_f32_i32 v95, v95
  v_pk_mul_f32 v[20:21], v[92:93], v[22:23]
  v_pk_add_f32 v[18:19], v[22:23], v[24:25]
  v_pk_fma_f32 v[20:21], v[94:95], v[24:25], v[20:21]
  v_add_f32 v18, v18, v19
  v_add_f32 v20, v20, v21
  s_add_u32 m0, s100, 9216
  v_lshrrev_b32 v10, 1, v221
  v_add_u32 v10, v10, v240
  v_mad_u64_u32 v[30:31], s[64:65], v10, 1, v[28:29]
  s_waitcnt vmcnt(8)
  global_load_lds_dwordx4 v[30:31], off
  s_waitcnt vmcnt(8)
  buffer_load_dwordx4 v[80:83], v218, s[32:35], s80 offen nt
  v_add_f32_dpp v21, v18, v18 row_ror:8 row_mask:0xf bank_mask:0xc
  v_add_f32_dpp v21, v20, v20 row_ror:8 row_mask:0xf bank_mask:0x3
  v_add_f32_dpp v20, v34, v34 row_half_mirror row_mask:0xf bank_mask:0x5
  s_nop 0
  v_add_f32_dpp v20, v21, v21 row_half_mirror row_mask:0xf bank_mask:0xa
  s_nop 1
  v_add_f32_dpp v20, v20, v20 quad_perm:[2,3,0,1] row_mask:0xf bank_mask:0xf
  s_nop 1
  v_add_f32_dpp v20, v20, v20 quad_perm:[1,0,3,2] row_mask:0xf bank_mask:0xf
  v_cndmask_b32_e64 v32, v32, v20, s[50:51]
  v_perm_b32 v129, v134, v132, s56
  v_perm_b32 v134, v134, v132, s57
  v_perm_b32 v132, v135, v133, s56
  v_perm_b32 v135, v135, v133, s57
  v_dot2_f32_bf16 v22, v129, v48, 0
  v_dot2_f32_bf16 v23, v134, v49, 0
  v_dot2_f32_bf16 v24, v132, v50, 0
  v_dot2_f32_bf16 v25, v135, v51, 0
  v_cvt_f32_i32 v96, v96
  v_cvt_f32_i32 v97, v97
  v_cvt_f32_i32 v98, v98
  v_cvt_f32_i32 v99, v99
  v_pk_mul_f32 v[20:21], v[96:97], v[22:23]
  v_pk_add_f32 v[18:19], v[22:23], v[24:25]
  v_pk_fma_f32 v[20:21], v[98:99], v[24:25], v[20:21]
  v_add_f32 v18, v18, v19
  v_add_f32 v20, v20, v21
  s_waitcnt vmcnt(8)
  buffer_load_dwordx4 v[84:87], v219, s[32:35], s80 offen nt
  v_add_f32_dpp v34, v18, v18 row_ror:8 row_mask:0xf bank_mask:0xc
  v_add_f32_dpp v34, v20, v20 row_ror:8 row_mask:0xf bank_mask:0x3
  v_perm_b32 v133, v138, v136, s56
  v_perm_b32 v138, v138, v136, s57
  v_perm_b32 v136, v139, v137, s56
  v_perm_b32 v139, v139, v137, s57
  v_dot2_f32_bf16 v22, v133, v52, 0
  v_dot2_f32_bf16 v23, v138, v53, 0
  v_dot2_f32_bf16 v24, v136, v54, 0
  v_dot2_f32_bf16 v25, v139, v55, 0
  v_cvt_f32_i32 v100, v100
  v_cvt_f32_i32 v101, v101
  v_cvt_f32_i32 v102, v102
  v_cvt_f32_i32 v103, v103
  v_pk_mul_f32 v[20:21], v[100:101], v[22:23]
  v_pk_add_f32 v[18:19], v[22:23], v[24:25]
  v_pk_fma_f32 v[20:21], v[102:103], v[24:25], v[20:21]
  v_add_f32 v18, v18, v19
  v_add_f32 v20, v20, v21
  s_add_u32 m0, s100, 10240
  v_lshrrev_b32 v10, 1, v222
  v_add_u32 v10, v10, v241
  v_mad_u64_u32 v[30:31], s[64:65], v10, 1, v[28:29]
  s_waitcnt vmcnt(8)
  global_load_lds_dwordx4 v[30:31], off
  s_waitcnt vmcnt(8)
  buffer_load_dwordx4 v[88:91], v220, s[32:35], s80 offen nt
  v_add_f32_dpp v21, v18, v18 row_ror:8 row_mask:0xf bank_mask:0xc
  v_add_f32_dpp v21, v20, v20 row_ror:8 row_mask:0xf bank_mask:0x3
  v_add_f32_dpp v20, v34, v34 row_half_mirror row_mask:0xf bank_mask:0x5
  s_nop 0
  v_add_f32_dpp v20, v21, v21 row_half_mirror row_mask:0xf bank_mask:0xa
  s_nop 1
  v_add_f32_dpp v20, v20, v20 quad_perm:[2,3,0,1] row_mask:0xf bank_mask:0xf
  s_nop 1
  v_add_f32_dpp v20, v20, v20 quad_perm:[1,0,3,2] row_mask:0xf bank_mask:0xf
  v_cndmask_b32_e64 v32, v32, v20, s[52:53]
L_it3:
  s_waitcnt lgkmcnt(0)
  s_add_u32 s44, s78, 0x03030303
  v_msad_u8 v9, s78, v40, 0
  v_msad_u8 v10, s44, v40, 0
  v_msad_u8 v9, s78, v41, v9
  v_msad_u8 v10, s44, v41, v10
  v_msad_u8 v9, s78, v42, v9
  v_msad_u8 v10, s44, v42, v10
  v_sub_u32 v9, v9, v10
  v_mov_b32 v8, s90
  s_add_u32 s78, s78, 0x01010101
  v_readlane_b32 s66, v9, 0
  v_readlane_b32 s67, v9, 1
  s_mov_b64 exec, 1
  global_store_byte v7, v8, s[30:31]
  s_mov_b64 exec, 3
  global_load_dwordx3 v[40:42], v239, s[30:31] sc1
  s_mov_b64 exec, -1
  s_add_u32 s69, s66, s67
  s_add_u32 s44, s69, s95
  s_mov_b32 s95, s69
  s_ashr_i32 s69, s44, 1
  s_add_u32 s69, s69, s91
  s_cmp_lt_u32 s90, 5
  s_cselect_b32 s69, 0, s69
  s_add_u32 s90, s90, 1
  v_dot2_f32_bf16 v22, v125, v56, 0
  v_dot2_f32_bf16 v23, v130, v57, 0
  v_dot2_f32_bf16 v24, v128, v58, 0
  v_dot2_f32_bf16 v25, v131, v59, 0
  v_cvt_f32_i32 v104, v104
  v_cvt_f32_i32 v105, v105
  v_cvt_f32_i32 v106, v106
  v_cvt_f32_i32 v107, v107
  v_pk_mul_f32 v[20:21], v[104:105], v[22:23]
  v_pk_add_f32 v[18:19], v[22:23], v[24:25]
  v_pk_fma_f32 v[20:21], v[106:107], v[24:25], v[20:21]
  v_add_f32 v18, v18, v19
  v_add_f32 v20, v20, v21
  s_cmp_gt_i32 s69, 17
  s_cbranch_scc1 L_q2
  s_cmp_gt_i32 s69, -13
  s_cbranch_scc1 L_p2
  s_waitcnt vmcnt(6)
L_p2:
  s_waitcnt vmcnt(8)
L_q2:
  s_waitcnt vmcnt(9)
  buffer_load_dwordx4 v[92:95], v221, s[32:35], 0 offen nt
  v_add_f32_dpp v21, v18, v18 row_ror:8 row_mask:0xf bank_mask:0xc
  v_add_f32_dpp v21, v20, v20 row_ror:8 row_mask:0xf bank_mask:0x3
  v_add_f32_dpp v20, v35, v35 row_half_mirror row_mask:0xf bank_mask:0x5
  s_nop 0
  v_add_f32_dpp v20, v21, v21 row_half_mirror row_mask:0xf bank_mask:0xa
  s_nop 1
  v_add_f32_dpp v20, v20, v20 quad_perm:[2,3,0,1] row_mask:0xf bank_mask:0xf
  s_nop 1
  v_add_f32_dpp v20, v20, v20 quad_perm:[1,0,3,2] row_mask:0xf bank_mask:0xf
  v_cndmask_b32_e64 v33, v33, v20, s[50:51]
  v_dot2_f32_bf16 v22, v129, v60, 0
  v_dot2_f32_bf16 v23, v134, v61, 0
  v_dot2_f32_bf16 v24, v132, v62, 0
  v_dot2_f32_bf16 v25, v135, v63, 0
  v_cvt_f32_i32 v108, v108
  v_cvt_f32_i32 v109, v109
  v_cvt_f32_i32 v110, v110
  v_cvt_f32_i32 v111, v111
  v_pk_mul_f32 v[20:21], v[108:109], v[22:23]
  v_pk_add_f32 v[18:19], v[22:23], v[24:25]
  v_pk_fma_f32 v[20:21], v[110:111], v[24:25], v[20:21]
  v_add_f32 v18, v18, v19
  v_add_f32 v20, v20, v21
  s_add_u32 m0, s100, 11264
  v_lshrrev_b32 v10, 1, v223
  v_add_u32 v10, v10, v242
  v_mad_u64_u32 v[30:31], s[64:65], v10, 1, v[28:29]
  global_load_lds_dwordx4 v[30:31], off
  s_cmp_gt_i32 s69, 17
  s_cbranch_scc1 L_q3
  s_cmp_gt_i32 s69, 2
  s_cbranch_scc1 L_p3
  s_waitcnt vmcnt(8)
L_p3:
  s_waitcnt vmcnt(10)
L_q3:
  s_waitcnt vmcnt(11)
  buffer_load_dwordx4 v[96:99], v222, s[32:35], 0 offen nt
  v_add_f32_dpp v35, v18, v18 row_ror:8 row_mask:0xf bank_mask:0xc
  v_add_f32_dpp v35, v20, v20 row_ror:8 row_mask:0xf bank_mask:0x3
  s_waitcnt vmcnt(11)
  ds_read_b64 v[140:141], v12 offset:6144
  ds_read_b64 v[142:143], v12 offset:6272
  ds_read_b64 v[144:145], v12 offset:7168
  ds_read_b64 v[146:147], v12 offset:7296
  ds_read_b64 v[148:149], v12 offset:8192
  ds_read_b64 v[150:151], v12 offset:8320
  v_dot2_f32_bf16 v22, v133, v64, 0
  v_dot2_f32_bf16 v23, v138, v65, 0
  v_dot2_f32_bf16 v24, v136, v66, 0
  v_dot2_f32_bf16 v25, v139, v67, 0
  v_cvt_f32_i32 v112, v112
  v_cvt_f32_i32 v113, v113
  v_cvt_f32_i32 v114, v114
  v_cvt_f32_i32 v115, v115
  v_pk_mul_f32 v[20:21], v[112:113], v[22:23]
  v_pk_add_f32 v[18:19], v[22:23], v[24:25]
  v_pk_fma_f32 v[20:21], v[114:115], v[24:25], v[20:21]
  v_add_f32 v18, v18, v19
  v_add_f32 v20, v20, v21
  s_cmp_lt_i32 s69, -25
  s_cbranch_scc0 L_t4
  s_waitcnt vmcnt(8)
L_t4:
  s_cmp_gt_i32 s69, 17
  s_cbranch_scc1 L_q5
  s_cmp_gt_i32 s69, 9
  s_cbranch_scc1 L_p5
  s_waitcnt vmcnt(9)
L_p5:
  s_waitcnt vmcnt(11)
L_q5:
  s_waitcnt vmcnt(12)
  buffer_load_dwordx4 v[100:103], v223, s[32:35], 0 offen nt
  v_add_f32_dpp v21, v18, v18 row_ror:8 row_mask:0xf bank_mask:0xc
  v_add_f32_dpp v21, v20, v20 row_ror:8 row_mask:0xf bank_mask:0x3
  v_add_f32_dpp v20, v35, v35 row_half_mirror row_mask:0xf bank_mask:0x5
  s_nop 0
  v_add_f32_dpp v20, v21, v21 row_half_mirror row_mask:0xf bank_mask:0xa
  s_nop 1
  v_add_f32_dpp v20, v20, v20 quad_perm:[2,3,0,1] row_mask:0xf bank_mask:0xf
  s_nop 1
  v_add_f32_dpp v20, v20, v20 quad_perm:[1,0,3,2] row_mask:0xf bank_mask:0xf
  v_cndmask_b32_e64 v33, v33, v20, s[52:53]
L_it4:
  s_waitcnt lgkmcnt(0)
  s_add_u32 s44, s78, 0x03030303
  v_msad_u8 v9, s78, v36, 0
  v_msad_u8 v10, s44, v36, 0
  v_msad_u8 v9, s78, v37, v9
  v_msad_u8 v10, s44, v37, v10
  v_msad_u8 v9, s78, v38, v9
  v_msad_u8 v10, s44, v38, v10
  v_sub_u32 v9, v9, v10
  v_mov_b32 v8, s90
  s_add_u32 s78, s78, 0x01010101
  v_readlane_b32 s66, v9, 0
  v_readlane_b32 s67, v9, 1
  s_mov_b64 exec, 1
  global_store_byte v7, v8, s[30:31]
  s_mov_b64 exec, 3
  global_load_dwordx3 v[36:38], v236, s[30:31] sc1
  s_mov_b64 exec, -1
  s_add_u32 s69, s66, s67
  s_add_u32 s44, s69, s95
  s_mov_b32 s95, s69
  s_ashr_i32 s69, s44, 1
  s_add_u32 s69, s69, s91
  s_cmp_lt_u32 s90, 5
  s_cselect_b32 s69, 0, s69
  s_add_u32 s90, s90, 1
  v_perm_b32 v137, v142, v140, s56
  v_perm_b32 v142, v142, v140, s57
  v_perm_b32 v140, v143, v141, s56
  v_perm_b32 v143, v143, v141, s57
  v_dot2_f32_bf16 v22, v137, v44, 0
  v_dot2_f32_bf16 v23, v142, v45, 0
  v_dot2_f32_bf16 v24, v140, v46, 0
  v_dot2_f32_bf16 v25, v143, v47, 0
  v_cvt_f32_i32 v68, v68
  v_cvt_f32_i32 v69, v69
  v_cvt_f32_i32 v70, v70
  v_cvt_f32_i32 v71, v71
  v_pk_mul_f32 v[20:21], v[68:69], v[22:23]
  v_pk_add_f32 v[18:19], v[22:23], v[24:25]
  v_pk_fma_f32 v[20:21], v[70:71], v[24:25], v[20:21]
  v_add_f32 v18, v18, v19
  v_add_f32 v20, v20, v21
  s_add_u32 m0, s100, 12288
  v_lshrrev_b32 v10, 1, v224
  v_add_u32 v10, v10, v240
  v_mad_u64_u32 v[30:31], s[64:65], v10, 1, v[28:29]
  global_load_lds_dwordx4 v[30:31], off
  s_cmp_gt_i32 s69, 17
  s_cbranch_scc1 L_q6
  s_cmp_gt_i32 s69, -13
  s_cbranch_scc1 L_p6
  s_waitcnt vmcnt(7)
L_p6:
  s_waitcnt vmcnt(10)
L_q6:
  s_waitcnt vmcnt(12)
  buffer_load_dwordx4 v[104:107], v221, s[32:35], s80 offen nt
  v_add_f32_dpp v34, v18, v18 row_ror:8 row_mask:0xf bank_mask:0xc
  v_add_f32_dpp v34, v20, v20 row_ror:8 row_mask:0xf bank_mask:0x3
  v_perm_b32 v141, v146, v144, s56
  v_perm_b32 v146, v146, v144, s57
  v_perm_b32 v144, v147, v145, s56
  v_perm_b32 v147, v147, v145, s57
  v_dot2_f32_bf16 v22, v141, v48, 0
  v_dot2_f32_bf16 v23, v146, v49, 0
  v_dot2_f32_bf16 v24, v144, v50, 0
  v_dot2_f32_bf16 v25, v147, v51, 0
  v_cvt_f32_i32 v72, v72
  v_cvt_f32_i32 v73, v73
  v_cvt_f32_i32 v74, v74
  v_cvt_f32_i32 v75, v75
  v_pk_mul_f32 v[20:21], v[72:73], v[22:23]
  v_pk_add_f32 v[18:19], v[22:23], v[24:25]
  v_pk_fma_f32 v[20:21], v[74:75], v[24:25], v[20:21]
  v_add_f32 v18, v18, v19
  v_add_f32 v20, v20, v21
  s_cmp_gt_i32 s69, 17
  s_cbranch_scc1 L_q7
  s_cmp_gt_i32 s69, 2
  s_cbranch_scc1 L_p7
  s_waitcnt vmcnt(8)
L_p7:
  s_waitcnt vmcnt(11)
L_q7:
  s_waitcnt vmcnt(13)
  buffer_load_dwordx4 v[108:111], v222, s[32:35], s80 offen nt
  v_add_f32_dpp v21, v18, v18 row_ror:8 row_mask:0xf bank_mask:0xc
  v_add_f32_dpp v21, v20, v20 row_ror:8 row_mask:0xf bank_mask:0x3
  v_add_f32_dpp v20, v34, v34 row_half_mirror row_mask:0xf bank_mask:0x5
  s_nop 0
  v_add_f32_dpp v20, v21, v21 row_half_mirror row_mask:0xf bank_mask:0xa
  s_nop 1
  v_add_f32_dpp v20, v20, v20 quad_perm:[2,3,0,1] row_mask:0xf bank_mask:0xf
  s_nop 1
  v_add_f32_dpp v20, v20, v20 quad_perm:[1,0,3,2] row_mask:0xf bank_mask:0xf
  v_cndmask_b32_e64 v32, v32, v20, s[54:55]
  ds_write_b32 v1, v32 offset:0
  v_perm_b32 v145, v150, v148, s56
  v_perm_b32 v150, v150, v148, s57
  v_perm_b32 v148, v151, v149, s56
  v_perm_b32 v151, v151, v149, s57
  v_dot2_f32_bf16 v22, v145, v52, 0
  v_dot2_f32_bf16 v23, v150, v53, 0
  v_dot2_f32_bf16 v24, v148, v54, 0
  v_dot2_f32_bf16 v25, v151, v55, 0
  v_cvt_f32_i32 v76, v76
  v_cvt_f32_i32 v77, v77
  v_cvt_f32_i32 v78, v78
  v_cvt_f32_i32 v79, v79
  v_pk_mul_f32 v[20:21], v[76:77], v[22:23]
  v_pk_add_f32 v[18:19], v[22:23], v[24:25]
  v_pk_fma_f32 v[20:21], v[78:79], v[24:25], v[20:21]
  v_add_f32 v18, v18, v19
  v_add_f32 v20, v20, v21
  s_add_u32 m0, s100, 13312
  v_lshrrev_b32 v10, 1, v225
  v_add_u32 v10, v10, v241
  v_mad_u64_u32 v[30:31], s[64:65], v10, 1, v[28:29]
  global_load_lds_dwordx4 v[30:31], off
  s_cmp_lt_i32 s69, -25
  s_cbranch_scc0 L_t8
  s_waitcnt vmcnt(8)
L_t8:
  s_cmp_gt_i32 s69, 17
  s_cbranch_scc1 L_q9
  s_cmp_gt_i32 s69, 9
  s_cbranch_scc1 L_p9
  s_waitcnt vmcnt(10)
L_p9:
  s_waitcnt vmcnt(13)
L_q9:
  s_waitcnt vmcnt(15)
  buffer_load_dwordx4 v[112:115], v223, s[32:35], s80 offen nt
  v_add_f32_dpp v34, v18, v18 row_ror:8 row_mask:0xf bank_mask:0xc
  v_add_f32_dpp v34, v20, v20 row_ror:8 row_mask:0xf bank_mask:0x3
L_it5:
  s_waitcnt lgkmcnt(0)
  s_mov_b64 exec, 1
  global_load_dwordx2 v[26:27], v11, s[30:31] sc1
  s_mov_b64 exec, -1
  s_waitcnt vmcnt(11)
  s_add_u32 s44, s78, 0x03030303
  v_msad_u8 v9, s78, v40, 0
  v_msad_u8 v10, s44, v40, 0
  v_msad_u8 v9, s78, v41, v9
  v_msad_u8 v10, s44, v41, v10
  v_msad_u8 v9, s78, v42, v9
  v_msad_u8 v10, s44, v42, v10
  v_sub_u32 v9, v9, v10
  v_mov_b32 v8, s90
  s_add_u32 s78, s78, 0x01010101
  v_readlane_b32 s66, v9, 0
  v_readlane_b32 s67, v9, 1
  s_mov_b64 exec, 1
  global_store_byte v7, v8, s[30:31]
  s_mov_b64 exec, 3
  global_load_dwordx3 v[40:42], v237, s[30:31] sc1
  s_mov_b64 exec, -1
  s_add_u32 s69, s66, s67
  s_add_u32 s44, s69, s95
  s_mov_b32 s95, s69
  s_ashr_i32 s69, s44, 1
  s_add_u32 s69, s69, s91
  s_cmp_lt_u32 s90, 5
  s_cselect_b32 s69, 0, s69
  s_add_u32 s90, s90, 1
  v_dot2_f32_bf16 v22, v137, v56, 0
  v_dot2_f32_bf16 v23, v142, v57, 0
  v_dot2_f32_bf16 v24, v140, v58, 0
  v_dot2_f32_bf16 v25, v143, v59, 0
  v_cvt_f32_i32 v80, v80
  v_cvt_f32_i32 v81, v81
  v_cvt_f32_i32 v82, v82
  v_cvt_f32_i32 v83, v83
  v_pk_mul_f32 v[20:21], v[80:81], v[22:23]
  v_pk_add_f32 v[18:19], v[22:23], v[24:25]
  v_pk_fma_f32 v[20:21], v[82:83], v[24:25], v[20:21]
  v_add_f32 v18, v18, v19
  v_add_f32 v20, v20, v21
  s_cmp_gt_i32 s69, 17
  s_cbranch_scc1 L_q10
  s_cmp_gt_i32 s69, -13
  s_cbranch_scc1 L_p10
  s_waitcnt vmcnt(7)
L_p10:
  s_waitcnt vmcnt(11)
L_q10:
  s_waitcnt vmcnt(12)
  buffer_load_dwordx4 v[68:71], v224, s[32:35], 0 offen nt
  v_add_f32_dpp v35, v18, v18 row_ror:8 row_mask:0xf bank_mask:0xc
  v_add_f32_dpp v35, v20, v20 row_ror:8 row_mask:0xf bank_mask:0x3
  v_dot2_f32_bf16 v22, v141, v60, 0
  v_dot2_f32_bf16 v23, v146, v61, 0
  v_dot2_f32_bf16 v24, v144, v62, 0
  v_dot2_f32_bf16 v25, v147, v63, 0
  v_cvt_f32_i32 v84, v84
  v_cvt_f32_i32 v85, v85
  v_cvt_f32_i32 v86, v86
  v_cvt_f32_i32 v87, v87
  v_pk_mul_f32 v[20:21], v[84:85], v[22:23]
  v_pk_add_f32 v[18:19], v[22:23], v[24:25]
  v_pk_fma_f32 v[20:21], v[86:87], v[24:25], v[20:21]
  v_add_f32 v18, v18, v19
  v_add_f32 v20, v20, v21
  s_add_u32 m0, s100, 14336
  v_lshrrev_b32 v10, 1, v226
  v_add_u32 v10, v10, v242
  v_mad_u64_u32 v[30:31], s[64:65], v10, 1, v[28:29]
  global_load_lds_dwordx4 v[30:31], off
  s_cmp_gt_i32 s69, 17
  s_cbranch_scc1 L_q11
  s_cmp_gt_i32 s69, 2
  s_cbranch_scc1 L_p11
  s_waitcnt vmcnt(9)
L_p11:
  s_waitcnt vmcnt(13)
L_q11:
  s_waitcnt vmcnt(14)
  buffer_load_dwordx4 v[72:75], v225, s[32:35], 0 offen nt
  v_add_f32_dpp v21, v18, v18 row_ror:8 row_mask:0xf bank_mask:0xc
  v_add_f32_dpp v21, v20, v20 row_ror:8 row_mask:0xf bank_mask:0x3
  v_add_f32_dpp v20, v35, v35 row_half_mirror row_mask:0xf bank_mask:0x5
  s_nop 0
  v_add_f32_dpp v20, v21, v21 row_half_mirror row_mask:0xf bank_mask:0xa
  s_nop 1
  v_add_f32_dpp v20, v20, v20 quad_perm:[2,3,0,1] row_mask:0xf bank_mask:0xf
  s_nop 1
  v_add_f32_dpp v20, v20, v20 quad_perm:[1,0,3,2] row_mask:0xf bank_mask:0xf
  v_cndmask_b32_e64 v33, v33, v20, s[54:55]
  ds_write_b32 v1, v33 offset:3072
  s_waitcnt vmcnt(13)
  ds_read_b64 v[152:153], v12 offset:9216
  ds_read_b64 v[154:155], v12 offset:9344
  ds_read_b64 v[156:157], v12 offset:10240
  ds_read_b64 v[158:159], v12 offset:10368
  ds_read_b64 v[160:161], v12 offset:11264
  ds_read_b64 v[162:163], v12 offset:11392
  v_dot2_f32_bf16 v22, v145, v64, 0
  v_dot2_f32_bf16 v23, v150, v65, 0
  v_dot2_f32_bf16 v24, v148, v66, 0
  v_dot2_f32_bf16 v25, v151, v67, 0
  v_cvt_f32_i32 v88, v88
  v_cvt_f32_i32 v89, v89
  v_cvt_f32_i32 v90, v90
  v_cvt_f32_i32 v91, v91
  v_pk_mul_f32 v[20:21], v[88:89], v[22:23]
  v_pk_add_f32 v[18:19], v[22:23], v[24:25]
  v_pk_fma_f32 v[20:21], v[90:91], v[24:25], v[20:21]
  v_add_f32 v18, v18, v19
  v_add_f32 v20, v20, v21
  s_cmp_lt_i32 s69, -25
  s_cbranch_scc0 L_t12
  s_waitcnt vmcnt(9)
L_t12:
  s_cmp_gt_i32 s69, 17
  s_cbranch_scc1 L_q13
  s_cmp_gt_i32 s69, 9
  s_cbranch_scc1 L_p13
  s_waitcnt vmcnt(10)
L_p13:
  s_waitcnt vmcnt(14)
L_q13:
  s_waitcnt vmcnt(15)
  buffer_load_dwordx4 v[76:79], v226, s[32:35], 0 offen nt
  v_add_f32_dpp v35, v18, v18 row_ror:8 row_mask:0xf bank_mask:0xc
  v_add_f32_dpp v35, v20, v20 row_ror:8 row_mask:0xf bank_mask:0x3
L_it6:
  s_waitcnt lgkmcnt(0)
  s_waitcnt vmcnt(11)
  s_add_u32 s44, s78, 0x03030303
  v_msad_u8 v9, s78, v36, 0
  v_msad_u8 v10, s44, v36, 0
  v_msad_u8 v9, s78, v37, v9
  v_msad_u8 v10, s44, v37, v10
  v_msad_u8 v9, s78, v38, v9
  v_msad_u8 v10, s44, v38, v10
  v_sub_u32 v9, v9, v10
  v_mov_b32 v8, s90
  s_add_u32 s78, s78, 0x01010101
  v_readlane_b32 s66, v9, 0
  v_readlane_b32 s67, v9, 1
  s_mov_b64 exec, 1
  global_store_byte v7, v8, s[30:31]
  s_mov_b64 exec, 3
  global_load_dwordx3 v[36:38], v238, s[30:31] sc1
  s_mov_b64 exec, -1
  s_add_u32 s69, s66, s67
  s_add_u32 s44, s69, s95
  s_mov_b32 s95, s69
  s_ashr_i32 s69, s44, 1
  s_add_u32 s69, s69, s91
  s_cmp_lt_u32 s90, 5
  s_cselect_b32 s69, 0, s69
  s_add_u32 s90, s90, 1
  v_perm_b32 v149, v154, v152, s56
  v_perm_b32 v154, v154, v152, s57
  v_perm_b32 v152, v155, v153, s56
  v_perm_b32 v155, v155, v153, s57
  v_dot2_f32_bf16 v22, v149, v44, 0
  v_dot2_f32_bf16 v23, v154, v45, 0
  v_dot2_f32_bf16 v24, v152, v46, 0
  v_dot2_f32_bf16 v25, v155, v47, 0
  v_cvt_f32_i32 v92, v92
  v_cvt_f32_i32 v93, v93
  v_cvt_f32_i32 v94, v94
  v_cvt_f32_i32 v95, v95
  v_pk_mul_f32 v[20:21], v[92:93], v[22:23]
  v_pk_add_f32 v[18:19], v[22:23], v[24:25]
  v_pk_fma_f32 v[20:21], v[94:95], v[24:25], v[20:21]
  v_add_f32 v18, v18, v19
  v_add_f32 v20, v20, v21
  s_add_u32 m0, s100, 15360
  v_lshrrev_b32 v10, 1, v227
  v_add_u32 v10, v10, v240
  v_mad_u64_u32 v[30:31], s[64:65], v10, 1, v[28:29]
  global_load_lds_dwordx4 v[30:31], off
  s_cmp_gt_i32 s69, 17
  s_cbranch_scc1 L_q14
  s_cmp_gt_i32 s69, -13
  s_cbranch_scc1 L_p14
  s_waitcnt vmcnt(7)
L_p14:
  s_waitcnt vmcnt(11)
L_q14:
  s_waitcnt vmcnt(13)
  buffer_load_dwordx4 v[80:83], v224, s[32:35], s80 offen nt
  v_add_f32_dpp v21, v18, v18 row_ror:8 row_mask:0xf bank_mask:0xc
  v_add_f32_dpp v21, v20, v20 row_ror:8 row_mask:0xf bank_mask:0x3
  v_add_f32_dpp v20, v34, v34 row_half_mirror row_mask:0xf bank_mask:0x5
  s_nop 0
  v_add_f32_dpp v20, v21, v21 row_half_mirror row_mask:0xf bank_mask:0xa
  s_nop 1
  v_add_f32_dpp v20, v20, v20 quad_perm:[2,3,0,1] row_mask:0xf bank_mask:0xf
  s_nop 1
  v_add_f32_dpp v20, v20, v20 quad_perm:[1,0,3,2] row_mask:0xf bank_mask:0xf
  v_cndmask_b32_e64 v32, v32, v20, s[48:49]
  v_perm_b32 v153, v158, v156, s56
  v_perm_b32 v158, v158, v156, s57
  v_perm_b32 v156, v159, v157, s56
  v_perm_b32 v159, v159, v157, s57
  v_dot2_f32_bf16 v22, v153, v48, 0
  v_dot2_f32_bf16 v23, v158, v49, 0
  v_dot2_f32_bf16 v24, v156, v50, 0
  v_dot2_f32_bf16 v25, v159, v51, 0
  v_cvt_f32_i32 v96, v96
  v_cvt_f32_i32 v97, v97
  v_cvt_f32_i32 v98, v98
  v_cvt_f32_i32 v99, v99
  v_pk_mul_f32 v[20:21], v[96:97], v[22:23]
  v_pk_add_f32 v[18:19], v[22:23], v[24:25]
  v_pk_fma_f32 v[20:21], v[98:99], v[24:25], v[20:21]
  v_add_f32 v18, v18, v19
  v_add_f32 v20, v20, v21
  s_cmp_gt_i32 s69, 17
  s_cbranch_scc1 L_q15
  s_cmp_gt_i32 s69, 2
  s_cbranch_scc1 L_p15
  s_waitcnt vmcnt(8)
L_p15:
  s_waitcnt vmcnt(12)
L_q15:
  s_waitcnt vmcnt(14)
  buffer_load_dwordx4 v[84:87], v225, s[32:35], s80 offen nt
  v_add_f32_dpp v34, v18, v18 row_ror:8 row_mask:0xf bank_mask:0xc
  v_add_f32_dpp v34, v20, v20 row_ror:8 row_mask:0xf bank_mask:0x3
  v_perm_b32 v157, v162, v160, s56
  v_perm_b32 v162, v162, v160, s57
  v_perm_b32 v160, v163, v161, s56
  v_perm_b32 v163, v163, v161, s57
  v_dot2_f32_bf16 v22, v157, v52, 0
  v_dot2_f32_bf16 v23, v162, v53, 0
  v_dot2_f32_bf16 v24, v160, v54, 0
  v_dot2_f32_bf16 v25, v163, v55, 0
  v_cvt_f32_i32 v100, v100
  v_cvt_f32_i32 v101, v101
  v_cvt_f32_i32 v102, v102
  v_cvt_f32_i32 v103, v103
  v_pk_mul_f32 v[20:21], v[100:101], v[22:23]
  v_pk_add_f32 v[18:19], v[22:23], v[24:25]
  v_pk_fma_f32 v[20:21], v[102:103], v[24:25], v[20:21]
  v_add_f32 v18, v18, v19
  v_add_f32 v20, v20, v21
  s_add_u32 m0, s100, 16384
  v_lshrrev_b32 v10, 1, v228
  v_add_u32 v10, v10, v241
  v_mad_u64_u32 v[30:31], s[64:65], v10, 1, v[28:29]
  global_load_lds_dwordx4 v[30:31], off
  s_cmp_lt_i32 s69, -25
  s_cbranch_scc0 L_t16
  s_waitcnt vmcnt(8)
L_t16:
  s_cmp_gt_i32 s69, 17
  s_cbranch_scc1 L_q17
  s_cmp_gt_i32 s69, 9
  s_cbranch_scc1 L_p17
  s_waitcnt vmcnt(10)
L_p17:
  s_waitcnt vmcnt(14)
L_q17:
  s_waitcnt vmcnt(16)
  buffer_load_dwordx4 v[88:91], v226, s[32:35], s80 offen nt
  v_add_f32_dpp v21, v18, v18 row_ror:8 row_mask:0xf bank_mask:0xc
  v_add_f32_dpp v21, v20, v20 row_ror:8 row_mask:0xf bank_mask:0x3
  v_add_f32_dpp v20, v34, v34 row_half_mirror row_mask:0xf bank_mask:0x5
  s_nop 0
  v_add_f32_dpp v20, v21, v21 row_half_mirror row_mask:0xf bank_mask:0xa
  s_nop 1
  v_add_f32_dpp v20, v20, v20 quad_perm:[2,3,0,1] row_mask:0xf bank_mask:0xf
  s_nop 1
  v_add_f32_dpp v20, v20, v20 quad_perm:[1,0,3,2] row_mask:0xf bank_mask:0xf
  v_cndmask_b32_e64 v32, v32, v20, s[50:51]
L_it7:
  s_waitcnt lgkmcnt(0)
  s_waitcnt vmcnt(10)
  v_add3_u32 v9, v26, v27, s58
  s_nop 0
  v_readfirstlane_b32 s91, v9
  s_add_u32 s44, s78, 0x03030303
  v_msad_u8 v9, s78, v40, 0
  v_msad_u8 v10, s44, v40, 0
  v_msad_u8 v9, s78, v41, v9
  v_msad_u8 v10, s44, v41, v10
  v_msad_u8 v9, s78, v42, v9
  v_msad_u8 v10, s44, v42, v10
  v_sub_u32 v9, v9, v10
  v_mov_b32 v8, s90
  s_add_u32 s78, s78, 0x01010101
  v_readlane_b32 s66, v9, 0
  v_readlane_b32 s67, v9, 1
  s_mov_b64 exec, 1
  global_store_byte v7, v8, s[30:31]
  s_mov_b64 exec, 3
  global_load_dwordx3 v[40:42], v239, s[30:31] sc1
  s_mov_b64 exec, -1
  s_add_u32 s69, s66, s67
  s_add_u32 s44, s69, s95
  s_mov_b32 s95, s69
  s_ashr_i32 s69, s44, 1
  s_add_u32 s69, s69, s91
  s_cmp_lt_u32 s90, 5
  s_cselect_b32 s69, 0, s69
  s_add_u32 s90, s90, 1
  v_dot2_f32_bf16 v22, v149, v56, 0
  v_dot2_f32_bf16 v23, v154, v57, 0
  v_dot2_f32_bf16 v24, v152, v58, 0
  v_dot2_f32_bf16 v25, v155, v59, 0
  v_cvt_f32_i32 v104, v104
  v_cvt_f32_i32 v105, v105
  v_cvt_f32_i32 v106, v106
  v_cvt_f32_i32 v107, v107
  v_pk_mul_f32 v[20:21], v[104:105], v[22:23]
  v_pk_add_f32 v[18:19], v[22:23], v[24:25]
  v_pk_fma_f32 v[20:21], v[106:107], v[24:25], v[20:21]
  v_add_f32 v18, v18, v19
  v_add_f32 v20, v20, v21
  s_cmp_gt_i32 s69, 17
  s_cbranch_scc1 L_q18
  s_cmp_gt_i32 s69, -13
  s_cbranch_scc1 L_p18
  s_waitcnt vmcnt(6)
L_p18:
  s_waitcnt vmcnt(10)
L_q18:
  s_waitcnt vmcnt(11)
  buffer_load_dwordx4 v[92:95], v227, s[32:35], 0 offen nt
  v_add_f32_dpp v21, v18, v18 row_ror:8 row_mask:0xf bank_mask:0xc
  v_add_f32_dpp v21, v20, v20 row_ror:8 row_mask:0xf bank_mask:0x3
  v_add_f32_dpp v20, v35, v35 row_half_mirror row_mask:0xf bank_mask:0x5
  s_nop 0
  v_add_f32_dpp v20, v21, v21 row_half_mirror row_mask:0xf bank_mask:0xa
  s_nop 1
  v_add_f32_dpp v20, v20, v20 quad_perm:[2,3,0,1] row_mask:0xf bank_mask:0xf
  s_nop 1
  v_add_f32_dpp v20, v20, v20 quad_perm:[1,0,3,2] row_mask:0xf bank_mask:0xf
  v_cndmask_b32_e64 v33, v33, v20, s[48:49]
  v_dot2_f32_bf16 v22, v153, v60, 0
  v_dot2_f32_bf16 v23, v158, v61, 0
  v_dot2_f32_bf16 v24, v156, v62, 0
  v_dot2_f32_bf16 v25, v159, v63, 0
  v_cvt_f32_i32 v108, v108
  v_cvt_f32_i32 v109, v109
  v_cvt_f32_i32 v110, v110
  v_cvt_f32_i32 v111, v111
  v_pk_mul_f32 v[20:21], v[108:109], v[22:23]
  v_pk_add_f32 v[18:19], v[22:23], v[24:25]
  v_pk_fma_f32 v[20:21], v[110:111], v[24:25], v[20:21]
  v_add_f32 v18, v18, v19
  v_add_f32 v20, v20, v21
  s_add_u32 m0, s100, 17408
  v_lshrrev_b32 v10, 1, v229
  v_add_u32 v10, v10, v242
  v_mad_u64_u32 v[30:31], s[64:65], v10, 1, v[28:29]
  global_load_lds_dwordx4 v[30:31], off
  s_cmp_gt_i32 s69, 17
  s_cbranch_scc1 L_q19
  s_cmp_gt_i32 s69, 2
  s_cbranch_scc1 L_p19
  s_waitcnt vmcnt(8)
L_p19:
  s_waitcnt vmcnt(12)
L_q19:
  s_waitcnt vmcnt(13)
  buffer_load_dwordx4 v[96:99], v228, s[32:35], 0 offen nt
  v_add_f32_dpp v35, v18, v18 row_ror:8 row_mask:0xf bank_mask:0xc
  v_add_f32_dpp v35, v20, v20 row_ror:8 row_mask:0xf bank_mask:0x3
  s_waitcnt vmcnt(12)
  ds_read_b64 v[164:165], v12 offset:12288
  ds_read_b64 v[166:167], v12 offset:12416
  ds_read_b64 v[168:169], v12 offset:13312
  ds_read_b64 v[170:171], v12 offset:13440
  ds_read_b64 v[172:173], v12 offset:14336
  ds_read_b64 v[174:175], v12 offset:14464
  v_dot2_f32_bf16 v22, v157, v64, 0
  v_dot2_f32_bf16 v23, v162, v65, 0
  v_dot2_f32_bf16 v24, v160, v66, 0
  v_dot2_f32_bf16 v25, v163, v67, 0
  v_cvt_f32_i32 v112, v112
  v_cvt_f32_i32 v113, v113
  v_cvt_f32_i32 v114, v114
  v_cvt_f32_i32 v115, v115
  v_pk_mul_f32 v[20:21], v[112:113], v[22:23]
  v_pk_add_f32 v[18:19], v[22:23], v[24:25]
  v_pk_fma_f32 v[20:21], v[114:115], v[24:25], v[20:21]
  v_add_f32 v18, v18, v19
  v_add_f32 v20, v20, v21
  s_cmp_lt_i32 s69, -25
  s_cbranch_scc0 L_t20
  s_waitcnt vmcnt(8)
L_t20:
  s_cmp_gt_i32 s69, 17
  s_cbranch_scc1 L_q21
  s_cmp_gt_i32 s69, 9
  s_cbranch_scc1 L_p21
  s_waitcnt vmcnt(9)
L_p21:
  s_waitcnt vmcnt(13)
L_q21:
  s_waitcnt vmcnt(14)
  buffer_load_dwordx4 v[100:103], v229, s[32:35], 0 offen nt
  v_add_f32_dpp v21, v18, v18 row_ror:8 row_mask:0xf bank_mask:0xc
  v_add_f32_dpp v21, v20, v20 row_ror:8 row_mask:0xf bank_mask:0x3
  v_add_f32_dpp v20, v35, v35 row_half_mirror row_mask:0xf bank_mask:0x5
  s_nop 0
  v_add_f32_dpp v20, v21, v21 row_half_mirror row_mask:0xf bank_mask:0xa
  s_nop 1
  v_add_f32_dpp v20, v20, v20 quad_perm:[2,3,0,1] row_mask:0xf bank_mask:0xf
  s_nop 1
  v_add_f32_dpp v20, v20, v20 quad_perm:[1,0,3,2] row_mask:0xf bank_mask:0xf
  v_cndmask_b32_e64 v33, v33, v20, s[50:51]
  v_mov_b32 v8, 1
  ds_write_b32 v6, v8 offset:0
L_it8:
  s_waitcnt lgkmcnt(0)
  s_waitcnt vmcnt(10)
  s_add_u32 s44, s78, 0x03030303
  v_msad_u8 v9, s78, v36, 0
  v_msad_u8 v10, s44, v36, 0
  v_msad_u8 v9, s78, v37, v9
  v_msad_u8 v10, s44, v37, v10
  v_msad_u8 v9, s78, v38, v9
  v_msad_u8 v10, s44, v38, v10
  v_sub_u32 v9, v9, v10
  v_mov_b32 v8, s90
  s_add_u32 s78, s78, 0x01010101
  v_readlane_b32 s66, v9, 0
  v_readlane_b32 s67, v9, 1
  s_mov_b64 exec, 1
  global_store_byte v7, v8, s[30:31]
  s_mov_b64 exec, 3
  global_load_dwordx3 v[36:38], v236, s[30:31] sc1
  s_mov_b64 exec, -1
  s_add_u32 s69, s66, s67
  s_add_u32 s44, s69, s95
  s_mov_b32 s95, s69
  s_ashr_i32 s69, s44, 1
  s_add_u32 s69, s69, s91
  s_cmp_lt_u32 s90, 5
  s_cselect_b32 s69, 0, s69
  s_add_u32 s90, s90, 1
  v_perm_b32 v161, v166, v164, s56
  v_perm_b32 v166, v166, v164, s57
  v_perm_b32 v164, v167, v165, s56
  v_perm_b32 v167, v167, v165, s57
  v_dot2_f32_bf16 v22, v161, v44, 0
  v_dot2_f32_bf16 v23, v166, v45, 0
  v_dot2_f32_bf16 v24, v164, v46, 0
  v_dot2_f32_bf16 v25, v167, v47, 0
  v_cvt_f32_i32 v68, v68
  v_cvt_f32_i32 v69, v69
  v_cvt_f32_i32 v70, v70
  v_cvt_f32_i32 v71, v71
  v_pk_mul_f32 v[20:21], v[68:69], v[22:23]
  v_pk_add_f32 v[18:19], v[22:23], v[24:25]
  v_pk_fma_f32 v[20:21], v[70:71], v[24:25], v[20:21]
  v_add_f32 v18, v18, v19
  v_add_f32 v20, v20, v21
  s_add_u32 m0, s100, 18432
  v_lshrrev_b32 v10, 1, v230
  v_add_u32 v10, v10, v240
  v_mad_u64_u32 v[30:31], s[64:65], v10, 1, v[28:29]
  global_load_lds_dwordx4 v[30:31], off
  s_cmp_gt_i32 s69, 17
  s_cbranch_scc1 L_q22
  s_cmp_gt_i32 s69, -13
  s_cbranch_scc1 L_p22
  s_waitcnt vmcnt(7)
L_p22:
  s_waitcnt vmcnt(10)
L_q22:
  s_waitcnt vmcnt(12)
  buffer_load_dwordx4 v[104:107], v227, s[32:35], s80 offen nt
  v_add_f32_dpp v34, v18, v18 row_ror:8 row_mask:0xf bank_mask:0xc
  v_add_f32_dpp v34, v20, v20 row_ror:8 row_mask:0xf bank_mask:0x3
  v_perm_b32 v165, v170, v168, s56
  v_perm_b32 v170, v170, v168, s57
  v_perm_b32 v168, v171, v169, s56
  v_perm_b32 v171, v171, v169, s57
  v_dot2_f32_bf16 v22, v165, v48, 0
  v_dot2_f32_bf16 v23, v170, v49, 0
  v_dot2_f32_bf16 v24, v168, v50, 0
  v_dot2_f32_bf16 v25, v171, v51, 0
  v_cvt_f32_i32 v72, v72
  v_cvt_f32_i32 v73, v73
  v_cvt_f32_i32 v74, v74
  v_cvt_f32_i32 v75, v75
  v_pk_mul_f32 v[20:21], v[72:73], v[22:23]
  v_pk_add_f32 v[18:19], v[22:23], v[24:25]
  v_pk_fma_f32 v[20:21], v[74:75], v[24:25], v[20:21]
  v_add_f32 v18, v18, v19
  v_add_f32 v20, v20, v21
  s_cmp_gt_i32 s69, 17
  s_cbranch_scc1 L_q23
  s_cmp_gt_i32 s69, 2
  s_cbranch_scc1 L_p23
  s_waitcnt vmcnt(8)
L_p23:
  s_waitcnt vmcnt(11)
L_q23:
  s_waitcnt vmcnt(13)
  buffer_load_dwordx4 v[108:111], v228, s[32:35], s80 offen nt
  v_add_f32_dpp v21, v18, v18 row_ror:8 row_mask:0xf bank_mask:0xc
  v_add_f32_dpp v21, v20, v20 row_ror:8 row_mask:0xf bank_mask:0x3
  v_add_f32_dpp v20, v34, v34 row_half_mirror row_mask:0xf bank_mask:0x5
  s_nop 0
  v_add_f32_dpp v20, v21, v21 row_half_mirror row_mask:0xf bank_mask:0xa
  s_nop 1
  v_add_f32_dpp v20, v20, v20 quad_perm:[2,3,0,1] row_mask:0xf bank_mask:0xf
  s_nop 1
  v_add_f32_dpp v20, v20, v20 quad_perm:[1,0,3,2] row_mask:0xf bank_mask:0xf
  v_cndmask_b32_e64 v32, v32, v20, s[52:53]
  v_perm_b32 v169, v174, v172, s56
  v_perm_b32 v174, v174, v172, s57
  v_perm_b32 v172, v175, v173, s56
  v_perm_b32 v175, v175, v173, s57
  v_dot2_f32_bf16 v22, v169, v52, 0
  v_dot2_f32_bf16 v23, v174, v53, 0
  v_dot2_f32_bf16 v24, v172, v54, 0
  v_dot2_f32_bf16 v25, v175, v55, 0
  v_cvt_f32_i32 v76, v76
  v_cvt_f32_i32 v77, v77
  v_cvt_f32_i32 v78, v78
  v_cvt_f32_i32 v79, v79
  v_pk_mul_f32 v[20:21], v[76:77], v[22:23]
  v_pk_add_f32 v[18:19], v[22:23], v[24:25]
  v_pk_fma_f32 v[20:21], v[78:79], v[24:25], v[20:21]
  v_add_f32 v18, v18, v19
  v_add_f32 v20, v20, v21
  s_add_u32 m0, s100, 19456
  v_lshrrev_b32 v10, 1, v231
  v_add_u32 v10, v10, v241
  v_mad_u64_u32 v[30:31], s[64:65], v10, 1, v[28:29]
  global_load_lds_dwordx4 v[30:31], off
  s_cmp_lt_i32 s69, -25
  s_cbranch_scc0 L_t24
  s_waitcnt vmcnt(8)
L_t24:
  s_cmp_gt_i32 s69, 17
  s_cbranch_scc1 L_q25
  s_cmp_gt_i32 s69, 9
  s_cbranch_scc1 L_p25
  s_waitcnt vmcnt(10)
L_p25:
  s_waitcnt vmcnt(13)
L_q25:
  s_waitcnt vmcnt(15)
  buffer_load_dwordx4 v[112:115], v229, s[32:35], s80 offen nt
  v_add_f32_dpp v34, v18, v18 row_ror:8 row_mask:0xf bank_mask:0xc
  v_add_f32_dpp v34, v20, v20 row_ror:8 row_mask:0xf bank_mask:0x3
L_it9:
  s_waitcnt lgkmcnt(0)
  s_waitcnt vmcnt(10)
  s_add_u32 s44, s78, 0x03030303
  v_msad_u8 v9, s78, v40, 0
  v_msad_u8 v10, s44, v40, 0
  v_msad_u8 v9, s78, v41, v9
  v_msad_u8 v10, s44, v41, v10
  v_msad_u8 v9, s78, v42, v9
  v_msad_u8 v10, s44, v42, v10
  v_sub_u32 v9, v9, v10
  v_mov_b32 v8, s90
  s_add_u32 s78, s78, 0x01010101
  v_readlane_b32 s66, v9, 0
  v_readlane_b32 s67, v9, 1
  s_mov_b64 exec, 1
  global_store_byte v7, v8, s[30:31]
  s_mov_b64 exec, 3
  global_load_dwordx3 v[40:42], v237, s[30:31] sc1
  s_mov_b64 exec, -1
  s_add_u32 s69, s66, s67
  s_add_u32 s44, s69, s95
  s_mov_b32 s95, s69
  s_ashr_i32 s69, s44, 1
  s_add_u32 s69, s69, s91
  s_cmp_lt_u32 s90, 5
  s_cselect_b32 s69, 0, s69
  s_add_u32 s90, s90, 1
  v_dot2_f32_bf16 v22, v161, v56, 0
  v_dot2_f32_bf16 v23, v166, v57, 0
  v_dot2_f32_bf16 v24, v164, v58, 0
  v_dot2_f32_bf16 v25, v167, v59, 0
  v_cvt_f32_i32 v80, v80
  v_cvt_f32_i32 v81, v81
  v_cvt_f32_i32 v82, v82
  v_cvt_f32_i32 v83, v83
  v_pk_mul_f32 v[20:21], v[80:81], v[22:23]
  v_pk_add_f32 v[18:19], v[22:23], v[24:25]
  v_pk_fma_f32 v[20:21], v[82:83], v[24:25], v[20:21]
  v_add_f32 v18, v18, v19
  v_add_f32 v20, v20, v21
  s_cmp_gt_i32 s69, 17
  s_cbranch_scc1 L_q26
  s_cmp_gt_i32 s69, -13
  s_cbranch_scc1 L_p26
  s_waitcnt vmcnt(6)
L_p26:
  s_waitcnt vmcnt(10)
L_q26:
  s_waitcnt vmcnt(11)
  buffer_load_dwordx4 v[68:71], v230, s[32:35], 0 offen nt
  v_add_f32_dpp v35, v18, v18 row_ror:8 row_mask:0xf bank_mask:0xc
  v_add_f32_dpp v35, v20, v20 row_ror:8 row_mask:0xf bank_mask:0x3
  v_dot2_f32_bf16 v22, v165, v60, 0
  v_dot2_f32_bf16 v23, v170, v61, 0
  v_dot2_f32_bf16 v24, v168, v62, 0
  v_dot2_f32_bf16 v25, v171, v63, 0
  v_cvt_f32_i32 v84, v84
  v_cvt_f32_i32 v85, v85
  v_cvt_f32_i32 v86, v86
  v_cvt_f32_i32 v87, v87
  v_pk_mul_f32 v[20:21], v[84:85], v[22:23]
  v_pk_add_f32 v[18:19], v[22:23], v[24:25]
  v_pk_fma_f32 v[20:21], v[86:87], v[24:25], v[20:21]
  v_add_f32 v18, v18, v19
  v_add_f32 v20, v20, v21
  s_add_u32 m0, s100, 20480
  v_lshrrev_b32 v10, 1, v232
  v_add_u32 v10, v10, v242
  v_mad_u64_u32 v[30:31], s[64:65], v10, 1, v[28:29]
  global_load_lds_dwordx4 v[30:31], off
  s_cmp_gt_i32 s69, 17
  s_cbranch_scc1 L_q27
  s_cmp_gt_i32 s69, 2
  s_cbranch_scc1 L_p27
  s_waitcnt vmcnt(8)
L_p27:
  s_waitcnt vmcnt(12)
L_q27:
  s_waitcnt vmcnt(13)
  buffer_load_dwordx4 v[72:75], v231, s[32:35], 0 offen nt
  v_add_f32_dpp v21, v18, v18 row_ror:8 row_mask:0xf bank_mask:0xc
  v_add_f32_dpp v21, v20, v20 row_ror:8 row_mask:0xf bank_mask:0x3
  v_add_f32_dpp v20, v35, v35 row_half_mirror row_mask:0xf bank_mask:0x5
  s_nop 0
  v_add_f32_dpp v20, v21, v21 row_half_mirror row_mask:0xf bank_mask:0xa
  s_nop 1
  v_add_f32_dpp v20, v20, v20 quad_perm:[2,3,0,1] row_mask:0xf bank_mask:0xf
  s_nop 1
  v_add_f32_dpp v20, v20, v20 quad_perm:[1,0,3,2] row_mask:0xf bank_mask:0xf
  v_cndmask_b32_e64 v33, v33, v20, s[52:53]
  s_waitcnt vmcnt(12)
  ds_read_b64 v[176:177], v12 offset:15360
  ds_read_b64 v[178:179], v12 offset:15488
  ds_read_b64 v[180:181], v12 offset:16384
  ds_read_b64 v[182:183], v12 offset:16512
  ds_read_b64 v[184:185], v12 offset:17408
  ds_read_b64 v[186:187], v12 offset:17536
  v_dot2_f32_bf16 v22, v169, v64, 0
  v_dot2_f32_bf16 v23, v174, v65, 0
  v_dot2_f32_bf16 v24, v172, v66, 0
  v_dot2_f32_bf16 v25, v175, v67, 0
  v_cvt_f32_i32 v88, v88
  v_cvt_f32_i32 v89, v89
  v_cvt_f32_i32 v90, v90
  v_cvt_f32_i32 v91, v91
  v_pk_mul_f32 v[20:21], v[88:89], v[22:23]
  v_pk_add_f32 v[18:19], v[22:23], v[24:25]
  v_pk_fma_f32 v[20:21], v[90:91], v[24:25], v[20:21]
  v_add_f32 v18, v18, v19
  v_add_f32 v20, v20, v21
  s_cmp_lt_i32 s69, -25
  s_cbranch_scc0 L_t28
  s_waitcnt vmcnt(8)
L_t28:
  s_cmp_gt_i32 s69, 17
  s_cbranch_scc1 L_q29
  s_cmp_gt_i32 s69, 9
  s_cbranch_scc1 L_p29
  s_waitcnt vmcnt(9)
L_p29:
  s_waitcnt vmcnt(13)
L_q29:
  s_waitcnt vmcnt(14)
  buffer_load_dwordx4 v[76:79], v232, s[32:35], 0 offen nt
  v_add_f32_dpp v35, v18, v18 row_ror:8 row_mask:0xf bank_mask:0xc
  v_add_f32_dpp v35, v20, v20 row_ror:8 row_mask:0xf bank_mask:0x3
L_it10:
  s_waitcnt lgkmcnt(0)
  s_waitcnt vmcnt(10)
  s_add_u32 s44, s78, 0x03030303
  v_msad_u8 v9, s78, v36, 0
  v_msad_u8 v10, s44, v36, 0
  v_msad_u8 v9, s78, v37, v9
  v_msad_u8 v10, s44, v37, v10
  v_msad_u8 v9, s78, v38, v9
  v_msad_u8 v10, s44, v38, v10
  v_sub_u32 v9, v9, v10
  v_mov_b32 v8, s90
  s_add_u32 s78, s78, 0x01010101
  v_readlane_b32 s66, v9, 0
  v_readlane_b32 s67, v9, 1
  s_mov_b64 exec, 1
  global_store_byte v7, v8, s[30:31]
  s_mov_b64 exec, 3
  global_load_dwordx3 v[36:38], v238, s[30:31] sc1
  s_mov_b64 exec, -1
  s_add_u32 s69, s66, s67
  s_add_u32 s44, s69, s95
  s_mov_b32 s95, s69
  s_ashr_i32 s69, s44, 1
  s_add_u32 s69, s69, s91
  s_cmp_lt_u32 s90, 5
  s_cselect_b32 s69, 0, s69
  s_add_u32 s90, s90, 1
  v_perm_b32 v173, v178, v176, s56
  v_perm_b32 v178, v178, v176, s57
  v_perm_b32 v176, v179, v177, s56
  v_perm_b32 v179, v179, v177, s57
  v_dot2_f32_bf16 v22, v173, v44, 0
  v_dot2_f32_bf16 v23, v178, v45, 0
  v_dot2_f32_bf16 v24, v176, v46, 0
  v_dot2_f32_bf16 v25, v179, v47, 0
  v_cvt_f32_i32 v92, v92
  v_cvt_f32_i32 v93, v93
  v_cvt_f32_i32 v94, v94
  v_cvt_f32_i32 v95, v95
  v_pk_mul_f32 v[20:21], v[92:93], v[22:23]
  v_pk_add_f32 v[18:19], v[22:23], v[24:25]
  v_pk_fma_f32 v[20:21], v[94:95], v[24:25], v[20:21]
  v_add_f32 v18, v18, v19
  v_add_f32 v20, v20, v21
  s_add_u32 m0, s100, 21504
  v_lshrrev_b32 v10, 1, v233
  v_add_u32 v10, v10, v240
  v_mad_u64_u32 v[30:31], s[64:65], v10, 1, v[28:29]
  global_load_lds_dwordx4 v[30:31], off
  s_cmp_gt_i32 s69, 17
  s_cbranch_scc1 L_q30
  s_cmp_gt_i32 s69, -13
  s_cbranch_scc1 L_p30
  s_waitcnt vmcnt(7)
L_p30:
  s_waitcnt vmcnt(10)
L_q30:
  s_waitcnt vmcnt(12)
  buffer_load_dwordx4 v[80:83], v230, s[32:35], s80 offen nt
  v_add_f32_dpp v21, v18, v18 row_ror:8 row_mask:0xf bank_mask:0xc
  v_add_f32_dpp v21, v20, v20 row_ror:8 row_mask:0xf bank_mask:0x3
  v_add_f32_dpp v20, v34, v34 row_half_mirror row_mask:0xf bank_mask:0x5
  s_nop 0
  v_add_f32_dpp v20, v21, v21 row_half_mirror row_mask:0xf bank_mask:0xa
  s_nop 1
  v_add_f32_dpp v20, v20, v20 quad_perm:[2,3,0,1] row_mask:0xf bank_mask:0xf
  s_nop 1
  v_add_f32_dpp v20, v20, v20 quad_perm:[1,0,3,2] row_mask:0xf bank_mask:0xf
  v_cndmask_b32_e64 v32, v32, v20, s[54:55]
  ds_write_b32 v1, v32 offset:512
  v_perm_b32 v177, v182, v180, s56
  v_perm_b32 v182, v182, v180, s57
  v_perm_b32 v180, v183, v181, s56
  v_perm_b32 v183, v183, v181, s57
  v_dot2_f32_bf16 v22, v177, v48, 0
  v_dot2_f32_bf16 v23, v182, v49, 0
  v_dot2_f32_bf16 v24, v180, v50, 0
  v_dot2_f32_bf16 v25, v183, v51, 0
  v_cvt_f32_i32 v96, v96
  v_cvt_f32_i32 v97, v97
  v_cvt_f32_i32 v98, v98
  v_cvt_f32_i32 v99, v99
  v_pk_mul_f32 v[20:21], v[96:97], v[22:23]
  v_pk_add_f32 v[18:19], v[22:23], v[24:25]
  v_pk_fma_f32 v[20:21], v[98:99], v[24:25], v[20:21]
  v_add_f32 v18, v18, v19
  v_add_f32 v20, v20, v21
  s_cmp_gt_i32 s69, 17
  s_cbranch_scc1 L_q31
  s_cmp_gt_i32 s69, 2
  s_cbranch_scc1 L_p31
  s_waitcnt vmcnt(8)
L_p31:
  s_waitcnt vmcnt(11)
L_q31:
  s_waitcnt vmcnt(13)
  buffer_load_dwordx4 v[84:87], v231, s[32:35], s80 offen nt
  v_add_f32_dpp v34, v18, v18 row_ror:8 row_mask:0xf bank_mask:0xc
  v_add_f32_dpp v34, v20, v20 row_ror:8 row_mask:0xf bank_mask:0x3
  v_perm_b32 v181, v186, v184, s56
  v_perm_b32 v186, v186, v184, s57
  v_perm_b32 v184, v187, v185, s56
  v_perm_b32 v187, v187, v185, s57
  v_dot2_f32_bf16 v22, v181, v52, 0
  v_dot2_f32_bf16 v23, v186, v53, 0
  v_dot2_f32_bf16 v24, v184, v54, 0
  v_dot2_f32_bf16 v25, v187, v55, 0
  v_cvt_f32_i32 v100, v100
  v_cvt_f32_i32 v101, v101
  v_cvt_f32_i32 v102, v102
  v_cvt_f32_i32 v103, v103
  v_pk_mul_f32 v[20:21], v[100:101], v[22:23]
  v_pk_add_f32 v[18:19], v[22:23], v[24:25]
  v_pk_fma_f32 v[20:21], v[102:103], v[24:25], v[20:21]
  v_add_f32 v18, v18, v19
  v_add_f32 v20, v20, v21
  s_add_u32 m0, s100, 22528
  v_lshrrev_b32 v10, 1, v234
  v_add_u32 v10, v10, v241
  v_mad_u64_u32 v[30:31], s[64:65], v10, 1, v[28:29]
  global_load_lds_dwordx4 v[30:31], off
  s_cmp_lt_i32 s69, -25
  s_cbranch_scc0 L_t32
  s_waitcnt vmcnt(8)
L_t32:
  s_cmp_gt_i32 s69, 17
  s_cbranch_scc1 L_q33
  s_cmp_gt_i32 s69, 9
  s_cbranch_scc1 L_p33
  s_waitcnt vmcnt(10)
L_p33:
  s_waitcnt vmcnt(13)
L_q33:
  s_waitcnt vmcnt(15)
  buffer_load_dwordx4 v[88:91], v232, s[32:35], s80 offen nt
  v_add_f32_dpp v21, v18, v18 row_ror:8 row_mask:0xf bank_mask:0xc
  v_add_f32_dpp v21, v20, v20 row_ror:8 row_mask:0xf bank_mask:0x3
  v_add_f32_dpp v20, v34, v34 row_half_mirror row_mask:0xf bank_mask:0x5
  s_nop 0
  v_add_f32_dpp v20, v21, v21 row_half_mirror row_mask:0xf bank_mask:0xa
  s_nop 1
  v_add_f32_dpp v20, v20, v20 quad_perm:[2,3,0,1] row_mask:0xf bank_mask:0xf
  s_nop 1
  v_add_f32_dpp v20, v20, v20 quad_perm:[1,0,3,2] row_mask:0xf bank_mask:0xf
  v_cndmask_b32_e64 v32, v32, v20, s[48:49]
L_it11:
  s_waitcnt lgkmcnt(0)
  s_waitcnt vmcnt(10)
  s_add_u32 s44, s78, 0x03030303
  v_msad_u8 v9, s78, v40, 0
  v_msad_u8 v10, s44, v40, 0
  v_msad_u8 v9, s78, v41, v9
  v_msad_u8 v10, s44, v41, v10
  v_msad_u8 v9, s78, v42, v9
  v_msad_u8 v10, s44, v42, v10
  v_sub_u32 v9, v9, v10
  v_mov_b32 v8, s90
  s_add_u32 s78, s78, 0x01010101
  v_readlane_b32 s66, v9, 0
  v_readlane_b32 s67, v9, 1
  s_mov_b64 exec, 1
  global_store_byte v7, v8, s[30:31]
  s_mov_b64 exec, 3
  global_load_dwordx3 v[40:42], v239, s[30:31] sc1
  s_mov_b64 exec, -1
  s_add_u32 s69, s66, s67
  s_add_u32 s44, s69, s95
  s_mov_b32 s95, s69
  s_ashr_i32 s69, s44, 1
  s_add_u32 s69, s69, s91
  s_cmp_lt_u32 s90, 5
  s_cselect_b32 s69, 0, s69
  s_add_u32 s90, s90, 1
  v_dot2_f32_bf16 v22, v173, v56, 0
  v_dot2_f32_bf16 v23, v178, v57, 0
  v_dot2_f32_bf16 v24, v176, v58, 0
  v_dot2_f32_bf16 v25, v179, v59, 0
  v_cvt_f32_i32 v104, v104
  v_cvt_f32_i32 v105, v105
  v_cvt_f32_i32 v106, v106
  v_cvt_f32_i32 v107, v107
  v_pk_mul_f32 v[20:21], v[104:105], v[22:23]
  v_pk_add_f32 v[18:19], v[22:23], v[24:25]
  v_pk_fma_f32 v[20:21], v[106:107], v[24:25], v[20:21]
  v_add_f32 v18, v18, v19
  v_add_f32 v20, v20, v21
  s_cmp_gt_i32 s69, 17
  s_cbranch_scc1 L_q34
  s_cmp_gt_i32 s69, -13
  s_cbranch_scc1 L_p34
  s_waitcnt vmcnt(6)
L_p34:
  s_waitcnt vmcnt(10)
L_q34:
  s_waitcnt vmcnt(11)
  buffer_load_dwordx4 v[92:95], v233, s[32:35], 0 offen nt
  v_add_f32_dpp v21, v18, v18 row_ror:8 row_mask:0xf bank_mask:0xc
  v_add_f32_dpp v21, v20, v20 row_ror:8 row_mask:0xf bank_mask:0x3
  v_add_f32_dpp v20, v35, v35 row_half_mirror row_mask:0xf bank_mask:0x5
  s_nop 0
  v_add_f32_dpp v20, v21, v21 row_half_mirror row_mask:0xf bank_mask:0xa
  s_nop 1
  v_add_f32_dpp v20, v20, v20 quad_perm:[2,3,0,1] row_mask:0xf bank_mask:0xf
  s_nop 1
  v_add_f32_dpp v20, v20, v20 quad_perm:[1,0,3,2] row_mask:0xf bank_mask:0xf
  v_cndmask_b32_e64 v33, v33, v20, s[54:55]
  ds_write_b32 v1, v33 offset:3584
  v_dot2_f32_bf16 v22, v177, v60, 0
  v_dot2_f32_bf16 v23, v182, v61, 0
  v_dot2_f32_bf16 v24, v180, v62, 0
  v_dot2_f32_bf16 v25, v183, v63, 0
  v_cvt_f32_i32 v108, v108
  v_cvt_f32_i32 v109, v109
  v_cvt_f32_i32 v110, v110
  v_cvt_f32_i32 v111, v111
  v_pk_mul_f32 v[20:21], v[108:109], v[22:23]
  v_pk_add_f32 v[18:19], v[22:23], v[24:25]
  v_pk_fma_f32 v[20:21], v[110:111], v[24:25], v[20:21]
  v_add_f32 v18, v18, v19
  v_add_f32 v20, v20, v21
  s_add_u32 m0, s100, 23552
  v_lshrrev_b32 v10, 1, v235
  v_add_u32 v10, v10, v242
  v_mad_u64_u32 v[30:31], s[64:65], v10, 1, v[28:29]
  global_load_lds_dwordx4 v[30:31], off
  s_cmp_gt_i32 s69, 17
  s_cbranch_scc1 L_q35
  s_cmp_gt_i32 s69, 2
  s_cbranch_scc1 L_p35
  s_waitcnt vmcnt(8)
L_p35:
  s_waitcnt vmcnt(12)
L_q35:
  s_waitcnt vmcnt(13)
  buffer_load_dwordx4 v[96:99], v234, s[32:35], 0 offen nt
  v_add_f32_dpp v35, v18, v18 row_ror:8 row_mask:0xf bank_mask:0xc
  v_add_f32_dpp v35, v20, v20 row_ror:8 row_mask:0xf bank_mask:0x3
  s_waitcnt vmcnt(12)
  ds_read_b64 v[188:189], v12 offset:18432
  ds_read_b64 v[190:191], v12 offset:18560
  ds_read_b64 v[192:193], v12 offset:19456
  ds_read_b64 v[194:195], v12 offset:19584
  ds_read_b64 v[196:197], v12 offset:20480
  ds_read_b64 v[198:199], v12 offset:20608
  v_dot2_f32_bf16 v22, v181, v64, 0
  v_dot2_f32_bf16 v23, v186, v65, 0
  v_dot2_f32_bf16 v24, v184, v66, 0
  v_dot2_f32_bf16 v25, v187, v67, 0
  v_cvt_f32_i32 v112, v112
  v_cvt_f32_i32 v113, v113
  v_cvt_f32_i32 v114, v114
  v_cvt_f32_i32 v115, v115
  v_pk_mul_f32 v[20:21], v[112:113], v[22:23]
  v_pk_add_f32 v[18:19], v[22:23], v[24:25]
  v_pk_fma_f32 v[20:21], v[114:115], v[24:25], v[20:21]
  v_add_f32 v18, v18, v19
  v_add_f32 v20, v20, v21
  s_cmp_lt_i32 s69, -25
  s_cbranch_scc0 L_t36
  s_waitcnt vmcnt(8)
L_t36:
  s_cmp_gt_i32 s69, 17
  s_cbranch_scc1 L_q37
  s_cmp_gt_i32 s69, 9
  s_cbranch_scc1 L_p37
  s_waitcnt vmcnt(9)
L_p37:
  s_waitcnt vmcnt(13)
L_q37:
  s_waitcnt vmcnt(14)
  buffer_load_dwordx4 v[100:103], v235, s[32:35], 0 offen nt
  v_add_f32_dpp v21, v18, v18 row_ror:8 row_mask:0xf bank_mask:0xc
  v_add_f32_dpp v21, v20, v20 row_ror:8 row_mask:0xf bank_mask:0x3
  v_add_f32_dpp v20, v35, v35 row_half_mirror row_mask:0xf bank_mask:0x5
  s_nop 0
  v_add_f32_dpp v20, v21, v21 row_half_mirror row_mask:0xf bank_mask:0xa
  s_nop 1
  v_add_f32_dpp v20, v20, v20 quad_perm:[2,3,0,1] row_mask:0xf bank_mask:0xf
  s_nop 1
  v_add_f32_dpp v20, v20, v20 quad_perm:[1,0,3,2] row_mask:0xf bank_mask:0xf
  v_cndmask_b32_e64 v33, v33, v20, s[48:49]
L_it12:
  s_waitcnt lgkmcnt(0)
  s_waitcnt vmcnt(10)
  s_add_u32 s44, s78, 0x03030303
  v_msad_u8 v9, s78, v36, 0
  v_msad_u8 v10, s44, v36, 0
  v_msad_u8 v9, s78, v37, v9
  v_msad_u8 v10, s44, v37, v10
  v_msad_u8 v9, s78, v38, v9
  v_msad_u8 v10, s44, v38, v10
  v_sub_u32 v9, v9, v10
  v_mov_b32 v8, s90
  s_add_u32 s78, s78, 0x01010101
  v_readlane_b32 s66, v9, 0
  v_readlane_b32 s67, v9, 1
  s_mov_b64 exec, 1
  global_store_byte v7, v8, s[30:31]
  s_mov_b64 exec, 3
  global_load_dwordx3 v[36:38], v236, s[30:31] sc1
  s_mov_b64 exec, -1
  s_add_u32 s69, s66, s67
  s_add_u32 s44, s69, s95
  s_mov_b32 s95, s69
  s_ashr_i32 s69, s44, 1
  s_add_u32 s69, s69, s91
  s_cmp_lt_u32 s90, 5
  s_cselect_b32 s69, 0, s69
  s_add_u32 s90, s90, 1
  v_perm_b32 v185, v190, v188, s56
  v_perm_b32 v190, v190, v188, s57
  v_perm_b32 v188, v191, v189, s56
  v_perm_b32 v191, v191, v189, s57
  v_dot2_f32_bf16 v22, v185, v44, 0
  v_dot2_f32_bf16 v23, v190, v45, 0
  v_dot2_f32_bf16 v24, v188, v46, 0
  v_dot2_f32_bf16 v25, v191, v47, 0
  v_cvt_f32_i32 v68, v68
  v_cvt_f32_i32 v69, v69
  v_cvt_f32_i32 v70, v70
  v_cvt_f32_i32 v71, v71
  v_pk_mul_f32 v[20:21], v[68:69], v[22:23]
  v_pk_add_f32 v[18:19], v[22:23], v[24:25]
  v_pk_fma_f32 v[20:21], v[70:71], v[24:25], v[20:21]
  v_add_f32 v18, v18, v19
  v_add_f32 v20, v20, v21
  s_cmp_gt_i32 s69, 17
  s_cbranch_scc1 L_q38
  s_cmp_gt_i32 s69, -13
  s_cbranch_scc1 L_p38
  s_waitcnt vmcnt(6)
L_p38:
  s_waitcnt vmcnt(9)
L_q38:
  s_waitcnt vmcnt(11)
  buffer_load_dwordx4 v[104:107], v233, s[32:35], s80 offen nt
  v_add_f32_dpp v34, v18, v18 row_ror:8 row_mask:0xf bank_mask:0xc
  v_add_f32_dpp v34, v20, v20 row_ror:8 row_mask:0xf bank_mask:0x3
  v_perm_b32 v189, v194, v192, s56
  v_perm_b32 v194, v194, v192, s57
  v_perm_b32 v192, v195, v193, s56
  v_perm_b32 v195, v195, v193, s57
  v_dot2_f32_bf16 v22, v189, v48, 0
  v_dot2_f32_bf16 v23, v194, v49, 0
  v_dot2_f32_bf16 v24, v192, v50, 0
  v_dot2_f32_bf16 v25, v195, v51, 0
  v_cvt_f32_i32 v72, v72
  v_cvt_f32_i32 v73, v73
  v_cvt_f32_i32 v74, v74
  v_cvt_f32_i32 v75, v75
  v_pk_mul_f32 v[20:21], v[72:73], v[22:23]
  v_pk_add_f32 v[18:19], v[22:23], v[24:25]
  v_pk_fma_f32 v[20:21], v[74:75], v[24:25], v[20:21]
  v_add_f32 v18, v18, v19
  v_add_f32 v20, v20, v21
  s_cmp_gt_i32 s69, 17
  s_cbranch_scc1 L_q39
  s_cmp_gt_i32 s69, 2
  s_cbranch_scc1 L_p39
  s_waitcnt vmcnt(7)
L_p39:
  s_waitcnt vmcnt(10)
L_q39:
  s_waitcnt vmcnt(12)
  buffer_load_dwordx4 v[108:111], v234, s[32:35], s80 offen nt
  v_add_f32_dpp v21, v18, v18 row_ror:8 row_mask:0xf bank_mask:0xc
  v_add_f32_dpp v21, v20, v20 row_ror:8 row_mask:0xf bank_mask:0x3
  v_add_f32_dpp v20, v34, v34 row_half_mirror row_mask:0xf bank_mask:0x5
  s_nop 0
  v_add_f32_dpp v20, v21, v21 row_half_mirror row_mask:0xf bank_mask:0xa
  s_nop 1
  v_add_f32_dpp v20, v20, v20 quad_perm:[2,3,0,1] row_mask:0xf bank_mask:0xf
  s_nop 1
  v_add_f32_dpp v20, v20, v20 quad_perm:[1,0,3,2] row_mask:0xf bank_mask:0xf
  v_cndmask_b32_e64 v32, v32, v20, s[50:51]
  v_perm_b32 v193, v198, v196, s56
  v_perm_b32 v198, v198, v196, s57
  v_perm_b32 v196, v199, v197, s56
  v_perm_b32 v199, v199, v197, s57
  v_dot2_f32_bf16 v22, v193, v52, 0
  v_dot2_f32_bf16 v23, v198, v53, 0
  v_dot2_f32_bf16 v24, v196, v54, 0
  v_dot2_f32_bf16 v25, v199, v55, 0
  v_cvt_f32_i32 v76, v76
  v_cvt_f32_i32 v77, v77
  v_cvt_f32_i32 v78, v78
  v_cvt_f32_i32 v79, v79
  v_pk_mul_f32 v[20:21], v[76:77], v[22:23]
  v_pk_add_f32 v[18:19], v[22:23], v[24:25]
  v_pk_fma_f32 v[20:21], v[78:79], v[24:25], v[20:21]
  v_add_f32 v18, v18, v19
  v_add_f32 v20, v20, v21
  s_cmp_lt_i32 s69, -25
  s_cbranch_scc0 L_t40
  s_waitcnt vmcnt(6)
L_t40:
  s_cmp_gt_i32 s69, 17
  s_cbranch_scc1 L_q41
  s_cmp_gt_i32 s69, 9
  s_cbranch_scc1 L_p41
  s_waitcnt vmcnt(8)
L_p41:
  s_waitcnt vmcnt(11)
L_q41:
  s_waitcnt vmcnt(13)
  buffer_load_dwordx4 v[112:115], v235, s[32:35], s80 offen nt
  v_add_f32_dpp v34, v18, v18 row_ror:8 row_mask:0xf bank_mask:0xc
  v_add_f32_dpp v34, v20, v20 row_ror:8 row_mask:0xf bank_mask:0x3
L_it13:
  s_waitcnt lgkmcnt(0)
  s_mov_b64 exec, 1
  global_load_dwordx2 v[26:27], v11, s[30:31] sc1
  s_mov_b64 exec, -1
  s_waitcnt vmcnt(9)
  s_add_u32 s44, s78, 0x03030303
  v_msad_u8 v9, s78, v40, 0
  v_msad_u8 v10, s44, v40, 0
  v_msad_u8 v9, s78, v41, v9
  v_msad_u8 v10, s44, v41, v10
  v_msad_u8 v9, s78, v42, v9
  v_msad_u8 v10, s44, v42, v10
  v_sub_u32 v9, v9, v10
  v_mov_b32 v8, s90
  s_add_u32 s78, s78, 0x01010101
  v_readlane_b32 s66, v9, 0
  v_readlane_b32 s67, v9, 1
  s_mov_b64 exec, 1
  global_store_byte v7, v8, s[30:31]
  s_mov_b64 exec, 3
  global_load_dwordx3 v[40:42], v237, s[30:31] sc1
  s_mov_b64 exec, -1
  s_add_u32 s69, s66, s67
  s_add_u32 s44, s69, s95
  s_mov_b32 s95, s69
  s_ashr_i32 s69, s44, 1
  s_add_u32 s69, s69, s91
  s_cmp_lt_u32 s90, 5
  s_cselect_b32 s69, 0, s69
  s_add_u32 s90, s90, 1
  v_dot2_f32_bf16 v22, v185, v56, 0
  v_dot2_f32_bf16 v23, v190, v57, 0
  v_dot2_f32_bf16 v24, v188, v58, 0
  v_dot2_f32_bf16 v25, v191, v59, 0
  v_cvt_f32_i32 v80, v80
  v_cvt_f32_i32 v81, v81
  v_cvt_f32_i32 v82, v82
  v_cvt_f32_i32 v83, v83
  v_pk_mul_f32 v[20:21], v[80:81], v[22:23]
  v_pk_add_f32 v[18:19], v[22:23], v[24:25]
  v_pk_fma_f32 v[20:21], v[82:83], v[24:25], v[20:21]
  v_add_f32 v18, v18, v19
  v_add_f32 v20, v20, v21
  s_cmp_gt_i32 s69, 17
  s_cbranch_scc1 L_q42
  s_cmp_gt_i32 s69, -13
  s_cbranch_scc1 L_p42
  s_waitcnt vmcnt(6)
L_p42:
  s_waitcnt vmcnt(9)
L_q42:
  s_waitcnt vmcnt(10)
  buffer_load_dwordx4 v[68:71], v212, s[32:35], s3 offen nt
  v_add_f32_dpp v35, v18, v18 row_ror:8 row_mask:0xf bank_mask:0xc
  v_add_f32_dpp v35, v20, v20 row_ror:8 row_mask:0xf bank_mask:0x3
  v_dot2_f32_bf16 v22, v189, v60, 0
  v_dot2_f32_bf16 v23, v194, v61, 0
  v_dot2_f32_bf16 v24, v192, v62, 0
  v_dot2_f32_bf16 v25, v195, v63, 0
  v_cvt_f32_i32 v84, v84
  v_cvt_f32_i32 v85, v85
  v_cvt_f32_i32 v86, v86
  v_cvt_f32_i32 v87, v87
  v_pk_mul_f32 v[20:21], v[84:85], v[22:23]
  v_pk_add_f32 v[18:19], v[22:23], v[24:25]
  v_pk_fma_f32 v[20:21], v[86:87], v[24:25], v[20:21]
  v_add_f32 v18, v18, v19
  v_add_f32 v20, v20, v21
  s_cmp_gt_i32 s69, 17
  s_cbranch_scc1 L_q43
  s_cmp_gt_i32 s69, 2
  s_cbranch_scc1 L_p43
  s_waitcnt vmcnt(7)
L_p43:
  s_waitcnt vmcnt(10)
L_q43:
  s_waitcnt vmcnt(11)
  buffer_load_dwordx4 v[72:75], v213, s[32:35], s3 offen nt
  v_add_f32_dpp v21, v18, v18 row_ror:8 row_mask:0xf bank_mask:0xc
  v_add_f32_dpp v21, v20, v20 row_ror:8 row_mask:0xf bank_mask:0x3
  v_add_f32_dpp v20, v35, v35 row_half_mirror row_mask:0xf bank_mask:0x5
  s_nop 0
  v_add_f32_dpp v20, v21, v21 row_half_mirror row_mask:0xf bank_mask:0xa
  s_nop 1
  v_add_f32_dpp v20, v20, v20 quad_perm:[2,3,0,1] row_mask:0xf bank_mask:0xf
  s_nop 1
  v_add_f32_dpp v20, v20, v20 quad_perm:[1,0,3,2] row_mask:0xf bank_mask:0xf
  v_cndmask_b32_e64 v33, v33, v20, s[50:51]
  s_waitcnt vmcnt(10)
  ds_read_b64 v[200:201], v12 offset:21504
  ds_read_b64 v[202:203], v12 offset:21632
  ds_read_b64 v[204:205], v12 offset:22528
  ds_read_b64 v[206:207], v12 offset:22656
  ds_read_b64 v[208:209], v12 offset:23552
  ds_read_b64 v[210:211], v12 offset:23680
  v_dot2_f32_bf16 v22, v193, v64, 0
  v_dot2_f32_bf16 v23, v198, v65, 0
  v_dot2_f32_bf16 v24, v196, v66, 0
  v_dot2_f32_bf16 v25, v199, v67, 0
  v_cvt_f32_i32 v88, v88
  v_cvt_f32_i32 v89, v89
  v_cvt_f32_i32 v90, v90
  v_cvt_f32_i32 v91, v91
  v_pk_mul_f32 v[20:21], v[88:89], v[22:23]
  v_pk_add_f32 v[18:19], v[22:23], v[24:25]
  v_pk_fma_f32 v[20:21], v[90:91], v[24:25], v[20:21]
  v_add_f32 v18, v18, v19
  v_add_f32 v20, v20, v21
  s_cmp_lt_i32 s69, -25
  s_cbranch_scc0 L_t44
  s_waitcnt vmcnt(7)
L_t44:
  s_cmp_gt_i32 s69, 17
  s_cbranch_scc1 L_q45
  s_cmp_gt_i32 s69, 9
  s_cbranch_scc1 L_p45
  s_waitcnt vmcnt(8)
L_p45:
  s_waitcnt vmcnt(11)
L_q45:
  s_waitcnt vmcnt(12)
  buffer_load_dwordx4 v[76:79], v214, s[32:35], s3 offen nt
  v_add_f32_dpp v35, v18, v18 row_ror:8 row_mask:0xf bank_mask:0xc
  v_add_f32_dpp v35, v20, v20 row_ror:8 row_mask:0xf bank_mask:0x3
L_it14:
  s_waitcnt lgkmcnt(0)
  ds_read_b32 v4, v14 offset:16
  s_waitcnt vmcnt(8)
  s_add_u32 s44, s78, 0x03030303
  v_msad_u8 v9, s78, v36, 0
  v_msad_u8 v10, s44, v36, 0
  v_msad_u8 v9, s78, v37, v9
  v_msad_u8 v10, s44, v37, v10
  v_msad_u8 v9, s78, v38, v9
  v_msad_u8 v10, s44, v38, v10
  v_sub_u32 v9, v9, v10
  v_mov_b32 v8, s90
  s_add_u32 s78, s78, 0x01010101
  v_readlane_b32 s66, v9, 0
  v_readlane_b32 s67, v9, 1
  s_mov_b64 exec, 1
  global_store_byte v7, v8, s[30:31]
  s_mov_b64 exec, 3
  global_load_dwordx3 v[36:38], v238, s[30:31] sc1
  s_mov_b64 exec, -1
  s_add_u32 s69, s66, s67
  s_add_u32 s44, s69, s95
  s_mov_b32 s95, s69
  s_ashr_i32 s69, s44, 1
  s_add_u32 s69, s69, s91
  s_cmp_lt_u32 s90, 5
  s_cselect_b32 s69, 0, s69
  s_add_u32 s90, s90, 1
  v_perm_b32 v197, v202, v200, s56
  v_perm_b32 v202, v202, v200, s57
  v_perm_b32 v200, v203, v201, s56
  v_perm_b32 v203, v203, v201, s57
  v_dot2_f32_bf16 v22, v197, v44, 0
  v_dot2_f32_bf16 v23, v202, v45, 0
  v_dot2_f32_bf16 v24, v200, v46, 0
  v_dot2_f32_bf16 v25, v203, v47, 0
  v_cvt_f32_i32 v92, v92
  v_cvt_f32_i32 v93, v93
  v_cvt_f32_i32 v94, v94
  v_cvt_f32_i32 v95, v95
  v_pk_mul_f32 v[20:21], v[92:93], v[22:23]
  v_pk_add_f32 v[18:19], v[22:23], v[24:25]
  v_pk_fma_f32 v[20:21], v[94:95], v[24:25], v[20:21]
  v_add_f32 v18, v18, v19
  v_add_f32 v20, v20, v21
  s_cmp_gt_i32 s69, 17
  s_cbranch_scc1 L_q46
  s_cmp_gt_i32 s69, -13
  s_cbranch_scc1 L_p46
  s_waitcnt vmcnt(5)
L_p46:
  s_waitcnt vmcnt(9)
L_q46:
  s_waitcnt vmcnt(10)
  buffer_load_dwordx4 v[80:83], v215, s[32:35], s3 offen nt
  v_add_f32_dpp v21, v18, v18 row_ror:8 row_mask:0xf bank_mask:0xc
  v_add_f32_dpp v21, v20, v20 row_ror:8 row_mask:0xf bank_mask:0x3
  v_add_f32_dpp v20, v34, v34 row_half_mirror row_mask:0xf bank_mask:0x5
  s_nop 0
  v_add_f32_dpp v20, v21, v21 row_half_mirror row_mask:0xf bank_mask:0xa
  s_nop 1
  v_add_f32_dpp v20, v20, v20 quad_perm:[2,3,0,1] row_mask:0xf bank_mask:0xf
  s_nop 1
  v_add_f32_dpp v20, v20, v20 quad_perm:[1,0,3,2] row_mask:0xf bank_mask:0xf
  v_cndmask_b32_e64 v32, v32, v20, s[52:53]
  v_perm_b32 v201, v206, v204, s56
  v_perm_b32 v206, v206, v204, s57
  v_perm_b32 v204, v207, v205, s56
  v_perm_b32 v207, v207, v205, s57
  v_dot2_f32_bf16 v22, v201, v48, 0
  v_dot2_f32_bf16 v23, v206, v49, 0
  v_dot2_f32_bf16 v24, v204, v50, 0
  v_dot2_f32_bf16 v25, v207, v51, 0
  v_cvt_f32_i32 v96, v96
  v_cvt_f32_i32 v97, v97
  v_cvt_f32_i32 v98, v98
  v_cvt_f32_i32 v99, v99
  v_pk_mul_f32 v[20:21], v[96:97], v[22:23]
  v_pk_add_f32 v[18:19], v[22:23], v[24:25]
  v_pk_fma_f32 v[20:21], v[98:99], v[24:25], v[20:21]
  v_add_f32 v18, v18, v19
  v_add_f32 v20, v20, v21
  s_cmp_gt_i32 s69, 17
  s_cbranch_scc1 L_q47
  s_cmp_gt_i32 s69, 2
  s_cbranch_scc1 L_p47
  s_waitcnt vmcnt(6)
L_p47:
  s_waitcnt vmcnt(10)
L_q47:
  s_waitcnt vmcnt(11)
  buffer_load_dwordx4 v[84:87], v216, s[32:35], s3 offen nt
  v_add_f32_dpp v34, v18, v18 row_ror:8 row_mask:0xf bank_mask:0xc
  v_add_f32_dpp v34, v20, v20 row_ror:8 row_mask:0xf bank_mask:0x3
  v_perm_b32 v205, v210, v208, s56
  v_perm_b32 v210, v210, v208, s57
  v_perm_b32 v208, v211, v209, s56
  v_perm_b32 v211, v211, v209, s57
  v_dot2_f32_bf16 v22, v205, v52, 0
  v_dot2_f32_bf16 v23, v210, v53, 0
  v_dot2_f32_bf16 v24, v208, v54, 0
  v_dot2_f32_bf16 v25, v211, v55, 0
  v_cvt_f32_i32 v100, v100
  v_cvt_f32_i32 v101, v101
  v_cvt_f32_i32 v102, v102
  v_cvt_f32_i32 v103, v103
  v_pk_mul_f32 v[20:21], v[100:101], v[22:23]
  v_pk_add_f32 v[18:19], v[22:23], v[24:25]
  v_pk_fma_f32 v[20:21], v[102:103], v[24:25], v[20:21]
  v_add_f32 v18, v18, v19
  v_add_f32 v20, v20, v21
  s_cmp_lt_i32 s69, -25
  s_cbranch_scc0 L_t48
  s_waitcnt vmcnt(6)
L_t48:
  s_cmp_gt_i32 s69, 17
  s_cbranch_scc1 L_q49
  s_cmp_gt_i32 s69, 9
  s_cbranch_scc1 L_p49
  s_waitcnt vmcnt(7)
L_p49:
  s_waitcnt vmcnt(11)
L_q49:
  s_waitcnt vmcnt(12)
  buffer_load_dwordx4 v[88:91], v217, s[32:35], s3 offen nt
  v_add_f32_dpp v21, v18, v18 row_ror:8 row_mask:0xf bank_mask:0xc
  v_add_f32_dpp v21, v20, v20 row_ror:8 row_mask:0xf bank_mask:0x3
  v_add_f32_dpp v20, v34, v34 row_half_mirror row_mask:0xf bank_mask:0x5
  s_nop 0
  v_add_f32_dpp v20, v21, v21 row_half_mirror row_mask:0xf bank_mask:0xa
  s_nop 1
  v_add_f32_dpp v20, v20, v20 quad_perm:[2,3,0,1] row_mask:0xf bank_mask:0xf
  s_nop 1
  v_add_f32_dpp v20, v20, v20 quad_perm:[1,0,3,2] row_mask:0xf bank_mask:0xf
  v_cndmask_b32_e64 v32, v32, v20, s[54:55]
  ds_write_b32 v1, v32 offset:1024
L_it15:
  s_mov_b32 s47, 3
L_fq15:
  s_waitcnt lgkmcnt(0)
  v_readfirstlane_b32 s46, v4
  s_cmp_ge_u32 s46, s47
  s_cbranch_scc1 L_fq15_ok
  s_cmp_eq_u32 s94, 0
  s_cbranch_scc1 L_fq15_ok
  s_sub_u32 s94, s94, 1
  ds_read_b32 v4, v14 offset:16
  s_branch L_fq15
L_fq15_ok:
  s_waitcnt vmcnt(7)
  v_add3_u32 v9, v26, v27, s58
  s_nop 0
  v_readfirstlane_b32 s91, v9
  s_add_u32 s44, s78, 0x03030303
  v_msad_u8 v9, s78, v40, 0
  v_msad_u8 v10, s44, v40, 0
  v_msad_u8 v9, s78, v41, v9
  v_msad_u8 v10, s44, v41, v10
  v_msad_u8 v9, s78, v42, v9
  v_msad_u8 v10, s44, v42, v10
  v_sub_u32 v9, v9, v10
  v_mov_b32 v8, s90
  s_add_u32 s78, s78, 0x01010101
  v_readlane_b32 s66, v9, 0
  v_readlane_b32 s67, v9, 1
  s_mov_b64 exec, 1
  global_store_byte v7, v8, s[30:31]
  s_mov_b64 exec, 3
  global_load_dwordx3 v[40:42], v239, s[30:31] sc1
  s_mov_b64 exec, -1
  s_add_u32 s69, s66, s67
  s_add_u32 s44, s69, s95
  s_mov_b32 s95, s69
  s_ashr_i32 s69, s44, 1
  s_add_u32 s69, s69, s91
  s_cmp_lt_u32 s90, 5
  s_cselect_b32 s69, 0, s69
  s_add_u32 s90, s90, 1
  v_dot2_f32_bf16 v22, v197, v56, 0
  v_dot2_f32_bf16 v23, v202, v57, 0
  v_dot2_f32_bf16 v24, v200, v58, 0
  v_dot2_f32_bf16 v25, v203, v59, 0
  v_cvt_f32_i32 v104, v104
  v_cvt_f32_i32 v105, v105
  v_cvt_f32_i32 v106, v106
  v_cvt_f32_i32 v107, v107
  ds_read_b128 v[44:47], v15 offset:2560
  v_pk_mul_f32 v[20:21], v[104:105], v[22:23]
  v_pk_add_f32 v[18:19], v[22:23], v[24:25]
  v_pk_fma_f32 v[20:21], v[106:107], v[24:25], v[20:21]
  v_add_f32 v18, v18, v19
  v_add_f32 v20, v20, v21
  s_cmp_gt_i32 s69, 17
  s_cbranch_scc1 L_q50
  s_cmp_gt_i32 s69, -13
  s_cbranch_scc1 L_p50
  s_waitcnt vmcnt(5)
L_p50:
  s_waitcnt vmcnt(8)
L_q50:
  s_waitcnt vmcnt(9)
  buffer_load_dwordx4 v[92:95], v218, s[32:35], s3 offen nt
  v_add_f32_dpp v21, v18, v18 row_ror:8 row_mask:0xf bank_mask:0xc
  v_add_f32_dpp v21, v20, v20 row_ror:8 row_mask:0xf bank_mask:0x3
  v_add_f32_dpp v20, v35, v35 row_half_mirror row_mask:0xf bank_mask:0x5
  s_nop 0
  v_add_f32_dpp v20, v21, v21 row_half_mirror row_mask:0xf bank_mask:0xa
  s_nop 1
  v_add_f32_dpp v20, v20, v20 quad_perm:[2,3,0,1] row_mask:0xf bank_mask:0xf
  s_nop 1
  v_add_f32_dpp v20, v20, v20 quad_perm:[1,0,3,2] row_mask:0xf bank_mask:0xf
  v_cndmask_b32_e64 v33, v33, v20, s[52:53]
  v_dot2_f32_bf16 v22, v201, v60, 0
  v_dot2_f32_bf16 v23, v206, v61, 0
  v_dot2_f32_bf16 v24, v204, v62, 0
  v_dot2_f32_bf16 v25, v207, v63, 0
  v_cvt_f32_i32 v108, v108
  v_cvt_f32_i32 v109, v109
  v_cvt_f32_i32 v110, v110
  v_cvt_f32_i32 v111, v111
  ds_read_b128 v[48:51], v16 offset:2560
  v_pk_mul_f32 v[20:21], v[108:109], v[22:23]
  v_pk_add_f32 v[18:19], v[22:23], v[24:25]
  v_pk_fma_f32 v[20:21], v[110:111], v[24:25], v[20:21]
  v_add_f32 v18, v18, v19
  v_add_f32 v20, v20, v21
  s_cmp_gt_i32 s69, 17
  s_cbranch_scc1 L_q51
  s_cmp_gt_i32 s69, 2
  s_cbranch_scc1 L_p51
  s_waitcnt vmcnt(6)
L_p51:
  s_waitcnt vmcnt(9)
L_q51:
  s_waitcnt vmcnt(10)
  buffer_load_dwordx4 v[96:99], v219, s[32:35], s3 offen nt
  v_add_f32_dpp v35, v18, v18 row_ror:8 row_mask:0xf bank_mask:0xc
  v_add_f32_dpp v35, v20, v20 row_ror:8 row_mask:0xf bank_mask:0x3
  v_dot2_f32_bf16 v22, v205, v64, 0
  v_dot2_f32_bf16 v23, v210, v65, 0
  v_dot2_f32_bf16 v24, v208, v66, 0
  v_dot2_f32_bf16 v25, v211, v67, 0
  v_cvt_f32_i32 v112, v112
  v_cvt_f32_i32 v113, v113
  v_cvt_f32_i32 v114, v114
  v_cvt_f32_i32 v115, v115
  ds_read_b128 v[52:55], v17 offset:2560
  v_pk_mul_f32 v[20:21], v[112:113], v[22:23]
  v_pk_add_f32 v[18:19], v[22:23], v[24:25]
  v_pk_fma_f32 v[20:21], v[114:115], v[24:25], v[20:21]
  v_add_f32 v18, v18, v19
  v_add_f32 v20, v20, v21
  s_cmp_lt_i32 s69, -25
  s_cbranch_scc0 L_t52
  s_waitcnt vmcnt(6)
L_t52:
  s_cmp_gt_i32 s69, 17
  s_cbranch_scc1 L_q53
  s_cmp_gt_i32 s69, 9
  s_cbranch_scc1 L_p53
  s_waitcnt vmcnt(7)
L_p53:
  s_waitcnt vmcnt(10)
L_q53:
  s_waitcnt vmcnt(11)
  buffer_load_dwordx4 v[100:103], v220, s[32:35], s3 offen nt
  v_add_f32_dpp v21, v18, v18 row_ror:8 row_mask:0xf bank_mask:0xc
  v_add_f32_dpp v21, v20, v20 row_ror:8 row_mask:0xf bank_mask:0x3
  v_add_f32_dpp v20, v35, v35 row_half_mirror row_mask:0xf bank_mask:0x5
  s_nop 0
  v_add_f32_dpp v20, v21, v21 row_half_mirror row_mask:0xf bank_mask:0xa
  s_nop 1
  v_add_f32_dpp v20, v20, v20 quad_perm:[2,3,0,1] row_mask:0xf bank_mask:0xf
  s_nop 1
  v_add_f32_dpp v20, v20, v20 quad_perm:[1,0,3,2] row_mask:0xf bank_mask:0xf
  v_cndmask_b32_e64 v33, v33, v20, s[54:55]
  ds_write_b32 v1, v33 offset:4096
  v_mov_b32 v8, 2
  ds_write_b32 v6, v8 offset:0
  v_add_u32 v15, 2048, v15
  v_add_u32 v16, 2048, v16
  v_add_u32 v17, 2048, v17
  s_mov_b32 s43, 2
  s_movk_i32 s101, 6144
  s_mov_b32 s34, 1572864
  s_add_u32 s32, s32, s3
  s_addc_u32 s33, s33, 0
  s_mov_b32 s68, 3
  s_lshl_b32 s44, s68, 2
  s_lshr_b64 s[64:65], s[96:97], s44
  s_and_b32 s64, s64, 15
  s_lshl4_add_u32 s68, s68, s64
  s_mul_i32 s44, s68, 1572864
  s_add_u32 s36, s6, s44
  s_addc_u32 s37, s7, 0
.p2align 6
L_k:
  s_add_u32 s44, s43, 2
  s_min_u32 s47, s44, 16
  v_add_u32 v15, 1024, v15
  v_and_b32 v15, 0xfff, v15
  v_add_u32 v16, 1024, v16
  v_and_b32 v16, 0xfff, v16
  v_add_u32 v17, 1024, v17
  v_and_b32 v17, 0xfff, v17
  v_add_u32 v2, s101, v1
  s_addk_i32 s101, 3072
  s_cmpk_eq_u32 s101, 18432
  s_cselect_b32 s101, 0, s101
  s_waitcnt lgkmcnt(0)
  s_waitcnt vmcnt(8)
  s_add_u32 s44, s78, 0x03030303
  v_msad_u8 v9, s78, v36, 0
  v_msad_u8 v10, s44, v36, 0
  v_msad_u8 v9, s78, v37, v9
  v_msad_u8 v10, s44, v37, v10
  v_msad_u8 v9, s78, v38, v9
  v_msad_u8 v10, s44, v38, v10
  v_sub_u32 v9, v9, v10
  v_mov_b32 v8, s90
  s_add_u32 s78, s78, 0x01010101
  v_readlane_b32 s66, v9, 0
  v_readlane_b32 s67, v9, 1
  s_mov_b64 exec, 1
  global_store_byte v7, v8, s[30:31]
  s_mov_b64 exec, 3
  global_load_dwordx3 v[36:38], v236, s[30:31] sc1
  s_mov_b64 exec, -1
  s_add_u32 s69, s66, s67
  s_add_u32 s44, s69, s95
  s_mov_b32 s95, s69
  s_ashr_i32 s69, s44, 1
  s_add_u32 s69, s69, s91
  s_cmp_lt_u32 s90, 5
  s_cselect_b32 s69, 0, s69
  s_add_u32 s90, s90, 1
  v_dot2_f32_bf16 v22, v13, v44, 0
  v_dot2_f32_bf16 v23, v118, v45, 0
  v_dot2_f32_bf16 v24, v116, v46, 0
  v_dot2_f32_bf16 v25, v119, v47, 0
  v_cvt_f32_i32 v68, v68
  v_cvt_f32_i32 v69, v69
  v_cvt_f32_i32 v70, v70
  v_cvt_f32_i32 v71, v71
  v_pk_mul_f32 v[20:21], v[68:69], v[22:23]
  v_pk_add_f32 v[18:19], v[22:23], v[24:25]
  v_pk_fma_f32 v[20:21], v[70:71], v[24:25], v[20:21]
  v_add_f32 v18, v18, v19
  v_add_f32 v20, v20, v21
  s_cmp_gt_i32 s69, 17
  s_cbranch_scc1 L_q54
  s_cmp_gt_i32 s69, -13
  s_cbranch_scc1 L_p54
  s_waitcnt vmcnt(5)
L_p54:
  s_waitcnt vmcnt(8)
L_q54:
  s_waitcnt vmcnt(9)
  buffer_load_dwordx4 v[104:107], v221, s[32:35], 0 offen nt
  v_add_f32_dpp v34, v18, v18 row_ror:8 row_mask:0xf bank_mask:0xc
  v_add_f32_dpp v34, v20, v20 row_ror:8 row_mask:0xf bank_mask:0x3
  v_dot2_f32_bf16 v22, v117, v48, 0
  v_dot2_f32_bf16 v23, v122, v49, 0
  v_dot2_f32_bf16 v24, v120, v50, 0
  v_dot2_f32_bf16 v25, v123, v51, 0
  v_cvt_f32_i32 v72, v72
  v_cvt_f32_i32 v73, v73
  v_cvt_f32_i32 v74, v74
  v_cvt_f32_i32 v75, v75
  v_pk_mul_f32 v[20:21], v[72:73], v[22:23]
  v_pk_add_f32 v[18:19], v[22:23], v[24:25]
  v_pk_fma_f32 v[20:21], v[74:75], v[24:25], v[20:21]
  v_add_f32 v18, v18, v19
  v_add_f32 v20, v20, v21
  s_cmp_gt_i32 s69, 17
  s_cbranch_scc1 L_q55
  s_cmp_gt_i32 s69, 2
  s_cbranch_scc1 L_p55
  s_waitcnt vmcnt(6)
L_p55:
  s_waitcnt vmcnt(9)
L_q55:
  s_waitcnt vmcnt(10)
  buffer_load_dwordx4 v[108:111], v222, s[32:35], 0 offen nt
  v_add_f32_dpp v21, v18, v18 row_ror:8 row_mask:0xf bank_mask:0xc
  v_add_f32_dpp v21, v20, v20 row_ror:8 row_mask:0xf bank_mask:0x3
  v_add_f32_dpp v20, v34, v34 row_half_mirror row_mask:0xf bank_mask:0x5
  s_nop 0
  v_add_f32_dpp v20, v21, v21 row_half_mirror row_mask:0xf bank_mask:0xa
  s_nop 1
  v_add_f32_dpp v20, v20, v20 quad_perm:[2,3,0,1] row_mask:0xf bank_mask:0xf
  s_nop 1
  v_add_f32_dpp v20, v20, v20 quad_perm:[1,0,3,2] row_mask:0xf bank_mask:0xf
  v_cndmask_b32_e64 v32, v32, v20, s[48:49]
  v_dot2_f32_bf16 v22, v121, v52, 0
  v_dot2_f32_bf16 v23, v126, v53, 0
  v_dot2_f32_bf16 v24, v124, v54, 0
  v_dot2_f32_bf16 v25, v127, v55, 0
  v_cvt_f32_i32 v76, v76
  v_cvt_f32_i32 v77, v77
  v_cvt_f32_i32 v78, v78
  v_cvt_f32_i32 v79, v79
  v_pk_mul_f32 v[20:21], v[76:77], v[22:23]
  v_pk_add_f32 v[18:19], v[22:23], v[24:25]
  v_pk_fma_f32 v[20:21], v[78:79], v[24:25], v[20:21]
  v_add_f32 v18, v18, v19
  v_add_f32 v20, v20, v21
  s_cmp_lt_i32 s69, -25
  s_cbranch_scc0 L_t56
  s_waitcnt vmcnt(6)
L_t56:
  s_cmp_gt_i32 s69, 17
  s_cbranch_scc1 L_q57
  s_cmp_gt_i32 s69, 9
  s_cbranch_scc1 L_p57
  s_waitcnt vmcnt(7)
L_p57:
  s_waitcnt vmcnt(10)
L_q57:
  s_waitcnt vmcnt(11)
  buffer_load_dwordx4 v[112:115], v223, s[32:35], 0 offen nt
  v_add_f32_dpp v34, v18, v18 row_ror:8 row_mask:0xf bank_mask:0xc
  v_add_f32_dpp v34, v20, v20 row_ror:8 row_mask:0xf bank_mask:0x3
  s_waitcnt vmcnt(8)
  s_add_u32 s44, s78, 0x03030303
  v_msad_u8 v9, s78, v40, 0
  v_msad_u8 v10, s44, v40, 0
  v_msad_u8 v9, s78, v41, v9
  v_msad_u8 v10, s44, v41, v10
  v_msad_u8 v9, s78, v42, v9
  v_msad_u8 v10, s44, v42, v10
  v_sub_u32 v9, v9, v10
  v_mov_b32 v8, s90
  s_add_u32 s78, s78, 0x01010101
  v_readlane_b32 s66, v9, 0
  v_readlane_b32 s67, v9, 1
  s_mov_b64 exec, 1
  global_store_byte v7, v8, s[30:31]
  s_mov_b64 exec, 3
  global_load_dwordx3 v[40:42], v237, s[30:31] sc1
  s_mov_b64 exec, -1
  s_add_u32 s69, s66, s67
  s_add_u32 s44, s69, s95
  s_mov_b32 s95, s69
  s_ashr_i32 s69, s44, 1
  s_add_u32 s69, s69, s91
  s_cmp_lt_u32 s90, 5
  s_cselect_b32 s69, 0, s69
  s_add_u32 s90, s90, 1
  v_dot2_f32_bf16 v22, v125, v44, 0
  v_dot2_f32_bf16 v23, v130, v45, 0
  v_dot2_f32_bf16 v24, v128, v46, 0
  v_dot2_f32_bf16 v25, v131, v47, 0
  v_cvt_f32_i32 v80, v80
  v_cvt_f32_i32 v81, v81
  v_cvt_f32_i32 v82, v82
  v_cvt_f32_i32 v83, v83
  v_pk_mul_f32 v[20:21], v[80:81], v[22:23]
  v_pk_add_f32 v[18:19], v[22:23], v[24:25]
  v_pk_fma_f32 v[20:21], v[82:83], v[24:25], v[20:21]
  v_add_f32 v18, v18, v19
  v_add_f32 v20, v20, v21
  s_cmp_gt_i32 s69, 17
  s_cbranch_scc1 L_q58
  s_cmp_gt_i32 s69, -13
  s_cbranch_scc1 L_p58
  s_waitcnt vmcnt(5)
L_p58:
  s_waitcnt vmcnt(8)
L_q58:
  s_waitcnt vmcnt(9)
  buffer_load_dwordx4 v[68:71], v224, s[32:35], 0 offen nt
  v_add_f32_dpp v21, v18, v18 row_ror:8 row_mask:0xf bank_mask:0xc
  v_add_f32_dpp v21, v20, v20 row_ror:8 row_mask:0xf bank_mask:0x3
  v_add_f32_dpp v20, v34, v34 row_half_mirror row_mask:0xf bank_mask:0x5
  s_nop 0
  v_add_f32_dpp v20, v21, v21 row_half_mirror row_mask:0xf bank_mask:0xa
  s_nop 1
  v_add_f32_dpp v20, v20, v20 quad_perm:[2,3,0,1] row_mask:0xf bank_mask:0xf
  s_nop 1
  v_add_f32_dpp v20, v20, v20 quad_perm:[1,0,3,2] row_mask:0xf bank_mask:0xf
  v_cndmask_b32_e64 v32, v32, v20, s[50:51]
  v_dot2_f32_bf16 v22, v129, v48, 0
  v_dot2_f32_bf16 v23, v134, v49, 0
  v_dot2_f32_bf16 v24, v132, v50, 0
  v_dot2_f32_bf16 v25, v135, v51, 0
  v_cvt_f32_i32 v84, v84
  v_cvt_f32_i32 v85, v85
  v_cvt_f32_i32 v86, v86
  v_cvt_f32_i32 v87, v87
  v_pk_mul_f32 v[20:21], v[84:85], v[22:23]
  v_pk_add_f32 v[18:19], v[22:23], v[24:25]
  v_pk_fma_f32 v[20:21], v[86:87], v[24:25], v[20:21]
  v_add_f32 v18, v18, v19
  v_add_f32 v20, v20, v21
  s_cmp_gt_i32 s69, 17
  s_cbranch_scc1 L_q59
  s_cmp_gt_i32 s69, 2
  s_cbranch_scc1 L_p59
  s_waitcnt vmcnt(6)
L_p59:
  s_waitcnt vmcnt(9)
L_q59:
  s_waitcnt vmcnt(10)
  buffer_load_dwordx4 v[72:75], v225, s[32:35], 0 offen nt
  v_add_f32_dpp v34, v18, v18 row_ror:8 row_mask:0xf bank_mask:0xc
  v_add_f32_dpp v34, v20, v20 row_ror:8 row_mask:0xf bank_mask:0x3
  v_dot2_f32_bf16 v22, v133, v52, 0
  v_dot2_f32_bf16 v23, v138, v53, 0
  v_dot2_f32_bf16 v24, v136, v54, 0
  v_dot2_f32_bf16 v25, v139, v55, 0
  v_cvt_f32_i32 v88, v88
  v_cvt_f32_i32 v89, v89
  v_cvt_f32_i32 v90, v90
  v_cvt_f32_i32 v91, v91
  v_pk_mul_f32 v[20:21], v[88:89], v[22:23]
  v_pk_add_f32 v[18:19], v[22:23], v[24:25]
  v_pk_fma_f32 v[20:21], v[90:91], v[24:25], v[20:21]
  v_add_f32 v18, v18, v19
  v_add_f32 v20, v20, v21
  s_cmp_lt_i32 s69, -25
  s_cbranch_scc0 L_t60
  s_waitcnt vmcnt(6)
L_t60:
  s_cmp_gt_i32 s69, 17
  s_cbranch_scc1 L_q61
  s_cmp_gt_i32 s69, 9
  s_cbranch_scc1 L_p61
  s_waitcnt vmcnt(7)
L_p61:
  s_waitcnt vmcnt(10)
L_q61:
  s_waitcnt vmcnt(11)
  buffer_load_dwordx4 v[76:79], v226, s[32:35], 0 offen nt
  v_add_f32_dpp v21, v18, v18 row_ror:8 row_mask:0xf bank_mask:0xc
  v_add_f32_dpp v21, v20, v20 row_ror:8 row_mask:0xf bank_mask:0x3
  v_add_f32_dpp v20, v34, v34 row_half_mirror row_mask:0xf bank_mask:0x5
  s_nop 0
  v_add_f32_dpp v20, v21, v21 row_half_mirror row_mask:0xf bank_mask:0xa
  s_nop 1
  v_add_f32_dpp v20, v20, v20 quad_perm:[2,3,0,1] row_mask:0xf bank_mask:0xf
  s_nop 1
  v_add_f32_dpp v20, v20, v20 quad_perm:[1,0,3,2] row_mask:0xf bank_mask:0xf
  v_cndmask_b32_e64 v32, v32, v20, s[52:53]
  s_waitcnt vmcnt(8)
  s_add_u32 s44, s78, 0x03030303
  v_msad_u8 v9, s78, v36, 0
  v_msad_u8 v10, s44, v36, 0
  v_msad_u8 v9, s78, v37, v9
  v_msad_u8 v10, s44, v37, v10
  v_msad_u8 v9, s78, v38, v9
  v_msad_u8 v10, s44, v38, v10
  v_sub_u32 v9, v9, v10
  v_mov_b32 v8, s90
  s_add_u32 s78, s78, 0x01010101
  v_readlane_b32 s66, v9, 0
  v_readlane_b32 s67, v9, 1
  s_mov_b64 exec, 1
  global_store_byte v7, v8, s[30:31]
  s_mov_b64 exec, 3
  global_load_dwordx3 v[36:38], v238, s[30:31] sc1
  s_mov_b64 exec, -1
  s_add_u32 s69, s66, s67
  s_add_u32 s44, s69, s95
  s_mov_b32 s95, s69
  s_ashr_i32 s69, s44, 1
  s_add_u32 s69, s69, s91
  s_cmp_lt_u32 s90, 5
  s_cselect_b32 s69, 0, s69
  s_add_u32 s90, s90, 1
  v_dot2_f32_bf16 v22, v137, v44, 0
  v_dot2_f32_bf16 v23, v142, v45, 0
  v_dot2_f32_bf16 v24, v140, v46, 0
  v_dot2_f32_bf16 v25, v143, v47, 0
  v_cvt_f32_i32 v92, v92
  v_cvt_f32_i32 v93, v93
  v_cvt_f32_i32 v94, v94
  v_cvt_f32_i32 v95, v95
  v_pk_mul_f32 v[20:21], v[92:93], v[22:23]
  v_pk_add_f32 v[18:19], v[22:23], v[24:25]
  v_pk_fma_f32 v[20:21], v[94:95], v[24:25], v[20:21]
  v_add_f32 v18, v18, v19
  v_add_f32 v20, v20, v21
  s_cmp_gt_i32 s69, 17
  s_cbranch_scc1 L_q62
  s_cmp_gt_i32 s69, -13
  s_cbranch_scc1 L_p62
  s_waitcnt vmcnt(5)
L_p62:
  s_waitcnt vmcnt(8)
L_q62:
  s_waitcnt vmcnt(9)
  buffer_load_dwordx4 v[80:83], v227, s[32:35], 0 offen nt
  v_add_f32_dpp v34, v18, v18 row_ror:8 row_mask:0xf bank_mask:0xc
  v_add_f32_dpp v34, v20, v20 row_ror:8 row_mask:0xf bank_mask:0x3
  v_dot2_f32_bf16 v22, v141, v48, 0
  v_dot2_f32_bf16 v23, v146, v49, 0
  v_dot2_f32_bf16 v24, v144, v50, 0
  v_dot2_f32_bf16 v25, v147, v51, 0
  v_cvt_f32_i32 v96, v96
  v_cvt_f32_i32 v97, v97
  v_cvt_f32_i32 v98, v98
  v_cvt_f32_i32 v99, v99
  v_pk_mul_f32 v[20:21], v[96:97], v[22:23]
  v_pk_add_f32 v[18:19], v[22:23], v[24:25]
  v_pk_fma_f32 v[20:21], v[98:99], v[24:25], v[20:21]
  v_add_f32 v18, v18, v19
  v_add_f32 v20, v20, v21
  s_cmp_gt_i32 s69, 17
  s_cbranch_scc1 L_q63
  s_cmp_gt_i32 s69, 2
  s_cbranch_scc1 L_p63
  s_waitcnt vmcnt(6)
L_p63:
  s_waitcnt vmcnt(9)
L_q63:
  s_waitcnt vmcnt(10)
  buffer_load_dwordx4 v[84:87], v228, s[32:35], 0 offen nt
  v_add_f32_dpp v21, v18, v18 row_ror:8 row_mask:0xf bank_mask:0xc
  v_add_f32_dpp v21, v20, v20 row_ror:8 row_mask:0xf bank_mask:0x3
  v_add_f32_dpp v20, v34, v34 row_half_mirror row_mask:0xf bank_mask:0x5
  s_nop 0
  v_add_f32_dpp v20, v21, v21 row_half_mirror row_mask:0xf bank_mask:0xa
  s_nop 1
  v_add_f32_dpp v20, v20, v20 quad_perm:[2,3,0,1] row_mask:0xf bank_mask:0xf
  s_nop 1
  v_add_f32_dpp v20, v20, v20 quad_perm:[1,0,3,2] row_mask:0xf bank_mask:0xf
  v_cndmask_b32_e64 v32, v32, v20, s[54:55]
  ds_write_b32 v2, v32 offset:0
  v_dot2_f32_bf16 v22, v145, v52, 0
  v_dot2_f32_bf16 v23, v150, v53, 0
  v_dot2_f32_bf16 v24, v148, v54, 0
  v_dot2_f32_bf16 v25, v151, v55, 0
  v_cvt_f32_i32 v100, v100
  v_cvt_f32_i32 v101, v101
  v_cvt_f32_i32 v102, v102
  v_cvt_f32_i32 v103, v103
  v_pk_mul_f32 v[20:21], v[100:101], v[22:23]
  v_pk_add_f32 v[18:19], v[22:23], v[24:25]
  v_pk_fma_f32 v[20:21], v[102:103], v[24:25], v[20:21]
  v_add_f32 v18, v18, v19
  v_add_f32 v20, v20, v21
  s_cmp_lt_i32 s69, -25
  s_cbranch_scc0 L_t64
  s_waitcnt vmcnt(6)
L_t64:
  s_cmp_gt_i32 s69, 17
  s_cbranch_scc1 L_q65
  s_cmp_gt_i32 s69, 9
  s_cbranch_scc1 L_p65
  s_waitcnt vmcnt(7)
L_p65:
  s_waitcnt vmcnt(10)
L_q65:
  s_waitcnt vmcnt(11)
  buffer_load_dwordx4 v[88:91], v229, s[32:35], 0 offen nt
  v_add_f32_dpp v34, v18, v18 row_ror:8 row_mask:0xf bank_mask:0xc
  v_add_f32_dpp v34, v20, v20 row_ror:8 row_mask:0xf bank_mask:0x3
  s_waitcnt vmcnt(8)
  s_add_u32 s44, s78, 0x03030303
  v_msad_u8 v9, s78, v40, 0
  v_msad_u8 v10, s44, v40, 0
  v_msad_u8 v9, s78, v41, v9
  v_msad_u8 v10, s44, v41, v10
  v_msad_u8 v9, s78, v42, v9
  v_msad_u8 v10, s44, v42, v10
  v_sub_u32 v9, v9, v10
  v_mov_b32 v8, s90
  s_add_u32 s78, s78, 0x01010101
  v_readlane_b32 s66, v9, 0
  v_readlane_b32 s67, v9, 1
  s_mov_b64 exec, 1
  global_store_byte v7, v8, s[30:31]
  s_mov_b64 exec, 3
  global_load_dwordx3 v[40:42], v239, s[30:31] sc1
  s_mov_b64 exec, -1
  s_add_u32 s69, s66, s67
  s_add_u32 s44, s69, s95
  s_mov_b32 s95, s69
  s_ashr_i32 s69, s44, 1
  s_add_u32 s69, s69, s91
  s_cmp_lt_u32 s90, 5
  s_cselect_b32 s69, 0, s69
  s_add_u32 s90, s90, 1
  v_dot2_f32_bf16 v22, v149, v44, 0
  v_dot2_f32_bf16 v23, v154, v45, 0
  v_dot2_f32_bf16 v24, v152, v46, 0
  v_dot2_f32_bf16 v25, v155, v47, 0
  v_cvt_f32_i32 v104, v104
  v_cvt_f32_i32 v105, v105
  v_cvt_f32_i32 v106, v106
  v_cvt_f32_i32 v107, v107
  v_pk_mul_f32 v[20:21], v[104:105], v[22:23]
  v_pk_add_f32 v[18:19], v[22:23], v[24:25]
  v_pk_fma_f32 v[20:21], v[106:107], v[24:25], v[20:21]
  v_add_f32 v18, v18, v19
  v_add_f32 v20, v20, v21
  s_cmp_gt_i32 s69, 17
  s_cbranch_scc1 L_q66
  s_cmp_gt_i32 s69, -13
  s_cbranch_scc1 L_p66
  s_waitcnt vmcnt(5)
L_p66:
  s_waitcnt vmcnt(8)
L_q66:
  s_waitcnt vmcnt(9)
  buffer_load_dwordx4 v[92:95], v230, s[32:35], 0 offen nt
  v_add_f32_dpp v21, v18, v18 row_ror:8 row_mask:0xf bank_mask:0xc
  v_add_f32_dpp v21, v20, v20 row_ror:8 row_mask:0xf bank_mask:0x3
  v_add_f32_dpp v20, v34, v34 row_half_mirror row_mask:0xf bank_mask:0x5
  s_nop 0
  v_add_f32_dpp v20, v21, v21 row_half_mirror row_mask:0xf bank_mask:0xa
  s_nop 1
  v_add_f32_dpp v20, v20, v20 quad_perm:[2,3,0,1] row_mask:0xf bank_mask:0xf
  s_nop 1
  v_add_f32_dpp v20, v20, v20 quad_perm:[1,0,3,2] row_mask:0xf bank_mask:0xf
  v_cndmask_b32_e64 v32, v32, v20, s[48:49]
  v_dot2_f32_bf16 v22, v153, v48, 0
  v_dot2_f32_bf16 v23, v158, v49, 0
  v_dot2_f32_bf16 v24, v156, v50, 0
  v_dot2_f32_bf16 v25, v159, v51, 0
  v_cvt_f32_i32 v108, v108
  v_cvt_f32_i32 v109, v109
  v_cvt_f32_i32 v110, v110
  v_cvt_f32_i32 v111, v111
  v_pk_mul_f32 v[20:21], v[108:109], v[22:23]
  v_pk_add_f32 v[18:19], v[22:23], v[24:25]
  v_pk_fma_f32 v[20:21], v[110:111], v[24:25], v[20:21]
  v_add_f32 v18, v18, v19
  v_add_f32 v20, v20, v21
  s_cmp_gt_i32 s69, 17
  s_cbranch_scc1 L_q67
  s_cmp_gt_i32 s69, 2
  s_cbranch_scc1 L_p67
  s_waitcnt vmcnt(6)
L_p67:
  s_waitcnt vmcnt(9)
L_q67:
  s_waitcnt vmcnt(10)
  buffer_load_dwordx4 v[96:99], v231, s[32:35], 0 offen nt
  v_add_f32_dpp v34, v18, v18 row_ror:8 row_mask:0xf bank_mask:0xc
  v_add_f32_dpp v34, v20, v20 row_ror:8 row_mask:0xf bank_mask:0x3
  v_dot2_f32_bf16 v22, v157, v52, 0
  v_dot2_f32_bf16 v23, v162, v53, 0
  v_dot2_f32_bf16 v24, v160, v54, 0
  v_dot2_f32_bf16 v25, v163, v55, 0
  v_cvt_f32_i32 v112, v112
  v_cvt_f32_i32 v113, v113
  v_cvt_f32_i32 v114, v114
  v_cvt_f32_i32 v115, v115
  v_pk_mul_f32 v[20:21], v[112:113], v[22:23]
  v_pk_add_f32 v[18:19], v[22:23], v[24:25]
  v_pk_fma_f32 v[20:21], v[114:115], v[24:25], v[20:21]
  v_add_f32 v18, v18, v19
  v_add_f32 v20, v20, v21
  s_cmp_lt_i32 s69, -25
  s_cbranch_scc0 L_t68
  s_waitcnt vmcnt(6)
L_t68:
  s_cmp_gt_i32 s69, 17
  s_cbranch_scc1 L_q69
  s_cmp_gt_i32 s69, 9
  s_cbranch_scc1 L_p69
  s_waitcnt vmcnt(7)
L_p69:
  s_waitcnt vmcnt(10)
L_q69:
  s_waitcnt vmcnt(11)
  buffer_load_dwordx4 v[100:103], v232, s[32:35], 0 offen nt
  v_add_f32_dpp v21, v18, v18 row_ror:8 row_mask:0xf bank_mask:0xc
  v_add_f32_dpp v21, v20, v20 row_ror:8 row_mask:0xf bank_mask:0x3
  v_add_f32_dpp v20, v34, v34 row_half_mirror row_mask:0xf bank_mask:0x5
  s_nop 0
  v_add_f32_dpp v20, v21, v21 row_half_mirror row_mask:0xf bank_mask:0xa
  s_nop 1
  v_add_f32_dpp v20, v20, v20 quad_perm:[2,3,0,1] row_mask:0xf bank_mask:0xf
  s_nop 1
  v_add_f32_dpp v20, v20, v20 quad_perm:[1,0,3,2] row_mask:0xf bank_mask:0xf
  v_cndmask_b32_e64 v32, v32, v20, s[50:51]
  s_waitcnt vmcnt(8)
  s_add_u32 s44, s78, 0x03030303
  v_msad_u8 v9, s78, v36, 0
  v_msad_u8 v10, s44, v36, 0
  v_msad_u8 v9, s78, v37, v9
  v_msad_u8 v10, s44, v37, v10
  v_msad_u8 v9, s78, v38, v9
  v_msad_u8 v10, s44, v38, v10
  v_sub_u32 v9, v9, v10
  v_mov_b32 v8, s90
  s_add_u32 s78, s78, 0x01010101
  v_readlane_b32 s66, v9, 0
  v_readlane_b32 s67, v9, 1
  s_mov_b64 exec, 1
  global_store_byte v7, v8, s[30:31]
  s_mov_b64 exec, 3
  global_load_dwordx3 v[36:38], v236, s[30:31] sc1
  s_mov_b64 exec, -1
  s_add_u32 s69, s66, s67
  s_add_u32 s44, s69, s95
  s_mov_b32 s95, s69
  s_ashr_i32 s69, s44, 1
  s_add_u32 s69, s69, s91
  s_cmp_lt_u32 s90, 5
  s_cselect_b32 s69, 0, s69
  s_add_u32 s90, s90, 1
  v_dot2_f32_bf16 v22, v161, v44, 0
  v_dot2_f32_bf16 v23, v166, v45, 0
  v_dot2_f32_bf16 v24, v164, v46, 0
  v_dot2_f32_bf16 v25, v167, v47, 0
  v_cvt_f32_i32 v68, v68
  v_cvt_f32_i32 v69, v69
  v_cvt_f32_i32 v70, v70
  v_cvt_f32_i32 v71, v71
  v_pk_mul_f32 v[20:21], v[68:69], v[22:23]
  v_pk_add_f32 v[18:19], v[22:23], v[24:25]
  v_pk_fma_f32 v[20:21], v[70:71], v[24:25], v[20:21]
  v_add_f32 v18, v18, v19
  v_add_f32 v20, v20, v21
  s_cmp_gt_i32 s69, 17
  s_cbranch_scc1 L_q70
  s_cmp_gt_i32 s69, -13
  s_cbranch_scc1 L_p70
  s_waitcnt vmcnt(5)
L_p70:
  s_waitcnt vmcnt(8)
L_q70:
  s_waitcnt vmcnt(9)
  buffer_load_dwordx4 v[104:107], v233, s[32:35], 0 offen nt
  v_add_f32_dpp v34, v18, v18 row_ror:8 row_mask:0xf bank_mask:0xc
  v_add_f32_dpp v34, v20, v20 row_ror:8 row_mask:0xf bank_mask:0x3
  v_dot2_f32_bf16 v22, v165, v48, 0
  v_dot2_f32_bf16 v23, v170, v49, 0
  v_dot2_f32_bf16 v24, v168, v50, 0
  v_dot2_f32_bf16 v25, v171, v51, 0
  v_cvt_f32_i32 v72, v72
  v_cvt_f32_i32 v73, v73
  v_cvt_f32_i32 v74, v74
  v_cvt_f32_i32 v75, v75
  v_pk_mul_f32 v[20:21], v[72:73], v[22:23]
  v_pk_add_f32 v[18:19], v[22:23], v[24:25]
  v_pk_fma_f32 v[20:21], v[74:75], v[24:25], v[20:21]
  v_add_f32 v18, v18, v19
  v_add_f32 v20, v20, v21
  s_cmp_gt_i32 s69, 17
  s_cbranch_scc1 L_q71
  s_cmp_gt_i32 s69, 2
  s_cbranch_scc1 L_p71
  s_waitcnt vmcnt(6)
L_p71:
  s_waitcnt vmcnt(9)
L_q71:
  s_waitcnt vmcnt(10)
  buffer_load_dwordx4 v[108:111], v234, s[32:35], 0 offen nt
  v_add_f32_dpp v21, v18, v18 row_ror:8 row_mask:0xf bank_mask:0xc
  v_add_f32_dpp v21, v20, v20 row_ror:8 row_mask:0xf bank_mask:0x3
  v_add_f32_dpp v20, v34, v34 row_half_mirror row_mask:0xf bank_mask:0x5
  s_nop 0
  v_add_f32_dpp v20, v21, v21 row_half_mirror row_mask:0xf bank_mask:0xa
  s_nop 1
  v_add_f32_dpp v20, v20, v20 quad_perm:[2,3,0,1] row_mask:0xf bank_mask:0xf
  s_nop 1
  v_add_f32_dpp v20, v20, v20 quad_perm:[1,0,3,2] row_mask:0xf bank_mask:0xf
  v_cndmask_b32_e64 v32, v32, v20, s[52:53]
  v_dot2_f32_bf16 v22, v169, v52, 0
  v_dot2_f32_bf16 v23, v174, v53, 0
  v_dot2_f32_bf16 v24, v172, v54, 0
  v_dot2_f32_bf16 v25, v175, v55, 0
  v_cvt_f32_i32 v76, v76
  v_cvt_f32_i32 v77, v77
  v_cvt_f32_i32 v78, v78
  v_cvt_f32_i32 v79, v79
  v_pk_mul_f32 v[20:21], v[76:77], v[22:23]
  v_pk_add_f32 v[18:19], v[22:23], v[24:25]
  v_pk_fma_f32 v[20:21], v[78:79], v[24:25], v[20:21]
  v_add_f32 v18, v18, v19
  v_add_f32 v20, v20, v21
  s_cmp_lt_i32 s69, -25
  s_cbranch_scc0 L_t72
  s_waitcnt vmcnt(6)
L_t72:
  s_cmp_gt_i32 s69, 17
  s_cbranch_scc1 L_q73
  s_cmp_gt_i32 s69, 9
  s_cbranch_scc1 L_p73
  s_waitcnt vmcnt(7)
L_p73:
  s_waitcnt vmcnt(10)
L_q73:
  s_waitcnt vmcnt(11)
  buffer_load_dwordx4 v[112:115], v235, s[32:35], 0 offen nt
  v_add_f32_dpp v34, v18, v18 row_ror:8 row_mask:0xf bank_mask:0xc
  v_add_f32_dpp v34, v20, v20 row_ror:8 row_mask:0xf bank_mask:0x3
  s_mov_b64 exec, 1
  global_load_dwordx2 v[26:27], v11, s[30:31] sc1
  s_mov_b64 exec, -1
  s_waitcnt vmcnt(9)
  s_add_u32 s44, s78, 0x03030303
  v_msad_u8 v9, s78, v40, 0
  v_msad_u8 v10, s44, v40, 0
  v_msad_u8 v9, s78, v41, v9
  v_msad_u8 v10, s44, v41, v10
  v_msad_u8 v9, s78, v42, v9
  v_msad_u8 v10, s44, v42, v10
  v_sub_u32 v9, v9, v10
  v_mov_b32 v8, s90
  s_add_u32 s78, s78, 0x01010101
  v_readlane_b32 s66, v9, 0
  v_readlane_b32 s67, v9, 1
  s_mov_b64 exec, 1
  global_store_byte v7, v8, s[30:31]
  s_mov_b64 exec, 3
  global_load_dwordx3 v[40:42], v237, s[30:31] sc1
  s_mov_b64 exec, -1
  s_add_u32 s69, s66, s67
  s_add_u32 s44, s69, s95
  s_mov_b32 s95, s69
  s_ashr_i32 s69, s44, 1
  s_add_u32 s69, s69, s91
  s_cmp_lt_u32 s90, 5
  s_cselect_b32 s69, 0, s69
  s_add_u32 s90, s90, 1
  v_dot2_f32_bf16 v22, v173, v44, 0
  v_dot2_f32_bf16 v23, v178, v45, 0
  v_dot2_f32_bf16 v24, v176, v46, 0
  v_dot2_f32_bf16 v25, v179, v47, 0
  v_cvt_f32_i32 v80, v80
  v_cvt_f32_i32 v81, v81
  v_cvt_f32_i32 v82, v82
  v_cvt_f32_i32 v83, v83
  v_pk_mul_f32 v[20:21], v[80:81], v[22:23]
  v_pk_add_f32 v[18:19], v[22:23], v[24:25]
  v_pk_fma_f32 v[20:21], v[82:83], v[24:25], v[20:21]
  v_add_f32 v18, v18, v19
  v_add_f32 v20, v20, v21
  s_cmp_gt_i32 s69, 17
  s_cbranch_scc1 L_q74
  s_cmp_gt_i32 s69, -13
  s_cbranch_scc1 L_p74
  s_waitcnt vmcnt(6)
L_p74:
  s_waitcnt vmcnt(9)
L_q74:
  s_waitcnt vmcnt(10)
  buffer_load_dwordx4 v[68:71], v212, s[36:39], 0 offen nt
  v_add_f32_dpp v21, v18, v18 row_ror:8 row_mask:0xf bank_mask:0xc
  v_add_f32_dpp v21, v20, v20 row_ror:8 row_mask:0xf bank_mask:0x3
  v_add_f32_dpp v20, v34, v34 row_half_mirror row_mask:0xf bank_mask:0x5
  s_nop 0
  v_add_f32_dpp v20, v21, v21 row_half_mirror row_mask:0xf bank_mask:0xa
  s_nop 1
  v_add_f32_dpp v20, v20, v20 quad_perm:[2,3,0,1] row_mask:0xf bank_mask:0xf
  s_nop 1
  v_add_f32_dpp v20, v20, v20 quad_perm:[1,0,3,2] row_mask:0xf bank_mask:0xf
  v_cndmask_b32_e64 v32, v32, v20, s[54:55]
  ds_write_b32 v2, v32 offset:512
  v_dot2_f32_bf16 v22, v177, v48, 0
  v_dot2_f32_bf16 v23, v182, v49, 0
  v_dot2_f32_bf16 v24, v180, v50, 0
  v_dot2_f32_bf16 v25, v183, v51, 0
  v_cvt_f32_i32 v84, v84
  v_cvt_f32_i32 v85, v85
  v_cvt_f32_i32 v86, v86
  v_cvt_f32_i32 v87, v87
  v_pk_mul_f32 v[20:21], v[84:85], v[22:23]
  v_pk_add_f32 v[18:19], v[22:23], v[24:25]
  v_pk_fma_f32 v[20:21], v[86:87], v[24:25], v[20:21]
  v_add_f32 v18, v18, v19
  v_add_f32 v20, v20, v21
  s_cmp_gt_i32 s69, 17
  s_cbranch_scc1 L_q75
  s_cmp_gt_i32 s69, 2
  s_cbranch_scc1 L_p75
  s_waitcnt vmcnt(7)
L_p75:
  s_waitcnt vmcnt(10)
L_q75:
  s_waitcnt vmcnt(11)
  buffer_load_dwordx4 v[72:75], v213, s[36:39], 0 offen nt
  v_add_f32_dpp v34, v18, v18 row_ror:8 row_mask:0xf bank_mask:0xc
  v_add_f32_dpp v34, v20, v20 row_ror:8 row_mask:0xf bank_mask:0x3
  v_dot2_f32_bf16 v22, v181, v52, 0
  v_dot2_f32_bf16 v23, v186, v53, 0
  v_dot2_f32_bf16 v24, v184, v54, 0
  v_dot2_f32_bf16 v25, v187, v55, 0
  v_cvt_f32_i32 v88, v88
  v_cvt_f32_i32 v89, v89
  v_cvt_f32_i32 v90, v90
  v_cvt_f32_i32 v91, v91
  v_pk_mul_f32 v[20:21], v[88:89], v[22:23]
  v_pk_add_f32 v[18:19], v[22:23], v[24:25]
  v_pk_fma_f32 v[20:21], v[90:91], v[24:25], v[20:21]
  v_add_f32 v18, v18, v19
  v_add_f32 v20, v20, v21
  s_cmp_lt_i32 s69, -25
  s_cbranch_scc0 L_t76
  s_waitcnt vmcnt(7)
L_t76:
  s_cmp_gt_i32 s69, 17
  s_cbranch_scc1 L_q77
  s_cmp_gt_i32 s69, 9
  s_cbranch_scc1 L_p77
  s_waitcnt vmcnt(8)
L_p77:
  s_waitcnt vmcnt(11)
L_q77:
  s_waitcnt vmcnt(12)
  buffer_load_dwordx4 v[76:79], v214, s[36:39], 0 offen nt
  v_add_f32_dpp v21, v18, v18 row_ror:8 row_mask:0xf bank_mask:0xc
  v_add_f32_dpp v21, v20, v20 row_ror:8 row_mask:0xf bank_mask:0x3
  v_add_f32_dpp v20, v34, v34 row_half_mirror row_mask:0xf bank_mask:0x5
  s_nop 0
  v_add_f32_dpp v20, v21, v21 row_half_mirror row_mask:0xf bank_mask:0xa
  s_nop 1
  v_add_f32_dpp v20, v20, v20 quad_perm:[2,3,0,1] row_mask:0xf bank_mask:0xf
  s_nop 1
  v_add_f32_dpp v20, v20, v20 quad_perm:[1,0,3,2] row_mask:0xf bank_mask:0xf
  v_cndmask_b32_e64 v32, v32, v20, s[48:49]
  ds_read_b32 v4, v14 offset:16
  s_waitcnt vmcnt(9)
  s_add_u32 s44, s78, 0x03030303
  v_msad_u8 v9, s78, v36, 0
  v_msad_u8 v10, s44, v36, 0
  v_msad_u8 v9, s78, v37, v9
  v_msad_u8 v10, s44, v37, v10
  v_msad_u8 v9, s78, v38, v9
  v_msad_u8 v10, s44, v38, v10
  v_sub_u32 v9, v9, v10
  v_mov_b32 v8, s90
  s_add_u32 s78, s78, 0x01010101
  v_readlane_b32 s66, v9, 0
  v_readlane_b32 s67, v9, 1
  s_mov_b64 exec, 1
  global_store_byte v7, v8, s[30:31]
  s_mov_b64 exec, 3
  global_load_dwordx3 v[36:38], v238, s[30:31] sc1
  s_mov_b64 exec, -1
  s_add_u32 s69, s66, s67
  s_add_u32 s44, s69, s95
  s_mov_b32 s95, s69
  s_ashr_i32 s69, s44, 1
  s_add_u32 s69, s69, s91
  s_cmp_lt_u32 s90, 5
  s_cselect_b32 s69, 0, s69
  s_add_u32 s90, s90, 1
  v_dot2_f32_bf16 v22, v185, v44, 0
  v_dot2_f32_bf16 v23, v190, v45, 0
  v_dot2_f32_bf16 v24, v188, v46, 0
  v_dot2_f32_bf16 v25, v191, v47, 0
  v_cvt_f32_i32 v92, v92
  v_cvt_f32_i32 v93, v93
  v_cvt_f32_i32 v94, v94
  v_cvt_f32_i32 v95, v95
  v_pk_mul_f32 v[20:21], v[92:93], v[22:23]
  v_pk_add_f32 v[18:19], v[22:23], v[24:25]
  v_pk_fma_f32 v[20:21], v[94:95], v[24:25], v[20:21]
  v_add_f32 v18, v18, v19
  v_add_f32 v20, v20, v21
  s_cmp_gt_i32 s69, 17
  s_cbranch_scc1 L_q78
  s_cmp_gt_i32 s69, -13
  s_cbranch_scc1 L_p78
  s_waitcnt vmcnt(5)
L_p78:
  s_waitcnt vmcnt(9)
L_q78:
  s_waitcnt vmcnt(10)
  buffer_load_dwordx4 v[80:83], v215, s[36:39], 0 offen nt
  v_add_f32_dpp v34, v18, v18 row_ror:8 row_mask:0xf bank_mask:0xc
  v_add_f32_dpp v34, v20, v20 row_ror:8 row_mask:0xf bank_mask:0x3
  v_dot2_f32_bf16 v22, v189, v48, 0
  v_dot2_f32_bf16 v23, v194, v49, 0
  v_dot2_f32_bf16 v24, v192, v50, 0
  v_dot2_f32_bf16 v25, v195, v51, 0
  v_cvt_f32_i32 v96, v96
  v_cvt_f32_i32 v97, v97
  v_cvt_f32_i32 v98, v98
  v_cvt_f32_i32 v99, v99
  v_pk_mul_f32 v[20:21], v[96:97], v[22:23]
  v_pk_add_f32 v[18:19], v[22:23], v[24:25]
  v_pk_fma_f32 v[20:21], v[98:99], v[24:25], v[20:21]
  v_add_f32 v18, v18, v19
  v_add_f32 v20, v20, v21
  s_cmp_gt_i32 s69, 17
  s_cbranch_scc1 L_q79
  s_cmp_gt_i32 s69, 2
  s_cbranch_scc1 L_p79
  s_waitcnt vmcnt(6)
L_p79:
  s_waitcnt vmcnt(10)
L_q79:
  s_waitcnt vmcnt(11)
  buffer_load_dwordx4 v[84:87], v216, s[36:39], 0 offen nt
  v_add_f32_dpp v21, v18, v18 row_ror:8 row_mask:0xf bank_mask:0xc
  v_add_f32_dpp v21, v20, v20 row_ror:8 row_mask:0xf bank_mask:0x3
  v_add_f32_dpp v20, v34, v34 row_half_mirror row_mask:0xf bank_mask:0x5
  s_nop 0
  v_add_f32_dpp v20, v21, v21 row_half_mirror row_mask:0xf bank_mask:0xa
  s_nop 1
  v_add_f32_dpp v20, v20, v20 quad_perm:[2,3,0,1] row_mask:0xf bank_mask:0xf
  s_nop 1
  v_add_f32_dpp v20, v20, v20 quad_perm:[1,0,3,2] row_mask:0xf bank_mask:0xf
  v_cndmask_b32_e64 v32, v32, v20, s[50:51]
  v_dot2_f32_bf16 v22, v193, v52, 0
  v_dot2_f32_bf16 v23, v198, v53, 0
  v_dot2_f32_bf16 v24, v196, v54, 0
  v_dot2_f32_bf16 v25, v199, v55, 0
  v_cvt_f32_i32 v100, v100
  v_cvt_f32_i32 v101, v101
  v_cvt_f32_i32 v102, v102
  v_cvt_f32_i32 v103, v103
  v_pk_mul_f32 v[20:21], v[100:101], v[22:23]
  v_pk_add_f32 v[18:19], v[22:23], v[24:25]
  v_pk_fma_f32 v[20:21], v[102:103], v[24:25], v[20:21]
  v_add_f32 v18, v18, v19
  v_add_f32 v20, v20, v21
  s_cmp_lt_i32 s69, -25
  s_cbranch_scc0 L_t80
  s_waitcnt vmcnt(6)
L_t80:
  s_cmp_gt_i32 s69, 17
  s_cbranch_scc1 L_q81
  s_cmp_gt_i32 s69, 9
  s_cbranch_scc1 L_p81
  s_waitcnt vmcnt(7)
L_p81:
  s_waitcnt vmcnt(11)
L_q81:
  s_waitcnt vmcnt(12)
  buffer_load_dwordx4 v[88:91], v217, s[36:39], 0 offen nt
  v_add_f32_dpp v34, v18, v18 row_ror:8 row_mask:0xf bank_mask:0xc
  v_add_f32_dpp v34, v20, v20 row_ror:8 row_mask:0xf bank_mask:0x3
L_qn:
  s_waitcnt lgkmcnt(0)
  v_readfirstlane_b32 s46, v4
  s_cmp_ge_u32 s46, s47
  s_cbranch_scc1 L_qn_ok
  s_cmp_eq_u32 s94, 0
  s_cbranch_scc1 L_qn_ok
  s_sub_u32 s94, s94, 1
  ds_read_b32 v4, v14 offset:16
  s_branch L_qn
L_qn_ok:
  s_waitcnt vmcnt(8)
  v_add3_u32 v9, v26, v27, s58
  s_nop 0
  v_readfirstlane_b32 s91, v9
  s_add_u32 s44, s78, 0x03030303
  v_msad_u8 v9, s78, v40, 0
  v_msad_u8 v10, s44, v40, 0
  v_msad_u8 v9, s78, v41, v9
  v_msad_u8 v10, s44, v41, v10
  v_msad_u8 v9, s78, v42, v9
  v_msad_u8 v10, s44, v42, v10
  v_sub_u32 v9, v9, v10
  v_mov_b32 v8, s90
  s_add_u32 s78, s78, 0x01010101
  v_readlane_b32 s66, v9, 0
  v_readlane_b32 s67, v9, 1
  s_mov_b64 exec, 1
  global_store_byte v7, v8, s[30:31]
  s_mov_b64 exec, 3
  global_load_dwordx3 v[40:42], v239, s[30:31] sc1
  s_mov_b64 exec, -1
  s_add_u32 s69, s66, s67
  s_add_u32 s44, s69, s95
  s_mov_b32 s95, s69
  s_ashr_i32 s69, s44, 1
  s_add_u32 s69, s69, s91
  s_cmp_lt_u32 s90, 5
  s_cselect_b32 s69, 0, s69
  s_add_u32 s90, s90, 1
  v_dot2_f32_bf16 v22, v197, v44, 0
  v_dot2_f32_bf16 v23, v202, v45, 0
  v_dot2_f32_bf16 v24, v200, v46, 0
  v_dot2_f32_bf16 v25, v203, v47, 0
  v_cvt_f32_i32 v104, v104
  v_cvt_f32_i32 v105, v105
  v_cvt_f32_i32 v106, v106
  v_cvt_f32_i32 v107, v107
  ds_read_b128 v[44:47], v15 offset:512
  v_pk_mul_f32 v[20:21], v[104:105], v[22:23]
  v_pk_add_f32 v[18:19], v[22:23], v[24:25]
  v_pk_fma_f32 v[20:21], v[106:107], v[24:25], v[20:21]
  v_add_f32 v18, v18, v19
  v_add_f32 v20, v20, v21
  s_cmp_gt_i32 s69, 17
  s_cbranch_scc1 L_q82
  s_cmp_gt_i32 s69, -13
  s_cbranch_scc1 L_p82
  s_waitcnt vmcnt(5)
L_p82:
  s_waitcnt vmcnt(8)
L_q82:
  s_waitcnt vmcnt(9)
  buffer_load_dwordx4 v[92:95], v218, s[36:39], 0 offen nt
  v_add_f32_dpp v21, v18, v18 row_ror:8 row_mask:0xf bank_mask:0xc
  v_add_f32_dpp v21, v20, v20 row_ror:8 row_mask:0xf bank_mask:0x3
  v_add_f32_dpp v20, v34, v34 row_half_mirror row_mask:0xf bank_mask:0x5
  s_nop 0
  v_add_f32_dpp v20, v21, v21 row_half_mirror row_mask:0xf bank_mask:0xa
  s_nop 1
  v_add_f32_dpp v20, v20, v20 quad_perm:[2,3,0,1] row_mask:0xf bank_mask:0xf
  s_nop 1
  v_add_f32_dpp v20, v20, v20 quad_perm:[1,0,3,2] row_mask:0xf bank_mask:0xf
  v_cndmask_b32_e64 v32, v32, v20, s[52:53]
  v_dot2_f32_bf16 v22, v201, v48, 0
  v_dot2_f32_bf16 v23, v206, v49, 0
  v_dot2_f32_bf16 v24, v204, v50, 0
  v_dot2_f32_bf16 v25, v207, v51, 0
  v_cvt_f32_i32 v108, v108
  v_cvt_f32_i32 v109, v109
  v_cvt_f32_i32 v110, v110
  v_cvt_f32_i32 v111, v111
  ds_read_b128 v[48:51], v16 offset:512
  v_pk_mul_f32 v[20:21], v[108:109], v[22:23]
  v_pk_add_f32 v[18:19], v[22:23], v[24:25]
  v_pk_fma_f32 v[20:21], v[110:111], v[24:25], v[20:21]
  v_add_f32 v18, v18, v19
  v_add_f32 v20, v20, v21
  s_cmp_gt_i32 s69, 17
  s_cbranch_scc1 L_q83
  s_cmp_gt_i32 s69, 2
  s_cbranch_scc1 L_p83
  s_waitcnt vmcnt(6)
L_p83:
  s_waitcnt vmcnt(9)
L_q83:
  s_waitcnt vmcnt(10)
  buffer_load_dwordx4 v[96:99], v219, s[36:39], 0 offen nt
  v_add_f32_dpp v34, v18, v18 row_ror:8 row_mask:0xf bank_mask:0xc
  v_add_f32_dpp v34, v20, v20 row_ror:8 row_mask:0xf bank_mask:0x3
  v_dot2_f32_bf16 v22, v205, v52, 0
  v_dot2_f32_bf16 v23, v210, v53, 0
  v_dot2_f32_bf16 v24, v208, v54, 0
  v_dot2_f32_bf16 v25, v211, v55, 0
  v_cvt_f32_i32 v112, v112
  v_cvt_f32_i32 v113, v113
  v_cvt_f32_i32 v114, v114
  v_cvt_f32_i32 v115, v115
  ds_read_b128 v[52:55], v17 offset:512
  v_pk_mul_f32 v[20:21], v[112:113], v[22:23]
  v_pk_add_f32 v[18:19], v[22:23], v[24:25]
  v_pk_fma_f32 v[20:21], v[114:115], v[24:25], v[20:21]
  v_add_f32 v18, v18, v19
  v_add_f32 v20, v20, v21
  s_cmp_lt_i32 s69, -25
  s_cbranch_scc0 L_t84
  s_waitcnt vmcnt(6)
L_t84:
  s_cmp_gt_i32 s69, 17
  s_cbranch_scc1 L_q85
  s_cmp_gt_i32 s69, 9
  s_cbranch_scc1 L_p85
  s_waitcnt vmcnt(7)
L_p85:
  s_waitcnt vmcnt(10)
L_q85:
  s_waitcnt vmcnt(11)
  buffer_load_dwordx4 v[100:103], v220, s[36:39], 0 offen nt
  v_add_f32_dpp v21, v18, v18 row_ror:8 row_mask:0xf bank_mask:0xc
  v_add_f32_dpp v21, v20, v20 row_ror:8 row_mask:0xf bank_mask:0x3
  v_add_f32_dpp v20, v34, v34 row_half_mirror row_mask:0xf bank_mask:0x5
  s_nop 0
  v_add_f32_dpp v20, v21, v21 row_half_mirror row_mask:0xf bank_mask:0xa
  s_nop 1
  v_add_f32_dpp v20, v20, v20 quad_perm:[2,3,0,1] row_mask:0xf bank_mask:0xf
  s_nop 1
  v_add_f32_dpp v20, v20, v20 quad_perm:[1,0,3,2] row_mask:0xf bank_mask:0xf
  v_cndmask_b32_e64 v32, v32, v20, s[54:55]
  ds_write_b32 v2, v32 offset:1024
  s_add_u32 s43, s43, 1
  v_mov_b32 v4, s43
  ds_write_b32 v6, v4 offset:0
  s_mov_b64 s[32:33], s[36:37]
  s_add_u32 s68, s43, 1
  s_sub_u32 s45, s68, 16
  s_lshl_b32 s46, s45, 2
  s_lshr_b64 s[64:65], s[92:93], s46
  s_and_b32 s46, s64, 15
  s_cmp_lt_u32 s68, 16
  s_cselect_b32 s68, s68, s46
  s_cselect_b32 s70, s6, s12
  s_cselect_b32 s71, s7, s13
  s_lshl_b32 s44, s68, 2
  s_lshr_b64 s[64:65], s[96:97], s44
  s_and_b32 s64, s64, 15
  s_lshl4_add_u32 s68, s68, s64
  s_mul_i32 s44, s68, 1572864
  s_add_u32 s36, s70, s44
  s_addc_u32 s37, s71, 0
  s_cmp_lt_u32 s43, 16
  s_cbranch_scc1 L_k
L_vpre:
  v_lshrrev_b32 v116, 4, v0
  v_and_b32 v119, 15, v0
  v_and_or_b32 v120, v0, 7, 16
  v_lshl_add_u32 v119, v119, 4, v116
  v_mul_u32_u24 v119, 683, v119
  v_lshrrev_b32 v119, 11, v119
  v_lshlrev_b32 v119, 2, v119
  v_lshl_add_u32 v120, v120, 4, v116
  v_mul_u32_u24 v120, 683, v120
  v_lshrrev_b32 v120, 11, v120
  v_lshlrev_b32 v120, 2, v120
  s_mov_b64 vcc, 0
  s_mov_b32 s43, 0
  s_lshl_b32 s68, s43, 2
  s_lshr_b64 s[64:65], s[92:93], s68
  s_and_b32 s68, s64, 15
  s_add_u32 s47, s68, 1
  ds_read_b32 v4, v14 offset:20
L_a0:
  s_waitcnt lgkmcnt(0)
  v_readfirstlane_b32 s46, v4
  s_cmp_ge_u32 s46, s47
  s_cbranch_scc1 L_a0_ok
  s_cmp_eq_u32 s94, 0
  s_cbranch_scc1 L_a0_ok
  s_sub_u32 s94, s94, 1
  ds_read_b32 v4, v14 offset:20
  s_branch L_a0
L_a0_ok:
  v_lshl_add_u32 v121, s68, 9, v119
  v_lshl_add_u32 v122, s68, 9, v120
  ds_read_b32 v116, v121 offset:37376
  ds_read_b32 v117, v122 offset:37376
.p2align 6
L_v:
  s_add_u32 s45, s43, 1
  s_min_u32 s45, s45, 15
  s_lshl_b32 s68, s45, 2
  s_lshr_b64 s[64:65], s[92:93], s68
  s_and_b32 s68, s64, 15
  s_add_u32 s47, s68, 1
  v_lshl_add_u32 v121, s68, 9, v119
  v_lshl_add_u32 v122, s68, 9, v120
  s_waitcnt lgkmcnt(0)
  s_waitcnt vmcnt(8)
  s_add_u32 s44, s78, 0x03030303
  v_msad_u8 v9, s78, v36, 0
  v_msad_u8 v10, s44, v36, 0
  v_msad_u8 v9, s78, v37, v9
  v_msad_u8 v10, s44, v37, v10
  v_msad_u8 v9, s78, v38, v9
  v_msad_u8 v10, s44, v38, v10
  v_sub_u32 v9, v9, v10
  v_mov_b32 v8, s90
  s_add_u32 s78, s78, 0x01010101
  v_readlane_b32 s66, v9, 0
  v_readlane_b32 s67, v9, 1
  s_mov_b64 exec, 1
  global_store_byte v7, v8, s[30:31]
  s_mov_b64 exec, 3
  global_load_dwordx3 v[36:38], v236, s[30:31] sc1
  s_mov_b64 exec, -1
  s_add_u32 s69, s66, s67
  s_add_u32 s44, s69, s95
  s_mov_b32 s95, s69
  s_ashr_i32 s69, s44, 1
  s_add_u32 s69, s69, s91
  s_cmp_lt_u32 s90, 5
  s_cselect_b32 s69, 0, s69
  s_add_u32 s90, s90, 1
  v_mov_b32_dpp v18, v116 row_newbcast:0 row_mask:0xf bank_mask:0xf
  v_cvt_f32_i32 v68, v68
  v_cvt_f32_i32 v69, v69
  v_cvt_f32_i32 v70, v70
  v_cvt_f32_i32 v71, v71
  v_pk_mul_f32 v[44:45], v[68:69], v[18:19] op_sel_hi:[1,0]
  v_pk_mul_f32 v[46:47], v[70:71], v[18:19] op_sel_hi:[1,0]
  s_cmp_gt_i32 s69, 17
  s_cbranch_scc1 L_q86
  s_cmp_gt_i32 s69, -10
  s_cbranch_scc1 L_p86
  s_waitcnt vmcnt(5)
L_p86:
  s_waitcnt vmcnt(8)
L_q86:
  s_waitcnt vmcnt(9)
  buffer_load_dwordx4 v[104:107], v221, s[32:35], 0 offen nt
  v_mov_b32_dpp v18, v116 row_newbcast:1 row_mask:0xf bank_mask:0xf
  v_cvt_f32_i32 v72, v72
  v_cvt_f32_i32 v73, v73
  v_cvt_f32_i32 v74, v74
  v_cvt_f32_i32 v75, v75
  v_pk_mul_f32 v[48:49], v[72:73], v[18:19] op_sel_hi:[1,0]
  v_pk_mul_f32 v[50:51], v[74:75], v[18:19] op_sel_hi:[1,0]
  s_cmp_gt_i32 s69, 17
  s_cbranch_scc1 L_q87
  s_cmp_gt_i32 s69, 5
  s_cbranch_scc1 L_p87
  s_waitcnt vmcnt(6)
L_p87:
  s_waitcnt vmcnt(9)
L_q87:
  s_waitcnt vmcnt(10)
  buffer_load_dwordx4 v[108:111], v222, s[32:35], 0 offen nt
  v_mov_b32_dpp v18, v116 row_newbcast:2 row_mask:0xf bank_mask:0xf
  v_cvt_f32_i32 v76, v76
  v_cvt_f32_i32 v77, v77
  v_cvt_f32_i32 v78, v78
  v_cvt_f32_i32 v79, v79
  v_pk_mul_f32 v[52:53], v[76:77], v[18:19] op_sel_hi:[1,0]
  v_pk_mul_f32 v[54:55], v[78:79], v[18:19] op_sel_hi:[1,0]
  s_cmp_lt_i32 s69, -25
  s_cbranch_scc0 L_t88
  s_waitcnt vmcnt(6)
L_t88:
  s_cmp_gt_i32 s69, 17
  s_cbranch_scc1 L_q89
  s_cmp_gt_i32 s69, 12
  s_cbranch_scc1 L_p89
  s_waitcnt vmcnt(7)
L_p89:
  s_waitcnt vmcnt(10)
L_q89:
  s_waitcnt vmcnt(11)
  buffer_load_dwordx4 v[112:115], v223, s[32:35], 0 offen nt
  s_waitcnt vmcnt(8)
  s_add_u32 s44, s78, 0x03030303
  v_msad_u8 v9, s78, v40, 0
  v_msad_u8 v10, s44, v40, 0
  v_msad_u8 v9, s78, v41, v9
  v_msad_u8 v10, s44, v41, v10
  v_msad_u8 v9, s78, v42, v9
  v_msad_u8 v10, s44, v42, v10
  v_sub_u32 v9, v9, v10
  v_mov_b32 v8, s90
  s_add_u32 s78, s78, 0x01010101
  v_readlane_b32 s66, v9, 0
  v_readlane_b32 s67, v9, 1
  s_mov_b64 exec, 1
  global_store_byte v7, v8, s[30:31]
  s_mov_b64 exec, 3
  global_load_dwordx3 v[40:42], v237, s[30:31] sc1
  s_mov_b64 exec, -1
  s_add_u32 s69, s66, s67
  s_add_u32 s44, s69, s95
  s_mov_b32 s95, s69
  s_ashr_i32 s69, s44, 1
  s_add_u32 s69, s69, s91
  s_cmp_lt_u32 s90, 5
  s_cselect_b32 s69, 0, s69
  s_add_u32 s90, s90, 1
  v_mov_b32_dpp v18, v116 row_newbcast:3 row_mask:0xf bank_mask:0xf
  v_cvt_f32_i32 v80, v80
  v_cvt_f32_i32 v81, v81
  v_cvt_f32_i32 v82, v82
  v_cvt_f32_i32 v83, v83
  v_pk_fma_f32 v[44:45], v[80:81], v[18:19], v[44:45] op_sel_hi:[1,0,1]
  v_pk_fma_f32 v[46:47], v[82:83], v[18:19], v[46:47] op_sel_hi:[1,0,1]
  s_cmp_gt_i32 s69, 17
  s_cbranch_scc1 L_q90
  s_cmp_gt_i32 s69, -10
  s_cbranch_scc1 L_p90
  s_waitcnt vmcnt(5)
L_p90:
  s_waitcnt vmcnt(8)
L_q90:
  s_waitcnt vmcnt(9)
  buffer_load_dwordx4 v[68:71], v224, s[32:35], 0 offen nt
  v_mov_b32_dpp v18, v116 row_newbcast:4 row_mask:0xf bank_mask:0xf
  v_cvt_f32_i32 v84, v84
  v_cvt_f32_i32 v85, v85
  v_cvt_f32_i32 v86, v86
  v_cvt_f32_i32 v87, v87
  v_pk_fma_f32 v[48:49], v[84:85], v[18:19], v[48:49] op_sel_hi:[1,0,1]
  v_pk_fma_f32 v[50:51], v[86:87], v[18:19], v[50:51] op_sel_hi:[1,0,1]
  s_cmp_gt_i32 s69, 17
  s_cbranch_scc1 L_q91
  s_cmp_gt_i32 s69, 5
  s_cbranch_scc1 L_p91
  s_waitcnt vmcnt(6)
L_p91:
  s_waitcnt vmcnt(9)
L_q91:
  s_waitcnt vmcnt(10)
  buffer_load_dwordx4 v[72:75], v225, s[32:35], 0 offen nt
  v_mov_b32_dpp v18, v116 row_newbcast:5 row_mask:0xf bank_mask:0xf
  v_cvt_f32_i32 v88, v88
  v_cvt_f32_i32 v89, v89
  v_cvt_f32_i32 v90, v90
  v_cvt_f32_i32 v91, v91
  v_pk_fma_f32 v[52:53], v[88:89], v[18:19], v[52:53] op_sel_hi:[1,0,1]
  v_pk_fma_f32 v[54:55], v[90:91], v[18:19], v[54:55] op_sel_hi:[1,0,1]
  s_cmp_lt_i32 s69, -25
  s_cbranch_scc0 L_t92
  s_waitcnt vmcnt(6)
L_t92:
  s_cmp_gt_i32 s69, 17
  s_cbranch_scc1 L_q93
  s_cmp_gt_i32 s69, 12
  s_cbranch_scc1 L_p93
  s_waitcnt vmcnt(7)
L_p93:
  s_waitcnt vmcnt(10)
L_q93:
  s_waitcnt vmcnt(11)
  buffer_load_dwordx4 v[76:79], v226, s[32:35], 0 offen nt
  s_waitcnt vmcnt(8)
  s_add_u32 s44, s78, 0x03030303
  v_msad_u8 v9, s78, v36, 0
  v_msad_u8 v10, s44, v36, 0
  v_msad_u8 v9, s78, v37, v9
  v_msad_u8 v10, s44, v37, v10
  v_msad_u8 v9, s78, v38, v9
  v_msad_u8 v10, s44, v38, v10
  v_sub_u32 v9, v9, v10
  v_mov_b32 v8, s90
  s_add_u32 s78, s78, 0x01010101
  v_readlane_b32 s66, v9, 0
  v_readlane_b32 s67, v9, 1
  s_mov_b64 exec, 1
  global_store_byte v7, v8, s[30:31]
  s_mov_b64 exec, 3
  global_load_dwordx3 v[36:38], v238, s[30:31] sc1
  s_mov_b64 exec, -1
  s_add_u32 s69, s66, s67
  s_add_u32 s44, s69, s95
  s_mov_b32 s95, s69
  s_ashr_i32 s69, s44, 1
  s_add_u32 s69, s69, s91
  s_cmp_lt_u32 s90, 5
  s_cselect_b32 s69, 0, s69
  s_add_u32 s90, s90, 1
  v_mov_b32_dpp v18, v116 row_newbcast:6 row_mask:0xf bank_mask:0xf
  v_cvt_f32_i32 v92, v92
  v_cvt_f32_i32 v93, v93
  v_cvt_f32_i32 v94, v94
  v_cvt_f32_i32 v95, v95
  v_pk_fma_f32 v[44:45], v[92:93], v[18:19], v[44:45] op_sel_hi:[1,0,1]
  v_pk_fma_f32 v[46:47], v[94:95], v[18:19], v[46:47] op_sel_hi:[1,0,1]
  s_cmp_gt_i32 s69, 17
  s_cbranch_scc1 L_q94
  s_cmp_gt_i32 s69, -10
  s_cbranch_scc1 L_p94
  s_waitcnt vmcnt(5)
L_p94:
  s_waitcnt vmcnt(8)
L_q94:
  s_waitcnt vmcnt(9)
  buffer_load_dwordx4 v[80:83], v227, s[32:35], 0 offen nt
  v_mov_b32 v9, s43
  ds_write_b32 v14, v9 offset:28
  v_mov_b32_dpp v18, v116 row_newbcast:7 row_mask:0xf bank_mask:0xf
  v_cvt_f32_i32 v96, v96
  v_cvt_f32_i32 v97, v97
  v_cvt_f32_i32 v98, v98
  v_cvt_f32_i32 v99, v99
  v_pk_fma_f32 v[48:49], v[96:97], v[18:19], v[48:49] op_sel_hi:[1,0,1]
  v_pk_fma_f32 v[50:51], v[98:99], v[18:19], v[50:51] op_sel_hi:[1,0,1]
  s_cmp_gt_i32 s69, 17
  s_cbranch_scc1 L_q95
  s_cmp_gt_i32 s69, 5
  s_cbranch_scc1 L_p95
  s_waitcnt vmcnt(6)
L_p95:
  s_waitcnt vmcnt(9)
L_q95:
  s_waitcnt vmcnt(10)
  buffer_load_dwordx4 v[84:87], v228, s[32:35], 0 offen nt
  v_mov_b32_dpp v18, v116 row_newbcast:8 row_mask:0xf bank_mask:0xf
  v_cvt_f32_i32 v100, v100
  v_cvt_f32_i32 v101, v101
  v_cvt_f32_i32 v102, v102
  v_cvt_f32_i32 v103, v103
  v_pk_fma_f32 v[52:53], v[100:101], v[18:19], v[52:53] op_sel_hi:[1,0,1]
  v_pk_fma_f32 v[54:55], v[102:103], v[18:19], v[54:55] op_sel_hi:[1,0,1]
  s_cmp_lt_i32 s69, -25
  s_cbranch_scc0 L_t96
  s_waitcnt vmcnt(6)
L_t96:
  s_cmp_gt_i32 s69, 17
  s_cbranch_scc1 L_q97
  s_cmp_gt_i32 s69, 12
  s_cbranch_scc1 L_p97
  s_waitcnt vmcnt(7)
L_p97:
  s_waitcnt vmcnt(10)
L_q97:
  s_waitcnt vmcnt(11)
  buffer_load_dwordx4 v[88:91], v229, s[32:35], 0 offen nt
  s_waitcnt vmcnt(8)
  s_add_u32 s44, s78, 0x03030303
  v_msad_u8 v9, s78, v40, 0
  v_msad_u8 v10, s44, v40, 0
  v_msad_u8 v9, s78, v41, v9
  v_msad_u8 v10, s44, v41, v10
  v_msad_u8 v9, s78, v42, v9
  v_msad_u8 v10, s44, v42, v10
  v_sub_u32 v9, v9, v10
  v_mov_b32 v8, s90
  s_add_u32 s78, s78, 0x01010101
  v_readlane_b32 s66, v9, 0
  v_readlane_b32 s67, v9, 1
  s_mov_b64 exec, 1
  global_store_byte v7, v8, s[30:31]
  s_mov_b64 exec, 3
  global_load_dwordx3 v[40:42], v239, s[30:31] sc1
  s_mov_b64 exec, -1
  s_add_u32 s69, s66, s67
  s_add_u32 s44, s69, s95
  s_mov_b32 s95, s69
  s_ashr_i32 s69, s44, 1
  s_add_u32 s69, s69, s91
  s_cmp_lt_u32 s90, 5
  s_cselect_b32 s69, 0, s69
  s_add_u32 s90, s90, 1
  v_mov_b32_dpp v18, v116 row_newbcast:9 row_mask:0xf bank_mask:0xf
  v_cvt_f32_i32 v104, v104
  v_cvt_f32_i32 v105, v105
  v_cvt_f32_i32 v106, v106
  v_cvt_f32_i32 v107, v107
  v_pk_fma_f32 v[44:45], v[104:105], v[18:19], v[44:45] op_sel_hi:[1,0,1]
  v_pk_fma_f32 v[46:47], v[106:107], v[18:19], v[46:47] op_sel_hi:[1,0,1]
  s_cmp_gt_i32 s69, 17
  s_cbranch_scc1 L_q98
  s_cmp_gt_i32 s69, -10
  s_cbranch_scc1 L_p98
  s_waitcnt vmcnt(5)
L_p98:
  s_waitcnt vmcnt(8)
L_q98:
  s_waitcnt vmcnt(9)
  buffer_load_dwordx4 v[92:95], v230, s[32:35], 0 offen nt
  v_mov_b32_dpp v18, v116 row_newbcast:10 row_mask:0xf bank_mask:0xf
  v_cvt_f32_i32 v108, v108
  v_cvt_f32_i32 v109, v109
  v_cvt_f32_i32 v110, v110
  v_cvt_f32_i32 v111, v111
  v_pk_fma_f32 v[48:49], v[108:109], v[18:19], v[48:49] op_sel_hi:[1,0,1]
  v_pk_fma_f32 v[50:51], v[110:111], v[18:19], v[50:51] op_sel_hi:[1,0,1]
  s_cmp_gt_i32 s69, 17
  s_cbranch_scc1 L_q99
  s_cmp_gt_i32 s69, 5
  s_cbranch_scc1 L_p99
  s_waitcnt vmcnt(6)
L_p99:
  s_waitcnt vmcnt(9)
L_q99:
  s_waitcnt vmcnt(10)
  buffer_load_dwordx4 v[96:99], v231, s[32:35], 0 offen nt
  v_mov_b32_dpp v18, v116 row_newbcast:11 row_mask:0xf bank_mask:0xf
  v_cvt_f32_i32 v112, v112
  v_cvt_f32_i32 v113, v113
  v_cvt_f32_i32 v114, v114
  v_cvt_f32_i32 v115, v115
  v_pk_fma_f32 v[52:53], v[112:113], v[18:19], v[52:53] op_sel_hi:[1,0,1]
  v_pk_fma_f32 v[54:55], v[114:115], v[18:19], v[54:55] op_sel_hi:[1,0,1]
  s_cmp_lt_i32 s69, -25
  s_cbranch_scc0 L_t100
  s_waitcnt vmcnt(6)
L_t100:
  s_cmp_gt_i32 s69, 17
  s_cbranch_scc1 L_q101
  s_cmp_gt_i32 s69, 12
  s_cbranch_scc1 L_p101
  s_waitcnt vmcnt(7)
L_p101:
  s_waitcnt vmcnt(10)
L_q101:
  s_waitcnt vmcnt(11)
  buffer_load_dwordx4 v[100:103], v232, s[32:35], 0 offen nt
  s_waitcnt vmcnt(8)
  s_add_u32 s44, s78, 0x03030303
  v_msad_u8 v9, s78, v36, 0
  v_msad_u8 v10, s44, v36, 0
  v_msad_u8 v9, s78, v37, v9
  v_msad_u8 v10, s44, v37, v10
  v_msad_u8 v9, s78, v38, v9
  v_msad_u8 v10, s44, v38, v10
  v_sub_u32 v9, v9, v10
  v_mov_b32 v8, s90
  s_add_u32 s78, s78, 0x01010101
  v_readlane_b32 s66, v9, 0
  v_readlane_b32 s67, v9, 1
  s_mov_b64 exec, 1
  global_store_byte v7, v8, s[30:31]
  s_mov_b64 exec, 3
  global_load_dwordx3 v[36:38], v236, s[30:31] sc1
  s_mov_b64 exec, -1
  s_add_u32 s69, s66, s67
  s_add_u32 s44, s69, s95
  s_mov_b32 s95, s69
  s_ashr_i32 s69, s44, 1
  s_add_u32 s69, s69, s91
  s_cmp_lt_u32 s90, 5
  s_cselect_b32 s69, 0, s69
  s_add_u32 s90, s90, 1
  v_mov_b32_dpp v18, v116 row_newbcast:12 row_mask:0xf bank_mask:0xf
  v_cvt_f32_i32 v68, v68
  v_cvt_f32_i32 v69, v69
  v_cvt_f32_i32 v70, v70
  v_cvt_f32_i32 v71, v71
  v_pk_fma_f32 v[44:45], v[68:69], v[18:19], v[44:45] op_sel_hi:[1,0,1]
  v_pk_fma_f32 v[46:47], v[70:71], v[18:19], v[46:47] op_sel_hi:[1,0,1]
  s_cmp_gt_i32 s69, 17
  s_cbranch_scc1 L_q102
  s_cmp_gt_i32 s69, -10
  s_cbranch_scc1 L_p102
  s_waitcnt vmcnt(5)
L_p102:
  s_waitcnt vmcnt(8)
L_q102:
  s_waitcnt vmcnt(9)
  buffer_load_dwordx4 v[104:107], v233, s[32:35], 0 offen nt
  v_mov_b32_dpp v18, v116 row_newbcast:13 row_mask:0xf bank_mask:0xf
  v_cvt_f32_i32 v72, v72
  v_cvt_f32_i32 v73, v73
  v_cvt_f32_i32 v74, v74
  v_cvt_f32_i32 v75, v75
  v_pk_fma_f32 v[48:49], v[72:73], v[18:19], v[48:49] op_sel_hi:[1,0,1]
  v_pk_fma_f32 v[50:51], v[74:75], v[18:19], v[50:51] op_sel_hi:[1,0,1]
  s_cmp_gt_i32 s69, 17
  s_cbranch_scc1 L_q103
  s_cmp_gt_i32 s69, 5
  s_cbranch_scc1 L_p103
  s_waitcnt vmcnt(6)
L_p103:
  s_waitcnt vmcnt(9)
L_q103:
  s_waitcnt vmcnt(10)
  buffer_load_dwordx4 v[108:111], v234, s[32:35], 0 offen nt
  v_mov_b32_dpp v18, v116 row_newbcast:14 row_mask:0xf bank_mask:0xf
  v_cvt_f32_i32 v76, v76
  v_cvt_f32_i32 v77, v77
  v_cvt_f32_i32 v78, v78
  v_cvt_f32_i32 v79, v79
  v_pk_fma_f32 v[52:53], v[76:77], v[18:19], v[52:53] op_sel_hi:[1,0,1]
  v_pk_fma_f32 v[54:55], v[78:79], v[18:19], v[54:55] op_sel_hi:[1,0,1]
  s_cmp_lt_i32 s69, -25
  s_cbranch_scc0 L_t104
  s_waitcnt vmcnt(6)
L_t104:
  s_cmp_gt_i32 s69, 17
  s_cbranch_scc1 L_q105
  s_cmp_gt_i32 s69, 12
  s_cbranch_scc1 L_p105
  s_waitcnt vmcnt(7)
L_p105:
  s_waitcnt vmcnt(10)
L_q105:
  s_waitcnt vmcnt(11)
  buffer_load_dwordx4 v[112:115], v235, s[32:35], 0 offen nt
  ds_read_b32 v4, v14 offset:20
  s_cbranch_vccz L_in
  s_waitcnt vmcnt(10)
L_in:
  s_cbranch_vccnz L_c15
  s_mov_b64 exec, 1
  global_load_dwordx2 v[26:27], v11, s[30:31] sc1
  s_mov_b64 exec, -1
  s_waitcnt vmcnt(9)
  s_add_u32 s44, s78, 0x03030303
  v_msad_u8 v9, s78, v40, 0
  v_msad_u8 v10, s44, v40, 0
  v_msad_u8 v9, s78, v41, v9
  v_msad_u8 v10, s44, v41, v10
  v_msad_u8 v9, s78, v42, v9
  v_msad_u8 v10, s44, v42, v10
  v_sub_u32 v9, v9, v10
  v_mov_b32 v8, s90
  s_add_u32 s78, s78, 0x01010101
  v_readlane_b32 s66, v9, 0
  v_readlane_b32 s67, v9, 1
  s_mov_b64 exec, 1
  global_store_byte v7, v8, s[30:31]
  s_mov_b64 exec, 3
  global_load_dwordx3 v[40:42], v237, s[30:31] sc1
  s_mov_b64 exec, -1
  s_add_u32 s69, s66, s67
  s_add_u32 s44, s69, s95
  s_mov_b32 s95, s69
  s_ashr_i32 s69, s44, 1
  s_add_u32 s69, s69, s91
  s_cmp_lt_u32 s90, 5
  s_cselect_b32 s69, 0, s69
  s_add_u32 s90, s90, 1
L_c15:
  v_mov_b32_dpp v18, v116 row_newbcast:15 row_mask:0xf bank_mask:0xf
  v_cvt_f32_i32 v80, v80
  v_cvt_f32_i32 v81, v81
  v_cvt_f32_i32 v82, v82
  v_cvt_f32_i32 v83, v83
  v_pk_fma_f32 v[44:45], v[80:81], v[18:19], v[44:45] op_sel_hi:[1,0,1]
  v_pk_fma_f32 v[46:47], v[82:83], v[18:19], v[46:47] op_sel_hi:[1,0,1]
  s_cbranch_vccz L_f15
  s_waitcnt vmcnt(9)
  s_branch L_g15
L_f15:
  s_cmp_gt_i32 s69, 17
  s_cbranch_scc1 L_q106
  s_cmp_gt_i32 s69, -10
  s_cbranch_scc1 L_p106
  s_waitcnt vmcnt(6)
L_p106:
  s_waitcnt vmcnt(9)
L_q106:
  s_waitcnt vmcnt(10)
  buffer_load_dwordx4 v[68:71], v212, s[36:39], 0 offen nt
L_g15:
  v_mov_b32_dpp v18, v117 row_newbcast:0 row_mask:0xf bank_mask:0xf
  v_cvt_f32_i32 v84, v84
  v_cvt_f32_i32 v85, v85
  v_cvt_f32_i32 v86, v86
  v_cvt_f32_i32 v87, v87
  v_pk_fma_f32 v[48:49], v[84:85], v[18:19], v[48:49] op_sel_hi:[1,0,1]
  v_pk_fma_f32 v[50:51], v[86:87], v[18:19], v[50:51] op_sel_hi:[1,0,1]
  s_cbranch_vccz L_f16
  s_waitcnt vmcnt(8)
  s_branch L_g16
L_f16:
  s_cmp_gt_i32 s69, 17
  s_cbranch_scc1 L_q107
  s_cmp_gt_i32 s69, 5
  s_cbranch_scc1 L_p107
  s_waitcnt vmcnt(7)
L_p107:
  s_waitcnt vmcnt(10)
L_q107:
  s_waitcnt vmcnt(11)
  buffer_load_dwordx4 v[72:75], v213, s[36:39], 0 offen nt
L_g16:
  v_mov_b32_dpp v18, v117 row_newbcast:1 row_mask:0xf bank_mask:0xf
  v_cvt_f32_i32 v88, v88
  v_cvt_f32_i32 v89, v89
  v_cvt_f32_i32 v90, v90
  v_cvt_f32_i32 v91, v91
  v_pk_fma_f32 v[52:53], v[88:89], v[18:19], v[52:53] op_sel_hi:[1,0,1]
  v_pk_fma_f32 v[54:55], v[90:91], v[18:19], v[54:55] op_sel_hi:[1,0,1]
  s_cbranch_vccz L_f17
  s_waitcnt vmcnt(6)
  s_branch L_g17
L_f17:
  s_cmp_lt_i32 s69, -25
  s_cbranch_scc0 L_t108
  s_waitcnt vmcnt(7)
L_t108:
  s_cmp_gt_i32 s69, 17
  s_cbranch_scc1 L_q109
  s_cmp_gt_i32 s69, 12
  s_cbranch_scc1 L_p109
  s_waitcnt vmcnt(8)
L_p109:
  s_waitcnt vmcnt(11)
L_q109:
  s_waitcnt vmcnt(12)
  buffer_load_dwordx4 v[76:79], v214, s[36:39], 0 offen nt
L_g17:
L_an:
  s_waitcnt lgkmcnt(0)
  v_readfirstlane_b32 s46, v4
  s_cmp_ge_u32 s46, s47
  s_cbranch_scc1 L_an_ok
  s_cmp_eq_u32 s94, 0
  s_cbranch_scc1 L_an_ok
  s_sub_u32 s94, s94, 1
  ds_read_b32 v4, v14 offset:20
  s_branch L_an
L_an_ok:
  ds_read_b32 v116, v121 offset:37376
  ds_read_b32 v118, v122 offset:37376
  s_cbranch_vccnz L_c18
  s_waitcnt vmcnt(9)
  s_add_u32 s44, s78, 0x03030303
  v_msad_u8 v9, s78, v36, 0
  v_msad_u8 v10, s44, v36, 0
  v_msad_u8 v9, s78, v37, v9
  v_msad_u8 v10, s44, v37, v10
  v_msad_u8 v9, s78, v38, v9
  v_msad_u8 v10, s44, v38, v10
  v_sub_u32 v9, v9, v10
  v_mov_b32 v8, s90
  s_add_u32 s78, s78, 0x01010101
  v_readlane_b32 s66, v9, 0
  v_readlane_b32 s67, v9, 1
  s_mov_b64 exec, 1
  global_store_byte v7, v8, s[30:31]
  s_mov_b64 exec, 3
  global_load_dwordx3 v[36:38], v238, s[30:31] sc1
  s_mov_b64 exec, -1
  s_add_u32 s69, s66, s67
  s_add_u32 s44, s69, s95
  s_mov_b32 s95, s69
  s_ashr_i32 s69, s44, 1
  s_add_u32 s69, s69, s91
  s_cmp_lt_u32 s90, 5
  s_cselect_b32 s69, 0, s69
  s_add_u32 s90, s90, 1
L_c18:
  v_mov_b32_dpp v18, v117 row_newbcast:2 row_mask:0xf bank_mask:0xf
  v_cvt_f32_i32 v92, v92
  v_cvt_f32_i32 v93, v93
  v_cvt_f32_i32 v94, v94
  v_cvt_f32_i32 v95, v95
  v_pk_fma_f32 v[44:45], v[92:93], v[18:19], v[44:45] op_sel_hi:[1,0,1]
  v_pk_fma_f32 v[46:47], v[94:95], v[18:19], v[46:47] op_sel_hi:[1,0,1]
  s_cbranch_vccz L_f18
  s_waitcnt vmcnt(5)
  s_branch L_g18
L_f18:
  s_cmp_gt_i32 s69, 17
  s_cbranch_scc1 L_q110
  s_cmp_gt_i32 s69, -10
  s_cbranch_scc1 L_p110
  s_waitcnt vmcnt(5)
L_p110:
  s_waitcnt vmcnt(9)
L_q110:
  s_waitcnt vmcnt(10)
  buffer_load_dwordx4 v[80:83], v215, s[36:39], 0 offen nt
L_g18:
  v_mov_b32 v9, s43
  ds_write_b32 v14, v9 offset:24
  v_mov_b32_dpp v18, v117 row_newbcast:3 row_mask:0xf bank_mask:0xf
  v_cvt_f32_i32 v96, v96
  v_cvt_f32_i32 v97, v97
  v_cvt_f32_i32 v98, v98
  v_cvt_f32_i32 v99, v99
  v_pk_fma_f32 v[48:49], v[96:97], v[18:19], v[48:49] op_sel_hi:[1,0,1]
  v_pk_fma_f32 v[50:51], v[98:99], v[18:19], v[50:51] op_sel_hi:[1,0,1]
  s_cbranch_vccz L_f19
  s_waitcnt vmcnt(4)
  s_branch L_g19
L_f19:
  s_cmp_gt_i32 s69, 17
  s_cbranch_scc1 L_q111
  s_cmp_gt_i32 s69, 5
  s_cbranch_scc1 L_p111
  s_waitcnt vmcnt(6)
L_p111:
  s_waitcnt vmcnt(10)
L_q111:
  s_waitcnt vmcnt(11)
  buffer_load_dwordx4 v[84:87], v216, s[36:39], 0 offen nt
L_g19:
  v_mov_b32_dpp v18, v117 row_newbcast:4 row_mask:0xf bank_mask:0xf
  v_cvt_f32_i32 v100, v100
  v_cvt_f32_i32 v101, v101
  v_cvt_f32_i32 v102, v102
  v_cvt_f32_i32 v103, v103
  v_pk_fma_f32 v[52:53], v[100:101], v[18:19], v[52:53] op_sel_hi:[1,0,1]
  v_pk_fma_f32 v[54:55], v[102:103], v[18:19], v[54:55] op_sel_hi:[1,0,1]
  s_cbranch_vccz L_f20
  s_waitcnt vmcnt(2)
  s_branch L_g20
L_f20:
  s_cmp_lt_i32 s69, -25
  s_cbranch_scc0 L_t112
  s_waitcnt vmcnt(6)
L_t112:
  s_cmp_gt_i32 s69, 17
  s_cbranch_scc1 L_q113
  s_cmp_gt_i32 s69, 12
  s_cbranch_scc1 L_p113
  s_waitcnt vmcnt(7)
L_p113:
  s_waitcnt vmcnt(11)
L_q113:
  s_waitcnt vmcnt(12)
  buffer_load_dwordx4 v[88:91], v217, s[36:39], 0 offen nt
L_g20:
  s_cbranch_vccnz L_c21
  s_waitcnt vmcnt(8)
  v_add3_u32 v9, v26, v27, s58
  s_nop 0
  v_readfirstlane_b32 s91, v9
  s_add_u32 s44, s78, 0x03030303
  v_msad_u8 v9, s78, v40, 0
  v_msad_u8 v10, s44, v40, 0
  v_msad_u8 v9, s78, v41, v9
  v_msad_u8 v10, s44, v41, v10
  v_msad_u8 v9, s78, v42, v9
  v_msad_u8 v10, s44, v42, v10
  v_sub_u32 v9, v9, v10
  v_mov_b32 v8, s90
  s_add_u32 s78, s78, 0x01010101
  v_readlane_b32 s66, v9, 0
  v_readlane_b32 s67, v9, 1
  s_mov_b64 exec, 1
  global_store_byte v7, v8, s[30:31]
  s_mov_b64 exec, 3
  global_load_dwordx3 v[40:42], v239, s[30:31] sc1
  s_mov_b64 exec, -1
  s_add_u32 s69, s66, s67
  s_add_u32 s44, s69, s95
  s_mov_b32 s95, s69
  s_ashr_i32 s69, s44, 1
  s_add_u32 s69, s69, s91
  s_cmp_lt_u32 s90, 5
  s_cselect_b32 s69, 0, s69
  s_add_u32 s90, s90, 1
L_c21:
  v_mov_b32_dpp v18, v117 row_newbcast:5 row_mask:0xf bank_mask:0xf
  v_cvt_f32_i32 v104, v104
  v_cvt_f32_i32 v105, v105
  v_cvt_f32_i32 v106, v106
  v_cvt_f32_i32 v107, v107
  v_pk_fma_f32 v[44:45], v[104:105], v[18:19], v[44:45] op_sel_hi:[1,0,1]
  v_pk_fma_f32 v[46:47], v[106:107], v[18:19], v[46:47] op_sel_hi:[1,0,1]
  s_cbranch_vccz L_f21
  s_waitcnt vmcnt(1)
  s_branch L_g21
L_f21:
  s_cmp_gt_i32 s69, 17
  s_cbranch_scc1 L_q114
  s_cmp_gt_i32 s69, -10
  s_cbranch_scc1 L_p114
  s_waitcnt vmcnt(5)
L_p114:
  s_waitcnt vmcnt(8)
L_q114:
  s_waitcnt vmcnt(9)
  buffer_load_dwordx4 v[92:95], v218, s[36:39], 0 offen nt
L_g21:
  v_mov_b32_dpp v18, v117 row_newbcast:6 row_mask:0xf bank_mask:0xf
  v_cvt_f32_i32 v108, v108
  v_cvt_f32_i32 v109, v109
  v_cvt_f32_i32 v110, v110
  v_cvt_f32_i32 v111, v111
  v_pk_fma_f32 v[48:49], v[108:109], v[18:19], v[48:49] op_sel_hi:[1,0,1]
  v_pk_fma_f32 v[50:51], v[110:111], v[18:19], v[50:51] op_sel_hi:[1,0,1]
  s_cbranch_vccz L_f22
  s_waitcnt vmcnt(0)
  s_branch L_g22
L_f22:
  s_cmp_gt_i32 s69, 17
  s_cbranch_scc1 L_q115
  s_cmp_gt_i32 s69, 5
  s_cbranch_scc1 L_p115
  s_waitcnt vmcnt(6)
L_p115:
  s_waitcnt vmcnt(9)
L_q115:
  s_waitcnt vmcnt(10)
  buffer_load_dwordx4 v[96:99], v219, s[36:39], 0 offen nt
L_g22:
  v_mov_b32_dpp v18, v117 row_newbcast:7 row_mask:0xf bank_mask:0xf
  v_cvt_f32_i32 v112, v112
  v_cvt_f32_i32 v113, v113
  v_cvt_f32_i32 v114, v114
  v_cvt_f32_i32 v115, v115
  v_pk_fma_f32 v[52:53], v[112:113], v[18:19], v[52:53] op_sel_hi:[1,0,1]
  v_pk_fma_f32 v[54:55], v[114:115], v[18:19], v[54:55] op_sel_hi:[1,0,1]
  s_cbranch_vccz L_f23
  s_branch L_g23
L_f23:
  s_cmp_lt_i32 s69, -25
  s_cbranch_scc0 L_t116
  s_waitcnt vmcnt(6)
L_t116:
  s_cmp_gt_i32 s69, 17
  s_cbranch_scc1 L_q117
  s_cmp_gt_i32 s69, 12
  s_cbranch_scc1 L_p117
  s_waitcnt vmcnt(7)
L_p117:
  s_waitcnt vmcnt(10)
L_q117:
  s_waitcnt vmcnt(11)
  buffer_load_dwordx4 v[100:103], v220, s[36:39], 0 offen nt
L_g23:
  s_add_u32 s43, s43, 1
  v_permlane32_swap_b32 v44, v46
  v_permlane32_swap_b32 v45, v47
  v_permlane32_swap_b32 v48, v50
  v_permlane32_swap_b32 v49, v51
  v_permlane32_swap_b32 v52, v54
  v_permlane32_swap_b32 v53, v55
  v_add_f32 v44, v44, v50
  v_add_f32 v45, v45, v51
  v_add_f32 v48, v48, v54
  v_add_f32 v49, v49, v55
  v_add_f32 v52, v52, v46
  v_add_f32 v53, v53, v47
  s_add_u32 s44, s43, 16
  s_cmp_eq_u32 s43, 15
  s_cselect_b64 vcc, -1, 0
  v_mov_b32 v4, s44
  v_permlane16_swap_b32 v44, v45
  v_permlane16_swap_b32 v48, v49
  v_permlane16_swap_b32 v52, v53
  v_add_f32 v44, v44, v53
  v_add_f32 v48, v48, v45
  v_add_f32 v52, v52, v49
  s_waitcnt lgkmcnt(0)
  ds_write_b32 v3, v44 offset:0
  ds_write_b32 v3, v48 offset:256
  ds_write_b32 v3, v52 offset:512
  s_cmp_eq_u32 s43, 16
  s_cbranch_scc1 L_vend
  ds_write_b32 v6, v4 offset:0
  v_mov_b32 v117, v118
  v_add_u32 v3, 3072, v3
  s_mov_b64 s[32:33], s[36:37]
  s_add_u32 s45, s43, 1
  s_min_u32 s45, s45, 15
  s_lshl_b32 s68, s45, 2
  s_lshr_b64 s[64:65], s[92:93], s68
  s_and_b32 s68, s64, 15
  s_lshl_b32 s44, s68, 2
  s_lshr_b64 s[64:65], s[96:97], s44
  s_and_b32 s64, s64, 15
  s_lshl4_add_u32 s68, s68, s64
  s_mul_i32 s44, s68, 1572864
  s_add_u32 s36, s12, s44
  s_addc_u32 s37, s13, 0
  s_branch L_v
L_vend:
  s_waitcnt lgkmcnt(0)
  s_barrier
  s_endpgm
L_helper:
  s_add_u32 s68, s42, 32
  s_mul_i32 s44, s68, 384
  s_add_u32 s32, s4, s44
  s_addc_u32 s33, s5, 0
  global_load_dwordx2 v[68:69], v26, s[32:33]
  global_load_dwordx2 v[70:71], v27, s[32:33]
  s_setprio 0
  s_load_dwordx4 s[28:31], s[0:1], 96
  s_getpc_b64 s[82:83]
L_pc118:
  s_lshl_b32 s44, s2, 6
  s_add_u32 s44, s44, L_order-L_pc118
  s_add_u32 s82, s82, s44
  s_addc_u32 s83, s83, 0
  s_load_dwordx2 s[92:93], s[82:83], 0
  s_load_dwordx2 s[96:97], s[82:83], 8
  s_mov_b32 s94, 4000000
  s_and_b32 s41, s2, 7
  s_lshl_b32 s41, s41, 1
  s_bitcmp1_b32 s2, 3
  s_addc_u32 s41, s41, 0
  s_load_dword s3, s[82:83], 24
  s_load_dwordx2 s[98:99], s[82:83], 16
  s_waitcnt lgkmcnt(0)
  v_min_u32 v22, 2, v20
  v_lshlrev_b32 v23, 3, v22
  v_bfe_u32 v23, s99, v23, 8
  v_mul_u32_u24 v36, 4352, v23
  v_add_u32 v36, 7340032, v36
  v_and_b32 v23, 15, v23
  v_lshlrev_b32 v37, 4, v23
  v_lshl_add_u32 v22, v22, 4, s42
  v_mul_u32_u24 v45, 4352, v22
  v_add_u32 v45, 7340032, v45
  s_getreg_b32 s81, hwreg(HW_REG_HW_ID, 13, 2)
  s_getreg_b32 s79, hwreg(HW_REG_HW_ID, 8, 4)
  s_getreg_b32 s46, hwreg(HW_REG_XCC_ID, 0, 3)
  s_mul_i32 s46, s46, 4352
  s_add_u32 s46, s46, 8126464
  v_lshrrev_b32 v22, 1, v20
  v_lshl_add_u32 v42, v22, 8, s46
  v_and_b32 v22, 1, v20
  v_lshl_add_u32 v42, v22, 4, v42
  s_and_b32 s45, s81, 2
  s_lshl_b32 s44, s45, 9
  s_add_u32 s44, s44, s46
  v_add_u32 v44, s44, v20
  s_lshl_b32 s45, s45, 1
  s_add_u32 s46, s46, s45
  s_add_u32 s46, s46, 2048
  v_mov_b32 v43, s46
  v_mul_u32_u24 v39, 384, v20
  v_add_u32 v39, 7864320, v39
  v_mov_b32 v40, 0
  v_mov_b32 v41, 0
  s_mov_b32 s95, 0
  s_mov_b32 s90, 0
  s_mov_b32 s80, 0
  s_mov_b64 exec, 0x3ffff
  global_store_dwordx4 v42, v[48:51], s[30:31]
  s_mov_b64 exec, -1
  v_add_u32 v33, 0, v20
  s_and_b32 s44, s41, 1
  v_add_u32 v23, s44, v33
  v_cmp_le_u32 vcc, 43, v23
  s_add_u32 s45, s44, 42
  v_mov_b32 v24, s45
  v_cndmask_b32 v24, 0, v24, vcc
  v_cmp_le_u32 vcc, 86, v23
  v_add_u32 v22, v33, v24
  s_sub_u32 s45, 43, s44
  v_mov_b32 v24, s45
  v_cndmask_b32 v24, 0, v24, vcc
  s_mul_i32 s44, s44, 43
  s_lshr_b32 s45, s41, 1
  s_lshl_b32 s45, s45, 8
  s_add_u32 s44, s44, s45
  v_add3_u32 v22, v22, v24, s44
  v_and_b32 v33, 255, v22
  v_lshlrev_b32 v33, 1, v33
  v_add_u32 v34, 64, v20
  s_and_b32 s44, s41, 1
  v_add_u32 v23, s44, v34
  v_cmp_le_u32 vcc, 43, v23
  s_add_u32 s45, s44, 42
  v_mov_b32 v24, s45
  v_cndmask_b32 v24, 0, v24, vcc
  v_cmp_le_u32 vcc, 86, v23
  v_add_u32 v22, v34, v24
  s_sub_u32 s45, 43, s44
  v_mov_b32 v24, s45
  v_cndmask_b32 v24, 0, v24, vcc
  s_mul_i32 s44, s44, 43
  s_lshr_b32 s45, s41, 1
  s_lshl_b32 s45, s45, 8
  s_add_u32 s44, s44, s45
  v_add3_u32 v22, v22, v24, s44
  v_and_b32 v34, 255, v22
  v_lshlrev_b32 v34, 1, v34
  v_lshlrev_b32 v46, 2, v20
  v_mul_u32_u24 v199, 12, v20
  v_add_u32 v199, 45568, v199
  s_mov_b32 s101, 0
  v_mov_b32 v47, 118912
  v_mov_b32 v51, -1
  v_mov_b32 v60, 0
  v_mov_b32 v61, 0
  v_mov_b32 v62, 0
  v_mov_b32 v63, 0
  v_mov_b32 v64, 0
  v_mov_b32 v65, 0
  v_mov_b32 v66, 0
  v_mov_b32 v67, 0
  s_and_b32 s45, s2, 7
  s_lshl_b32 s45, s45, 9
  v_and_b32 v22, 31, v20
  v_lshl_add_u32 v22, v22, 4, s45
  v_lshrrev_b32 v23, 5, v20
  v_lshl_add_u32 v22, v23, 16, v22
  v_lshlrev_b32 v23, 2, v23
  s_lshr_b32 s44, s96, 0
  v_bfe_u32 v24, s44, v23, 4
  v_lshl_add_u32 v188, v24, 12, v22
  v_add_u32 v22, 0x20000, v22
  s_lshr_b32 s44, s96, 8
  v_bfe_u32 v24, s44, v23, 4
  v_lshl_add_u32 v189, v24, 12, v22
  v_add_u32 v22, 0x20000, v22
  s_lshr_b32 s44, s96, 16
  v_bfe_u32 v24, s44, v23, 4
  v_lshl_add_u32 v190, v24, 12, v22
  v_add_u32 v22, 0x20000, v22
  s_lshr_b32 s44, s96, 24
  v_bfe_u32 v24, s44, v23, 4
  v_lshl_add_u32 v191, v24, 12, v22
  v_add_u32 v22, 0x20000, v22
  s_lshr_b32 s44, s97, 0
  v_bfe_u32 v24, s44, v23, 4
  v_lshl_add_u32 v192, v24, 12, v22
  v_add_u32 v22, 0x20000, v22
  s_lshr_b32 s44, s97, 8
  v_bfe_u32 v24, s44, v23, 4
  v_lshl_add_u32 v193, v24, 12, v22
  v_add_u32 v22, 0x20000, v22
  s_lshr_b32 s44, s97, 16
  v_bfe_u32 v24, s44, v23, 4
  v_lshl_add_u32 v194, v24, 12, v22
  v_add_u32 v22, 0x20000, v22
  s_lshr_b32 s44, s97, 24
  v_bfe_u32 v24, s44, v23, 4
  v_lshl_add_u32 v195, v24, 12, v22
  s_mov_b32 s69, 0
  s_movk_i32 m0, 4608
  s_branch L_hq_nl
L_hk:
  s_sub_u32 s47, s43, 1
L_hsw:
  ds_read_b128 v[104:107], v14 offset:0
  s_waitcnt lgkmcnt(0)
  v_min_u32 v104, v104, v105
  v_min3_u32 v104, v104, v106, v107
  s_nop 0
  v_readfirstlane_b32 s46, v104
  s_cmp_ge_u32 s46, s47
  s_cbranch_scc1 L_hsw_ok
  s_cmp_eq_u32 s94, 0
  s_cbranch_scc1 L_hsw_ok
  s_sub_u32 s94, s94, 1
  s_sleep 1
  s_branch L_hsw
L_hsw_ok:
  s_bitcmp1_b32 s80, s47
  s_cbranch_scc0 L_fas
  s_lshl_b64 exec, 1, s47
  s_mul_i32 s44, s47, 384
  s_add_u32 s44, s44, 7864320
  s_mov_b32 s78, 1
  s_atomic_add s78, s[30:31], s44 glc
  s_mov_b64 exec, -1
L_fas:
  s_cmp_lt_u32 s43, 5
  s_cbranch_scc1 L_hs_done
  s_add_u32 s68, s69, 2
  s_min_u32 s68, s68, s47
L_hs:
  ds_read_u16_d16_hi v60, v33 offset:4608
  ds_read_u16_d16_hi v61, v34 offset:4608
  ds_read_u16_d16_hi v62, v33 offset:12800
  ds_read_u16_d16_hi v63, v34 offset:12800
  ds_read_u16_d16_hi v64, v33 offset:20992
  ds_read_u16_d16_hi v65, v34 offset:20992
  ds_read_u16_d16_hi v66, v33 offset:29184
  ds_read_u16_d16_hi v67, v34 offset:29184
  v_add_u32 v200, s101, v199
  v_add_u32 v201, 1536, v200
  s_addk_i32 s101, 3072
  s_cmpk_eq_u32 s101, 18432
  s_cselect_b32 s101, 0, s101
  s_add_u32 s69, s69, 1
  s_waitcnt lgkmcnt(4)
  ds_read2_b32 v[76:77], v200 offset0:0 offset1:1
  ds_read_b32 v72, v200 offset:8
  ds_read2_b32 v[78:79], v200 offset0:192 offset1:193
  ds_read_b32 v73, v200 offset:776
  ds_read2_b32 v[80:81], v201 offset0:0 offset1:1
  ds_read_b32 v74, v201 offset:8
  ds_read2_b32 v[82:83], v201 offset0:192 offset1:193
  ds_read_b32 v75, v201 offset:776
  s_waitcnt lgkmcnt(0)
  v_add_f32 v76, v76, v77
  v_add_f32 v78, v78, v79
  v_add_f32 v80, v80, v81
  v_add_f32 v82, v82, v83
  v_add_f32 v72, v72, v76
  v_add_f32 v73, v73, v78
  v_add_f32 v74, v74, v80
  v_add_f32 v75, v75, v82
  v_fma_f32 v72, -v62, v74, v72
  v_fma_f32 v73, -v63, v75, v73
  v_mul_f32 v74, s67, v60
  v_mul_f32 v75, s67, v61
  v_mul_f32 v72, v72, v74
  v_mul_f32 v73, v73, v75
  v_max_f32 v48, v72, v73
  s_nop 1
  v_max_f32_dpp v48, v48, v48 row_ror:8 row_mask:0xf bank_mask:0xf
  s_nop 1
  v_max_f32_dpp v48, v48, v48 row_ror:4 row_mask:0xf bank_mask:0xf
  s_nop 1
  v_max_f32_dpp v48, v48, v48 row_ror:2 row_mask:0xf bank_mask:0xf
  s_nop 1
  v_max_f32_dpp v48, v48, v48 row_ror:1 row_mask:0xf bank_mask:0xf
  v_mov_b32 v22, v48
  s_nop 1
  v_permlane16_swap_b32 v48, v22
  v_max_f32 v48, v48, v22
  v_mov_b32 v22, v48
  s_nop 1
  v_permlane32_swap_b32 v48, v22
  v_max_f32 v48, v48, v22
  v_sub_f32 v72, v72, v48
  v_sub_f32 v73, v73, v48
  v_exp_f32 v72, v72
  v_exp_f32 v73, v73
  s_nop 0
  v_add_f32 v49, v72, v73
  v_mul_f32 v72, v72, v64
  v_mul_f32 v73, v73, v65
  v_mul_f32 v50, v72, v66
  v_fmac_f32 v50, v73, v67
  ds_write_b32 v46, v72 offset:37376
  ds_write_b32 v46, v73 offset:37632
  s_nop 1
  v_add_f32_dpp v49, v49, v49 row_ror:8 row_mask:0xf bank_mask:0xf
  s_nop 1
  v_add_f32_dpp v49, v49, v49 row_ror:4 row_mask:0xf bank_mask:0xf
  s_nop 1
  v_add_f32_dpp v49, v49, v49 row_ror:2 row_mask:0xf bank_mask:0xf
  s_nop 1
  v_add_f32_dpp v49, v49, v49 row_ror:1 row_mask:0xf bank_mask:0xf
  v_mov_b32 v22, v49
  s_nop 1
  v_permlane16_swap_b32 v49, v22
  v_add_f32 v49, v49, v22
  v_mov_b32 v22, v49
  s_nop 1
  v_permlane32_swap_b32 v49, v22
  v_add_f32 v49, v49, v22
  s_nop 1
  v_add_f32_dpp v50, v50, v50 row_ror:8 row_mask:0xf bank_mask:0xf
  s_nop 1
  v_add_f32_dpp v50, v50, v50 row_ror:4 row_mask:0xf bank_mask:0xf
  s_nop 1
  v_add_f32_dpp v50, v50, v50 row_ror:2 row_mask:0xf bank_mask:0xf
  s_nop 1
  v_add_f32_dpp v50, v50, v50 row_ror:1 row_mask:0xf bank_mask:0xf
  v_mov_b32 v22, v50
  s_nop 1
  v_permlane16_swap_b32 v50, v22
  v_add_f32 v50, v50, v22
  v_mov_b32 v22, v50
  s_nop 1
  v_permlane32_swap_b32 v50, v22
  v_add_f32 v50, v50, v22
  v_mov_b32 v22, s69
  ds_write_b128 v47, v[48:51]
  ds_write_b32 v14, v22 offset:20
  v_add_u32 v46, 512, v46
  v_add_u32 v47, 16, v47
  v_add_u32 v33, 512, v33
  v_add_u32 v34, 512, v34
  s_cmp_lt_u32 s69, s68
  s_cbranch_scc1 L_hs
L_hs_done:
  s_bitcmp1_b32 s80, s47
  s_cbranch_scc0 L_fbs
  s_waitcnt vmcnt(0) lgkmcnt(0)
  v_sub_u32 v42, s78, v40
  s_nop 0
  v_readlane_b32 s46, v42, s47
  s_min_u32 s46, s46, 15
  s_lshl_b32 s46, s46, 1
  s_sub_u32 s46, s46, 15
  s_cmp_le_u32 s47, 0
  s_cselect_b32 s44, 9, 6
  s_mul_i32 s46, s46, s44
  s_add_u32 s46, s46, s95
  s_add_u32 s46, s46, 8
  s_ashr_i32 s46, s46, 4
  v_mov_b32 v42, s46
  s_mov_b64 exec, 1
  global_store_dword v43, v42, s[30:31]
  s_mov_b64 exec, -1
L_fbs:
  s_cmp_eq_u32 s47, 1
  s_cbranch_scc0 L_el
  s_bitcmp0_b32 s81, 0
  s_cbranch_scc0 L_el
  s_mov_b64 exec, 0xffff
  global_load_ubyte v42, v44, s[30:31] sc1
  s_waitcnt vmcnt(0)
  v_cmp_ne_u32 s[64:65], 0, v42
  s_lshr_b32 s44, s64, s79
  s_bcnt1_i32_b32 s44, s44
  s_sub_u32 s45, s44, 1
  s_cmp_lt_u32 s45, 7
  s_cbranch_scc0 L_el
  s_lshl_b32 s80, 0x10204081, s45
  s_and_b32 s80, s80, 0x7d555554
  s_mov_b32 exec_lo, s80
  global_load_dword v40, v39, s[30:31] sc1
  s_cmp_eq_u32 s44, 4
  s_cbranch_scc0 L_el
L_el:
  s_mov_b64 exec, -1
L_hq:
  s_add_u32 s43, s43, 1
  s_cmp_gt_u32 s43, 16
  s_cbranch_scc1 L_hq_skip
  s_waitcnt vmcnt(0)
  v_lshlrev_b32 v76, 16, v68
  v_and_b32 v77, s66, v68
  v_lshlrev_b32 v78, 16, v69
  v_and_b32 v79, s66, v69
  v_lshlrev_b32 v80, 16, v70
  v_and_b32 v81, s66, v70
  v_lshlrev_b32 v82, 16, v71
  v_and_b32 v83, s66, v71
  v_mul_f32 v76, v76, v52
  v_mul_f32 v77, v77, v53
  v_mul_f32 v78, v78, v54
  v_mul_f32 v79, v79, v55
  v_mul_f32 v80, v80, v56
  v_mul_f32 v81, v81, v57
  v_mul_f32 v82, v82, v58
  v_mul_f32 v83, v83, v59
  v_cvt_pk_bf16_f32 v84, v76, v80
  v_cvt_pk_bf16_f32 v85, v77, v81
  v_cvt_pk_bf16_f32 v86, v78, v82
  v_cvt_pk_bf16_f32 v87, v79, v83
  v_lshlrev_b32 v76, 16, v84
  v_and_b32 v80, s66, v84
  v_lshlrev_b32 v77, 16, v85
  v_and_b32 v81, s66, v85
  v_lshlrev_b32 v78, 16, v86
  v_and_b32 v82, s66, v86
  v_lshlrev_b32 v79, 16, v87
  v_and_b32 v83, s66, v87
  v_fma_f32 v76, v80, v30, v76
  v_fma_f32 v77, v81, v30, v77
  v_fma_f32 v78, v82, v30, v78
  v_fma_f32 v79, v83, v30, v79
  v_cvt_pk_bf16_f32 v84, v76, v77
  v_cvt_pk_bf16_f32 v85, v78, v79
  v_xor_b32 v86, v31, v84
  v_xor_b32 v87, v31, v85
  v_mov_b32 v22, s43
  ds_write_b16 v28, v84 offset:512
  ds_write_b16_d16_hi v28, v84 offset:516
  ds_write_b16 v28, v85 offset:520
  ds_write_b16_d16_hi v28, v85 offset:524
  ds_write_b16 v29, v86 offset:514
  ds_write_b16_d16_hi v29, v86 offset:518
  ds_write_b16 v29, v87 offset:522
  ds_write_b16_d16_hi v29, v87 offset:526
  ds_write_b32 v14, v22 offset:16
  v_add_u32 v28, 1024, v28
  v_add_u32 v29, 1024, v29
  v_and_b32 v28, 0xfff, v28
  v_and_b32 v29, 0xfff, v29
  s_cmp_eq_u32 s43, 16
  s_cbranch_scc1 L_hq_nl
  s_lshl_b32 s44, s43, 2
  s_lshr_b64 s[64:65], s[96:97], s44
  s_and_b32 s64, s64, 15
  s_lshl4_add_u32 s68, s43, s64
  s_mul_i32 s44, s68, 384
  s_add_u32 s32, s4, s44
  s_addc_u32 s33, s5, 0
  global_load_dwordx2 v[68:69], v26, s[32:33]
  global_load_dwordx2 v[70:71], v27, s[32:33]
L_hq_nl:
  s_sub_u32 s44, s43, 4
  s_cmp_lt_u32 s44, 2
  s_cbranch_scc0 L_sc_done
  global_load_lds_dwordx4 v188, s[8:9]
  s_addk_i32 m0, 1024
  s_waitcnt vmcnt(3)
  global_load_lds_dwordx4 v189, s[8:9]
  s_addk_i32 m0, 1024
  s_waitcnt vmcnt(3)
  global_load_lds_dwordx4 v190, s[8:9]
  s_addk_i32 m0, 1024
  s_waitcnt vmcnt(3)
  global_load_lds_dwordx4 v191, s[8:9]
  s_addk_i32 m0, 1024
  s_waitcnt vmcnt(3)
  global_load_lds_dwordx4 v192, s[8:9]
  s_addk_i32 m0, 1024
  s_waitcnt vmcnt(3)
  global_load_lds_dwordx4 v193, s[8:9]
  s_addk_i32 m0, 1024
  s_waitcnt vmcnt(3)
  global_load_lds_dwordx4 v194, s[8:9]
  s_addk_i32 m0, 1024
  s_waitcnt vmcnt(3)
  global_load_lds_dwordx4 v195, s[8:9]
  s_addk_i32 m0, 1024
  s_mov_b64 s[8:9], s[10:11]
  s_mov_b64 s[10:11], s[14:15]
  s_mov_b64 s[14:15], s[16:17]
  s_waitcnt vmcnt(3)
  global_load_lds_dwordx4 v188, s[8:9]
  s_addk_i32 m0, 1024
  s_waitcnt vmcnt(3)
  global_load_lds_dwordx4 v189, s[8:9]
  s_addk_i32 m0, 1024
  s_waitcnt vmcnt(3)
  global_load_lds_dwordx4 v190, s[8:9]
  s_addk_i32 m0, 1024
  s_waitcnt vmcnt(3)
  global_load_lds_dwordx4 v191, s[8:9]
  s_addk_i32 m0, 1024
  s_waitcnt vmcnt(3)
  global_load_lds_dwordx4 v192, s[8:9]
  s_addk_i32 m0, 1024
  s_waitcnt vmcnt(3)
  global_load_lds_dwordx4 v193, s[8:9]
  s_addk_i32 m0, 1024
  s_waitcnt vmcnt(3)
  global_load_lds_dwordx4 v194, s[8:9]
  s_addk_i32 m0, 1024
  s_waitcnt vmcnt(3)
  global_load_lds_dwordx4 v195, s[8:9]
  s_addk_i32 m0, 1024
  s_mov_b64 s[8:9], s[10:11]
  s_mov_b64 s[10:11], s[14:15]
  s_mov_b64 s[14:15], s[16:17]
  s_cmp_eq_u32 s43, 5
  s_cbranch_scc0 L_sc_done
  s_waitcnt vmcnt(0)
L_sc_done:
  s_cmp_eq_u32 s43, 16
  s_cbranch_scc0 L_hq_skip
  s_cmp_eq_u32 s3, 0
  s_cbranch_scc0 L_hq_skip
  s_mov_b64 exec, 7
  global_store_dword v45, v14, s[30:31] sc1
  s_waitcnt vmcnt(0)
  s_mov_b64 exec, 1
  global_store_dword v37, v38, s[28:29] sc1
  s_mov_b64 exec, -1
L_hq_skip:
  s_waitcnt lgkmcnt(0)
  s_cmp_lt_u32 s43, 18
  s_cbranch_scc1 L_hk
  v_and_b32 v24, 15, v20
  v_lshlrev_b32 v24, 1, v24
  global_load_ushort v25, v24, s[82:83] offset:32
  s_mov_b32 s43, 0
  v_min_u32 v28, 23, v20
  v_lshlrev_b32 v28, 4, v28
  v_lshlrev_b32 v22, 1, v28
  v_subrev_u32 v196, 256, v22
  v_add_u32 v197, 512, v22
  v_min_u32 v197, v196, v197
  v_add_u32 v197, 64000, v197
  v_subrev_u32 v196, 512, v22
  v_add_u32 v198, 256, v22
  v_min_u32 v198, v196, v198
  v_add_u32 v198, 64000, v198
  v_add_u32 v196, 64000, v22
  v_add_u32 v28, 113152, v28
  v_lshlrev_b32 v32, 4, v20
  v_add_u32 v30, 113152, v32
  v_cmp_gt_u32 vcc, 24, v20
  v_lshrrev_b32 v21, 1, v35
  s_mul_i32 s44, s98, 384
  s_add_u32 s26, s26, s44
  s_addc_u32 s27, s27, 0
  v_mov_b32 v31, s2
  v_mul_u32_u24 v31, 6144, v31
  v_add_u32 v31, 8388608, v31
  v_add_u32 v23, 0, v32
  v_add_u32 v188, v23, v31
  v_add_u32 v23, 1024, v32
  v_add_u32 v189, v23, v31
  v_add_u32 v23, 2048, v32
  v_add_u32 v190, v23, v31
  v_add_u32 v23, 3072, v32
  v_add_u32 v191, v23, v31
  v_add_u32 v23, 4096, v32
  v_add_u32 v192, v23, v31
  v_add_u32 v23, 5120, v32
  v_add_u32 v193, v23, v31
  s_mov_b32 s45, 14
  s_lshl_b32 s68, s45, 2
  s_lshr_b64 s[64:65], s[92:93], s68
  s_and_b32 s68, s64, 15
  v_lshl_add_u32 v23, s68, 4, v32
  v_cndmask_b32 v23, v23, v32, vcc
  v_add_u32 v23, 5376, v23
  v_add_u32 v168, v23, v31
  s_waitcnt vmcnt(0)
  v_lshrrev_b32 v31, 4, v25
  v_mul_u32_u24 v31, 6144, v31
  v_add_u32 v31, 8388608, v31
  v_and_b32 v25, 15, v25
  v_mul_u32_u24 v25, 384, v25
  s_lshl4_add_u32 s44, s3, 5760
  v_mov_b32 v23, s44
  v_add_u32 v187, v23, v31
  v_add_u32_dpp v23, v25, v21 row_newbcast:0 row_mask:0xf bank_mask:0xf
  v_mov_b32_dpp v29, v31 row_newbcast:0 row_mask:0xf bank_mask:0xf
  v_add_u32 v172, v23, v29
  v_add_u32_dpp v23, v25, v21 row_newbcast:1 row_mask:0xf bank_mask:0xf
  v_mov_b32_dpp v29, v31 row_newbcast:1 row_mask:0xf bank_mask:0xf
  v_add_u32 v173, v23, v29
  v_add_u32_dpp v23, v25, v21 row_newbcast:2 row_mask:0xf bank_mask:0xf
  v_mov_b32_dpp v29, v31 row_newbcast:2 row_mask:0xf bank_mask:0xf
  v_add_u32 v174, v23, v29
  v_add_u32_dpp v23, v25, v21 row_newbcast:3 row_mask:0xf bank_mask:0xf
  v_mov_b32_dpp v29, v31 row_newbcast:3 row_mask:0xf bank_mask:0xf
  v_add_u32 v175, v23, v29
  v_add_u32_dpp v23, v25, v21 row_newbcast:4 row_mask:0xf bank_mask:0xf
  v_mov_b32_dpp v29, v31 row_newbcast:4 row_mask:0xf bank_mask:0xf
  v_add_u32 v176, v23, v29
  v_add_u32_dpp v23, v25, v21 row_newbcast:5 row_mask:0xf bank_mask:0xf
  v_mov_b32_dpp v29, v31 row_newbcast:5 row_mask:0xf bank_mask:0xf
  v_add_u32 v177, v23, v29
  v_add_u32_dpp v23, v25, v21 row_newbcast:6 row_mask:0xf bank_mask:0xf
  v_mov_b32_dpp v29, v31 row_newbcast:6 row_mask:0xf bank_mask:0xf
  v_add_u32 v178, v23, v29
  v_add_u32_dpp v23, v25, v21 row_newbcast:7 row_mask:0xf bank_mask:0xf
  v_mov_b32_dpp v29, v31 row_newbcast:7 row_mask:0xf bank_mask:0xf
  v_add_u32 v179, v23, v29
  v_add_u32_dpp v23, v25, v21 row_newbcast:8 row_mask:0xf bank_mask:0xf
  v_mov_b32_dpp v29, v31 row_newbcast:8 row_mask:0xf bank_mask:0xf
  v_add_u32 v180, v23, v29
  v_add_u32_dpp v23, v25, v21 row_newbcast:9 row_mask:0xf bank_mask:0xf
  v_mov_b32_dpp v29, v31 row_newbcast:9 row_mask:0xf bank_mask:0xf
  v_add_u32 v181, v23, v29
  v_add_u32_dpp v23, v25, v21 row_newbcast:10 row_mask:0xf bank_mask:0xf
  v_mov_b32_dpp v29, v31 row_newbcast:10 row_mask:0xf bank_mask:0xf
  v_add_u32 v182, v23, v29
  v_add_u32_dpp v23, v25, v21 row_newbcast:11 row_mask:0xf bank_mask:0xf
  v_mov_b32_dpp v29, v31 row_newbcast:11 row_mask:0xf bank_mask:0xf
  v_add_u32 v183, v23, v29
  v_add_u32_dpp v23, v25, v21 row_newbcast:12 row_mask:0xf bank_mask:0xf
  v_mov_b32_dpp v29, v31 row_newbcast:12 row_mask:0xf bank_mask:0xf
  v_add_u32 v184, v23, v29
  v_add_u32_dpp v23, v25, v21 row_newbcast:13 row_mask:0xf bank_mask:0xf
  v_mov_b32_dpp v29, v31 row_newbcast:13 row_mask:0xf bank_mask:0xf
  v_add_u32 v185, v23, v29
  v_add_u32_dpp v23, v25, v21 row_newbcast:14 row_mask:0xf bank_mask:0xf
  v_mov_b32_dpp v29, v31 row_newbcast:14 row_mask:0xf bank_mask:0xf
  v_add_u32 v186, v23, v29
  v_mov_b32 v108, -1
  v_mov_b32 v109, -1
  v_mov_b32 v110, -1
  v_mov_b32 v111, -1
  s_lshl4_add_u32 s44, s3, 118912
  v_mov_b32 v23, s44
  ds_write_b128 v28, v[108:111] offset:5376
  ds_write_b32 v23, v38 offset:12
L_hp:
  s_min_u32 s44, s3, 13
  s_cmp_eq_u32 s44, s43
  s_cbranch_scc0 L_hc_ok
L_hc:
  global_load_dword v104, v37, s[28:29] sc1
  s_waitcnt vmcnt(0)
  v_cmp_ne_u32 s[64:65], 1, v104
  s_cmp_eq_u64 s[64:65], 0
  s_cbranch_scc1 L_hc_ok
  s_cmp_eq_u32 s94, 0
  s_cbranch_scc1 L_hc_ok
  s_sub_u32 s94, s94, 1
  s_sleep 64
  s_branch L_hc
L_hc_ok:
  s_lshl_b32 s68, s43, 2
  s_lshr_b64 s[64:65], s[92:93], s68
  s_and_b32 s68, s64, 15
  s_lshl4_add_u32 s44, s68, 118912
  v_mov_b32 v23, s44
  s_cmp_eq_u32 s43, 14
  s_cbranch_scc0 L_hp_mid
  ds_read_b128 v[144:147], v30 offset:0
  ds_read_b128 v[148:151], v30 offset:1024
  ds_read_b128 v[152:155], v30 offset:2048
  ds_read_b128 v[156:159], v30 offset:3072
  ds_read_b128 v[160:163], v30 offset:4096
  ds_read_b128 v[164:167], v30 offset:5120
L_hm:
  ds_read_b32 v104, v14 offset:24
  s_waitcnt lgkmcnt(0)
  v_readfirstlane_b32 s46, v104
  s_cmp_ge_u32 s46, 14
  s_cbranch_scc1 L_hm_ok
  s_cmp_eq_u32 s94, 0
  s_cbranch_scc1 L_hm_ok
  s_sub_u32 s94, s94, 1
  s_sleep 1
  s_branch L_hm
L_hm_ok:
  global_store_dwordx4 v188, v[144:147], s[30:31] sc1
  global_store_dwordx4 v189, v[148:151], s[30:31] sc1
  global_store_dwordx4 v190, v[152:155], s[30:31] sc1
  global_store_dwordx4 v191, v[156:159], s[30:31] sc1
  global_store_dwordx4 v192, v[160:163], s[30:31] sc1
  s_mov_b32 exec_hi, 0xffffff
  global_store_dwordx4 v193, v[164:167], s[30:31] sc1
  s_mov_b64 exec, 7
  s_waitcnt vmcnt(0)
  global_atomic_add v36, v38, s[30:31] sc1
  s_mov_b64 exec, -1
L_hp_mid:
  s_add_u32 s43, s43, 1
  s_add_u32 s47, s43, 16
L_hpw:
  ds_read_b128 v[104:107], v14 offset:0
  s_waitcnt lgkmcnt(0)
  v_min_u32 v104, v104, v105
  v_min3_u32 v104, v104, v106, v107
  s_nop 0
  v_readfirstlane_b32 s46, v104
  s_cmp_ge_u32 s46, s47
  s_cbranch_scc1 L_hpw_ok
  s_cmp_eq_u32 s94, 0
  s_cbranch_scc1 L_hpw_ok
  s_sub_u32 s94, s94, 1
  s_sleep 1
  s_branch L_hpw
L_hpw_ok:
  s_bitcmp1_b32 s80, s47
  s_cbranch_scc0 L_fap
  s_lshl_b64 exec, 1, s47
  s_mul_i32 s44, s47, 384
  s_add_u32 s44, s44, 7864320
  s_mov_b32 s78, 1
  s_atomic_add s78, s[30:31], s44 glc
  s_mov_b64 exec, -1
L_fap:
  ds_read_b128 v[72:75], v196 offset:0
  ds_read_b128 v[76:79], v196 offset:16
  ds_read_b128 v[80:83], v197 offset:768
  ds_read_b128 v[84:87], v197 offset:784
  ds_read_b128 v[88:91], v198 offset:1536
  ds_read_b128 v[92:95], v198 offset:1552
  ds_read_b128 v[96:99], v196 offset:2304
  ds_read_b128 v[100:103], v196 offset:2320
  ds_read_b128 v[48:51], v23
  s_waitcnt lgkmcnt(0)
  v_pk_add_f32 v[72:73], v[72:73], v[80:81]
  v_pk_add_f32 v[88:89], v[88:89], v[96:97]
  v_pk_add_f32 v[74:75], v[74:75], v[82:83]
  v_pk_add_f32 v[90:91], v[90:91], v[98:99]
  v_pk_add_f32 v[76:77], v[76:77], v[84:85]
  v_pk_add_f32 v[92:93], v[92:93], v[100:101]
  v_pk_add_f32 v[78:79], v[78:79], v[86:87]
  v_pk_add_f32 v[94:95], v[94:95], v[102:103]
  v_pk_add_f32 v[72:73], v[72:73], v[88:89]
  v_pk_add_f32 v[74:75], v[74:75], v[90:91]
  v_pk_add_f32 v[76:77], v[76:77], v[92:93]
  v_pk_add_f32 v[78:79], v[78:79], v[94:95]
  v_pk_add_f32 v[72:73], v[72:73], v[50:51] op_sel_hi:[1,0] neg_lo:[0,1] neg_hi:[0,1]
  v_pk_add_f32 v[74:75], v[74:75], v[50:51] op_sel_hi:[1,0] neg_lo:[0,1] neg_hi:[0,1]
  v_pk_add_f32 v[76:77], v[76:77], v[50:51] op_sel_hi:[1,0] neg_lo:[0,1] neg_hi:[0,1]
  v_pk_add_f32 v[78:79], v[78:79], v[50:51] op_sel_hi:[1,0] neg_lo:[0,1] neg_hi:[0,1]
  v_max3_f32 v25, |v72|, |v73|, |v74|
  v_max3_f32 v25, v25, |v75|, |v76|
  v_max3_f32 v25, v25, |v77|, |v78|
  v_max_f32_e64 v25, v25, |v79|
  s_nop 1
  v_max_f32_dpp v25, v25, v25 row_ror:8 row_mask:0xf bank_mask:0xf
  s_nop 1
  v_max_f32_dpp v25, v25, v25 row_ror:4 row_mask:0xf bank_mask:0xf
  s_nop 1
  v_max_f32_dpp v25, v25, v25 row_ror:2 row_mask:0xf bank_mask:0xf
  s_nop 1
  v_max_f32_dpp v25, v25, v25 row_ror:1 row_mask:0xf bank_mask:0xf
  v_mov_b32 v29, v25
  s_nop 1
  v_permlane16_swap_b32 v25, v29
  v_max_f32 v25, v25, v29
  v_mov_b32 v29, v25
  s_nop 1
  v_permlane32_swap_b32 v25, v29
  v_max_f32 v25, v25, v29
  v_frexp_exp_i32_f32 v25, v25
  v_sub_u32 v29, 14, v25
  v_add_u32 v51, 242, v25
  v_ldexp_f32 v72, v72, v29
  v_ldexp_f32 v73, v73, v29
  v_ldexp_f32 v74, v74, v29
  v_ldexp_f32 v75, v75, v29
  v_ldexp_f32 v76, v76, v29
  v_ldexp_f32 v77, v77, v29
  v_ldexp_f32 v78, v78, v29
  v_ldexp_f32 v79, v79, v29
  v_cvt_pk_f16_f32 v108, v72, v73
  v_cvt_pk_f16_f32 v109, v74, v75
  v_cvt_pk_f16_f32 v110, v76, v77
  v_cvt_pk_f16_f32 v111, v78, v79
  v_min_u32 v108, -2, v108
  v_min_u32 v109, -2, v109
  v_min_u32 v110, -2, v110
  v_min_u32 v111, -2, v111
  s_cmp_eq_u32 s43, 15
  s_cbranch_scc1 L_hp_last
  ds_write_b32 v23, v51 offset:12
  v_add_u32 v196, 3072, v196
  v_add_u32 v197, 3072, v197
  v_add_u32 v198, 3072, v198
  ds_write_b128 v28, v[108:111]
  v_add_u32 v28, 384, v28
  s_bitcmp1_b32 s80, s47
  s_cbranch_scc0 L_fbp
  s_waitcnt vmcnt(0) lgkmcnt(0)
  v_sub_u32 v42, s78, v40
  s_nop 0
  v_readlane_b32 s46, v42, s47
  s_min_u32 s46, s46, 15
  s_lshl_b32 s46, s46, 1
  s_sub_u32 s46, s46, 15
  s_cmp_le_u32 s47, 0
  s_cselect_b32 s44, 9, 6
  s_mul_i32 s46, s46, s44
  s_add_u32 s46, s46, s95
  s_add_u32 s46, s46, 8
  s_ashr_i32 s46, s46, 4
  v_mov_b32 v42, s46
  s_mov_b64 exec, 1
  global_store_dword v43, v42, s[30:31]
  s_mov_b64 exec, -1
L_fbp:
  s_branch L_hp
L_hp_last:
  v_cndmask_b32 v108, v48, v108, vcc
  v_cndmask_b32 v109, v49, v109, vcc
  v_cndmask_b32 v110, v50, v110, vcc
  v_cndmask_b32 v111, v51, v111, vcc
  s_mov_b64 exec, 0x1ffffff
  global_store_dwordx4 v168, v[108:111], s[30:31] sc1
  s_mov_b64 exec, -1
  v_subrev_u32 v196, 256, v35
  v_add_u32 v197, 512, v35
  v_min_u32 v197, v196, v197
  v_add_u32 v197, 110080, v197
  v_subrev_u32 v196, 512, v35
  v_add_u32 v198, 256, v35
  v_min_u32 v198, v196, v198
  v_add_u32 v198, 110080, v198
  v_add_u32 v196, 110080, v35
L_hn:
  ds_read_b32 v104, v14 offset:28
  s_waitcnt lgkmcnt(0)
  v_readfirstlane_b32 s46, v104
  s_cmp_ge_u32 s46, 15
  s_cbranch_scc1 L_hn_ok
  s_cmp_eq_u32 s94, 0
  s_cbranch_scc1 L_hn_ok
  s_sub_u32 s94, s94, 1
  s_sleep 1
  s_branch L_hn
L_hn_ok:
  s_mov_b64 exec, 1
L_hw:
  global_atomic_add v68, v36, v14, s[30:31] sc0 sc1
  s_waitcnt vmcnt(0)
  v_readfirstlane_b32 s46, v68
  s_cmp_ge_u32 s46, 16
  s_cbranch_scc1 L_hw_ok
  s_cmp_eq_u32 s94, 0
  s_cbranch_scc1 L_hw_ok
  s_sub_u32 s94, s94, 1
  s_branch L_hw
L_hw_ok:
  s_mov_b64 exec, -1
L_hg:
  global_load_dwordx4 v[52:55], v187, s[30:31] sc1
  global_load_dwordx2 v[112:113], v172, s[30:31] sc1
  global_load_dwordx2 v[114:115], v173, s[30:31] sc1
  global_load_dwordx2 v[116:117], v174, s[30:31] sc1
  global_load_dwordx2 v[118:119], v175, s[30:31] sc1
  global_load_dwordx2 v[120:121], v176, s[30:31] sc1
  global_load_dwordx2 v[122:123], v177, s[30:31] sc1
  global_load_dwordx2 v[124:125], v178, s[30:31] sc1
  global_load_dwordx2 v[126:127], v179, s[30:31] sc1
  global_load_dwordx2 v[128:129], v180, s[30:31] sc1
  global_load_dwordx2 v[130:131], v181, s[30:31] sc1
  global_load_dwordx2 v[132:133], v182, s[30:31] sc1
  global_load_dwordx2 v[134:135], v183, s[30:31] sc1
  global_load_dwordx2 v[136:137], v184, s[30:31] sc1
  global_load_dwordx2 v[138:139], v185, s[30:31] sc1
  global_load_dwordx2 v[140:141], v186, s[30:31] sc1
  s_waitcnt vmcnt(15)
  v_mov_b32 v23, v55
  v_mov_b32 v24, v52
  s_nop 1
  v_max_f32_dpp v24, v24, v24 row_ror:8 row_mask:0xf bank_mask:0xf
  s_nop 1
  v_max_f32_dpp v24, v24, v24 row_ror:4 row_mask:0xf bank_mask:0xf
  s_nop 1
  v_max_f32_dpp v24, v24, v24 row_ror:2 row_mask:0xf bank_mask:0xf
  s_nop 1
  v_max_f32_dpp v24, v24, v24 row_ror:1 row_mask:0xf bank_mask:0xf
  v_sub_f32 v24, v52, v24
  v_exp_f32 v24, v24
  v_subrev_u32 v55, 256, v55
  v_mul_f32 v25, v24, v53
  s_nop 1
  v_add_f32_dpp v25, v25, v25 row_ror:8 row_mask:0xf bank_mask:0xf
  s_nop 1
  v_add_f32_dpp v25, v25, v25 row_ror:4 row_mask:0xf bank_mask:0xf
  s_nop 1
  v_add_f32_dpp v25, v25, v25 row_ror:2 row_mask:0xf bank_mask:0xf
  s_nop 1
  v_add_f32_dpp v25, v25, v25 row_ror:1 row_mask:0xf bank_mask:0xf
  v_rcp_f32 v25, v25
  s_nop 0
  v_mul_f32 v24, v24, v25
  v_ldexp_f32 v25, v24, v55
  v_mul_f32_e64 v54, v24, -v54
  v_readlane_b32 s63, v24, 15
  v_readlane_b32 s44, v54, 15
  v_readlane_b32 s48, v25, 0
  v_readlane_b32 s49, v25, 1
  v_readlane_b32 s50, v25, 2
  v_readlane_b32 s51, v25, 3
  v_readlane_b32 s52, v25, 4
  v_readlane_b32 s53, v25, 5
  v_readlane_b32 s54, v25, 6
  v_readlane_b32 s55, v25, 7
  v_readlane_b32 s56, v25, 8
  v_readlane_b32 s57, v25, 9
  v_readlane_b32 s58, v25, 10
  v_readlane_b32 s59, v25, 11
  v_readlane_b32 s60, v25, 12
  v_readlane_b32 s61, v25, 13
  v_readlane_b32 s62, v25, 14
  v_mov_b32 v108, s44
  v_mov_b32 v109, s44
  v_mov_b32 v110, s44
  v_mov_b32 v111, s44
  s_waitcnt vmcnt(14)
  v_max3_u32 v23, v23, v112, v113
  v_fma_mix_f32 v108, v112, s48, v108 op_sel:[0,0,0] op_sel_hi:[1,0,0]
  v_fma_mix_f32 v109, v112, s48, v109 op_sel:[1,0,0] op_sel_hi:[1,0,0]
  v_fma_mix_f32 v110, v113, s48, v110 op_sel:[0,0,0] op_sel_hi:[1,0,0]
  v_fma_mix_f32 v111, v113, s48, v111 op_sel:[1,0,0] op_sel_hi:[1,0,0]
  s_waitcnt vmcnt(13)
  v_max3_u32 v23, v23, v114, v115
  v_fma_mix_f32 v108, v114, s49, v108 op_sel:[0,0,0] op_sel_hi:[1,0,0]
  v_fma_mix_f32 v109, v114, s49, v109 op_sel:[1,0,0] op_sel_hi:[1,0,0]
  v_fma_mix_f32 v110, v115, s49, v110 op_sel:[0,0,0] op_sel_hi:[1,0,0]
  v_fma_mix_f32 v111, v115, s49, v111 op_sel:[1,0,0] op_sel_hi:[1,0,0]
  s_waitcnt vmcnt(12)
  v_max3_u32 v23, v23, v116, v117
  v_fma_mix_f32 v108, v116, s50, v108 op_sel:[0,0,0] op_sel_hi:[1,0,0]
  v_fma_mix_f32 v109, v116, s50, v109 op_sel:[1,0,0] op_sel_hi:[1,0,0]
  v_fma_mix_f32 v110, v117, s50, v110 op_sel:[0,0,0] op_sel_hi:[1,0,0]
  v_fma_mix_f32 v111, v117, s50, v111 op_sel:[1,0,0] op_sel_hi:[1,0,0]
  s_waitcnt vmcnt(11)
  v_max3_u32 v23, v23, v118, v119
  v_fma_mix_f32 v108, v118, s51, v108 op_sel:[0,0,0] op_sel_hi:[1,0,0]
  v_fma_mix_f32 v109, v118, s51, v109 op_sel:[1,0,0] op_sel_hi:[1,0,0]
  v_fma_mix_f32 v110, v119, s51, v110 op_sel:[0,0,0] op_sel_hi:[1,0,0]
  v_fma_mix_f32 v111, v119, s51, v111 op_sel:[1,0,0] op_sel_hi:[1,0,0]
  s_waitcnt vmcnt(10)
  v_max3_u32 v23, v23, v120, v121
  v_fma_mix_f32 v108, v120, s52, v108 op_sel:[0,0,0] op_sel_hi:[1,0,0]
  v_fma_mix_f32 v109, v120, s52, v109 op_sel:[1,0,0] op_sel_hi:[1,0,0]
  v_fma_mix_f32 v110, v121, s52, v110 op_sel:[0,0,0] op_sel_hi:[1,0,0]
  v_fma_mix_f32 v111, v121, s52, v111 op_sel:[1,0,0] op_sel_hi:[1,0,0]
  s_waitcnt vmcnt(9)
  v_max3_u32 v23, v23, v122, v123
  v_fma_mix_f32 v108, v122, s53, v108 op_sel:[0,0,0] op_sel_hi:[1,0,0]
  v_fma_mix_f32 v109, v122, s53, v109 op_sel:[1,0,0] op_sel_hi:[1,0,0]
  v_fma_mix_f32 v110, v123, s53, v110 op_sel:[0,0,0] op_sel_hi:[1,0,0]
  v_fma_mix_f32 v111, v123, s53, v111 op_sel:[1,0,0] op_sel_hi:[1,0,0]
  s_waitcnt vmcnt(8)
  v_max3_u32 v23, v23, v124, v125
  v_fma_mix_f32 v108, v124, s54, v108 op_sel:[0,0,0] op_sel_hi:[1,0,0]
  v_fma_mix_f32 v109, v124, s54, v109 op_sel:[1,0,0] op_sel_hi:[1,0,0]
  v_fma_mix_f32 v110, v125, s54, v110 op_sel:[0,0,0] op_sel_hi:[1,0,0]
  v_fma_mix_f32 v111, v125, s54, v111 op_sel:[1,0,0] op_sel_hi:[1,0,0]
  s_waitcnt vmcnt(7)
  v_max3_u32 v23, v23, v126, v127
  v_fma_mix_f32 v108, v126, s55, v108 op_sel:[0,0,0] op_sel_hi:[1,0,0]
  v_fma_mix_f32 v109, v126, s55, v109 op_sel:[1,0,0] op_sel_hi:[1,0,0]
  v_fma_mix_f32 v110, v127, s55, v110 op_sel:[0,0,0] op_sel_hi:[1,0,0]
  v_fma_mix_f32 v111, v127, s55, v111 op_sel:[1,0,0] op_sel_hi:[1,0,0]
  s_waitcnt vmcnt(6)
  v_max3_u32 v23, v23, v128, v129
  v_fma_mix_f32 v108, v128, s56, v108 op_sel:[0,0,0] op_sel_hi:[1,0,0]
  v_fma_mix_f32 v109, v128, s56, v109 op_sel:[1,0,0] op_sel_hi:[1,0,0]
  v_fma_mix_f32 v110, v129, s56, v110 op_sel:[0,0,0] op_sel_hi:[1,0,0]
  v_fma_mix_f32 v111, v129, s56, v111 op_sel:[1,0,0] op_sel_hi:[1,0,0]
  s_waitcnt vmcnt(5)
  v_max3_u32 v23, v23, v130, v131
  v_fma_mix_f32 v108, v130, s57, v108 op_sel:[0,0,0] op_sel_hi:[1,0,0]
  v_fma_mix_f32 v109, v130, s57, v109 op_sel:[1,0,0] op_sel_hi:[1,0,0]
  v_fma_mix_f32 v110, v131, s57, v110 op_sel:[0,0,0] op_sel_hi:[1,0,0]
  v_fma_mix_f32 v111, v131, s57, v111 op_sel:[1,0,0] op_sel_hi:[1,0,0]
  s_waitcnt vmcnt(4)
  v_max3_u32 v23, v23, v132, v133
  v_fma_mix_f32 v108, v132, s58, v108 op_sel:[0,0,0] op_sel_hi:[1,0,0]
  v_fma_mix_f32 v109, v132, s58, v109 op_sel:[1,0,0] op_sel_hi:[1,0,0]
  v_fma_mix_f32 v110, v133, s58, v110 op_sel:[0,0,0] op_sel_hi:[1,0,0]
  v_fma_mix_f32 v111, v133, s58, v111 op_sel:[1,0,0] op_sel_hi:[1,0,0]
  s_waitcnt vmcnt(3)
  v_max3_u32 v23, v23, v134, v135
  v_fma_mix_f32 v108, v134, s59, v108 op_sel:[0,0,0] op_sel_hi:[1,0,0]
  v_fma_mix_f32 v109, v134, s59, v109 op_sel:[1,0,0] op_sel_hi:[1,0,0]
  v_fma_mix_f32 v110, v135, s59, v110 op_sel:[0,0,0] op_sel_hi:[1,0,0]
  v_fma_mix_f32 v111, v135, s59, v111 op_sel:[1,0,0] op_sel_hi:[1,0,0]
  s_waitcnt vmcnt(2)
  v_max3_u32 v23, v23, v136, v137
  v_fma_mix_f32 v108, v136, s60, v108 op_sel:[0,0,0] op_sel_hi:[1,0,0]
  v_fma_mix_f32 v109, v136, s60, v109 op_sel:[1,0,0] op_sel_hi:[1,0,0]
  v_fma_mix_f32 v110, v137, s60, v110 op_sel:[0,0,0] op_sel_hi:[1,0,0]
  v_fma_mix_f32 v111, v137, s60, v111 op_sel:[1,0,0] op_sel_hi:[1,0,0]
  s_waitcnt vmcnt(1)
  v_max3_u32 v23, v23, v138, v139
  v_fma_mix_f32 v108, v138, s61, v108 op_sel:[0,0,0] op_sel_hi:[1,0,0]
  v_fma_mix_f32 v109, v138, s61, v109 op_sel:[1,0,0] op_sel_hi:[1,0,0]
  v_fma_mix_f32 v110, v139, s61, v110 op_sel:[0,0,0] op_sel_hi:[1,0,0]
  v_fma_mix_f32 v111, v139, s61, v111 op_sel:[1,0,0] op_sel_hi:[1,0,0]
  s_waitcnt vmcnt(0)
  v_max3_u32 v23, v23, v140, v141
  v_cmp_eq_u32 s[64:65], -1, v23
  v_fma_mix_f32 v108, v140, s62, v108 op_sel:[0,0,0] op_sel_hi:[1,0,0]
  v_fma_mix_f32 v109, v140, s62, v109 op_sel:[1,0,0] op_sel_hi:[1,0,0]
  v_fma_mix_f32 v110, v141, s62, v110 op_sel:[0,0,0] op_sel_hi:[1,0,0]
  v_fma_mix_f32 v111, v141, s62, v111 op_sel:[1,0,0] op_sel_hi:[1,0,0]
  s_cmp_eq_u64 s[64:65], 0
  s_cbranch_scc1 L_hg_ok
  s_cmp_eq_u32 s94, 0
  s_cbranch_scc1 L_hg_ok
  s_sub_u32 s94, s94, 1
  s_branch L_hg
L_hg_ok:
  s_mov_b32 exec_hi, 0xffff
  s_barrier
  ds_read_b128 v[72:75], v196 offset:0
  ds_read_b128 v[76:79], v197 offset:768
  ds_read_b128 v[80:83], v198 offset:1536
  ds_read_b128 v[84:87], v196 offset:2304
  s_waitcnt lgkmcnt(3)
  v_fmac_f32 v108, s63, v72
  v_fmac_f32 v109, s63, v73
  v_fmac_f32 v110, s63, v74
  v_fmac_f32 v111, s63, v75
  s_waitcnt lgkmcnt(2)
  v_fmac_f32 v108, s63, v76
  v_fmac_f32 v109, s63, v77
  v_fmac_f32 v110, s63, v78
  v_fmac_f32 v111, s63, v79
  s_waitcnt lgkmcnt(1)
  v_fmac_f32 v108, s63, v80
  v_fmac_f32 v109, s63, v81
  v_fmac_f32 v110, s63, v82
  v_fmac_f32 v111, s63, v83
  s_waitcnt lgkmcnt(0)
  v_fmac_f32 v108, s63, v84
  v_fmac_f32 v109, s63, v85
  v_fmac_f32 v110, s63, v86
  v_fmac_f32 v111, s63, v87
  v_cvt_pk_bf16_f32 v108, v108, v109
  v_cvt_pk_bf16_f32 v109, v110, v111
  global_store_dwordx2 v21, v[108:109], s[26:27]
L_end:
  s_endpgm
.p2align 6
.type L_order,@object
L_order:
  .long 0x76afedcb, 0x24351098, 0x200000, 0x500, 0x20, 0x251200, 0x2, 0x0
  .long 0x2c001c, 0x4c003c, 0x6c005c, 0x8c007c, 0xac009c, 0xcc00bc, 0xec00dc, 0xf00fc
  .long 0x56afedcb, 0x74321098, 0xe00000, 0x0, 0x70, 0x201e00, 0x7, 0x0
  .long 0x270007, 0x470037, 0x670057, 0x870077, 0xa70097, 0xc700b7, 0xe700d7, 0x1f00f7
  .long 0x765fedcb, 0xa4321098, 0xd00000, 0xf00, 0xaf, 0x1d002f, 0xa, 0x0
  .long 0xa10042, 0x37000c4, 0x53103f4, 0x80205b2, 0xa140881, 0xd540a91, 0xdd20d61, 0x2f0de3
  .long 0x75afedcb, 0x64321098, 0x500000, 0x400, 0x60, 0x241500, 0x6, 0x0
  .long 0x160006, 0x460026, 0x660056, 0x860076, 0xa60096, 0xc600b6, 0xe600d6, 0x3f00f6
  .long 0x765feacb, 0xd4321098, 0x900000, 0xf00, 0xd0, 0x2f1900, 0xd, 0x0
  .long 0x120002, 0x320022, 0x620052, 0x820072, 0xa20092, 0xc200b2, 0xe200d2, 0x4f00f2
  .long 0x765fadcb, 0xe4321098, 0x800000, 0xc00, 0xe0, 0x2c1800, 0xe, 0x0
  .long 0x130003, 0x330023, 0x630043, 0x830073, 0xa30093, 0xc300b3, 0xe300d3, 0x5f00f3
  .long 0x76afedcb, 0x34521098, 0x300000, 0x700, 0x30, 0x271300, 0x3, 0x0
  .long 0x1d000d, 0x3d002d, 0x5d004d, 0x8d007d, 0xad009d, 0xcd00bd, 0xed00dd, 0x6f00fd
  .long 0x76afedcb, 0x54321098, 0x400000, 0x400, 0x54, 0x240014, 0x5, 0x0
  .long 0x1ca00fb, 0x68e060c, 0xa3e084a, 0xaea0abc, 0xc6d0bdc, 0xe2d0e1c, 0xe9e0e5b, 0x7f0eaa
  .long 0x76afedcb, 0x45321098, 0x200000, 0x500, 0x40, 0x251200, 0x4, 0x0
  .long 0x1e000e, 0x3e002e, 0x5e004e, 0x7e006e, 0xae009e, 0xce00be, 0xee00de, 0x8f00fe
  .long 0x76afedcb, 0x84321095, 0xe00000, 0x0, 0x80, 0x201e00, 0x8, 0x0
  .long 0x180008, 0x380028, 0x580048, 0x780068, 0xa80088, 0xc800b8, 0xe800d8, 0x9f00f8
  .long 0x765fedab, 0xc4321098, 0xd00000, 0xf00, 0xc0, 0x2f1d00, 0xc, 0x0
  .long 0x110001, 0x310021, 0x510041, 0x710061, 0x910081, 0xc100b1, 0xe100d1, 0xaf00f1
  .long 0x76afedcb, 0x94321058, 0x500000, 0x400, 0x90, 0x241500, 0x9, 0x0
  .long 0x190009, 0x390029, 0x590049, 0x790069, 0x990089, 0xc900a9, 0xe900d9, 0xbf00f9
  .long 0x765aedcb, 0xf4321098, 0x900000, 0xf00, 0xf0, 0x2f1900, 0xf, 0x0
  .long 0x140004, 0x340024, 0x540044, 0x740064, 0x940084, 0xb400a4, 0xe400d4, 0xcf00f4
  .long 0x765fedca, 0xb4321098, 0x800000, 0xc00, 0xb0, 0x2c1800, 0xb, 0x0
  .long 0x100000, 0x300020, 0x500040, 0x700060, 0x900080, 0xb000a0, 0xe000c0, 0xdf00f0
  .long 0x76afedcb, 0x4321598, 0x300000, 0x700, 0x0, 0x271300, 0x0, 0x0
  .long 0x1a000a, 0x3a002a, 0x5a004a, 0x7a006a, 0x9a008a, 0xba00aa, 0xda00ca, 0xef00fa
  .long 0x76afedcb, 0x14325098, 0x400000, 0x400, 0x10, 0x241400, 0x1, 0x0
  .long 0x1b000b, 0x3b002b, 0x5b004b, 0x7b006b, 0x9b008b, 0xbb00ab, 0xdb00cb, 0xff00eb
  .long 0x765fadcb, 0xe4321098, 0x11b11111, 0x11111e11, 0xe1, 0x2e1b01, 0xe, 0x0
  .long 0x1230113, 0x1430133, 0x1630153, 0x1830173, 0x1a30193, 0x1c301b3, 0x1e301d3, 0x10f01f3
  .long 0x765fedcb, 0x8432109a, 0x11c11111, 0x11111911, 0x81, 0x291c01, 0x8, 0x0
  .long 0x1280108, 0x1480138, 0x1680158, 0x1880178, 0x1a80198, 0x1c801b8, 0x1e801d8, 0x11f01f8
  .long 0x76afedcb, 0x94321058, 0x11911111, 0x11111711, 0x91, 0x271901, 0x9, 0x0
  .long 0x1190109, 0x1490139, 0x1690159, 0x1890179, 0x1a90199, 0x1c901b9, 0x1e901d9, 0x12f01f9
  .long 0x765aedcb, 0xf4321098, 0x11911111, 0x11111d11, 0xf1, 0x2d1901, 0xf, 0x0
  .long 0x1140104, 0x1440124, 0x1640154, 0x1840174, 0x1a40194, 0x1c401b4, 0x1e401d4, 0x13f01f4
  .long 0x765fedab, 0xc4321098, 0x11a11111, 0x11111d11, 0xc1, 0x2d1a01, 0xc, 0x0
  .long 0x1110101, 0x1310121, 0x1610151, 0x1810171, 0x1a10191, 0x1c101b1, 0x1e101d1, 0x14f01f1
  .long 0x76afedcb, 0x34521098, 0x11311111, 0x11111511, 0x31, 0x251301, 0x3, 0x0
  .long 0x11d010d, 0x13d012d, 0x16d014d, 0x18d017d, 0x1ad019d, 0x1cd01bd, 0x1ed01dd, 0x15f01fd
  .long 0xa65fedcb, 0x74321098, 0x11911111, 0x11111511, 0x71, 0x251901, 0x7, 0x0
  .long 0x1170107, 0x1370127, 0x1570147, 0x1870177, 0x1a70197, 0x1c701b7, 0x1e701d7, 0x16f01f7
  .long 0x76afedcb, 0x24351098, 0x11011111, 0x11111211, 0x21, 0x221001, 0x2, 0x0
  .long 0x11c010c, 0x13c012c, 0x15c014c, 0x18c016c, 0x1ac019c, 0x1cc01bc, 0x1ec01dc, 0x17f01fc
  .long 0x765fedca, 0xb4321098, 0x11b11111, 0x11111e11, 0xb1, 0x2e1b01, 0xb, 0x0
  .long 0x1100100, 0x1300120, 0x1500140, 0x1700160, 0x1a00190, 0x1c001b0, 0x1e001d0, 0x18f01f0
  .long 0x7a5fedcb, 0x64321098, 0x11c11111, 0x11111911, 0x61, 0x291c01, 0x6, 0x0
  .long 0x1160106, 0x1360126, 0x1560146, 0x1760166, 0x1a60186, 0x1c601b6, 0x1e601d6, 0x19f01f6
  .long 0x76afedcb, 0x54321098, 0x11911111, 0x11111711, 0x59, 0x270119, 0x5, 0x0
  .long 0xc50045, 0x1350129, 0x1b50165, 0x25601e5, 0xd1502d7, 0xe050d95, 0xf750e85, 0x1af0ff5
  .long 0x765feacb, 0xd4321098, 0x11911111, 0x11111d11, 0xd1, 0x2d1901, 0xd, 0x0
  .long 0x1120102, 0x1320122, 0x1520142, 0x1720162, 0x1920182, 0x1c201a2, 0x1e201d2, 0x1bf01f2
  .long 0x76afedcb, 0x4321598, 0x11411111, 0x11111211, 0x1, 0x221401, 0x0, 0x0
  .long 0x11a010a, 0x13a012a, 0x15a014a, 0x17a016a, 0x19a018a, 0x1ba01aa, 0x1ea01da, 0x1cf01fa
  .long 0x76afedcb, 0x14325098, 0x11311111, 0x11111511, 0x11, 0x251301, 0x1, 0x0
  .long 0x11b010b, 0x13b012b, 0x15b014b, 0x17b016b, 0x19b018b, 0x1bb01ab, 0x1eb01cb, 0x1df01fb
  .long 0x765fedcb, 0xa4321098, 0x11911111, 0x11111511, 0xa5, 0x190125, 0xa, 0x0
  .long 0x850005, 0x1670155, 0x42501d5, 0x91504a5, 0x9950975, 0xc4509f5, 0xe350cc5, 0x1ef0eb5
  .long 0x76afedcb, 0x45321098, 0x11011111, 0x11111211, 0x41, 0x221001, 0x4, 0x0
  .long 0x11e010e, 0x13e012e, 0x15e014e, 0x17e016e, 0x19e018e, 0x1be01ae, 0x1de01ce, 0x1ff01ee
  .long 0x76afedcb, 0x34521098, 0x22122222, 0x22222322, 0x32, 0x231102, 0x3, 0x0
  .long 0x22d021d, 0x24d023d, 0x26d025d, 0x28d027d, 0x2ad029d, 0x2cd02bd, 0x2ed02dd, 0x20f02fd
  .long 0x76afedcb, 0x54321098, 0x22f22222, 0x22222622, 0x5f, 0x26021f, 0x5, 0x0
  .long 0x2990235, 0x40502b5, 0x5250485, 0x66505a5, 0x74506e5, 0x7c50779, 0xf5507f7, 0x21f0fd5
  .long 0x765fedcb, 0xa4321098, 0x22822222, 0x22222622, 0xa6, 0x180226, 0xa, 0x0
  .long 0x2550215, 0x2a80295, 0x60502d5, 0x6450635, 0x6b50685, 0x77506c5, 0xb6507f5, 0x22f0be5
  .long 0x765aedcb, 0xf4321098, 0x22f22222, 0x22222c22, 0xf2, 0x2c1f02, 0xf, 0x0
  .long 0x2140204, 0x2440224, 0x2640254, 0x2840274, 0x2a40294, 0x2c402b4, 0x2e402d4, 0x23f02f4
  .long 0x76afedcb, 0x24351098, 0x22022222, 0x22222122, 0x22, 0x211002, 0x2, 0x0
  .long 0x21c020c, 0x23c022c, 0x26c025c, 0x28c027c, 0x2ac029c, 0x2cc02bc, 0x2ec02dc, 0x24f02fc
  .long 0x75afedcb, 0x64321098, 0x22922222, 0x22222622, 0x62, 0x261902, 0x6, 0x0
  .long 0x2160206, 0x2360226, 0x2660246, 0x2860276, 0x2a60296, 0x2c602b6, 0x2e602d6, 0x25f02f6
  .long 0x765feacb, 0xd4321098, 0x22a22222, 0x22222e22, 0xd2, 0x2e1a02, 0xd, 0x0
  .long 0x2120202, 0x2320222, 0x2520242, 0x2820272, 0x2a20292, 0x2c202b2, 0x2e202d2, 0x26f02f2
  .long 0x76afedcb, 0x14325098, 0x22122222, 0x22222922, 0x12, 0x291102, 0x1, 0x0
  .long 0x21b020b, 0x23b022b, 0x25b024b, 0x28b026b, 0x2ab029b, 0x2cb02bb, 0x2eb02db, 0x27f02fb
  .long 0x76afedcb, 0x4321598, 0x22122222, 0x22222322, 0x2, 0x231102, 0x0, 0x0
  .long 0x21a020a, 0x23a022a, 0x25a024a, 0x27a026a, 0x2aa029a, 0x2ca02ba, 0x2ea02da, 0x28f02fa
  .long 0x76afedcb, 0x94321058, 0x22f22222, 0x22222622, 0x92, 0x261f02, 0x9, 0x0
  .long 0x2190209, 0x2390229, 0x2590249, 0x2790269, 0x2a90289, 0x2c902b9, 0x2e902d9, 0x29f02f9
  .long 0x765fedcb, 0x8432109a, 0x22822222, 0x22222622, 0x82, 0x261802, 0x8, 0x0
  .long 0x2180208, 0x2380228, 0x2580248, 0x2780268, 0x2980288, 0x2c802b8, 0x2e802d8, 0x2af02f8
  .long 0x765fedca, 0xb4321098, 0x22f22222, 0x22222c22, 0xb2, 0x2c1f02, 0xb, 0x0
  .long 0x2100200, 0x2300220, 0x2500240, 0x2700260, 0x2900280, 0x2c002a0, 0x2e002d0, 0x2bf02f0
  .long 0x76afedcb, 0x45321098, 0x22022222, 0x22222122, 0x42, 0x211002, 0x4, 0x0
  .long 0x21e020e, 0x23e022e, 0x25e024e, 0x27e026e, 0x29e028e, 0x2be02ae, 0x2ee02de, 0x2cf02fe
  .long 0x56afedcb, 0x74321098, 0x22922222, 0x22222622, 0x72, 0x261902, 0x7, 0x0
  .long 0x2170207, 0x2370227, 0x2570247, 0x2770267, 0x2970287, 0x2b702a7, 0x2e702c7, 0x2df02f7
  .long 0x765fadcb, 0xe4321098, 0x22a22222, 0x22222e22, 0xe2, 0x2e1a02, 0xe, 0x0
  .long 0x2130203, 0x2330223, 0x2530243, 0x2730263, 0x2930283, 0x2b302a3, 0x2d302c3, 0x2ef02f3
  .long 0x765fedab, 0xc4321098, 0x22b22222, 0x22222c22, 0xc2, 0x2c1b02, 0xc, 0x0
  .long 0x2110201, 0x2310221, 0x2510241, 0x2710261, 0x2910281, 0x2b102a1, 0x2d102c1, 0x2ff02e1
  .long 0xa65fedcb, 0x74321098, 0x33633333, 0x33333933, 0x73, 0x291603, 0x7, 0x0
  .long 0x3270317, 0x3470337, 0x3670357, 0x3870377, 0x3a70397, 0x3c703b7, 0x3e703d7, 0x30f03f7
  .long 0x765feacb, 0xd4321098, 0x33a33333, 0x33333e33, 0xd3, 0x2e1a03, 0xd, 0x0
  .long 0x3220302, 0x3420332, 0x3620352, 0x3820372, 0x3a20392, 0x3c203b2, 0x3e203d2, 0x31f03f2
  .long 0x76afedcb, 0x24351098, 0x33133333, 0x33333433, 0x23, 0x241103, 0x2, 0x0
  .long 0x31c030c, 0x34c033c, 0x36c035c, 0x38c037c, 0x3ac039c, 0x3cc03bc, 0x3ec03dc, 0x32f03fc
  .long 0x765fedab, 0xc4321098, 0x33e33333, 0x33333e33, 0xc3, 0x2e1e03, 0xc, 0x0
  .long 0x3110301, 0x3410321, 0x3610351, 0x3810371, 0x3a10391, 0x3c103b1, 0x3e103d1, 0x33f03f1
  .long 0x76afedcb, 0x54321098, 0x33333333, 0x33333333, 0x53, 0x230313, 0x5, 0x0
  .long 0xea006d, 0x1db015d, 0x81b03ca, 0x92e089d, 0x9aa093b, 0xb7e09bc, 0xd0e0bfb, 0x34f0d8a
  .long 0x75afedcb, 0x64321098, 0x33d33333, 0x33333833, 0x63, 0x281d03, 0x6, 0x0
  .long 0x3160306, 0x3360326, 0x3660346, 0x3860376, 0x3a60396, 0x3c603b6, 0x3e603d6, 0x35f03f6
  .long 0x76afedcb, 0x45321098, 0x33033333, 0x33333033, 0x43, 0x201003, 0x4, 0x0
  .long 0x31e030e, 0x33e032e, 0x35e034e, 0x38e037e, 0x3ae039e, 0x3ce03be, 0x3ee03de, 0x36f03fe
  .long 0x765fedca, 0xb4321098, 0x33833333, 0x33333f33, 0xb3, 0x2f1803, 0xb, 0x0
  .long 0x3100300, 0x3300320, 0x3500340, 0x3800360, 0x3a00390, 0x3c003b0, 0x3e003d0, 0x37f03f0
  .long 0x765fedcb, 0x8432109a, 0x33633333, 0x33333933, 0x83, 0x291603, 0x8, 0x0
  .long 0x3180308, 0x3380328, 0x3580348, 0x3780368, 0x3a80398, 0x3c803b8, 0x3e803d8, 0x38f03f8
  .long 0x765fedcb, 0xa4321098, 0x33a33333, 0x33333e33, 0xae, 0x1a032e, 0xa, 0x0
  .long 0x1800103, 0x2e30262, 0x3310312, 0x67103b3, 0x72306f4, 0x94407a1, 0xf5209c2, 0x39f0fd1
  .long 0x76afedcb, 0x34521098, 0x33133333, 0x33333433, 0x33, 0x241103, 0x3, 0x0
  .long 0x31d030d, 0x33d032d, 0x35d034d, 0x37d036d, 0x39d038d, 0x3cd03bd, 0x3ed03dd, 0x3af03fd
  .long 0x765fadcb, 0xe4321098, 0x33e33333, 0x33333e33, 0xe3, 0x2e1e03, 0xe, 0x0
  .long 0x3130303, 0x3330323, 0x3530343, 0x3730363, 0x3930383, 0x3c303a3, 0x3e303d3, 0x3bf03f3
  .long 0x76afedcb, 0x4321598, 0x33333333, 0x33333333, 0x3, 0x231303, 0x0, 0x0
  .long 0x31a030a, 0x33a032a, 0x35a034a, 0x37a036a, 0x39a038a, 0x3ba03aa, 0x3ea03da, 0x3cf03fa
  .long 0x76afedcb, 0x94321058, 0x33d33333, 0x33333833, 0x93, 0x281d03, 0x9, 0x0
  .long 0x3190309, 0x3390329, 0x3590349, 0x3790369, 0x3990389, 0x3b903a9, 0x3e903c9, 0x3df03f9
  .long 0x76afedcb, 0x14325098, 0x33033333, 0x33333033, 0x13, 0x201003, 0x1, 0x0
  .long 0x31b030b, 0x33b032b, 0x35b034b, 0x37b036b, 0x39b038b, 0x3bb03ab, 0x3db03cb, 0x3ef03fb
  .long 0x765aedcb, 0xf4321098, 0x33833333, 0x33333f33, 0xf3, 0x2f1803, 0xf, 0x0
  .long 0x3140304, 0x3340324, 0x3540344, 0x3740364, 0x3940384, 0x3b403a4, 0x3d403c4, 0x3ff03e4
  .long 0x7a5fedcb, 0x64321098, 0x44f44444, 0x44444044, 0x64, 0x201f04, 0x6, 0x0
  .long 0x4260416, 0x4460436, 0x4660456, 0x4860476, 0x4a60496, 0x4c604b6, 0x4e604d6, 0x40f04f6
  .long 0x76afedcb, 0x45321098, 0x44144444, 0x44444344, 0x44, 0x231104, 0x4, 0x0
  .long 0x42e040e, 0x44e043e, 0x46e045e, 0x48e047e, 0x4ae049e, 0x4ce04be, 0x4ee04de, 0x41f04fe
  .long 0x76afedcb, 0x34521098, 0x44244444, 0x44444544, 0x34, 0x251204, 0x3, 0x0
  .long 0x41d040d, 0x44d043d, 0x46d045d, 0x48d047d, 0x4ad049d, 0x4cd04bd, 0x4ed04dd, 0x42f04fd
  .long 0x76afedcb, 0x14325098, 0x44144444, 0x44444344, 0x14, 0x231104, 0x1, 0x0
  .long 0x41b040b, 0x44b042b, 0x46b045b, 0x48b047b, 0x4ab049b, 0x4cb04bb, 0x4eb04db, 0x43f04fb
  .long 0x765fadcb, 0xe4321098, 0x44744444, 0x44444c44, 0xe4, 0x2c1704, 0xe, 0x0
  .long 0x4130403, 0x4330423, 0x4630453, 0x4830473, 0x4a30493, 0x4c304b3, 0x4e304d3, 0x44f04f3
  .long 0x765fedcb, 0xa4321098, 0x44644444, 0x44444b44, 0xab, 0x16042b, 0xa, 0x0
  .long 0x52404d1, 0x70405a0, 0xa630782, 0xbb40b31, 0xc920c10, 0xe410ce1, 0xf700ec2, 0x45f0ff3
  .long 0xa65fedcb, 0x74321098, 0x44744444, 0x44444344, 0x74, 0x231704, 0x7, 0x0
  .long 0x4170407, 0x4370427, 0x4570447, 0x4870477, 0x4a70497, 0x4c704b7, 0x4e704d7, 0x46f04f7
  .long 0x765fedca, 0xb4321098, 0x44644444, 0x44444d44, 0xb4, 0x2d1604, 0xb, 0x0
  .long 0x4100400, 0x4300420, 0x4500440, 0x4800460, 0x4a00490, 0x4c004b0, 0x4e004d0, 0x47f04f0
  .long 0x765fedcb, 0x8432109a, 0x44f44444, 0x44444044, 0x84, 0x201f04, 0x8, 0x0
  .long 0x4180408, 0x4380428, 0x4580448, 0x4780468, 0x4a80498, 0x4c804b8, 0x4e804d8, 0x48f04f8
  .long 0x76afedcb, 0x54321098, 0x44144444, 0x44444344, 0x51, 0x230411, 0x5, 0x0
  .long 0x27b020d, 0x32c028a, 0x41e03ad, 0x4ba043b, 0xb6a05fe, 0xc5b0bed, 0xd4b0cdc, 0x49f0dcd
  .long 0x76afedcb, 0x24351098, 0x44244444, 0x44444544, 0x24, 0x251204, 0x2, 0x0
  .long 0x41c040c, 0x43c042c, 0x45c044c, 0x47c046c, 0x49c048c, 0x4cc04bc, 0x4ec04dc, 0x4af04fc
  .long 0x76afedcb, 0x4321598, 0x44144444, 0x44444344, 0x4, 0x231104, 0x0, 0x0
  .long 0x41a040a, 0x43a042a, 0x45a044a, 0x47a046a, 0x49a048a, 0x4ca04aa, 0x4ea04da, 0x4bf04fa
  .long 0x765aedcb, 0xf4321098, 0x44744444, 0x44444c44, 0xf4, 0x2c1704, 0xf, 0x0
  .long 0x4140404, 0x4340424, 0x4540444, 0x4740464, 0x4940484, 0x4b404a4, 0x4e404d4, 0x4cf04f4
  .long 0x765fedab, 0xc4321098, 0x44644444, 0x44444b44, 0xc4, 0x2b1604, 0xc, 0x0
  .long 0x4110401, 0x4310421, 0x4510441, 0x4710461, 0x4910481, 0x4b104a1, 0x4e104c1, 0x4df04f1
  .long 0x765fedcb, 0x943210a8, 0x44744444, 0x44444344, 0x94, 0x231704, 0x9, 0x0
  .long 0x4190409, 0x4390429, 0x4590449, 0x4790469, 0x4990489, 0x4b904a9, 0x4d904c9, 0x4ef04f9
  .long 0x765feacb, 0xd4321098, 0x44644444, 0x44444d44, 0xd4, 0x2d1604, 0xd, 0x0
  .long 0x4120402, 0x4320422, 0x4520442, 0x4720462, 0x4920482, 0x4b204a2, 0x4d204c2, 0x4ff04e2
  .long 0x76afedcb, 0x24351098, 0x55055555, 0x55555155, 0x25, 0x211005, 0x2, 0x0
  .long 0x52c051c, 0x54c053c, 0x56c055c, 0x58c057c, 0x5ac059c, 0x5cc05bc, 0x5ec05dc, 0x50f05fc
  .long 0x76afedcb, 0x54321098, 0x55b55555, 0x55555755, 0x5b, 0x27051b, 0x5, 0x0
  .long 0x1850105, 0x53502f5, 0x5980575, 0x72505b5, 0x95507a5, 0xe4509d5, 0xf650ec5, 0x51f0fe5
  .long 0x765aedcb, 0xf4321098, 0x55f55555, 0x55555b55, 0xf5, 0x2b1f05, 0xf, 0x0
  .long 0x5140504, 0x5440534, 0x5640554, 0x5840574, 0x5a40594, 0x5c405b4, 0x5e405d4, 0x52f05f4
  .long 0x765fedab, 0xc4321098, 0x55b55555, 0x55555f55, 0xc5, 0x2f1b05, 0xc, 0x0
  .long 0x5110501, 0x5410521, 0x5610551, 0x5810571, 0x5a10591, 0x5c105b1, 0x5e105d1, 0x53f05f1
  .long 0x765fedcb, 0x943210a8, 0x55855555, 0x55555955, 0x95, 0x291805, 0x9, 0x0
  .long 0x5190509, 0x5390529, 0x5690559, 0x5890579, 0x5a90599, 0x5c905b9, 0x5e905d9, 0x54f05f9
  .long 0x765fedcb, 0xa4321098, 0x55a55555, 0x55555755, 0xa7, 0x1a0527, 0xa, 0x0
  .long 0xe50065, 0x1a50125, 0x5950515, 0x87505d6, 0xc3808f5, 0xf050cb9, 0xf850f46, 0x55f0fc8
  .long 0x76afedcb, 0x14325098, 0x55255555, 0x55555455, 0x15, 0x241205, 0x1, 0x0
  .long 0x51b050b, 0x53b052b, 0x55b054b, 0x58b057b, 0x5ab059b, 0x5cb05bb, 0x5eb05db, 0x56f05fb
  .long 0x765fadcb, 0xe4321098, 0x55b55555, 0x55555c55, 0xe5, 0x2c1b05, 0xe, 0x0
  .long 0x5130503, 0x5330523, 0x5530543, 0x5830563, 0x5a30593, 0x5c305b3, 0x5e305d3, 0x57f05f3
  .long 0x76afedcb, 0x34521098, 0x55055555, 0x55555155, 0x35, 0x211005, 0x3, 0x0
  .long 0x51d050d, 0x53d052d, 0x55d054d, 0x57d056d, 0x5ad059d, 0x5cd05bd, 0x5ed05dd, 0x58f05fd
  .long 0x76afedcb, 0x84321095, 0x55b55555, 0x55555755, 0x85, 0x271b05, 0x8, 0x0
  .long 0x5180508, 0x5380528, 0x5580548, 0x5780568, 0x5a80588, 0x5c805b8, 0x5e805d8, 0x59f05f8
  .long 0x765fedca, 0xb4321098, 0x55f55555, 0x55555b55, 0xb5, 0x2b1f05, 0xb, 0x0
  .long 0x5100500, 0x5300520, 0x5500540, 0x5700560, 0x5900580, 0x5c005b0, 0x5e005d0, 0x5af05f0
  .long 0x765feacb, 0xd4321098, 0x55b55555, 0x55555f55, 0xd5, 0x2f1b05, 0xd, 0x0
  .long 0x5120502, 0x5320522, 0x5520542, 0x5720562, 0x5920582, 0x5c205a2, 0x5e205d2, 0x5bf05f2
  .long 0xa65fedcb, 0x74321098, 0x55855555, 0x55555955, 0x75, 0x291805, 0x7, 0x0
  .long 0x5170507, 0x5370527, 0x5570547, 0x5770567, 0x5970587, 0x5b705a7, 0x5e705d7, 0x5cf05f7
  .long 0x7a5fedcb, 0x64321098, 0x55a55555, 0x55555755, 0x65, 0x271a05, 0x6, 0x0
  .long 0x5160506, 0x5360526, 0x5560546, 0x5760566, 0x5960586, 0x5b605a6, 0x5e605c6, 0x5df05f6
  .long 0x76afedcb, 0x4321598, 0x55255555, 0x55555455, 0x5, 0x241205, 0x0, 0x0
  .long 0x51a050a, 0x53a052a, 0x55a054a, 0x57a056a, 0x59a058a, 0x5ba05aa, 0x5da05ca, 0x5ef05fa
  .long 0x76afedcb, 0x45321098, 0x55155555, 0x55555955, 0x45, 0x291105, 0x4, 0x0
  .long 0x51e050e, 0x53e052e, 0x55e054e, 0x57e056e, 0x59e058e, 0x5be05ae, 0x5de05ce, 0x5ff05ee
  .long 0x76afedcb, 0x24351098, 0x66466666, 0x66666666, 0x26, 0x261406, 0x2, 0x0
  .long 0x62c061c, 0x64c063c, 0x66c065c, 0x68c067c, 0x6ac069c, 0x6cc06bc, 0x6ec06dc, 0x60f06fc
  .long 0x765fadcb, 0xe4321098, 0x66666666, 0x66666c66, 0xe6, 0x2c1606, 0xe, 0x0
  .long 0x6230603, 0x6430633, 0x6630653, 0x6830673, 0x6a30693, 0x6c306b3, 0x6e306d3, 0x61f06f3
  .long 0xa65fedcb, 0x74321098, 0x66c66666, 0x66666166, 0x76, 0x211c06, 0x7, 0x0
  .long 0x6170607, 0x6470637, 0x6670657, 0x6870677, 0x6a70697, 0x6c706b7, 0x6e706d7, 0x62f06f7
  .long 0x76afedcb, 0x14325098, 0x66066666, 0x66666666, 0x16, 0x261006, 0x1, 0x0
  .long 0x61b060b, 0x64b062b, 0x66b065b, 0x68b067b, 0x6ab069b, 0x6cb06bb, 0x6eb06db, 0x63f06fb
  .long 0x75afedcb, 0x64321098, 0x66e66666, 0x66666666, 0x66, 0x261e06, 0x6, 0x0
  .long 0x6160606, 0x6360626, 0x6660656, 0x6860676, 0x6a60696, 0x6c606b6, 0x6e606d6, 0x64f06f6
  .long 0x76afedcb, 0x34521098, 0x66066666, 0x66666066, 0x36, 0x201006, 0x3, 0x0
  .long 0x61d060d, 0x63d062d, 0x66d064d, 0x68d067d, 0x6ad069d, 0x6cd06bd, 0x6ed06dd, 0x65f06fd
  .long 0x765fedcb, 0xa4321098, 0x66f66666, 0x66666d66, 0xad, 0x1f062d, 0xa, 0x0
  .long 0x1410134, 0x47001b2, 0x6e204f2, 0x8a40820, 0xa0208c3, 0xb130a80, 0xb900b52, 0x66f0ed3
  .long 0x765fedab, 0xc4321098, 0x66566666, 0x66666e66, 0xc6, 0x2e1506, 0xc, 0x0
  .long 0x6110601, 0x6310621, 0x6510641, 0x6810661, 0x6a10691, 0x6c106b1, 0x6e106d1, 0x67f06f1
  .long 0x76afedcb, 0x45321098, 0x66466666, 0x66666666, 0x46, 0x261406, 0x4, 0x0
  .long 0x61e060e, 0x63e062e, 0x65e064e, 0x67e066e, 0x6ae069e, 0x6ce06be, 0x6ee06de, 0x68f06fe
  .long 0x765fedca, 0xb4321098, 0x66666666, 0x66666c66, 0xb6, 0x2c1606, 0xb, 0x0
  .long 0x6100600, 0x6300620, 0x6500640, 0x6700660, 0x6a00680, 0x6c006b0, 0x6e006d0, 0x69f06f0
  .long 0x765fedcb, 0x943210a8, 0x66c66666, 0x66666166, 0x96, 0x211c06, 0x9, 0x0
  .long 0x6190609, 0x6390629, 0x6590649, 0x6790669, 0x6990689, 0x6c906b9, 0x6e906d9, 0x6af06f9
  .long 0x76afedcb, 0x54321098, 0x66066666, 0x66666666, 0x50, 0x260610, 0x5, 0x0
  .long 0x1fe017c, 0x2ce024c, 0x3eb036e, 0x58d050c, 0x65d063b, 0x71a06da, 0xdac079c, 0x6bf0f2a
  .long 0x76afedcb, 0x84321095, 0x66e66666, 0x66666666, 0x86, 0x261e06, 0x8, 0x0
  .long 0x6180608, 0x6380628, 0x6580648, 0x6780668, 0x6980688, 0x6b806a8, 0x6e806d8, 0x6cf06f8
  .long 0x76afedcb, 0x4321598, 0x66066666, 0x66666066, 0x6, 0x201006, 0x0, 0x0
  .long 0x61a060a, 0x63a062a, 0x65a064a, 0x67a066a, 0x69a068a, 0x6ba06aa, 0x6ea06ca, 0x6df06fa
  .long 0x765feacb, 0xd4321098, 0x66f66666, 0x66666d66, 0xd6, 0x2d1f06, 0xd, 0x0
  .long 0x6120602, 0x6320622, 0x6520642, 0x6720662, 0x6920682, 0x6b206a2, 0x6d206c2, 0x6ef06f2
  .long 0x765aedcb, 0xf4321098, 0x66566666, 0x66666e66, 0xf6, 0x2e1506, 0xf, 0x0
  .long 0x6140604, 0x6340624, 0x6540644, 0x6740664, 0x6940684, 0x6b406a4, 0x6d406c4, 0x6ff06e4
  .long 0x765aedcb, 0xf4321098, 0x77877777, 0x77777b77, 0xf7, 0x2b1807, 0xf, 0x0
  .long 0x7240714, 0x7440734, 0x7640754, 0x7840774, 0x7a40794, 0x7c407b4, 0x7e407d4, 0x70f07f4
  .long 0x76afedcb, 0x4321598, 0x77077777, 0x77777877, 0x7, 0x281007, 0x0, 0x0
  .long 0x72a070a, 0x74a073a, 0x76a075a, 0x78a077a, 0x7aa079a, 0x7ca07ba, 0x7ea07da, 0x71f07fa
  .long 0x765fadcb, 0xe4321098, 0x77b77777, 0x77777e77, 0xe7, 0x2e1b07, 0xe, 0x0
  .long 0x7130703, 0x7430733, 0x7630753, 0x7830773, 0x7a30793, 0x7c307b3, 0x7e307d3, 0x72f07f3
  .long 0x76afedcb, 0x45321098, 0x77277777, 0x77777177, 0x47, 0x211207, 0x4, 0x0
  .long 0x71e070e, 0x74e072e, 0x76e075e, 0x78e077e, 0x7ae079e, 0x7ce07be, 0x7ee07de, 0x73f07fe
  .long 0x7a5fedcb, 0x64321098, 0x77f77777, 0x77777a77, 0x67, 0x2a1f07, 0x6, 0x0
  .long 0x7160706, 0x7360726, 0x7660756, 0x7860776, 0x7a60796, 0x7c607b6, 0x7e607d6, 0x74f07f6
  .long 0x76afedcb, 0x34521098, 0x77277777, 0x77777277, 0x37, 0x221207, 0x3, 0x0
  .long 0x71d070d, 0x73d072d, 0x76d074d, 0x78d077d, 0x7ad079d, 0x7cd07bd, 0x7ed07dd, 0x75f07fd
  .long 0x765fedca, 0xb4321098, 0x77677777, 0x77777c77, 0xb7, 0x2c1607, 0xb, 0x0
  .long 0x7100700, 0x7300720, 0x7500740, 0x7800770, 0x7a00790, 0x7c007b0, 0x7e007d0, 0x76f07f0
  .long 0x76afedcb, 0x94321058, 0x77f77777, 0x77777677, 0x97, 0x261f07, 0x9, 0x0
  .long 0x7190709, 0x7390729, 0x7590749, 0x7890769, 0x7a90799, 0x7c907b9, 0x7e907d9, 0x77f07f9
  .long 0x765feacb, 0xd4321098, 0x77877777, 0x77777b77, 0xd7, 0x2b1807, 0xd, 0x0
  .long 0x7120702, 0x7320722, 0x7520742, 0x7720762, 0x7a20792, 0x7c207b2, 0x7e207d2, 0x78f07f2
  .long 0x76afedcb, 0x24351098, 0x77077777, 0x77777877, 0x27, 0x281007, 0x2, 0x0
  .long 0x71c070c, 0x73c072c, 0x75c074c, 0x77c076c, 0x7ac078c, 0x7cc07bc, 0x7ec07dc, 0x79f07fc
  .long 0x765fedab, 0xc4321098, 0x77b77777, 0x77777e77, 0xc7, 0x2e1b07, 0xc, 0x0
  .long 0x7110701, 0x7310721, 0x7510741, 0x7710761, 0x7910781, 0x7c107b1, 0x7e107d1, 0x7af07f1
  .long 0x76afedcb, 0x14325098, 0x77277777, 0x77777177, 0x17, 0x211207, 0x1, 0x0
  .long 0x71b070b, 0x73b072b, 0x75b074b, 0x77b076b, 0x79b078b, 0x7cb07ab, 0x7eb07db, 0x7bf07fb
  .long 0x765fedcb, 0x8432109a, 0x77f77777, 0x77777a77, 0x87, 0x2a1f07, 0x8, 0x0
  .long 0x7180708, 0x7380728, 0x7580748, 0x7780768, 0x7980788, 0x7b807a8, 0x7e807d8, 0x7cf07f8
  .long 0x76afedcb, 0x54321098, 0x77277777, 0x77777277, 0x52, 0x220712, 0x5, 0x0
  .long 0x8e000c, 0x4ac042d, 0x5ea056b, 0x75d073e, 0x87e07bb, 0xc4e08fc, 0xf1c0cca, 0x7df0f9d
  .long 0x765fedcb, 0xa4321098, 0x77677777, 0x77777c77, 0xac, 0x16072c, 0xa, 0x0
  .long 0xd00053, 0x2b00234, 0x44302f1, 0x57304c4, 0x6900613, 0xc030760, 0xd200c84, 0x7ef0fa4
  .long 0x56afedcb, 0x74321098, 0x77f77777, 0x77777677, 0x77, 0x261f07, 0x7, 0x0
  .long 0x7170707, 0x7370727, 0x7570747, 0x7770767, 0x7970787, 0x7b707a7, 0x7d707c7, 0x7ff07e7
  .long 0x765feacb, 0xd4321098, 0x88788888, 0x88888f88, 0xd8, 0x2f1708, 0xd, 0x0
  .long 0x8220812, 0x8420832, 0x8620852, 0x8820872, 0x8a20892, 0x8c208b2, 0x8e208d2, 0x80f08f2
  .long 0x76afedcb, 0x14325098, 0x88388888, 0x88888188, 0x18, 0x211308, 0x1, 0x0
  .long 0x82b080b, 0x84b083b, 0x86b085b, 0x88b087b, 0x8ab089b, 0x8cb08bb, 0x8eb08db, 0x81f08fb
  .long 0x765fedca, 0xb4321098, 0x88788888, 0x88888d88, 0xb8, 0x2d1708, 0xb, 0x0
  .long 0x8100800, 0x8400830, 0x8600850, 0x8800870, 0x8a00890, 0x8c008b0, 0x8e008d0, 0x82f08f0
  .long 0x765fedcb, 0xa4321098, 0x88788888, 0x88888288, 0xa2, 0x170822, 0xa, 0x0
  .long 0x1c50175, 0x75501f5, 0x84507d5, 0x8b70865, 0x92508e5, 0xd0509a5, 0xe150d85, 0x83f0e95
  .long 0x76afedcb, 0x4321598, 0x88488888, 0x88888288, 0x8, 0x221408, 0x0, 0x0
  .long 0x81a080a, 0x83a082a, 0x86a085a, 0x88a087a, 0x8aa089a, 0x8ca08ba, 0x8ea08da, 0x84f08fa
  .long 0x76afedcb, 0x94321058, 0x88788888, 0x88888188, 0x98, 0x211708, 0x9, 0x0
  .long 0x8190809, 0x8390829, 0x8690849, 0x8890879, 0x8a90899, 0x8c908b9, 0x8e908d9, 0x85f08f9
  .long 0x75afedcb, 0x64321098, 0x88d88888, 0x88888288, 0x68, 0x221d08, 0x6, 0x0
  .long 0x8160806, 0x8360826, 0x8560846, 0x8860876, 0x8a60896, 0x8c608b6, 0x8e608d6, 0x86f08f6
  .long 0x76afedcb, 0x45321098, 0x88288888, 0x88888788, 0x48, 0x271208, 0x4, 0x0
  .long 0x81e080e, 0x83e082e, 0x85e084e, 0x88e086e, 0x8ae089e, 0x8ce08be, 0x8ee08de, 0x87f08fe
  .long 0x765fedab, 0xc4321098, 0x88788888, 0x88888f88, 0xc8, 0x2f1708, 0xc, 0x0
  .long 0x8110801, 0x8310821, 0x8510841, 0x8710861, 0x8a10891, 0x8c108b1, 0x8e108d1, 0x88f08f1
  .long 0x76afedcb, 0x34521098, 0x88388888, 0x88888188, 0x38, 0x211308, 0x3, 0x0
  .long 0x81d080d, 0x83d082d, 0x85d084d, 0x87d086d, 0x8ad088d, 0x8cd08bd, 0x8ed08dd, 0x89f08fd
  .long 0x765aedcb, 0xf4321098, 0x88788888, 0x88888d88, 0xf8, 0x2d1708, 0xf, 0x0
  .long 0x8140804, 0x8340824, 0x8540844, 0x8740864, 0x8940884, 0x8c408b4, 0x8e408d4, 0x8af08f4
  .long 0xa65fedcb, 0x74321098, 0x88788888, 0x88888288, 0x78, 0x221708, 0x7, 0x0
  .long 0x8170807, 0x8370827, 0x8570847, 0x8770867, 0x8970887, 0x8c708a7, 0x8e708d7, 0x8bf08f7
  .long 0x765fadcb, 0xe4321098, 0x88a88888, 0x88888d88, 0xe8, 0x2d1a08, 0xe, 0x0
  .long 0x8130803, 0x8330823, 0x8530843, 0x8730863, 0x8930883, 0x8b308a3, 0x8e308d3, 0x8cf08f3
  .long 0x76afedcb, 0x54321098, 0x88788888, 0x88888188, 0x57, 0x210817, 0x5, 0x0
  .long 0x4650445, 0x4e504c5, 0x8250805, 0x8590835, 0x8a50885, 0xc1508b5, 0xc950c75, 0x8df0cf5
  .long 0x76afedcb, 0x84321095, 0x88d88888, 0x88888288, 0x88, 0x221d08, 0x8, 0x0
  .long 0x8180808, 0x8380828, 0x8580848, 0x8780868, 0x8980888, 0x8b808a8, 0x8d808c8, 0x8ef08f8
  .long 0x76afedcb, 0x24351098, 0x88288888, 0x88888788, 0x28, 0x271208, 0x2, 0x0
  .long 0x81c080c, 0x83c082c, 0x85c084c, 0x87c086c, 0x89c088c, 0x8bc08ac, 0x8dc08cc, 0x8ff08ec
  .long 0x76afedcb, 0x94321058, 0x99a99999, 0x99999899, 0x99, 0x281a09, 0x9, 0x0
  .long 0x9290919, 0x9490939, 0x9690959, 0x9890979, 0x9a90999, 0x9c909b9, 0x9e909d9, 0x90f09f9
  .long 0x76afedcb, 0x54321098, 0x99599999, 0x99999599, 0x55, 0x250915, 0x5, 0x0
  .long 0xb90036, 0x6f50675, 0xa2b099d, 0xaad0a65, 0xce50b55, 0xf0e0ed5, 0xf8b0f45, 0x91f0fc5
  .long 0x76afedcb, 0x45321098, 0x99399999, 0x99999299, 0x49, 0x221309, 0x4, 0x0
  .long 0x91e090e, 0x94e093e, 0x96e095e, 0x98e097e, 0x9ae099e, 0x9ce09be, 0x9ee09de, 0x92f09fe
  .long 0x76afedcb, 0x14325098, 0x99399999, 0x99999999, 0x19, 0x291309, 0x1, 0x0
  .long 0x91b090b, 0x94b092b, 0x96b095b, 0x98b097b, 0x9ab099b, 0x9cb09bb, 0x9eb09db, 0x93f09fb
  .long 0x765aedcb, 0xf4321098, 0x99c99999, 0x99999e99, 0xf9, 0x2e1c09, 0xf, 0x0
  .long 0x9140904, 0x9340924, 0x9640954, 0x9840974, 0x9a40994, 0x9c409b4, 0x9e409d4, 0x94f09f4
  .long 0x765fadcb, 0xe4321098, 0x99b99999, 0x99999a99, 0xe9, 0x2a1b09, 0xe, 0x0
  .long 0x9130903, 0x9330923, 0x9630943, 0x9830973, 0x9a30993, 0x9c309b3, 0x9e309d3, 0x95f09f3
  .long 0x765fedab, 0xc4321098, 0x99899999, 0x99999a99, 0xc9, 0x2a1809, 0xc, 0x0
  .long 0x9110901, 0x9310921, 0x9510941, 0x9810971, 0x9a10991, 0x9c109b1, 0x9e109d1, 0x96f09f1
  .long 0x56afedcb, 0x74321098, 0x99e99999, 0x99999599, 0x79, 0x251e09, 0x7, 0x0
  .long 0x9170907, 0x9370927, 0x9570947, 0x9870967, 0x9a70997, 0x9c709b7, 0x9e709d7, 0x97f09f7
  .long 0x75afedcb, 0x64321098, 0x99a99999, 0x99999899, 0x69, 0x281a09, 0x6, 0x0
  .long 0x9160906, 0x9360926, 0x9560946, 0x9760966, 0x9a60996, 0x9c609b6, 0x9e609d6, 0x98f09f6
  .long 0x76afedcb, 0x34521098, 0x99599999, 0x99999599, 0x39, 0x251509, 0x3, 0x0
  .long 0x91d090d, 0x93d092d, 0x95d094d, 0x97d096d, 0x9ad098d, 0x9cd09bd, 0x9ed09dd, 0x99f09fd
  .long 0x76afedcb, 0x4321598, 0x99399999, 0x99999299, 0x9, 0x221309, 0x0, 0x0
  .long 0x91a090a, 0x93a092a, 0x95a094a, 0x97a096a, 0x99a098a, 0x9ca09ba, 0x9ea09da, 0x9af09fa
  .long 0x76afedcb, 0x24351098, 0x99399999, 0x99999999, 0x29, 0x291309, 0x2, 0x0
  .long 0x91c090c, 0x93c092c, 0x95c094c, 0x97c096c, 0x99c098c, 0x9cc09ac, 0x9ec09dc, 0x9bf09fc
  .long 0x765feacb, 0xd4321098, 0x99c99999, 0x99999e99, 0xd9, 0x2e1c09, 0xd, 0x0
  .long 0x9120902, 0x9320922, 0x9520942, 0x9720962, 0x9920982, 0x9b209a2, 0x9e209d2, 0x9cf09f2
  .long 0x765fedca, 0xb4321098, 0x99b99999, 0x99999a99, 0xb9, 0x2a1b09, 0xb, 0x0
  .long 0x9100900, 0x9300920, 0x9500940, 0x9700960, 0x9900980, 0x9b009a0, 0x9e009c0, 0x9df09f0
  .long 0x765fedcb, 0xa4321098, 0x99899999, 0x99999a99, 0xaa, 0x18092a, 0xa, 0x0
  .long 0x7c80746, 0x9610953, 0xa2509d0, 0xaa50a35, 0xb050ab5, 0xd190b85, 0xe740d97, 0x9ef0ef0
  .long 0x76afedcb, 0x84321095, 0x99e99999, 0x99999599, 0x89, 0x251e09, 0x8, 0x0
  .long 0x9180908, 0x9380928, 0x9580948, 0x9780968, 0x9980988, 0x9b809a8, 0x9d809c8, 0x9ff09e8
  .long 0x765feacb, 0xd4321098, 0xaadaaaaa, 0xaaaaadaa, 0xda, 0x2d1d0a, 0xd, 0x0
  .long 0xa220a12, 0xa420a32, 0xa620a52, 0xa820a72, 0xaa20a92, 0xac20ab2, 0xae20ad2, 0xa0f0af2
  .long 0x765aedcb, 0xf4321098, 0xaa8aaaaa, 0xaaaaafaa, 0xfa, 0x2f180a, 0xf, 0x0
  .long 0xa240a04, 0xa440a34, 0xa640a54, 0xa840a74, 0xaa40a94, 0xac40ab4, 0xae40ad4, 0xa1f0af4
  .long 0x76afedcb, 0x14325098, 0xaa5aaaaa, 0xaaaaaaaa, 0x1a, 0x2a150a, 0x1, 0x0
  .long 0xa1b0a0b, 0xa4b0a3b, 0xa6b0a5b, 0xa8b0a7b, 0xaab0a9b, 0xacb0abb, 0xaeb0adb, 0xa2f0afb
  .long 0x76afedcb, 0x45321098, 0xaa4aaaaa, 0xaaaaaaaa, 0x4a, 0x2a140a, 0x4, 0x0
  .long 0xa1e0a0e, 0xa4e0a2e, 0xa6e0a5e, 0xa8e0a7e, 0xaae0a9e, 0xace0abe, 0xaee0ade, 0xa3f0afe
  .long 0x75afedcb, 0x64321098, 0xaadaaaaa, 0xaaaaa8aa, 0x6a, 0x281d0a, 0x6, 0x0
  .long 0xa160a06, 0xa360a26, 0xa660a56, 0xa860a76, 0xaa60a96, 0xac60ab6, 0xae60ad6, 0xa4f0af6
  .long 0x765fedcb, 0xa4321098, 0xaaeaaaaa, 0xaaaaa9aa, 0xa9, 0x1e0a29, 0xa, 0x0
  .long 0x1960118, 0x3070275, 0x5490388, 0x5f505c7, 0x9b50935, 0xc250ad7, 0xe650ca5, 0xa5f0ee5
  .long 0x765fadcb, 0xe4321098, 0xaa5aaaaa, 0xaaaaabaa, 0xea, 0x2b150a, 0xe, 0x0
  .long 0xa130a03, 0xa330a23, 0xa530a43, 0xa830a73, 0xaa30a93, 0xac30ab3, 0xae30ad3, 0xa6f0af3
  .long 0x76afedcb, 0x84321095, 0xaadaaaaa, 0xaaaaa3aa, 0x8a, 0x231d0a, 0x8, 0x0
  .long 0xa180a08, 0xa380a28, 0xa580a48, 0xa880a68, 0xaa80a98, 0xac80ab8, 0xae80ad8, 0xa7f0af8
  .long 0x765fedca, 0xb4321098, 0xaadaaaaa, 0xaaaaadaa, 0xba, 0x2d1d0a, 0xb, 0x0
  .long 0xa100a00, 0xa300a20, 0xa500a40, 0xa700a60, 0xaa00a90, 0xac00ab0, 0xae00ad0, 0xa8f0af0
  .long 0x765fedab, 0xc4321098, 0xaa8aaaaa, 0xaaaaafaa, 0xca, 0x2f180a, 0xc, 0x0
  .long 0xa110a01, 0xa310a21, 0xa510a41, 0xa710a61, 0xaa10a81, 0xac10ab1, 0xae10ad1, 0xa9f0af1
  .long 0x76afedcb, 0x34521098, 0xaa5aaaaa, 0xaaaaaaaa, 0x3a, 0x2a150a, 0x3, 0x0
  .long 0xa1d0a0d, 0xa3d0a2d, 0xa5d0a4d, 0xa7d0a6d, 0xa9d0a8d, 0xacd0abd, 0xaed0add, 0xaaf0afd
  .long 0x76afedcb, 0x24351098, 0xaa4aaaaa, 0xaaaaaaaa, 0x2a, 0x2a140a, 0x2, 0x0
  .long 0xa1c0a0c, 0xa3c0a2c, 0xa5c0a4c, 0xa7c0a6c, 0xa9c0a8c, 0xacc0aac, 0xaec0adc, 0xabf0afc
  .long 0x76afedcb, 0x54321098, 0xaadaaaaa, 0xaaaaa8aa, 0x5d, 0x280a1d, 0x5, 0x0
  .long 0xa50025, 0x3d90356, 0x8e80866, 0xa460a05, 0xa850a78, 0xb150af9, 0xb950b35, 0xacf0bb5
  .long 0xa65fedcb, 0x74321098, 0xaaeaaaaa, 0xaaaaa9aa, 0x7a, 0x291e0a, 0x7, 0x0
  .long 0xa170a07, 0xa370a27, 0xa570a47, 0xa770a67, 0xa970a87, 0xab70aa7, 0xae70ac7, 0xadf0af7
  .long 0x76afedcb, 0x4321598, 0xaa4aaaaa, 0xaaaaa1aa, 0xa, 0x21140a, 0x0, 0x0
  .long 0xa1a0a0a, 0xa3a0a2a, 0xa5a0a4a, 0xa7a0a6a, 0xa9a0a8a, 0xaba0aaa, 0xada0aca, 0xaef0afa
  .long 0x76afedcb, 0x94321058, 0xaadaaaaa, 0xaaaaa3aa, 0x9a, 0x231d0a, 0x9, 0x0
  .long 0xa190a09, 0xa390a29, 0xa590a49, 0xa790a69, 0xa990a89, 0xab90aa9, 0xad90ac9, 0xaff0ae9
  .long 0x76afedcb, 0x54321098, 0xbbebbbbb, 0xbbbbbabb, 0x5e, 0x2a0b1e, 0x5, 0x0
  .long 0x980017, 0x3b50335, 0x6c80646, 0x9f80977, 0xad50a55, 0xd250b86, 0xee60e69, 0xb0f0fa5
  .long 0x765fadcb, 0xe4321098, 0xbbdbbbbb, 0xbbbbbdbb, 0xeb, 0x2d1d0b, 0xe, 0x0
  .long 0xb230b03, 0xb430b33, 0xb630b53, 0xb830b73, 0xba30b93, 0xbc30bb3, 0xbe30bd3, 0xb1f0bf3
  .long 0x765fedcb, 0xa4321098, 0xbb6bbbbb, 0xbbbbb3bb, 0xa3, 0x160b23, 0xa, 0x0
  .long 0x2850205, 0x3c50345, 0x4350415, 0x4950467, 0x4e904b5, 0xaf50a75, 0xbd50ba9, 0xb2f0e55
  .long 0x765fedab, 0xc4321098, 0xbbdbbbbb, 0xbbbbbbbb, 0xcb, 0x2b1d0b, 0xc, 0x0
  .long 0xb110b01, 0xb410b21, 0xb610b51, 0xb810b71, 0xba10b91, 0xbc10bb1, 0xbe10bd1, 0xb3f0bf1
  .long 0xa65fedcb, 0x74321098, 0xbb6bbbbb, 0xbbbbb0bb, 0x7b, 0x20160b, 0x7, 0x0
  .long 0xb170b07, 0xb370b27, 0xb670b57, 0xb870b77, 0xba70b97, 0xbc70bb7, 0xbe70bd7, 0xb4f0bf7
  .long 0x765feacb, 0xd4321098, 0xbb5bbbbb, 0xbbbbbdbb, 0xdb, 0x2d150b, 0xd, 0x0
  .long 0xb120b02, 0xb320b22, 0xb620b42, 0xb820b72, 0xba20b92, 0xbc20bb2, 0xbe20bd2, 0xb5f0bf2
  .long 0x76afedcb, 0x4321598, 0xbb1bbbbb, 0xbbbbb6bb, 0xb, 0x26110b, 0x0, 0x0
  .long 0xb1a0b0a, 0xb3a0b2a, 0xb5a0b4a, 0xb8a0b7a, 0xbaa0b9a, 0xbca0bba, 0xbea0bda, 0xb6f0bfa
  .long 0x76afedcb, 0x45321098, 0xbb3bbbbb, 0xbbbbb8bb, 0x4b, 0x28130b, 0x4, 0x0
  .long 0xb1e0b0e, 0xb3e0b2e, 0xb5e0b4e, 0xb8e0b6e, 0xbae0b9e, 0xbce0bbe, 0xbee0bde, 0xb7f0bfe
  .long 0x75afedcb, 0x64321098, 0xbbebbbbb, 0xbbbbbabb, 0x6b, 0x2a1e0b, 0x6, 0x0
  .long 0xb160b06, 0xb360b26, 0xb560b46, 0xb760b66, 0xba60b96, 0xbc60bb6, 0xbe60bd6, 0xb8f0bf6
  .long 0x765fedca, 0xb4321098, 0xbbdbbbbb, 0xbbbbbdbb, 0xbb, 0x2d1d0b, 0xb, 0x0
  .long 0xb100b00, 0xb300b20, 0xb500b40, 0xb700b60, 0xba00b80, 0xbc00bb0, 0xbe00bd0, 0xb9f0bf0
  .long 0x765fedcb, 0x943210a8, 0xbb6bbbbb, 0xbbbbb3bb, 0x9b, 0x23160b, 0x9, 0x0
  .long 0xb190b09, 0xb390b29, 0xb590b49, 0xb790b69, 0xb990b89, 0xbc90bb9, 0xbe90bd9, 0xbaf0bf9
  .long 0x765aedcb, 0xf4321098, 0xbbdbbbbb, 0xbbbbbbbb, 0xfb, 0x2b1d0b, 0xf, 0x0
  .long 0xb140b04, 0xb340b24, 0xb540b44, 0xb740b64, 0xb940b84, 0xbc40ba4, 0xbe40bd4, 0xbbf0bf4
  .long 0x765fedcb, 0x8432109a, 0xbb6bbbbb, 0xbbbbb0bb, 0x8b, 0x20160b, 0x8, 0x0
  .long 0xb180b08, 0xb380b28, 0xb580b48, 0xb780b68, 0xb980b88, 0xbb80ba8, 0xbe80bd8, 0xbcf0bf8
  .long 0x76afedcb, 0x24351098, 0xbb4bbbbb, 0xbbbbb3bb, 0x2b, 0x23140b, 0x2, 0x0
  .long 0xb1c0b0c, 0xb3c0b2c, 0xb5c0b4c, 0xb7c0b6c, 0xb9c0b8c, 0xbbc0bac, 0xbec0bcc, 0xbdf0bfc
  .long 0x76afedcb, 0x34521098, 0xbb1bbbbb, 0xbbbbb6bb, 0x3b, 0x26110b, 0x3, 0x0
  .long 0xb1d0b0d, 0xb3d0b2d, 0xb5d0b4d, 0xb7d0b6d, 0xb9d0b8d, 0xbbd0bad, 0xbdd0bcd, 0xbef0bfd
  .long 0x76afedcb, 0x14325098, 0xbb3bbbbb, 0xbbbbb8bb, 0x1b, 0x28130b, 0x1, 0x0
  .long 0xb1b0b0b, 0xb3b0b2b, 0xb5b0b4b, 0xb7b0b6b, 0xb9b0b8b, 0xbbb0bab, 0xbdb0bcb, 0xbff0beb
  .long 0x765fadcb, 0xe4321098, 0xcccccccc, 0xcccccccc, 0xec, 0x2c1c0c, 0xe, 0x0
  .long 0xc230c13, 0xc430c33, 0xc630c53, 0xc830c73, 0xca30c93, 0xcc30cb3, 0xce30cd3, 0xc0f0cf3
  .long 0x765fedca, 0xb4321098, 0xcc7ccccc, 0xcccccbcc, 0xbc, 0x2b170c, 0xb, 0x0
  .long 0xc200c00, 0xc400c30, 0xc600c50, 0xc800c70, 0xca00c90, 0xcc00cb0, 0xce00cd0, 0xc1f0cf0
  .long 0x76afedcb, 0x54321098, 0xccaccccc, 0xccccc9cc, 0x5a, 0x290c1a, 0x5, 0x0
  .long 0x2650145, 0x31502e5, 0x5550395, 0x8c505d5, 0x9860909, 0xca70c35, 0xe750cb5, 0xc2f0ef5
  .long 0x765fedcb, 0x8432109a, 0xccaccccc, 0xccccc7cc, 0x8c, 0x271a0c, 0x8, 0x0
  .long 0xc180c08, 0xc480c28, 0xc680c58, 0xc880c78, 0xca80c98, 0xcc80cb8, 0xce80cd8, 0xc3f0cf8
  .long 0x76afedcb, 0x45321098, 0xcc2ccccc, 0xccccc5cc, 0x4c, 0x25120c, 0x4, 0x0
  .long 0xc1e0c0e, 0xc3e0c2e, 0xc6e0c5e, 0xc8e0c7e, 0xcae0c9e, 0xcce0cbe, 0xcee0cde, 0xc4f0cfe
  .long 0x76afedcb, 0x14325098, 0xcc1ccccc, 0xccccc4cc, 0x1c, 0x24110c, 0x1, 0x0
  .long 0xc1b0c0b, 0xc3b0c2b, 0xc6b0c4b, 0xc8b0c7b, 0xcab0c9b, 0xccb0cbb, 0xceb0cdb, 0xc5f0cfb
  .long 0x76afedcb, 0x34521098, 0xcc4ccccc, 0xccccc1cc, 0x3c, 0x21140c, 0x3, 0x0
  .long 0xc1d0c0d, 0xc3d0c2d, 0xc5d0c4d, 0xc8d0c7d, 0xcad0c9d, 0xccd0cbd, 0xced0cdd, 0xc6f0cfd
  .long 0x7a5fedcb, 0x64321098, 0xcc7ccccc, 0xccccc0cc, 0x6c, 0x20170c, 0x6, 0x0
  .long 0xc160c06, 0xc360c26, 0xc560c46, 0xc860c66, 0xca60c96, 0xcc60cb6, 0xce60cd6, 0xc7f0cf6
  .long 0x765aedcb, 0xf4321098, 0xcccccccc, 0xcccccccc, 0xfc, 0x2c1c0c, 0xf, 0x0
  .long 0xc140c04, 0xc340c24, 0xc540c44, 0xc740c64, 0xca40c94, 0xcc40cb4, 0xce40cd4, 0xc8f0cf4
  .long 0x765feacb, 0xd4321098, 0xcc7ccccc, 0xcccccbcc, 0xdc, 0x2b170c, 0xd, 0x0
  .long 0xc120c02, 0xc320c22, 0xc520c42, 0xc720c62, 0xca20c82, 0xcc20cb2, 0xce20cd2, 0xc9f0cf2
  .long 0x56afedcb, 0x74321098, 0xccaccccc, 0xccccc9cc, 0x7c, 0x291a0c, 0x7, 0x0
  .long 0xc170c07, 0xc370c27, 0xc570c47, 0xc770c67, 0xc970c87, 0xcc70cb7, 0xce70cd7, 0xcaf0cf7
  .long 0x765fedcb, 0x943210a8, 0xccaccccc, 0xccccc7cc, 0x9c, 0x271a0c, 0x9, 0x0
  .long 0xc190c09, 0xc390c29, 0xc590c49, 0xc790c69, 0xc990c89, 0xcc90ca9, 0xce90cd9, 0xcbf0cf9
  .long 0x76afedcb, 0x4321598, 0xcc2ccccc, 0xccccc5cc, 0xc, 0x25120c, 0x0, 0x0
  .long 0xc1a0c0a, 0xc3a0c2a, 0xc5a0c4a, 0xc7a0c6a, 0xc9a0c8a, 0xcba0caa, 0xcea0cda, 0xccf0cfa
  .long 0x76afedcb, 0x24351098, 0xcc1ccccc, 0xccccc4cc, 0x2c, 0x24110c, 0x2, 0x0
  .long 0xc1c0c0c, 0xc3c0c2c, 0xc5c0c4c, 0xc7c0c6c, 0xc9c0c8c, 0xcbc0cac, 0xcec0ccc, 0xcdf0cfc
  .long 0x765fedab, 0xc4321098, 0xcc5ccccc, 0xcccccbcc, 0xcc, 0x2b150c, 0xc, 0x0
  .long 0xc110c01, 0xc310c21, 0xc510c41, 0xc710c61, 0xc910c81, 0xcb10ca1, 0xcd10cc1, 0xcef0cf1
  .long 0x765fedcb, 0xa4321098, 0xcc7ccccc, 0xccccc0cc, 0xa0, 0x170c20, 0xa, 0x0
  .long 0x950015, 0x3e50365, 0x4880406, 0x6d50655, 0xbc80b47, 0xe250c76, 0xf350ea5, 0xcff0fb5
  .long 0x76afedcb, 0x45321098, 0xdd3ddddd, 0xddddd2dd, 0x4d, 0x22130d, 0x4, 0x0
  .long 0xd2e0d1e, 0xd4e0d3e, 0xd6e0d5e, 0xd8e0d7e, 0xdae0d9e, 0xdce0dbe, 0xdee0dde, 0xd0f0dfe
  .long 0x765fedcb, 0x943210a8, 0xdd9ddddd, 0xdddddadd, 0x9d, 0x2a190d, 0x9, 0x0
  .long 0xd290d09, 0xd490d39, 0xd690d59, 0xd890d79, 0xda90d99, 0xdc90db9, 0xde90dd9, 0xd1f0df9
  .long 0x765fedca, 0xb4321098, 0xddeddddd, 0xdddddcdd, 0xbd, 0x2c1e0d, 0xb, 0x0
  .long 0xd100d00, 0xd400d30, 0xd600d50, 0xd800d70, 0xda00d90, 0xdc00db0, 0xde00dd0, 0xd2f0df0
  .long 0x75afedcb, 0x64321098, 0xdd8ddddd, 0xddddd8dd, 0x6d, 0x28180d, 0x6, 0x0
  .long 0xd160d06, 0xd460d26, 0xd660d56, 0xd860d76, 0xda60d96, 0xdc60db6, 0xde60dd6, 0xd3f0df6
  .long 0x76afedcb, 0x14325098, 0xdd1ddddd, 0xddddd4dd, 0x1d, 0x24110d, 0x1, 0x0
  .long 0xd1b0d0b, 0xd3b0d2b, 0xd6b0d5b, 0xd8b0d7b, 0xdab0d9b, 0xdcb0dbb, 0xdeb0ddb, 0xd4f0dfb
  .long 0x765aedcb, 0xf4321098, 0xddcddddd, 0xdddddfdd, 0xfd, 0x2f1c0d, 0xf, 0x0
  .long 0xd140d04, 0xd340d24, 0xd640d44, 0xd840d74, 0xda40d94, 0xdc40db4, 0xde40dd4, 0xd5f0df4
  .long 0x765fedab, 0xc4321098, 0xddcddddd, 0xdddddfdd, 0xcd, 0x2f1c0d, 0xc, 0x0
  .long 0xd110d01, 0xd310d21, 0xd510d41, 0xd810d71, 0xda10d91, 0xdc10db1, 0xde10dd1, 0xd6f0df1
  .long 0x765fedcb, 0x8432109a, 0xddcddddd, 0xddddd1dd, 0x8d, 0x211c0d, 0x8, 0x0
  .long 0xd180d08, 0xd380d28, 0xd580d48, 0xd880d68, 0xda80d98, 0xdc80db8, 0xde80dd8, 0xd7f0df8
  .long 0x76afedcb, 0x4321598, 0xdd3ddddd, 0xddddd2dd, 0xd, 0x22130d, 0x0, 0x0
  .long 0xd1a0d0a, 0xd3a0d2a, 0xd5a0d4a, 0xd7a0d6a, 0xdaa0d9a, 0xdca0dba, 0xdea0dda, 0xd8f0dfa
  .long 0xa65fedcb, 0x74321098, 0xdd9ddddd, 0xdddddadd, 0x7d, 0x2a190d, 0x7, 0x0
  .long 0xd170d07, 0xd370d27, 0xd570d47, 0xd770d67, 0xda70d87, 0xdc70db7, 0xde70dd7, 0xd9f0df7
  .long 0x76afedcb, 0x24351098, 0xdd0ddddd, 0xddddd8dd, 0x2d, 0x28100d, 0x2, 0x0
  .long 0xd1c0d0c, 0xd3c0d2c, 0xd5c0d4c, 0xd7c0d6c, 0xd9c0d8c, 0xdcc0dbc, 0xdec0ddc, 0xdaf0dfc
  .long 0x76afedcb, 0x54321098, 0xdd8ddddd, 0xddddd8dd, 0x58, 0x280d18, 0x5, 0x0
  .long 0xd50055, 0x2a50225, 0x3f50375, 0x5c50545, 0x7850705, 0x9e50965, 0xa950a15, 0xdbf0d36
  .long 0x76afedcb, 0x34521098, 0xdd1ddddd, 0xddddd4dd, 0x3d, 0x24110d, 0x3, 0x0
  .long 0xd1d0d0d, 0xd3d0d2d, 0xd5d0d4d, 0xd7d0d6d, 0xd9d0d8d, 0xdbd0dad, 0xded0ddd, 0xdcf0dfd
  .long 0x765feacb, 0xd4321098, 0xddcddddd, 0xdddddfdd, 0xdd, 0x2f1c0d, 0xd, 0x0
  .long 0xd120d02, 0xd320d22, 0xd520d42, 0xd720d62, 0xd920d82, 0xdb20da2, 0xde20dc2, 0xddf0df2
  .long 0x765fadcb, 0xe4321098, 0xddcddddd, 0xdddddfdd, 0xed, 0x2f1c0d, 0xe, 0x0
  .long 0xd130d03, 0xd330d23, 0xd530d43, 0xd730d63, 0xd930d83, 0xdb30da3, 0xdd30dc3, 0xdef0df3
  .long 0x765fedcb, 0xa4321098, 0xddcddddd, 0xddddd1dd, 0xa1, 0x1c0d21, 0xa, 0x0
  .long 0x2c50245, 0x5850505, 0x6a90627, 0x7b50735, 0x8550815, 0x8d50895, 0xc650ae5, 0xdff0d78
  .long 0x765fedcb, 0xa4321098, 0xee9eeeee, 0xeeeee4ee, 0xa4, 0x190e24, 0xa, 0x0
  .long 0x750035, 0xf500b5, 0x3a50325, 0x5e50565, 0xcd50c55, 0xdc50d45, 0xf150e87, 0xe0f0f95
  .long 0x76afedcb, 0x24351098, 0xee4eeeee, 0xeeeee2ee, 0x2e, 0x22140e, 0x2, 0x0
  .long 0xe2c0e0c, 0xe4c0e3c, 0xe6c0e5c, 0xe8c0e7c, 0xeac0e9c, 0xecc0ebc, 0xeec0edc, 0xe1f0efc
  .long 0x76afedcb, 0x34521098, 0xee4eeeee, 0xeeeee0ee, 0x3e, 0x20140e, 0x3, 0x0
  .long 0xe1d0e0d, 0xe4d0e3d, 0xe6d0e5d, 0xe8d0e7d, 0xead0e9d, 0xecd0ebd, 0xeed0edd, 0xe2f0efd
  .long 0x76afedcb, 0x84321095, 0xeeceeeee, 0xeeeee5ee, 0x8e, 0x251c0e, 0x8, 0x0
  .long 0xe180e08, 0xe480e28, 0xe680e58, 0xe880e78, 0xea80e98, 0xec80eb8, 0xee80ed8, 0xe3f0ef8
  .long 0x765fedab, 0xc4321098, 0xeebeeeee, 0xeeeeebee, 0xce, 0x2b1b0e, 0xc, 0x0
  .long 0xe110e01, 0xe310e21, 0xe610e51, 0xe810e71, 0xea10e91, 0xec10eb1, 0xee10ed1, 0xe4f0ef1
  .long 0x76afedcb, 0x14325098, 0xee4eeeee, 0xeeeee3ee, 0x1e, 0x23140e, 0x1, 0x0
  .long 0xe1b0e0b, 0xe3b0e2b, 0xe6b0e4b, 0xe8b0e7b, 0xeab0e9b, 0xecb0ebb, 0xeeb0edb, 0xe5f0efb
  .long 0x76afedcb, 0x94321058, 0xeeeeeeee, 0xeeeee9ee, 0x9e, 0x291e0e, 0x9, 0x0
  .long 0xe190e09, 0xe390e29, 0xe590e49, 0xe890e79, 0xea90e99, 0xec90eb9, 0xee90ed9, 0xe6f0ef9
  .long 0x765aedcb, 0xf4321098, 0xeeaeeeee, 0xeeeeeaee, 0xfe, 0x2a1a0e, 0xf, 0x0
  .long 0xe140e04, 0xe340e24, 0xe540e44, 0xe840e64, 0xea40e94, 0xec40eb4, 0xee40ed4, 0xe7f0ef4
  .long 0xa65fedcb, 0x74321098, 0xee9eeeee, 0xeeeee4ee, 0x7e, 0x24190e, 0x7, 0x0
  .long 0xe170e07, 0xe370e27, 0xe570e47, 0xe770e67, 0xea70e97, 0xec70eb7, 0xee70ed7, 0xe8f0ef7
  .long 0x76afedcb, 0x45321098, 0xee4eeeee, 0xeeeee2ee, 0x4e, 0x22140e, 0x4, 0x0
  .long 0xe1e0e0e, 0xe3e0e2e, 0xe5e0e4e, 0xe7e0e6e, 0xeae0e8e, 0xece0ebe, 0xeee0ede, 0xe9f0efe
  .long 0x76afedcb, 0x4321598, 0xee4eeeee, 0xeeeee0ee, 0xe, 0x20140e, 0x0, 0x0
  .long 0xe1a0e0a, 0xe3a0e2a, 0xe5a0e4a, 0xe7a0e6a, 0xe9a0e8a, 0xeca0eba, 0xeea0eda, 0xeaf0efa
  .long 0x76afedcb, 0x54321098, 0xeeceeeee, 0xeeeee5ee, 0x5c, 0x250e1c, 0x5, 0x0
  .long 0x1950115, 0x6a50625, 0x9c50945, 0xc850c05, 0xd650d55, 0xdd50d75, 0xdf50de5, 0xebf0e38
  .long 0x765feacb, 0xd4321098, 0xeebeeeee, 0xeeeeebee, 0xde, 0x2b1b0e, 0xd, 0x0
  .long 0xe120e02, 0xe320e22, 0xe520e42, 0xe720e62, 0xe920e82, 0xeb20ea2, 0xee20ed2, 0xecf0ef2
  .long 0x765fadcb, 0xe4321098, 0xee5eeeee, 0xeeeeedee, 0xee, 0x2d150e, 0xe, 0x0
  .long 0xe130e03, 0xe330e23, 0xe530e43, 0xe730e63, 0xe930e83, 0xeb30ea3, 0xee30ec3, 0xedf0ef3
  .long 0x75afedcb, 0x64321098, 0xeeeeeeee, 0xeeeee9ee, 0x6e, 0x291e0e, 0x6, 0x0
  .long 0xe160e06, 0xe360e26, 0xe560e46, 0xe760e66, 0xe960e86, 0xeb60ea6, 0xed60ec6, 0xeef0ef6
  .long 0x765fedca, 0xb4321098, 0xeeaeeeee, 0xeeeeeaee, 0xbe, 0x2a1a0e, 0xb, 0x0
  .long 0xe100e00, 0xe300e20, 0xe500e40, 0xe700e60, 0xe900e80, 0xeb00ea0, 0xed00ec0, 0xeff0ee0
  .long 0x76afedcb, 0x45321098, 0xff5fffff, 0xfffff7ff, 0x4f, 0x27150f, 0x4, 0x0
  .long 0xf2e0f1e, 0xf4e0f3e, 0xf6e0f5e, 0xf8e0f7e, 0xfae0f9e, 0xfce0fbe, 0xfee0fde, 0xf0f0ffe
  .long 0x76afedcb, 0x24351098, 0xff2fffff, 0xfffff4ff, 0x2f, 0x24120f, 0x2, 0x0
  .long 0xf2c0f0c, 0xf4c0f3c, 0xf6c0f5c, 0xf8c0f7c, 0xfac0f9c, 0xfcc0fbc, 0xfec0fdc, 0xf1f0ffc
  .long 0x76afedcb, 0x4321598, 0xff0fffff, 0xfffff8ff, 0xf, 0x28100f, 0x0, 0x0
  .long 0xf1a0f0a, 0xf4a0f3a, 0xf6a0f5a, 0xf8a0f7a, 0xfaa0f9a, 0xfca0fba, 0xfea0fda, 0xf2f0ffa
  .long 0x76afedcb, 0x94321058, 0xff6fffff, 0xfffff0ff, 0x9f, 0x20160f, 0x9, 0x0
  .long 0xf190f09, 0xf490f29, 0xf690f59, 0xf890f79, 0xfa90f99, 0xfc90fb9, 0xfe90fd9, 0xf3f0ff9
  .long 0x7a5fedcb, 0x64321098, 0xff5fffff, 0xfffff7ff, 0x6f, 0x27150f, 0x6, 0x0
  .long 0xf160f06, 0xf360f26, 0xf660f56, 0xf860f76, 0xfa60f96, 0xfc60fb6, 0xfe60fd6, 0xf4f0ff6
  .long 0x765feacb, 0xd4321098, 0xffffffff, 0xfffffeff, 0xdf, 0x2e1f0f, 0xd, 0x0
  .long 0xf120f02, 0xf320f22, 0xf620f42, 0xf820f72, 0xfa20f92, 0xfc20fb2, 0xfe20fd2, 0xf5f0ff2
  .long 0xa65fedcb, 0x74321098, 0xffbfffff, 0xfffff8ff, 0x7f, 0x281b0f, 0x7, 0x0
  .long 0xf170f07, 0xf370f27, 0xf570f47, 0xf870f77, 0xfa70f97, 0xfc70fb7, 0xfe70fd7, 0xf6f0ff7
  .long 0x765fedca, 0xb4321098, 0xff9fffff, 0xfffffbff, 0xbf, 0x2b190f, 0xb, 0x0
  .long 0xf100f00, 0xf300f20, 0xf500f40, 0xf800f60, 0xfa00f90, 0xfc00fb0, 0xfe00fd0, 0xf7f0ff0
  .long 0x76afedcb, 0x14325098, 0xff5fffff, 0xfffff7ff, 0x1f, 0x27150f, 0x1, 0x0
  .long 0xf1b0f0b, 0xf3b0f2b, 0xf5b0f4b, 0xf7b0f6b, 0xfab0f9b, 0xfcb0fbb, 0xfeb0fdb, 0xf8f0ffb
  .long 0x76afedcb, 0x34521098, 0xff2fffff, 0xfffff4ff, 0x3f, 0x24120f, 0x3, 0x0
  .long 0xf1d0f0d, 0xf3d0f2d, 0xf5d0f4d, 0xf7d0f6d, 0xfad0f8d, 0xfcd0fbd, 0xfed0fdd, 0xf9f0ffd
  .long 0x765aedcb, 0xf4321098, 0xffefffff, 0xfffffcff, 0xff, 0x2c1e0f, 0xf, 0x0
  .long 0xf140f04, 0xf340f24, 0xf540f44, 0xf740f64, 0xf940f84, 0xfc40fb4, 0xfe40fd4, 0xfaf0ff4
  .long 0x76afedcb, 0x54321098, 0xff6fffff, 0xfffff0ff, 0x56, 0x200f16, 0x5, 0x0
  .long 0x3850305, 0x4750455, 0x4f504d5, 0x6950615, 0x7e50765, 0xb450b25, 0xbc50ba5, 0xfbf0f39
  .long 0x765fedcb, 0x8432109a, 0xff5fffff, 0xfffff7ff, 0x8f, 0x27150f, 0x8, 0x0
  .long 0xf180f08, 0xf380f28, 0xf580f48, 0xf780f68, 0xf980f88, 0xfb80fa8, 0xfe80fd8, 0xfcf0ff8
  .long 0x765fedab, 0xc4321098, 0xffffffff, 0xfffffeff, 0xcf, 0x2e1f0f, 0xc, 0x0
  .long 0xf110f01, 0xf310f21, 0xf510f41, 0xf710f61, 0xf910f81, 0xfb10fa1, 0xfe10fc1, 0xfdf0ff1
  .long 0x765fedcb, 0xa4321098, 0xffbfffff, 0xfffff8ff, 0xa8, 0x1b0f28, 0xa, 0x0
  .long 0x3d50355, 0x7950715, 0x9850905, 0xac50a45, 0xbf50b75, 0xda50d35, 0xf250db5, 0xfef0f67
  .long 0x765fadcb, 0xe4321098, 0xff9fffff, 0xfffffbff, 0xef, 0x2b190f, 0xe, 0x0
  .long 0xf130f03, 0xf330f23, 0xf530f43, 0xf730f63, 0xf930f83, 0xfb30fa3, 0xfd30fc3, 0xfff0fe3
L_order_end:
.section .rodata,"a"
.p2align 6
.amdhsa_kernel standalone__kv_cache_quant_pre_rope_vs_post_rope__sampling_kernel
  .amdhsa_next_free_vgpr 243
  .amdhsa_next_free_sgpr 102
  .amdhsa_accum_offset 244
  .amdhsa_group_segment_fixed_size 0
  .amdhsa_kernarg_size 112
  .amdhsa_user_sgpr_count 2
  .amdhsa_user_sgpr_kernarg_segment_ptr 1
  .amdhsa_system_sgpr_workgroup_id_x 1
.end_amdhsa_kernel
```

```asm
; @launch grid=(256,1,1) block=(320,1,1) lds=162304
.amdgcn_target "amdgcn-amd-amdhsa--gfx950"
.text
.globl standalone__kv_cache_quant_pre_rope_vs_post_rope__sampling_kernel
.p2align 12
.type L_pad,@object
L_pad:
.fill 832, 4, 0xbf810000
.p2align 8
.type standalone__kv_cache_quant_pre_rope_vs_post_rope__sampling_kernel,@function
standalone__kv_cache_quant_pre_rope_vs_post_rope__sampling_kernel:
  s_cmpk_ge_u32 s2, 0x100
  s_cbranch_scc1 L_end
  s_load_dwordx16 s[4:19], s[0:1], 0
  s_load_dwordx8 s[20:27], s[0:1], 64
  v_readfirstlane_b32 s40, v0
  s_lshr_b32 s42, s2, 4
  s_cmp_lg_u32 s40, 0
  s_cbranch_scc1 L_s0
  s_setprio 3
  s_getpc_b64 s[64:65]
L_pc0:
  s_and_b32 s44, s2, 56
  v_and_b32 v20, 63, v0
  v_lshl_add_u32 v1, v20, 6, s44
  v_lshlrev_b32 v1, 4, v1
  v_min_u32 v1, L_order_end-L_pc0-1028, v1
  s_bfm_b64 exec, 43, 0
  global_load_dword v2, v1, s[64:65] offset:1024
  s_mov_b64 exec, -1
  v_min_u32 v21, 47, v20
  v_add_u32 v22, 24, v21
  v_subrev_u32 v23, 24, v21
  v_min_u32 v27, v22, v23
  s_mul_i32 s44, s42, 48
  v_add_lshl_u32 v22, v21, s44, 3
  v_add_lshl_u32 v23, v27, s44, 3
  v_lshlrev_b32 v26, 3, v21
  s_and_b32 s44, s2, 7
  s_lshr_b32 s45, s2, 3
  s_mul_i32 s68, s44, 96
  s_add_u32 s68, s68, s45
  v_and_b32 v3, 15, v21
  v_lshl_add_u32 v3, s68, 4, v3
  v_and_b32 v4, 48, v21
  v_lshl_add_u32 v3, v4, 5, v3
  v_lshlrev_b32 v3, 6, v3
  s_mul_i32 s68, s44, 98304
  v_subrev_u32 v12, s68, v3
  s_and_b32 s68, s45, 3
  s_lshl4_add_u32 s44, s68, s44
  s_lshr_b32 s45, s45, 2
  s_lshl_b32 s45, s45, 8
  s_add_u32 s44, s44, s45
  v_and_b32 v4, 7, v20
  v_lshl_add_u32 v4, s44, 3, v4
  v_and_b32 v5, 24, v20
  v_lshl_add_u32 v4, v5, 6, v4
  v_and_b32 v5, 32, v20
  v_lshl_add_u32 v4, v5, 1, v4
  v_lshlrev_b32 v4, 6, v4
  s_waitcnt lgkmcnt(0)
  global_load_dwordx2 v[108:109], v22, s[4:5]
  global_load_dwordx2 v[110:111], v23, s[4:5]
  global_load_dwordx2 v[104:105], v26, s[18:19]
  global_load_dwordx2 v[106:107], v26, s[20:21]
  v_lshlrev_b32 v27, 3, v27
  s_add_u32 s68, s42, 16
  s_mul_i32 s44, s68, 384
  s_add_u32 s32, s4, s44
  s_addc_u32 s33, s5, 0
  global_load_dwordx2 v[68:69], v26, s[32:33]
  global_load_dwordx2 v[70:71], v27, s[32:33]
  global_load_dword v5, v3, s[22:23]
  global_load_dword v6, v3, s[24:25]
  global_load_dword v7, v4, s[8:9]
  global_load_dword v8, v4, s[10:11]
  global_load_dword v9, v4, s[14:15]
  global_load_dword v10, v4, s[16:17]
  global_load_dword v11, v12, s[4:5]
  v_mov_b32 v14, 0
  v_cmp_gt_u32 vcc, 24, v21
  v_mov_b32 v48, 0
  v_mov_b32 v49, 0
  v_mov_b32 v50, 0
  v_mov_b32 v51, 0
  ds_write_b128 v14, v[48:51] offset:0
  ds_write_b128 v14, v[48:51] offset:16
  s_waitcnt lgkmcnt(0)
  s_barrier
  s_mov_b32 s66, 0xffff0000
  s_mov_b32 s67, 0x3dd53b95
  v_cndmask_b32_e64 v30, 1.0, -1.0, vcc
  v_lshlrev_b32 v35, 4, v21
  v_mov_b32 v28, v35
  v_lshlrev_b32 v29, 1, v27
  v_mov_b32 v22, 0x80008000
  v_cndmask_b32 v31, v14, v22, vcc
  v_mov_b32 v38, 1
  s_mov_b32 s43, 1
  s_waitcnt vmcnt(9)
  v_lshlrev_b32 v52, 16, v104
  v_and_b32 v53, s66, v104
  v_lshlrev_b32 v54, 16, v105
  v_and_b32 v55, s66, v105
  v_lshlrev_b32 v56, 16, v106
  v_and_b32 v57, s66, v106
  v_lshlrev_b32 v58, 16, v107
  v_and_b32 v59, s66, v107
L_hr:
  v_lshlrev_b32 v76, 16, v108
  v_and_b32 v77, s66, v108
  v_lshlrev_b32 v78, 16, v109
  v_and_b32 v79, s66, v109
  v_lshlrev_b32 v80, 16, v110
  v_and_b32 v81, s66, v110
  v_lshlrev_b32 v82, 16, v111
  v_and_b32 v83, s66, v111
  v_mul_f32 v76, v76, v52
  v_mul_f32 v77, v77, v53
  v_mul_f32 v78, v78, v54
  v_mul_f32 v79, v79, v55
  v_mul_f32 v80, v80, v56
  v_mul_f32 v81, v81, v57
  v_mul_f32 v82, v82, v58
  v_mul_f32 v83, v83, v59
  v_cvt_pk_bf16_f32 v84, v76, v80
  v_cvt_pk_bf16_f32 v85, v77, v81
  v_cvt_pk_bf16_f32 v86, v78, v82
  v_cvt_pk_bf16_f32 v87, v79, v83
  v_lshlrev_b32 v76, 16, v84
  v_and_b32 v80, s66, v84
  v_lshlrev_b32 v77, 16, v85
  v_and_b32 v81, s66, v85
  v_lshlrev_b32 v78, 16, v86
  v_and_b32 v82, s66, v86
  v_lshlrev_b32 v79, 16, v87
  v_and_b32 v83, s66, v87
  v_fma_f32 v76, v80, v30, v76
  v_fma_f32 v77, v81, v30, v77
  v_fma_f32 v78, v82, v30, v78
  v_fma_f32 v79, v83, v30, v79
  v_cvt_pk_bf16_f32 v84, v76, v77
  v_cvt_pk_bf16_f32 v85, v78, v79
  v_xor_b32 v86, v31, v84
  v_xor_b32 v87, v31, v85
  v_mov_b32 v22, s43
  ds_write_b16 v28, v84 offset:512
  ds_write_b16_d16_hi v28, v84 offset:516
  ds_write_b16 v28, v85 offset:520
  ds_write_b16_d16_hi v28, v85 offset:524
  ds_write_b16 v29, v86 offset:514
  ds_write_b16_d16_hi v29, v86 offset:518
  ds_write_b16 v29, v87 offset:522
  ds_write_b16_d16_hi v29, v87 offset:526
  ds_write_b32 v14, v22 offset:16
  v_add_u32 v28, 1024, v28
  v_add_u32 v29, 1024, v29
  v_and_b32 v28, 0xfff, v28
  v_and_b32 v29, 0xfff, v29
  s_cmp_eq_u32 s43, 2
  s_cbranch_scc1 L_helper
  s_mov_b32 s43, 2
  s_waitcnt vmcnt(7) lgkmcnt(0)
  v_mov_b32 v108, v68
  v_mov_b32 v109, v69
  v_mov_b32 v110, v70
  v_mov_b32 v111, v71
  s_branch L_hr
L_s0:
  v_subrev_u32 v0, 64, v0
  s_sub_u32 s40, s40, 64
  s_and_b32 s44, s2, 7
  s_lshl_b32 s44, s44, 8
  s_bfe_u32 s41, s2, 0x10003
  s_mul_i32 s45, s41, 43
  s_add_u32 s44, s44, s45
  s_mulk_i32 s44, 768
  v_lshl_add_u32 v212, v0, 4, s44
  v_add_u32 v213, 4096, v212
  v_add_u32 v214, 8192, v212
  v_add_u32 v215, 12288, v212
  v_add_u32 v216, 16384, v212
  v_add_u32 v217, 20480, v212
  v_add_u32 v218, 24576, v212
  s_lshr_b32 s40, s40, 6
  v_lshrrev_b32 v25, 4, v0
  v_and_b32 v24, 15, v0
  v_mul_u32_u24 v20, 11, v25
  v_lshrrev_b32 v20, 5, v20
  v_mad_i32_i24 v20, v20, -3, v25
  v_lshlrev_b32 v21, 4, v24
  v_lshl_add_u32 v15, v20, 8, v21
  v_add_u32 v20, 256, v15
  v_subrev_u32 v21, 512, v15
  v_min_u32 v16, v20, v21
  v_add_u32 v20, 512, v15
  v_subrev_u32 v21, 256, v15
  v_min_u32 v17, v20, v21
  v_cmp_gt_u32 vcc, 8, v24
  v_lshlrev_b32 v23, 3, v24
  v_lshrrev_b32 v22, 1, v15
  v_add3_u32 v20, v22, v23, 64
  v_subrev_u32 v21, 384, v20
  v_min_u32 v20, v20, v21
  v_sub_u32 v20, v20, v22
  v_cndmask_b32 v240, v20, v23, vcc
  v_lshrrev_b32 v22, 1, v16
  v_add3_u32 v20, v22, v23, 64
  v_subrev_u32 v21, 384, v20
  v_min_u32 v20, v20, v21
  v_sub_u32 v20, v20, v22
  v_cndmask_b32 v241, v20, v23, vcc
  v_lshrrev_b32 v22, 1, v17
  v_add3_u32 v20, v22, v23, 64
  v_subrev_u32 v21, 384, v20
  v_min_u32 v20, v20, v21
  v_sub_u32 v20, v20, v22
  v_cndmask_b32 v242, v20, v23, vcc
  s_mul_i32 s100, s40, 24576
  s_add_u32 s100, s100, 64000
  s_mul_i32 s44, s42, 1572864
  s_mov_b32 s34, 51904512
  s_mov_b32 s35, 0x20000
  s_mov_b32 s80, 25165824
  s_mov_b32 s3, 50331648
  s_waitcnt lgkmcnt(0)
  s_add_u32 s32, s6, s44
  s_addc_u32 s33, s7, 0
  v_mov_b32 v21, s22
  v_mov_b32 v28, s24
  v_cndmask_b32 v28, v28, v21, vcc
  v_mov_b32 v21, s23
  v_mov_b32 v29, s25
  v_cndmask_b32 v29, v29, v21, vcc
  s_add_u32 m0, s100, 0
  v_lshrrev_b32 v10, 1, v212
  v_add_u32 v10, v10, v240
  v_mad_u64_u32 v[30:31], s[64:65], v10, 1, v[28:29]
  global_load_lds_dwordx4 v[30:31], off
  buffer_load_dwordx4 v[68:71], v212, s[32:35], 0 offen nt
  buffer_load_dwordx4 v[72:75], v213, s[32:35], 0 offen nt
  s_add_u32 m0, s100, 1024
  v_lshrrev_b32 v10, 1, v213
  v_add_u32 v10, v10, v241
  v_mad_u64_u32 v[30:31], s[64:65], v10, 1, v[28:29]
  global_load_lds_dwordx4 v[30:31], off
  buffer_load_dwordx4 v[76:79], v214, s[32:35], 0 offen nt
  buffer_load_dwordx4 v[80:83], v212, s[32:35], s80 offen nt
  s_add_u32 m0, s100, 2048
  v_lshrrev_b32 v10, 1, v214
  v_add_u32 v10, v10, v242
  v_mad_u64_u32 v[30:31], s[64:65], v10, 1, v[28:29]
  global_load_lds_dwordx4 v[30:31], off
  buffer_load_dwordx4 v[84:87], v213, s[32:35], s80 offen nt
  s_barrier
  s_load_dwordx4 s[28:31], s[0:1], 96
  s_getpc_b64 s[82:83]
L_pc1:
  s_lshl_b32 s44, s2, 6
  s_add_u32 s44, s44, L_order-L_pc1
  s_add_u32 s82, s82, s44
  s_addc_u32 s83, s83, 0
  s_load_dwordx2 s[92:93], s[82:83], 0
  s_load_dwordx2 s[96:97], s[82:83], 8
  s_mov_b32 s94, 4000000
  s_mul_i32 s44, s41, 768
  s_add_u32 s44, s44, 32256
  v_add_u32 v20, s44, v212
  v_add_u32 v21, 65280, v212
  s_mul_i32 s45, s41, 3
  v_add_u32 v22, s45, v25
  v_cmp_ge_u32 s[48:49], v22, 17
  v_cmp_ge_u32 s[50:51], v22, 1
  v_cmp_ge_u32 s[52:53], v22, 18
  v_cmp_ge_u32 s[54:55], v22, 2
  v_add_u32 v235, 94208, v21
  v_add_u32 v234, 90112, v21
  v_add_u32 v233, 86016, v21
  v_add_u32 v232, 81920, v21
  v_add_u32 v231, 77824, v21
  v_add_u32 v230, 73728, v21
  v_add_u32 v229, 69632, v21
  v_cndmask_b32_e64 v228, v20, v21, s[54:55]
  v_add_u32 v228, 65536, v228
  v_cndmask_b32_e64 v227, v20, v21, s[52:53]
  v_add_u32 v227, 61440, v227
  v_add_u32 v226, 57344, v20
  v_add_u32 v225, 53248, v20
  v_add_u32 v224, 49152, v20
  v_add_u32 v223, 45056, v20
  v_add_u32 v222, 40960, v20
  v_add_u32 v221, 36864, v20
  v_cndmask_b32_e64 v220, v212, v20, s[50:51]
  v_add_u32 v220, 32768, v220
  v_cndmask_b32_e64 v219, v212, v20, s[48:49]
  v_add_u32 v219, 28672, v219
  v_lshrrev_b32 v22, 6, v0
  v_bfe_u32 v23, v0, 4, 2
  v_mov_b32 v14, 0
  v_and_b32 v20, 3, v0
  v_lshl_add_u32 v1, v20, 5, v25
  v_and_b32 v20, 4, v0
  v_lshl_add_u32 v1, v20, 2, v1
  v_and_b32 v20, 8, v0
  v_mad_u32_u24 v1, v20, 48, v1
  v_lshlrev_b32 v1, 2, v1
  v_add_u32 v1, 45568, v1
  v_lshl_add_u32 v21, v24, 2, v23
  v_mul_u32_u24 v20, 192, v22
  v_add_lshl_u32 v3, v20, v21, 2
  v_add_u32 v3, 64000, v3
  v_lshlrev_b32 v6, 2, v22
  v_mov_b32 v32, 0
  v_mov_b32 v34, 0
  v_mov_b32 v33, 0
  v_mov_b32 v35, 0
  s_mov_b32 s48, 0x11111111
  s_mov_b32 s49, s48
  s_mov_b32 s50, 0x22222222
  s_mov_b32 s51, s50
  s_mov_b32 s52, 0x44444444
  s_mov_b32 s53, s52
  s_mov_b32 s54, 0x88888888
  s_mov_b32 s55, s54
  s_mov_b32 s56, 0x05040100
  s_mov_b32 s57, 0x07060302
  s_mov_b32 s38, 1572864
  s_mov_b32 s39, 0x20000
  v_lshlrev_b32 v21, 8, v23
  v_add_u32 v21, s100, v21
  v_lshl_add_u32 v12, v24, 3, v21
  s_getreg_b32 s81, hwreg(HW_REG_HW_ID, 13, 2)
  s_getreg_b32 s79, hwreg(HW_REG_HW_ID, 8, 4)
  s_getreg_b32 s46, hwreg(HW_REG_XCC_ID, 0, 3)
  s_mul_i32 s46, s46, 4352
  s_add_u32 s46, s46, 8126464
  s_add_u32 s44, s46, 2048
  v_mov_b32 v11, s44
  s_and_b32 s45, s81, 2
  s_lshl_b32 s45, s45, 9
  s_lshl_b32 s44, s40, 8
  s_add_u32 s44, s44, s45
  s_add_u32 s44, s44, s46
  s_add_u32 s44, s44, s79
  s_and_b32 s81, s81, 1
  s_lshl_b32 s81, s81, 4
  s_add_u32 s44, s44, s81
  v_mov_b32 v7, s44
  s_xor_b32 s45, s45, 1024
  s_add_u32 s46, s46, s45
  v_and_b32 v8, 1, v0
  v_lshl_add_u32 v8, v8, 4, s46
  v_bfe_u32 v21, v0, 1, 2
  v_mad_u32_u24 v21, v21, 4, v22
  v_add_u32 v9, 0, v21
  v_and_b32 v9, 3, v9
  v_lshl_add_u32 v236, v9, 8, v8
  v_add_u32 v9, 1, v21
  v_and_b32 v9, 3, v9
  v_lshl_add_u32 v237, v9, 8, v8
  v_add_u32 v9, 2, v21
  v_and_b32 v9, 3, v9
  v_lshl_add_u32 v238, v9, 8, v8
  v_add_u32 v9, 3, v21
  v_and_b32 v9, 3, v9
  v_lshl_add_u32 v239, v9, 8, v8
  s_mov_b32 s78, 0xfefefeff
  v_mov_b32 v36, 0
  v_mov_b32 v37, 0
  v_mov_b32 v38, 0
  v_mov_b32 v39, 0
  v_mov_b32 v40, 0
  v_mov_b32 v41, 0
  v_mov_b32 v42, 0
  v_mov_b32 v43, 0
  v_mov_b32 v26, 0
  v_mov_b32 v27, 0
  v_mov_b32 v8, 3
  s_cmp_lt_u32 s40, 4
  s_cselect_b64 s[60:61], 1, 0
  s_getreg_b32 s58, hwreg(HW_REG_XCC_ID, 0, 1)
  s_mul_i32 s58, s58, -6
  s_add_u32 s58, s58, 3
  s_mov_b32 s91, s58
  s_mov_b32 s69, 0
  s_mov_b32 s95, 0
  buffer_load_dwordx4 v[88:91], v214, s[32:35], s80 offen nt
  s_add_u32 m0, s100, 3072
  v_lshrrev_b32 v10, 1, v215
  v_add_u32 v10, v10, v240
  v_mad_u64_u32 v[30:31], s[64:65], v10, 1, v[28:29]
  s_waitcnt vmcnt(8)
  global_load_lds_dwordx4 v[30:31], off
  s_waitcnt vmcnt(8)
  buffer_load_dwordx4 v[92:95], v215, s[32:35], 0 offen nt
  s_add_u32 m0, s100, 4096
  v_lshrrev_b32 v10, 1, v216
  v_add_u32 v10, v10, v241
  v_mad_u64_u32 v[30:31], s[64:65], v10, 1, v[28:29]
  s_waitcnt vmcnt(8)
  global_load_lds_dwordx4 v[30:31], off
  s_waitcnt vmcnt(8)
  buffer_load_dwordx4 v[96:99], v216, s[32:35], 0 offen nt
  s_mov_b32 s47, 1
  ds_read_b32 v4, v14 offset:16
L_fqz:
  s_waitcnt lgkmcnt(0)
  v_readfirstlane_b32 s46, v4
  s_cmp_ge_u32 s46, s47
  s_cbranch_scc1 L_fqz_ok
  s_cmp_eq_u32 s94, 0
  s_cbranch_scc1 L_fqz_ok
  s_sub_u32 s94, s94, 1
  ds_read_b32 v4, v14 offset:16
  s_branch L_fqz
L_fqz_ok:
  ds_read_b128 v[44:47], v15 offset:512
  ds_read_b128 v[48:51], v16 offset:512
  ds_read_b128 v[52:55], v17 offset:512
  s_add_u32 m0, s100, 5120
  v_lshrrev_b32 v10, 1, v217
  v_add_u32 v10, v10, v242
  v_mad_u64_u32 v[30:31], s[64:65], v10, 1, v[28:29]
  s_waitcnt vmcnt(8)
  global_load_lds_dwordx4 v[30:31], off
  s_waitcnt vmcnt(7)
  ds_read_b64 v[116:117], v12 offset:0
  ds_read_b64 v[118:119], v12 offset:128
  ds_read_b64 v[120:121], v12 offset:1024
  ds_read_b64 v[122:123], v12 offset:1152
  ds_read_b64 v[124:125], v12 offset:2048
  ds_read_b64 v[126:127], v12 offset:2176
  buffer_load_dwordx4 v[100:103], v217, s[32:35], 0 offen nt
L_it0:
  s_mov_b32 s47, 2
  ds_read_b32 v4, v14 offset:16
L_fq0:
  s_waitcnt lgkmcnt(0)
  v_readfirstlane_b32 s46, v4
  s_cmp_ge_u32 s46, s47
  s_cbranch_scc1 L_fq0_ok
  s_cmp_eq_u32 s94, 0
  s_cbranch_scc1 L_fq0_ok
  s_sub_u32 s94, s94, 1
  ds_read_b32 v4, v14 offset:16
  s_branch L_fq0
L_fq0_ok:
  ds_read_b128 v[56:59], v15 offset:1536
  ds_read_b128 v[60:63], v16 offset:1536
  ds_read_b128 v[64:67], v17 offset:1536
  v_perm_b32 v13, v118, v116, s56
  v_perm_b32 v118, v118, v116, s57
  v_perm_b32 v116, v119, v117, s56
  v_perm_b32 v119, v119, v117, s57
  v_dot2_f32_bf16 v22, v13, v44, 0
  v_dot2_f32_bf16 v23, v118, v45, 0
  v_dot2_f32_bf16 v24, v116, v46, 0
  v_dot2_f32_bf16 v25, v119, v47, 0
  v_cvt_f32_i32 v68, v68
  v_cvt_f32_i32 v69, v69
  v_cvt_f32_i32 v70, v70
  v_cvt_f32_i32 v71, v71
  v_pk_mul_f32 v[20:21], v[68:69], v[22:23]
  v_pk_add_f32 v[18:19], v[22:23], v[24:25]
  v_pk_fma_f32 v[20:21], v[70:71], v[24:25], v[20:21]
  v_add_f32 v18, v18, v19
  v_add_f32 v20, v20, v21
  s_add_u32 m0, s100, 6144
  v_lshrrev_b32 v10, 1, v218
  v_add_u32 v10, v10, v240
  v_mad_u64_u32 v[30:31], s[64:65], v10, 1, v[28:29]
  global_load_lds_dwordx4 v[30:31], off
  s_waitcnt vmcnt(8)
  buffer_load_dwordx4 v[104:107], v215, s[32:35], s80 offen nt
  v_perm_b32 v117, v122, v120, s56
  v_perm_b32 v122, v122, v120, s57
  v_perm_b32 v120, v123, v121, s56
  v_perm_b32 v123, v123, v121, s57
  v_dot2_f32_bf16 v22, v117, v48, 0
  v_add_f32_dpp v34, v18, v18 row_ror:8 row_mask:0xf bank_mask:0xc
  v_add_f32_dpp v34, v20, v20 row_ror:8 row_mask:0xf bank_mask:0x3
  v_dot2_f32_bf16 v23, v122, v49, 0
  v_dot2_f32_bf16 v24, v120, v50, 0
  v_dot2_f32_bf16 v25, v123, v51, 0
  v_cvt_f32_i32 v72, v72
  v_cvt_f32_i32 v73, v73
  v_cvt_f32_i32 v74, v74
  v_cvt_f32_i32 v75, v75
  v_pk_mul_f32 v[20:21], v[72:73], v[22:23]
  v_pk_add_f32 v[18:19], v[22:23], v[24:25]
  v_pk_fma_f32 v[20:21], v[74:75], v[24:25], v[20:21]
  v_add_f32 v18, v18, v19
  v_add_f32 v20, v20, v21
  s_waitcnt vmcnt(8)
  buffer_load_dwordx4 v[108:111], v216, s[32:35], s80 offen nt
  v_perm_b32 v121, v126, v124, s56
  v_perm_b32 v126, v126, v124, s57
  v_perm_b32 v124, v127, v125, s56
  v_perm_b32 v127, v127, v125, s57
  v_dot2_f32_bf16 v22, v121, v52, 0
  v_add_f32_dpp v21, v18, v18 row_ror:8 row_mask:0xf bank_mask:0xc
  v_add_f32_dpp v21, v20, v20 row_ror:8 row_mask:0xf bank_mask:0x3
  v_add_f32_dpp v20, v34, v34 row_half_mirror row_mask:0xf bank_mask:0x5
  v_dot2_f32_bf16 v23, v126, v53, 0
  v_add_f32_dpp v20, v21, v21 row_half_mirror row_mask:0xf bank_mask:0xa
  v_dot2_f32_bf16 v24, v124, v54, 0
  v_dot2_f32_bf16 v25, v127, v55, 0
  v_add_f32_dpp v20, v20, v20 quad_perm:[2,3,0,1] row_mask:0xf bank_mask:0xf
  v_cvt_f32_i32 v76, v76
  v_cvt_f32_i32 v77, v77
  v_add_f32_dpp v20, v20, v20 quad_perm:[1,0,3,2] row_mask:0xf bank_mask:0xf
  v_cndmask_b32_e64 v32, v32, v20, s[48:49]
  v_cvt_f32_i32 v78, v78
  v_cvt_f32_i32 v79, v79
  v_pk_mul_f32 v[20:21], v[76:77], v[22:23]
  v_pk_add_f32 v[18:19], v[22:23], v[24:25]
  v_pk_fma_f32 v[20:21], v[78:79], v[24:25], v[20:21]
  v_add_f32 v18, v18, v19
  v_add_f32 v20, v20, v21
  s_add_u32 m0, s100, 7168
  v_lshrrev_b32 v10, 1, v219
  v_add_u32 v10, v10, v241
  v_mad_u64_u32 v[30:31], s[64:65], v10, 1, v[28:29]
  s_waitcnt vmcnt(8)
  global_load_lds_dwordx4 v[30:31], off
  s_waitcnt vmcnt(8)
  buffer_load_dwordx4 v[112:115], v217, s[32:35], s80 offen nt
L_it1:
  s_waitcnt lgkmcnt(0)
  v_dot2_f32_bf16 v22, v13, v56, 0
  v_add_f32_dpp v34, v18, v18 row_ror:8 row_mask:0xf bank_mask:0xc
  v_add_f32_dpp v34, v20, v20 row_ror:8 row_mask:0xf bank_mask:0x3
  v_dot2_f32_bf16 v23, v118, v57, 0
  v_dot2_f32_bf16 v24, v116, v58, 0
  v_dot2_f32_bf16 v25, v119, v59, 0
  v_cvt_f32_i32 v80, v80
  v_cvt_f32_i32 v81, v81
  v_cvt_f32_i32 v82, v82
  v_cvt_f32_i32 v83, v83
  v_pk_mul_f32 v[20:21], v[80:81], v[22:23]
  v_pk_add_f32 v[18:19], v[22:23], v[24:25]
  v_pk_fma_f32 v[20:21], v[82:83], v[24:25], v[20:21]
  v_add_f32 v18, v18, v19
  v_add_f32 v20, v20, v21
  s_waitcnt vmcnt(8)
  buffer_load_dwordx4 v[68:71], v218, s[32:35], 0 offen nt
  v_dot2_f32_bf16 v22, v117, v60, 0
  v_add_f32_dpp v35, v18, v18 row_ror:8 row_mask:0xf bank_mask:0xc
  v_add_f32_dpp v35, v20, v20 row_ror:8 row_mask:0xf bank_mask:0x3
  v_dot2_f32_bf16 v23, v122, v61, 0
  v_dot2_f32_bf16 v24, v120, v62, 0
  v_dot2_f32_bf16 v25, v123, v63, 0
  v_cvt_f32_i32 v84, v84
  v_cvt_f32_i32 v85, v85
  v_cvt_f32_i32 v86, v86
  v_cvt_f32_i32 v87, v87
  v_pk_mul_f32 v[20:21], v[84:85], v[22:23]
  v_pk_add_f32 v[18:19], v[22:23], v[24:25]
  v_pk_fma_f32 v[20:21], v[86:87], v[24:25], v[20:21]
  v_add_f32 v18, v18, v19
  v_add_f32 v20, v20, v21
  s_add_u32 m0, s100, 8192
  v_lshrrev_b32 v10, 1, v220
  v_add_u32 v10, v10, v242
  v_mad_u64_u32 v[30:31], s[64:65], v10, 1, v[28:29]
  s_waitcnt vmcnt(8)
  global_load_lds_dwordx4 v[30:31], off
  s_waitcnt vmcnt(8)
  buffer_load_dwordx4 v[72:75], v219, s[32:35], 0 offen nt
  ds_read_b64 v[128:129], v12 offset:3072
  ds_read_b64 v[130:131], v12 offset:3200
  ds_read_b64 v[132:133], v12 offset:4096
  ds_read_b64 v[134:135], v12 offset:4224
  ds_read_b64 v[136:137], v12 offset:5120
  ds_read_b64 v[138:139], v12 offset:5248
  v_dot2_f32_bf16 v22, v121, v64, 0
  v_add_f32_dpp v21, v18, v18 row_ror:8 row_mask:0xf bank_mask:0xc
  v_add_f32_dpp v21, v20, v20 row_ror:8 row_mask:0xf bank_mask:0x3
  v_add_f32_dpp v20, v35, v35 row_half_mirror row_mask:0xf bank_mask:0x5
  v_dot2_f32_bf16 v23, v126, v65, 0
  v_add_f32_dpp v20, v21, v21 row_half_mirror row_mask:0xf bank_mask:0xa
  v_dot2_f32_bf16 v24, v124, v66, 0
  v_dot2_f32_bf16 v25, v127, v67, 0
  v_add_f32_dpp v20, v20, v20 quad_perm:[2,3,0,1] row_mask:0xf bank_mask:0xf
  v_cvt_f32_i32 v88, v88
  v_cvt_f32_i32 v89, v89
  v_add_f32_dpp v20, v20, v20 quad_perm:[1,0,3,2] row_mask:0xf bank_mask:0xf
  v_cndmask_b32_e64 v33, v33, v20, s[48:49]
  v_cvt_f32_i32 v90, v90
  v_cvt_f32_i32 v91, v91
  v_pk_mul_f32 v[20:21], v[88:89], v[22:23]
  v_pk_add_f32 v[18:19], v[22:23], v[24:25]
  v_pk_fma_f32 v[20:21], v[90:91], v[24:25], v[20:21]
  v_add_f32 v18, v18, v19
  v_add_f32 v20, v20, v21
  s_waitcnt vmcnt(8)
  buffer_load_dwordx4 v[76:79], v220, s[32:35], 0 offen nt
L_it2:
  s_waitcnt lgkmcnt(0)
  v_perm_b32 v125, v130, v128, s56
  v_perm_b32 v130, v130, v128, s57
  v_perm_b32 v128, v131, v129, s56
  v_perm_b32 v131, v131, v129, s57
  v_dot2_f32_bf16 v22, v125, v44, 0
  v_add_f32_dpp v35, v18, v18 row_ror:8 row_mask:0xf bank_mask:0xc
  v_add_f32_dpp v35, v20, v20 row_ror:8 row_mask:0xf bank_mask:0x3
  v_dot2_f32_bf16 v23, v130, v45, 0
  v_dot2_f32_bf16 v24, v128, v46, 0
  v_dot2_f32_bf16 v25, v131, v47, 0
  v_cvt_f32_i32 v92, v92
  v_cvt_f32_i32 v93, v93
  v_cvt_f32_i32 v94, v94
  v_cvt_f32_i32 v95, v95
  v_pk_mul_f32 v[20:21], v[92:93], v[22:23]
  v_pk_add_f32 v[18:19], v[22:23], v[24:25]
  v_pk_fma_f32 v[20:21], v[94:95], v[24:25], v[20:21]
  v_add_f32 v18, v18, v19
  v_add_f32 v20, v20, v21
  s_add_u32 m0, s100, 9216
  v_lshrrev_b32 v10, 1, v221
  v_add_u32 v10, v10, v240
  v_mad_u64_u32 v[30:31], s[64:65], v10, 1, v[28:29]
  s_waitcnt vmcnt(8)
  global_load_lds_dwordx4 v[30:31], off
  s_waitcnt vmcnt(8)
  buffer_load_dwordx4 v[80:83], v218, s[32:35], s80 offen nt
  v_perm_b32 v129, v134, v132, s56
  v_perm_b32 v134, v134, v132, s57
  v_perm_b32 v132, v135, v133, s56
  v_perm_b32 v135, v135, v133, s57
  v_dot2_f32_bf16 v22, v129, v48, 0
  v_add_f32_dpp v21, v18, v18 row_ror:8 row_mask:0xf bank_mask:0xc
  v_add_f32_dpp v21, v20, v20 row_ror:8 row_mask:0xf bank_mask:0x3
  v_add_f32_dpp v20, v34, v34 row_half_mirror row_mask:0xf bank_mask:0x5
  v_dot2_f32_bf16 v23, v134, v49, 0
  v_add_f32_dpp v20, v21, v21 row_half_mirror row_mask:0xf bank_mask:0xa
  v_dot2_f32_bf16 v24, v132, v50, 0
  v_dot2_f32_bf16 v25, v135, v51, 0
  v_add_f32_dpp v20, v20, v20 quad_perm:[2,3,0,1] row_mask:0xf bank_mask:0xf
  v_cvt_f32_i32 v96, v96
  v_cvt_f32_i32 v97, v97
  v_add_f32_dpp v20, v20, v20 quad_perm:[1,0,3,2] row_mask:0xf bank_mask:0xf
  v_cndmask_b32_e64 v32, v32, v20, s[50:51]
  v_cvt_f32_i32 v98, v98
  v_cvt_f32_i32 v99, v99
  v_pk_mul_f32 v[20:21], v[96:97], v[22:23]
  v_pk_add_f32 v[18:19], v[22:23], v[24:25]
  v_pk_fma_f32 v[20:21], v[98:99], v[24:25], v[20:21]
  v_add_f32 v18, v18, v19
  v_add_f32 v20, v20, v21
  s_waitcnt vmcnt(8)
  buffer_load_dwordx4 v[84:87], v219, s[32:35], s80 offen nt
  v_perm_b32 v133, v138, v136, s56
  v_perm_b32 v138, v138, v136, s57
  v_perm_b32 v136, v139, v137, s56
  v_perm_b32 v139, v139, v137, s57
  v_dot2_f32_bf16 v22, v133, v52, 0
  v_add_f32_dpp v34, v18, v18 row_ror:8 row_mask:0xf bank_mask:0xc
  v_add_f32_dpp v34, v20, v20 row_ror:8 row_mask:0xf bank_mask:0x3
  v_dot2_f32_bf16 v23, v138, v53, 0
  v_dot2_f32_bf16 v24, v136, v54, 0
  v_dot2_f32_bf16 v25, v139, v55, 0
  v_cvt_f32_i32 v100, v100
  v_cvt_f32_i32 v101, v101
  v_cvt_f32_i32 v102, v102
  v_cvt_f32_i32 v103, v103
  v_pk_mul_f32 v[20:21], v[100:101], v[22:23]
  v_pk_add_f32 v[18:19], v[22:23], v[24:25]
  v_pk_fma_f32 v[20:21], v[102:103], v[24:25], v[20:21]
  v_add_f32 v18, v18, v19
  v_add_f32 v20, v20, v21
  s_add_u32 m0, s100, 10240
  v_lshrrev_b32 v10, 1, v222
  v_add_u32 v10, v10, v241
  v_mad_u64_u32 v[30:31], s[64:65], v10, 1, v[28:29]
  s_waitcnt vmcnt(8)
  global_load_lds_dwordx4 v[30:31], off
  s_waitcnt vmcnt(8)
  buffer_load_dwordx4 v[88:91], v220, s[32:35], s80 offen nt
L_it3:
  s_waitcnt lgkmcnt(0)
  s_add_u32 s44, s78, 0x03030303
  v_msad_u8 v9, s78, v40, 0
  v_msad_u8 v10, s44, v40, 0
  v_msad_u8 v9, s78, v41, v9
  v_msad_u8 v10, s44, v41, v10
  v_msad_u8 v9, s78, v42, v9
  v_msad_u8 v10, s44, v42, v10
  s_mov_b64 exec, 3
  global_store_byte v7, v8, s[30:31]
  global_load_dwordx3 v[40:42], v239, s[30:31] sc1
  v_sub_u32 v9, v9, v10
  v_add_u32 v8, 1, v8
  s_mov_b64 exec, -1
  v_readlane_b32 s66, v9, 0
  v_readlane_b32 s67, v9, 1
  s_add_u32 s78, s78, 0x01010101
  s_lshl1_add_u32 s69, s91, s95
  s_add_u32 s95, s66, s67
  s_mov_b32 s69, 0
  v_dot2_f32_bf16 v22, v125, v56, 0
  v_add_f32_dpp v21, v18, v18 row_ror:8 row_mask:0xf bank_mask:0xc
  v_add_f32_dpp v21, v20, v20 row_ror:8 row_mask:0xf bank_mask:0x3
  v_add_f32_dpp v20, v34, v34 row_half_mirror row_mask:0xf bank_mask:0x5
  v_dot2_f32_bf16 v23, v130, v57, 0
  v_add_f32_dpp v20, v21, v21 row_half_mirror row_mask:0xf bank_mask:0xa
  v_dot2_f32_bf16 v24, v128, v58, 0
  v_dot2_f32_bf16 v25, v131, v59, 0
  v_add_f32_dpp v20, v20, v20 quad_perm:[2,3,0,1] row_mask:0xf bank_mask:0xf
  v_cvt_f32_i32 v104, v104
  v_cvt_f32_i32 v105, v105
  v_add_f32_dpp v20, v20, v20 quad_perm:[1,0,3,2] row_mask:0xf bank_mask:0xf
  v_cndmask_b32_e64 v32, v32, v20, s[52:53]
  v_cvt_f32_i32 v106, v106
  v_cvt_f32_i32 v107, v107
  v_pk_mul_f32 v[20:21], v[104:105], v[22:23]
  v_pk_add_f32 v[18:19], v[22:23], v[24:25]
  v_pk_fma_f32 v[20:21], v[106:107], v[24:25], v[20:21]
  v_add_f32 v18, v18, v19
  v_add_f32 v20, v20, v21
  s_cmpk_gt_i32 s69, 0x31
  s_cbranch_scc1 L_p2_4
  s_cmpk_gt_i32 s69, 0xffed
  s_cbranch_scc1 L_p2_1
  s_waitcnt vmcnt(6)
L_p2_1:
  s_waitcnt vmcnt(8)
L_p2_4:
  s_waitcnt vmcnt(9)
  buffer_load_dwordx4 v[92:95], v221, s[32:35], 0 offen nt
  v_dot2_f32_bf16 v22, v129, v60, 0
  v_add_f32_dpp v21, v18, v18 row_ror:8 row_mask:0xf bank_mask:0xc
  v_add_f32_dpp v21, v20, v20 row_ror:8 row_mask:0xf bank_mask:0x3
  v_add_f32_dpp v20, v35, v35 row_half_mirror row_mask:0xf bank_mask:0x5
  v_dot2_f32_bf16 v23, v134, v61, 0
  v_add_f32_dpp v20, v21, v21 row_half_mirror row_mask:0xf bank_mask:0xa
  v_dot2_f32_bf16 v24, v132, v62, 0
  v_dot2_f32_bf16 v25, v135, v63, 0
  v_add_f32_dpp v20, v20, v20 quad_perm:[2,3,0,1] row_mask:0xf bank_mask:0xf
  v_cvt_f32_i32 v108, v108
  v_cvt_f32_i32 v109, v109
  v_add_f32_dpp v20, v20, v20 quad_perm:[1,0,3,2] row_mask:0xf bank_mask:0xf
  v_cndmask_b32_e64 v33, v33, v20, s[50:51]
  v_cvt_f32_i32 v110, v110
  v_cvt_f32_i32 v111, v111
  v_pk_mul_f32 v[20:21], v[108:109], v[22:23]
  v_pk_add_f32 v[18:19], v[22:23], v[24:25]
  v_pk_fma_f32 v[20:21], v[110:111], v[24:25], v[20:21]
  v_add_f32 v18, v18, v19
  v_add_f32 v20, v20, v21
  s_add_u32 m0, s100, 11264
  v_lshrrev_b32 v10, 1, v223
  v_add_u32 v10, v10, v242
  v_mad_u64_u32 v[30:31], s[64:65], v10, 1, v[28:29]
  global_load_lds_dwordx4 v[30:31], off
  s_cmpk_gt_i32 s69, 0x31
  s_cbranch_scc1 L_p3_4
  s_cmpk_gt_i32 s69, 0xb
  s_cbranch_scc1 L_p3_2
  s_waitcnt vmcnt(8)
L_p3_2:
  s_waitcnt vmcnt(10)
L_p3_4:
  s_waitcnt vmcnt(11)
  buffer_load_dwordx4 v[96:99], v222, s[32:35], 0 offen nt
  s_waitcnt vmcnt(11)
  ds_read_b64 v[140:141], v12 offset:6144
  ds_read_b64 v[142:143], v12 offset:6272
  ds_read_b64 v[144:145], v12 offset:7168
  ds_read_b64 v[146:147], v12 offset:7296
  ds_read_b64 v[148:149], v12 offset:8192
  ds_read_b64 v[150:151], v12 offset:8320
  v_dot2_f32_bf16 v22, v133, v64, 0
  v_add_f32_dpp v35, v18, v18 row_ror:8 row_mask:0xf bank_mask:0xc
  v_add_f32_dpp v35, v20, v20 row_ror:8 row_mask:0xf bank_mask:0x3
  v_dot2_f32_bf16 v23, v138, v65, 0
  v_dot2_f32_bf16 v24, v136, v66, 0
  v_dot2_f32_bf16 v25, v139, v67, 0
  v_cvt_f32_i32 v112, v112
  v_cvt_f32_i32 v113, v113
  v_cvt_f32_i32 v114, v114
  v_cvt_f32_i32 v115, v115
  v_pk_mul_f32 v[20:21], v[112:113], v[22:23]
  v_pk_add_f32 v[18:19], v[22:23], v[24:25]
  v_pk_fma_f32 v[20:21], v[114:115], v[24:25], v[20:21]
  v_add_f32 v18, v18, v19
  v_add_f32 v20, v20, v21
  s_cmpk_gt_i32 s69, 0x31
  s_cbranch_scc1 L_p4_4
  s_cmpk_gt_i32 s69, 0x1d
  s_cbranch_scc1 L_p4_3
  s_cmpk_gt_i32 s69, 0xffcd
  s_cbranch_scc1 L_p4_0
  s_waitcnt vmcnt(8)
L_p4_0:
  s_waitcnt vmcnt(9)
L_p4_3:
  s_waitcnt vmcnt(11)
L_p4_4:
  s_waitcnt vmcnt(12)
  buffer_load_dwordx4 v[100:103], v223, s[32:35], 0 offen nt
L_it4:
  s_waitcnt lgkmcnt(0)
  s_add_u32 s44, s78, 0x03030303
  v_msad_u8 v9, s78, v36, 0
  v_msad_u8 v10, s44, v36, 0
  v_msad_u8 v9, s78, v37, v9
  v_msad_u8 v10, s44, v37, v10
  v_msad_u8 v9, s78, v38, v9
  v_msad_u8 v10, s44, v38, v10
  s_mov_b64 exec, 3
  global_store_byte v7, v8, s[30:31]
  global_load_dwordx3 v[36:38], v236, s[30:31] sc1
  v_sub_u32 v9, v9, v10
  v_add_u32 v8, 1, v8
  s_mov_b64 exec, -1
  v_readlane_b32 s66, v9, 0
  v_readlane_b32 s67, v9, 1
  s_add_u32 s78, s78, 0x01010101
  s_lshl1_add_u32 s69, s91, s95
  s_add_u32 s95, s66, s67
  s_mov_b32 s69, 0
  v_perm_b32 v137, v142, v140, s56
  v_perm_b32 v142, v142, v140, s57
  v_perm_b32 v140, v143, v141, s56
  v_perm_b32 v143, v143, v141, s57
  v_dot2_f32_bf16 v22, v137, v44, 0
  v_add_f32_dpp v21, v18, v18 row_ror:8 row_mask:0xf bank_mask:0xc
  v_add_f32_dpp v21, v20, v20 row_ror:8 row_mask:0xf bank_mask:0x3
  v_add_f32_dpp v20, v35, v35 row_half_mirror row_mask:0xf bank_mask:0x5
  v_dot2_f32_bf16 v23, v142, v45, 0
  v_add_f32_dpp v20, v21, v21 row_half_mirror row_mask:0xf bank_mask:0xa
  v_dot2_f32_bf16 v24, v140, v46, 0
  v_dot2_f32_bf16 v25, v143, v47, 0
  v_add_f32_dpp v20, v20, v20 quad_perm:[2,3,0,1] row_mask:0xf bank_mask:0xf
  v_cvt_f32_i32 v68, v68
  v_cvt_f32_i32 v69, v69
  v_add_f32_dpp v20, v20, v20 quad_perm:[1,0,3,2] row_mask:0xf bank_mask:0xf
  v_cndmask_b32_e64 v33, v33, v20, s[52:53]
  v_cvt_f32_i32 v70, v70
  v_cvt_f32_i32 v71, v71
  v_pk_mul_f32 v[20:21], v[68:69], v[22:23]
  v_pk_add_f32 v[18:19], v[22:23], v[24:25]
  v_pk_fma_f32 v[20:21], v[70:71], v[24:25], v[20:21]
  v_add_f32 v18, v18, v19
  v_add_f32 v20, v20, v21
  s_add_u32 m0, s100, 12288
  v_lshrrev_b32 v10, 1, v224
  v_add_u32 v10, v10, v240
  v_mad_u64_u32 v[30:31], s[64:65], v10, 1, v[28:29]
  global_load_lds_dwordx4 v[30:31], off
  s_cmpk_gt_i32 s69, 0x31
  s_cbranch_scc1 L_p5_4
  s_cmpk_gt_i32 s69, 0xffed
  s_cbranch_scc1 L_p5_1
  s_waitcnt vmcnt(7)
L_p5_1:
  s_waitcnt vmcnt(10)
L_p5_4:
  s_waitcnt vmcnt(12)
  buffer_load_dwordx4 v[104:107], v221, s[32:35], s80 offen nt
  v_perm_b32 v141, v146, v144, s56
  v_perm_b32 v146, v146, v144, s57
  v_perm_b32 v144, v147, v145, s56
  v_perm_b32 v147, v147, v145, s57
  v_dot2_f32_bf16 v22, v141, v48, 0
  v_add_f32_dpp v34, v18, v18 row_ror:8 row_mask:0xf bank_mask:0xc
  v_add_f32_dpp v34, v20, v20 row_ror:8 row_mask:0xf bank_mask:0x3
  v_dot2_f32_bf16 v23, v146, v49, 0
  v_dot2_f32_bf16 v24, v144, v50, 0
  v_dot2_f32_bf16 v25, v147, v51, 0
  v_cvt_f32_i32 v72, v72
  v_cvt_f32_i32 v73, v73
  v_cvt_f32_i32 v74, v74
  v_cvt_f32_i32 v75, v75
  v_pk_mul_f32 v[20:21], v[72:73], v[22:23]
  v_pk_add_f32 v[18:19], v[22:23], v[24:25]
  v_pk_fma_f32 v[20:21], v[74:75], v[24:25], v[20:21]
  v_add_f32 v18, v18, v19
  v_add_f32 v20, v20, v21
  s_cmpk_gt_i32 s69, 0x31
  s_cbranch_scc1 L_p6_4
  s_cmpk_gt_i32 s69, 0xb
  s_cbranch_scc1 L_p6_2
  s_waitcnt vmcnt(8)
L_p6_2:
  s_waitcnt vmcnt(11)
L_p6_4:
  s_waitcnt vmcnt(13)
  buffer_load_dwordx4 v[108:111], v222, s[32:35], s80 offen nt
  v_perm_b32 v145, v150, v148, s56
  v_perm_b32 v150, v150, v148, s57
  v_perm_b32 v148, v151, v149, s56
  v_perm_b32 v151, v151, v149, s57
  v_dot2_f32_bf16 v22, v145, v52, 0
  v_add_f32_dpp v21, v18, v18 row_ror:8 row_mask:0xf bank_mask:0xc
  v_add_f32_dpp v21, v20, v20 row_ror:8 row_mask:0xf bank_mask:0x3
  v_add_f32_dpp v20, v34, v34 row_half_mirror row_mask:0xf bank_mask:0x5
  v_dot2_f32_bf16 v23, v150, v53, 0
  v_add_f32_dpp v20, v21, v21 row_half_mirror row_mask:0xf bank_mask:0xa
  v_dot2_f32_bf16 v24, v148, v54, 0
  v_dot2_f32_bf16 v25, v151, v55, 0
  v_add_f32_dpp v20, v20, v20 quad_perm:[2,3,0,1] row_mask:0xf bank_mask:0xf
  v_cvt_f32_i32 v76, v76
  v_cvt_f32_i32 v77, v77
  v_add_f32_dpp v20, v20, v20 quad_perm:[1,0,3,2] row_mask:0xf bank_mask:0xf
  v_cndmask_b32_e64 v32, v32, v20, s[54:55]
  ds_write_b32 v1, v32 offset:0
  v_cvt_f32_i32 v78, v78
  v_cvt_f32_i32 v79, v79
  v_pk_mul_f32 v[20:21], v[76:77], v[22:23]
  v_pk_add_f32 v[18:19], v[22:23], v[24:25]
  v_pk_fma_f32 v[20:21], v[78:79], v[24:25], v[20:21]
  v_add_f32 v18, v18, v19
  v_add_f32 v20, v20, v21
  s_add_u32 m0, s100, 13312
  v_lshrrev_b32 v10, 1, v225
  v_add_u32 v10, v10, v241
  v_mad_u64_u32 v[30:31], s[64:65], v10, 1, v[28:29]
  global_load_lds_dwordx4 v[30:31], off
  s_cmpk_gt_i32 s69, 0x31
  s_cbranch_scc1 L_p7_4
  s_cmpk_gt_i32 s69, 0x1d
  s_cbranch_scc1 L_p7_3
  s_cmpk_gt_i32 s69, 0xffcd
  s_cbranch_scc1 L_p7_0
  s_waitcnt vmcnt(8)
L_p7_0:
  s_waitcnt vmcnt(10)
L_p7_3:
  s_waitcnt vmcnt(13)
L_p7_4:
  s_waitcnt vmcnt(15)
  buffer_load_dwordx4 v[112:115], v223, s[32:35], s80 offen nt
L_it5:
  s_waitcnt lgkmcnt(0)
  s_waitcnt vmcnt(10)
  s_add_u32 s44, s78, 0x03030303
  v_msad_u8 v9, s78, v40, 0
  v_msad_u8 v10, s44, v40, 0
  v_msad_u8 v9, s78, v41, v9
  v_msad_u8 v10, s44, v41, v10
  v_msad_u8 v9, s78, v42, v9
  v_msad_u8 v10, s44, v42, v10
  s_mov_b64 exec, 3
  global_load_dwordx2 v[26:27], v11, s[30:31] sc1
  global_store_byte v7, v8, s[30:31]
  global_load_dwordx3 v[40:42], v237, s[30:31] sc1
  v_sub_u32 v9, v9, v10
  v_add_u32 v8, 1, v8
  s_mov_b64 exec, -1
  v_readlane_b32 s66, v9, 0
  v_readlane_b32 s67, v9, 1
  s_add_u32 s78, s78, 0x01010101
  s_lshl1_add_u32 s69, s91, s95
  s_add_u32 s95, s66, s67
  s_add_u32 s69, s69, s95
  v_dot2_f32_bf16 v22, v137, v56, 0
  v_add_f32_dpp v34, v18, v18 row_ror:8 row_mask:0xf bank_mask:0xc
  v_add_f32_dpp v34, v20, v20 row_ror:8 row_mask:0xf bank_mask:0x3
  v_dot2_f32_bf16 v23, v142, v57, 0
  v_dot2_f32_bf16 v24, v140, v58, 0
  v_dot2_f32_bf16 v25, v143, v59, 0
  v_cvt_f32_i32 v80, v80
  v_cvt_f32_i32 v81, v81
  v_cvt_f32_i32 v82, v82
  v_cvt_f32_i32 v83, v83
  v_pk_mul_f32 v[20:21], v[80:81], v[22:23]
  v_pk_add_f32 v[18:19], v[22:23], v[24:25]
  v_pk_fma_f32 v[20:21], v[82:83], v[24:25], v[20:21]
  v_add_f32 v18, v18, v19
  v_add_f32 v20, v20, v21
  s_cmpk_gt_i32 s69, 0x31
  s_cbranch_scc1 L_p8_4
  s_cmpk_gt_i32 s69, 0xffed
  s_cbranch_scc1 L_p8_1
  s_waitcnt vmcnt(7)
L_p8_1:
  s_waitcnt vmcnt(11)
L_p8_4:
  s_waitcnt vmcnt(12)
  buffer_load_dwordx4 v[68:71], v224, s[32:35], 0 offen nt
  v_dot2_f32_bf16 v22, v141, v60, 0
  v_add_f32_dpp v35, v18, v18 row_ror:8 row_mask:0xf bank_mask:0xc
  v_add_f32_dpp v35, v20, v20 row_ror:8 row_mask:0xf bank_mask:0x3
  v_dot2_f32_bf16 v23, v146, v61, 0
  v_dot2_f32_bf16 v24, v144, v62, 0
  v_dot2_f32_bf16 v25, v147, v63, 0
  v_cvt_f32_i32 v84, v84
  v_cvt_f32_i32 v85, v85
  v_cvt_f32_i32 v86, v86
  v_cvt_f32_i32 v87, v87
  v_pk_mul_f32 v[20:21], v[84:85], v[22:23]
  v_pk_add_f32 v[18:19], v[22:23], v[24:25]
  v_pk_fma_f32 v[20:21], v[86:87], v[24:25], v[20:21]
  v_add_f32 v18, v18, v19
  v_add_f32 v20, v20, v21
  s_add_u32 m0, s100, 14336
  v_lshrrev_b32 v10, 1, v226
  v_add_u32 v10, v10, v242
  v_mad_u64_u32 v[30:31], s[64:65], v10, 1, v[28:29]
  global_load_lds_dwordx4 v[30:31], off
  s_cmpk_gt_i32 s69, 0x31
  s_cbranch_scc1 L_p9_4
  s_cmpk_gt_i32 s69, 0xb
  s_cbranch_scc1 L_p9_2
  s_waitcnt vmcnt(9)
L_p9_2:
  s_waitcnt vmcnt(13)
L_p9_4:
  s_waitcnt vmcnt(14)
  buffer_load_dwordx4 v[72:75], v225, s[32:35], 0 offen nt
  s_waitcnt vmcnt(13)
  ds_read_b64 v[152:153], v12 offset:9216
  ds_read_b64 v[154:155], v12 offset:9344
  ds_read_b64 v[156:157], v12 offset:10240
  ds_read_b64 v[158:159], v12 offset:10368
  ds_read_b64 v[160:161], v12 offset:11264
  ds_read_b64 v[162:163], v12 offset:11392
  v_dot2_f32_bf16 v22, v145, v64, 0
  v_add_f32_dpp v21, v18, v18 row_ror:8 row_mask:0xf bank_mask:0xc
  v_add_f32_dpp v21, v20, v20 row_ror:8 row_mask:0xf bank_mask:0x3
  v_add_f32_dpp v20, v35, v35 row_half_mirror row_mask:0xf bank_mask:0x5
  v_dot2_f32_bf16 v23, v150, v65, 0
  v_add_f32_dpp v20, v21, v21 row_half_mirror row_mask:0xf bank_mask:0xa
  v_dot2_f32_bf16 v24, v148, v66, 0
  v_dot2_f32_bf16 v25, v151, v67, 0
  v_add_f32_dpp v20, v20, v20 quad_perm:[2,3,0,1] row_mask:0xf bank_mask:0xf
  v_cvt_f32_i32 v88, v88
  v_cvt_f32_i32 v89, v89
  v_add_f32_dpp v20, v20, v20 quad_perm:[1,0,3,2] row_mask:0xf bank_mask:0xf
  v_cndmask_b32_e64 v33, v33, v20, s[54:55]
  ds_write_b32 v1, v33 offset:3072
  v_cvt_f32_i32 v90, v90
  v_cvt_f32_i32 v91, v91
  v_pk_mul_f32 v[20:21], v[88:89], v[22:23]
  v_pk_add_f32 v[18:19], v[22:23], v[24:25]
  v_pk_fma_f32 v[20:21], v[90:91], v[24:25], v[20:21]
  v_add_f32 v18, v18, v19
  v_add_f32 v20, v20, v21
  s_cmpk_gt_i32 s69, 0x31
  s_cbranch_scc1 L_p10_4
  s_cmpk_gt_i32 s69, 0x1d
  s_cbranch_scc1 L_p10_3
  s_cmpk_gt_i32 s69, 0xffcd
  s_cbranch_scc1 L_p10_0
  s_waitcnt vmcnt(9)
L_p10_0:
  s_waitcnt vmcnt(10)
L_p10_3:
  s_waitcnt vmcnt(14)
L_p10_4:
  s_waitcnt vmcnt(15)
  buffer_load_dwordx4 v[76:79], v226, s[32:35], 0 offen nt
L_it6:
  s_waitcnt lgkmcnt(0)
  s_waitcnt vmcnt(11)
  s_add_u32 s44, s78, 0x03030303
  v_msad_u8 v9, s78, v36, 0
  v_msad_u8 v10, s44, v36, 0
  v_msad_u8 v9, s78, v37, v9
  v_msad_u8 v10, s44, v37, v10
  v_msad_u8 v9, s78, v38, v9
  v_msad_u8 v10, s44, v38, v10
  s_mov_b64 exec, 3
  global_store_byte v7, v8, s[30:31]
  global_load_dwordx3 v[36:38], v238, s[30:31] sc1
  v_sub_u32 v9, v9, v10
  v_add_u32 v8, 1, v8
  s_mov_b64 exec, -1
  v_readlane_b32 s66, v9, 0
  v_readlane_b32 s67, v9, 1
  s_add_u32 s78, s78, 0x01010101
  s_lshl1_add_u32 s69, s91, s95
  s_add_u32 s95, s66, s67
  s_add_u32 s69, s69, s95
  v_perm_b32 v149, v154, v152, s56
  v_perm_b32 v154, v154, v152, s57
  v_perm_b32 v152, v155, v153, s56
  v_perm_b32 v155, v155, v153, s57
  v_dot2_f32_bf16 v22, v149, v44, 0
  v_add_f32_dpp v35, v18, v18 row_ror:8 row_mask:0xf bank_mask:0xc
  v_add_f32_dpp v35, v20, v20 row_ror:8 row_mask:0xf bank_mask:0x3
  v_dot2_f32_bf16 v23, v154, v45, 0
  v_dot2_f32_bf16 v24, v152, v46, 0
  v_dot2_f32_bf16 v25, v155, v47, 0
  v_cvt_f32_i32 v92, v92
  v_cvt_f32_i32 v93, v93
  v_cvt_f32_i32 v94, v94
  v_cvt_f32_i32 v95, v95
  v_pk_mul_f32 v[20:21], v[92:93], v[22:23]
  v_pk_add_f32 v[18:19], v[22:23], v[24:25]
  v_pk_fma_f32 v[20:21], v[94:95], v[24:25], v[20:21]
  v_add_f32 v18, v18, v19
  v_add_f32 v20, v20, v21
  s_add_u32 m0, s100, 15360
  v_lshrrev_b32 v10, 1, v227
  v_add_u32 v10, v10, v240
  v_mad_u64_u32 v[30:31], s[64:65], v10, 1, v[28:29]
  global_load_lds_dwordx4 v[30:31], off
  s_cmpk_gt_i32 s69, 0x31
  s_cbranch_scc1 L_p11_4
  s_cmpk_gt_i32 s69, 0xffed
  s_cbranch_scc1 L_p11_1
  s_waitcnt vmcnt(7)
L_p11_1:
  s_waitcnt vmcnt(11)
L_p11_4:
  s_waitcnt vmcnt(13)
  buffer_load_dwordx4 v[80:83], v224, s[32:35], s80 offen nt
  v_perm_b32 v153, v158, v156, s56
  v_perm_b32 v158, v158, v156, s57
  v_perm_b32 v156, v159, v157, s56
  v_perm_b32 v159, v159, v157, s57
  v_dot2_f32_bf16 v22, v153, v48, 0
  v_add_f32_dpp v21, v18, v18 row_ror:8 row_mask:0xf bank_mask:0xc
  v_add_f32_dpp v21, v20, v20 row_ror:8 row_mask:0xf bank_mask:0x3
  v_add_f32_dpp v20, v34, v34 row_half_mirror row_mask:0xf bank_mask:0x5
  v_dot2_f32_bf16 v23, v158, v49, 0
  v_add_f32_dpp v20, v21, v21 row_half_mirror row_mask:0xf bank_mask:0xa
  v_dot2_f32_bf16 v24, v156, v50, 0
  v_dot2_f32_bf16 v25, v159, v51, 0
  v_add_f32_dpp v20, v20, v20 quad_perm:[2,3,0,1] row_mask:0xf bank_mask:0xf
  v_cvt_f32_i32 v96, v96
  v_cvt_f32_i32 v97, v97
  v_add_f32_dpp v20, v20, v20 quad_perm:[1,0,3,2] row_mask:0xf bank_mask:0xf
  v_cndmask_b32_e64 v32, v32, v20, s[48:49]
  v_cvt_f32_i32 v98, v98
  v_cvt_f32_i32 v99, v99
  v_pk_mul_f32 v[20:21], v[96:97], v[22:23]
  v_pk_add_f32 v[18:19], v[22:23], v[24:25]
  v_pk_fma_f32 v[20:21], v[98:99], v[24:25], v[20:21]
  v_add_f32 v18, v18, v19
  v_add_f32 v20, v20, v21
  s_cmpk_gt_i32 s69, 0x31
  s_cbranch_scc1 L_p12_4
  s_cmpk_gt_i32 s69, 0xb
  s_cbranch_scc1 L_p12_2
  s_waitcnt vmcnt(8)
L_p12_2:
  s_waitcnt vmcnt(12)
L_p12_4:
  s_waitcnt vmcnt(14)
  buffer_load_dwordx4 v[84:87], v225, s[32:35], s80 offen nt
  v_perm_b32 v157, v162, v160, s56
  v_perm_b32 v162, v162, v160, s57
  v_perm_b32 v160, v163, v161, s56
  v_perm_b32 v163, v163, v161, s57
  v_dot2_f32_bf16 v22, v157, v52, 0
  v_add_f32_dpp v34, v18, v18 row_ror:8 row_mask:0xf bank_mask:0xc
  v_add_f32_dpp v34, v20, v20 row_ror:8 row_mask:0xf bank_mask:0x3
  v_dot2_f32_bf16 v23, v162, v53, 0
  v_dot2_f32_bf16 v24, v160, v54, 0
  v_dot2_f32_bf16 v25, v163, v55, 0
  v_cvt_f32_i32 v100, v100
  v_cvt_f32_i32 v101, v101
  v_cvt_f32_i32 v102, v102
  v_cvt_f32_i32 v103, v103
  v_pk_mul_f32 v[20:21], v[100:101], v[22:23]
  v_pk_add_f32 v[18:19], v[22:23], v[24:25]
  v_pk_fma_f32 v[20:21], v[102:103], v[24:25], v[20:21]
  v_add_f32 v18, v18, v19
  v_add_f32 v20, v20, v21
  s_add_u32 m0, s100, 16384
  v_lshrrev_b32 v10, 1, v228
  v_add_u32 v10, v10, v241
  v_mad_u64_u32 v[30:31], s[64:65], v10, 1, v[28:29]
  global_load_lds_dwordx4 v[30:31], off
  s_cmpk_gt_i32 s69, 0x31
  s_cbranch_scc1 L_p13_4
  s_cmpk_gt_i32 s69, 0x1d
  s_cbranch_scc1 L_p13_3
  s_cmpk_gt_i32 s69, 0xffcd
  s_cbranch_scc1 L_p13_0
  s_waitcnt vmcnt(8)
L_p13_0:
  s_waitcnt vmcnt(10)
L_p13_3:
  s_waitcnt vmcnt(14)
L_p13_4:
  s_waitcnt vmcnt(16)
  buffer_load_dwordx4 v[88:91], v226, s[32:35], s80 offen nt
L_it7:
  s_waitcnt lgkmcnt(0)
  s_waitcnt vmcnt(10)
  s_add_u32 s44, s78, 0x03030303
  v_msad_u8 v9, s78, v40, 0
  v_msad_u8 v10, s44, v40, 0
  v_msad_u8 v9, s78, v41, v9
  v_msad_u8 v10, s44, v41, v10
  v_msad_u8 v9, s78, v42, v9
  v_msad_u8 v10, s44, v42, v10
  s_mov_b64 exec, 3
  global_store_byte v7, v8, s[30:31]
  global_load_dwordx3 v[40:42], v239, s[30:31] sc1
  v_sub_u32 v9, v9, v10
  v_add3_u32 v10, v26, v27, s58
  v_add_u32 v8, 1, v8
  s_mov_b64 exec, -1
  v_readlane_b32 s66, v9, 0
  v_readlane_b32 s67, v9, 1
  v_readlane_b32 s91, v10, 0
  s_add_u32 s78, s78, 0x01010101
  s_lshl1_add_u32 s69, s91, s95
  s_add_u32 s95, s66, s67
  s_add_u32 s69, s69, s95
  v_dot2_f32_bf16 v22, v149, v56, 0
  v_add_f32_dpp v21, v18, v18 row_ror:8 row_mask:0xf bank_mask:0xc
  v_add_f32_dpp v21, v20, v20 row_ror:8 row_mask:0xf bank_mask:0x3
  v_add_f32_dpp v20, v34, v34 row_half_mirror row_mask:0xf bank_mask:0x5
  v_dot2_f32_bf16 v23, v154, v57, 0
  v_add_f32_dpp v20, v21, v21 row_half_mirror row_mask:0xf bank_mask:0xa
  v_dot2_f32_bf16 v24, v152, v58, 0
  v_dot2_f32_bf16 v25, v155, v59, 0
  v_add_f32_dpp v20, v20, v20 quad_perm:[2,3,0,1] row_mask:0xf bank_mask:0xf
  v_cvt_f32_i32 v104, v104
  v_cvt_f32_i32 v105, v105
  v_add_f32_dpp v20, v20, v20 quad_perm:[1,0,3,2] row_mask:0xf bank_mask:0xf
  v_cndmask_b32_e64 v32, v32, v20, s[50:51]
  v_cvt_f32_i32 v106, v106
  v_cvt_f32_i32 v107, v107
  v_pk_mul_f32 v[20:21], v[104:105], v[22:23]
  v_pk_add_f32 v[18:19], v[22:23], v[24:25]
  v_pk_fma_f32 v[20:21], v[106:107], v[24:25], v[20:21]
  v_add_f32 v18, v18, v19
  v_add_f32 v20, v20, v21
  s_cmpk_gt_i32 s69, 0x31
  s_cbranch_scc1 L_p14_4
  s_cmpk_gt_i32 s69, 0xffed
  s_cbranch_scc1 L_p14_1
  s_waitcnt vmcnt(6)
L_p14_1:
  s_waitcnt vmcnt(10)
L_p14_4:
  s_waitcnt vmcnt(11)
  buffer_load_dwordx4 v[92:95], v227, s[32:35], 0 offen nt
  v_dot2_f32_bf16 v22, v153, v60, 0
  v_add_f32_dpp v21, v18, v18 row_ror:8 row_mask:0xf bank_mask:0xc
  v_add_f32_dpp v21, v20, v20 row_ror:8 row_mask:0xf bank_mask:0x3
  v_add_f32_dpp v20, v35, v35 row_half_mirror row_mask:0xf bank_mask:0x5
  v_dot2_f32_bf16 v23, v158, v61, 0
  v_add_f32_dpp v20, v21, v21 row_half_mirror row_mask:0xf bank_mask:0xa
  v_dot2_f32_bf16 v24, v156, v62, 0
  v_dot2_f32_bf16 v25, v159, v63, 0
  v_add_f32_dpp v20, v20, v20 quad_perm:[2,3,0,1] row_mask:0xf bank_mask:0xf
  v_cvt_f32_i32 v108, v108
  v_cvt_f32_i32 v109, v109
  v_add_f32_dpp v20, v20, v20 quad_perm:[1,0,3,2] row_mask:0xf bank_mask:0xf
  v_cndmask_b32_e64 v33, v33, v20, s[48:49]
  v_cvt_f32_i32 v110, v110
  v_cvt_f32_i32 v111, v111
  v_pk_mul_f32 v[20:21], v[108:109], v[22:23]
  v_pk_add_f32 v[18:19], v[22:23], v[24:25]
  v_pk_fma_f32 v[20:21], v[110:111], v[24:25], v[20:21]
  v_add_f32 v18, v18, v19
  v_add_f32 v20, v20, v21
  s_add_u32 m0, s100, 17408
  v_lshrrev_b32 v10, 1, v229
  v_add_u32 v10, v10, v242
  v_mad_u64_u32 v[30:31], s[64:65], v10, 1, v[28:29]
  global_load_lds_dwordx4 v[30:31], off
  s_cmpk_gt_i32 s69, 0x31
  s_cbranch_scc1 L_p15_4
  s_cmpk_gt_i32 s69, 0xb
  s_cbranch_scc1 L_p15_2
  s_waitcnt vmcnt(8)
L_p15_2:
  s_waitcnt vmcnt(12)
L_p15_4:
  s_waitcnt vmcnt(13)
  buffer_load_dwordx4 v[96:99], v228, s[32:35], 0 offen nt
  s_waitcnt vmcnt(12)
  ds_read_b64 v[164:165], v12 offset:12288
  ds_read_b64 v[166:167], v12 offset:12416
  ds_read_b64 v[168:169], v12 offset:13312
  ds_read_b64 v[170:171], v12 offset:13440
  ds_read_b64 v[172:173], v12 offset:14336
  ds_read_b64 v[174:175], v12 offset:14464
  v_dot2_f32_bf16 v22, v157, v64, 0
  v_add_f32_dpp v35, v18, v18 row_ror:8 row_mask:0xf bank_mask:0xc
  v_add_f32_dpp v35, v20, v20 row_ror:8 row_mask:0xf bank_mask:0x3
  v_dot2_f32_bf16 v23, v162, v65, 0
  v_dot2_f32_bf16 v24, v160, v66, 0
  v_dot2_f32_bf16 v25, v163, v67, 0
  v_cvt_f32_i32 v112, v112
  v_cvt_f32_i32 v113, v113
  v_cvt_f32_i32 v114, v114
  v_cvt_f32_i32 v115, v115
  v_pk_mul_f32 v[20:21], v[112:113], v[22:23]
  v_pk_add_f32 v[18:19], v[22:23], v[24:25]
  v_pk_fma_f32 v[20:21], v[114:115], v[24:25], v[20:21]
  v_add_f32 v18, v18, v19
  v_add_f32 v20, v20, v21
  s_cmpk_gt_i32 s69, 0x31
  s_cbranch_scc1 L_p16_4
  s_cmpk_gt_i32 s69, 0x1d
  s_cbranch_scc1 L_p16_3
  s_cmpk_gt_i32 s69, 0xffcd
  s_cbranch_scc1 L_p16_0
  s_waitcnt vmcnt(8)
L_p16_0:
  s_waitcnt vmcnt(9)
L_p16_3:
  s_waitcnt vmcnt(13)
L_p16_4:
  s_waitcnt vmcnt(14)
  buffer_load_dwordx4 v[100:103], v229, s[32:35], 0 offen nt
  v_mov_b32 v9, 1
  ds_write_b32 v6, v9 offset:0
L_it8:
  s_waitcnt lgkmcnt(0)
  s_waitcnt vmcnt(10)
  s_add_u32 s44, s78, 0x03030303
  v_msad_u8 v9, s78, v36, 0
  v_msad_u8 v10, s44, v36, 0
  v_msad_u8 v9, s78, v37, v9
  v_msad_u8 v10, s44, v37, v10
  v_msad_u8 v9, s78, v38, v9
  v_msad_u8 v10, s44, v38, v10
  s_mov_b64 exec, 3
  global_store_byte v7, v8, s[30:31]
  global_load_dwordx3 v[36:38], v236, s[30:31] sc1
  v_sub_u32 v9, v9, v10
  v_add_u32 v8, 1, v8
  s_mov_b64 exec, -1
  v_readlane_b32 s66, v9, 0
  v_readlane_b32 s67, v9, 1
  s_add_u32 s78, s78, 0x01010101
  s_lshl1_add_u32 s69, s91, s95
  s_add_u32 s95, s66, s67
  s_add_u32 s69, s69, s95
  v_perm_b32 v161, v166, v164, s56
  v_perm_b32 v166, v166, v164, s57
  v_perm_b32 v164, v167, v165, s56
  v_perm_b32 v167, v167, v165, s57
  v_dot2_f32_bf16 v22, v161, v44, 0
  v_add_f32_dpp v21, v18, v18 row_ror:8 row_mask:0xf bank_mask:0xc
  v_add_f32_dpp v21, v20, v20 row_ror:8 row_mask:0xf bank_mask:0x3
  v_add_f32_dpp v20, v35, v35 row_half_mirror row_mask:0xf bank_mask:0x5
  v_dot2_f32_bf16 v23, v166, v45, 0
  v_add_f32_dpp v20, v21, v21 row_half_mirror row_mask:0xf bank_mask:0xa
  v_dot2_f32_bf16 v24, v164, v46, 0
  v_dot2_f32_bf16 v25, v167, v47, 0
  v_add_f32_dpp v20, v20, v20 quad_perm:[2,3,0,1] row_mask:0xf bank_mask:0xf
  v_cvt_f32_i32 v68, v68
  v_cvt_f32_i32 v69, v69
  v_add_f32_dpp v20, v20, v20 quad_perm:[1,0,3,2] row_mask:0xf bank_mask:0xf
  v_cndmask_b32_e64 v33, v33, v20, s[50:51]
  v_cvt_f32_i32 v70, v70
  v_cvt_f32_i32 v71, v71
  v_pk_mul_f32 v[20:21], v[68:69], v[22:23]
  v_pk_add_f32 v[18:19], v[22:23], v[24:25]
  v_pk_fma_f32 v[20:21], v[70:71], v[24:25], v[20:21]
  v_add_f32 v18, v18, v19
  v_add_f32 v20, v20, v21
  s_add_u32 m0, s100, 18432
  v_lshrrev_b32 v10, 1, v230
  v_add_u32 v10, v10, v240
  v_mad_u64_u32 v[30:31], s[64:65], v10, 1, v[28:29]
  global_load_lds_dwordx4 v[30:31], off
  s_cmpk_gt_i32 s69, 0x31
  s_cbranch_scc1 L_p17_4
  s_cmpk_gt_i32 s69, 0xffed
  s_cbranch_scc1 L_p17_1
  s_waitcnt vmcnt(7)
L_p17_1:
  s_waitcnt vmcnt(10)
L_p17_4:
  s_waitcnt vmcnt(12)
  buffer_load_dwordx4 v[104:107], v227, s[32:35], s80 offen nt
  v_perm_b32 v165, v170, v168, s56
  v_perm_b32 v170, v170, v168, s57
  v_perm_b32 v168, v171, v169, s56
  v_perm_b32 v171, v171, v169, s57
  v_dot2_f32_bf16 v22, v165, v48, 0
  v_add_f32_dpp v34, v18, v18 row_ror:8 row_mask:0xf bank_mask:0xc
  v_add_f32_dpp v34, v20, v20 row_ror:8 row_mask:0xf bank_mask:0x3
  v_dot2_f32_bf16 v23, v170, v49, 0
  v_dot2_f32_bf16 v24, v168, v50, 0
  v_dot2_f32_bf16 v25, v171, v51, 0
  v_cvt_f32_i32 v72, v72
  v_cvt_f32_i32 v73, v73
  v_cvt_f32_i32 v74, v74
  v_cvt_f32_i32 v75, v75
  v_pk_mul_f32 v[20:21], v[72:73], v[22:23]
  v_pk_add_f32 v[18:19], v[22:23], v[24:25]
  v_pk_fma_f32 v[20:21], v[74:75], v[24:25], v[20:21]
  v_add_f32 v18, v18, v19
  v_add_f32 v20, v20, v21
  s_cmpk_gt_i32 s69, 0x31
  s_cbranch_scc1 L_p18_4
  s_cmpk_gt_i32 s69, 0xb
  s_cbranch_scc1 L_p18_2
  s_waitcnt vmcnt(8)
L_p18_2:
  s_waitcnt vmcnt(11)
L_p18_4:
  s_waitcnt vmcnt(13)
  buffer_load_dwordx4 v[108:111], v228, s[32:35], s80 offen nt
  v_perm_b32 v169, v174, v172, s56
  v_perm_b32 v174, v174, v172, s57
  v_perm_b32 v172, v175, v173, s56
  v_perm_b32 v175, v175, v173, s57
  v_dot2_f32_bf16 v22, v169, v52, 0
  v_add_f32_dpp v21, v18, v18 row_ror:8 row_mask:0xf bank_mask:0xc
  v_add_f32_dpp v21, v20, v20 row_ror:8 row_mask:0xf bank_mask:0x3
  v_add_f32_dpp v20, v34, v34 row_half_mirror row_mask:0xf bank_mask:0x5
  v_dot2_f32_bf16 v23, v174, v53, 0
  v_add_f32_dpp v20, v21, v21 row_half_mirror row_mask:0xf bank_mask:0xa
  v_dot2_f32_bf16 v24, v172, v54, 0
  v_dot2_f32_bf16 v25, v175, v55, 0
  v_add_f32_dpp v20, v20, v20 quad_perm:[2,3,0,1] row_mask:0xf bank_mask:0xf
  v_cvt_f32_i32 v76, v76
  v_cvt_f32_i32 v77, v77
  v_add_f32_dpp v20, v20, v20 quad_perm:[1,0,3,2] row_mask:0xf bank_mask:0xf
  v_cndmask_b32_e64 v32, v32, v20, s[52:53]
  v_cvt_f32_i32 v78, v78
  v_cvt_f32_i32 v79, v79
  v_pk_mul_f32 v[20:21], v[76:77], v[22:23]
  v_pk_add_f32 v[18:19], v[22:23], v[24:25]
  v_pk_fma_f32 v[20:21], v[78:79], v[24:25], v[20:21]
  v_add_f32 v18, v18, v19
  v_add_f32 v20, v20, v21
  s_add_u32 m0, s100, 19456
  v_lshrrev_b32 v10, 1, v231
  v_add_u32 v10, v10, v241
  v_mad_u64_u32 v[30:31], s[64:65], v10, 1, v[28:29]
  global_load_lds_dwordx4 v[30:31], off
  s_cmpk_gt_i32 s69, 0x31
  s_cbranch_scc1 L_p19_4
  s_cmpk_gt_i32 s69, 0x1d
  s_cbranch_scc1 L_p19_3
  s_cmpk_gt_i32 s69, 0xffcd
  s_cbranch_scc1 L_p19_0
  s_waitcnt vmcnt(8)
L_p19_0:
  s_waitcnt vmcnt(10)
L_p19_3:
  s_waitcnt vmcnt(13)
L_p19_4:
  s_waitcnt vmcnt(15)
  buffer_load_dwordx4 v[112:115], v229, s[32:35], s80 offen nt
L_it9:
  s_waitcnt lgkmcnt(0)
  s_waitcnt vmcnt(10)
  s_add_u32 s44, s78, 0x03030303
  v_msad_u8 v9, s78, v40, 0
  v_msad_u8 v10, s44, v40, 0
  v_msad_u8 v9, s78, v41, v9
  v_msad_u8 v10, s44, v41, v10
  v_msad_u8 v9, s78, v42, v9
  v_msad_u8 v10, s44, v42, v10
  s_mov_b64 exec, 3
  global_store_byte v7, v8, s[30:31]
  global_load_dwordx3 v[40:42], v237, s[30:31] sc1
  v_sub_u32 v9, v9, v10
  v_add_u32 v8, 1, v8
  s_mov_b64 exec, -1
  v_readlane_b32 s66, v9, 0
  v_readlane_b32 s67, v9, 1
  s_add_u32 s78, s78, 0x01010101
  s_lshl1_add_u32 s69, s91, s95
  s_add_u32 s95, s66, s67
  s_add_u32 s69, s69, s95
  v_dot2_f32_bf16 v22, v161, v56, 0
  v_add_f32_dpp v34, v18, v18 row_ror:8 row_mask:0xf bank_mask:0xc
  v_add_f32_dpp v34, v20, v20 row_ror:8 row_mask:0xf bank_mask:0x3
  v_dot2_f32_bf16 v23, v166, v57, 0
  v_dot2_f32_bf16 v24, v164, v58, 0
  v_dot2_f32_bf16 v25, v167, v59, 0
  v_cvt_f32_i32 v80, v80
  v_cvt_f32_i32 v81, v81
  v_cvt_f32_i32 v82, v82
  v_cvt_f32_i32 v83, v83
  v_pk_mul_f32 v[20:21], v[80:81], v[22:23]
  v_pk_add_f32 v[18:19], v[22:23], v[24:25]
  v_pk_fma_f32 v[20:21], v[82:83], v[24:25], v[20:21]
  v_add_f32 v18, v18, v19
  v_add_f32 v20, v20, v21
  s_cmpk_gt_i32 s69, 0x31
  s_cbranch_scc1 L_p20_4
  s_cmpk_gt_i32 s69, 0xffed
  s_cbranch_scc1 L_p20_1
  s_waitcnt vmcnt(6)
L_p20_1:
  s_waitcnt vmcnt(10)
L_p20_4:
  s_waitcnt vmcnt(11)
  buffer_load_dwordx4 v[68:71], v230, s[32:35], 0 offen nt
  v_dot2_f32_bf16 v22, v165, v60, 0
  v_add_f32_dpp v35, v18, v18 row_ror:8 row_mask:0xf bank_mask:0xc
  v_add_f32_dpp v35, v20, v20 row_ror:8 row_mask:0xf bank_mask:0x3
  v_dot2_f32_bf16 v23, v170, v61, 0
  v_dot2_f32_bf16 v24, v168, v62, 0
  v_dot2_f32_bf16 v25, v171, v63, 0
  v_cvt_f32_i32 v84, v84
  v_cvt_f32_i32 v85, v85
  v_cvt_f32_i32 v86, v86
  v_cvt_f32_i32 v87, v87
  v_pk_mul_f32 v[20:21], v[84:85], v[22:23]
  v_pk_add_f32 v[18:19], v[22:23], v[24:25]
  v_pk_fma_f32 v[20:21], v[86:87], v[24:25], v[20:21]
  v_add_f32 v18, v18, v19
  v_add_f32 v20, v20, v21
  s_add_u32 m0, s100, 20480
  v_lshrrev_b32 v10, 1, v232
  v_add_u32 v10, v10, v242
  v_mad_u64_u32 v[30:31], s[64:65], v10, 1, v[28:29]
  global_load_lds_dwordx4 v[30:31], off
  s_cmpk_gt_i32 s69, 0x31
  s_cbranch_scc1 L_p21_4
  s_cmpk_gt_i32 s69, 0xb
  s_cbranch_scc1 L_p21_2
  s_waitcnt vmcnt(8)
L_p21_2:
  s_waitcnt vmcnt(12)
L_p21_4:
  s_waitcnt vmcnt(13)
  buffer_load_dwordx4 v[72:75], v231, s[32:35], 0 offen nt
  s_waitcnt vmcnt(12)
  ds_read_b64 v[176:177], v12 offset:15360
  ds_read_b64 v[178:179], v12 offset:15488
  ds_read_b64 v[180:181], v12 offset:16384
  ds_read_b64 v[182:183], v12 offset:16512
  ds_read_b64 v[184:185], v12 offset:17408
  ds_read_b64 v[186:187], v12 offset:17536
  v_dot2_f32_bf16 v22, v169, v64, 0
  v_add_f32_dpp v21, v18, v18 row_ror:8 row_mask:0xf bank_mask:0xc
  v_add_f32_dpp v21, v20, v20 row_ror:8 row_mask:0xf bank_mask:0x3
  v_add_f32_dpp v20, v35, v35 row_half_mirror row_mask:0xf bank_mask:0x5
  v_dot2_f32_bf16 v23, v174, v65, 0
  v_add_f32_dpp v20, v21, v21 row_half_mirror row_mask:0xf bank_mask:0xa
  v_dot2_f32_bf16 v24, v172, v66, 0
  v_dot2_f32_bf16 v25, v175, v67, 0
  v_add_f32_dpp v20, v20, v20 quad_perm:[2,3,0,1] row_mask:0xf bank_mask:0xf
  v_cvt_f32_i32 v88, v88
  v_cvt_f32_i32 v89, v89
  v_add_f32_dpp v20, v20, v20 quad_perm:[1,0,3,2] row_mask:0xf bank_mask:0xf
  v_cndmask_b32_e64 v33, v33, v20, s[52:53]
  v_cvt_f32_i32 v90, v90
  v_cvt_f32_i32 v91, v91
  v_pk_mul_f32 v[20:21], v[88:89], v[22:23]
  v_pk_add_f32 v[18:19], v[22:23], v[24:25]
  v_pk_fma_f32 v[20:21], v[90:91], v[24:25], v[20:21]
  v_add_f32 v18, v18, v19
  v_add_f32 v20, v20, v21
  s_cmpk_gt_i32 s69, 0x31
  s_cbranch_scc1 L_p22_4
  s_cmpk_gt_i32 s69, 0x1d
  s_cbranch_scc1 L_p22_3
  s_cmpk_gt_i32 s69, 0xffcd
  s_cbranch_scc1 L_p22_0
  s_waitcnt vmcnt(8)
L_p22_0:
  s_waitcnt vmcnt(9)
L_p22_3:
  s_waitcnt vmcnt(13)
L_p22_4:
  s_waitcnt vmcnt(14)
  buffer_load_dwordx4 v[76:79], v232, s[32:35], 0 offen nt
L_it10:
  s_waitcnt lgkmcnt(0)
  s_waitcnt vmcnt(10)
  s_add_u32 s44, s78, 0x03030303
  v_msad_u8 v9, s78, v36, 0
  v_msad_u8 v10, s44, v36, 0
  v_msad_u8 v9, s78, v37, v9
  v_msad_u8 v10, s44, v37, v10
  v_msad_u8 v9, s78, v38, v9
  v_msad_u8 v10, s44, v38, v10
  s_mov_b64 exec, 3
  global_store_byte v7, v8, s[30:31]
  global_load_dwordx3 v[36:38], v238, s[30:31] sc1
  v_sub_u32 v9, v9, v10
  v_add_u32 v8, 1, v8
  s_mov_b64 exec, -1
  v_readlane_b32 s66, v9, 0
  v_readlane_b32 s67, v9, 1
  s_add_u32 s78, s78, 0x01010101
  s_lshl1_add_u32 s69, s91, s95
  s_add_u32 s95, s66, s67
  s_add_u32 s69, s69, s95
  v_perm_b32 v173, v178, v176, s56
  v_perm_b32 v178, v178, v176, s57
  v_perm_b32 v176, v179, v177, s56
  v_perm_b32 v179, v179, v177, s57
  v_dot2_f32_bf16 v22, v173, v44, 0
  v_add_f32_dpp v35, v18, v18 row_ror:8 row_mask:0xf bank_mask:0xc
  v_add_f32_dpp v35, v20, v20 row_ror:8 row_mask:0xf bank_mask:0x3
  v_dot2_f32_bf16 v23, v178, v45, 0
  v_dot2_f32_bf16 v24, v176, v46, 0
  v_dot2_f32_bf16 v25, v179, v47, 0
  v_cvt_f32_i32 v92, v92
  v_cvt_f32_i32 v93, v93
  v_cvt_f32_i32 v94, v94
  v_cvt_f32_i32 v95, v95
  v_pk_mul_f32 v[20:21], v[92:93], v[22:23]
  v_pk_add_f32 v[18:19], v[22:23], v[24:25]
  v_pk_fma_f32 v[20:21], v[94:95], v[24:25], v[20:21]
  v_add_f32 v18, v18, v19
  v_add_f32 v20, v20, v21
  s_add_u32 m0, s100, 21504
  v_lshrrev_b32 v10, 1, v233
  v_add_u32 v10, v10, v240
  v_mad_u64_u32 v[30:31], s[64:65], v10, 1, v[28:29]
  global_load_lds_dwordx4 v[30:31], off
  s_cmpk_gt_i32 s69, 0x31
  s_cbranch_scc1 L_p23_4
  s_cmpk_gt_i32 s69, 0xffed
  s_cbranch_scc1 L_p23_1
  s_waitcnt vmcnt(7)
L_p23_1:
  s_waitcnt vmcnt(10)
L_p23_4:
  s_waitcnt vmcnt(12)
  buffer_load_dwordx4 v[80:83], v230, s[32:35], s80 offen nt
  v_perm_b32 v177, v182, v180, s56
  v_perm_b32 v182, v182, v180, s57
  v_perm_b32 v180, v183, v181, s56
  v_perm_b32 v183, v183, v181, s57
  v_dot2_f32_bf16 v22, v177, v48, 0
  v_add_f32_dpp v21, v18, v18 row_ror:8 row_mask:0xf bank_mask:0xc
  v_add_f32_dpp v21, v20, v20 row_ror:8 row_mask:0xf bank_mask:0x3
  v_add_f32_dpp v20, v34, v34 row_half_mirror row_mask:0xf bank_mask:0x5
  v_dot2_f32_bf16 v23, v182, v49, 0
  v_add_f32_dpp v20, v21, v21 row_half_mirror row_mask:0xf bank_mask:0xa
  v_dot2_f32_bf16 v24, v180, v50, 0
  v_dot2_f32_bf16 v25, v183, v51, 0
  v_add_f32_dpp v20, v20, v20 quad_perm:[2,3,0,1] row_mask:0xf bank_mask:0xf
  v_cvt_f32_i32 v96, v96
  v_cvt_f32_i32 v97, v97
  v_add_f32_dpp v20, v20, v20 quad_perm:[1,0,3,2] row_mask:0xf bank_mask:0xf
  v_cndmask_b32_e64 v32, v32, v20, s[54:55]
  ds_write_b32 v1, v32 offset:512
  v_cvt_f32_i32 v98, v98
  v_cvt_f32_i32 v99, v99
  v_pk_mul_f32 v[20:21], v[96:97], v[22:23]
  v_pk_add_f32 v[18:19], v[22:23], v[24:25]
  v_pk_fma_f32 v[20:21], v[98:99], v[24:25], v[20:21]
  v_add_f32 v18, v18, v19
  v_add_f32 v20, v20, v21
  s_cmpk_gt_i32 s69, 0x31
  s_cbranch_scc1 L_p24_4
  s_cmpk_gt_i32 s69, 0xb
  s_cbranch_scc1 L_p24_2
  s_waitcnt vmcnt(8)
L_p24_2:
  s_waitcnt vmcnt(11)
L_p24_4:
  s_waitcnt vmcnt(13)
  buffer_load_dwordx4 v[84:87], v231, s[32:35], s80 offen nt
  v_perm_b32 v181, v186, v184, s56
  v_perm_b32 v186, v186, v184, s57
  v_perm_b32 v184, v187, v185, s56
  v_perm_b32 v187, v187, v185, s57
  v_dot2_f32_bf16 v22, v181, v52, 0
  v_add_f32_dpp v34, v18, v18 row_ror:8 row_mask:0xf bank_mask:0xc
  v_add_f32_dpp v34, v20, v20 row_ror:8 row_mask:0xf bank_mask:0x3
  v_dot2_f32_bf16 v23, v186, v53, 0
  v_dot2_f32_bf16 v24, v184, v54, 0
  v_dot2_f32_bf16 v25, v187, v55, 0
  v_cvt_f32_i32 v100, v100
  v_cvt_f32_i32 v101, v101
  v_cvt_f32_i32 v102, v102
  v_cvt_f32_i32 v103, v103
  v_pk_mul_f32 v[20:21], v[100:101], v[22:23]
  v_pk_add_f32 v[18:19], v[22:23], v[24:25]
  v_pk_fma_f32 v[20:21], v[102:103], v[24:25], v[20:21]
  v_add_f32 v18, v18, v19
  v_add_f32 v20, v20, v21
  s_add_u32 m0, s100, 22528
  v_lshrrev_b32 v10, 1, v234
  v_add_u32 v10, v10, v241
  v_mad_u64_u32 v[30:31], s[64:65], v10, 1, v[28:29]
  global_load_lds_dwordx4 v[30:31], off
  s_cmpk_gt_i32 s69, 0x31
  s_cbranch_scc1 L_p25_4
  s_cmpk_gt_i32 s69, 0x1d
  s_cbranch_scc1 L_p25_3
  s_cmpk_gt_i32 s69, 0xffcd
  s_cbranch_scc1 L_p25_0
  s_waitcnt vmcnt(8)
L_p25_0:
  s_waitcnt vmcnt(10)
L_p25_3:
  s_waitcnt vmcnt(13)
L_p25_4:
  s_waitcnt vmcnt(15)
  buffer_load_dwordx4 v[88:91], v232, s[32:35], s80 offen nt
L_it11:
  s_waitcnt lgkmcnt(0)
  s_waitcnt vmcnt(10)
  s_add_u32 s44, s78, 0x03030303
  v_msad_u8 v9, s78, v40, 0
  v_msad_u8 v10, s44, v40, 0
  v_msad_u8 v9, s78, v41, v9
  v_msad_u8 v10, s44, v41, v10
  v_msad_u8 v9, s78, v42, v9
  v_msad_u8 v10, s44, v42, v10
  s_mov_b64 exec, 3
  global_store_byte v7, v8, s[30:31]
  global_load_dwordx3 v[40:42], v239, s[30:31] sc1
  v_sub_u32 v9, v9, v10
  v_add_u32 v8, 1, v8
  s_mov_b64 exec, -1
  v_readlane_b32 s66, v9, 0
  v_readlane_b32 s67, v9, 1
  s_add_u32 s78, s78, 0x01010101
  s_lshl1_add_u32 s69, s91, s95
  s_add_u32 s95, s66, s67
  s_add_u32 s69, s69, s95
  v_dot2_f32_bf16 v22, v173, v56, 0
  v_add_f32_dpp v21, v18, v18 row_ror:8 row_mask:0xf bank_mask:0xc
  v_add_f32_dpp v21, v20, v20 row_ror:8 row_mask:0xf bank_mask:0x3
  v_add_f32_dpp v20, v34, v34 row_half_mirror row_mask:0xf bank_mask:0x5
  v_dot2_f32_bf16 v23, v178, v57, 0
  v_add_f32_dpp v20, v21, v21 row_half_mirror row_mask:0xf bank_mask:0xa
  v_dot2_f32_bf16 v24, v176, v58, 0
  v_dot2_f32_bf16 v25, v179, v59, 0
  v_add_f32_dpp v20, v20, v20 quad_perm:[2,3,0,1] row_mask:0xf bank_mask:0xf
  v_cvt_f32_i32 v104, v104
  v_cvt_f32_i32 v105, v105
  v_add_f32_dpp v20, v20, v20 quad_perm:[1,0,3,2] row_mask:0xf bank_mask:0xf
  v_cndmask_b32_e64 v32, v32, v20, s[48:49]
  v_cvt_f32_i32 v106, v106
  v_cvt_f32_i32 v107, v107
  v_pk_mul_f32 v[20:21], v[104:105], v[22:23]
  v_pk_add_f32 v[18:19], v[22:23], v[24:25]
  v_pk_fma_f32 v[20:21], v[106:107], v[24:25], v[20:21]
  v_add_f32 v18, v18, v19
  v_add_f32 v20, v20, v21
  s_cmpk_gt_i32 s69, 0x31
  s_cbranch_scc1 L_p26_4
  s_cmpk_gt_i32 s69, 0xffed
  s_cbranch_scc1 L_p26_1
  s_waitcnt vmcnt(6)
L_p26_1:
  s_waitcnt vmcnt(10)
L_p26_4:
  s_waitcnt vmcnt(11)
  buffer_load_dwordx4 v[92:95], v233, s[32:35], 0 offen nt
  v_dot2_f32_bf16 v22, v177, v60, 0
  v_add_f32_dpp v21, v18, v18 row_ror:8 row_mask:0xf bank_mask:0xc
  v_add_f32_dpp v21, v20, v20 row_ror:8 row_mask:0xf bank_mask:0x3
  v_add_f32_dpp v20, v35, v35 row_half_mirror row_mask:0xf bank_mask:0x5
  v_dot2_f32_bf16 v23, v182, v61, 0
  v_add_f32_dpp v20, v21, v21 row_half_mirror row_mask:0xf bank_mask:0xa
  v_dot2_f32_bf16 v24, v180, v62, 0
  v_dot2_f32_bf16 v25, v183, v63, 0
  v_add_f32_dpp v20, v20, v20 quad_perm:[2,3,0,1] row_mask:0xf bank_mask:0xf
  v_cvt_f32_i32 v108, v108
  v_cvt_f32_i32 v109, v109
  v_add_f32_dpp v20, v20, v20 quad_perm:[1,0,3,2] row_mask:0xf bank_mask:0xf
  v_cndmask_b32_e64 v33, v33, v20, s[54:55]
  ds_write_b32 v1, v33 offset:3584
  v_cvt_f32_i32 v110, v110
  v_cvt_f32_i32 v111, v111
  v_pk_mul_f32 v[20:21], v[108:109], v[22:23]
  v_pk_add_f32 v[18:19], v[22:23], v[24:25]
  v_pk_fma_f32 v[20:21], v[110:111], v[24:25], v[20:21]
  v_add_f32 v18, v18, v19
  v_add_f32 v20, v20, v21
  s_add_u32 m0, s100, 23552
  v_lshrrev_b32 v10, 1, v235
  v_add_u32 v10, v10, v242
  v_mad_u64_u32 v[30:31], s[64:65], v10, 1, v[28:29]
  global_load_lds_dwordx4 v[30:31], off
  s_cmpk_gt_i32 s69, 0x31
  s_cbranch_scc1 L_p27_4
  s_cmpk_gt_i32 s69, 0xb
  s_cbranch_scc1 L_p27_2
  s_waitcnt vmcnt(8)
L_p27_2:
  s_waitcnt vmcnt(12)
L_p27_4:
  s_waitcnt vmcnt(13)
  buffer_load_dwordx4 v[96:99], v234, s[32:35], 0 offen nt
  s_waitcnt vmcnt(12)
  ds_read_b64 v[188:189], v12 offset:18432
  ds_read_b64 v[190:191], v12 offset:18560
  ds_read_b64 v[192:193], v12 offset:19456
  ds_read_b64 v[194:195], v12 offset:19584
  ds_read_b64 v[196:197], v12 offset:20480
  ds_read_b64 v[198:199], v12 offset:20608
  v_dot2_f32_bf16 v22, v181, v64, 0
  v_add_f32_dpp v35, v18, v18 row_ror:8 row_mask:0xf bank_mask:0xc
  v_add_f32_dpp v35, v20, v20 row_ror:8 row_mask:0xf bank_mask:0x3
  v_dot2_f32_bf16 v23, v186, v65, 0
  v_dot2_f32_bf16 v24, v184, v66, 0
  v_dot2_f32_bf16 v25, v187, v67, 0
  v_cvt_f32_i32 v112, v112
  v_cvt_f32_i32 v113, v113
  v_cvt_f32_i32 v114, v114
  v_cvt_f32_i32 v115, v115
  v_pk_mul_f32 v[20:21], v[112:113], v[22:23]
  v_pk_add_f32 v[18:19], v[22:23], v[24:25]
  v_pk_fma_f32 v[20:21], v[114:115], v[24:25], v[20:21]
  v_add_f32 v18, v18, v19
  v_add_f32 v20, v20, v21
  s_cmpk_gt_i32 s69, 0x31
  s_cbranch_scc1 L_p28_4
  s_cmpk_gt_i32 s69, 0x1d
  s_cbranch_scc1 L_p28_3
  s_cmpk_gt_i32 s69, 0xffcd
  s_cbranch_scc1 L_p28_0
  s_waitcnt vmcnt(8)
L_p28_0:
  s_waitcnt vmcnt(9)
L_p28_3:
  s_waitcnt vmcnt(13)
L_p28_4:
  s_waitcnt vmcnt(14)
  buffer_load_dwordx4 v[100:103], v235, s[32:35], 0 offen nt
L_it12:
  s_waitcnt lgkmcnt(0)
  s_waitcnt vmcnt(10)
  s_add_u32 s44, s78, 0x03030303
  v_msad_u8 v9, s78, v36, 0
  v_msad_u8 v10, s44, v36, 0
  v_msad_u8 v9, s78, v37, v9
  v_msad_u8 v10, s44, v37, v10
  v_msad_u8 v9, s78, v38, v9
  v_msad_u8 v10, s44, v38, v10
  s_mov_b64 exec, 3
  global_store_byte v7, v8, s[30:31]
  global_load_dwordx3 v[36:38], v236, s[30:31] sc1
  v_sub_u32 v9, v9, v10
  v_add_u32 v8, 1, v8
  s_mov_b64 exec, -1
  v_readlane_b32 s66, v9, 0
  v_readlane_b32 s67, v9, 1
  s_add_u32 s78, s78, 0x01010101
  s_lshl1_add_u32 s69, s91, s95
  s_add_u32 s95, s66, s67
  s_add_u32 s69, s69, s95
  v_perm_b32 v185, v190, v188, s56
  v_perm_b32 v190, v190, v188, s57
  v_perm_b32 v188, v191, v189, s56
  v_perm_b32 v191, v191, v189, s57
  v_dot2_f32_bf16 v22, v185, v44, 0
  v_add_f32_dpp v21, v18, v18 row_ror:8 row_mask:0xf bank_mask:0xc
  v_add_f32_dpp v21, v20, v20 row_ror:8 row_mask:0xf bank_mask:0x3
  v_add_f32_dpp v20, v35, v35 row_half_mirror row_mask:0xf bank_mask:0x5
  v_dot2_f32_bf16 v23, v190, v45, 0
  v_add_f32_dpp v20, v21, v21 row_half_mirror row_mask:0xf bank_mask:0xa
  v_dot2_f32_bf16 v24, v188, v46, 0
  v_dot2_f32_bf16 v25, v191, v47, 0
  v_add_f32_dpp v20, v20, v20 quad_perm:[2,3,0,1] row_mask:0xf bank_mask:0xf
  v_cvt_f32_i32 v68, v68
  v_cvt_f32_i32 v69, v69
  v_add_f32_dpp v20, v20, v20 quad_perm:[1,0,3,2] row_mask:0xf bank_mask:0xf
  v_cndmask_b32_e64 v33, v33, v20, s[48:49]
  v_cvt_f32_i32 v70, v70
  v_cvt_f32_i32 v71, v71
  v_pk_mul_f32 v[20:21], v[68:69], v[22:23]
  v_pk_add_f32 v[18:19], v[22:23], v[24:25]
  v_pk_fma_f32 v[20:21], v[70:71], v[24:25], v[20:21]
  v_add_f32 v18, v18, v19
  v_add_f32 v20, v20, v21
  s_cmpk_gt_i32 s69, 0x31
  s_cbranch_scc1 L_p29_4
  s_cmpk_gt_i32 s69, 0xffed
  s_cbranch_scc1 L_p29_1
  s_waitcnt vmcnt(6)
L_p29_1:
  s_waitcnt vmcnt(9)
L_p29_4:
  s_waitcnt vmcnt(11)
  buffer_load_dwordx4 v[104:107], v233, s[32:35], s80 offen nt
  v_perm_b32 v189, v194, v192, s56
  v_perm_b32 v194, v194, v192, s57
  v_perm_b32 v192, v195, v193, s56
  v_perm_b32 v195, v195, v193, s57
  v_dot2_f32_bf16 v22, v189, v48, 0
  v_add_f32_dpp v34, v18, v18 row_ror:8 row_mask:0xf bank_mask:0xc
  v_add_f32_dpp v34, v20, v20 row_ror:8 row_mask:0xf bank_mask:0x3
  v_dot2_f32_bf16 v23, v194, v49, 0
  v_dot2_f32_bf16 v24, v192, v50, 0
  v_dot2_f32_bf16 v25, v195, v51, 0
  v_cvt_f32_i32 v72, v72
  v_cvt_f32_i32 v73, v73
  v_cvt_f32_i32 v74, v74
  v_cvt_f32_i32 v75, v75
  v_pk_mul_f32 v[20:21], v[72:73], v[22:23]
  v_pk_add_f32 v[18:19], v[22:23], v[24:25]
  v_pk_fma_f32 v[20:21], v[74:75], v[24:25], v[20:21]
  v_add_f32 v18, v18, v19
  v_add_f32 v20, v20, v21
  s_cmpk_gt_i32 s69, 0x31
  s_cbranch_scc1 L_p30_4
  s_cmpk_gt_i32 s69, 0xb
  s_cbranch_scc1 L_p30_2
  s_waitcnt vmcnt(7)
L_p30_2:
  s_waitcnt vmcnt(10)
L_p30_4:
  s_waitcnt vmcnt(12)
  buffer_load_dwordx4 v[108:111], v234, s[32:35], s80 offen nt
  v_perm_b32 v193, v198, v196, s56
  v_perm_b32 v198, v198, v196, s57
  v_perm_b32 v196, v199, v197, s56
  v_perm_b32 v199, v199, v197, s57
  v_dot2_f32_bf16 v22, v193, v52, 0
  v_add_f32_dpp v21, v18, v18 row_ror:8 row_mask:0xf bank_mask:0xc
  v_add_f32_dpp v21, v20, v20 row_ror:8 row_mask:0xf bank_mask:0x3
  v_add_f32_dpp v20, v34, v34 row_half_mirror row_mask:0xf bank_mask:0x5
  v_dot2_f32_bf16 v23, v198, v53, 0
  v_add_f32_dpp v20, v21, v21 row_half_mirror row_mask:0xf bank_mask:0xa
  v_dot2_f32_bf16 v24, v196, v54, 0
  v_dot2_f32_bf16 v25, v199, v55, 0
  v_add_f32_dpp v20, v20, v20 quad_perm:[2,3,0,1] row_mask:0xf bank_mask:0xf
  v_cvt_f32_i32 v76, v76
  v_cvt_f32_i32 v77, v77
  v_add_f32_dpp v20, v20, v20 quad_perm:[1,0,3,2] row_mask:0xf bank_mask:0xf
  v_cndmask_b32_e64 v32, v32, v20, s[50:51]
  v_cvt_f32_i32 v78, v78
  v_cvt_f32_i32 v79, v79
  v_pk_mul_f32 v[20:21], v[76:77], v[22:23]
  v_pk_add_f32 v[18:19], v[22:23], v[24:25]
  v_pk_fma_f32 v[20:21], v[78:79], v[24:25], v[20:21]
  v_add_f32 v18, v18, v19
  v_add_f32 v20, v20, v21
  s_cmpk_gt_i32 s69, 0x31
  s_cbranch_scc1 L_p31_4
  s_cmpk_gt_i32 s69, 0x1d
  s_cbranch_scc1 L_p31_3
  s_cmpk_gt_i32 s69, 0xffcd
  s_cbranch_scc1 L_p31_0
  s_waitcnt vmcnt(6)
L_p31_0:
  s_waitcnt vmcnt(8)
L_p31_3:
  s_waitcnt vmcnt(11)
L_p31_4:
  s_waitcnt vmcnt(13)
  buffer_load_dwordx4 v[112:115], v235, s[32:35], s80 offen nt
L_it13:
  s_waitcnt lgkmcnt(0)
  s_waitcnt vmcnt(8)
  s_add_u32 s44, s78, 0x03030303
  v_msad_u8 v9, s78, v40, 0
  v_msad_u8 v10, s44, v40, 0
  v_msad_u8 v9, s78, v41, v9
  v_msad_u8 v10, s44, v41, v10
  v_msad_u8 v9, s78, v42, v9
  v_msad_u8 v10, s44, v42, v10
  s_mov_b64 exec, 3
  global_load_dwordx2 v[26:27], v11, s[30:31] sc1
  global_store_byte v7, v8, s[30:31]
  global_load_dwordx3 v[40:42], v237, s[30:31] sc1
  v_sub_u32 v9, v9, v10
  v_add_u32 v8, 1, v8
  s_mov_b64 exec, -1
  v_readlane_b32 s66, v9, 0
  v_readlane_b32 s67, v9, 1
  s_add_u32 s78, s78, 0x01010101
  s_lshl1_add_u32 s69, s91, s95
  s_add_u32 s95, s66, s67
  s_add_u32 s69, s69, s95
  v_dot2_f32_bf16 v22, v185, v56, 0
  v_add_f32_dpp v34, v18, v18 row_ror:8 row_mask:0xf bank_mask:0xc
  v_add_f32_dpp v34, v20, v20 row_ror:8 row_mask:0xf bank_mask:0x3
  v_dot2_f32_bf16 v23, v190, v57, 0
  v_dot2_f32_bf16 v24, v188, v58, 0
  v_dot2_f32_bf16 v25, v191, v59, 0
  v_cvt_f32_i32 v80, v80
  v_cvt_f32_i32 v81, v81
  v_cvt_f32_i32 v82, v82
  v_cvt_f32_i32 v83, v83
  v_pk_mul_f32 v[20:21], v[80:81], v[22:23]
  v_pk_add_f32 v[18:19], v[22:23], v[24:25]
  v_pk_fma_f32 v[20:21], v[82:83], v[24:25], v[20:21]
  v_add_f32 v18, v18, v19
  v_add_f32 v20, v20, v21
  s_cmpk_gt_i32 s69, 0x31
  s_cbranch_scc1 L_p32_4
  s_cmpk_gt_i32 s69, 0xffed
  s_cbranch_scc1 L_p32_1
  s_waitcnt vmcnt(6)
L_p32_1:
  s_waitcnt vmcnt(9)
L_p32_4:
  s_waitcnt vmcnt(10)
  buffer_load_dwordx4 v[68:71], v212, s[32:35], s3 offen nt
  v_dot2_f32_bf16 v22, v189, v60, 0
  v_add_f32_dpp v35, v18, v18 row_ror:8 row_mask:0xf bank_mask:0xc
  v_add_f32_dpp v35, v20, v20 row_ror:8 row_mask:0xf bank_mask:0x3
  v_dot2_f32_bf16 v23, v194, v61, 0
  v_dot2_f32_bf16 v24, v192, v62, 0
  v_dot2_f32_bf16 v25, v195, v63, 0
  v_cvt_f32_i32 v84, v84
  v_cvt_f32_i32 v85, v85
  v_cvt_f32_i32 v86, v86
  v_cvt_f32_i32 v87, v87
  v_pk_mul_f32 v[20:21], v[84:85], v[22:23]
  v_pk_add_f32 v[18:19], v[22:23], v[24:25]
  v_pk_fma_f32 v[20:21], v[86:87], v[24:25], v[20:21]
  v_add_f32 v18, v18, v19
  v_add_f32 v20, v20, v21
  s_cmpk_gt_i32 s69, 0x31
  s_cbranch_scc1 L_p33_4
  s_cmpk_gt_i32 s69, 0xb
  s_cbranch_scc1 L_p33_2
  s_waitcnt vmcnt(7)
L_p33_2:
  s_waitcnt vmcnt(10)
L_p33_4:
  s_waitcnt vmcnt(11)
  buffer_load_dwordx4 v[72:75], v213, s[32:35], s3 offen nt
  s_waitcnt vmcnt(10)
  ds_read_b64 v[200:201], v12 offset:21504
  ds_read_b64 v[202:203], v12 offset:21632
  ds_read_b64 v[204:205], v12 offset:22528
  ds_read_b64 v[206:207], v12 offset:22656
  ds_read_b64 v[208:209], v12 offset:23552
  ds_read_b64 v[210:211], v12 offset:23680
  v_dot2_f32_bf16 v22, v193, v64, 0
  v_add_f32_dpp v21, v18, v18 row_ror:8 row_mask:0xf bank_mask:0xc
  v_add_f32_dpp v21, v20, v20 row_ror:8 row_mask:0xf bank_mask:0x3
  v_add_f32_dpp v20, v35, v35 row_half_mirror row_mask:0xf bank_mask:0x5
  v_dot2_f32_bf16 v23, v198, v65, 0
  v_add_f32_dpp v20, v21, v21 row_half_mirror row_mask:0xf bank_mask:0xa
  v_dot2_f32_bf16 v24, v196, v66, 0
  v_dot2_f32_bf16 v25, v199, v67, 0
  v_add_f32_dpp v20, v20, v20 quad_perm:[2,3,0,1] row_mask:0xf bank_mask:0xf
  v_cvt_f32_i32 v88, v88
  v_cvt_f32_i32 v89, v89
  v_add_f32_dpp v20, v20, v20 quad_perm:[1,0,3,2] row_mask:0xf bank_mask:0xf
  v_cndmask_b32_e64 v33, v33, v20, s[50:51]
  v_cvt_f32_i32 v90, v90
  v_cvt_f32_i32 v91, v91
  v_pk_mul_f32 v[20:21], v[88:89], v[22:23]
  v_pk_add_f32 v[18:19], v[22:23], v[24:25]
  v_pk_fma_f32 v[20:21], v[90:91], v[24:25], v[20:21]
  v_add_f32 v18, v18, v19
  v_add_f32 v20, v20, v21
  s_cmpk_gt_i32 s69, 0x31
  s_cbranch_scc1 L_p34_4
  s_cmpk_gt_i32 s69, 0x1d
  s_cbranch_scc1 L_p34_3
  s_cmpk_gt_i32 s69, 0xffcd
  s_cbranch_scc1 L_p34_0
  s_waitcnt vmcnt(7)
L_p34_0:
  s_waitcnt vmcnt(8)
L_p34_3:
  s_waitcnt vmcnt(11)
L_p34_4:
  s_waitcnt vmcnt(12)
  buffer_load_dwordx4 v[76:79], v214, s[32:35], s3 offen nt
L_it14:
  s_waitcnt lgkmcnt(0)
  ds_read_b32 v4, v14 offset:16
  s_waitcnt vmcnt(8)
  s_add_u32 s44, s78, 0x03030303
  v_msad_u8 v9, s78, v36, 0
  v_msad_u8 v10, s44, v36, 0
  v_msad_u8 v9, s78, v37, v9
  v_msad_u8 v10, s44, v37, v10
  v_msad_u8 v9, s78, v38, v9
  v_msad_u8 v10, s44, v38, v10
  s_mov_b64 exec, 3
  global_store_byte v7, v8, s[30:31]
  global_load_dwordx3 v[36:38], v238, s[30:31] sc1
  v_sub_u32 v9, v9, v10
  v_add_u32 v8, 1, v8
  s_mov_b64 exec, -1
  v_readlane_b32 s66, v9, 0
  v_readlane_b32 s67, v9, 1
  s_add_u32 s78, s78, 0x01010101
  s_lshl1_add_u32 s69, s91, s95
  s_add_u32 s95, s66, s67
  s_add_u32 s69, s69, s95
  v_perm_b32 v197, v202, v200, s56
  v_perm_b32 v202, v202, v200, s57
  v_perm_b32 v200, v203, v201, s56
  v_perm_b32 v203, v203, v201, s57
  v_dot2_f32_bf16 v22, v197, v44, 0
  v_add_f32_dpp v35, v18, v18 row_ror:8 row_mask:0xf bank_mask:0xc
  v_add_f32_dpp v35, v20, v20 row_ror:8 row_mask:0xf bank_mask:0x3
  v_dot2_f32_bf16 v23, v202, v45, 0
  v_dot2_f32_bf16 v24, v200, v46, 0
  v_dot2_f32_bf16 v25, v203, v47, 0
  v_cvt_f32_i32 v92, v92
  v_cvt_f32_i32 v93, v93
  v_cvt_f32_i32 v94, v94
  v_cvt_f32_i32 v95, v95
  v_pk_mul_f32 v[20:21], v[92:93], v[22:23]
  v_pk_add_f32 v[18:19], v[22:23], v[24:25]
  v_pk_fma_f32 v[20:21], v[94:95], v[24:25], v[20:21]
  v_add_f32 v18, v18, v19
  v_add_f32 v20, v20, v21
  s_cmpk_gt_i32 s69, 0x31
  s_cbranch_scc1 L_p35_4
  s_cmpk_gt_i32 s69, 0xffed
  s_cbranch_scc1 L_p35_1
  s_waitcnt vmcnt(5)
L_p35_1:
  s_waitcnt vmcnt(9)
L_p35_4:
  s_waitcnt vmcnt(10)
  buffer_load_dwordx4 v[80:83], v215, s[32:35], s3 offen nt
  v_perm_b32 v201, v206, v204, s56
  v_perm_b32 v206, v206, v204, s57
  v_perm_b32 v204, v207, v205, s56
  v_perm_b32 v207, v207, v205, s57
  v_dot2_f32_bf16 v22, v201, v48, 0
  v_add_f32_dpp v21, v18, v18 row_ror:8 row_mask:0xf bank_mask:0xc
  v_add_f32_dpp v21, v20, v20 row_ror:8 row_mask:0xf bank_mask:0x3
  v_add_f32_dpp v20, v34, v34 row_half_mirror row_mask:0xf bank_mask:0x5
  v_dot2_f32_bf16 v23, v206, v49, 0
  v_add_f32_dpp v20, v21, v21 row_half_mirror row_mask:0xf bank_mask:0xa
  v_dot2_f32_bf16 v24, v204, v50, 0
  v_dot2_f32_bf16 v25, v207, v51, 0
  v_add_f32_dpp v20, v20, v20 quad_perm:[2,3,0,1] row_mask:0xf bank_mask:0xf
  v_cvt_f32_i32 v96, v96
  v_cvt_f32_i32 v97, v97
  v_add_f32_dpp v20, v20, v20 quad_perm:[1,0,3,2] row_mask:0xf bank_mask:0xf
  v_cndmask_b32_e64 v32, v32, v20, s[52:53]
  v_cvt_f32_i32 v98, v98
  v_cvt_f32_i32 v99, v99
  v_pk_mul_f32 v[20:21], v[96:97], v[22:23]
  v_pk_add_f32 v[18:19], v[22:23], v[24:25]
  v_pk_fma_f32 v[20:21], v[98:99], v[24:25], v[20:21]
  v_add_f32 v18, v18, v19
  v_add_f32 v20, v20, v21
  s_cmpk_gt_i32 s69, 0x31
  s_cbranch_scc1 L_p36_4
  s_cmpk_gt_i32 s69, 0xb
  s_cbranch_scc1 L_p36_2
  s_waitcnt vmcnt(6)
L_p36_2:
  s_waitcnt vmcnt(10)
L_p36_4:
  s_waitcnt vmcnt(11)
  buffer_load_dwordx4 v[84:87], v216, s[32:35], s3 offen nt
  v_perm_b32 v205, v210, v208, s56
  v_perm_b32 v210, v210, v208, s57
  v_perm_b32 v208, v211, v209, s56
  v_perm_b32 v211, v211, v209, s57
  v_dot2_f32_bf16 v22, v205, v52, 0
  v_add_f32_dpp v34, v18, v18 row_ror:8 row_mask:0xf bank_mask:0xc
  v_add_f32_dpp v34, v20, v20 row_ror:8 row_mask:0xf bank_mask:0x3
  v_dot2_f32_bf16 v23, v210, v53, 0
  v_dot2_f32_bf16 v24, v208, v54, 0
  v_dot2_f32_bf16 v25, v211, v55, 0
  v_cvt_f32_i32 v100, v100
  v_cvt_f32_i32 v101, v101
  v_cvt_f32_i32 v102, v102
  v_cvt_f32_i32 v103, v103
  v_pk_mul_f32 v[20:21], v[100:101], v[22:23]
  v_pk_add_f32 v[18:19], v[22:23], v[24:25]
  v_pk_fma_f32 v[20:21], v[102:103], v[24:25], v[20:21]
  v_add_f32 v18, v18, v19
  v_add_f32 v20, v20, v21
  s_cmpk_gt_i32 s69, 0x31
  s_cbranch_scc1 L_p37_4
  s_cmpk_gt_i32 s69, 0x1d
  s_cbranch_scc1 L_p37_3
  s_cmpk_gt_i32 s69, 0xffcd
  s_cbranch_scc1 L_p37_0
  s_waitcnt vmcnt(6)
L_p37_0:
  s_waitcnt vmcnt(7)
L_p37_3:
  s_waitcnt vmcnt(11)
L_p37_4:
  s_waitcnt vmcnt(12)
  buffer_load_dwordx4 v[88:91], v217, s[32:35], s3 offen nt
L_it15:
  s_mov_b32 s47, 3
L_fq15:
  s_waitcnt lgkmcnt(0)
  v_readfirstlane_b32 s46, v4
  s_cmp_ge_u32 s46, s47
  s_cbranch_scc1 L_fq15_ok
  s_cmp_eq_u32 s94, 0
  s_cbranch_scc1 L_fq15_ok
  s_sub_u32 s94, s94, 1
  ds_read_b32 v4, v14 offset:16
  s_branch L_fq15
L_fq15_ok:
  s_waitcnt vmcnt(7)
  s_add_u32 s44, s78, 0x03030303
  v_msad_u8 v9, s78, v40, 0
  v_msad_u8 v10, s44, v40, 0
  v_msad_u8 v9, s78, v41, v9
  v_msad_u8 v10, s44, v41, v10
  v_msad_u8 v9, s78, v42, v9
  v_msad_u8 v10, s44, v42, v10
  s_mov_b64 exec, 3
  global_store_byte v7, v8, s[30:31]
  global_load_dwordx3 v[40:42], v239, s[30:31] sc1
  v_sub_u32 v9, v9, v10
  v_add3_u32 v10, v26, v27, s58
  v_add_u32 v8, 1, v8
  s_mov_b64 exec, -1
  v_readlane_b32 s66, v9, 0
  v_readlane_b32 s67, v9, 1
  v_readlane_b32 s91, v10, 0
  s_add_u32 s78, s78, 0x01010101
  s_lshl1_add_u32 s69, s91, s95
  s_add_u32 s95, s66, s67
  s_add_u32 s69, s69, s95
  v_dot2_f32_bf16 v22, v197, v56, 0
  v_add_f32_dpp v21, v18, v18 row_ror:8 row_mask:0xf bank_mask:0xc
  v_add_f32_dpp v21, v20, v20 row_ror:8 row_mask:0xf bank_mask:0x3
  v_add_f32_dpp v20, v34, v34 row_half_mirror row_mask:0xf bank_mask:0x5
  v_dot2_f32_bf16 v23, v202, v57, 0
  v_add_f32_dpp v20, v21, v21 row_half_mirror row_mask:0xf bank_mask:0xa
  v_dot2_f32_bf16 v24, v200, v58, 0
  v_dot2_f32_bf16 v25, v203, v59, 0
  v_add_f32_dpp v20, v20, v20 quad_perm:[2,3,0,1] row_mask:0xf bank_mask:0xf
  v_cvt_f32_i32 v104, v104
  v_cvt_f32_i32 v105, v105
  v_add_f32_dpp v20, v20, v20 quad_perm:[1,0,3,2] row_mask:0xf bank_mask:0xf
  v_cndmask_b32_e64 v32, v32, v20, s[54:55]
  ds_write_b32 v1, v32 offset:1024
  v_cvt_f32_i32 v106, v106
  v_cvt_f32_i32 v107, v107
  ds_read_b128 v[44:47], v15 offset:2560
  v_pk_mul_f32 v[20:21], v[104:105], v[22:23]
  v_pk_add_f32 v[18:19], v[22:23], v[24:25]
  v_pk_fma_f32 v[20:21], v[106:107], v[24:25], v[20:21]
  v_add_f32 v18, v18, v19
  v_add_f32 v20, v20, v21
  s_cmpk_gt_i32 s69, 0x31
  s_cbranch_scc1 L_p38_4
  s_cmpk_gt_i32 s69, 0xffed
  s_cbranch_scc1 L_p38_1
  s_waitcnt vmcnt(5)
L_p38_1:
  s_waitcnt vmcnt(8)
L_p38_4:
  s_waitcnt vmcnt(9)
  buffer_load_dwordx4 v[92:95], v218, s[32:35], s3 offen nt
  v_dot2_f32_bf16 v22, v201, v60, 0
  v_add_f32_dpp v21, v18, v18 row_ror:8 row_mask:0xf bank_mask:0xc
  v_add_f32_dpp v21, v20, v20 row_ror:8 row_mask:0xf bank_mask:0x3
  v_add_f32_dpp v20, v35, v35 row_half_mirror row_mask:0xf bank_mask:0x5
  v_dot2_f32_bf16 v23, v206, v61, 0
  v_add_f32_dpp v20, v21, v21 row_half_mirror row_mask:0xf bank_mask:0xa
  v_dot2_f32_bf16 v24, v204, v62, 0
  v_dot2_f32_bf16 v25, v207, v63, 0
  v_add_f32_dpp v20, v20, v20 quad_perm:[2,3,0,1] row_mask:0xf bank_mask:0xf
  v_cvt_f32_i32 v108, v108
  v_cvt_f32_i32 v109, v109
  v_add_f32_dpp v20, v20, v20 quad_perm:[1,0,3,2] row_mask:0xf bank_mask:0xf
  v_cndmask_b32_e64 v33, v33, v20, s[52:53]
  v_cvt_f32_i32 v110, v110
  v_cvt_f32_i32 v111, v111
  ds_read_b128 v[48:51], v16 offset:2560
  v_pk_mul_f32 v[20:21], v[108:109], v[22:23]
  v_pk_add_f32 v[18:19], v[22:23], v[24:25]
  v_pk_fma_f32 v[20:21], v[110:111], v[24:25], v[20:21]
  v_add_f32 v18, v18, v19
  v_add_f32 v20, v20, v21
  s_cmpk_gt_i32 s69, 0x31
  s_cbranch_scc1 L_p39_4
  s_cmpk_gt_i32 s69, 0xb
  s_cbranch_scc1 L_p39_2
  s_waitcnt vmcnt(6)
L_p39_2:
  s_waitcnt vmcnt(9)
L_p39_4:
  s_waitcnt vmcnt(10)
  buffer_load_dwordx4 v[96:99], v219, s[32:35], s3 offen nt
  v_dot2_f32_bf16 v22, v205, v64, 0
  v_add_f32_dpp v35, v18, v18 row_ror:8 row_mask:0xf bank_mask:0xc
  v_add_f32_dpp v35, v20, v20 row_ror:8 row_mask:0xf bank_mask:0x3
  v_dot2_f32_bf16 v23, v210, v65, 0
  v_dot2_f32_bf16 v24, v208, v66, 0
  v_dot2_f32_bf16 v25, v211, v67, 0
  v_cvt_f32_i32 v112, v112
  v_cvt_f32_i32 v113, v113
  v_cvt_f32_i32 v114, v114
  v_cvt_f32_i32 v115, v115
  ds_read_b128 v[52:55], v17 offset:2560
  v_pk_mul_f32 v[20:21], v[112:113], v[22:23]
  v_pk_add_f32 v[18:19], v[22:23], v[24:25]
  v_pk_fma_f32 v[20:21], v[114:115], v[24:25], v[20:21]
  v_add_f32 v18, v18, v19
  v_add_f32 v20, v20, v21
  s_cmpk_gt_i32 s69, 0x31
  s_cbranch_scc1 L_p40_4
  s_cmpk_gt_i32 s69, 0x1d
  s_cbranch_scc1 L_p40_3
  s_cmpk_gt_i32 s69, 0xffcd
  s_cbranch_scc1 L_p40_0
  s_waitcnt vmcnt(6)
L_p40_0:
  s_waitcnt vmcnt(7)
L_p40_3:
  s_waitcnt vmcnt(10)
L_p40_4:
  s_waitcnt vmcnt(11)
  buffer_load_dwordx4 v[100:103], v220, s[32:35], s3 offen nt
  s_nop 0
  v_add_f32_dpp v21, v18, v18 row_ror:8 row_mask:0xf bank_mask:0xc
  v_add_f32_dpp v21, v20, v20 row_ror:8 row_mask:0xf bank_mask:0x3
  v_add_f32_dpp v20, v35, v35 row_half_mirror row_mask:0xf bank_mask:0x5
  s_nop 0
  v_add_f32_dpp v20, v21, v21 row_half_mirror row_mask:0xf bank_mask:0xa
  s_nop 1
  v_add_f32_dpp v20, v20, v20 quad_perm:[2,3,0,1] row_mask:0xf bank_mask:0xf
  s_nop 1
  v_add_f32_dpp v20, v20, v20 quad_perm:[1,0,3,2] row_mask:0xf bank_mask:0xf
  v_cndmask_b32_e64 v33, v33, v20, s[54:55]
  ds_write_b32 v1, v33 offset:4096
  v_mov_b32 v9, 2
  ds_write_b32 v6, v9 offset:0
  v_add_u32 v15, 2048, v15
  v_add_u32 v16, 2048, v16
  v_add_u32 v17, 2048, v17
  s_mov_b32 s43, 2
  s_movk_i32 s101, 6144
  s_mov_b32 s34, 1572864
  s_add_u32 s32, s32, s3
  s_addc_u32 s33, s33, 0
  s_mov_b32 s68, 3
  s_lshl_b32 s44, s68, 2
  s_lshr_b64 s[64:65], s[96:97], s44
  s_and_b32 s64, s64, 15
  s_lshl4_add_u32 s68, s68, s64
  s_mul_i32 s44, s68, 1572864
  s_add_u32 s36, s6, s44
  s_addc_u32 s37, s7, 0
.p2align 6
L_k:
  s_add_u32 s44, s43, 2
  s_min_u32 s47, s44, 16
  v_add_u32 v15, 1024, v15
  v_and_b32 v15, 0xfff, v15
  v_add_u32 v16, 1024, v16
  v_and_b32 v16, 0xfff, v16
  v_add_u32 v17, 1024, v17
  v_and_b32 v17, 0xfff, v17
  v_add_u32 v2, s101, v1
  s_addk_i32 s101, 3072
  s_cmpk_eq_u32 s101, 18432
  s_cselect_b32 s101, 0, s101
  s_waitcnt lgkmcnt(0)
  s_waitcnt vmcnt(8)
  s_add_u32 s44, s78, 0x03030303
  v_msad_u8 v9, s78, v36, 0
  v_msad_u8 v10, s44, v36, 0
  v_msad_u8 v9, s78, v37, v9
  v_msad_u8 v10, s44, v37, v10
  v_msad_u8 v9, s78, v38, v9
  v_msad_u8 v10, s44, v38, v10
  s_mov_b64 exec, 3
  global_store_byte v7, v8, s[30:31]
  global_load_dwordx3 v[36:38], v236, s[30:31] sc1
  v_sub_u32 v9, v9, v10
  v_add_u32 v8, 1, v8
  s_mov_b64 exec, -1
  v_readlane_b32 s66, v9, 0
  v_readlane_b32 s67, v9, 1
  s_add_u32 s78, s78, 0x01010101
  s_lshl1_add_u32 s69, s91, s95
  s_add_u32 s95, s66, s67
  s_add_u32 s69, s69, s95
  v_dot2_f32_bf16 v22, v13, v44, 0
  v_dot2_f32_bf16 v23, v118, v45, 0
  v_dot2_f32_bf16 v24, v116, v46, 0
  v_dot2_f32_bf16 v25, v119, v47, 0
  v_cvt_f32_i32 v68, v68
  v_cvt_f32_i32 v69, v69
  v_cvt_f32_i32 v70, v70
  v_cvt_f32_i32 v71, v71
  v_pk_mul_f32 v[20:21], v[68:69], v[22:23]
  v_pk_add_f32 v[18:19], v[22:23], v[24:25]
  v_pk_fma_f32 v[20:21], v[70:71], v[24:25], v[20:21]
  v_add_f32 v18, v18, v19
  v_add_f32 v20, v20, v21
  s_cmpk_gt_i32 s69, 0x2d
  s_cbranch_scc1 L_p41_4
  s_cmpk_gt_i32 s69, 0xffe9
  s_cbranch_scc1 L_p41_1
  s_waitcnt vmcnt(5)
L_p41_1:
  s_waitcnt vmcnt(8)
L_p41_4:
  s_waitcnt vmcnt(9)
  buffer_load_dwordx4 v[104:107], v221, s[32:35], 0 offen nt
  v_dot2_f32_bf16 v22, v117, v48, 0
  v_add_f32_dpp v34, v18, v18 row_ror:8 row_mask:0xf bank_mask:0xc
  v_add_f32_dpp v34, v20, v20 row_ror:8 row_mask:0xf bank_mask:0x3
  v_dot2_f32_bf16 v23, v122, v49, 0
  v_dot2_f32_bf16 v24, v120, v50, 0
  v_dot2_f32_bf16 v25, v123, v51, 0
  v_cvt_f32_i32 v72, v72
  v_cvt_f32_i32 v73, v73
  v_cvt_f32_i32 v74, v74
  v_cvt_f32_i32 v75, v75
  v_pk_mul_f32 v[20:21], v[72:73], v[22:23]
  v_pk_add_f32 v[18:19], v[22:23], v[24:25]
  v_pk_fma_f32 v[20:21], v[74:75], v[24:25], v[20:21]
  v_add_f32 v18, v18, v19
  v_add_f32 v20, v20, v21
  s_cmpk_gt_i32 s69, 0x2d
  s_cbranch_scc1 L_p42_4
  s_cmpk_gt_i32 s69, 0x7
  s_cbranch_scc1 L_p42_2
  s_waitcnt vmcnt(6)
L_p42_2:
  s_waitcnt vmcnt(9)
L_p42_4:
  s_waitcnt vmcnt(10)
  buffer_load_dwordx4 v[108:111], v222, s[32:35], 0 offen nt
  v_dot2_f32_bf16 v22, v121, v52, 0
  v_add_f32_dpp v21, v18, v18 row_ror:8 row_mask:0xf bank_mask:0xc
  v_add_f32_dpp v21, v20, v20 row_ror:8 row_mask:0xf bank_mask:0x3
  v_add_f32_dpp v20, v34, v34 row_half_mirror row_mask:0xf bank_mask:0x5
  v_dot2_f32_bf16 v23, v126, v53, 0
  v_add_f32_dpp v20, v21, v21 row_half_mirror row_mask:0xf bank_mask:0xa
  v_dot2_f32_bf16 v24, v124, v54, 0
  v_dot2_f32_bf16 v25, v127, v55, 0
  v_add_f32_dpp v20, v20, v20 quad_perm:[2,3,0,1] row_mask:0xf bank_mask:0xf
  v_cvt_f32_i32 v76, v76
  v_cvt_f32_i32 v77, v77
  v_add_f32_dpp v20, v20, v20 quad_perm:[1,0,3,2] row_mask:0xf bank_mask:0xf
  v_cndmask_b32_e64 v32, v32, v20, s[48:49]
  v_cvt_f32_i32 v78, v78
  v_cvt_f32_i32 v79, v79
  v_pk_mul_f32 v[20:21], v[76:77], v[22:23]
  v_pk_add_f32 v[18:19], v[22:23], v[24:25]
  v_pk_fma_f32 v[20:21], v[78:79], v[24:25], v[20:21]
  v_add_f32 v18, v18, v19
  v_add_f32 v20, v20, v21
  s_cmpk_gt_i32 s69, 0x2d
  s_cbranch_scc1 L_p43_4
  s_cmpk_gt_i32 s69, 0x19
  s_cbranch_scc1 L_p43_3
  s_cmpk_gt_i32 s69, 0xffc9
  s_cbranch_scc1 L_p43_0
  s_waitcnt vmcnt(6)
L_p43_0:
  s_waitcnt vmcnt(7)
L_p43_3:
  s_waitcnt vmcnt(10)
L_p43_4:
  s_waitcnt vmcnt(11)
  buffer_load_dwordx4 v[112:115], v223, s[32:35], 0 offen nt
  s_waitcnt vmcnt(8)
  s_add_u32 s44, s78, 0x03030303
  v_msad_u8 v9, s78, v40, 0
  v_msad_u8 v10, s44, v40, 0
  v_msad_u8 v9, s78, v41, v9
  v_msad_u8 v10, s44, v41, v10
  v_msad_u8 v9, s78, v42, v9
  v_msad_u8 v10, s44, v42, v10
  s_mov_b64 exec, 3
  global_store_byte v7, v8, s[30:31]
  global_load_dwordx3 v[40:42], v237, s[30:31] sc1
  v_sub_u32 v9, v9, v10
  v_add_u32 v8, 1, v8
  s_mov_b64 exec, -1
  v_readlane_b32 s66, v9, 0
  v_readlane_b32 s67, v9, 1
  s_add_u32 s78, s78, 0x01010101
  s_lshl1_add_u32 s69, s91, s95
  s_add_u32 s95, s66, s67
  s_add_u32 s69, s69, s95
  v_dot2_f32_bf16 v22, v125, v44, 0
  v_add_f32_dpp v34, v18, v18 row_ror:8 row_mask:0xf bank_mask:0xc
  v_add_f32_dpp v34, v20, v20 row_ror:8 row_mask:0xf bank_mask:0x3
  v_dot2_f32_bf16 v23, v130, v45, 0
  v_dot2_f32_bf16 v24, v128, v46, 0
  v_dot2_f32_bf16 v25, v131, v47, 0
  v_cvt_f32_i32 v80, v80
  v_cvt_f32_i32 v81, v81
  v_cvt_f32_i32 v82, v82
  v_cvt_f32_i32 v83, v83
  v_pk_mul_f32 v[20:21], v[80:81], v[22:23]
  v_pk_add_f32 v[18:19], v[22:23], v[24:25]
  v_pk_fma_f32 v[20:21], v[82:83], v[24:25], v[20:21]
  v_add_f32 v18, v18, v19
  v_add_f32 v20, v20, v21
  s_cmpk_gt_i32 s69, 0x2d
  s_cbranch_scc1 L_p44_4
  s_cmpk_gt_i32 s69, 0xffe9
  s_cbranch_scc1 L_p44_1
  s_waitcnt vmcnt(5)
L_p44_1:
  s_waitcnt vmcnt(8)
L_p44_4:
  s_waitcnt vmcnt(9)
  buffer_load_dwordx4 v[68:71], v224, s[32:35], 0 offen nt
  v_dot2_f32_bf16 v22, v129, v48, 0
  v_add_f32_dpp v21, v18, v18 row_ror:8 row_mask:0xf bank_mask:0xc
  v_add_f32_dpp v21, v20, v20 row_ror:8 row_mask:0xf bank_mask:0x3
  v_add_f32_dpp v20, v34, v34 row_half_mirror row_mask:0xf bank_mask:0x5
  v_dot2_f32_bf16 v23, v134, v49, 0
  v_add_f32_dpp v20, v21, v21 row_half_mirror row_mask:0xf bank_mask:0xa
  v_dot2_f32_bf16 v24, v132, v50, 0
  v_dot2_f32_bf16 v25, v135, v51, 0
  v_add_f32_dpp v20, v20, v20 quad_perm:[2,3,0,1] row_mask:0xf bank_mask:0xf
  v_cvt_f32_i32 v84, v84
  v_cvt_f32_i32 v85, v85
  v_add_f32_dpp v20, v20, v20 quad_perm:[1,0,3,2] row_mask:0xf bank_mask:0xf
  v_cndmask_b32_e64 v32, v32, v20, s[50:51]
  v_cvt_f32_i32 v86, v86
  v_cvt_f32_i32 v87, v87
  v_pk_mul_f32 v[20:21], v[84:85], v[22:23]
  v_pk_add_f32 v[18:19], v[22:23], v[24:25]
  v_pk_fma_f32 v[20:21], v[86:87], v[24:25], v[20:21]
  v_add_f32 v18, v18, v19
  v_add_f32 v20, v20, v21
  s_cmpk_gt_i32 s69, 0x2d
  s_cbranch_scc1 L_p45_4
  s_cmpk_gt_i32 s69, 0x7
  s_cbranch_scc1 L_p45_2
  s_waitcnt vmcnt(6)
L_p45_2:
  s_waitcnt vmcnt(9)
L_p45_4:
  s_waitcnt vmcnt(10)
  buffer_load_dwordx4 v[72:75], v225, s[32:35], 0 offen nt
  v_dot2_f32_bf16 v22, v133, v52, 0
  v_add_f32_dpp v34, v18, v18 row_ror:8 row_mask:0xf bank_mask:0xc
  v_add_f32_dpp v34, v20, v20 row_ror:8 row_mask:0xf bank_mask:0x3
  v_dot2_f32_bf16 v23, v138, v53, 0
  v_dot2_f32_bf16 v24, v136, v54, 0
  v_dot2_f32_bf16 v25, v139, v55, 0
  v_cvt_f32_i32 v88, v88
  v_cvt_f32_i32 v89, v89
  v_cvt_f32_i32 v90, v90
  v_cvt_f32_i32 v91, v91
  v_pk_mul_f32 v[20:21], v[88:89], v[22:23]
  v_pk_add_f32 v[18:19], v[22:23], v[24:25]
  v_pk_fma_f32 v[20:21], v[90:91], v[24:25], v[20:21]
  v_add_f32 v18, v18, v19
  v_add_f32 v20, v20, v21
  s_cmpk_gt_i32 s69, 0x2d
  s_cbranch_scc1 L_p46_4
  s_cmpk_gt_i32 s69, 0x19
  s_cbranch_scc1 L_p46_3
  s_cmpk_gt_i32 s69, 0xffc9
  s_cbranch_scc1 L_p46_0
  s_waitcnt vmcnt(6)
L_p46_0:
  s_waitcnt vmcnt(7)
L_p46_3:
  s_waitcnt vmcnt(10)
L_p46_4:
  s_waitcnt vmcnt(11)
  buffer_load_dwordx4 v[76:79], v226, s[32:35], 0 offen nt
  v_mov_b32 v9, s43
  ds_write_b32 v14, v9 offset:28
  s_waitcnt vmcnt(8)
  s_add_u32 s44, s78, 0x03030303
  v_msad_u8 v9, s78, v36, 0
  v_msad_u8 v10, s44, v36, 0
  v_msad_u8 v9, s78, v37, v9
  v_msad_u8 v10, s44, v37, v10
  v_msad_u8 v9, s78, v38, v9
  v_msad_u8 v10, s44, v38, v10
  s_mov_b64 exec, 3
  global_store_byte v7, v8, s[30:31]
  global_load_dwordx3 v[36:38], v238, s[30:31] sc1
  v_sub_u32 v9, v9, v10
  v_add_u32 v8, 1, v8
  s_mov_b64 exec, -1
  v_readlane_b32 s66, v9, 0
  v_readlane_b32 s67, v9, 1
  s_add_u32 s78, s78, 0x01010101
  s_lshl1_add_u32 s69, s91, s95
  s_add_u32 s95, s66, s67
  s_add_u32 s69, s69, s95
  v_dot2_f32_bf16 v22, v137, v44, 0
  v_add_f32_dpp v21, v18, v18 row_ror:8 row_mask:0xf bank_mask:0xc
  v_add_f32_dpp v21, v20, v20 row_ror:8 row_mask:0xf bank_mask:0x3
  v_add_f32_dpp v20, v34, v34 row_half_mirror row_mask:0xf bank_mask:0x5
  v_dot2_f32_bf16 v23, v142, v45, 0
  v_add_f32_dpp v20, v21, v21 row_half_mirror row_mask:0xf bank_mask:0xa
  v_dot2_f32_bf16 v24, v140, v46, 0
  v_dot2_f32_bf16 v25, v143, v47, 0
  v_add_f32_dpp v20, v20, v20 quad_perm:[2,3,0,1] row_mask:0xf bank_mask:0xf
  v_cvt_f32_i32 v92, v92
  v_cvt_f32_i32 v93, v93
  v_add_f32_dpp v20, v20, v20 quad_perm:[1,0,3,2] row_mask:0xf bank_mask:0xf
  v_cndmask_b32_e64 v32, v32, v20, s[52:53]
  v_cvt_f32_i32 v94, v94
  v_cvt_f32_i32 v95, v95
  v_pk_mul_f32 v[20:21], v[92:93], v[22:23]
  v_pk_add_f32 v[18:19], v[22:23], v[24:25]
  v_pk_fma_f32 v[20:21], v[94:95], v[24:25], v[20:21]
  v_add_f32 v18, v18, v19
  v_add_f32 v20, v20, v21
  s_cmpk_gt_i32 s69, 0x2d
  s_cbranch_scc1 L_p47_4
  s_cmpk_gt_i32 s69, 0xffe9
  s_cbranch_scc1 L_p47_1
  s_waitcnt vmcnt(5)
L_p47_1:
  s_waitcnt vmcnt(8)
L_p47_4:
  s_waitcnt vmcnt(9)
  buffer_load_dwordx4 v[80:83], v227, s[32:35], 0 offen nt
  v_dot2_f32_bf16 v22, v141, v48, 0
  v_add_f32_dpp v34, v18, v18 row_ror:8 row_mask:0xf bank_mask:0xc
  v_add_f32_dpp v34, v20, v20 row_ror:8 row_mask:0xf bank_mask:0x3
  v_dot2_f32_bf16 v23, v146, v49, 0
  v_dot2_f32_bf16 v24, v144, v50, 0
  v_dot2_f32_bf16 v25, v147, v51, 0
  v_cvt_f32_i32 v96, v96
  v_cvt_f32_i32 v97, v97
  v_cvt_f32_i32 v98, v98
  v_cvt_f32_i32 v99, v99
  v_pk_mul_f32 v[20:21], v[96:97], v[22:23]
  v_pk_add_f32 v[18:19], v[22:23], v[24:25]
  v_pk_fma_f32 v[20:21], v[98:99], v[24:25], v[20:21]
  v_add_f32 v18, v18, v19
  v_add_f32 v20, v20, v21
  s_cmpk_gt_i32 s69, 0x2d
  s_cbranch_scc1 L_p48_4
  s_cmpk_gt_i32 s69, 0x7
  s_cbranch_scc1 L_p48_2
  s_waitcnt vmcnt(6)
L_p48_2:
  s_waitcnt vmcnt(9)
L_p48_4:
  s_waitcnt vmcnt(10)
  buffer_load_dwordx4 v[84:87], v228, s[32:35], 0 offen nt
  v_dot2_f32_bf16 v22, v145, v52, 0
  v_add_f32_dpp v21, v18, v18 row_ror:8 row_mask:0xf bank_mask:0xc
  v_add_f32_dpp v21, v20, v20 row_ror:8 row_mask:0xf bank_mask:0x3
  v_add_f32_dpp v20, v34, v34 row_half_mirror row_mask:0xf bank_mask:0x5
  v_dot2_f32_bf16 v23, v150, v53, 0
  v_add_f32_dpp v20, v21, v21 row_half_mirror row_mask:0xf bank_mask:0xa
  v_dot2_f32_bf16 v24, v148, v54, 0
  v_dot2_f32_bf16 v25, v151, v55, 0
  v_add_f32_dpp v20, v20, v20 quad_perm:[2,3,0,1] row_mask:0xf bank_mask:0xf
  v_cvt_f32_i32 v100, v100
  v_cvt_f32_i32 v101, v101
  v_add_f32_dpp v20, v20, v20 quad_perm:[1,0,3,2] row_mask:0xf bank_mask:0xf
  v_cndmask_b32_e64 v32, v32, v20, s[54:55]
  ds_write_b32 v2, v32 offset:0
  v_cvt_f32_i32 v102, v102
  v_cvt_f32_i32 v103, v103
  v_pk_mul_f32 v[20:21], v[100:101], v[22:23]
  v_pk_add_f32 v[18:19], v[22:23], v[24:25]
  v_pk_fma_f32 v[20:21], v[102:103], v[24:25], v[20:21]
  v_add_f32 v18, v18, v19
  v_add_f32 v20, v20, v21
  s_cmpk_gt_i32 s69, 0x2d
  s_cbranch_scc1 L_p49_4
  s_cmpk_gt_i32 s69, 0x19
  s_cbranch_scc1 L_p49_3
  s_cmpk_gt_i32 s69, 0xffc9
  s_cbranch_scc1 L_p49_0
  s_waitcnt vmcnt(6)
L_p49_0:
  s_waitcnt vmcnt(7)
L_p49_3:
  s_waitcnt vmcnt(10)
L_p49_4:
  s_waitcnt vmcnt(11)
  buffer_load_dwordx4 v[88:91], v229, s[32:35], 0 offen nt
  s_waitcnt vmcnt(8)
  s_add_u32 s44, s78, 0x03030303
  v_msad_u8 v9, s78, v40, 0
  v_msad_u8 v10, s44, v40, 0
  v_msad_u8 v9, s78, v41, v9
  v_msad_u8 v10, s44, v41, v10
  v_msad_u8 v9, s78, v42, v9
  v_msad_u8 v10, s44, v42, v10
  s_mov_b64 exec, 3
  global_store_byte v7, v8, s[30:31]
  global_load_dwordx3 v[40:42], v239, s[30:31] sc1
  v_sub_u32 v9, v9, v10
  v_add_u32 v8, 1, v8
  s_mov_b64 exec, -1
  v_readlane_b32 s66, v9, 0
  v_readlane_b32 s67, v9, 1
  s_add_u32 s78, s78, 0x01010101
  s_lshl1_add_u32 s69, s91, s95
  s_add_u32 s95, s66, s67
  s_add_u32 s69, s69, s95
  v_dot2_f32_bf16 v22, v149, v44, 0
  v_add_f32_dpp v34, v18, v18 row_ror:8 row_mask:0xf bank_mask:0xc
  v_add_f32_dpp v34, v20, v20 row_ror:8 row_mask:0xf bank_mask:0x3
  v_dot2_f32_bf16 v23, v154, v45, 0
  v_dot2_f32_bf16 v24, v152, v46, 0
  v_dot2_f32_bf16 v25, v155, v47, 0
  v_cvt_f32_i32 v104, v104
  v_cvt_f32_i32 v105, v105
  v_cvt_f32_i32 v106, v106
  v_cvt_f32_i32 v107, v107
  v_pk_mul_f32 v[20:21], v[104:105], v[22:23]
  v_pk_add_f32 v[18:19], v[22:23], v[24:25]
  v_pk_fma_f32 v[20:21], v[106:107], v[24:25], v[20:21]
  v_add_f32 v18, v18, v19
  v_add_f32 v20, v20, v21
  s_cmpk_gt_i32 s69, 0x2d
  s_cbranch_scc1 L_p50_4
  s_cmpk_gt_i32 s69, 0xffe9
  s_cbranch_scc1 L_p50_1
  s_waitcnt vmcnt(5)
L_p50_1:
  s_waitcnt vmcnt(8)
L_p50_4:
  s_waitcnt vmcnt(9)
  buffer_load_dwordx4 v[92:95], v230, s[32:35], 0 offen nt
  v_dot2_f32_bf16 v22, v153, v48, 0
  v_add_f32_dpp v21, v18, v18 row_ror:8 row_mask:0xf bank_mask:0xc
  v_add_f32_dpp v21, v20, v20 row_ror:8 row_mask:0xf bank_mask:0x3
  v_add_f32_dpp v20, v34, v34 row_half_mirror row_mask:0xf bank_mask:0x5
  v_dot2_f32_bf16 v23, v158, v49, 0
  v_add_f32_dpp v20, v21, v21 row_half_mirror row_mask:0xf bank_mask:0xa
  v_dot2_f32_bf16 v24, v156, v50, 0
  v_dot2_f32_bf16 v25, v159, v51, 0
  v_add_f32_dpp v20, v20, v20 quad_perm:[2,3,0,1] row_mask:0xf bank_mask:0xf
  v_cvt_f32_i32 v108, v108
  v_cvt_f32_i32 v109, v109
  v_add_f32_dpp v20, v20, v20 quad_perm:[1,0,3,2] row_mask:0xf bank_mask:0xf
  v_cndmask_b32_e64 v32, v32, v20, s[48:49]
  v_cvt_f32_i32 v110, v110
  v_cvt_f32_i32 v111, v111
  v_pk_mul_f32 v[20:21], v[108:109], v[22:23]
  v_pk_add_f32 v[18:19], v[22:23], v[24:25]
  v_pk_fma_f32 v[20:21], v[110:111], v[24:25], v[20:21]
  v_add_f32 v18, v18, v19
  v_add_f32 v20, v20, v21
  s_cmpk_gt_i32 s69, 0x2d
  s_cbranch_scc1 L_p51_4
  s_cmpk_gt_i32 s69, 0x7
  s_cbranch_scc1 L_p51_2
  s_waitcnt vmcnt(6)
L_p51_2:
  s_waitcnt vmcnt(9)
L_p51_4:
  s_waitcnt vmcnt(10)
  buffer_load_dwordx4 v[96:99], v231, s[32:35], 0 offen nt
  v_dot2_f32_bf16 v22, v157, v52, 0
  v_add_f32_dpp v34, v18, v18 row_ror:8 row_mask:0xf bank_mask:0xc
  v_add_f32_dpp v34, v20, v20 row_ror:8 row_mask:0xf bank_mask:0x3
  v_dot2_f32_bf16 v23, v162, v53, 0
  v_dot2_f32_bf16 v24, v160, v54, 0
  v_dot2_f32_bf16 v25, v163, v55, 0
  v_cvt_f32_i32 v112, v112
  v_cvt_f32_i32 v113, v113
  v_cvt_f32_i32 v114, v114
  v_cvt_f32_i32 v115, v115
  v_pk_mul_f32 v[20:21], v[112:113], v[22:23]
  v_pk_add_f32 v[18:19], v[22:23], v[24:25]
  v_pk_fma_f32 v[20:21], v[114:115], v[24:25], v[20:21]
  v_add_f32 v18, v18, v19
  v_add_f32 v20, v20, v21
  s_cmpk_gt_i32 s69, 0x2d
  s_cbranch_scc1 L_p52_4
  s_cmpk_gt_i32 s69, 0x19
  s_cbranch_scc1 L_p52_3
  s_cmpk_gt_i32 s69, 0xffc9
  s_cbranch_scc1 L_p52_0
  s_waitcnt vmcnt(6)
L_p52_0:
  s_waitcnt vmcnt(7)
L_p52_3:
  s_waitcnt vmcnt(10)
L_p52_4:
  s_waitcnt vmcnt(11)
  buffer_load_dwordx4 v[100:103], v232, s[32:35], 0 offen nt
  s_waitcnt vmcnt(8)
  s_add_u32 s44, s78, 0x03030303
  v_msad_u8 v9, s78, v36, 0
  v_msad_u8 v10, s44, v36, 0
  v_msad_u8 v9, s78, v37, v9
  v_msad_u8 v10, s44, v37, v10
  v_msad_u8 v9, s78, v38, v9
  v_msad_u8 v10, s44, v38, v10
  s_mov_b64 exec, 3
  global_store_byte v7, v8, s[30:31]
  global_load_dwordx3 v[36:38], v236, s[30:31] sc1
  v_sub_u32 v9, v9, v10
  v_add_u32 v8, 1, v8
  s_mov_b64 exec, -1
  v_readlane_b32 s66, v9, 0
  v_readlane_b32 s67, v9, 1
  s_add_u32 s78, s78, 0x01010101
  s_lshl1_add_u32 s69, s91, s95
  s_add_u32 s95, s66, s67
  s_add_u32 s69, s69, s95
  v_dot2_f32_bf16 v22, v161, v44, 0
  v_add_f32_dpp v21, v18, v18 row_ror:8 row_mask:0xf bank_mask:0xc
  v_add_f32_dpp v21, v20, v20 row_ror:8 row_mask:0xf bank_mask:0x3
  v_add_f32_dpp v20, v34, v34 row_half_mirror row_mask:0xf bank_mask:0x5
  v_dot2_f32_bf16 v23, v166, v45, 0
  v_add_f32_dpp v20, v21, v21 row_half_mirror row_mask:0xf bank_mask:0xa
  v_dot2_f32_bf16 v24, v164, v46, 0
  v_dot2_f32_bf16 v25, v167, v47, 0
  v_add_f32_dpp v20, v20, v20 quad_perm:[2,3,0,1] row_mask:0xf bank_mask:0xf
  v_cvt_f32_i32 v68, v68
  v_cvt_f32_i32 v69, v69
  v_add_f32_dpp v20, v20, v20 quad_perm:[1,0,3,2] row_mask:0xf bank_mask:0xf
  v_cndmask_b32_e64 v32, v32, v20, s[50:51]
  v_cvt_f32_i32 v70, v70
  v_cvt_f32_i32 v71, v71
  v_pk_mul_f32 v[20:21], v[68:69], v[22:23]
  v_pk_add_f32 v[18:19], v[22:23], v[24:25]
  v_pk_fma_f32 v[20:21], v[70:71], v[24:25], v[20:21]
  v_add_f32 v18, v18, v19
  v_add_f32 v20, v20, v21
  s_cmpk_gt_i32 s69, 0x2d
  s_cbranch_scc1 L_p53_4
  s_cmpk_gt_i32 s69, 0xffe9
  s_cbranch_scc1 L_p53_1
  s_waitcnt vmcnt(5)
L_p53_1:
  s_waitcnt vmcnt(8)
L_p53_4:
  s_waitcnt vmcnt(9)
  buffer_load_dwordx4 v[104:107], v233, s[32:35], 0 offen nt
  v_dot2_f32_bf16 v22, v165, v48, 0
  v_add_f32_dpp v34, v18, v18 row_ror:8 row_mask:0xf bank_mask:0xc
  v_add_f32_dpp v34, v20, v20 row_ror:8 row_mask:0xf bank_mask:0x3
  v_dot2_f32_bf16 v23, v170, v49, 0
  v_dot2_f32_bf16 v24, v168, v50, 0
  v_dot2_f32_bf16 v25, v171, v51, 0
  v_cvt_f32_i32 v72, v72
  v_cvt_f32_i32 v73, v73
  v_cvt_f32_i32 v74, v74
  v_cvt_f32_i32 v75, v75
  v_pk_mul_f32 v[20:21], v[72:73], v[22:23]
  v_pk_add_f32 v[18:19], v[22:23], v[24:25]
  v_pk_fma_f32 v[20:21], v[74:75], v[24:25], v[20:21]
  v_add_f32 v18, v18, v19
  v_add_f32 v20, v20, v21
  s_cmpk_gt_i32 s69, 0x2d
  s_cbranch_scc1 L_p54_4
  s_cmpk_gt_i32 s69, 0x7
  s_cbranch_scc1 L_p54_2
  s_waitcnt vmcnt(6)
L_p54_2:
  s_waitcnt vmcnt(9)
L_p54_4:
  s_waitcnt vmcnt(10)
  buffer_load_dwordx4 v[108:111], v234, s[32:35], 0 offen nt
  v_dot2_f32_bf16 v22, v169, v52, 0
  v_add_f32_dpp v21, v18, v18 row_ror:8 row_mask:0xf bank_mask:0xc
  v_add_f32_dpp v21, v20, v20 row_ror:8 row_mask:0xf bank_mask:0x3
  v_add_f32_dpp v20, v34, v34 row_half_mirror row_mask:0xf bank_mask:0x5
  v_dot2_f32_bf16 v23, v174, v53, 0
  v_add_f32_dpp v20, v21, v21 row_half_mirror row_mask:0xf bank_mask:0xa
  v_dot2_f32_bf16 v24, v172, v54, 0
  v_dot2_f32_bf16 v25, v175, v55, 0
  v_add_f32_dpp v20, v20, v20 quad_perm:[2,3,0,1] row_mask:0xf bank_mask:0xf
  v_cvt_f32_i32 v76, v76
  v_cvt_f32_i32 v77, v77
  v_add_f32_dpp v20, v20, v20 quad_perm:[1,0,3,2] row_mask:0xf bank_mask:0xf
  v_cndmask_b32_e64 v32, v32, v20, s[52:53]
  v_cvt_f32_i32 v78, v78
  v_cvt_f32_i32 v79, v79
  v_pk_mul_f32 v[20:21], v[76:77], v[22:23]
  v_pk_add_f32 v[18:19], v[22:23], v[24:25]
  v_pk_fma_f32 v[20:21], v[78:79], v[24:25], v[20:21]
  v_add_f32 v18, v18, v19
  v_add_f32 v20, v20, v21
  s_cmpk_gt_i32 s69, 0x2d
  s_cbranch_scc1 L_p55_4
  s_cmpk_gt_i32 s69, 0x19
  s_cbranch_scc1 L_p55_3
  s_cmpk_gt_i32 s69, 0xffc9
  s_cbranch_scc1 L_p55_0
  s_waitcnt vmcnt(6)
L_p55_0:
  s_waitcnt vmcnt(7)
L_p55_3:
  s_waitcnt vmcnt(10)
L_p55_4:
  s_waitcnt vmcnt(11)
  buffer_load_dwordx4 v[112:115], v235, s[32:35], 0 offen nt
  s_waitcnt vmcnt(8)
  s_add_u32 s44, s78, 0x03030303
  v_msad_u8 v9, s78, v40, 0
  v_msad_u8 v10, s44, v40, 0
  v_msad_u8 v9, s78, v41, v9
  v_msad_u8 v10, s44, v41, v10
  v_msad_u8 v9, s78, v42, v9
  v_msad_u8 v10, s44, v42, v10
  s_mov_b64 exec, 3
  global_load_dwordx2 v[26:27], v11, s[30:31] sc1
  global_store_byte v7, v8, s[30:31]
  global_load_dwordx3 v[40:42], v237, s[30:31] sc1
  v_sub_u32 v9, v9, v10
  v_add_u32 v8, 1, v8
  s_mov_b64 exec, -1
  v_readlane_b32 s66, v9, 0
  v_readlane_b32 s67, v9, 1
  s_add_u32 s78, s78, 0x01010101
  s_lshl1_add_u32 s69, s91, s95
  s_add_u32 s95, s66, s67
  s_add_u32 s69, s69, s95
  v_dot2_f32_bf16 v22, v173, v44, 0
  v_add_f32_dpp v34, v18, v18 row_ror:8 row_mask:0xf bank_mask:0xc
  v_add_f32_dpp v34, v20, v20 row_ror:8 row_mask:0xf bank_mask:0x3
  v_dot2_f32_bf16 v23, v178, v45, 0
  v_dot2_f32_bf16 v24, v176, v46, 0
  v_dot2_f32_bf16 v25, v179, v47, 0
  v_cvt_f32_i32 v80, v80
  v_cvt_f32_i32 v81, v81
  v_cvt_f32_i32 v82, v82
  v_cvt_f32_i32 v83, v83
  v_pk_mul_f32 v[20:21], v[80:81], v[22:23]
  v_pk_add_f32 v[18:19], v[22:23], v[24:25]
  v_pk_fma_f32 v[20:21], v[82:83], v[24:25], v[20:21]
  v_add_f32 v18, v18, v19
  v_add_f32 v20, v20, v21
  s_cmpk_gt_i32 s69, 0x2d
  s_cbranch_scc1 L_p56_4
  s_cmpk_gt_i32 s69, 0xffe9
  s_cbranch_scc1 L_p56_1
  s_waitcnt vmcnt(6)
L_p56_1:
  s_waitcnt vmcnt(9)
L_p56_4:
  s_waitcnt vmcnt(10)
  buffer_load_dwordx4 v[68:71], v212, s[36:39], 0 offen nt
  v_dot2_f32_bf16 v22, v177, v48, 0
  v_add_f32_dpp v21, v18, v18 row_ror:8 row_mask:0xf bank_mask:0xc
  v_add_f32_dpp v21, v20, v20 row_ror:8 row_mask:0xf bank_mask:0x3
  v_add_f32_dpp v20, v34, v34 row_half_mirror row_mask:0xf bank_mask:0x5
  v_dot2_f32_bf16 v23, v182, v49, 0
  v_add_f32_dpp v20, v21, v21 row_half_mirror row_mask:0xf bank_mask:0xa
  v_dot2_f32_bf16 v24, v180, v50, 0
  v_dot2_f32_bf16 v25, v183, v51, 0
  v_add_f32_dpp v20, v20, v20 quad_perm:[2,3,0,1] row_mask:0xf bank_mask:0xf
  v_cvt_f32_i32 v84, v84
  v_cvt_f32_i32 v85, v85
  v_add_f32_dpp v20, v20, v20 quad_perm:[1,0,3,2] row_mask:0xf bank_mask:0xf
  v_cndmask_b32_e64 v32, v32, v20, s[54:55]
  ds_write_b32 v2, v32 offset:512
  v_cvt_f32_i32 v86, v86
  v_cvt_f32_i32 v87, v87
  v_pk_mul_f32 v[20:21], v[84:85], v[22:23]
  v_pk_add_f32 v[18:19], v[22:23], v[24:25]
  v_pk_fma_f32 v[20:21], v[86:87], v[24:25], v[20:21]
  v_add_f32 v18, v18, v19
  v_add_f32 v20, v20, v21
  s_cmpk_gt_i32 s69, 0x2d
  s_cbranch_scc1 L_p57_4
  s_cmpk_gt_i32 s69, 0x7
  s_cbranch_scc1 L_p57_2
  s_waitcnt vmcnt(7)
L_p57_2:
  s_waitcnt vmcnt(10)
L_p57_4:
  s_waitcnt vmcnt(11)
  buffer_load_dwordx4 v[72:75], v213, s[36:39], 0 offen nt
  v_dot2_f32_bf16 v22, v181, v52, 0
  v_add_f32_dpp v34, v18, v18 row_ror:8 row_mask:0xf bank_mask:0xc
  v_add_f32_dpp v34, v20, v20 row_ror:8 row_mask:0xf bank_mask:0x3
  v_dot2_f32_bf16 v23, v186, v53, 0
  v_dot2_f32_bf16 v24, v184, v54, 0
  v_dot2_f32_bf16 v25, v187, v55, 0
  v_cvt_f32_i32 v88, v88
  v_cvt_f32_i32 v89, v89
  v_cvt_f32_i32 v90, v90
  v_cvt_f32_i32 v91, v91
  v_pk_mul_f32 v[20:21], v[88:89], v[22:23]
  v_pk_add_f32 v[18:19], v[22:23], v[24:25]
  v_pk_fma_f32 v[20:21], v[90:91], v[24:25], v[20:21]
  v_add_f32 v18, v18, v19
  v_add_f32 v20, v20, v21
  s_cmpk_gt_i32 s69, 0x2d
  s_cbranch_scc1 L_p58_4
  s_cmpk_gt_i32 s69, 0x19
  s_cbranch_scc1 L_p58_3
  s_cmpk_gt_i32 s69, 0xffc9
  s_cbranch_scc1 L_p58_0
  s_waitcnt vmcnt(7)
L_p58_0:
  s_waitcnt vmcnt(8)
L_p58_3:
  s_waitcnt vmcnt(11)
L_p58_4:
  s_waitcnt vmcnt(12)
  buffer_load_dwordx4 v[76:79], v214, s[36:39], 0 offen nt
  ds_read_b32 v4, v14 offset:16
  s_waitcnt vmcnt(9)
  s_add_u32 s44, s78, 0x03030303
  v_msad_u8 v9, s78, v36, 0
  v_msad_u8 v10, s44, v36, 0
  v_msad_u8 v9, s78, v37, v9
  v_msad_u8 v10, s44, v37, v10
  v_msad_u8 v9, s78, v38, v9
  v_msad_u8 v10, s44, v38, v10
  s_mov_b64 exec, 3
  global_store_byte v7, v8, s[30:31]
  global_load_dwordx3 v[36:38], v238, s[30:31] sc1
  v_sub_u32 v9, v9, v10
  v_add_u32 v8, 1, v8
  s_mov_b64 exec, -1
  v_readlane_b32 s66, v9, 0
  v_readlane_b32 s67, v9, 1
  s_add_u32 s78, s78, 0x01010101
  s_lshl1_add_u32 s69, s91, s95
  s_add_u32 s95, s66, s67
  s_add_u32 s69, s69, s95
  v_dot2_f32_bf16 v22, v185, v44, 0
  v_add_f32_dpp v21, v18, v18 row_ror:8 row_mask:0xf bank_mask:0xc
  v_add_f32_dpp v21, v20, v20 row_ror:8 row_mask:0xf bank_mask:0x3
  v_add_f32_dpp v20, v34, v34 row_half_mirror row_mask:0xf bank_mask:0x5
  v_dot2_f32_bf16 v23, v190, v45, 0
  v_add_f32_dpp v20, v21, v21 row_half_mirror row_mask:0xf bank_mask:0xa
  v_dot2_f32_bf16 v24, v188, v46, 0
  v_dot2_f32_bf16 v25, v191, v47, 0
  v_add_f32_dpp v20, v20, v20 quad_perm:[2,3,0,1] row_mask:0xf bank_mask:0xf
  v_cvt_f32_i32 v92, v92
  v_cvt_f32_i32 v93, v93
  v_add_f32_dpp v20, v20, v20 quad_perm:[1,0,3,2] row_mask:0xf bank_mask:0xf
  v_cndmask_b32_e64 v32, v32, v20, s[48:49]
  v_cvt_f32_i32 v94, v94
  v_cvt_f32_i32 v95, v95
  v_pk_mul_f32 v[20:21], v[92:93], v[22:23]
  v_pk_add_f32 v[18:19], v[22:23], v[24:25]
  v_pk_fma_f32 v[20:21], v[94:95], v[24:25], v[20:21]
  v_add_f32 v18, v18, v19
  v_add_f32 v20, v20, v21
  s_cmpk_gt_i32 s69, 0x2d
  s_cbranch_scc1 L_p59_4
  s_cmpk_gt_i32 s69, 0xffe9
  s_cbranch_scc1 L_p59_1
  s_waitcnt vmcnt(5)
L_p59_1:
  s_waitcnt vmcnt(9)
L_p59_4:
  s_waitcnt vmcnt(10)
  buffer_load_dwordx4 v[80:83], v215, s[36:39], 0 offen nt
  v_dot2_f32_bf16 v22, v189, v48, 0
  v_add_f32_dpp v34, v18, v18 row_ror:8 row_mask:0xf bank_mask:0xc
  v_add_f32_dpp v34, v20, v20 row_ror:8 row_mask:0xf bank_mask:0x3
  v_dot2_f32_bf16 v23, v194, v49, 0
  v_dot2_f32_bf16 v24, v192, v50, 0
  v_dot2_f32_bf16 v25, v195, v51, 0
  v_cvt_f32_i32 v96, v96
  v_cvt_f32_i32 v97, v97
  v_cvt_f32_i32 v98, v98
  v_cvt_f32_i32 v99, v99
  v_pk_mul_f32 v[20:21], v[96:97], v[22:23]
  v_pk_add_f32 v[18:19], v[22:23], v[24:25]
  v_pk_fma_f32 v[20:21], v[98:99], v[24:25], v[20:21]
  v_add_f32 v18, v18, v19
  v_add_f32 v20, v20, v21
  s_cmpk_gt_i32 s69, 0x2d
  s_cbranch_scc1 L_p60_4
  s_cmpk_gt_i32 s69, 0x7
  s_cbranch_scc1 L_p60_2
  s_waitcnt vmcnt(6)
L_p60_2:
  s_waitcnt vmcnt(10)
L_p60_4:
  s_waitcnt vmcnt(11)
  buffer_load_dwordx4 v[84:87], v216, s[36:39], 0 offen nt
  v_dot2_f32_bf16 v22, v193, v52, 0
  v_add_f32_dpp v21, v18, v18 row_ror:8 row_mask:0xf bank_mask:0xc
  v_add_f32_dpp v21, v20, v20 row_ror:8 row_mask:0xf bank_mask:0x3
  v_add_f32_dpp v20, v34, v34 row_half_mirror row_mask:0xf bank_mask:0x5
  v_dot2_f32_bf16 v23, v198, v53, 0
  v_add_f32_dpp v20, v21, v21 row_half_mirror row_mask:0xf bank_mask:0xa
  v_dot2_f32_bf16 v24, v196, v54, 0
  v_dot2_f32_bf16 v25, v199, v55, 0
  v_add_f32_dpp v20, v20, v20 quad_perm:[2,3,0,1] row_mask:0xf bank_mask:0xf
  v_cvt_f32_i32 v100, v100
  v_cvt_f32_i32 v101, v101
  v_add_f32_dpp v20, v20, v20 quad_perm:[1,0,3,2] row_mask:0xf bank_mask:0xf
  v_cndmask_b32_e64 v32, v32, v20, s[50:51]
  v_cvt_f32_i32 v102, v102
  v_cvt_f32_i32 v103, v103
  v_pk_mul_f32 v[20:21], v[100:101], v[22:23]
  v_pk_add_f32 v[18:19], v[22:23], v[24:25]
  v_pk_fma_f32 v[20:21], v[102:103], v[24:25], v[20:21]
  v_add_f32 v18, v18, v19
  v_add_f32 v20, v20, v21
  s_cmpk_gt_i32 s69, 0x2d
  s_cbranch_scc1 L_p61_4
  s_cmpk_gt_i32 s69, 0x19
  s_cbranch_scc1 L_p61_3
  s_cmpk_gt_i32 s69, 0xffc9
  s_cbranch_scc1 L_p61_0
  s_waitcnt vmcnt(6)
L_p61_0:
  s_waitcnt vmcnt(7)
L_p61_3:
  s_waitcnt vmcnt(11)
L_p61_4:
  s_waitcnt vmcnt(12)
  buffer_load_dwordx4 v[88:91], v217, s[36:39], 0 offen nt
L_qn:
  s_waitcnt lgkmcnt(0)
  v_readfirstlane_b32 s46, v4
  s_cmp_ge_u32 s46, s47
  s_cbranch_scc1 L_qn_ok
  s_cmp_eq_u32 s94, 0
  s_cbranch_scc1 L_qn_ok
  s_sub_u32 s94, s94, 1
  ds_read_b32 v4, v14 offset:16
  s_branch L_qn
L_qn_ok:
  s_waitcnt vmcnt(8)
  s_add_u32 s44, s78, 0x03030303
  v_msad_u8 v9, s78, v40, 0
  v_msad_u8 v10, s44, v40, 0
  v_msad_u8 v9, s78, v41, v9
  v_msad_u8 v10, s44, v41, v10
  v_msad_u8 v9, s78, v42, v9
  v_msad_u8 v10, s44, v42, v10
  s_mov_b64 exec, 3
  global_store_byte v7, v8, s[30:31]
  global_load_dwordx3 v[40:42], v239, s[30:31] sc1
  v_sub_u32 v9, v9, v10
  v_add3_u32 v10, v26, v27, s58
  v_add_u32 v8, 1, v8
  s_mov_b64 exec, -1
  v_readlane_b32 s66, v9, 0
  v_readlane_b32 s67, v9, 1
  v_readlane_b32 s91, v10, 0
  s_add_u32 s78, s78, 0x01010101
  s_lshl1_add_u32 s69, s91, s95
  s_add_u32 s95, s66, s67
  s_add_u32 s69, s69, s95
  v_dot2_f32_bf16 v22, v197, v44, 0
  v_add_f32_dpp v34, v18, v18 row_ror:8 row_mask:0xf bank_mask:0xc
  v_add_f32_dpp v34, v20, v20 row_ror:8 row_mask:0xf bank_mask:0x3
  v_dot2_f32_bf16 v23, v202, v45, 0
  v_dot2_f32_bf16 v24, v200, v46, 0
  v_dot2_f32_bf16 v25, v203, v47, 0
  v_cvt_f32_i32 v104, v104
  v_cvt_f32_i32 v105, v105
  v_cvt_f32_i32 v106, v106
  v_cvt_f32_i32 v107, v107
  ds_read_b128 v[44:47], v15 offset:512
  v_pk_mul_f32 v[20:21], v[104:105], v[22:23]
  v_pk_add_f32 v[18:19], v[22:23], v[24:25]
  v_pk_fma_f32 v[20:21], v[106:107], v[24:25], v[20:21]
  v_add_f32 v18, v18, v19
  v_add_f32 v20, v20, v21
  s_cmpk_gt_i32 s69, 0x2d
  s_cbranch_scc1 L_p62_4
  s_cmpk_gt_i32 s69, 0xffe9
  s_cbranch_scc1 L_p62_1
  s_waitcnt vmcnt(5)
L_p62_1:
  s_waitcnt vmcnt(8)
L_p62_4:
  s_waitcnt vmcnt(9)
  buffer_load_dwordx4 v[92:95], v218, s[36:39], 0 offen nt
  v_dot2_f32_bf16 v22, v201, v48, 0
  v_add_f32_dpp v21, v18, v18 row_ror:8 row_mask:0xf bank_mask:0xc
  v_add_f32_dpp v21, v20, v20 row_ror:8 row_mask:0xf bank_mask:0x3
  v_add_f32_dpp v20, v34, v34 row_half_mirror row_mask:0xf bank_mask:0x5
  v_dot2_f32_bf16 v23, v206, v49, 0
  v_add_f32_dpp v20, v21, v21 row_half_mirror row_mask:0xf bank_mask:0xa
  v_dot2_f32_bf16 v24, v204, v50, 0
  v_dot2_f32_bf16 v25, v207, v51, 0
  v_add_f32_dpp v20, v20, v20 quad_perm:[2,3,0,1] row_mask:0xf bank_mask:0xf
  v_cvt_f32_i32 v108, v108
  v_cvt_f32_i32 v109, v109
  v_add_f32_dpp v20, v20, v20 quad_perm:[1,0,3,2] row_mask:0xf bank_mask:0xf
  v_cndmask_b32_e64 v32, v32, v20, s[52:53]
  v_cvt_f32_i32 v110, v110
  v_cvt_f32_i32 v111, v111
  ds_read_b128 v[48:51], v16 offset:512
  v_pk_mul_f32 v[20:21], v[108:109], v[22:23]
  v_pk_add_f32 v[18:19], v[22:23], v[24:25]
  v_pk_fma_f32 v[20:21], v[110:111], v[24:25], v[20:21]
  v_add_f32 v18, v18, v19
  v_add_f32 v20, v20, v21
  s_cmpk_gt_i32 s69, 0x2d
  s_cbranch_scc1 L_p63_4
  s_cmpk_gt_i32 s69, 0x7
  s_cbranch_scc1 L_p63_2
  s_waitcnt vmcnt(6)
L_p63_2:
  s_waitcnt vmcnt(9)
L_p63_4:
  s_waitcnt vmcnt(10)
  buffer_load_dwordx4 v[96:99], v219, s[36:39], 0 offen nt
  v_dot2_f32_bf16 v22, v205, v52, 0
  v_add_f32_dpp v34, v18, v18 row_ror:8 row_mask:0xf bank_mask:0xc
  v_add_f32_dpp v34, v20, v20 row_ror:8 row_mask:0xf bank_mask:0x3
  v_dot2_f32_bf16 v23, v210, v53, 0
  v_dot2_f32_bf16 v24, v208, v54, 0
  v_dot2_f32_bf16 v25, v211, v55, 0
  v_cvt_f32_i32 v112, v112
  v_cvt_f32_i32 v113, v113
  v_cvt_f32_i32 v114, v114
  v_cvt_f32_i32 v115, v115
  ds_read_b128 v[52:55], v17 offset:512
  v_pk_mul_f32 v[20:21], v[112:113], v[22:23]
  v_pk_add_f32 v[18:19], v[22:23], v[24:25]
  v_pk_fma_f32 v[20:21], v[114:115], v[24:25], v[20:21]
  v_add_f32 v18, v18, v19
  v_add_f32 v20, v20, v21
  s_cmpk_gt_i32 s69, 0x2d
  s_cbranch_scc1 L_p64_4
  s_cmpk_gt_i32 s69, 0x19
  s_cbranch_scc1 L_p64_3
  s_cmpk_gt_i32 s69, 0xffc9
  s_cbranch_scc1 L_p64_0
  s_waitcnt vmcnt(6)
L_p64_0:
  s_waitcnt vmcnt(7)
L_p64_3:
  s_waitcnt vmcnt(10)
L_p64_4:
  s_waitcnt vmcnt(11)
  buffer_load_dwordx4 v[100:103], v220, s[36:39], 0 offen nt
  s_nop 0
  v_add_f32_dpp v21, v18, v18 row_ror:8 row_mask:0xf bank_mask:0xc
  v_add_f32_dpp v21, v20, v20 row_ror:8 row_mask:0xf bank_mask:0x3
  v_add_f32_dpp v20, v34, v34 row_half_mirror row_mask:0xf bank_mask:0x5
  s_nop 0
  v_add_f32_dpp v20, v21, v21 row_half_mirror row_mask:0xf bank_mask:0xa
  s_nop 1
  v_add_f32_dpp v20, v20, v20 quad_perm:[2,3,0,1] row_mask:0xf bank_mask:0xf
  s_nop 1
  v_add_f32_dpp v20, v20, v20 quad_perm:[1,0,3,2] row_mask:0xf bank_mask:0xf
  v_cndmask_b32_e64 v32, v32, v20, s[54:55]
  ds_write_b32 v2, v32 offset:1024
  s_add_u32 s43, s43, 1
  v_mov_b32 v4, s43
  ds_write_b32 v6, v4 offset:0
  s_mov_b64 s[32:33], s[36:37]
  s_add_u32 s68, s43, 1
  s_sub_u32 s45, s68, 16
  s_lshl_b32 s46, s45, 2
  s_lshr_b64 s[64:65], s[92:93], s46
  s_and_b32 s46, s64, 15
  s_cmp_lt_u32 s68, 16
  s_cselect_b32 s68, s68, s46
  s_cselect_b32 s70, s6, s12
  s_cselect_b32 s71, s7, s13
  s_lshl_b32 s44, s68, 2
  s_lshr_b64 s[64:65], s[96:97], s44
  s_and_b32 s64, s64, 15
  s_lshl4_add_u32 s68, s68, s64
  s_mul_i32 s44, s68, 1572864
  s_add_u32 s36, s70, s44
  s_addc_u32 s37, s71, 0
  s_cmp_lt_u32 s43, 16
  s_cbranch_scc1 L_k
L_vpre:
  v_lshrrev_b32 v116, 4, v0
  v_and_b32 v119, 15, v0
  v_and_or_b32 v120, v0, 7, 16
  v_lshl_add_u32 v119, v119, 4, v116
  v_mul_u32_u24 v119, 683, v119
  v_lshrrev_b32 v119, 11, v119
  v_lshlrev_b32 v119, 2, v119
  v_lshl_add_u32 v120, v120, 4, v116
  v_mul_u32_u24 v120, 683, v120
  v_lshrrev_b32 v120, 11, v120
  v_lshlrev_b32 v120, 2, v120
  s_mov_b64 vcc, 0
  s_mov_b32 s43, 0
  s_lshl_b32 s68, s43, 2
  s_lshr_b64 s[64:65], s[92:93], s68
  s_and_b32 s68, s64, 15
  s_add_u32 s47, s68, 1
  ds_read_b32 v4, v14 offset:20
L_a0:
  s_waitcnt lgkmcnt(0)
  v_readfirstlane_b32 s46, v4
  s_cmp_ge_u32 s46, s47
  s_cbranch_scc1 L_a0_ok
  s_cmp_eq_u32 s94, 0
  s_cbranch_scc1 L_a0_ok
  s_sub_u32 s94, s94, 1
  ds_read_b32 v4, v14 offset:20
  s_branch L_a0
L_a0_ok:
  v_lshl_add_u32 v121, s68, 9, v119
  v_lshl_add_u32 v122, s68, 9, v120
  ds_read_b32 v116, v121 offset:37376
  ds_read_b32 v117, v122 offset:37376
.p2align 6
L_v:
  s_add_u32 s45, s43, 1
  s_min_u32 s45, s45, 15
  s_lshl_b32 s68, s45, 2
  s_lshr_b64 s[64:65], s[92:93], s68
  s_and_b32 s68, s64, 15
  s_add_u32 s47, s68, 1
  v_lshl_add_u32 v121, s68, 9, v119
  v_lshl_add_u32 v122, s68, 9, v120
  s_waitcnt lgkmcnt(0)
  s_waitcnt vmcnt(8)
  s_add_u32 s44, s78, 0x03030303
  v_msad_u8 v9, s78, v36, 0
  v_msad_u8 v10, s44, v36, 0
  v_msad_u8 v9, s78, v37, v9
  v_msad_u8 v10, s44, v37, v10
  v_msad_u8 v9, s78, v38, v9
  v_msad_u8 v10, s44, v38, v10
  s_mov_b64 exec, 3
  global_store_byte v7, v8, s[30:31]
  global_load_dwordx3 v[36:38], v236, s[30:31] sc1
  v_sub_u32 v9, v9, v10
  v_add_u32 v8, 1, v8
  s_mov_b64 exec, -1
  v_readlane_b32 s66, v9, 0
  v_readlane_b32 s67, v9, 1
  s_add_u32 s78, s78, 0x01010101
  s_lshl1_add_u32 s69, s91, s95
  s_add_u32 s95, s66, s67
  s_add_u32 s69, s69, s95
  v_mov_b32_dpp v18, v116 row_newbcast:0 row_mask:0xf bank_mask:0xf
  v_cvt_f32_i32 v68, v68
  v_cvt_f32_i32 v69, v69
  v_cvt_f32_i32 v70, v70
  v_cvt_f32_i32 v71, v71
  v_pk_mul_f32 v[44:45], v[68:69], v[18:19] op_sel_hi:[1,0]
  v_pk_mul_f32 v[46:47], v[70:71], v[18:19] op_sel_hi:[1,0]
  s_cmpk_gt_i32 s69, 0x35
  s_cbranch_scc1 L_p65_4
  s_cmpk_gt_i32 s69, 0xfff1
  s_cbranch_scc1 L_p65_1
  s_waitcnt vmcnt(5)
L_p65_1:
  s_waitcnt vmcnt(8)
L_p65_4:
  s_waitcnt vmcnt(9)
  buffer_load_dwordx4 v[104:107], v221, s[32:35], 0 offen nt
  v_mov_b32_dpp v18, v116 row_newbcast:1 row_mask:0xf bank_mask:0xf
  v_cvt_f32_i32 v72, v72
  v_cvt_f32_i32 v73, v73
  v_cvt_f32_i32 v74, v74
  v_cvt_f32_i32 v75, v75
  v_pk_mul_f32 v[48:49], v[72:73], v[18:19] op_sel_hi:[1,0]
  v_pk_mul_f32 v[50:51], v[74:75], v[18:19] op_sel_hi:[1,0]
  s_cmpk_gt_i32 s69, 0x35
  s_cbranch_scc1 L_p66_4
  s_cmpk_gt_i32 s69, 0xf
  s_cbranch_scc1 L_p66_2
  s_waitcnt vmcnt(6)
L_p66_2:
  s_waitcnt vmcnt(9)
L_p66_4:
  s_waitcnt vmcnt(10)
  buffer_load_dwordx4 v[108:111], v222, s[32:35], 0 offen nt
  v_mov_b32_dpp v18, v116 row_newbcast:2 row_mask:0xf bank_mask:0xf
  v_cvt_f32_i32 v76, v76
  v_cvt_f32_i32 v77, v77
  v_cvt_f32_i32 v78, v78
  v_cvt_f32_i32 v79, v79
  v_pk_mul_f32 v[52:53], v[76:77], v[18:19] op_sel_hi:[1,0]
  v_pk_mul_f32 v[54:55], v[78:79], v[18:19] op_sel_hi:[1,0]
  s_cmpk_gt_i32 s69, 0x35
  s_cbranch_scc1 L_p67_4
  s_cmpk_gt_i32 s69, 0x21
  s_cbranch_scc1 L_p67_3
  s_cmpk_gt_i32 s69, 0xffd1
  s_cbranch_scc1 L_p67_0
  s_waitcnt vmcnt(6)
L_p67_0:
  s_waitcnt vmcnt(7)
L_p67_3:
  s_waitcnt vmcnt(10)
L_p67_4:
  s_waitcnt vmcnt(11)
  buffer_load_dwordx4 v[112:115], v223, s[32:35], 0 offen nt
  s_waitcnt vmcnt(8)
  s_add_u32 s44, s78, 0x03030303
  v_msad_u8 v9, s78, v40, 0
  v_msad_u8 v10, s44, v40, 0
  v_msad_u8 v9, s78, v41, v9
  v_msad_u8 v10, s44, v41, v10
  v_msad_u8 v9, s78, v42, v9
  v_msad_u8 v10, s44, v42, v10
  s_mov_b64 exec, 3
  global_store_byte v7, v8, s[30:31]
  global_load_dwordx3 v[40:42], v237, s[30:31] sc1
  v_sub_u32 v9, v9, v10
  v_add_u32 v8, 1, v8
  s_mov_b64 exec, -1
  v_readlane_b32 s66, v9, 0
  v_readlane_b32 s67, v9, 1
  s_add_u32 s78, s78, 0x01010101
  s_lshl1_add_u32 s69, s91, s95
  s_add_u32 s95, s66, s67
  s_add_u32 s69, s69, s95
  v_mov_b32_dpp v18, v116 row_newbcast:3 row_mask:0xf bank_mask:0xf
  v_cvt_f32_i32 v80, v80
  v_cvt_f32_i32 v81, v81
  v_cvt_f32_i32 v82, v82
  v_cvt_f32_i32 v83, v83
  v_pk_fma_f32 v[44:45], v[80:81], v[18:19], v[44:45] op_sel_hi:[1,0,1]
  v_pk_fma_f32 v[46:47], v[82:83], v[18:19], v[46:47] op_sel_hi:[1,0,1]
  s_cmpk_gt_i32 s69, 0x35
  s_cbranch_scc1 L_p68_4
  s_cmpk_gt_i32 s69, 0xfff1
  s_cbranch_scc1 L_p68_1
  s_waitcnt vmcnt(5)
L_p68_1:
  s_waitcnt vmcnt(8)
L_p68_4:
  s_waitcnt vmcnt(9)
  buffer_load_dwordx4 v[68:71], v224, s[32:35], 0 offen nt
  v_mov_b32_dpp v18, v116 row_newbcast:4 row_mask:0xf bank_mask:0xf
  v_cvt_f32_i32 v84, v84
  v_cvt_f32_i32 v85, v85
  v_cvt_f32_i32 v86, v86
  v_cvt_f32_i32 v87, v87
  v_pk_fma_f32 v[48:49], v[84:85], v[18:19], v[48:49] op_sel_hi:[1,0,1]
  v_pk_fma_f32 v[50:51], v[86:87], v[18:19], v[50:51] op_sel_hi:[1,0,1]
  s_cmpk_gt_i32 s69, 0x35
  s_cbranch_scc1 L_p69_4
  s_cmpk_gt_i32 s69, 0xf
  s_cbranch_scc1 L_p69_2
  s_waitcnt vmcnt(6)
L_p69_2:
  s_waitcnt vmcnt(9)
L_p69_4:
  s_waitcnt vmcnt(10)
  buffer_load_dwordx4 v[72:75], v225, s[32:35], 0 offen nt
  v_mov_b32_dpp v18, v116 row_newbcast:5 row_mask:0xf bank_mask:0xf
  v_cvt_f32_i32 v88, v88
  v_cvt_f32_i32 v89, v89
  v_cvt_f32_i32 v90, v90
  v_cvt_f32_i32 v91, v91
  v_pk_fma_f32 v[52:53], v[88:89], v[18:19], v[52:53] op_sel_hi:[1,0,1]
  v_pk_fma_f32 v[54:55], v[90:91], v[18:19], v[54:55] op_sel_hi:[1,0,1]
  s_cmpk_gt_i32 s69, 0x35
  s_cbranch_scc1 L_p70_4
  s_cmpk_gt_i32 s69, 0x21
  s_cbranch_scc1 L_p70_3
  s_cmpk_gt_i32 s69, 0xffd1
  s_cbranch_scc1 L_p70_0
  s_waitcnt vmcnt(6)
L_p70_0:
  s_waitcnt vmcnt(7)
L_p70_3:
  s_waitcnt vmcnt(10)
L_p70_4:
  s_waitcnt vmcnt(11)
  buffer_load_dwordx4 v[76:79], v226, s[32:35], 0 offen nt
  v_add_u32_e64 v9, s43, 16
  ds_write_b32 v14, v9 offset:28
  s_waitcnt vmcnt(8)
  s_add_u32 s44, s78, 0x03030303
  v_msad_u8 v9, s78, v36, 0
  v_msad_u8 v10, s44, v36, 0
  v_msad_u8 v9, s78, v37, v9
  v_msad_u8 v10, s44, v37, v10
  v_msad_u8 v9, s78, v38, v9
  v_msad_u8 v10, s44, v38, v10
  s_mov_b64 exec, 3
  global_store_byte v7, v8, s[30:31]
  global_load_dwordx3 v[36:38], v238, s[30:31] sc1
  v_sub_u32 v9, v9, v10
  v_add_u32 v8, 1, v8
  s_mov_b64 exec, -1
  v_readlane_b32 s66, v9, 0
  v_readlane_b32 s67, v9, 1
  s_add_u32 s78, s78, 0x01010101
  s_lshl1_add_u32 s69, s91, s95
  s_add_u32 s95, s66, s67
  s_add_u32 s69, s69, s95
  v_mov_b32_dpp v18, v116 row_newbcast:6 row_mask:0xf bank_mask:0xf
  v_cvt_f32_i32 v92, v92
  v_cvt_f32_i32 v93, v93
  v_cvt_f32_i32 v94, v94
  v_cvt_f32_i32 v95, v95
  v_pk_fma_f32 v[44:45], v[92:93], v[18:19], v[44:45] op_sel_hi:[1,0,1]
  v_pk_fma_f32 v[46:47], v[94:95], v[18:19], v[46:47] op_sel_hi:[1,0,1]
  s_cmpk_gt_i32 s69, 0x35
  s_cbranch_scc1 L_p71_4
  s_cmpk_gt_i32 s69, 0xfff1
  s_cbranch_scc1 L_p71_1
  s_waitcnt vmcnt(5)
L_p71_1:
  s_waitcnt vmcnt(8)
L_p71_4:
  s_waitcnt vmcnt(9)
  buffer_load_dwordx4 v[80:83], v227, s[32:35], 0 offen nt
  v_mov_b32_dpp v18, v116 row_newbcast:7 row_mask:0xf bank_mask:0xf
  v_cvt_f32_i32 v96, v96
  v_cvt_f32_i32 v97, v97
  v_cvt_f32_i32 v98, v98
  v_cvt_f32_i32 v99, v99
  v_pk_fma_f32 v[48:49], v[96:97], v[18:19], v[48:49] op_sel_hi:[1,0,1]
  v_pk_fma_f32 v[50:51], v[98:99], v[18:19], v[50:51] op_sel_hi:[1,0,1]
  s_cmpk_gt_i32 s69, 0x35
  s_cbranch_scc1 L_p72_4
  s_cmpk_gt_i32 s69, 0xf
  s_cbranch_scc1 L_p72_2
  s_waitcnt vmcnt(6)
L_p72_2:
  s_waitcnt vmcnt(9)
L_p72_4:
  s_waitcnt vmcnt(10)
  buffer_load_dwordx4 v[84:87], v228, s[32:35], 0 offen nt
  v_mov_b32_dpp v18, v116 row_newbcast:8 row_mask:0xf bank_mask:0xf
  v_cvt_f32_i32 v100, v100
  v_cvt_f32_i32 v101, v101
  v_cvt_f32_i32 v102, v102
  v_cvt_f32_i32 v103, v103
  v_pk_fma_f32 v[52:53], v[100:101], v[18:19], v[52:53] op_sel_hi:[1,0,1]
  v_pk_fma_f32 v[54:55], v[102:103], v[18:19], v[54:55] op_sel_hi:[1,0,1]
  s_cmpk_gt_i32 s69, 0x35
  s_cbranch_scc1 L_p73_4
  s_cmpk_gt_i32 s69, 0x21
  s_cbranch_scc1 L_p73_3
  s_cmpk_gt_i32 s69, 0xffd1
  s_cbranch_scc1 L_p73_0
  s_waitcnt vmcnt(6)
L_p73_0:
  s_waitcnt vmcnt(7)
L_p73_3:
  s_waitcnt vmcnt(10)
L_p73_4:
  s_waitcnt vmcnt(11)
  buffer_load_dwordx4 v[88:91], v229, s[32:35], 0 offen nt
  s_waitcnt vmcnt(8)
  s_add_u32 s44, s78, 0x03030303
  v_msad_u8 v9, s78, v40, 0
  v_msad_u8 v10, s44, v40, 0
  v_msad_u8 v9, s78, v41, v9
  v_msad_u8 v10, s44, v41, v10
  v_msad_u8 v9, s78, v42, v9
  v_msad_u8 v10, s44, v42, v10
  s_mov_b64 exec, 3
  global_store_byte v7, v8, s[30:31]
  global_load_dwordx3 v[40:42], v239, s[30:31] sc1
  v_sub_u32 v9, v9, v10
  v_add_u32 v8, 1, v8
  s_mov_b64 exec, -1
  v_readlane_b32 s66, v9, 0
  v_readlane_b32 s67, v9, 1
  s_add_u32 s78, s78, 0x01010101
  s_lshl1_add_u32 s69, s91, s95
  s_add_u32 s95, s66, s67
  s_add_u32 s69, s69, s95
  v_mov_b32_dpp v18, v116 row_newbcast:9 row_mask:0xf bank_mask:0xf
  v_cvt_f32_i32 v104, v104
  v_cvt_f32_i32 v105, v105
  v_cvt_f32_i32 v106, v106
  v_cvt_f32_i32 v107, v107
  v_pk_fma_f32 v[44:45], v[104:105], v[18:19], v[44:45] op_sel_hi:[1,0,1]
  v_pk_fma_f32 v[46:47], v[106:107], v[18:19], v[46:47] op_sel_hi:[1,0,1]
  s_cmpk_gt_i32 s69, 0x35
  s_cbranch_scc1 L_p74_4
  s_cmpk_gt_i32 s69, 0xfff1
  s_cbranch_scc1 L_p74_1
  s_waitcnt vmcnt(5)
L_p74_1:
  s_waitcnt vmcnt(8)
L_p74_4:
  s_waitcnt vmcnt(9)
  buffer_load_dwordx4 v[92:95], v230, s[32:35], 0 offen nt
  v_mov_b32_dpp v18, v116 row_newbcast:10 row_mask:0xf bank_mask:0xf
  v_cvt_f32_i32 v108, v108
  v_cvt_f32_i32 v109, v109
  v_cvt_f32_i32 v110, v110
  v_cvt_f32_i32 v111, v111
  v_pk_fma_f32 v[48:49], v[108:109], v[18:19], v[48:49] op_sel_hi:[1,0,1]
  v_pk_fma_f32 v[50:51], v[110:111], v[18:19], v[50:51] op_sel_hi:[1,0,1]
  s_cmpk_gt_i32 s69, 0x35
  s_cbranch_scc1 L_p75_4
  s_cmpk_gt_i32 s69, 0xf
  s_cbranch_scc1 L_p75_2
  s_waitcnt vmcnt(6)
L_p75_2:
  s_waitcnt vmcnt(9)
L_p75_4:
  s_waitcnt vmcnt(10)
  buffer_load_dwordx4 v[96:99], v231, s[32:35], 0 offen nt
  v_mov_b32_dpp v18, v116 row_newbcast:11 row_mask:0xf bank_mask:0xf
  v_cvt_f32_i32 v112, v112
  v_cvt_f32_i32 v113, v113
  v_cvt_f32_i32 v114, v114
  v_cvt_f32_i32 v115, v115
  v_pk_fma_f32 v[52:53], v[112:113], v[18:19], v[52:53] op_sel_hi:[1,0,1]
  v_pk_fma_f32 v[54:55], v[114:115], v[18:19], v[54:55] op_sel_hi:[1,0,1]
  s_cmpk_gt_i32 s69, 0x35
  s_cbranch_scc1 L_p76_4
  s_cmpk_gt_i32 s69, 0x21
  s_cbranch_scc1 L_p76_3
  s_cmpk_gt_i32 s69, 0xffd1
  s_cbranch_scc1 L_p76_0
  s_waitcnt vmcnt(6)
L_p76_0:
  s_waitcnt vmcnt(7)
L_p76_3:
  s_waitcnt vmcnt(10)
L_p76_4:
  s_waitcnt vmcnt(11)
  buffer_load_dwordx4 v[100:103], v232, s[32:35], 0 offen nt
  s_waitcnt vmcnt(8)
  s_add_u32 s44, s78, 0x03030303
  v_msad_u8 v9, s78, v36, 0
  v_msad_u8 v10, s44, v36, 0
  v_msad_u8 v9, s78, v37, v9
  v_msad_u8 v10, s44, v37, v10
  v_msad_u8 v9, s78, v38, v9
  v_msad_u8 v10, s44, v38, v10
  s_mov_b64 exec, 3
  global_store_byte v7, v8, s[30:31]
  global_load_dwordx3 v[36:38], v236, s[30:31] sc1
  v_sub_u32 v9, v9, v10
  v_add_u32 v8, 1, v8
  s_mov_b64 exec, -1
  v_readlane_b32 s66, v9, 0
  v_readlane_b32 s67, v9, 1
  s_add_u32 s78, s78, 0x01010101
  s_lshl1_add_u32 s69, s91, s95
  s_add_u32 s95, s66, s67
  s_add_u32 s69, s69, s95
  v_mov_b32_dpp v18, v116 row_newbcast:12 row_mask:0xf bank_mask:0xf
  v_cvt_f32_i32 v68, v68
  v_cvt_f32_i32 v69, v69
  v_cvt_f32_i32 v70, v70
  v_cvt_f32_i32 v71, v71
  v_pk_fma_f32 v[44:45], v[68:69], v[18:19], v[44:45] op_sel_hi:[1,0,1]
  v_pk_fma_f32 v[46:47], v[70:71], v[18:19], v[46:47] op_sel_hi:[1,0,1]
  s_cmpk_gt_i32 s69, 0x35
  s_cbranch_scc1 L_p77_4
  s_cmpk_gt_i32 s69, 0xfff1
  s_cbranch_scc1 L_p77_1
  s_waitcnt vmcnt(5)
L_p77_1:
  s_waitcnt vmcnt(8)
L_p77_4:
  s_waitcnt vmcnt(9)
  buffer_load_dwordx4 v[104:107], v233, s[32:35], 0 offen nt
  v_mov_b32_dpp v18, v116 row_newbcast:13 row_mask:0xf bank_mask:0xf
  v_cvt_f32_i32 v72, v72
  v_cvt_f32_i32 v73, v73
  v_cvt_f32_i32 v74, v74
  v_cvt_f32_i32 v75, v75
  v_pk_fma_f32 v[48:49], v[72:73], v[18:19], v[48:49] op_sel_hi:[1,0,1]
  v_pk_fma_f32 v[50:51], v[74:75], v[18:19], v[50:51] op_sel_hi:[1,0,1]
  s_cmpk_gt_i32 s69, 0x35
  s_cbranch_scc1 L_p78_4
  s_cmpk_gt_i32 s69, 0xf
  s_cbranch_scc1 L_p78_2
  s_waitcnt vmcnt(6)
L_p78_2:
  s_waitcnt vmcnt(9)
L_p78_4:
  s_waitcnt vmcnt(10)
  buffer_load_dwordx4 v[108:111], v234, s[32:35], 0 offen nt
  v_mov_b32_dpp v18, v116 row_newbcast:14 row_mask:0xf bank_mask:0xf
  v_cvt_f32_i32 v76, v76
  v_cvt_f32_i32 v77, v77
  v_cvt_f32_i32 v78, v78
  v_cvt_f32_i32 v79, v79
  v_pk_fma_f32 v[52:53], v[76:77], v[18:19], v[52:53] op_sel_hi:[1,0,1]
  v_pk_fma_f32 v[54:55], v[78:79], v[18:19], v[54:55] op_sel_hi:[1,0,1]
  s_cmpk_gt_i32 s69, 0x35
  s_cbranch_scc1 L_p79_4
  s_cmpk_gt_i32 s69, 0x21
  s_cbranch_scc1 L_p79_3
  s_cmpk_gt_i32 s69, 0xffd1
  s_cbranch_scc1 L_p79_0
  s_waitcnt vmcnt(6)
L_p79_0:
  s_waitcnt vmcnt(7)
L_p79_3:
  s_waitcnt vmcnt(10)
L_p79_4:
  s_waitcnt vmcnt(11)
  buffer_load_dwordx4 v[112:115], v235, s[32:35], 0 offen nt
  s_cbranch_vccnz L_vtail
  ds_read_b32 v4, v14 offset:20
  s_waitcnt vmcnt(8)
  s_add_u32 s44, s78, 0x03030303
  v_msad_u8 v9, s78, v40, 0
  v_msad_u8 v10, s44, v40, 0
  v_msad_u8 v9, s78, v41, v9
  v_msad_u8 v10, s44, v41, v10
  v_msad_u8 v9, s78, v42, v9
  v_msad_u8 v10, s44, v42, v10
  s_mov_b64 exec, 3
  global_load_dwordx2 v[26:27], v11, s[30:31] sc1
  global_store_byte v7, v8, s[30:31]
  global_load_dwordx3 v[40:42], v237, s[30:31] sc1
  v_sub_u32 v9, v9, v10
  v_add_u32 v8, 1, v8
  s_mov_b64 exec, -1
  v_readlane_b32 s66, v9, 0
  v_readlane_b32 s67, v9, 1
  s_add_u32 s78, s78, 0x01010101
  s_lshl1_add_u32 s69, s91, s95
  s_add_u32 s95, s66, s67
  s_add_u32 s69, s69, s95
  v_mov_b32_dpp v18, v116 row_newbcast:15 row_mask:0xf bank_mask:0xf
  v_cvt_f32_i32 v80, v80
  v_cvt_f32_i32 v81, v81
  v_cvt_f32_i32 v82, v82
  v_cvt_f32_i32 v83, v83
  v_pk_fma_f32 v[44:45], v[80:81], v[18:19], v[44:45] op_sel_hi:[1,0,1]
  v_pk_fma_f32 v[46:47], v[82:83], v[18:19], v[46:47] op_sel_hi:[1,0,1]
  s_cmpk_gt_i32 s69, 0x35
  s_cbranch_scc1 L_p80_4
  s_cmpk_gt_i32 s69, 0xfff1
  s_cbranch_scc1 L_p80_1
  s_waitcnt vmcnt(6)
L_p80_1:
  s_waitcnt vmcnt(9)
L_p80_4:
  s_waitcnt vmcnt(10)
  buffer_load_dwordx4 v[68:71], v212, s[36:39], 0 offen nt
  v_mov_b32_dpp v18, v117 row_newbcast:0 row_mask:0xf bank_mask:0xf
  v_cvt_f32_i32 v84, v84
  v_cvt_f32_i32 v85, v85
  v_cvt_f32_i32 v86, v86
  v_cvt_f32_i32 v87, v87
  v_pk_fma_f32 v[48:49], v[84:85], v[18:19], v[48:49] op_sel_hi:[1,0,1]
  v_pk_fma_f32 v[50:51], v[86:87], v[18:19], v[50:51] op_sel_hi:[1,0,1]
  s_cmpk_gt_i32 s69, 0x35
  s_cbranch_scc1 L_p81_4
  s_cmpk_gt_i32 s69, 0xf
  s_cbranch_scc1 L_p81_2
  s_waitcnt vmcnt(7)
L_p81_2:
  s_waitcnt vmcnt(10)
L_p81_4:
  s_waitcnt vmcnt(11)
  buffer_load_dwordx4 v[72:75], v213, s[36:39], 0 offen nt
  v_mov_b32_dpp v18, v117 row_newbcast:1 row_mask:0xf bank_mask:0xf
  v_cvt_f32_i32 v88, v88
  v_cvt_f32_i32 v89, v89
  v_cvt_f32_i32 v90, v90
  v_cvt_f32_i32 v91, v91
  v_pk_fma_f32 v[52:53], v[88:89], v[18:19], v[52:53] op_sel_hi:[1,0,1]
  v_pk_fma_f32 v[54:55], v[90:91], v[18:19], v[54:55] op_sel_hi:[1,0,1]
  s_cmpk_gt_i32 s69, 0x35
  s_cbranch_scc1 L_p82_4
  s_cmpk_gt_i32 s69, 0x21
  s_cbranch_scc1 L_p82_3
  s_cmpk_gt_i32 s69, 0xffd1
  s_cbranch_scc1 L_p82_0
  s_waitcnt vmcnt(7)
L_p82_0:
  s_waitcnt vmcnt(8)
L_p82_3:
  s_waitcnt vmcnt(11)
L_p82_4:
  s_waitcnt vmcnt(12)
  buffer_load_dwordx4 v[76:79], v214, s[36:39], 0 offen nt
L_an:
  s_waitcnt lgkmcnt(0)
  v_readfirstlane_b32 s46, v4
  s_cmp_ge_u32 s46, s47
  s_cbranch_scc1 L_an_ok
  s_cmp_eq_u32 s94, 0
  s_cbranch_scc1 L_an_ok
  s_sub_u32 s94, s94, 1
  ds_read_b32 v4, v14 offset:20
  s_branch L_an
L_an_ok:
  ds_read_b32 v116, v121 offset:37376
  ds_read_b32 v118, v122 offset:37376
  v_add_u32_e64 v9, s43, 16
  ds_write_b32 v14, v9 offset:24
  s_waitcnt vmcnt(9)
  s_add_u32 s44, s78, 0x03030303
  v_msad_u8 v9, s78, v36, 0
  v_msad_u8 v10, s44, v36, 0
  v_msad_u8 v9, s78, v37, v9
  v_msad_u8 v10, s44, v37, v10
  v_msad_u8 v9, s78, v38, v9
  v_msad_u8 v10, s44, v38, v10
  s_mov_b64 exec, 3
  global_store_byte v7, v8, s[30:31]
  global_load_dwordx3 v[36:38], v238, s[30:31] sc1
  v_sub_u32 v9, v9, v10
  v_add_u32 v8, 1, v8
  s_mov_b64 exec, -1
  v_readlane_b32 s66, v9, 0
  v_readlane_b32 s67, v9, 1
  s_add_u32 s78, s78, 0x01010101
  s_lshl1_add_u32 s69, s91, s95
  s_add_u32 s95, s66, s67
  s_add_u32 s69, s69, s95
  v_mov_b32_dpp v18, v117 row_newbcast:2 row_mask:0xf bank_mask:0xf
  v_cvt_f32_i32 v92, v92
  v_cvt_f32_i32 v93, v93
  v_cvt_f32_i32 v94, v94
  v_cvt_f32_i32 v95, v95
  v_pk_fma_f32 v[44:45], v[92:93], v[18:19], v[44:45] op_sel_hi:[1,0,1]
  v_pk_fma_f32 v[46:47], v[94:95], v[18:19], v[46:47] op_sel_hi:[1,0,1]
  s_cmpk_gt_i32 s69, 0x35
  s_cbranch_scc1 L_p83_4
  s_cmpk_gt_i32 s69, 0xfff1
  s_cbranch_scc1 L_p83_1
  s_waitcnt vmcnt(5)
L_p83_1:
  s_waitcnt vmcnt(9)
L_p83_4:
  s_waitcnt vmcnt(10)
  buffer_load_dwordx4 v[80:83], v215, s[36:39], 0 offen nt
  v_mov_b32_dpp v18, v117 row_newbcast:3 row_mask:0xf bank_mask:0xf
  v_cvt_f32_i32 v96, v96
  v_cvt_f32_i32 v97, v97
  v_cvt_f32_i32 v98, v98
  v_cvt_f32_i32 v99, v99
  v_pk_fma_f32 v[48:49], v[96:97], v[18:19], v[48:49] op_sel_hi:[1,0,1]
  v_pk_fma_f32 v[50:51], v[98:99], v[18:19], v[50:51] op_sel_hi:[1,0,1]
  s_cmpk_gt_i32 s69, 0x35
  s_cbranch_scc1 L_p84_4
  s_cmpk_gt_i32 s69, 0xf
  s_cbranch_scc1 L_p84_2
  s_waitcnt vmcnt(6)
L_p84_2:
  s_waitcnt vmcnt(10)
L_p84_4:
  s_waitcnt vmcnt(11)
  buffer_load_dwordx4 v[84:87], v216, s[36:39], 0 offen nt
  v_mov_b32_dpp v18, v117 row_newbcast:4 row_mask:0xf bank_mask:0xf
  v_cvt_f32_i32 v100, v100
  v_cvt_f32_i32 v101, v101
  v_cvt_f32_i32 v102, v102
  v_cvt_f32_i32 v103, v103
  v_pk_fma_f32 v[52:53], v[100:101], v[18:19], v[52:53] op_sel_hi:[1,0,1]
  v_pk_fma_f32 v[54:55], v[102:103], v[18:19], v[54:55] op_sel_hi:[1,0,1]
  s_cmpk_gt_i32 s69, 0x35
  s_cbranch_scc1 L_p85_4
  s_cmpk_gt_i32 s69, 0x21
  s_cbranch_scc1 L_p85_3
  s_cmpk_gt_i32 s69, 0xffd1
  s_cbranch_scc1 L_p85_0
  s_waitcnt vmcnt(6)
L_p85_0:
  s_waitcnt vmcnt(7)
L_p85_3:
  s_waitcnt vmcnt(11)
L_p85_4:
  s_waitcnt vmcnt(12)
  buffer_load_dwordx4 v[88:91], v217, s[36:39], 0 offen nt
  s_waitcnt vmcnt(8)
  s_add_u32 s44, s78, 0x03030303
  v_msad_u8 v9, s78, v40, 0
  v_msad_u8 v10, s44, v40, 0
  v_msad_u8 v9, s78, v41, v9
  v_msad_u8 v10, s44, v41, v10
  v_msad_u8 v9, s78, v42, v9
  v_msad_u8 v10, s44, v42, v10
  s_mov_b64 exec, 3
  global_store_byte v7, v8, s[30:31]
  global_load_dwordx3 v[40:42], v239, s[30:31] sc1
  v_sub_u32 v9, v9, v10
  v_add3_u32 v10, v26, v27, s58
  v_add_u32 v8, 1, v8
  s_mov_b64 exec, -1
  v_readlane_b32 s66, v9, 0
  v_readlane_b32 s67, v9, 1
  v_readlane_b32 s91, v10, 0
  s_add_u32 s78, s78, 0x01010101
  s_lshl1_add_u32 s69, s91, s95
  s_add_u32 s95, s66, s67
  s_add_u32 s69, s69, s95
  v_mov_b32_dpp v18, v117 row_newbcast:5 row_mask:0xf bank_mask:0xf
  v_cvt_f32_i32 v104, v104
  v_cvt_f32_i32 v105, v105
  v_cvt_f32_i32 v106, v106
  v_cvt_f32_i32 v107, v107
  v_pk_fma_f32 v[44:45], v[104:105], v[18:19], v[44:45] op_sel_hi:[1,0,1]
  v_pk_fma_f32 v[46:47], v[106:107], v[18:19], v[46:47] op_sel_hi:[1,0,1]
  s_cmpk_gt_i32 s69, 0x35
  s_cbranch_scc1 L_p86_4
  s_cmpk_gt_i32 s69, 0xfff1
  s_cbranch_scc1 L_p86_1
  s_waitcnt vmcnt(5)
L_p86_1:
  s_waitcnt vmcnt(8)
L_p86_4:
  s_waitcnt vmcnt(9)
  buffer_load_dwordx4 v[92:95], v218, s[36:39], 0 offen nt
  v_mov_b32_dpp v18, v117 row_newbcast:6 row_mask:0xf bank_mask:0xf
  v_cvt_f32_i32 v108, v108
  v_cvt_f32_i32 v109, v109
  v_cvt_f32_i32 v110, v110
  v_cvt_f32_i32 v111, v111
  v_pk_fma_f32 v[48:49], v[108:109], v[18:19], v[48:49] op_sel_hi:[1,0,1]
  v_pk_fma_f32 v[50:51], v[110:111], v[18:19], v[50:51] op_sel_hi:[1,0,1]
  s_cmpk_gt_i32 s69, 0x35
  s_cbranch_scc1 L_p87_4
  s_cmpk_gt_i32 s69, 0xf
  s_cbranch_scc1 L_p87_2
  s_waitcnt vmcnt(6)
L_p87_2:
  s_waitcnt vmcnt(9)
L_p87_4:
  s_waitcnt vmcnt(10)
  buffer_load_dwordx4 v[96:99], v219, s[36:39], 0 offen nt
  v_mov_b32_dpp v18, v117 row_newbcast:7 row_mask:0xf bank_mask:0xf
  v_cvt_f32_i32 v112, v112
  v_cvt_f32_i32 v113, v113
  v_cvt_f32_i32 v114, v114
  v_cvt_f32_i32 v115, v115
  v_pk_fma_f32 v[52:53], v[112:113], v[18:19], v[52:53] op_sel_hi:[1,0,1]
  v_pk_fma_f32 v[54:55], v[114:115], v[18:19], v[54:55] op_sel_hi:[1,0,1]
  s_cmpk_gt_i32 s69, 0x35
  s_cbranch_scc1 L_p88_4
  s_cmpk_gt_i32 s69, 0x21
  s_cbranch_scc1 L_p88_3
  s_cmpk_gt_i32 s69, 0xffd1
  s_cbranch_scc1 L_p88_0
  s_waitcnt vmcnt(6)
L_p88_0:
  s_waitcnt vmcnt(7)
L_p88_3:
  s_waitcnt vmcnt(10)
L_p88_4:
  s_waitcnt vmcnt(11)
  buffer_load_dwordx4 v[100:103], v220, s[36:39], 0 offen nt
L_vred:
  s_add_u32 s43, s43, 1
  v_permlane32_swap_b32 v44, v46
  v_permlane32_swap_b32 v45, v47
  v_permlane32_swap_b32 v48, v50
  v_permlane32_swap_b32 v49, v51
  v_permlane32_swap_b32 v52, v54
  v_permlane32_swap_b32 v53, v55
  v_add_f32 v44, v44, v50
  v_add_f32 v45, v45, v51
  v_add_f32 v48, v48, v54
  v_add_f32 v49, v49, v55
  v_add_f32 v52, v52, v46
  v_add_f32 v53, v53, v47
  s_add_u32 s44, s43, 16
  s_cmp_eq_u32 s43, 15
  s_cselect_b64 vcc, -1, 0
  v_mov_b32 v4, s44
  v_permlane16_swap_b32 v44, v45
  v_permlane16_swap_b32 v48, v49
  v_permlane16_swap_b32 v52, v53
  v_add_f32 v44, v44, v53
  v_add_f32 v48, v48, v45
  v_add_f32 v52, v52, v49
  s_waitcnt lgkmcnt(0)
  ds_write_b32 v3, v44 offset:0
  ds_write_b32 v3, v48 offset:256
  ds_write_b32 v3, v52 offset:512
  s_cmp_eq_u32 s43, 16
  s_cbranch_scc1 L_vend
  ds_write_b32 v6, v4 offset:0
  v_mov_b32 v117, v118
  v_add_u32 v3, 3072, v3
  s_mov_b64 s[32:33], s[36:37]
  s_add_u32 s45, s43, 1
  s_min_u32 s45, s45, 15
  s_lshl_b32 s68, s45, 2
  s_lshr_b64 s[64:65], s[92:93], s68
  s_and_b32 s68, s64, 15
  s_lshl_b32 s44, s68, 2
  s_lshr_b64 s[64:65], s[96:97], s44
  s_and_b32 s64, s64, 15
  s_lshl4_add_u32 s68, s68, s64
  s_mul_i32 s44, s68, 1572864
  s_add_u32 s36, s12, s44
  s_addc_u32 s37, s13, 0
  s_branch L_v
L_vtail:
  s_waitcnt vmcnt(10)
  v_mov_b32_dpp v18, v116 row_newbcast:15 row_mask:0xf bank_mask:0xf
  v_cvt_f32_i32 v80, v80
  v_cvt_f32_i32 v81, v81
  v_cvt_f32_i32 v82, v82
  v_cvt_f32_i32 v83, v83
  v_pk_fma_f32 v[44:45], v[80:81], v[18:19], v[44:45] op_sel_hi:[1,0,1]
  v_pk_fma_f32 v[46:47], v[82:83], v[18:19], v[46:47] op_sel_hi:[1,0,1]
  s_waitcnt vmcnt(9)
  v_mov_b32_dpp v18, v117 row_newbcast:0 row_mask:0xf bank_mask:0xf
  v_cvt_f32_i32 v84, v84
  v_cvt_f32_i32 v85, v85
  v_cvt_f32_i32 v86, v86
  v_cvt_f32_i32 v87, v87
  v_pk_fma_f32 v[48:49], v[84:85], v[18:19], v[48:49] op_sel_hi:[1,0,1]
  v_pk_fma_f32 v[50:51], v[86:87], v[18:19], v[50:51] op_sel_hi:[1,0,1]
  s_waitcnt vmcnt(8)
  v_mov_b32_dpp v18, v117 row_newbcast:1 row_mask:0xf bank_mask:0xf
  v_cvt_f32_i32 v88, v88
  v_cvt_f32_i32 v89, v89
  v_cvt_f32_i32 v90, v90
  v_cvt_f32_i32 v91, v91
  v_pk_fma_f32 v[52:53], v[88:89], v[18:19], v[52:53] op_sel_hi:[1,0,1]
  v_pk_fma_f32 v[54:55], v[90:91], v[18:19], v[54:55] op_sel_hi:[1,0,1]
  s_waitcnt vmcnt(6)
  v_mov_b32_dpp v18, v117 row_newbcast:2 row_mask:0xf bank_mask:0xf
  v_cvt_f32_i32 v92, v92
  v_cvt_f32_i32 v93, v93
  v_cvt_f32_i32 v94, v94
  v_cvt_f32_i32 v95, v95
  v_pk_fma_f32 v[44:45], v[92:93], v[18:19], v[44:45] op_sel_hi:[1,0,1]
  v_pk_fma_f32 v[46:47], v[94:95], v[18:19], v[46:47] op_sel_hi:[1,0,1]
  s_waitcnt vmcnt(5)
  v_mov_b32_dpp v18, v117 row_newbcast:3 row_mask:0xf bank_mask:0xf
  v_cvt_f32_i32 v96, v96
  v_cvt_f32_i32 v97, v97
  v_cvt_f32_i32 v98, v98
  v_cvt_f32_i32 v99, v99
  v_pk_fma_f32 v[48:49], v[96:97], v[18:19], v[48:49] op_sel_hi:[1,0,1]
  v_pk_fma_f32 v[50:51], v[98:99], v[18:19], v[50:51] op_sel_hi:[1,0,1]
  s_waitcnt vmcnt(4)
  v_mov_b32_dpp v18, v117 row_newbcast:4 row_mask:0xf bank_mask:0xf
  v_cvt_f32_i32 v100, v100
  v_cvt_f32_i32 v101, v101
  v_cvt_f32_i32 v102, v102
  v_cvt_f32_i32 v103, v103
  v_pk_fma_f32 v[52:53], v[100:101], v[18:19], v[52:53] op_sel_hi:[1,0,1]
  v_pk_fma_f32 v[54:55], v[102:103], v[18:19], v[54:55] op_sel_hi:[1,0,1]
  s_waitcnt vmcnt(2)
  v_mov_b32_dpp v18, v117 row_newbcast:5 row_mask:0xf bank_mask:0xf
  v_cvt_f32_i32 v104, v104
  v_cvt_f32_i32 v105, v105
  v_cvt_f32_i32 v106, v106
  v_cvt_f32_i32 v107, v107
  v_pk_fma_f32 v[44:45], v[104:105], v[18:19], v[44:45] op_sel_hi:[1,0,1]
  v_pk_fma_f32 v[46:47], v[106:107], v[18:19], v[46:47] op_sel_hi:[1,0,1]
  s_waitcnt vmcnt(1)
  v_mov_b32_dpp v18, v117 row_newbcast:6 row_mask:0xf bank_mask:0xf
  v_cvt_f32_i32 v108, v108
  v_cvt_f32_i32 v109, v109
  v_cvt_f32_i32 v110, v110
  v_cvt_f32_i32 v111, v111
  v_pk_fma_f32 v[48:49], v[108:109], v[18:19], v[48:49] op_sel_hi:[1,0,1]
  v_pk_fma_f32 v[50:51], v[110:111], v[18:19], v[50:51] op_sel_hi:[1,0,1]
  s_waitcnt vmcnt(0)
  v_mov_b32_dpp v18, v117 row_newbcast:7 row_mask:0xf bank_mask:0xf
  v_cvt_f32_i32 v112, v112
  v_cvt_f32_i32 v113, v113
  v_cvt_f32_i32 v114, v114
  v_cvt_f32_i32 v115, v115
  v_pk_fma_f32 v[52:53], v[112:113], v[18:19], v[52:53] op_sel_hi:[1,0,1]
  v_pk_fma_f32 v[54:55], v[114:115], v[18:19], v[54:55] op_sel_hi:[1,0,1]
  s_branch L_vred
L_vend:
  s_waitcnt lgkmcnt(0)
  s_barrier
  s_endpgm
L_helper:
  s_add_u32 s68, s42, 32
  s_mul_i32 s44, s68, 384
  s_add_u32 s32, s4, s44
  s_addc_u32 s33, s5, 0
  global_load_dwordx2 v[68:69], v26, s[32:33]
  global_load_dwordx2 v[70:71], v27, s[32:33]
  s_setprio 0
  s_load_dwordx4 s[28:31], s[0:1], 96
  s_getpc_b64 s[82:83]
L_pc89:
  s_lshl_b32 s44, s2, 6
  s_add_u32 s44, s44, L_order-L_pc89
  s_add_u32 s82, s82, s44
  s_addc_u32 s83, s83, 0
  s_load_dwordx2 s[92:93], s[82:83], 0
  s_load_dwordx2 s[96:97], s[82:83], 8
  s_mov_b32 s94, 4000000
  s_and_b32 s41, s2, 7
  s_lshl_b32 s41, s41, 1
  s_bitcmp1_b32 s2, 3
  s_addc_u32 s41, s41, 0
  s_load_dword s3, s[82:83], 24
  s_load_dwordx2 s[98:99], s[82:83], 16
  s_waitcnt lgkmcnt(0)
  v_min_u32 v22, 2, v20
  v_lshlrev_b32 v23, 3, v22
  v_bfe_u32 v23, s99, v23, 8
  v_mul_u32_u24 v36, 4352, v23
  v_add_u32 v36, 7340032, v36
  v_and_b32 v23, 15, v23
  v_lshlrev_b32 v37, 4, v23
  v_lshl_add_u32 v22, v22, 4, s42
  v_mul_u32_u24 v45, 4352, v22
  v_add_u32 v45, 7340032, v45
  s_getreg_b32 s81, hwreg(HW_REG_HW_ID, 13, 2)
  s_getreg_b32 s79, hwreg(HW_REG_HW_ID, 8, 4)
  s_getreg_b32 s46, hwreg(HW_REG_XCC_ID, 0, 3)
  s_mul_i32 s46, s46, 4352
  s_add_u32 s46, s46, 8126464
  v_lshrrev_b32 v22, 1, v20
  v_lshl_add_u32 v42, v22, 8, s46
  v_and_b32 v22, 1, v20
  v_lshl_add_u32 v42, v22, 4, v42
  s_and_b32 s45, s81, 2
  s_lshl_b32 s44, s45, 9
  s_add_u32 s44, s44, s46
  v_add_u32 v44, s44, v20
  s_lshl_b32 s45, s45, 1
  s_add_u32 s46, s46, s45
  s_add_u32 s46, s46, 2048
  v_mov_b32 v43, s46
  v_mul_u32_u24 v39, 384, v20
  v_add_u32 v39, 7864320, v39
  v_mov_b32 v40, 0
  s_mov_b32 s47, 0
  s_mov_b32 s90, 0
  s_mov_b32 s80, 0
  s_mov_b64 exec, 0x3ffff
  global_store_dwordx4 v42, v[48:51], s[30:31]
  s_mov_b64 exec, -1
  v_add_u32 v33, 0, v20
  s_and_b32 s44, s41, 1
  v_add_u32 v23, s44, v33
  v_cmp_le_u32 vcc, 43, v23
  s_add_u32 s45, s44, 42
  v_mov_b32 v24, s45
  v_cndmask_b32 v24, 0, v24, vcc
  v_cmp_le_u32 vcc, 86, v23
  v_add_u32 v22, v33, v24
  s_sub_u32 s45, 43, s44
  v_mov_b32 v24, s45
  v_cndmask_b32 v24, 0, v24, vcc
  s_mul_i32 s44, s44, 43
  s_lshr_b32 s45, s41, 1
  s_lshl_b32 s45, s45, 8
  s_add_u32 s44, s44, s45
  v_add3_u32 v22, v22, v24, s44
  v_and_b32 v33, 255, v22
  v_lshlrev_b32 v33, 1, v33
  v_add_u32 v34, 64, v20
  s_and_b32 s44, s41, 1
  v_add_u32 v23, s44, v34
  v_cmp_le_u32 vcc, 43, v23
  s_add_u32 s45, s44, 42
  v_mov_b32 v24, s45
  v_cndmask_b32 v24, 0, v24, vcc
  v_cmp_le_u32 vcc, 86, v23
  v_add_u32 v22, v34, v24
  s_sub_u32 s45, 43, s44
  v_mov_b32 v24, s45
  v_cndmask_b32 v24, 0, v24, vcc
  s_mul_i32 s44, s44, 43
  s_lshr_b32 s45, s41, 1
  s_lshl_b32 s45, s45, 8
  s_add_u32 s44, s44, s45
  v_add3_u32 v22, v22, v24, s44
  v_and_b32 v34, 255, v22
  v_lshlrev_b32 v34, 1, v34
  v_lshlrev_b32 v46, 2, v20
  v_mul_u32_u24 v199, 12, v20
  v_add_u32 v199, 45568, v199
  s_mov_b32 s101, 0
  v_mov_b32 v47, 118912
  v_mov_b32 v51, -1
  v_mov_b32 v60, 0
  v_mov_b32 v61, 0
  v_mov_b32 v62, 0
  v_mov_b32 v63, 0
  v_mov_b32 v64, 0
  v_mov_b32 v65, 0
  v_mov_b32 v66, 0
  v_mov_b32 v67, 0
  s_and_b32 s45, s2, 7
  s_lshl_b32 s45, s45, 9
  v_and_b32 v22, 31, v20
  v_lshl_add_u32 v22, v22, 4, s45
  v_lshrrev_b32 v23, 5, v20
  v_lshl_add_u32 v22, v23, 16, v22
  v_lshlrev_b32 v23, 2, v23
  s_lshr_b32 s44, s96, 0
  v_bfe_u32 v24, s44, v23, 4
  v_lshl_add_u32 v188, v24, 12, v22
  v_add_u32 v22, 0x20000, v22
  s_lshr_b32 s44, s96, 8
  v_bfe_u32 v24, s44, v23, 4
  v_lshl_add_u32 v189, v24, 12, v22
  v_add_u32 v22, 0x20000, v22
  s_lshr_b32 s44, s96, 16
  v_bfe_u32 v24, s44, v23, 4
  v_lshl_add_u32 v190, v24, 12, v22
  v_add_u32 v22, 0x20000, v22
  s_lshr_b32 s44, s96, 24
  v_bfe_u32 v24, s44, v23, 4
  v_lshl_add_u32 v191, v24, 12, v22
  v_add_u32 v22, 0x20000, v22
  s_lshr_b32 s44, s97, 0
  v_bfe_u32 v24, s44, v23, 4
  v_lshl_add_u32 v192, v24, 12, v22
  v_add_u32 v22, 0x20000, v22
  s_lshr_b32 s44, s97, 8
  v_bfe_u32 v24, s44, v23, 4
  v_lshl_add_u32 v193, v24, 12, v22
  v_add_u32 v22, 0x20000, v22
  s_lshr_b32 s44, s97, 16
  v_bfe_u32 v24, s44, v23, 4
  v_lshl_add_u32 v194, v24, 12, v22
  v_add_u32 v22, 0x20000, v22
  s_lshr_b32 s44, s97, 24
  v_bfe_u32 v24, s44, v23, 4
  v_lshl_add_u32 v195, v24, 12, v22
  s_mov_b32 s69, 0
  s_movk_i32 m0, 4608
  s_branch L_hq_nl
L_hk:
  s_sub_u32 s47, s43, 1
L_hsw:
  ds_read_b128 v[104:107], v14 offset:0
  s_waitcnt lgkmcnt(0)
  v_min_u32 v104, v104, v105
  v_min3_u32 v104, v104, v106, v107
  s_nop 0
  v_readfirstlane_b32 s46, v104
  s_cmp_ge_u32 s46, s47
  s_cbranch_scc1 L_hsw_ok
  s_cmp_eq_u32 s94, 0
  s_cbranch_scc1 L_hsw_ok
  s_sub_u32 s94, s94, 1
  s_sleep 1
  s_branch L_hsw
L_hsw_ok:
  s_bitcmp1_b32 s80, s47
  s_cbranch_scc0 L_fas
  s_mul_i32 s44, s47, 384
  s_add_u32 s44, s44, 7864320
  s_movk_i32 s78, 1
  s_atomic_add s78, s[30:31], s44 glc
L_fas:
  s_cmp_lt_u32 s43, 5
  s_cbranch_scc1 L_hs_done
  s_add_u32 s68, s69, 2
  s_min_u32 s68, s68, s47
L_hs:
  ds_read_u16_d16_hi v60, v33 offset:4608
  ds_read_u16_d16_hi v61, v34 offset:4608
  ds_read_u16_d16_hi v62, v33 offset:12800
  ds_read_u16_d16_hi v63, v34 offset:12800
  ds_read_u16_d16_hi v64, v33 offset:20992
  ds_read_u16_d16_hi v65, v34 offset:20992
  ds_read_u16_d16_hi v66, v33 offset:29184
  ds_read_u16_d16_hi v67, v34 offset:29184
  v_add_u32 v200, s101, v199
  v_add_u32 v201, 1536, v200
  s_addk_i32 s101, 3072
  s_cmpk_eq_u32 s101, 18432
  s_cselect_b32 s101, 0, s101
  s_add_u32 s69, s69, 1
  s_waitcnt lgkmcnt(4)
  ds_read2_b32 v[76:77], v200 offset0:0 offset1:1
  ds_read_b32 v72, v200 offset:8
  ds_read2_b32 v[78:79], v200 offset0:192 offset1:193
  ds_read_b32 v73, v200 offset:776
  ds_read2_b32 v[80:81], v201 offset0:0 offset1:1
  ds_read_b32 v74, v201 offset:8
  ds_read2_b32 v[82:83], v201 offset0:192 offset1:193
  ds_read_b32 v75, v201 offset:776
  s_waitcnt lgkmcnt(0)
  v_add_f32 v76, v76, v77
  v_add_f32 v78, v78, v79
  v_add_f32 v80, v80, v81
  v_add_f32 v82, v82, v83
  v_add_f32 v72, v72, v76
  v_add_f32 v73, v73, v78
  v_add_f32 v74, v74, v80
  v_add_f32 v75, v75, v82
  v_fma_f32 v72, -v62, v74, v72
  v_fma_f32 v73, -v63, v75, v73
  v_mul_f32 v74, s67, v60
  v_mul_f32 v75, s67, v61
  v_mul_f32 v72, v72, v74
  v_mul_f32 v73, v73, v75
  v_max_f32 v48, v72, v73
  s_nop 1
  v_max_f32_dpp v48, v48, v48 row_ror:8 row_mask:0xf bank_mask:0xf
  s_nop 1
  v_max_f32_dpp v48, v48, v48 row_ror:4 row_mask:0xf bank_mask:0xf
  s_nop 1
  v_max_f32_dpp v48, v48, v48 row_ror:2 row_mask:0xf bank_mask:0xf
  s_nop 1
  v_max_f32_dpp v48, v48, v48 row_ror:1 row_mask:0xf bank_mask:0xf
  v_mov_b32 v22, v48
  s_nop 1
  v_permlane16_swap_b32 v48, v22
  v_max_f32 v48, v48, v22
  v_mov_b32 v22, v48
  s_nop 1
  v_permlane32_swap_b32 v48, v22
  v_max_f32 v48, v48, v22
  v_sub_f32 v72, v72, v48
  v_sub_f32 v73, v73, v48
  v_exp_f32 v72, v72
  v_exp_f32 v73, v73
  s_nop 0
  v_add_f32 v49, v72, v73
  v_mul_f32 v72, v72, v64
  v_mul_f32 v73, v73, v65
  v_mul_f32 v50, v72, v66
  v_fmac_f32 v50, v73, v67
  ds_write_b32 v46, v72 offset:37376
  ds_write_b32 v46, v73 offset:37632
  s_nop 1
  v_add_f32_dpp v49, v49, v49 row_ror:8 row_mask:0xf bank_mask:0xf
  s_nop 1
  v_add_f32_dpp v49, v49, v49 row_ror:4 row_mask:0xf bank_mask:0xf
  s_nop 1
  v_add_f32_dpp v49, v49, v49 row_ror:2 row_mask:0xf bank_mask:0xf
  s_nop 1
  v_add_f32_dpp v49, v49, v49 row_ror:1 row_mask:0xf bank_mask:0xf
  v_mov_b32 v22, v49
  s_nop 1
  v_permlane16_swap_b32 v49, v22
  v_add_f32 v49, v49, v22
  v_mov_b32 v22, v49
  s_nop 1
  v_permlane32_swap_b32 v49, v22
  v_add_f32 v49, v49, v22
  s_nop 1
  v_add_f32_dpp v50, v50, v50 row_ror:8 row_mask:0xf bank_mask:0xf
  s_nop 1
  v_add_f32_dpp v50, v50, v50 row_ror:4 row_mask:0xf bank_mask:0xf
  s_nop 1
  v_add_f32_dpp v50, v50, v50 row_ror:2 row_mask:0xf bank_mask:0xf
  s_nop 1
  v_add_f32_dpp v50, v50, v50 row_ror:1 row_mask:0xf bank_mask:0xf
  v_mov_b32 v22, v50
  s_nop 1
  v_permlane16_swap_b32 v50, v22
  v_add_f32 v50, v50, v22
  v_mov_b32 v22, v50
  s_nop 1
  v_permlane32_swap_b32 v50, v22
  v_add_f32 v50, v50, v22
  v_mov_b32 v22, s69
  ds_write_b128 v47, v[48:51]
  ds_write_b32 v14, v22 offset:20
  v_add_u32 v46, 512, v46
  v_add_u32 v47, 16, v47
  v_add_u32 v33, 512, v33
  v_add_u32 v34, 512, v34
  s_cmp_lt_u32 s69, s68
  s_cbranch_scc1 L_hs
L_hs_done:
  s_bitcmp1_b32 s80, s47
  s_cbranch_scc0 L_fbs
  s_waitcnt vmcnt(0) lgkmcnt(0)
  v_readlane_b32 s46, v40, s47
  s_sub_u32 s78, s78, s46
  s_bfe_u32 s46, s78, 0x80000
  s_min_u32 s46, s46, 15
  s_lshl_b32 s46, s46, 1
  s_sub_u32 s46, s46, 15
  s_cmp_gt_i32 s46, 0
  s_cselect_b32 s44, 2, 10
  s_mul_i32 s46, s46, s44
  s_add_u32 s46, s46, 8
  s_ashr_i32 s46, s46, 4
  v_mov_b32 v42, s46
  s_mov_b64 exec, 1
  global_store_dword v43, v42, s[30:31]
  s_mov_b64 exec, -1
L_fbs:
  s_cmp_eq_u32 s47, 1
  s_cbranch_scc0 L_el
  s_bitcmp0_b32 s81, 0
  s_cbranch_scc0 L_el
  s_mov_b64 exec, 0xffff
  global_load_ubyte v42, v44, s[30:31] sc1
  s_waitcnt vmcnt(0)
  v_cmp_ne_u32 s[64:65], 0, v42
  s_lshr_b32 s44, s64, s79
  s_bcnt1_i32_b32 s44, s44
  s_sub_u32 s45, s44, 1
  s_cmp_lt_u32 s45, 7
  s_cbranch_scc0 L_el
  s_lshl_b32 s80, 0x10204081, s45
  s_and_b32 s80, s80, 0x7d555554
  s_mov_b32 exec_lo, s80
  global_load_dword v40, v39, s[30:31] sc1
L_el:
  s_mov_b64 exec, -1
L_hq:
  s_add_u32 s43, s43, 1
  s_cmp_gt_u32 s43, 16
  s_cbranch_scc1 L_hq_nl
  s_waitcnt vmcnt(0)
  v_lshlrev_b32 v76, 16, v68
  v_and_b32 v77, s66, v68
  v_lshlrev_b32 v78, 16, v69
  v_and_b32 v79, s66, v69
  v_lshlrev_b32 v80, 16, v70
  v_and_b32 v81, s66, v70
  v_lshlrev_b32 v82, 16, v71
  v_and_b32 v83, s66, v71
  v_mul_f32 v76, v76, v52
  v_mul_f32 v77, v77, v53
  v_mul_f32 v78, v78, v54
  v_mul_f32 v79, v79, v55
  v_mul_f32 v80, v80, v56
  v_mul_f32 v81, v81, v57
  v_mul_f32 v82, v82, v58
  v_mul_f32 v83, v83, v59
  v_cvt_pk_bf16_f32 v84, v76, v80
  v_cvt_pk_bf16_f32 v85, v77, v81
  v_cvt_pk_bf16_f32 v86, v78, v82
  v_cvt_pk_bf16_f32 v87, v79, v83
  v_lshlrev_b32 v76, 16, v84
  v_and_b32 v80, s66, v84
  v_lshlrev_b32 v77, 16, v85
  v_and_b32 v81, s66, v85
  v_lshlrev_b32 v78, 16, v86
  v_and_b32 v82, s66, v86
  v_lshlrev_b32 v79, 16, v87
  v_and_b32 v83, s66, v87
  v_fma_f32 v76, v80, v30, v76
  v_fma_f32 v77, v81, v30, v77
  v_fma_f32 v78, v82, v30, v78
  v_fma_f32 v79, v83, v30, v79
  v_cvt_pk_bf16_f32 v84, v76, v77
  v_cvt_pk_bf16_f32 v85, v78, v79
  v_xor_b32 v86, v31, v84
  v_xor_b32 v87, v31, v85
  v_mov_b32 v22, s43
  ds_write_b16 v28, v84 offset:512
  ds_write_b16_d16_hi v28, v84 offset:516
  ds_write_b16 v28, v85 offset:520
  ds_write_b16_d16_hi v28, v85 offset:524
  ds_write_b16 v29, v86 offset:514
  ds_write_b16_d16_hi v29, v86 offset:518
  ds_write_b16 v29, v87 offset:522
  ds_write_b16_d16_hi v29, v87 offset:526
  ds_write_b32 v14, v22 offset:16
  v_add_u32 v28, 1024, v28
  v_add_u32 v29, 1024, v29
  v_and_b32 v28, 0xfff, v28
  v_and_b32 v29, 0xfff, v29
  s_cmp_eq_u32 s43, 16
  s_cbranch_scc1 L_hq_nl
  s_lshl_b32 s44, s43, 2
  s_lshr_b64 s[64:65], s[96:97], s44
  s_and_b32 s64, s64, 15
  s_lshl4_add_u32 s68, s43, s64
  s_mul_i32 s44, s68, 384
  s_add_u32 s32, s4, s44
  s_addc_u32 s33, s5, 0
  global_load_dwordx2 v[68:69], v26, s[32:33]
  global_load_dwordx2 v[70:71], v27, s[32:33]
L_hq_nl:
  s_sub_u32 s44, s43, 4
  s_cmp_lt_u32 s44, 2
  s_cbranch_scc0 L_sc_done
  global_load_lds_dwordx4 v188, s[8:9]
  s_addk_i32 m0, 1024
  s_waitcnt vmcnt(3)
  global_load_lds_dwordx4 v189, s[8:9]
  s_addk_i32 m0, 1024
  s_waitcnt vmcnt(3)
  global_load_lds_dwordx4 v190, s[8:9]
  s_addk_i32 m0, 1024
  s_waitcnt vmcnt(3)
  global_load_lds_dwordx4 v191, s[8:9]
  s_addk_i32 m0, 1024
  s_waitcnt vmcnt(3)
  global_load_lds_dwordx4 v192, s[8:9]
  s_addk_i32 m0, 1024
  s_waitcnt vmcnt(3)
  global_load_lds_dwordx4 v193, s[8:9]
  s_addk_i32 m0, 1024
  s_waitcnt vmcnt(3)
  global_load_lds_dwordx4 v194, s[8:9]
  s_addk_i32 m0, 1024
  s_waitcnt vmcnt(3)
  global_load_lds_dwordx4 v195, s[8:9]
  s_addk_i32 m0, 1024
  s_mov_b64 s[8:9], s[10:11]
  s_mov_b64 s[10:11], s[14:15]
  s_mov_b64 s[14:15], s[16:17]
  s_waitcnt vmcnt(3)
  global_load_lds_dwordx4 v188, s[8:9]
  s_addk_i32 m0, 1024
  s_waitcnt vmcnt(3)
  global_load_lds_dwordx4 v189, s[8:9]
  s_addk_i32 m0, 1024
  s_waitcnt vmcnt(3)
  global_load_lds_dwordx4 v190, s[8:9]
  s_addk_i32 m0, 1024
  s_waitcnt vmcnt(3)
  global_load_lds_dwordx4 v191, s[8:9]
  s_addk_i32 m0, 1024
  s_waitcnt vmcnt(3)
  global_load_lds_dwordx4 v192, s[8:9]
  s_addk_i32 m0, 1024
  s_waitcnt vmcnt(3)
  global_load_lds_dwordx4 v193, s[8:9]
  s_addk_i32 m0, 1024
  s_waitcnt vmcnt(3)
  global_load_lds_dwordx4 v194, s[8:9]
  s_addk_i32 m0, 1024
  s_waitcnt vmcnt(3)
  global_load_lds_dwordx4 v195, s[8:9]
  s_addk_i32 m0, 1024
  s_mov_b64 s[8:9], s[10:11]
  s_mov_b64 s[10:11], s[14:15]
  s_mov_b64 s[14:15], s[16:17]
  s_cmp_eq_u32 s43, 5
  s_cbranch_scc0 L_sc_done
  s_waitcnt vmcnt(0)
L_sc_done:
  s_cmp_eq_u32 s43, 16
  s_cbranch_scc0 L_hq_skip
  s_cmp_eq_u32 s3, 0
  s_cbranch_scc0 L_hq_skip
  s_mov_b64 exec, 7
  global_store_dword v45, v14, s[30:31] sc1
  s_waitcnt vmcnt(0)
  s_mov_b64 exec, 1
  global_store_dword v37, v38, s[28:29] sc1
  s_mov_b64 exec, -1
L_hq_skip:
  s_waitcnt lgkmcnt(0)
  s_cmp_lt_u32 s43, 18
  s_cbranch_scc1 L_hk
  v_and_b32 v24, 15, v20
  v_lshlrev_b32 v24, 1, v24
  global_load_ushort v25, v24, s[82:83] offset:32
  s_mov_b32 s43, 0
  v_min_u32 v28, 23, v20
  v_lshlrev_b32 v28, 4, v28
  v_lshlrev_b32 v22, 1, v28
  v_subrev_u32 v196, 256, v22
  v_add_u32 v197, 512, v22
  v_min_u32 v197, v196, v197
  v_add_u32 v197, 64000, v197
  v_subrev_u32 v196, 512, v22
  v_add_u32 v198, 256, v22
  v_min_u32 v198, v196, v198
  v_add_u32 v198, 64000, v198
  v_add_u32 v196, 64000, v22
  v_add_u32 v28, 113152, v28
  v_lshlrev_b32 v32, 4, v20
  v_add_u32 v30, 113152, v32
  v_cmp_gt_u32 vcc, 24, v20
  v_lshrrev_b32 v21, 1, v35
  s_mul_i32 s44, s98, 384
  s_add_u32 s26, s26, s44
  s_addc_u32 s27, s27, 0
  v_mov_b32 v31, s2
  v_mul_u32_u24 v31, 6144, v31
  v_add_u32 v31, 8388608, v31
  v_add_u32 v23, 0, v32
  v_add_u32 v188, v23, v31
  v_add_u32 v23, 1024, v32
  v_add_u32 v189, v23, v31
  v_add_u32 v23, 2048, v32
  v_add_u32 v190, v23, v31
  v_add_u32 v23, 3072, v32
  v_add_u32 v191, v23, v31
  v_add_u32 v23, 4096, v32
  v_add_u32 v192, v23, v31
  v_add_u32 v23, 5120, v32
  v_add_u32 v193, v23, v31
  s_mov_b32 s45, 14
  s_lshl_b32 s68, s45, 2
  s_lshr_b64 s[64:65], s[92:93], s68
  s_and_b32 s68, s64, 15
  v_lshl_add_u32 v23, s68, 4, v32
  v_cndmask_b32 v23, v23, v32, vcc
  v_add_u32 v23, 5376, v23
  v_add_u32 v168, v23, v31
  s_waitcnt vmcnt(0)
  v_lshrrev_b32 v31, 4, v25
  v_mul_u32_u24 v31, 6144, v31
  v_add_u32 v31, 8388608, v31
  v_and_b32 v25, 15, v25
  v_mul_u32_u24 v25, 384, v25
  s_lshl4_add_u32 s44, s3, 5760
  v_mov_b32 v23, s44
  v_add_u32 v187, v23, v31
  v_add_u32_dpp v23, v25, v21 row_newbcast:0 row_mask:0xf bank_mask:0xf
  v_mov_b32_dpp v29, v31 row_newbcast:0 row_mask:0xf bank_mask:0xf
  v_add_u32 v172, v23, v29
  v_add_u32_dpp v23, v25, v21 row_newbcast:1 row_mask:0xf bank_mask:0xf
  v_mov_b32_dpp v29, v31 row_newbcast:1 row_mask:0xf bank_mask:0xf
  v_add_u32 v173, v23, v29
  v_add_u32_dpp v23, v25, v21 row_newbcast:2 row_mask:0xf bank_mask:0xf
  v_mov_b32_dpp v29, v31 row_newbcast:2 row_mask:0xf bank_mask:0xf
  v_add_u32 v174, v23, v29
  v_add_u32_dpp v23, v25, v21 row_newbcast:3 row_mask:0xf bank_mask:0xf
  v_mov_b32_dpp v29, v31 row_newbcast:3 row_mask:0xf bank_mask:0xf
  v_add_u32 v175, v23, v29
  v_add_u32_dpp v23, v25, v21 row_newbcast:4 row_mask:0xf bank_mask:0xf
  v_mov_b32_dpp v29, v31 row_newbcast:4 row_mask:0xf bank_mask:0xf
  v_add_u32 v176, v23, v29
  v_add_u32_dpp v23, v25, v21 row_newbcast:5 row_mask:0xf bank_mask:0xf
  v_mov_b32_dpp v29, v31 row_newbcast:5 row_mask:0xf bank_mask:0xf
  v_add_u32 v177, v23, v29
  v_add_u32_dpp v23, v25, v21 row_newbcast:6 row_mask:0xf bank_mask:0xf
  v_mov_b32_dpp v29, v31 row_newbcast:6 row_mask:0xf bank_mask:0xf
  v_add_u32 v178, v23, v29
  v_add_u32_dpp v23, v25, v21 row_newbcast:7 row_mask:0xf bank_mask:0xf
  v_mov_b32_dpp v29, v31 row_newbcast:7 row_mask:0xf bank_mask:0xf
  v_add_u32 v179, v23, v29
  v_add_u32_dpp v23, v25, v21 row_newbcast:8 row_mask:0xf bank_mask:0xf
  v_mov_b32_dpp v29, v31 row_newbcast:8 row_mask:0xf bank_mask:0xf
  v_add_u32 v180, v23, v29
  v_add_u32_dpp v23, v25, v21 row_newbcast:9 row_mask:0xf bank_mask:0xf
  v_mov_b32_dpp v29, v31 row_newbcast:9 row_mask:0xf bank_mask:0xf
  v_add_u32 v181, v23, v29
  v_add_u32_dpp v23, v25, v21 row_newbcast:10 row_mask:0xf bank_mask:0xf
  v_mov_b32_dpp v29, v31 row_newbcast:10 row_mask:0xf bank_mask:0xf
  v_add_u32 v182, v23, v29
  v_add_u32_dpp v23, v25, v21 row_newbcast:11 row_mask:0xf bank_mask:0xf
  v_mov_b32_dpp v29, v31 row_newbcast:11 row_mask:0xf bank_mask:0xf
  v_add_u32 v183, v23, v29
  v_add_u32_dpp v23, v25, v21 row_newbcast:12 row_mask:0xf bank_mask:0xf
  v_mov_b32_dpp v29, v31 row_newbcast:12 row_mask:0xf bank_mask:0xf
  v_add_u32 v184, v23, v29
  v_add_u32_dpp v23, v25, v21 row_newbcast:13 row_mask:0xf bank_mask:0xf
  v_mov_b32_dpp v29, v31 row_newbcast:13 row_mask:0xf bank_mask:0xf
  v_add_u32 v185, v23, v29
  v_add_u32_dpp v23, v25, v21 row_newbcast:14 row_mask:0xf bank_mask:0xf
  v_mov_b32_dpp v29, v31 row_newbcast:14 row_mask:0xf bank_mask:0xf
  v_add_u32 v186, v23, v29
  v_mov_b32 v108, -1
  v_mov_b32 v109, -1
  v_mov_b32 v110, -1
  v_mov_b32 v111, -1
  s_lshl4_add_u32 s44, s3, 118912
  v_mov_b32 v23, s44
  ds_write_b128 v28, v[108:111] offset:5376
  ds_write_b32 v23, v38 offset:12
L_hp:
  s_min_u32 s44, s3, 13
  s_cmp_eq_u32 s44, s43
  s_cbranch_scc0 L_hc_ok
L_hc:
  global_load_dword v104, v37, s[28:29] sc1
  s_waitcnt vmcnt(0)
  v_cmp_ne_u32 s[64:65], 1, v104
  s_cmp_eq_u64 s[64:65], 0
  s_cbranch_scc1 L_hc_ok
  s_cmp_eq_u32 s94, 0
  s_cbranch_scc1 L_hc_ok
  s_sub_u32 s94, s94, 1
  s_sleep 64
  s_branch L_hc
L_hc_ok:
  s_lshl_b32 s68, s43, 2
  s_lshr_b64 s[64:65], s[92:93], s68
  s_and_b32 s68, s64, 15
  s_lshl4_add_u32 s44, s68, 118912
  v_mov_b32 v23, s44
  s_cmp_eq_u32 s43, 14
  s_cbranch_scc0 L_hp_mid
  ds_read_b128 v[144:147], v30 offset:0
  ds_read_b128 v[148:151], v30 offset:1024
  ds_read_b128 v[152:155], v30 offset:2048
  ds_read_b128 v[156:159], v30 offset:3072
  ds_read_b128 v[160:163], v30 offset:4096
  ds_read_b128 v[164:167], v30 offset:5120
L_hm:
  ds_read_b32 v104, v14 offset:24
  s_waitcnt lgkmcnt(0)
  v_readfirstlane_b32 s46, v104
  s_cmp_ge_u32 s46, 30
  s_cbranch_scc1 L_hm_ok
  s_cmp_eq_u32 s94, 0
  s_cbranch_scc1 L_hm_ok
  s_sub_u32 s94, s94, 1
  s_sleep 1
  s_branch L_hm
L_hm_ok:
  global_store_dwordx4 v188, v[144:147], s[30:31] sc1
  global_store_dwordx4 v189, v[148:151], s[30:31] sc1
  global_store_dwordx4 v190, v[152:155], s[30:31] sc1
  global_store_dwordx4 v191, v[156:159], s[30:31] sc1
  global_store_dwordx4 v192, v[160:163], s[30:31] sc1
  s_mov_b32 exec_hi, 0xffffff
  global_store_dwordx4 v193, v[164:167], s[30:31] sc1
  s_mov_b64 exec, 7
  s_waitcnt vmcnt(0)
  global_atomic_add v36, v38, s[30:31] sc1
  s_mov_b64 exec, -1
L_hp_mid:
  s_add_u32 s43, s43, 1
  s_add_u32 s47, s43, 16
L_hpw:
  ds_read_b128 v[104:107], v14 offset:0
  s_waitcnt lgkmcnt(0)
  v_min_u32 v104, v104, v105
  v_min3_u32 v104, v104, v106, v107
  s_nop 0
  v_readfirstlane_b32 s46, v104
  s_cmp_ge_u32 s46, s47
  s_cbranch_scc1 L_hpw_ok
  s_cmp_eq_u32 s94, 0
  s_cbranch_scc1 L_hpw_ok
  s_sub_u32 s94, s94, 1
  s_sleep 1
  s_branch L_hpw
L_hpw_ok:
  s_bitcmp1_b32 s80, s47
  s_cbranch_scc0 L_fap
  s_mul_i32 s44, s47, 384
  s_add_u32 s44, s44, 7864320
  s_movk_i32 s78, 1
  s_atomic_add s78, s[30:31], s44 glc
L_fap:
  ds_read_b128 v[72:75], v196 offset:0
  ds_read_b128 v[76:79], v196 offset:16
  ds_read_b128 v[80:83], v197 offset:768
  ds_read_b128 v[84:87], v197 offset:784
  ds_read_b128 v[88:91], v198 offset:1536
  ds_read_b128 v[92:95], v198 offset:1552
  ds_read_b128 v[96:99], v196 offset:2304
  ds_read_b128 v[100:103], v196 offset:2320
  ds_read_b128 v[48:51], v23
  s_waitcnt lgkmcnt(0)
  v_pk_add_f32 v[72:73], v[72:73], v[80:81]
  v_pk_add_f32 v[88:89], v[88:89], v[96:97]
  v_pk_add_f32 v[74:75], v[74:75], v[82:83]
  v_pk_add_f32 v[90:91], v[90:91], v[98:99]
  v_pk_add_f32 v[76:77], v[76:77], v[84:85]
  v_pk_add_f32 v[92:93], v[92:93], v[100:101]
  v_pk_add_f32 v[78:79], v[78:79], v[86:87]
  v_pk_add_f32 v[94:95], v[94:95], v[102:103]
  v_pk_add_f32 v[72:73], v[72:73], v[88:89]
  v_pk_add_f32 v[74:75], v[74:75], v[90:91]
  v_pk_add_f32 v[76:77], v[76:77], v[92:93]
  v_pk_add_f32 v[78:79], v[78:79], v[94:95]
  v_pk_add_f32 v[72:73], v[72:73], v[50:51] op_sel_hi:[1,0] neg_lo:[0,1] neg_hi:[0,1]
  v_pk_add_f32 v[74:75], v[74:75], v[50:51] op_sel_hi:[1,0] neg_lo:[0,1] neg_hi:[0,1]
  v_pk_add_f32 v[76:77], v[76:77], v[50:51] op_sel_hi:[1,0] neg_lo:[0,1] neg_hi:[0,1]
  v_pk_add_f32 v[78:79], v[78:79], v[50:51] op_sel_hi:[1,0] neg_lo:[0,1] neg_hi:[0,1]
  v_max3_f32 v25, |v72|, |v73|, |v74|
  v_max3_f32 v25, v25, |v75|, |v76|
  v_max3_f32 v25, v25, |v77|, |v78|
  v_max_f32_e64 v25, v25, |v79|
  s_nop 1
  v_max_f32_dpp v25, v25, v25 row_ror:8 row_mask:0xf bank_mask:0xf
  s_nop 1
  v_max_f32_dpp v25, v25, v25 row_ror:4 row_mask:0xf bank_mask:0xf
  s_nop 1
  v_max_f32_dpp v25, v25, v25 row_ror:2 row_mask:0xf bank_mask:0xf
  s_nop 1
  v_max_f32_dpp v25, v25, v25 row_ror:1 row_mask:0xf bank_mask:0xf
  v_mov_b32 v29, v25
  s_nop 1
  v_permlane16_swap_b32 v25, v29
  v_max_f32 v25, v25, v29
  v_mov_b32 v29, v25
  s_nop 1
  v_permlane32_swap_b32 v25, v29
  v_max_f32 v25, v25, v29
  v_frexp_exp_i32_f32 v25, v25
  v_sub_u32 v29, 14, v25
  v_add_u32 v51, 242, v25
  v_ldexp_f32 v72, v72, v29
  v_ldexp_f32 v73, v73, v29
  v_ldexp_f32 v74, v74, v29
  v_ldexp_f32 v75, v75, v29
  v_ldexp_f32 v76, v76, v29
  v_ldexp_f32 v77, v77, v29
  v_ldexp_f32 v78, v78, v29
  v_ldexp_f32 v79, v79, v29
  v_cvt_pk_f16_f32 v108, v72, v73
  v_cvt_pk_f16_f32 v109, v74, v75
  v_cvt_pk_f16_f32 v110, v76, v77
  v_cvt_pk_f16_f32 v111, v78, v79
  v_min_u32 v108, -2, v108
  v_min_u32 v109, -2, v109
  v_min_u32 v110, -2, v110
  v_min_u32 v111, -2, v111
  s_cmp_eq_u32 s43, 15
  s_cbranch_scc1 L_hp_last
  ds_write_b32 v23, v51 offset:12
  v_add_u32 v196, 3072, v196
  v_add_u32 v197, 3072, v197
  v_add_u32 v198, 3072, v198
  ds_write_b128 v28, v[108:111]
  v_add_u32 v28, 384, v28
  s_bitcmp1_b32 s80, s47
  s_cbranch_scc0 L_fbp
  s_waitcnt vmcnt(0) lgkmcnt(0)
  v_readlane_b32 s46, v40, s47
  s_sub_u32 s78, s78, s46
  s_bfe_u32 s46, s78, 0x80000
  s_min_u32 s46, s46, 15
  s_lshl_b32 s46, s46, 1
  s_sub_u32 s46, s46, 15
  s_cmp_gt_i32 s46, 0
  s_cselect_b32 s44, 2, 10
  s_mul_i32 s46, s46, s44
  s_add_u32 s46, s46, 8
  s_ashr_i32 s46, s46, 4
  v_mov_b32 v42, s46
  s_mov_b64 exec, 1
  global_store_dword v43, v42, s[30:31]
  s_mov_b64 exec, -1
L_fbp:
  s_branch L_hp
L_hp_last:
  v_cndmask_b32 v108, v48, v108, vcc
  v_cndmask_b32 v109, v49, v109, vcc
  v_cndmask_b32 v110, v50, v110, vcc
  v_cndmask_b32 v111, v51, v111, vcc
  s_mov_b64 exec, 0x1ffffff
  global_store_dwordx4 v168, v[108:111], s[30:31] sc1
  s_mov_b64 exec, -1
  v_subrev_u32 v196, 256, v35
  v_add_u32 v197, 512, v35
  v_min_u32 v197, v196, v197
  v_add_u32 v197, 110080, v197
  v_subrev_u32 v196, 512, v35
  v_add_u32 v198, 256, v35
  v_min_u32 v198, v196, v198
  v_add_u32 v198, 110080, v198
  v_add_u32 v196, 110080, v35
L_hn:
  ds_read_b32 v104, v14 offset:28
  s_waitcnt lgkmcnt(0)
  v_readfirstlane_b32 s46, v104
  s_cmp_ge_u32 s46, 31
  s_cbranch_scc1 L_hn_ok
  s_cmp_eq_u32 s94, 0
  s_cbranch_scc1 L_hn_ok
  s_sub_u32 s94, s94, 1
  s_sleep 1
  s_branch L_hn
L_hn_ok:
  s_mov_b64 exec, 1
L_hw:
  global_atomic_add v68, v36, v14, s[30:31] sc0 sc1
  s_waitcnt vmcnt(0)
  v_readfirstlane_b32 s46, v68
  s_cmp_ge_u32 s46, 16
  s_cbranch_scc1 L_hw_ok
  s_cmp_eq_u32 s94, 0
  s_cbranch_scc1 L_hw_ok
  s_sub_u32 s94, s94, 1
  s_branch L_hw
L_hw_ok:
  s_mov_b64 exec, -1
L_hg:
  global_load_dwordx4 v[52:55], v187, s[30:31] sc1
  global_load_dwordx2 v[112:113], v172, s[30:31] sc1
  global_load_dwordx2 v[114:115], v173, s[30:31] sc1
  global_load_dwordx2 v[116:117], v174, s[30:31] sc1
  global_load_dwordx2 v[118:119], v175, s[30:31] sc1
  global_load_dwordx2 v[120:121], v176, s[30:31] sc1
  global_load_dwordx2 v[122:123], v177, s[30:31] sc1
  global_load_dwordx2 v[124:125], v178, s[30:31] sc1
  global_load_dwordx2 v[126:127], v179, s[30:31] sc1
  global_load_dwordx2 v[128:129], v180, s[30:31] sc1
  global_load_dwordx2 v[130:131], v181, s[30:31] sc1
  global_load_dwordx2 v[132:133], v182, s[30:31] sc1
  global_load_dwordx2 v[134:135], v183, s[30:31] sc1
  global_load_dwordx2 v[136:137], v184, s[30:31] sc1
  global_load_dwordx2 v[138:139], v185, s[30:31] sc1
  global_load_dwordx2 v[140:141], v186, s[30:31] sc1
  s_waitcnt vmcnt(15)
  v_mov_b32 v23, v55
  v_mov_b32 v24, v52
  s_nop 1
  v_max_f32_dpp v24, v24, v24 row_ror:8 row_mask:0xf bank_mask:0xf
  s_nop 1
  v_max_f32_dpp v24, v24, v24 row_ror:4 row_mask:0xf bank_mask:0xf
  s_nop 1
  v_max_f32_dpp v24, v24, v24 row_ror:2 row_mask:0xf bank_mask:0xf
  s_nop 1
  v_max_f32_dpp v24, v24, v24 row_ror:1 row_mask:0xf bank_mask:0xf
  v_sub_f32 v24, v52, v24
  v_exp_f32 v24, v24
  v_subrev_u32 v55, 256, v55
  v_mul_f32 v25, v24, v53
  s_nop 1
  v_add_f32_dpp v25, v25, v25 row_ror:8 row_mask:0xf bank_mask:0xf
  s_nop 1
  v_add_f32_dpp v25, v25, v25 row_ror:4 row_mask:0xf bank_mask:0xf
  s_nop 1
  v_add_f32_dpp v25, v25, v25 row_ror:2 row_mask:0xf bank_mask:0xf
  s_nop 1
  v_add_f32_dpp v25, v25, v25 row_ror:1 row_mask:0xf bank_mask:0xf
  v_rcp_f32 v25, v25
  s_nop 0
  v_mul_f32 v24, v24, v25
  v_ldexp_f32 v25, v24, v55
  v_mul_f32_e64 v54, v24, -v54
  v_readlane_b32 s63, v24, 15
  v_readlane_b32 s44, v54, 15
  v_readlane_b32 s48, v25, 0
  v_readlane_b32 s49, v25, 1
  v_readlane_b32 s50, v25, 2
  v_readlane_b32 s51, v25, 3
  v_readlane_b32 s52, v25, 4
  v_readlane_b32 s53, v25, 5
  v_readlane_b32 s54, v25, 6
  v_readlane_b32 s55, v25, 7
  v_readlane_b32 s56, v25, 8
  v_readlane_b32 s57, v25, 9
  v_readlane_b32 s58, v25, 10
  v_readlane_b32 s59, v25, 11
  v_readlane_b32 s60, v25, 12
  v_readlane_b32 s61, v25, 13
  v_readlane_b32 s62, v25, 14
  v_mov_b32 v108, s44
  v_mov_b32 v109, s44
  v_mov_b32 v110, s44
  v_mov_b32 v111, s44
  s_waitcnt vmcnt(14)
  v_max3_u32 v23, v23, v112, v113
  v_fma_mix_f32 v108, v112, s48, v108 op_sel:[0,0,0] op_sel_hi:[1,0,0]
  v_fma_mix_f32 v109, v112, s48, v109 op_sel:[1,0,0] op_sel_hi:[1,0,0]
  v_fma_mix_f32 v110, v113, s48, v110 op_sel:[0,0,0] op_sel_hi:[1,0,0]
  v_fma_mix_f32 v111, v113, s48, v111 op_sel:[1,0,0] op_sel_hi:[1,0,0]
  s_waitcnt vmcnt(13)
  v_max3_u32 v23, v23, v114, v115
  v_fma_mix_f32 v108, v114, s49, v108 op_sel:[0,0,0] op_sel_hi:[1,0,0]
  v_fma_mix_f32 v109, v114, s49, v109 op_sel:[1,0,0] op_sel_hi:[1,0,0]
  v_fma_mix_f32 v110, v115, s49, v110 op_sel:[0,0,0] op_sel_hi:[1,0,0]
  v_fma_mix_f32 v111, v115, s49, v111 op_sel:[1,0,0] op_sel_hi:[1,0,0]
  s_waitcnt vmcnt(12)
  v_max3_u32 v23, v23, v116, v117
  v_fma_mix_f32 v108, v116, s50, v108 op_sel:[0,0,0] op_sel_hi:[1,0,0]
  v_fma_mix_f32 v109, v116, s50, v109 op_sel:[1,0,0] op_sel_hi:[1,0,0]
  v_fma_mix_f32 v110, v117, s50, v110 op_sel:[0,0,0] op_sel_hi:[1,0,0]
  v_fma_mix_f32 v111, v117, s50, v111 op_sel:[1,0,0] op_sel_hi:[1,0,0]
  s_waitcnt vmcnt(11)
  v_max3_u32 v23, v23, v118, v119
  v_fma_mix_f32 v108, v118, s51, v108 op_sel:[0,0,0] op_sel_hi:[1,0,0]
  v_fma_mix_f32 v109, v118, s51, v109 op_sel:[1,0,0] op_sel_hi:[1,0,0]
  v_fma_mix_f32 v110, v119, s51, v110 op_sel:[0,0,0] op_sel_hi:[1,0,0]
  v_fma_mix_f32 v111, v119, s51, v111 op_sel:[1,0,0] op_sel_hi:[1,0,0]
  s_waitcnt vmcnt(10)
  v_max3_u32 v23, v23, v120, v121
  v_fma_mix_f32 v108, v120, s52, v108 op_sel:[0,0,0] op_sel_hi:[1,0,0]
  v_fma_mix_f32 v109, v120, s52, v109 op_sel:[1,0,0] op_sel_hi:[1,0,0]
  v_fma_mix_f32 v110, v121, s52, v110 op_sel:[0,0,0] op_sel_hi:[1,0,0]
  v_fma_mix_f32 v111, v121, s52, v111 op_sel:[1,0,0] op_sel_hi:[1,0,0]
  s_waitcnt vmcnt(9)
  v_max3_u32 v23, v23, v122, v123
  v_fma_mix_f32 v108, v122, s53, v108 op_sel:[0,0,0] op_sel_hi:[1,0,0]
  v_fma_mix_f32 v109, v122, s53, v109 op_sel:[1,0,0] op_sel_hi:[1,0,0]
  v_fma_mix_f32 v110, v123, s53, v110 op_sel:[0,0,0] op_sel_hi:[1,0,0]
  v_fma_mix_f32 v111, v123, s53, v111 op_sel:[1,0,0] op_sel_hi:[1,0,0]
  s_waitcnt vmcnt(8)
  v_max3_u32 v23, v23, v124, v125
  v_fma_mix_f32 v108, v124, s54, v108 op_sel:[0,0,0] op_sel_hi:[1,0,0]
  v_fma_mix_f32 v109, v124, s54, v109 op_sel:[1,0,0] op_sel_hi:[1,0,0]
  v_fma_mix_f32 v110, v125, s54, v110 op_sel:[0,0,0] op_sel_hi:[1,0,0]
  v_fma_mix_f32 v111, v125, s54, v111 op_sel:[1,0,0] op_sel_hi:[1,0,0]
  s_waitcnt vmcnt(7)
  v_max3_u32 v23, v23, v126, v127
  v_fma_mix_f32 v108, v126, s55, v108 op_sel:[0,0,0] op_sel_hi:[1,0,0]
  v_fma_mix_f32 v109, v126, s55, v109 op_sel:[1,0,0] op_sel_hi:[1,0,0]
  v_fma_mix_f32 v110, v127, s55, v110 op_sel:[0,0,0] op_sel_hi:[1,0,0]
  v_fma_mix_f32 v111, v127, s55, v111 op_sel:[1,0,0] op_sel_hi:[1,0,0]
  s_waitcnt vmcnt(6)
  v_max3_u32 v23, v23, v128, v129
  v_fma_mix_f32 v108, v128, s56, v108 op_sel:[0,0,0] op_sel_hi:[1,0,0]
  v_fma_mix_f32 v109, v128, s56, v109 op_sel:[1,0,0] op_sel_hi:[1,0,0]
  v_fma_mix_f32 v110, v129, s56, v110 op_sel:[0,0,0] op_sel_hi:[1,0,0]
  v_fma_mix_f32 v111, v129, s56, v111 op_sel:[1,0,0] op_sel_hi:[1,0,0]
  s_waitcnt vmcnt(5)
  v_max3_u32 v23, v23, v130, v131
  v_fma_mix_f32 v108, v130, s57, v108 op_sel:[0,0,0] op_sel_hi:[1,0,0]
  v_fma_mix_f32 v109, v130, s57, v109 op_sel:[1,0,0] op_sel_hi:[1,0,0]
  v_fma_mix_f32 v110, v131, s57, v110 op_sel:[0,0,0] op_sel_hi:[1,0,0]
  v_fma_mix_f32 v111, v131, s57, v111 op_sel:[1,0,0] op_sel_hi:[1,0,0]
  s_waitcnt vmcnt(4)
  v_max3_u32 v23, v23, v132, v133
  v_fma_mix_f32 v108, v132, s58, v108 op_sel:[0,0,0] op_sel_hi:[1,0,0]
  v_fma_mix_f32 v109, v132, s58, v109 op_sel:[1,0,0] op_sel_hi:[1,0,0]
  v_fma_mix_f32 v110, v133, s58, v110 op_sel:[0,0,0] op_sel_hi:[1,0,0]
  v_fma_mix_f32 v111, v133, s58, v111 op_sel:[1,0,0] op_sel_hi:[1,0,0]
  s_waitcnt vmcnt(3)
  v_max3_u32 v23, v23, v134, v135
  v_fma_mix_f32 v108, v134, s59, v108 op_sel:[0,0,0] op_sel_hi:[1,0,0]
  v_fma_mix_f32 v109, v134, s59, v109 op_sel:[1,0,0] op_sel_hi:[1,0,0]
  v_fma_mix_f32 v110, v135, s59, v110 op_sel:[0,0,0] op_sel_hi:[1,0,0]
  v_fma_mix_f32 v111, v135, s59, v111 op_sel:[1,0,0] op_sel_hi:[1,0,0]
  s_waitcnt vmcnt(2)
  v_max3_u32 v23, v23, v136, v137
  v_fma_mix_f32 v108, v136, s60, v108 op_sel:[0,0,0] op_sel_hi:[1,0,0]
  v_fma_mix_f32 v109, v136, s60, v109 op_sel:[1,0,0] op_sel_hi:[1,0,0]
  v_fma_mix_f32 v110, v137, s60, v110 op_sel:[0,0,0] op_sel_hi:[1,0,0]
  v_fma_mix_f32 v111, v137, s60, v111 op_sel:[1,0,0] op_sel_hi:[1,0,0]
  s_waitcnt vmcnt(1)
  v_max3_u32 v23, v23, v138, v139
  v_fma_mix_f32 v108, v138, s61, v108 op_sel:[0,0,0] op_sel_hi:[1,0,0]
  v_fma_mix_f32 v109, v138, s61, v109 op_sel:[1,0,0] op_sel_hi:[1,0,0]
  v_fma_mix_f32 v110, v139, s61, v110 op_sel:[0,0,0] op_sel_hi:[1,0,0]
  v_fma_mix_f32 v111, v139, s61, v111 op_sel:[1,0,0] op_sel_hi:[1,0,0]
  s_waitcnt vmcnt(0)
  v_max3_u32 v23, v23, v140, v141
  v_cmp_eq_u32 s[64:65], -1, v23
  v_fma_mix_f32 v108, v140, s62, v108 op_sel:[0,0,0] op_sel_hi:[1,0,0]
  v_fma_mix_f32 v109, v140, s62, v109 op_sel:[1,0,0] op_sel_hi:[1,0,0]
  v_fma_mix_f32 v110, v141, s62, v110 op_sel:[0,0,0] op_sel_hi:[1,0,0]
  v_fma_mix_f32 v111, v141, s62, v111 op_sel:[1,0,0] op_sel_hi:[1,0,0]
  s_cmp_eq_u64 s[64:65], 0
  s_cbranch_scc1 L_hg_ok
  s_cmp_eq_u32 s94, 0
  s_cbranch_scc1 L_hg_ok
  s_sub_u32 s94, s94, 1
  s_branch L_hg
L_hg_ok:
  s_mov_b32 exec_hi, 0xffff
  s_barrier
  ds_read_b128 v[72:75], v196 offset:0
  ds_read_b128 v[76:79], v197 offset:768
  ds_read_b128 v[80:83], v198 offset:1536
  ds_read_b128 v[84:87], v196 offset:2304
  s_waitcnt lgkmcnt(3)
  v_fmac_f32 v108, s63, v72
  v_fmac_f32 v109, s63, v73
  v_fmac_f32 v110, s63, v74
  v_fmac_f32 v111, s63, v75
  s_waitcnt lgkmcnt(2)
  v_fmac_f32 v108, s63, v76
  v_fmac_f32 v109, s63, v77
  v_fmac_f32 v110, s63, v78
  v_fmac_f32 v111, s63, v79
  s_waitcnt lgkmcnt(1)
  v_fmac_f32 v108, s63, v80
  v_fmac_f32 v109, s63, v81
  v_fmac_f32 v110, s63, v82
  v_fmac_f32 v111, s63, v83
  s_waitcnt lgkmcnt(0)
  v_fmac_f32 v108, s63, v84
  v_fmac_f32 v109, s63, v85
  v_fmac_f32 v110, s63, v86
  v_fmac_f32 v111, s63, v87
  v_cvt_pk_bf16_f32 v108, v108, v109
  v_cvt_pk_bf16_f32 v109, v110, v111
  global_store_dwordx2 v21, v[108:109], s[26:27]
L_end:
  s_endpgm
.p2align 6
.type L_order,@object
L_order:
  .long 0x76afedcb, 0x45321098, 0x500000, 0x300, 0x40, 0x231500, 0x4, 0x0
  .long 0x2e001e, 0x4e003e, 0x6e005e, 0x8d007e, 0xae009e, 0xce00be, 0xee00de, 0xf00fe
  .long 0x96afedcb, 0x74321058, 0x700000, 0x700, 0x70, 0x271700, 0x7, 0x0
  .long 0x270007, 0x470037, 0x670057, 0x870077, 0xa70097, 0xc700b7, 0xe700d7, 0x1f00f7
  .long 0x765aedfb, 0xc4321098, 0xd00000, 0xf00, 0xc0, 0x2f1d00, 0xc, 0x0
  .long 0x110001, 0x410031, 0x610051, 0x810071, 0xa10091, 0xc100b1, 0xe100d1, 0x2f00f1
  .long 0x785fedcb, 0x6432109a, 0x900000, 0x200, 0x60, 0x221900, 0x6, 0x0
  .long 0x160006, 0x460026, 0x660056, 0x860076, 0xa60096, 0xc600b6, 0xe600d6, 0x3f00f6
  .long 0x765faecb, 0xd4321098, 0xf00000, 0xd00, 0xd0, 0x2d1f00, 0xd, 0x0
  .long 0x120002, 0x320022, 0x620052, 0x820072, 0xa20092, 0xc200b2, 0xe200d2, 0x4f00f2
  .long 0x765fedca, 0xb4321098, 0x800000, 0xf00, 0xb0, 0x2f1800, 0xb, 0x0
  .long 0x100000, 0x300020, 0x600040, 0x800070, 0xa00090, 0xc000b0, 0xe000d0, 0x5f00f0
  .long 0x76afedcb, 0x24351098, 0x400000, 0x0, 0x20, 0x201400, 0x2, 0x0
  .long 0x1c000c, 0x3c002c, 0x5c004c, 0x8c007c, 0xac009c, 0xcc00bc, 0xea00dc, 0x6f00fc
  .long 0x76afedcb, 0x14325098, 0x400000, 0x400, 0x10, 0x241400, 0x1, 0x0
  .long 0x1b000b, 0x3b002b, 0x5b004b, 0x8b006b, 0xab009b, 0xcb00bb, 0xeb00db, 0x7f00fb
  .long 0x76afedcb, 0x35421098, 0x500000, 0x300, 0x30, 0x231500, 0x3, 0x0
  .long 0x1d000d, 0x3d002d, 0x5d004d, 0x7d006d, 0xad009d, 0xcd00bd, 0xed00dd, 0x8f00fd
  .long 0x76afedcb, 0x94321058, 0x700000, 0x700, 0x90, 0x271700, 0x9, 0x0
  .long 0x170009, 0x390029, 0x590049, 0x790069, 0xa90089, 0xc900b9, 0xe900d9, 0x9f00f9
  .long 0x765aedcb, 0xf4321098, 0xd00000, 0xf00, 0xf0, 0x2f1d00, 0xf, 0x0
  .long 0x140004, 0x340021, 0x540044, 0x740064, 0x940084, 0xc400b4, 0xe400d4, 0xaf00f4
  .long 0x765fedcb, 0x8432109a, 0x900000, 0x200, 0x80, 0x221900, 0x8, 0x0
  .long 0x180008, 0x360028, 0x580048, 0x780068, 0x980088, 0xc800a8, 0xe800d8, 0xbf00f8
  .long 0x765fadcb, 0xe4321098, 0xf00000, 0xd00, 0xe0, 0x2d1f00, 0xe, 0x0
  .long 0x130003, 0x330023, 0x530042, 0x730063, 0x930083, 0xb300a3, 0xe300d3, 0xcf00f3
  .long 0x765fedcb, 0xa4321098, 0x800000, 0xf00, 0xaf, 0x18002f, 0xa, 0x0
  .long 0x500024, 0x14400a4, 0x2b40234, 0x6f40674, 0x7830703, 0xc1408c2, 0xd630c94, 0xdf0de3
  .long 0x76afedcb, 0x4351298, 0x400000, 0x0, 0x0, 0x201400, 0x0, 0x0
  .long 0x1a000a, 0x3a002a, 0x5a004a, 0x7a006a, 0x9a008a, 0xba00aa, 0xda00ca, 0xef00fa
  .long 0x76afedcb, 0x54321098, 0x400000, 0x400, 0x54, 0x240014, 0x5, 0x0
  .long 0x7b006c, 0x1cc00ec, 0x4be043e, 0x58d050d, 0x7de075e, 0xe1c084d, 0xe9c0e2e, 0xff0eae
  .long 0x765fadce, 0xb4321098, 0x11911111, 0x11111e11, 0xb1, 0x2e1901, 0xb, 0x0
  .long 0x1200110, 0x1400130, 0x1600150, 0x1800170, 0x1a00190, 0x1c001b0, 0x1e001d0, 0x10f01f0
  .long 0x76afedcb, 0x94321058, 0x11b11111, 0x11111011, 0x91, 0x201b01, 0x9, 0x0
  .long 0x1290109, 0x1490139, 0x1690159, 0x1890179, 0x1a90199, 0x1c901b9, 0x1e901d9, 0x11f01f9
  .long 0x765fedcb, 0x8432109a, 0x11a11111, 0x11111111, 0x81, 0x211a01, 0x8, 0x0
  .long 0x1180108, 0x1480138, 0x1680158, 0x1880178, 0x1a70198, 0x1c801b8, 0x1e801d8, 0x12f01f8
  .long 0x765feadb, 0xc4321098, 0x11811111, 0x11111e11, 0xc1, 0x2e1801, 0xc, 0x0
  .long 0x1110101, 0x1410121, 0x1610151, 0x1810171, 0x1a10191, 0x1c101b1, 0x1e101d1, 0x13f01f1
  .long 0x765aedcb, 0xf4321098, 0x11e11111, 0x11111f11, 0xf1, 0x2f1e01, 0xf, 0x0
  .long 0x1140104, 0x1340124, 0x1640154, 0x1840174, 0x1a40194, 0x1c401b4, 0x1e401d4, 0x14f01f4
  .long 0x76afedcb, 0x45321098, 0x11311111, 0x11111811, 0x41, 0x281301, 0x4, 0x0
  .long 0x11e010e, 0x13e012e, 0x16e014e, 0x18e017e, 0x1ae019e, 0x1ce01be, 0x1ee01dd, 0x15f01fe
  .long 0x7a5fedcb, 0x64321098, 0x11811111, 0x11111311, 0x61, 0x231801, 0x6, 0x0
  .long 0x1160106, 0x1360126, 0x1560146, 0x1860176, 0x1a60196, 0x1c601b6, 0x1e601d6, 0x16f01f6
  .long 0x76afedcb, 0x14325098, 0x11011111, 0x11111311, 0x11, 0x231001, 0x1, 0x0
  .long 0x11b010b, 0x13b012b, 0x15b014b, 0x18b016b, 0x1ab019b, 0x1cb01bb, 0x1eb01db, 0x17f01fa
  .long 0x765fadcb, 0xe4321098, 0x11911111, 0x11111e11, 0xe1, 0x2e1901, 0xe, 0x0
  .long 0x1130100, 0x1330123, 0x1530143, 0x1730163, 0x1a30193, 0x1c301b3, 0x1e301d3, 0x18f01f3
  .long 0x76afedcb, 0x54321098, 0x11b11111, 0x11111011, 0x5b, 0x20011b, 0x5, 0x0
  .long 0x3090119, 0x5450389, 0xc2505c5, 0xd650ca5, 0xe750de5, 0xf380ef5, 0xfb80f55, 0x19f0fd5
  .long 0x865fedcb, 0x7432109a, 0x11a11111, 0x11111111, 0x71, 0x211a01, 0x7, 0x0
  .long 0x1170107, 0x1370127, 0x1570147, 0x1770167, 0x1970187, 0x1c701b7, 0x1e701d7, 0x1af01f7
  .long 0x765feacb, 0xd4321098, 0x11811111, 0x11111e11, 0xd1, 0x2e1801, 0xd, 0x0
  .long 0x1120102, 0x1310122, 0x1520142, 0x1720162, 0x1920182, 0x1c201a2, 0x1e201d2, 0x1bf01f2
  .long 0x76afedcb, 0x24351098, 0x11411111, 0x11111711, 0x21, 0x271401, 0x2, 0x0
  .long 0x11c010c, 0x13c012c, 0x15c014c, 0x17c016c, 0x19c018c, 0x1bc01ac, 0x1ec01dc, 0x1cf01fc
  .long 0x76afedcb, 0x35421098, 0x11311111, 0x11111811, 0x31, 0x281301, 0x3, 0x0
  .long 0x11d010d, 0x13d012d, 0x15d014d, 0x17d016d, 0x19d018d, 0x1bd01ad, 0x1ed01cd, 0x1df01fd
  .long 0x765fedcb, 0xa4321098, 0x11811111, 0x11111311, 0xa3, 0x180123, 0xa, 0x0
  .long 0x850005, 0x1750166, 0x62501f5, 0x74506a5, 0xbd507c5, 0xd350d15, 0xdb50d95, 0x1ef0e55
  .long 0x76afedcb, 0x4325198, 0x11011111, 0x11111311, 0x1, 0x231001, 0x0, 0x0
  .long 0x11a010a, 0x13a012a, 0x15a014a, 0x17a016a, 0x19a018a, 0x1ba01aa, 0x1da01ca, 0x1ff01ea
  .long 0x76afedcb, 0x45321098, 0x22222222, 0x22222a22, 0x42, 0x2a1202, 0x4, 0x0
  .long 0x22e021e, 0x24e023e, 0x26e025e, 0x28b027e, 0x2ae029e, 0x2ce02be, 0x2ee02de, 0x20f02fe
  .long 0x7a5fedcb, 0x64321098, 0x22c22222, 0x22222622, 0x62, 0x261c02, 0x6, 0x0
  .long 0x2260206, 0x2460236, 0x2660256, 0x2860276, 0x2a60296, 0x2c602b6, 0x2e602d6, 0x21f02f6
  .long 0x76afedcb, 0x54321098, 0x22922222, 0x22222522, 0x59, 0x250219, 0x5, 0x0
  .long 0xb50035, 0x1850105, 0x2f502a8, 0x3550315, 0x3d50395, 0x6650575, 0x94506e5, 0x22f09c5
  .long 0x765aedcb, 0xf4321098, 0x22f22222, 0x22222f22, 0xf2, 0x2f1f02, 0xf, 0x0
  .long 0x2140204, 0x2440224, 0x2640254, 0x2840274, 0x2a40294, 0x2c402b2, 0x2e402d4, 0x23f02f4
  .long 0x76afedcb, 0x24351098, 0x22222222, 0x22222522, 0x22, 0x251202, 0x2, 0x0
  .long 0x21c020c, 0x23c022c, 0x26c025c, 0x28c027c, 0x2ac029c, 0x2ca02bc, 0x2ec02dc, 0x24f02fc
  .long 0x965fedcb, 0x743210a8, 0x22722222, 0x22222022, 0x72, 0x201702, 0x7, 0x0
  .long 0x2170207, 0x2370227, 0x2670247, 0x2870277, 0x2a70297, 0x2c702b7, 0x2e702d7, 0x25f02f7
  .long 0x765fadce, 0xb4321098, 0x22a22222, 0x22222e22, 0xb2, 0x2e1a02, 0xb, 0x0
  .long 0x2100200, 0x2300220, 0x2500240, 0x2800270, 0x2a00290, 0x2c002b0, 0x2e002d0, 0x26f02f0
  .long 0x76afedcb, 0x34521098, 0x22222222, 0x22222822, 0x32, 0x281202, 0x3, 0x0
  .long 0x21d020d, 0x23d022d, 0x25d024d, 0x28d026d, 0x2ad029d, 0x2cd02bd, 0x2ed02dd, 0x27f02fd
  .long 0x76afedcb, 0x15324098, 0x22222222, 0x22222a22, 0x12, 0x2a1202, 0x1, 0x0
  .long 0x21b020b, 0x23b022b, 0x25b024b, 0x27b026b, 0x2ab029b, 0x2cb02bb, 0x2eb02db, 0x28f02fb
  .long 0x765fedcb, 0xa4321098, 0x22c22222, 0x22222622, 0xa6, 0x1c0226, 0xa, 0x0
  .long 0x3650216, 0x42503e5, 0x73504a5, 0x7750755, 0x7d507b5, 0xb4507f5, 0xd050bc5, 0x29f0d85
  .long 0x76afedcb, 0x84321095, 0x22922222, 0x22222522, 0x82, 0x251902, 0x8, 0x0
  .long 0x2180208, 0x2380228, 0x2580248, 0x2780268, 0x2980288, 0x2c802b8, 0x2e802d8, 0x2af02f8
  .long 0x765aefcb, 0xd4321098, 0x22f22222, 0x22222f22, 0xd2, 0x2f1f02, 0xd, 0x0
  .long 0x2120202, 0x2320222, 0x2520242, 0x2720262, 0x2920282, 0x2c202a2, 0x2e202d2, 0x2bf02f2
  .long 0x76afedcb, 0x4351298, 0x22222222, 0x22222522, 0x2, 0x251202, 0x0, 0x0
  .long 0x21a020a, 0x23a022a, 0x25a024a, 0x27a026a, 0x29a028a, 0x2ba02aa, 0x2ea02da, 0x2cf02fa
  .long 0x765fedcb, 0x943210a8, 0x22722222, 0x22222022, 0x92, 0x201702, 0x9, 0x0
  .long 0x2190209, 0x2390229, 0x2570249, 0x2790269, 0x2990289, 0x2b902a9, 0x2e902c9, 0x2df02f9
  .long 0x765fadcb, 0xe4321098, 0x22a22222, 0x22222e22, 0xe2, 0x2e1a02, 0xe, 0x0
  .long 0x2130203, 0x2330223, 0x2530243, 0x2730260, 0x2930283, 0x2b302a3, 0x2d302c3, 0x2ef02f3
  .long 0x765fedab, 0xc4321098, 0x22922222, 0x22222d22, 0xc2, 0x2d1902, 0xc, 0x0
  .long 0x2110201, 0x2310221, 0x2510241, 0x2710261, 0x2910281, 0x2b102a1, 0x2d102c1, 0x2ff02e1
  .long 0x76afedcb, 0x84321059, 0x33b33333, 0x33333133, 0x83, 0x211b03, 0x8, 0x0
  .long 0x3280318, 0x3480338, 0x3680358, 0x3880378, 0x3a80398, 0x3c803b8, 0x3e803d8, 0x30f03f8
  .long 0x765aedcb, 0xf4321098, 0x33933333, 0x33333e33, 0xf3, 0x2e1903, 0xf, 0x0
  .long 0x3240304, 0x3440334, 0x3640354, 0x3840374, 0x3a40394, 0x3c403b4, 0x3e403d4, 0x31f03f4
  .long 0x76afedcb, 0x4321598, 0x33033333, 0x33333233, 0x3, 0x221003, 0x0, 0x0
  .long 0x31a030a, 0x34a033a, 0x36a035a, 0x38a037a, 0x3aa039a, 0x3ca03ba, 0x3ea03da, 0x32f03fa
  .long 0x765fedac, 0xb4321098, 0x33a33333, 0x33333b33, 0xb3, 0x2b1a03, 0xb, 0x0
  .long 0x3100300, 0x3400320, 0x3600350, 0x3800370, 0x3a00390, 0x3c003b0, 0x3e003d0, 0x33f03f0
  .long 0x76afedcb, 0x24531098, 0x33133333, 0x33333a33, 0x23, 0x2a1103, 0x2, 0x0
  .long 0x31c030c, 0x33c032c, 0x36c035c, 0x38c037c, 0x3ac039c, 0x3cc03bc, 0x3ec03dc, 0x34f03fc
  .long 0xa65fedcb, 0x74321098, 0x33933333, 0x33333133, 0x73, 0x211903, 0x7, 0x0
  .long 0x3170307, 0x3370327, 0x3670347, 0x3870377, 0x3a70397, 0x3c703b7, 0x3e703d6, 0x35f03f7
  .long 0x76afedcb, 0x15324098, 0x33333333, 0x33333633, 0x13, 0x261303, 0x1, 0x0
  .long 0x31b030b, 0x33b032b, 0x35b034b, 0x38b037b, 0x3ab039b, 0x3cb03bb, 0x3eb03db, 0x36f03fb
  .long 0x765fadcb, 0xe4321098, 0x33e33333, 0x33333a33, 0xe3, 0x2a1e03, 0xe, 0x0
  .long 0x3130303, 0x3330323, 0x3530343, 0x3830363, 0x3a30393, 0x3c303b3, 0x3e303d3, 0x37f03f2
  .long 0x76afedcb, 0x94321058, 0x33b33333, 0x33333133, 0x93, 0x211b03, 0x9, 0x0
  .long 0x3190308, 0x3390329, 0x3590349, 0x3790369, 0x3a90399, 0x3c903b9, 0x3e903d9, 0x38f03f9
  .long 0x765fedcb, 0xa4321098, 0x33933333, 0x33333e33, 0xae, 0x19032e, 0xa, 0x0
  .long 0x1320103, 0x1b20183, 0x2e30263, 0x4740314, 0x82304f4, 0xd5208a3, 0xe420dd2, 0x39f0ec2
  .long 0x76afedcb, 0x54321098, 0x33033333, 0x33333233, 0x50, 0x220310, 0x5, 0x0
  .long 0x1fb017b, 0x65e032a, 0x73c06de, 0xaeb07bc, 0xc6a0c4d, 0xd0c0ccd, 0xf1e0d8c, 0x3af0f9e
  .long 0x765fedab, 0xc4321098, 0x33a33333, 0x33333b33, 0xc3, 0x2b1a03, 0xc, 0x0
  .long 0x3110301, 0x3300321, 0x3510341, 0x3710361, 0x3910381, 0x3c103a1, 0x3e103d1, 0x3bf03f1
  .long 0x76afedcb, 0x34521098, 0x33133333, 0x33333a33, 0x33, 0x2a1103, 0x3, 0x0
  .long 0x31d030d, 0x33d032d, 0x35d034c, 0x37d036d, 0x39d038d, 0x3bd03ad, 0x3ed03dd, 0x3cf03fd
  .long 0xa75fedcb, 0x64321098, 0x33933333, 0x33333133, 0x63, 0x211903, 0x6, 0x0
  .long 0x3160306, 0x3360326, 0x3560346, 0x3760366, 0x3960386, 0x3b603a6, 0x3e603c6, 0x3df03f6
  .long 0x76afedcb, 0x45321098, 0x33333333, 0x33333633, 0x43, 0x261303, 0x4, 0x0
  .long 0x31e030e, 0x33e032e, 0x35e034e, 0x37e036b, 0x39e038e, 0x3be03ae, 0x3de03ce, 0x3ef03fe
  .long 0x765faecb, 0xd4321098, 0x33e33333, 0x33333a33, 0xd3, 0x2a1e03, 0xd, 0x0
  .long 0x3120302, 0x3320322, 0x3520342, 0x3720362, 0x3920382, 0x3b203a2, 0x3d203c2, 0x3ff03e2
  .long 0x765fedcb, 0x8432109a, 0x44a44444, 0x44444944, 0x84, 0x291a04, 0x8, 0x0
  .long 0x4280418, 0x4480438, 0x4680458, 0x4870478, 0x4a80498, 0x4c804b8, 0x4e804d8, 0x40f04f8
  .long 0x76afedcb, 0x4521398, 0x44544444, 0x44444544, 0x4, 0x251504, 0x0, 0x0
  .long 0x42a040a, 0x44a043a, 0x46a045a, 0x48a047a, 0x4aa049a, 0x4ca04ba, 0x4ea04da, 0x41f04fa
  .long 0x76afedcb, 0x24351098, 0x44344444, 0x44444644, 0x24, 0x261304, 0x2, 0x0
  .long 0x41c040c, 0x44c043c, 0x46c045c, 0x48c047c, 0x4ac049c, 0x4cc04bc, 0x4ec04dc, 0x42f04fc
  .long 0x76afedcb, 0x45321098, 0x44444444, 0x44444a44, 0x44, 0x2a1404, 0x4, 0x0
  .long 0x41e040e, 0x44e042e, 0x46e045e, 0x48e047e, 0x4ae049e, 0x4ce04bb, 0x4ee04de, 0x43f04fe
  .long 0x765fadce, 0xb4321098, 0x44744444, 0x44444b44, 0xb4, 0x2b1704, 0xb, 0x0
  .long 0x4100400, 0x4300420, 0x4600450, 0x4800470, 0x4a00490, 0x4c004b0, 0x4e004d0, 0x44f04f0
  .long 0x765feacb, 0xd4321098, 0x44644444, 0x44444c44, 0xd4, 0x2c1604, 0xd, 0x0
  .long 0x4120402, 0x4320422, 0x4620442, 0x4820472, 0x4a20492, 0x4c204b2, 0x4e204d2, 0x45f04f2
  .long 0x79afedcb, 0x64321058, 0x44744444, 0x44444744, 0x64, 0x271704, 0x6, 0x0
  .long 0x4160406, 0x4360426, 0x4560446, 0x4860476, 0x4a60496, 0x4c604b6, 0x4e604d6, 0x46f04f6
  .long 0x765aedcb, 0xf4321098, 0x44644444, 0x44444e44, 0xf4, 0x2e1604, 0xf, 0x0
  .long 0x4140404, 0x4340424, 0x4540444, 0x4840464, 0x4a40494, 0x4c404b4, 0x4e404d4, 0x47f04f1
  .long 0x865fedcb, 0x7432109a, 0x44a44444, 0x44444944, 0x74, 0x291a04, 0x7, 0x0
  .long 0x4170407, 0x4370427, 0x4570447, 0x4770467, 0x4a70497, 0x4c704b7, 0x4e704d7, 0x48f04f7
  .long 0x76afedcb, 0x34521098, 0x44544444, 0x44444544, 0x34, 0x251504, 0x3, 0x0
  .long 0x41a040d, 0x43d042d, 0x45d044d, 0x47d046d, 0x4ad048d, 0x4cd04bd, 0x4ed04dd, 0x49f04fd
  .long 0x76afedcb, 0x54321098, 0x44344444, 0x44444644, 0x53, 0x260413, 0x5, 0x0
  .long 0x1de015e, 0x3ee036e, 0x81b042c, 0x89b087e, 0x93d08fe, 0xd4e09bd, 0xf0d0dce, 0x4af0f8d
  .long 0x76afedcb, 0x15324098, 0x44444444, 0x44444a44, 0x14, 0x2a1404, 0x1, 0x0
  .long 0x41b040b, 0x43b042b, 0x45b044b, 0x47b046b, 0x49b048b, 0x4cb04ab, 0x4eb04db, 0x4bf04fb
  .long 0x765fadcb, 0xe4321098, 0x44744444, 0x44444b44, 0xe4, 0x2b1704, 0xe, 0x0
  .long 0x4130403, 0x4330423, 0x4530440, 0x4730463, 0x4930483, 0x4b304a3, 0x4e304d3, 0x4cf04f3
  .long 0x765fedcb, 0xa4321098, 0x44644444, 0x44444c44, 0xac, 0x16042c, 0xa, 0x0
  .long 0x5230452, 0x76405a3, 0x94207e4, 0xb1109c2, 0xb910b34, 0xc030bb4, 0xf740c83, 0x4df0ff4
  .long 0x76afedcb, 0x94321058, 0x44744444, 0x44444744, 0x94, 0x271704, 0x9, 0x0
  .long 0x4190409, 0x4390429, 0x4590449, 0x4790466, 0x4990489, 0x4b904a9, 0x4d904c9, 0x4ef04f9
  .long 0x765aedfb, 0xc4321098, 0x44644444, 0x44444e44, 0xc4, 0x2e1604, 0xc, 0x0
  .long 0x4110401, 0x4310421, 0x4510441, 0x4710461, 0x4910481, 0x4b104a1, 0x4d104c1, 0x4ff04e1
  .long 0x76afedcb, 0x34521098, 0x55455555, 0x55555855, 0x35, 0x281405, 0x3, 0x0
  .long 0x52d051d, 0x54d053d, 0x56d055d, 0x58c057d, 0x5ad059d, 0x5cd05bd, 0x5ed05dd, 0x50f05fd
  .long 0x765fedcb, 0x943210a8, 0x55f55555, 0x55555a55, 0x95, 0x2a1f05, 0x9, 0x0
  .long 0x5290509, 0x5490539, 0x5690559, 0x5890579, 0x5a90596, 0x5c905b9, 0x5e905d9, 0x51f05f9
  .long 0x765fadeb, 0xc4321098, 0x55755555, 0x55555c55, 0xc5, 0x2c1705, 0xc, 0x0
  .long 0x5110501, 0x5410531, 0x5610551, 0x5810571, 0x5a10591, 0x5c105b1, 0x5e105d1, 0x52f05f1
  .long 0x765feacd, 0xb4321098, 0x55c55555, 0x55555d55, 0xb5, 0x2d1c05, 0xb, 0x0
  .long 0x5100500, 0x5400520, 0x5600550, 0x5800570, 0x5a00590, 0x5c005b0, 0x5e005d0, 0x53f05f0
  .long 0xa65fedcb, 0x74321098, 0x55b55555, 0x55555455, 0x75, 0x241b05, 0x7, 0x0
  .long 0x5170507, 0x5370527, 0x5670557, 0x5870577, 0x5a70597, 0x5c705b7, 0x5e705d7, 0x54f05f7
  .long 0x76afedcb, 0x84321095, 0x55f55555, 0x55555755, 0x85, 0x271f05, 0x8, 0x0
  .long 0x5180508, 0x5380528, 0x5680548, 0x5880578, 0x5a80598, 0x5c805b8, 0x5e805d8, 0x55f05f8
  .long 0x76afedcb, 0x4325198, 0x55255555, 0x55555255, 0x5, 0x221205, 0x0, 0x0
  .long 0x51a050a, 0x53a052a, 0x55a054a, 0x58a057a, 0x5aa059a, 0x5ca05ba, 0x5ea05da, 0x56f05fa
  .long 0x765aedcb, 0xf4321098, 0x55955555, 0x55555d55, 0xf5, 0x2d1905, 0xf, 0x0
  .long 0x5140504, 0x5340524, 0x5540544, 0x5840564, 0x5a40594, 0x5c405b4, 0x5e405d4, 0x57f05f4
  .long 0x76afedcb, 0x24531098, 0x55455555, 0x55555855, 0x25, 0x281405, 0x2, 0x0
  .long 0x51c050c, 0x53c052c, 0x55c054c, 0x57c056c, 0x5ac059c, 0x5cc05bc, 0x5ec05dc, 0x58f05fc
  .long 0x795fedcb, 0x643210a8, 0x55f55555, 0x55555a55, 0x65, 0x2a1f05, 0x6, 0x0
  .long 0x5160506, 0x5360526, 0x5560546, 0x5760566, 0x5a60586, 0x5c605b6, 0x5e605d6, 0x59f05f6
  .long 0x765fadcb, 0xe4321098, 0x55755555, 0x55555c55, 0xe5, 0x2c1705, 0xe, 0x0
  .long 0x5130503, 0x5330521, 0x5530543, 0x5730563, 0x5930583, 0x5c305b3, 0x5e305d3, 0x5af05f3
  .long 0x765feacb, 0xd4321098, 0x55c55555, 0x55555d55, 0xd5, 0x2d1c05, 0xd, 0x0
  .long 0x5120502, 0x5300522, 0x5520542, 0x5720562, 0x5920582, 0x5c205a2, 0x5e205d2, 0x5bf05f2
  .long 0x765fedcb, 0xa4321098, 0x55b55555, 0x55555455, 0xa4, 0x1b0524, 0xa, 0x0
  .long 0xf50075, 0x6350547, 0x81506b5, 0x8950855, 0xb6508d5, 0xc290be5, 0xf050ca9, 0x5cf0f85
  .long 0x76afedcb, 0x54321098, 0x55f55555, 0x55555755, 0x5f, 0x27051f, 0x5, 0x0
  .long 0xc50045, 0x2b50235, 0x5580515, 0x8650595, 0xd2508e5, 0xdf50d75, 0xe850e05, 0x5df0fa5
  .long 0x76afedcb, 0x14325098, 0x55255555, 0x55555255, 0x15, 0x221205, 0x1, 0x0
  .long 0x51b050b, 0x53b052b, 0x55b054b, 0x57b056a, 0x59b058b, 0x5bb05ab, 0x5db05cb, 0x5ef05fb
  .long 0x76afedcb, 0x45321098, 0x55255555, 0x55555855, 0x45, 0x281205, 0x4, 0x0
  .long 0x51e050e, 0x53e052e, 0x55e054e, 0x57e056e, 0x59e058e, 0x5be05ae, 0x5de05ce, 0x5ff05ee
  .long 0x76afedcb, 0x24351098, 0x66166666, 0x66666566, 0x26, 0x251106, 0x2, 0x0
  .long 0x62c061c, 0x64c063c, 0x66c065c, 0x68c067c, 0x6ac069c, 0x6cc06bc, 0x6ec06dc, 0x60f06fc
  .long 0x765feacd, 0xb4321098, 0x66a66666, 0x66666b66, 0xb6, 0x2b1a06, 0xb, 0x0
  .long 0x6200600, 0x6400630, 0x6600650, 0x6800670, 0x6a00690, 0x6c006b0, 0x6e006d0, 0x61f06f0
  .long 0x76afedcb, 0x94321058, 0x66e66666, 0x66666366, 0x96, 0x231e06, 0x9, 0x0
  .long 0x6190609, 0x6490639, 0x6690659, 0x6890679, 0x6a70699, 0x6c906b9, 0x6e906d9, 0x62f06f9
  .long 0x76afedcb, 0x4325198, 0x66166666, 0x66666466, 0x6, 0x241106, 0x0, 0x0
  .long 0x61a060a, 0x64a062a, 0x66a065a, 0x68a067a, 0x6aa069a, 0x6ca06ba, 0x6ea06da, 0x63f06fa
  .long 0x76afedcb, 0x84321095, 0x66566666, 0x66666966, 0x86, 0x291506, 0x8, 0x0
  .long 0x6180608, 0x6380628, 0x6680658, 0x6880678, 0x6a80698, 0x6c606b8, 0x6e806d8, 0x64f06f8
  .long 0x76afedcb, 0x45321098, 0x66066666, 0x66666566, 0x46, 0x251006, 0x4, 0x0
  .long 0x61e060e, 0x63e062e, 0x66e064e, 0x68e067e, 0x6ae069e, 0x6ce06be, 0x6ee06dd, 0x65f06fe
  .long 0x765fedcb, 0xa4321098, 0x66966666, 0x66666a66, 0xaa, 0x19062a, 0xa, 0x0
  .long 0x2850205, 0x3730345, 0x3f303c5, 0x4b50435, 0x5990519, 0x92506e3, 0xb5209a5, 0x66f0ed4
  .long 0x765aedfb, 0xc4321098, 0x66866666, 0x66666f66, 0xc6, 0x2f1806, 0xc, 0x0
  .long 0x6110601, 0x6310621, 0x6510641, 0x6810661, 0x6a10691, 0x6c106b1, 0x6e106d1, 0x67f06f1
  .long 0x76afedcb, 0x54321098, 0x66166666, 0x66666566, 0x51, 0x250611, 0x5, 0x0
  .long 0x3cd034d, 0x63b060c, 0x91e06bb, 0xa2d099e, 0xb6d0aad, 0xbdc0b7e, 0xbfe0bed, 0x68f0e5d
  .long 0x765feacb, 0xd4321098, 0x66a66666, 0x66666b66, 0xd6, 0x2b1a06, 0xd, 0x0
  .long 0x6100602, 0x6320622, 0x6520642, 0x6720662, 0x6a20682, 0x6c206b2, 0x6e206d2, 0x69f06f2
  .long 0x96afedcb, 0x74321058, 0x66e66666, 0x66666366, 0x76, 0x231e06, 0x7, 0x0
  .long 0x6170607, 0x6370627, 0x6570647, 0x6770667, 0x6970687, 0x6c706b7, 0x6e706d7, 0x6af06f7
  .long 0x76afedcb, 0x14325098, 0x66166666, 0x66666466, 0x16, 0x241106, 0x1, 0x0
  .long 0x61b060b, 0x63a062b, 0x65b064b, 0x67b066b, 0x69b068b, 0x6cb06ab, 0x6eb06db, 0x6bf06fb
  .long 0x78afedcb, 0x64321095, 0x66566666, 0x66666966, 0x66, 0x291506, 0x6, 0x0
  .long 0x6160606, 0x6360626, 0x6560646, 0x6760666, 0x6960686, 0x6b606a6, 0x6e606d6, 0x6cf06f6
  .long 0x76afedcb, 0x35421098, 0x66066666, 0x66666566, 0x36, 0x251006, 0x3, 0x0
  .long 0x61d060d, 0x63d062d, 0x65d064d, 0x67d066d, 0x69d068d, 0x6bd06ad, 0x6ed06cd, 0x6df06fd
  .long 0x765fadcb, 0xe4321098, 0x66966666, 0x66666a66, 0xe6, 0x2a1906, 0xe, 0x0
  .long 0x6130603, 0x6330623, 0x6530643, 0x6730663, 0x6930683, 0x6b306a3, 0x6d306c3, 0x6ef06f3
  .long 0x765aedcb, 0xf4321098, 0x66866666, 0x66666f66, 0xf6, 0x2f1806, 0xf, 0x0
  .long 0x6140604, 0x6340624, 0x6540644, 0x6710664, 0x6940684, 0x6b406a4, 0x6d406c4, 0x6ff06e4
  .long 0x765fadcb, 0xe4321098, 0x77d77777, 0x77777f77, 0xe7, 0x2f1d07, 0xe, 0x0
  .long 0x7230713, 0x7430733, 0x7630753, 0x7800773, 0x7a30793, 0x7c307b3, 0x7e307d3, 0x70f07f3
  .long 0x76afedcb, 0x4321598, 0x77277777, 0x77777177, 0x7, 0x211207, 0x0, 0x0
  .long 0x72a070a, 0x74a073a, 0x76a075a, 0x78a077a, 0x7aa079a, 0x7ca07ba, 0x7ea07da, 0x71f07fa
  .long 0x765fedcb, 0xa4321098, 0x77877777, 0x77777d77, 0xad, 0x18072d, 0xa, 0x0
  .long 0xc30043, 0x53202f1, 0x5b20574, 0x96307a1, 0xa0409e3, 0xa840a13, 0xf520a93, 0x72f0fd2
  .long 0x76afedcb, 0x24351098, 0x77077777, 0x77777677, 0x27, 0x261007, 0x2, 0x0
  .long 0x71c070c, 0x74c072c, 0x76c075c, 0x78c077c, 0x7ac079c, 0x7cc07bb, 0x7ec07dc, 0x73f07fc
  .long 0x56afedcb, 0x74321098, 0x77677777, 0x77777377, 0x77, 0x231607, 0x7, 0x0
  .long 0x7170707, 0x7370727, 0x7670757, 0x7870777, 0x7a70797, 0x7c607b7, 0x7e707d7, 0x74f07f7
  .long 0x76afedcb, 0x45321098, 0x77477777, 0x77777677, 0x47, 0x261407, 0x4, 0x0
  .long 0x71e070e, 0x73e072e, 0x76e074e, 0x78e077e, 0x7ae079e, 0x7ce07be, 0x7ee07dd, 0x75f07fe
  .long 0x765aefcb, 0xd4321098, 0x77e77777, 0x77777c77, 0xd7, 0x2c1e07, 0xd, 0x0
  .long 0x7120702, 0x7320722, 0x7520742, 0x7820772, 0x7a20792, 0x7c207b2, 0x7e207d2, 0x76f07f2
  .long 0x76afedcb, 0x94321058, 0x77c77777, 0x77777677, 0x97, 0x261c07, 0x9, 0x0
  .long 0x7190709, 0x7390729, 0x7590749, 0x7890769, 0x7a90799, 0x7c907b9, 0x7e907d9, 0x77f07f8
  .long 0x765fadce, 0xb4321098, 0x77d77777, 0x77777f77, 0xb7, 0x2f1d07, 0xb, 0x0
  .long 0x7100700, 0x7300720, 0x7500740, 0x7700760, 0x7a00790, 0x7c007b0, 0x7e007d0, 0x78f07f0
  .long 0x76afedcb, 0x54321098, 0x77277777, 0x77777177, 0x52, 0x210712, 0x5, 0x0
  .long 0x24c020e, 0x28e027d, 0x56b02cc, 0x5fe05eb, 0xa3e071a, 0xc5e0abe, 0xdad0cde, 0x79f0f2a
  .long 0x765fedab, 0xc4321098, 0x77877777, 0x77777d77, 0xc7, 0x2d1807, 0xc, 0x0
  .long 0x7110701, 0x7310721, 0x7510741, 0x7710761, 0x7910781, 0x7c107b1, 0x7e107d1, 0x7af07f1
  .long 0x76afedcb, 0x14352098, 0x77077777, 0x77777677, 0x17, 0x261007, 0x1, 0x0
  .long 0x71b070b, 0x73b072b, 0x75b074b, 0x77b076b, 0x79b078b, 0x7cb07ab, 0x7eb07db, 0x7bf07fb
  .long 0x57afedcb, 0x64321098, 0x77677777, 0x77777377, 0x67, 0x231607, 0x6, 0x0
  .long 0x7160706, 0x7360726, 0x7560746, 0x7760766, 0x7960786, 0x7b607a6, 0x7e607d6, 0x7cf07f6
  .long 0x76afedcb, 0x35421098, 0x77477777, 0x77777677, 0x37, 0x261407, 0x3, 0x0
  .long 0x71d070d, 0x73d072d, 0x75d074d, 0x77d076d, 0x79d078d, 0x7bd07ad, 0x7ed07cd, 0x7df07fd
  .long 0x765aedcb, 0xf4321098, 0x77e77777, 0x77777c77, 0xf7, 0x2c1e07, 0xf, 0x0
  .long 0x7140704, 0x7340724, 0x7540744, 0x7740762, 0x7940784, 0x7b407a4, 0x7d407c4, 0x7ef07f4
  .long 0x76afedcb, 0x84321059, 0x77c77777, 0x77777677, 0x87, 0x261c07, 0x8, 0x0
  .long 0x7180708, 0x7380728, 0x7580748, 0x7780768, 0x7980788, 0x7b807a8, 0x7d807c8, 0x7ff07e8
  .long 0x765aedcb, 0xf4321098, 0x88e88888, 0x88888b88, 0xf8, 0x2b1e08, 0xf, 0x0
  .long 0x8240814, 0x8440834, 0x8640854, 0x8810874, 0x8a40894, 0x8c408b4, 0x8e408d4, 0x80f08f4
  .long 0x76afedcb, 0x14325098, 0x88388888, 0x88888488, 0x18, 0x241308, 0x1, 0x0
  .long 0x82b080b, 0x84b083b, 0x86b085b, 0x88b087b, 0x8ab089a, 0x8cb08bb, 0x8eb08db, 0x81f08fb
  .long 0x765fadcb, 0xe4321098, 0x88688888, 0x88888e88, 0xe8, 0x2e1608, 0xe, 0x0
  .long 0x8130803, 0x8430833, 0x8630853, 0x8830873, 0x8a00893, 0x8c308b3, 0x8e308d3, 0x82f08f3
  .long 0x96afedcb, 0x74321058, 0x88788888, 0x88888888, 0x78, 0x281708, 0x7, 0x0
  .long 0x8170807, 0x8470827, 0x8670857, 0x8870877, 0x8a70897, 0x8c708b7, 0x8e708d7, 0x83f08f7
  .long 0x76afedcb, 0x34521098, 0x88488888, 0x88888788, 0x38, 0x271408, 0x3, 0x0
  .long 0x81d080d, 0x83d082d, 0x86d085d, 0x88d087d, 0x8ad089d, 0x8cd08bd, 0x8ed08dd, 0x84f08fd
  .long 0x76afedcb, 0x54321098, 0x88e88888, 0x88888488, 0x5e, 0x24081e, 0x5, 0x0
  .long 0x3750145, 0x62903f5, 0x76506a9, 0x80507e5, 0x8c50885, 0xa1508d6, 0xc350a95, 0x85f0cb5
  .long 0x765fedcb, 0x8432109a, 0x88f88888, 0x88888988, 0x88, 0x291f08, 0x8, 0x0
  .long 0x8180808, 0x8380828, 0x8580848, 0x8880878, 0x8a80898, 0x8c808b8, 0x8e808d8, 0x86f08f8
  .long 0x76afedcb, 0x45321098, 0x88388888, 0x88888788, 0x48, 0x271308, 0x4, 0x0
  .long 0x81e080e, 0x83e082e, 0x85e084e, 0x88e086e, 0x8ae089e, 0x8ce08be, 0x8ee08de, 0x87f08fc
  .long 0x765aedfb, 0xc4321098, 0x88e88888, 0x88888b88, 0xc8, 0x2b1e08, 0xc, 0x0
  .long 0x8110801, 0x8310821, 0x8510841, 0x8710861, 0x8a10891, 0x8c108b1, 0x8e108d1, 0x88f08f1
  .long 0x76afedcb, 0x4325198, 0x88388888, 0x88888488, 0x8, 0x241308, 0x0, 0x0
  .long 0x81a080a, 0x83a082a, 0x85a084a, 0x87a086a, 0x8aa088a, 0x8ca08ba, 0x8ea08da, 0x89f08fa
  .long 0x765fadce, 0xb4321098, 0x88688888, 0x88888e88, 0xb8, 0x2e1608, 0xb, 0x0
  .long 0x8100800, 0x8300820, 0x8500840, 0x8700860, 0x8900880, 0x8c008b0, 0x8e008d0, 0x8af08f0
  .long 0x76afedcb, 0x94321058, 0x88788888, 0x88888888, 0x98, 0x281708, 0x9, 0x0
  .long 0x8190809, 0x8370829, 0x8590849, 0x8790869, 0x8990889, 0x8c908a9, 0x8e908d9, 0x8bf08f9
  .long 0x765feacb, 0xd4321098, 0x88e88888, 0x88888f88, 0xd8, 0x2f1e08, 0xd, 0x0
  .long 0x8120802, 0x8320822, 0x8520842, 0x8720862, 0x8920882, 0x8b208a2, 0x8e208d2, 0x8cf08f2
  .long 0x75afedcb, 0x64321098, 0x88e88888, 0x88888488, 0x68, 0x241e08, 0x6, 0x0
  .long 0x8160806, 0x8360826, 0x8560846, 0x8760866, 0x8960886, 0x8b608a6, 0x8e608c6, 0x8df08f6
  .long 0x765fedcb, 0xa4321098, 0x88f88888, 0x88888988, 0xa9, 0x1f0829, 0xa, 0x0
  .long 0x4880408, 0x6c50645, 0xa350868, 0xc550ab5, 0xcd50c75, 0xe250cf5, 0xf150ea5, 0x8ef0f95
  .long 0x76afedcb, 0x25341098, 0x88388888, 0x88888788, 0x28, 0x271308, 0x2, 0x0
  .long 0x81c080c, 0x83c082c, 0x85c084c, 0x87c086c, 0x89c088c, 0x8bc08ac, 0x8dc08cc, 0x8ff08ec
  .long 0x78afedcb, 0x64321095, 0x99799999, 0x99999099, 0x69, 0x201709, 0x6, 0x0
  .long 0x9260916, 0x9460936, 0x9660956, 0x9860976, 0x9a60996, 0x9c609b6, 0x9e609d6, 0x90f09f6
  .long 0x76afedcb, 0x45321098, 0x99199999, 0x99999899, 0x49, 0x281109, 0x4, 0x0
  .long 0x92e090e, 0x94e093e, 0x96e095e, 0x98e097e, 0x9ae099c, 0x9ce09be, 0x9ee09de, 0x91f09fe
  .long 0x76afedcb, 0x14325098, 0x99599999, 0x99999a99, 0x19, 0x2a1509, 0x1, 0x0
  .long 0x91b090b, 0x94b093b, 0x96b095b, 0x98b097b, 0x9ab099b, 0x9cb09bb, 0x9eb09db, 0x92f09fb
  .long 0x76afedcb, 0x4521398, 0x99399999, 0x99999599, 0x9, 0x251309, 0x0, 0x0
  .long 0x91a090a, 0x94a092a, 0x96a095a, 0x98a097a, 0x9aa099a, 0x9ca09ba, 0x9ea09da, 0x93f09fa
  .long 0x765feacb, 0xd4321098, 0x99999999, 0x99999c99, 0xd9, 0x2c1909, 0xd, 0x0
  .long 0x9120902, 0x9320922, 0x9620952, 0x9820972, 0x9a20992, 0x9c009b2, 0x9e209d2, 0x94f09f2
  .long 0x765aedcb, 0xf4321098, 0x99c99999, 0x99999b99, 0xf9, 0x2b1c09, 0xf, 0x0
  .long 0x9140904, 0x9340924, 0x9640944, 0x9840974, 0x9a40994, 0x9c409b4, 0x9e409d4, 0x95f09f4
  .long 0x765fadcb, 0xe4321098, 0x99599999, 0x99999d99, 0xe9, 0x2d1509, 0xe, 0x0
  .long 0x9130903, 0x9330923, 0x9530943, 0x9830973, 0x9a30993, 0x9c309b3, 0x9e109d3, 0x96f09f3
  .long 0x76afedcb, 0x94321058, 0x99d99999, 0x99999599, 0x99, 0x251d09, 0x9, 0x0
  .long 0x9190909, 0x9390929, 0x9590949, 0x9890969, 0x9a90999, 0x9c909b9, 0x9e909d9, 0x97f09f7
  .long 0x76afedcb, 0x84321095, 0x99799999, 0x99999099, 0x89, 0x201709, 0x8, 0x0
  .long 0x9180906, 0x9380928, 0x9580948, 0x9780968, 0x9a80998, 0x9c809b8, 0x9e809d8, 0x98f09f8
  .long 0x76afedcb, 0x25341098, 0x99199999, 0x99999899, 0x29, 0x281109, 0x2, 0x0
  .long 0x91c090c, 0x93c092c, 0x95c094c, 0x97c096c, 0x9ac098c, 0x9cc09bc, 0x9ec09dc, 0x99f09fc
  .long 0x76afedcb, 0x54321098, 0x99599999, 0x99999a99, 0x55, 0x2a0915, 0x5, 0x0
  .long 0x8e000e, 0x49d041d, 0x6c80648, 0x965092b, 0xb5509e5, 0xeb80e38, 0xf750ed5, 0x9af0ff5
  .long 0x76afedcb, 0x34521098, 0x99399999, 0x99999599, 0x39, 0x251309, 0x3, 0x0
  .long 0x91d090d, 0x93a092d, 0x95d094d, 0x97d096d, 0x99d098d, 0x9cd09ad, 0x9ed09dd, 0x9bf09fd
  .long 0x765feacd, 0xb4321098, 0x99999999, 0x99999c99, 0xb9, 0x2c1909, 0xb, 0x0
  .long 0x9100900, 0x9300920, 0x9500940, 0x9700960, 0x9900980, 0x9b009a0, 0x9e009d0, 0x9cf09f0
  .long 0x765fedcb, 0xa4321098, 0x99c99999, 0x99999b99, 0xab, 0x1c092b, 0xa, 0x0
  .long 0x3b10331, 0x4c30443, 0x6920612, 0x8840804, 0xa610954, 0xd240ce2, 0xef30e73, 0x9df0fa3
  .long 0x765fadeb, 0xc4321098, 0x99599999, 0x99999d99, 0xc9, 0x2d1509, 0xc, 0x0
  .long 0x9110901, 0x9310921, 0x9510941, 0x9710961, 0x9910981, 0x9b109a1, 0x9d109c1, 0x9ef09f1
  .long 0x96afedcb, 0x74321058, 0x99d99999, 0x99999599, 0x79, 0x251d09, 0x7, 0x0
  .long 0x9170907, 0x9370927, 0x9570947, 0x9770967, 0x9970987, 0x9b709a7, 0x9d709c7, 0x9ff09e7
  .long 0x765aedcb, 0xf4321098, 0xaa6aaaaa, 0xaaaaadaa, 0xfa, 0x2d160a, 0xf, 0x0
  .long 0xa240a14, 0xa440a34, 0xa640a54, 0xa820a74, 0xaa40a94, 0xac40ab4, 0xae40ad4, 0xa0f0af4
  .long 0x765fadce, 0xb4321098, 0xaaeaaaaa, 0xaaaaadaa, 0xba, 0x2d1e0a, 0xb, 0x0
  .long 0xa200a00, 0xa400a30, 0xa600a50, 0xa800a70, 0xaa00a90, 0xac00ab0, 0xae00ad0, 0xa1f0af0
  .long 0x76afedcb, 0x34521098, 0xaa1aaaaa, 0xaaaaa7aa, 0x3a, 0x27110a, 0x3, 0x0
  .long 0xa1d0a0d, 0xa4d0a3d, 0xa6d0a5d, 0xa8d0a7d, 0xaac0a9d, 0xacd0abd, 0xaed0add, 0xa2f0afd
  .long 0x76afedcb, 0x45321098, 0xaa2aaaaa, 0xaaaaa9aa, 0x4a, 0x29120a, 0x4, 0x0
  .long 0xa1e0a0e, 0xa4e0a2e, 0xa6e0a5e, 0xa8e0a7e, 0xaae0a9e, 0xace0aba, 0xaee0ade, 0xa3f0afe
  .long 0x765fedcb, 0xa4321098, 0xaaaaaaaa, 0xaaaaa8aa, 0xa8, 0x1a0a28, 0xa, 0x0
  .long 0x1d50155, 0x5050275, 0x5f50585, 0x8b50835, 0x9950915, 0xda50ac5, 0xee50e65, 0xa4f0f25
  .long 0x86afedcb, 0x74321095, 0xaadaaaaa, 0xaaaaa2aa, 0x7a, 0x221d0a, 0x7, 0x0
  .long 0xa170a07, 0xa370a27, 0xa670a47, 0xa870a77, 0xaa70a97, 0xac70ab7, 0xae70ad7, 0xa5f0af7
  .long 0x765fedab, 0xc4321098, 0xaa6aaaaa, 0xaaaaabaa, 0xca, 0x2b160a, 0xc, 0x0
  .long 0xa110a01, 0xa310a21, 0xa510a41, 0xa810a71, 0xaa10a91, 0xac10ab1, 0xae10ad1, 0xa6f0af1
  .long 0x765fedcb, 0x943210a8, 0xaaaaaaaa, 0xaaaaa1aa, 0x9a, 0x211a0a, 0x9, 0x0
  .long 0xa190a09, 0xa390a29, 0xa590a49, 0xa890a69, 0xaa90a99, 0xac90ab9, 0xae90ad9, 0xa7f0af6
  .long 0x765aefcb, 0xd4321098, 0xaa6aaaaa, 0xaaaaadaa, 0xda, 0x2d160a, 0xd, 0x0
  .long 0xa120a02, 0xa320a22, 0xa520a42, 0xa720a62, 0xaa20a92, 0xac20ab2, 0xae20ad2, 0xa8f0af2
  .long 0x765fadcb, 0xe4321098, 0xaaeaaaaa, 0xaaaaadaa, 0xea, 0x2d1e0a, 0xe, 0x0
  .long 0xa100a03, 0xa330a23, 0xa530a43, 0xa730a63, 0xaa30a83, 0xac30ab3, 0xae30ad3, 0xa9f0af3
  .long 0x76afedcb, 0x24531098, 0xaa1aaaaa, 0xaaaaa7aa, 0x2a, 0x27110a, 0x2, 0x0
  .long 0xa1c0a0c, 0xa3c0a2c, 0xa5c0a4c, 0xa7c0a6c, 0xa9c0a8c, 0xacc0abc, 0xaec0adc, 0xaaf0afc
  .long 0x76afedcb, 0x5321498, 0xaa2aaaaa, 0xaaaaa9aa, 0xa, 0x29120a, 0x0, 0x0
  .long 0xa1a0a0a, 0xa3a0a2a, 0xa5a0a4a, 0xa7a0a6a, 0xa9a0a8a, 0xaca0aaa, 0xaea0ada, 0xabf0afa
  .long 0x76afedcb, 0x54321098, 0xaaaaaaaa, 0xaaaaa8aa, 0x5a, 0x280a1a, 0x5, 0x0
  .long 0x1a50125, 0x2e50265, 0x3b50335, 0x4850405, 0x6950615, 0xa750a45, 0xd550af5, 0xacf0dd5
  .long 0x76afedcb, 0x84321095, 0xaadaaaaa, 0xaaaaa2aa, 0x8a, 0x221d0a, 0x8, 0x0
  .long 0xa180a08, 0xa380a28, 0xa570a48, 0xa780a68, 0xa980a88, 0xab80aa8, 0xae80ac8, 0xadf0af8
  .long 0x76afedcb, 0x14325098, 0xaa0aaaaa, 0xaaaaa1aa, 0x1a, 0x21100a, 0x1, 0x0
  .long 0xa1b0a0b, 0xa3b0a2b, 0xa5b0a4b, 0xa7b0a6b, 0xa9b0a8b, 0xabb0aab, 0xadb0acb, 0xaef0afb
  .long 0x795fedcb, 0x643210a8, 0xaaaaaaaa, 0xaaaaa1aa, 0x6a, 0x211a0a, 0x6, 0x0
  .long 0xa160a06, 0xa360a26, 0xa560a46, 0xa760a66, 0xa960a86, 0xab60aa6, 0xad60ac6, 0xaff0ae6
  .long 0x765fedcb, 0xa4321098, 0xbb8bbbbb, 0xbbbbb7bb, 0xa7, 0x180b27, 0xa, 0x0
  .long 0x950015, 0x46501c5, 0x55504e5, 0x84505d5, 0x8f50875, 0xaa50a25, 0xf350b86, 0xb0f0fb5
  .long 0x765fedac, 0xb4321098, 0xbbdbbbbb, 0xbbbbbcbb, 0xbb, 0x2c1d0b, 0xb, 0x0
  .long 0xb200b00, 0xb400b30, 0xb600b50, 0xb800b70, 0xba00b90, 0xbc00bb0, 0xbe00bd0, 0xb1f0bf0
  .long 0x765fedcb, 0x943210a8, 0xbbcbbbbb, 0xbbbbb0bb, 0x9b, 0x201c0b, 0x9, 0x0
  .long 0xb190b09, 0xb490b39, 0xb690b59, 0xb890b79, 0xba70b99, 0xbc90bb9, 0xbe90bd9, 0xb2f0bf9
  .long 0x765afdcb, 0xe4321098, 0xbb6bbbbb, 0xbbbbbcbb, 0xeb, 0x2c160b, 0xe, 0x0
  .long 0xb130b03, 0xb430b23, 0xb630b53, 0xb830b73, 0xba30b93, 0xbc30bb3, 0xbe30bd3, 0xb3f0bf3
  .long 0x76afedcb, 0x84321095, 0xbb8bbbbb, 0xbbbbb6bb, 0x8b, 0x26180b, 0x8, 0x0
  .long 0xb180b08, 0xb380b28, 0xb680b58, 0xb880b78, 0xba80b98, 0xbc80bb8, 0xbe80bd8, 0xb4f0bf8
  .long 0x765feacb, 0xd4321098, 0xbb5bbbbb, 0xbbbbbabb, 0xdb, 0x2a150b, 0xd, 0x0
  .long 0xb120b02, 0xb320b22, 0xb620b42, 0xb820b72, 0xba20b92, 0xbc20bb2, 0xbe20bd2, 0xb5f0bf2
  .long 0x76afedcb, 0x34521098, 0xbb1bbbbb, 0xbbbbb4bb, 0x3b, 0x24110b, 0x3, 0x0
  .long 0xb1d0b0d, 0xb3d0b2d, 0xb5d0b4d, 0xb8d0b7d, 0xbad0b9d, 0xbcd0bbd, 0xbeb0bdd, 0xb6f0bfd
  .long 0x76afedcb, 0x5321498, 0xbb1bbbbb, 0xbbbbb2bb, 0xb, 0x22110b, 0x0, 0x0
  .long 0xb1a0b0a, 0xb3a0b2a, 0xb5a0b4a, 0xb8a0b6a, 0xbaa0b9a, 0xbca0bba, 0xbea0bda, 0xb7f0bfa
  .long 0x7a5fedcb, 0x64321098, 0xbb8bbbbb, 0xbbbbb7bb, 0x6b, 0x27180b, 0x6, 0x0
  .long 0xb160b06, 0xb360b26, 0xb560b46, 0xb760b66, 0xba60b96, 0xbc60bb6, 0xbe60bd6, 0xb8f0bf6
  .long 0x765fedab, 0xc4321098, 0xbbdbbbbb, 0xbbbbbcbb, 0xcb, 0x2c1d0b, 0xc, 0x0
  .long 0xb100b01, 0xb310b21, 0xb510b41, 0xb710b61, 0xba10b81, 0xbc10bb1, 0xbe10bd1, 0xb9f0bf1
  .long 0x965fedcb, 0x743210a8, 0xbbcbbbbb, 0xbbbbb0bb, 0x7b, 0x201c0b, 0x7, 0x0
  .long 0xb170b07, 0xb370b27, 0xb570b47, 0xb770b67, 0xb970b87, 0xbc70bb7, 0xbe70bd7, 0xbaf0bf7
  .long 0x765aedcb, 0xf4321098, 0xbb6bbbbb, 0xbbbbbcbb, 0xfb, 0x2c160b, 0xf, 0x0
  .long 0xb140b04, 0xb330b24, 0xb540b44, 0xb740b64, 0xb940b84, 0xbc40ba4, 0xbe40bd4, 0xbbf0bf4
  .long 0x76afedcb, 0x54321098, 0xbb8bbbbb, 0xbbbbb6bb, 0x58, 0x260b18, 0x5, 0x0
  .long 0xd50055, 0x1650135, 0x1e501b5, 0x6f50675, 0x7a50725, 0xb480b05, 0xc150b85, 0xbcf0c95
  .long 0x76afedcb, 0x24351098, 0xbb1bbbbb, 0xbbbbb3bb, 0x2b, 0x23110b, 0x2, 0x0
  .long 0xb1c0b0c, 0xb3c0b2c, 0xb5c0b4c, 0xb7c0b6c, 0xb9c0b8c, 0xbbc0bac, 0xbec0bcc, 0xbdf0bfc
  .long 0x76afedcb, 0x14523098, 0xbb1bbbbb, 0xbbbbb4bb, 0x1b, 0x24110b, 0x1, 0x0
  .long 0xb1b0b0b, 0xb3b0b2b, 0xb5b0b4b, 0xb7b0b6b, 0xb9b0b8b, 0xbbb0bab, 0xbdb0bcb, 0xbef0bfb
  .long 0x76afedcb, 0x45321098, 0xbb1bbbbb, 0xbbbbb2bb, 0x4b, 0x22110b, 0x4, 0x0
  .long 0xb1e0b0e, 0xb3e0b2e, 0xb5e0b4e, 0xb7a0b6e, 0xb9e0b8e, 0xbbe0bae, 0xbde0bce, 0xbff0bee
  .long 0x765fadce, 0xb4321098, 0xcccccccc, 0xcccccccc, 0xbc, 0x2c1c0c, 0xb, 0x0
  .long 0xc200c10, 0xc400c30, 0xc600c50, 0xc800c70, 0xca00c90, 0xcc00cb0, 0xce00cd0, 0xc0f0cf0
  .long 0x765aedfb, 0xc4321098, 0xcc8ccccc, 0xcccccfcc, 0xcc, 0x2f180c, 0xc, 0x0
  .long 0xc210c01, 0xc410c31, 0xc610c51, 0xc810c71, 0xca10c91, 0xcc10cb1, 0xce10cd1, 0xc1f0cf1
  .long 0x765fedcb, 0x843210a9, 0xccbccccc, 0xccccc4cc, 0x8c, 0x241b0c, 0x8, 0x0
  .long 0xc180c08, 0xc480c38, 0xc680c58, 0xc880c78, 0xca80c98, 0xcc80cb8, 0xce80cd8, 0xc2f0cf8
  .long 0x765fedcb, 0xa4321098, 0xcceccccc, 0xccccc1cc, 0xa1, 0x1e0c21, 0xa, 0x0
  .long 0x1a80128, 0x3570305, 0x3d70385, 0x7950715, 0xae50a79, 0xc450af9, 0xcb70c65, 0xc3f0cc5
  .long 0x76afedcb, 0x34521098, 0xcc0ccccc, 0xccccc1cc, 0x3c, 0x21100c, 0x3, 0x0
  .long 0xc1d0c0d, 0xc3d0c2d, 0xc6d0c5d, 0xc8d0c7d, 0xcad0c9d, 0xccb0cbd, 0xced0cdd, 0xc4f0cfd
  .long 0x76afedcb, 0x25341098, 0xcc2ccccc, 0xccccc9cc, 0x2c, 0x29120c, 0x2, 0x0
  .long 0xc1c0c0c, 0xc3c0c2c, 0xc6c0c4c, 0xc8c0c7c, 0xcac0c9c, 0xccc0cbc, 0xcec0cdc, 0xc5f0cfc
  .long 0x76afedcb, 0x4321598, 0xcc0ccccc, 0xccccc1cc, 0xc, 0x21100c, 0x0, 0x0
  .long 0xc1a0c0a, 0xc3a0c2a, 0xc5a0c4a, 0xc8a0c7a, 0xcaa0c9a, 0xcca0cba, 0xcea0cda, 0xc6f0cfa
  .long 0x76afedcb, 0x54321098, 0xcc7ccccc, 0xccccc9cc, 0x57, 0x290c17, 0x5, 0x0
  .long 0x990019, 0x2d50255, 0x4690445, 0x4e904c5, 0x5a50525, 0x8b90839, 0x9880908, 0xc7f0cf6
  .long 0x765fadcb, 0xe4321098, 0xcccccccc, 0xcccccccc, 0xec, 0x2c1c0c, 0xe, 0x0
  .long 0xc130c00, 0xc330c23, 0xc530c43, 0xc730c63, 0xca30c93, 0xcc30cb3, 0xce30cd3, 0xc8f0cf3
  .long 0x765aedcb, 0xf4321098, 0xcc8ccccc, 0xcccccfcc, 0xfc, 0x2f180c, 0xf, 0x0
  .long 0xc110c04, 0xc340c24, 0xc540c44, 0xc740c64, 0xca40c84, 0xcc40cb4, 0xce40cd4, 0xc9f0cf4
  .long 0x765fedcb, 0x943210a8, 0xccbccccc, 0xccccc4cc, 0x9c, 0x241b0c, 0x9, 0x0
  .long 0xc190c09, 0xc390c28, 0xc590c49, 0xc790c69, 0xc990c89, 0xcc90cb9, 0xce90cd9, 0xcaf0cf9
  .long 0xa65fedcb, 0x74321098, 0xcceccccc, 0xccccc1cc, 0x7c, 0x211e0c, 0x7, 0x0
  .long 0xc170c07, 0xc370c27, 0xc570c47, 0xc770c67, 0xc970c87, 0xcc70ca7, 0xce70cd7, 0xcbf0cf7
  .long 0x76afedcb, 0x14523098, 0xcc0ccccc, 0xccccc1cc, 0x1c, 0x21100c, 0x1, 0x0
  .long 0xc1b0c0b, 0xc3b0c2b, 0xc5b0c4b, 0xc7b0c6b, 0xc9b0c8b, 0xcbb0cab, 0xceb0cdb, 0xccf0cfb
  .long 0x76afedcb, 0x45321098, 0xcc2ccccc, 0xccccc9cc, 0x4c, 0x29120c, 0x4, 0x0
  .long 0xc1e0c0e, 0xc3e0c2e, 0xc5c0c4e, 0xc7e0c6e, 0xc9e0c8e, 0xcbe0cae, 0xcee0cce, 0xcdf0cfe
  .long 0x765feacb, 0xd4321098, 0xcc6ccccc, 0xcccccbcc, 0xdc, 0x2b160c, 0xd, 0x0
  .long 0xc120c02, 0xc320c22, 0xc520c42, 0xc720c62, 0xc920c82, 0xcb20ca2, 0xcd20cc2, 0xcef0cf2
  .long 0x75afedcb, 0x64321098, 0xcc7ccccc, 0xccccc9cc, 0x6c, 0x29170c, 0x6, 0x0
  .long 0xc160c06, 0xc360c26, 0xc560c46, 0xc760c66, 0xc960c86, 0xcb60ca6, 0xcd60cc6, 0xcff0ce6
  .long 0x76afedcb, 0x24351098, 0xdd0ddddd, 0xddddd6dd, 0x2d, 0x26100d, 0x2, 0x0
  .long 0xd2c0d1c, 0xd4c0d3c, 0xd6c0d5c, 0xd8b0d7c, 0xdac0d9c, 0xdcc0dbc, 0xdec0ddc, 0xd0f0dfc
  .long 0x56afedcb, 0x74321098, 0xdd6ddddd, 0xddddd3dd, 0x7d, 0x23160d, 0x7, 0x0
  .long 0xd270d07, 0xd470d37, 0xd670d57, 0xd870d77, 0xda70d97, 0xdc70db7, 0xde70dd7, 0xd1f0df7
  .long 0x765aedcb, 0xf4321098, 0xddfddddd, 0xdddddbdd, 0xfd, 0x2b1f0d, 0xf, 0x0
  .long 0xd140d04, 0xd440d34, 0xd640d54, 0xd840d74, 0xda40d94, 0xdc40db4, 0xde40dd4, 0xd2f0df4
  .long 0x76afedcb, 0x94321058, 0xdddddddd, 0xddddd3dd, 0x9d, 0x231d0d, 0x9, 0x0
  .long 0xd190d09, 0xd490d29, 0xd690d59, 0xd890d79, 0xda90d99, 0xdc90db6, 0xde90dd9, 0xd3f0df9
  .long 0x76afedcb, 0x45321098, 0xdd3ddddd, 0xddddd0dd, 0x4d, 0x20130d, 0x4, 0x0
  .long 0xd1e0d0e, 0xd3e0d2e, 0xd6e0d5e, 0xd8e0d7e, 0xdae0d9e, 0xdca0dbe, 0xdee0dde, 0xd4f0dfe
  .long 0x765feadb, 0xc4321098, 0xddaddddd, 0xdddddedd, 0xcd, 0x2e1a0d, 0xc, 0x0
  .long 0xd110d01, 0xd310d21, 0xd610d41, 0xd810d71, 0xda10d91, 0xdc10db1, 0xde10dd1, 0xd5f0df1
  .long 0x765fadce, 0xb4321098, 0xddbddddd, 0xdddddfdd, 0xbd, 0x2f1b0d, 0xb, 0x0
  .long 0xd100d00, 0xd300d20, 0xd500d40, 0xd800d70, 0xda00d90, 0xdc00db0, 0xde00dd0, 0xd6f0df0
  .long 0x765fedcb, 0xa4321098, 0xddfddddd, 0xddddd0dd, 0xa0, 0x1f0d20, 0xa, 0x0
  .long 0xe50065, 0x1950115, 0x2d90259, 0x9850905, 0xba90b29, 0xdc50d45, 0xe350df8, 0xd7f0eb5
  .long 0x76afedcb, 0x14352098, 0xdd0ddddd, 0xddddd6dd, 0x1d, 0x26100d, 0x1, 0x0
  .long 0xd1b0d0b, 0xd3b0d2b, 0xd5b0d4b, 0xd7b0d6b, 0xdab0d9b, 0xdcb0dbb, 0xdeb0ddb, 0xd8f0dfb
  .long 0x76afedcb, 0x54321098, 0xdd6ddddd, 0xddddd3dd, 0x56, 0x230d16, 0x5, 0x0
  .long 0x4750455, 0x4f504d5, 0x7c70747, 0x8a50825, 0xa650a05, 0xb350a85, 0xce50bb5, 0xd9f0d17
  .long 0x76afedcb, 0x34521098, 0xdd2ddddd, 0xddddd8dd, 0x3d, 0x28120d, 0x3, 0x0
  .long 0xd1d0d0d, 0xd3d0d2d, 0xd5d0d4d, 0xd7d0d6d, 0xd9d0d8d, 0xdcd0dbd, 0xded0ddd, 0xdaf0dfd
  .long 0x79afedcb, 0x64321058, 0xdddddddd, 0xddddd3dd, 0x6d, 0x231d0d, 0x6, 0x0
  .long 0xd160d06, 0xd360d26, 0xd560d46, 0xd760d66, 0xd960d86, 0xdc60da6, 0xde60dd6, 0xdbf0df6
  .long 0x76afedcb, 0x5321498, 0xdd3ddddd, 0xddddd0dd, 0xd, 0x20130d, 0x0, 0x0
  .long 0xd1a0d0a, 0xd3a0d2a, 0xd5a0d4a, 0xd7a0d6a, 0xd9a0d8a, 0xdba0daa, 0xdea0dda, 0xdcf0dfa
  .long 0x765feacb, 0xd4321098, 0xddaddddd, 0xdddddedd, 0xdd, 0x2e1a0d, 0xd, 0x0
  .long 0xd120d02, 0xd320d22, 0xd510d42, 0xd720d62, 0xd920d82, 0xdb20da2, 0xde20dc2, 0xddf0df2
  .long 0x765fadcb, 0xe4321098, 0xddbddddd, 0xdddddfdd, 0xed, 0x2f1b0d, 0xe, 0x0
  .long 0xd130d03, 0xd330d23, 0xd530d43, 0xd730d60, 0xd930d83, 0xdb30da3, 0xdd30dc3, 0xdef0df3
  .long 0x765fedcb, 0x8432109a, 0xddfddddd, 0xddddd0dd, 0x8d, 0x201f0d, 0x8, 0x0
  .long 0xd180d08, 0xd380d28, 0xd580d48, 0xd780d68, 0xd980d88, 0xdb80da8, 0xdd80dc8, 0xdff0de8
  .long 0x7a5fedcb, 0x64321098, 0xeefeeeee, 0xeeeee2ee, 0x6e, 0x221f0e, 0x6, 0x0
  .long 0xe260e16, 0xe460e36, 0xe660e56, 0xe860e76, 0xea60e96, 0xec60eb6, 0xee60ed6, 0xe0f0ef6
  .long 0x76afedcb, 0x4351298, 0xee4eeeee, 0xeeeee2ee, 0xe, 0x22140e, 0x0, 0x0
  .long 0xe2a0e0a, 0xe4a0e3a, 0xe6a0e5a, 0xe8a0e7a, 0xeaa0e9a, 0xeca0eba, 0xeea0eda, 0xe1f0efa
  .long 0x76afedcb, 0x45321098, 0xee4eeeee, 0xeeeee9ee, 0x4e, 0x29140e, 0x4, 0x0
  .long 0xe1e0e0e, 0xe4e0e3e, 0xe6e0e5e, 0xe8e0e7e, 0xeab0e9e, 0xece0ebe, 0xeee0ede, 0xe2f0efe
  .long 0x76afedcb, 0x84321095, 0xee5eeeee, 0xeeeee0ee, 0x8e, 0x20150e, 0x8, 0x0
  .long 0xe180e08, 0xe480e28, 0xe680e58, 0xe880e78, 0xea80e98, 0xec80eb7, 0xee80ed8, 0xe3f0ef8
  .long 0x765feadb, 0xc4321098, 0xeeceeeee, 0xeeeeeeee, 0xce, 0x2e1c0e, 0xc, 0x0
  .long 0xe110e01, 0xe310e21, 0xe610e51, 0xe810e71, 0xea10e91, 0xec10eb1, 0xee10ed1, 0xe4f0ef1
  .long 0x76afedcb, 0x34521098, 0xee1eeeee, 0xeeeee3ee, 0x3e, 0x23110e, 0x3, 0x0
  .long 0xe1d0e0d, 0xe3d0e2d, 0xe6d0e4d, 0xe8d0e7d, 0xead0e9d, 0xecd0ebd, 0xeed0edd, 0xe5f0efd
  .long 0x76afedcb, 0x54321098, 0xeedeeeee, 0xeeeee8ee, 0x5d, 0x280e1d, 0x5, 0x0
  .long 0xa50025, 0x7850705, 0x9f90979, 0xad80a58, 0xb950b15, 0xdb90d39, 0xf450ee9, 0xe6f0fc5
  .long 0x765fadce, 0xb4321098, 0xeebeeeee, 0xeeeeebee, 0xbe, 0x2b1b0e, 0xb, 0x0
  .long 0xe100e00, 0xe300e20, 0xe500e40, 0xe800e60, 0xea00e90, 0xec00eb0, 0xee00ed0, 0xe7f0ef0
  .long 0x765fedcb, 0xa4321098, 0xeefeeeee, 0xeeeee2ee, 0xa2, 0x1f0e22, 0xa, 0x0
  .long 0xb80038, 0x3a50325, 0x5e50565, 0xad50a55, 0xbf50b75, 0xe150e06, 0xf490e95, 0xe8f0fc9
  .long 0x76afedcb, 0x24351098, 0xee4eeeee, 0xeeeee2ee, 0x2e, 0x22140e, 0x2, 0x0
  .long 0xe1a0e0c, 0xe3c0e2c, 0xe5c0e4c, 0xe7c0e6c, 0xeac0e8c, 0xecc0ebc, 0xeec0edc, 0xe9f0efc
  .long 0x76afedcb, 0x15324098, 0xee4eeeee, 0xeeeee9ee, 0x1e, 0x29140e, 0x1, 0x0
  .long 0xe1b0e0b, 0xe3b0e2b, 0xe5b0e4b, 0xe7b0e6b, 0xe9b0e8b, 0xecb0ebb, 0xeeb0edb, 0xeaf0efb
  .long 0x86afedcb, 0x74321095, 0xee5eeeee, 0xeeeee0ee, 0x7e, 0x20150e, 0x7, 0x0
  .long 0xe170e07, 0xe370e27, 0xe570e47, 0xe770e67, 0xe970e87, 0xec70ea7, 0xee70ed7, 0xebf0ef7
  .long 0x765feacb, 0xd4321098, 0xeeceeeee, 0xeeeeeeee, 0xde, 0x2e1c0e, 0xd, 0x0
  .long 0xe120e02, 0xe320e22, 0xe520e41, 0xe720e62, 0xe920e82, 0xeb20ea2, 0xee20ed2, 0xecf0ef2
  .long 0x765aedcb, 0xf4321098, 0xee5eeeee, 0xeeeeeaee, 0xfe, 0x2a150e, 0xf, 0x0
  .long 0xe140e04, 0xe340e24, 0xe540e44, 0xe740e64, 0xe940e84, 0xeb40ea4, 0xee40ec4, 0xedf0ef4
  .long 0x76afedcb, 0x94321058, 0xeedeeeee, 0xeeeee8ee, 0x9e, 0x281d0e, 0x9, 0x0
  .long 0xe190e09, 0xe390e29, 0xe590e49, 0xe790e69, 0xe990e89, 0xeb90ea9, 0xed90ec9, 0xeef0ef9
  .long 0x765fadcb, 0xe4321098, 0xeebeeeee, 0xeeeeebee, 0xee, 0x2b1b0e, 0xe, 0x0
  .long 0xe130e03, 0xe330e23, 0xe530e43, 0xe700e63, 0xe930e83, 0xeb30ea3, 0xed30ec3, 0xeff0ee3
  .long 0x76afedcb, 0x34521098, 0xff3fffff, 0xfffff4ff, 0x3f, 0x24130f, 0x3, 0x0
  .long 0xf2d0f1d, 0xf4d0f3d, 0xf6d0f5d, 0xf8b0f7d, 0xfad0f9d, 0xfcd0fbd, 0xfed0fdd, 0xf0f0ffd
  .long 0x76afedcb, 0x25341098, 0xff0fffff, 0xfffff9ff, 0x2f, 0x29100f, 0x2, 0x0
  .long 0xf2c0f0c, 0xf4c0f3c, 0xf6c0f5c, 0xf8c0f7c, 0xfac0f9c, 0xfcc0fbc, 0xfec0fdc, 0xf1f0ffc
  .long 0x76afedcb, 0x4321598, 0xff2fffff, 0xfffff8ff, 0xf, 0x28120f, 0x0, 0x0
  .long 0xf1a0f0a, 0xf4a0f3a, 0xf6a0f5a, 0xf8a0f7a, 0xfaa0f9a, 0xfca0fba, 0xfea0fda, 0xf2f0ffa
  .long 0x86afedcb, 0x74321095, 0xffbfffff, 0xfffff7ff, 0x7f, 0x271b0f, 0x7, 0x0
  .long 0xf170f07, 0xf470f27, 0xf670f57, 0xf870f77, 0xfa70f97, 0xfc70fb7, 0xfe70fd7, 0xf3f0ff7
  .long 0x795fedcb, 0x643210a8, 0xffdfffff, 0xfffff2ff, 0x6f, 0x221d0f, 0x6, 0x0
  .long 0xf160f06, 0xf360f26, 0xf660f56, 0xf860f76, 0xfa60f96, 0xfc60fb6, 0xfe60fd6, 0xf4f0ff6
  .long 0x765feacb, 0xd4321098, 0xffbfffff, 0xfffffdff, 0xdf, 0x2d1b0f, 0xd, 0x0
  .long 0xf120f02, 0xf320f22, 0xf620f42, 0xf820f72, 0xfa20f92, 0xfc20fb2, 0xfe20fd1, 0xf5f0ff2
  .long 0x76afedcb, 0x54321098, 0xffcfffff, 0xfffff5ff, 0x5c, 0x250f1c, 0x5, 0x0
  .long 0x2950215, 0x5b50535, 0x7f90779, 0x9d50955, 0xba50b25, 0xc850c05, 0xec50e45, 0xf6f0fe5
  .long 0x765aedcf, 0xb4321098, 0xff5fffff, 0xfffffcff, 0xbf, 0x2c150f, 0xb, 0x0
  .long 0xf100f00, 0xf300f20, 0xf500f40, 0xf800f60, 0xfa00f90, 0xfc00fb0, 0xfe00fd0, 0xf7f0ff0
  .long 0x76afedcb, 0x14523098, 0xff3fffff, 0xfffff4ff, 0x1f, 0x24130f, 0x1, 0x0
  .long 0xf1b0f0b, 0xf3b0f2b, 0xf5b0f4b, 0xf7b0f6b, 0xfab0f9b, 0xfcb0fbb, 0xfeb0fdb, 0xf8f0ffb
  .long 0x76afedcb, 0x45321098, 0xff0fffff, 0xfffff9ff, 0x4f, 0x29100f, 0x4, 0x0
  .long 0xf1c0f0e, 0xf3e0f2e, 0xf5e0f4e, 0xf7e0f6e, 0xfae0f8e, 0xfce0fbe, 0xfee0fde, 0xf9f0ffe
  .long 0x765fadcb, 0xe4321098, 0xffffffff, 0xfffffbff, 0xef, 0x2b1f0f, 0xe, 0x0
  .long 0xf130f03, 0xf330f23, 0xf530f43, 0xf730f63, 0xf930f83, 0xfc30fb3, 0xfe30fd3, 0xfaf0ff3
  .long 0x76afedcb, 0x84321095, 0xffbfffff, 0xfffff7ff, 0x8f, 0x271b0f, 0x8, 0x0
  .long 0xf180f08, 0xf370f28, 0xf580f48, 0xf780f68, 0xf980f88, 0xfc80fa8, 0xfe80fd8, 0xfbf0ff8
  .long 0x765fedcb, 0x943210a8, 0xffdfffff, 0xfffff2ff, 0x9f, 0x221d0f, 0x9, 0x0
  .long 0xf190f09, 0xf390f29, 0xf590f46, 0xf790f69, 0xf990f89, 0xfb90fa9, 0xfe90fd9, 0xfcf0ff9
  .long 0x765feadb, 0xc4321098, 0xffbfffff, 0xfffffdff, 0xcf, 0x2d1b0f, 0xc, 0x0
  .long 0xf110f01, 0xf310f21, 0xf510f41, 0xf710f61, 0xf910f81, 0xfb10fa1, 0xfe10fc1, 0xfdf0ff1
  .long 0x765fedcb, 0xa4321098, 0xffcfffff, 0xfffff5ff, 0xa5, 0x1c0f25, 0xa, 0x0
  .long 0x2450225, 0x2c502a5, 0x4950415, 0x6550605, 0x6d50685, 0x9750935, 0x9f509b5, 0xfef0f65
  .long 0x765aedcb, 0xf4321098, 0xff5fffff, 0xfffffcff, 0xff, 0x2c150f, 0xf, 0x0
  .long 0xf140f04, 0xf340f24, 0xf540f44, 0xf700f64, 0xf940f84, 0xfb40fa4, 0xfd40fc4, 0xfff0fe4
L_order_end:
.section .rodata,"a"
.p2align 6
.amdhsa_kernel standalone__kv_cache_quant_pre_rope_vs_post_rope__sampling_kernel
  .amdhsa_next_free_vgpr 243
  .amdhsa_next_free_sgpr 102
  .amdhsa_accum_offset 244
  .amdhsa_group_segment_fixed_size 0
  .amdhsa_kernarg_size 112
  .amdhsa_user_sgpr_count 2
  .amdhsa_user_sgpr_kernarg_segment_ptr 1
  .amdhsa_system_sgpr_workgroup_id_x 1
.end_amdhsa_kernel
```

```asm
; @launch grid=(256,1,1) block=(320,1,1) lds=162304
.amdgcn_target "amdgcn-amd-amdhsa--gfx950"
.text
.globl standalone__kv_cache_quant_pre_rope_vs_post_rope__sampling_kernel
.p2align 12
.type L_pad,@object
L_pad:
.fill 832, 4, 0xbf810000
.p2align 8
.type standalone__kv_cache_quant_pre_rope_vs_post_rope__sampling_kernel,@function
standalone__kv_cache_quant_pre_rope_vs_post_rope__sampling_kernel:
  s_cmpk_ge_u32 s2, 0x100
  s_cbranch_scc1 L_end
  s_load_dwordx16 s[4:19], s[0:1], 0
  s_load_dwordx8 s[20:27], s[0:1], 64
  s_load_dwordx4 s[28:31], s[0:1], 96
  v_readfirstlane_b32 s40, v0
  s_lshr_b32 s42, s2, 4
  s_cmp_lg_u32 s40, 0
  s_cbranch_scc1 L_s0
  s_setprio 3
  s_getpc_b64 s[64:65]
L_pc0:
  s_and_b32 s44, s2, 56
  v_and_b32 v20, 63, v0
  v_lshl_add_u32 v1, v20, 6, s44
  v_lshlrev_b32 v1, 4, v1
  v_min_u32 v1, L_order_end-L_pc0-1028, v1
  s_bfm_b64 exec, 43, 0
  global_load_dword v2, v1, s[64:65] offset:1024
  s_mov_b64 exec, -1
  v_min_u32 v21, 47, v20
  v_add_u32 v22, 24, v21
  v_subrev_u32 v23, 24, v21
  v_min_u32 v27, v22, v23
  s_mul_i32 s44, s42, 48
  v_add_lshl_u32 v22, v21, s44, 3
  v_add_lshl_u32 v23, v27, s44, 3
  v_lshlrev_b32 v26, 3, v21
  s_and_b32 s44, s2, 7
  s_lshr_b32 s45, s2, 3
  s_mul_i32 s68, s44, 96
  s_add_u32 s68, s68, s45
  v_and_b32 v3, 15, v21
  v_lshl_add_u32 v3, s68, 4, v3
  v_and_b32 v4, 48, v21
  v_lshl_add_u32 v3, v4, 5, v3
  v_lshlrev_b32 v3, 6, v3
  s_mul_i32 s68, s44, 98304
  v_subrev_u32 v12, s68, v3
  s_and_b32 s68, s45, 3
  s_lshl4_add_u32 s44, s68, s44
  s_lshr_b32 s45, s45, 2
  s_lshl_b32 s45, s45, 8
  s_add_u32 s44, s44, s45
  v_and_b32 v4, 7, v20
  v_lshl_add_u32 v4, s44, 3, v4
  v_and_b32 v5, 24, v20
  v_lshl_add_u32 v4, v5, 6, v4
  v_and_b32 v5, 32, v20
  v_lshl_add_u32 v4, v5, 1, v4
  v_lshlrev_b32 v4, 6, v4
  s_waitcnt lgkmcnt(0)
  global_load_dwordx2 v[108:109], v22, s[4:5]
  global_load_dwordx2 v[110:111], v23, s[4:5]
  global_load_dwordx2 v[104:105], v26, s[18:19]
  global_load_dwordx2 v[106:107], v26, s[20:21]
  v_lshlrev_b32 v27, 3, v27
  s_add_u32 s68, s42, 16
  s_mul_i32 s44, s68, 384
  s_add_u32 s32, s4, s44
  s_addc_u32 s33, s5, 0
  global_load_dwordx2 v[68:69], v26, s[32:33]
  global_load_dwordx2 v[70:71], v27, s[32:33]
  global_load_dword v5, v3, s[22:23]
  global_load_dword v6, v3, s[24:25]
  global_load_dword v7, v4, s[8:9]
  global_load_dword v8, v4, s[10:11]
  global_load_dword v9, v4, s[14:15]
  global_load_dword v10, v4, s[16:17]
  global_load_dword v11, v12, s[4:5]
  v_mov_b32 v14, 0
  v_cmp_gt_u32 vcc, 24, v21
  v_mov_b32 v48, 0
  v_mov_b32 v49, 0
  v_mov_b32 v50, 0
  v_mov_b32 v51, 0
  ds_write_b128 v14, v[48:51] offset:0
  ds_write_b128 v14, v[48:51] offset:16
  s_waitcnt lgkmcnt(0)
  s_barrier
  s_mov_b32 s66, 0xffff0000
  s_mov_b32 s67, 0x3dd53b95
  v_cndmask_b32_e64 v30, 1.0, -1.0, vcc
  v_lshlrev_b32 v35, 4, v21
  v_mov_b32 v28, v35
  v_lshlrev_b32 v29, 1, v27
  v_mov_b32 v22, 0x80008000
  v_cndmask_b32 v31, v14, v22, vcc
  v_mov_b32 v38, 1
  s_mov_b32 s43, 1
  s_waitcnt vmcnt(9)
  v_lshlrev_b32 v52, 16, v104
  v_and_b32 v53, s66, v104
  v_lshlrev_b32 v54, 16, v105
  v_and_b32 v55, s66, v105
  v_lshlrev_b32 v56, 16, v106
  v_and_b32 v57, s66, v106
  v_lshlrev_b32 v58, 16, v107
  v_and_b32 v59, s66, v107
L_hr:
  v_lshlrev_b32 v76, 16, v108
  v_and_b32 v77, s66, v108
  v_lshlrev_b32 v78, 16, v109
  v_and_b32 v79, s66, v109
  v_lshlrev_b32 v80, 16, v110
  v_and_b32 v81, s66, v110
  v_lshlrev_b32 v82, 16, v111
  v_and_b32 v83, s66, v111
  v_mul_f32 v76, v76, v52
  v_mul_f32 v77, v77, v53
  v_mul_f32 v78, v78, v54
  v_mul_f32 v79, v79, v55
  v_mul_f32 v80, v80, v56
  v_mul_f32 v81, v81, v57
  v_mul_f32 v82, v82, v58
  v_mul_f32 v83, v83, v59
  v_cvt_pk_bf16_f32 v84, v76, v80
  v_cvt_pk_bf16_f32 v85, v77, v81
  v_cvt_pk_bf16_f32 v86, v78, v82
  v_cvt_pk_bf16_f32 v87, v79, v83
  v_lshlrev_b32 v76, 16, v84
  v_and_b32 v80, s66, v84
  v_lshlrev_b32 v77, 16, v85
  v_and_b32 v81, s66, v85
  v_lshlrev_b32 v78, 16, v86
  v_and_b32 v82, s66, v86
  v_lshlrev_b32 v79, 16, v87
  v_and_b32 v83, s66, v87
  v_fma_f32 v76, v80, v30, v76
  v_fma_f32 v77, v81, v30, v77
  v_fma_f32 v78, v82, v30, v78
  v_fma_f32 v79, v83, v30, v79
  v_cvt_pk_bf16_f32 v84, v76, v77
  v_cvt_pk_bf16_f32 v85, v78, v79
  v_xor_b32 v86, v31, v84
  v_xor_b32 v87, v31, v85
  v_mov_b32 v22, s43
  ds_write_b16 v28, v84 offset:512
  ds_write_b16_d16_hi v28, v84 offset:516
  ds_write_b16 v28, v85 offset:520
  ds_write_b16_d16_hi v28, v85 offset:524
  ds_write_b16 v29, v86 offset:514
  ds_write_b16_d16_hi v29, v86 offset:518
  ds_write_b16 v29, v87 offset:522
  ds_write_b16_d16_hi v29, v87 offset:526
  ds_write_b32 v14, v22 offset:16
  v_add_u32 v28, 1024, v28
  v_add_u32 v29, 1024, v29
  v_and_b32 v28, 0xfff, v28
  v_and_b32 v29, 0xfff, v29
  s_cmp_eq_u32 s43, 2
  s_cbranch_scc1 L_helper
  s_mov_b32 s43, 2
  s_waitcnt vmcnt(7) lgkmcnt(0)
  v_mov_b32 v108, v68
  v_mov_b32 v109, v69
  v_mov_b32 v110, v70
  v_mov_b32 v111, v71
  s_branch L_hr
L_s0:
  v_subrev_u32 v0, 64, v0
  s_sub_u32 s40, s40, 64
  s_and_b32 s44, s2, 7
  s_lshl_b32 s44, s44, 8
  s_bfe_u32 s41, s2, 0x10003
  s_mul_i32 s45, s41, 43
  s_add_u32 s44, s44, s45
  s_mulk_i32 s44, 768
  v_lshl_add_u32 v212, v0, 4, s44
  v_add_u32 v213, 4096, v212
  v_add_u32 v214, 8192, v212
  v_add_u32 v215, 12288, v212
  v_add_u32 v216, 16384, v212
  v_add_u32 v217, 20480, v212
  v_add_u32 v218, 24576, v212
  s_lshr_b32 s40, s40, 6
  v_lshrrev_b32 v25, 4, v0
  v_and_b32 v24, 15, v0
  v_mul_u32_u24 v20, 11, v25
  v_lshrrev_b32 v20, 5, v20
  v_mad_i32_i24 v20, v20, -3, v25
  v_lshlrev_b32 v21, 4, v24
  v_lshl_add_u32 v15, v20, 8, v21
  v_add_u32 v20, 256, v15
  v_subrev_u32 v21, 512, v15
  v_min_u32 v16, v20, v21
  v_add_u32 v20, 512, v15
  v_subrev_u32 v21, 256, v15
  v_min_u32 v17, v20, v21
  v_cmp_gt_u32 vcc, 8, v24
  v_lshlrev_b32 v23, 3, v24
  v_lshrrev_b32 v22, 1, v15
  v_add3_u32 v20, v22, v23, 64
  v_subrev_u32 v21, 384, v20
  v_min_u32 v20, v20, v21
  v_sub_u32 v20, v20, v22
  v_cndmask_b32 v240, v20, v23, vcc
  v_lshrrev_b32 v22, 1, v16
  v_add3_u32 v20, v22, v23, 64
  v_subrev_u32 v21, 384, v20
  v_min_u32 v20, v20, v21
  v_sub_u32 v20, v20, v22
  v_cndmask_b32 v241, v20, v23, vcc
  v_lshrrev_b32 v22, 1, v17
  v_add3_u32 v20, v22, v23, 64
  v_subrev_u32 v21, 384, v20
  v_min_u32 v20, v20, v21
  v_sub_u32 v20, v20, v22
  v_cndmask_b32 v242, v20, v23, vcc
  s_mul_i32 s100, s40, 24576
  s_add_u32 s100, s100, 64000
  s_mul_i32 s44, s42, 1572864
  s_mov_b32 s34, 51904512
  s_mov_b32 s35, 0x20000
  s_mov_b32 s80, 25165824
  s_mov_b32 s3, 50331648
  s_waitcnt lgkmcnt(0)
  s_add_u32 s32, s6, s44
  s_addc_u32 s33, s7, 0
  v_mov_b32 v21, s22
  v_mov_b32 v28, s24
  v_cndmask_b32 v28, v28, v21, vcc
  v_mov_b32 v21, s23
  v_mov_b32 v29, s25
  v_cndmask_b32 v29, v29, v21, vcc
  s_add_u32 m0, s100, 0
  v_lshrrev_b32 v10, 1, v212
  v_add_u32 v10, v10, v240
  v_mad_u64_u32 v[30:31], s[64:65], v10, 1, v[28:29]
  global_load_lds_dwordx4 v[30:31], off
  buffer_load_dwordx4 v[68:71], v212, s[32:35], 0 offen nt
  buffer_load_dwordx4 v[72:75], v213, s[32:35], 0 offen nt
  s_add_u32 m0, s100, 1024
  v_lshrrev_b32 v10, 1, v213
  v_add_u32 v10, v10, v241
  v_mad_u64_u32 v[30:31], s[64:65], v10, 1, v[28:29]
  global_load_lds_dwordx4 v[30:31], off
  buffer_load_dwordx4 v[76:79], v214, s[32:35], 0 offen nt
  buffer_load_dwordx4 v[80:83], v212, s[32:35], s80 offen nt
  s_add_u32 m0, s100, 2048
  v_lshrrev_b32 v10, 1, v214
  v_add_u32 v10, v10, v242
  v_mad_u64_u32 v[30:31], s[64:65], v10, 1, v[28:29]
  global_load_lds_dwordx4 v[30:31], off
  buffer_load_dwordx4 v[84:87], v213, s[32:35], s80 offen nt
  s_barrier
  s_getpc_b64 s[82:83]
L_pc1:
  s_lshl_b32 s44, s2, 6
  s_add_u32 s44, s44, L_order-L_pc1
  s_add_u32 s82, s82, s44
  s_addc_u32 s83, s83, 0
  s_load_dwordx2 s[92:93], s[82:83], 0
  s_load_dwordx2 s[96:97], s[82:83], 8
  s_mov_b32 s94, 4000000
  s_mul_i32 s44, s41, 768
  s_add_u32 s44, s44, 32256
  v_add_u32 v20, s44, v212
  v_add_u32 v21, 65280, v212
  s_mul_i32 s45, s41, 3
  v_add_u32 v22, s45, v25
  v_cmp_ge_u32 s[48:49], v22, 17
  v_cmp_ge_u32 s[50:51], v22, 1
  v_cmp_ge_u32 s[52:53], v22, 18
  v_cmp_ge_u32 s[54:55], v22, 2
  v_add_u32 v235, 94208, v21
  v_add_u32 v234, 90112, v21
  v_add_u32 v233, 86016, v21
  v_add_u32 v232, 81920, v21
  v_add_u32 v231, 77824, v21
  v_add_u32 v230, 73728, v21
  v_add_u32 v229, 69632, v21
  v_cndmask_b32_e64 v228, v20, v21, s[54:55]
  v_add_u32 v228, 65536, v228
  v_cndmask_b32_e64 v227, v20, v21, s[52:53]
  v_add_u32 v227, 61440, v227
  v_add_u32 v226, 57344, v20
  v_add_u32 v225, 53248, v20
  v_add_u32 v224, 49152, v20
  v_add_u32 v223, 45056, v20
  v_add_u32 v222, 40960, v20
  v_add_u32 v221, 36864, v20
  v_cndmask_b32_e64 v220, v212, v20, s[50:51]
  v_add_u32 v220, 32768, v220
  v_cndmask_b32_e64 v219, v212, v20, s[48:49]
  v_add_u32 v219, 28672, v219
  v_lshrrev_b32 v22, 6, v0
  v_bfe_u32 v23, v0, 4, 2
  v_mov_b32 v14, 0
  v_and_b32 v20, 3, v0
  v_lshl_add_u32 v1, v20, 5, v25
  v_and_b32 v20, 4, v0
  v_lshl_add_u32 v1, v20, 2, v1
  v_and_b32 v20, 8, v0
  v_mad_u32_u24 v1, v20, 48, v1
  v_lshlrev_b32 v1, 2, v1
  v_add_u32 v1, 45568, v1
  v_lshl_add_u32 v21, v24, 2, v23
  v_mul_u32_u24 v20, 192, v22
  v_add_lshl_u32 v3, v20, v21, 2
  v_add_u32 v3, 64000, v3
  v_lshlrev_b32 v6, 2, v22
  v_mov_b32 v32, 0
  v_mov_b32 v34, 0
  v_mov_b32 v33, 0
  v_mov_b32 v35, 0
  s_mov_b32 s48, 0x11111111
  s_mov_b32 s49, s48
  s_mov_b32 s50, 0x22222222
  s_mov_b32 s51, s50
  s_mov_b32 s52, 0x44444444
  s_mov_b32 s53, s52
  s_mov_b32 s54, 0x88888888
  s_mov_b32 s55, s54
  s_mov_b32 s56, 0x05040100
  s_mov_b32 s57, 0x07060302
  s_mov_b32 s38, 1572864
  s_mov_b32 s39, 0x20000
  v_lshlrev_b32 v21, 8, v23
  v_add_u32 v21, s100, v21
  v_lshl_add_u32 v12, v24, 3, v21
  s_getreg_b32 s81, hwreg(HW_REG_HW_ID, 13, 2)
  s_getreg_b32 s79, hwreg(HW_REG_HW_ID, 8, 4)
  s_getreg_b32 s46, hwreg(HW_REG_XCC_ID, 0, 3)
  s_mul_i32 s46, s46, 4352
  s_add_u32 s46, s46, 8126464
  s_add_u32 s44, s46, 2048
  v_mov_b32 v11, s44
  s_and_b32 s45, s81, 2
  s_lshl_b32 s45, s45, 9
  s_lshl_b32 s44, s40, 8
  s_add_u32 s44, s44, s45
  s_add_u32 s44, s44, s46
  s_add_u32 s44, s44, s79
  s_and_b32 s81, s81, 1
  s_lshl_b32 s81, s81, 4
  s_add_u32 s44, s44, s81
  v_mov_b32 v7, s44
  s_xor_b32 s45, s45, 1024
  s_add_u32 s46, s46, s45
  v_and_b32 v8, 1, v0
  v_lshl_add_u32 v8, v8, 4, s46
  v_bfe_u32 v21, v0, 1, 2
  v_mad_u32_u24 v21, v21, 4, v22
  v_add_u32 v9, 0, v21
  v_and_b32 v9, 3, v9
  v_lshl_add_u32 v236, v9, 8, v8
  v_add_u32 v9, 1, v21
  v_and_b32 v9, 3, v9
  v_lshl_add_u32 v237, v9, 8, v8
  v_add_u32 v9, 2, v21
  v_and_b32 v9, 3, v9
  v_lshl_add_u32 v238, v9, 8, v8
  v_add_u32 v9, 3, v21
  v_and_b32 v9, 3, v9
  v_lshl_add_u32 v239, v9, 8, v8
  s_mov_b32 s78, 0xfefefeff
  v_mov_b32 v36, 0
  v_mov_b32 v37, 0
  v_mov_b32 v38, 0
  v_mov_b32 v39, 0
  v_mov_b32 v40, 0
  v_mov_b32 v41, 0
  v_mov_b32 v42, 0
  v_mov_b32 v43, 0
  v_mov_b32 v26, 0
  v_mov_b32 v27, 0
  v_mov_b32 v8, 3
  s_cmp_lt_u32 s40, 4
  s_cselect_b64 s[60:61], 1, 0
  s_getreg_b32 s58, hwreg(HW_REG_XCC_ID, 0, 1)
  s_mul_i32 s58, s58, -6
  s_add_u32 s58, s58, 3
  s_mov_b32 s91, s58
  s_mov_b32 s69, 0
  s_mov_b32 s95, 0
  buffer_load_dwordx4 v[88:91], v214, s[32:35], s80 offen nt
  s_add_u32 m0, s100, 3072
  v_lshrrev_b32 v10, 1, v215
  v_add_u32 v10, v10, v240
  v_mad_u64_u32 v[30:31], s[64:65], v10, 1, v[28:29]
  s_waitcnt vmcnt(8)
  global_load_lds_dwordx4 v[30:31], off
  s_waitcnt vmcnt(8)
  buffer_load_dwordx4 v[92:95], v215, s[32:35], 0 offen nt
  s_add_u32 m0, s100, 4096
  v_lshrrev_b32 v10, 1, v216
  v_add_u32 v10, v10, v241
  v_mad_u64_u32 v[30:31], s[64:65], v10, 1, v[28:29]
  s_waitcnt vmcnt(8)
  global_load_lds_dwordx4 v[30:31], off
  s_waitcnt vmcnt(8)
  buffer_load_dwordx4 v[96:99], v216, s[32:35], 0 offen nt
  s_mov_b32 s47, 1
  ds_read_b32 v4, v14 offset:16
L_fqz:
  s_waitcnt lgkmcnt(0)
  v_readfirstlane_b32 s46, v4
  s_cmp_ge_u32 s46, s47
  s_cbranch_scc1 L_fqz_ok
  s_cmp_eq_u32 s94, 0
  s_cbranch_scc1 L_fqz_ok
  s_sub_u32 s94, s94, 1
  ds_read_b32 v4, v14 offset:16
  s_branch L_fqz
L_fqz_ok:
  ds_read_b128 v[44:47], v15 offset:512
  ds_read_b128 v[48:51], v16 offset:512
  ds_read_b128 v[52:55], v17 offset:512
  s_add_u32 m0, s100, 5120
  v_lshrrev_b32 v10, 1, v217
  v_add_u32 v10, v10, v242
  v_mad_u64_u32 v[30:31], s[64:65], v10, 1, v[28:29]
  s_waitcnt vmcnt(8)
  global_load_lds_dwordx4 v[30:31], off
  s_waitcnt vmcnt(7)
  ds_read_b64 v[116:117], v12 offset:0
  ds_read_b64 v[118:119], v12 offset:128
  ds_read_b64 v[120:121], v12 offset:1024
  ds_read_b64 v[122:123], v12 offset:1152
  ds_read_b64 v[124:125], v12 offset:2048
  ds_read_b64 v[126:127], v12 offset:2176
  buffer_load_dwordx4 v[100:103], v217, s[32:35], 0 offen nt
L_it0:
  s_mov_b32 s47, 2
  ds_read_b32 v4, v14 offset:16
L_fq0:
  s_waitcnt lgkmcnt(0)
  v_readfirstlane_b32 s46, v4
  s_cmp_ge_u32 s46, s47
  s_cbranch_scc1 L_fq0_ok
  s_cmp_eq_u32 s94, 0
  s_cbranch_scc1 L_fq0_ok
  s_sub_u32 s94, s94, 1
  ds_read_b32 v4, v14 offset:16
  s_branch L_fq0
L_fq0_ok:
  ds_read_b128 v[56:59], v15 offset:1536
  ds_read_b128 v[60:63], v16 offset:1536
  ds_read_b128 v[64:67], v17 offset:1536
  v_perm_b32 v13, v118, v116, s56
  v_perm_b32 v118, v118, v116, s57
  v_perm_b32 v116, v119, v117, s56
  v_perm_b32 v119, v119, v117, s57
  v_dot2_f32_bf16 v22, v13, v44, 0
  v_dot2_f32_bf16 v23, v118, v45, 0
  v_dot2_f32_bf16 v24, v116, v46, 0
  v_dot2_f32_bf16 v25, v119, v47, 0
  v_cvt_f32_i32 v68, v68
  v_cvt_f32_i32 v69, v69
  v_cvt_f32_i32 v70, v70
  v_cvt_f32_i32 v71, v71
  v_pk_mul_f32 v[20:21], v[68:69], v[22:23]
  v_pk_add_f32 v[18:19], v[22:23], v[24:25]
  v_pk_fma_f32 v[20:21], v[70:71], v[24:25], v[20:21]
  v_add_f32 v18, v18, v19
  v_add_f32 v20, v20, v21
  s_add_u32 m0, s100, 6144
  v_lshrrev_b32 v10, 1, v218
  v_add_u32 v10, v10, v240
  v_mad_u64_u32 v[30:31], s[64:65], v10, 1, v[28:29]
  global_load_lds_dwordx4 v[30:31], off
  s_waitcnt vmcnt(8)
  buffer_load_dwordx4 v[104:107], v215, s[32:35], s80 offen nt
  v_perm_b32 v117, v122, v120, s56
  v_perm_b32 v122, v122, v120, s57
  v_perm_b32 v120, v123, v121, s56
  v_perm_b32 v123, v123, v121, s57
  v_dot2_f32_bf16 v22, v117, v48, 0
  v_add_f32_dpp v34, v18, v18 row_ror:8 row_mask:0xf bank_mask:0xc
  v_add_f32_dpp v34, v20, v20 row_ror:8 row_mask:0xf bank_mask:0x3
  v_dot2_f32_bf16 v23, v122, v49, 0
  v_dot2_f32_bf16 v24, v120, v50, 0
  v_dot2_f32_bf16 v25, v123, v51, 0
  v_cvt_f32_i32 v72, v72
  v_cvt_f32_i32 v73, v73
  v_cvt_f32_i32 v74, v74
  v_cvt_f32_i32 v75, v75
  v_pk_mul_f32 v[20:21], v[72:73], v[22:23]
  v_pk_add_f32 v[18:19], v[22:23], v[24:25]
  v_pk_fma_f32 v[20:21], v[74:75], v[24:25], v[20:21]
  v_add_f32 v18, v18, v19
  v_add_f32 v20, v20, v21
  s_waitcnt vmcnt(8)
  buffer_load_dwordx4 v[108:111], v216, s[32:35], s80 offen nt
  v_perm_b32 v121, v126, v124, s56
  v_perm_b32 v126, v126, v124, s57
  v_perm_b32 v124, v127, v125, s56
  v_perm_b32 v127, v127, v125, s57
  v_dot2_f32_bf16 v22, v121, v52, 0
  v_add_f32_dpp v21, v18, v18 row_ror:8 row_mask:0xf bank_mask:0xc
  v_add_f32_dpp v21, v20, v20 row_ror:8 row_mask:0xf bank_mask:0x3
  v_add_f32_dpp v20, v34, v34 row_half_mirror row_mask:0xf bank_mask:0x5
  v_dot2_f32_bf16 v23, v126, v53, 0
  v_add_f32_dpp v20, v21, v21 row_half_mirror row_mask:0xf bank_mask:0xa
  v_dot2_f32_bf16 v24, v124, v54, 0
  v_dot2_f32_bf16 v25, v127, v55, 0
  v_add_f32_dpp v20, v20, v20 quad_perm:[2,3,0,1] row_mask:0xf bank_mask:0xf
  v_cvt_f32_i32 v76, v76
  v_cvt_f32_i32 v77, v77
  v_add_f32_dpp v20, v20, v20 quad_perm:[1,0,3,2] row_mask:0xf bank_mask:0xf
  v_cndmask_b32_e64 v32, v32, v20, s[48:49]
  v_cvt_f32_i32 v78, v78
  v_cvt_f32_i32 v79, v79
  v_pk_mul_f32 v[20:21], v[76:77], v[22:23]
  v_pk_add_f32 v[18:19], v[22:23], v[24:25]
  v_pk_fma_f32 v[20:21], v[78:79], v[24:25], v[20:21]
  v_add_f32 v18, v18, v19
  v_add_f32 v20, v20, v21
  s_add_u32 m0, s100, 7168
  v_lshrrev_b32 v10, 1, v219
  v_add_u32 v10, v10, v241
  v_mad_u64_u32 v[30:31], s[64:65], v10, 1, v[28:29]
  s_waitcnt vmcnt(8)
  global_load_lds_dwordx4 v[30:31], off
  s_waitcnt vmcnt(8)
  buffer_load_dwordx4 v[112:115], v217, s[32:35], s80 offen nt
L_it1:
  s_waitcnt lgkmcnt(0)
  v_dot2_f32_bf16 v22, v13, v56, 0
  v_add_f32_dpp v34, v18, v18 row_ror:8 row_mask:0xf bank_mask:0xc
  v_add_f32_dpp v34, v20, v20 row_ror:8 row_mask:0xf bank_mask:0x3
  v_dot2_f32_bf16 v23, v118, v57, 0
  v_dot2_f32_bf16 v24, v116, v58, 0
  v_dot2_f32_bf16 v25, v119, v59, 0
  v_cvt_f32_i32 v80, v80
  v_cvt_f32_i32 v81, v81
  v_cvt_f32_i32 v82, v82
  v_cvt_f32_i32 v83, v83
  v_pk_mul_f32 v[20:21], v[80:81], v[22:23]
  v_pk_add_f32 v[18:19], v[22:23], v[24:25]
  v_pk_fma_f32 v[20:21], v[82:83], v[24:25], v[20:21]
  v_add_f32 v18, v18, v19
  v_add_f32 v20, v20, v21
  s_waitcnt vmcnt(8)
  buffer_load_dwordx4 v[68:71], v218, s[32:35], 0 offen nt
  v_dot2_f32_bf16 v22, v117, v60, 0
  v_add_f32_dpp v35, v18, v18 row_ror:8 row_mask:0xf bank_mask:0xc
  v_add_f32_dpp v35, v20, v20 row_ror:8 row_mask:0xf bank_mask:0x3
  v_dot2_f32_bf16 v23, v122, v61, 0
  v_dot2_f32_bf16 v24, v120, v62, 0
  v_dot2_f32_bf16 v25, v123, v63, 0
  v_cvt_f32_i32 v84, v84
  v_cvt_f32_i32 v85, v85
  v_cvt_f32_i32 v86, v86
  v_cvt_f32_i32 v87, v87
  v_pk_mul_f32 v[20:21], v[84:85], v[22:23]
  v_pk_add_f32 v[18:19], v[22:23], v[24:25]
  v_pk_fma_f32 v[20:21], v[86:87], v[24:25], v[20:21]
  v_add_f32 v18, v18, v19
  v_add_f32 v20, v20, v21
  s_add_u32 m0, s100, 8192
  v_lshrrev_b32 v10, 1, v220
  v_add_u32 v10, v10, v242
  v_mad_u64_u32 v[30:31], s[64:65], v10, 1, v[28:29]
  s_waitcnt vmcnt(8)
  global_load_lds_dwordx4 v[30:31], off
  s_waitcnt vmcnt(8)
  buffer_load_dwordx4 v[72:75], v219, s[32:35], 0 offen nt
  ds_read_b64 v[128:129], v12 offset:3072
  ds_read_b64 v[130:131], v12 offset:3200
  ds_read_b64 v[132:133], v12 offset:4096
  ds_read_b64 v[134:135], v12 offset:4224
  ds_read_b64 v[136:137], v12 offset:5120
  ds_read_b64 v[138:139], v12 offset:5248
  v_dot2_f32_bf16 v22, v121, v64, 0
  v_add_f32_dpp v21, v18, v18 row_ror:8 row_mask:0xf bank_mask:0xc
  v_add_f32_dpp v21, v20, v20 row_ror:8 row_mask:0xf bank_mask:0x3
  v_add_f32_dpp v20, v35, v35 row_half_mirror row_mask:0xf bank_mask:0x5
  v_dot2_f32_bf16 v23, v126, v65, 0
  v_add_f32_dpp v20, v21, v21 row_half_mirror row_mask:0xf bank_mask:0xa
  v_dot2_f32_bf16 v24, v124, v66, 0
  v_dot2_f32_bf16 v25, v127, v67, 0
  v_add_f32_dpp v20, v20, v20 quad_perm:[2,3,0,1] row_mask:0xf bank_mask:0xf
  v_cvt_f32_i32 v88, v88
  v_cvt_f32_i32 v89, v89
  v_add_f32_dpp v20, v20, v20 quad_perm:[1,0,3,2] row_mask:0xf bank_mask:0xf
  v_cndmask_b32_e64 v33, v33, v20, s[48:49]
  v_cvt_f32_i32 v90, v90
  v_cvt_f32_i32 v91, v91
  v_pk_mul_f32 v[20:21], v[88:89], v[22:23]
  v_pk_add_f32 v[18:19], v[22:23], v[24:25]
  v_pk_fma_f32 v[20:21], v[90:91], v[24:25], v[20:21]
  v_add_f32 v18, v18, v19
  v_add_f32 v20, v20, v21
  s_waitcnt vmcnt(8)
  buffer_load_dwordx4 v[76:79], v220, s[32:35], 0 offen nt
L_it2:
  s_waitcnt lgkmcnt(0)
  ds_read_b32 v4, v14 offset:24
  v_perm_b32 v125, v130, v128, s56
  v_perm_b32 v130, v130, v128, s57
  v_perm_b32 v128, v131, v129, s56
  v_perm_b32 v131, v131, v129, s57
  v_dot2_f32_bf16 v22, v125, v44, 0
  v_add_f32_dpp v35, v18, v18 row_ror:8 row_mask:0xf bank_mask:0xc
  v_add_f32_dpp v35, v20, v20 row_ror:8 row_mask:0xf bank_mask:0x3
  v_dot2_f32_bf16 v23, v130, v45, 0
  v_dot2_f32_bf16 v24, v128, v46, 0
  v_dot2_f32_bf16 v25, v131, v47, 0
  v_cvt_f32_i32 v92, v92
  v_cvt_f32_i32 v93, v93
  v_cvt_f32_i32 v94, v94
  v_cvt_f32_i32 v95, v95
  v_pk_mul_f32 v[20:21], v[92:93], v[22:23]
  v_pk_add_f32 v[18:19], v[22:23], v[24:25]
  v_pk_fma_f32 v[20:21], v[94:95], v[24:25], v[20:21]
  v_add_f32 v18, v18, v19
  v_add_f32 v20, v20, v21
  s_add_u32 m0, s100, 9216
  v_lshrrev_b32 v10, 1, v221
  v_add_u32 v10, v10, v240
  v_mad_u64_u32 v[30:31], s[64:65], v10, 1, v[28:29]
  s_waitcnt vmcnt(8)
  global_load_lds_dwordx4 v[30:31], off
  s_waitcnt vmcnt(8)
  buffer_load_dwordx4 v[80:83], v218, s[32:35], s80 offen nt
  v_perm_b32 v129, v134, v132, s56
  v_perm_b32 v134, v134, v132, s57
  v_perm_b32 v132, v135, v133, s56
  v_perm_b32 v135, v135, v133, s57
  v_dot2_f32_bf16 v22, v129, v48, 0
  v_add_f32_dpp v21, v18, v18 row_ror:8 row_mask:0xf bank_mask:0xc
  v_add_f32_dpp v21, v20, v20 row_ror:8 row_mask:0xf bank_mask:0x3
  v_add_f32_dpp v20, v34, v34 row_half_mirror row_mask:0xf bank_mask:0x5
  v_dot2_f32_bf16 v23, v134, v49, 0
  v_add_f32_dpp v20, v21, v21 row_half_mirror row_mask:0xf bank_mask:0xa
  v_dot2_f32_bf16 v24, v132, v50, 0
  v_dot2_f32_bf16 v25, v135, v51, 0
  v_add_f32_dpp v20, v20, v20 quad_perm:[2,3,0,1] row_mask:0xf bank_mask:0xf
  v_cvt_f32_i32 v96, v96
  v_cvt_f32_i32 v97, v97
  v_add_f32_dpp v20, v20, v20 quad_perm:[1,0,3,2] row_mask:0xf bank_mask:0xf
  v_cndmask_b32_e64 v32, v32, v20, s[50:51]
  v_cvt_f32_i32 v98, v98
  v_cvt_f32_i32 v99, v99
  v_pk_mul_f32 v[20:21], v[96:97], v[22:23]
  v_pk_add_f32 v[18:19], v[22:23], v[24:25]
  v_pk_fma_f32 v[20:21], v[98:99], v[24:25], v[20:21]
  v_add_f32 v18, v18, v19
  v_add_f32 v20, v20, v21
  s_waitcnt vmcnt(8)
  buffer_load_dwordx4 v[84:87], v219, s[32:35], s80 offen nt
  v_perm_b32 v133, v138, v136, s56
  v_perm_b32 v138, v138, v136, s57
  v_perm_b32 v136, v139, v137, s56
  v_perm_b32 v139, v139, v137, s57
  v_dot2_f32_bf16 v22, v133, v52, 0
  v_add_f32_dpp v34, v18, v18 row_ror:8 row_mask:0xf bank_mask:0xc
  v_add_f32_dpp v34, v20, v20 row_ror:8 row_mask:0xf bank_mask:0x3
  v_dot2_f32_bf16 v23, v138, v53, 0
  v_dot2_f32_bf16 v24, v136, v54, 0
  v_dot2_f32_bf16 v25, v139, v55, 0
  v_cvt_f32_i32 v100, v100
  v_cvt_f32_i32 v101, v101
  v_cvt_f32_i32 v102, v102
  v_cvt_f32_i32 v103, v103
  v_pk_mul_f32 v[20:21], v[100:101], v[22:23]
  v_pk_add_f32 v[18:19], v[22:23], v[24:25]
  v_pk_fma_f32 v[20:21], v[102:103], v[24:25], v[20:21]
  v_add_f32 v18, v18, v19
  v_add_f32 v20, v20, v21
  s_add_u32 m0, s100, 10240
  v_lshrrev_b32 v10, 1, v222
  v_add_u32 v10, v10, v241
  v_mad_u64_u32 v[30:31], s[64:65], v10, 1, v[28:29]
  s_waitcnt vmcnt(8)
  global_load_lds_dwordx4 v[30:31], off
  s_waitcnt vmcnt(8)
  buffer_load_dwordx4 v[88:91], v220, s[32:35], s80 offen nt
L_it3:
  s_mov_b32 s47, 1
L_fc:
  s_waitcnt lgkmcnt(0)
  v_readfirstlane_b32 s46, v4
  s_cmp_ge_u32 s46, s47
  s_cbranch_scc1 L_fc_ok
  s_cmp_eq_u32 s94, 0
  s_cbranch_scc1 L_fc_ok
  s_sub_u32 s94, s94, 1
  ds_read_b32 v4, v14 offset:24
  s_branch L_fc
L_fc_ok:
  s_add_u32 s44, s78, 0x03030303
  v_msad_u8 v9, s78, v40, 0
  v_msad_u8 v10, s44, v40, 0
  v_msad_u8 v9, s78, v41, v9
  v_msad_u8 v10, s44, v41, v10
  v_msad_u8 v9, s78, v42, v9
  v_msad_u8 v10, s44, v42, v10
  s_mov_b64 exec, 3
  global_store_byte v7, v8, s[30:31]
  global_load_dwordx3 v[40:42], v239, s[30:31] sc1
  v_sub_u32 v9, v9, v10
  v_add_u32 v8, 1, v8
  s_mov_b64 exec, -1
  v_readlane_b32 s66, v9, 0
  v_readlane_b32 s67, v9, 1
  s_add_u32 s78, s78, 0x01010101
  s_lshl1_add_u32 s69, s91, s95
  s_add_u32 s95, s66, s67
  s_mov_b32 s69, 0
  v_dot2_f32_bf16 v22, v125, v56, 0
  v_add_f32_dpp v21, v18, v18 row_ror:8 row_mask:0xf bank_mask:0xc
  v_add_f32_dpp v21, v20, v20 row_ror:8 row_mask:0xf bank_mask:0x3
  v_add_f32_dpp v20, v34, v34 row_half_mirror row_mask:0xf bank_mask:0x5
  v_dot2_f32_bf16 v23, v130, v57, 0
  v_add_f32_dpp v20, v21, v21 row_half_mirror row_mask:0xf bank_mask:0xa
  v_dot2_f32_bf16 v24, v128, v58, 0
  v_dot2_f32_bf16 v25, v131, v59, 0
  v_add_f32_dpp v20, v20, v20 quad_perm:[2,3,0,1] row_mask:0xf bank_mask:0xf
  v_cvt_f32_i32 v104, v104
  v_cvt_f32_i32 v105, v105
  v_add_f32_dpp v20, v20, v20 quad_perm:[1,0,3,2] row_mask:0xf bank_mask:0xf
  v_cndmask_b32_e64 v32, v32, v20, s[52:53]
  v_cvt_f32_i32 v106, v106
  v_cvt_f32_i32 v107, v107
  v_pk_mul_f32 v[20:21], v[104:105], v[22:23]
  v_pk_add_f32 v[18:19], v[22:23], v[24:25]
  v_pk_fma_f32 v[20:21], v[106:107], v[24:25], v[20:21]
  v_add_f32 v18, v18, v19
  v_add_f32 v20, v20, v21
  s_cmpk_gt_i32 s69, 0x31
  s_cbranch_scc1 L_p2_4
  s_cmpk_gt_i32 s69, 0xffed
  s_cbranch_scc1 L_p2_1
  s_waitcnt vmcnt(6)
L_p2_1:
  s_waitcnt vmcnt(8)
L_p2_4:
  s_waitcnt vmcnt(9)
  buffer_load_dwordx4 v[92:95], v221, s[32:35], 0 offen nt
  v_dot2_f32_bf16 v22, v129, v60, 0
  v_add_f32_dpp v21, v18, v18 row_ror:8 row_mask:0xf bank_mask:0xc
  v_add_f32_dpp v21, v20, v20 row_ror:8 row_mask:0xf bank_mask:0x3
  v_add_f32_dpp v20, v35, v35 row_half_mirror row_mask:0xf bank_mask:0x5
  v_dot2_f32_bf16 v23, v134, v61, 0
  v_add_f32_dpp v20, v21, v21 row_half_mirror row_mask:0xf bank_mask:0xa
  v_dot2_f32_bf16 v24, v132, v62, 0
  v_dot2_f32_bf16 v25, v135, v63, 0
  v_add_f32_dpp v20, v20, v20 quad_perm:[2,3,0,1] row_mask:0xf bank_mask:0xf
  v_cvt_f32_i32 v108, v108
  v_cvt_f32_i32 v109, v109
  v_add_f32_dpp v20, v20, v20 quad_perm:[1,0,3,2] row_mask:0xf bank_mask:0xf
  v_cndmask_b32_e64 v33, v33, v20, s[50:51]
  v_cvt_f32_i32 v110, v110
  v_cvt_f32_i32 v111, v111
  v_pk_mul_f32 v[20:21], v[108:109], v[22:23]
  v_pk_add_f32 v[18:19], v[22:23], v[24:25]
  v_pk_fma_f32 v[20:21], v[110:111], v[24:25], v[20:21]
  v_add_f32 v18, v18, v19
  v_add_f32 v20, v20, v21
  s_add_u32 m0, s100, 11264
  v_lshrrev_b32 v10, 1, v223
  v_add_u32 v10, v10, v242
  v_mad_u64_u32 v[30:31], s[64:65], v10, 1, v[28:29]
  global_load_lds_dwordx4 v[30:31], off
  s_cmpk_gt_i32 s69, 0x31
  s_cbranch_scc1 L_p3_4
  s_cmpk_gt_i32 s69, 0xb
  s_cbranch_scc1 L_p3_2
  s_waitcnt vmcnt(8)
L_p3_2:
  s_waitcnt vmcnt(10)
L_p3_4:
  s_waitcnt vmcnt(11)
  buffer_load_dwordx4 v[96:99], v222, s[32:35], 0 offen nt
  s_waitcnt vmcnt(11)
  ds_read_b64 v[140:141], v12 offset:6144
  ds_read_b64 v[142:143], v12 offset:6272
  ds_read_b64 v[144:145], v12 offset:7168
  ds_read_b64 v[146:147], v12 offset:7296
  ds_read_b64 v[148:149], v12 offset:8192
  ds_read_b64 v[150:151], v12 offset:8320
  v_dot2_f32_bf16 v22, v133, v64, 0
  v_add_f32_dpp v35, v18, v18 row_ror:8 row_mask:0xf bank_mask:0xc
  v_add_f32_dpp v35, v20, v20 row_ror:8 row_mask:0xf bank_mask:0x3
  v_dot2_f32_bf16 v23, v138, v65, 0
  v_dot2_f32_bf16 v24, v136, v66, 0
  v_dot2_f32_bf16 v25, v139, v67, 0
  v_cvt_f32_i32 v112, v112
  v_cvt_f32_i32 v113, v113
  v_cvt_f32_i32 v114, v114
  v_cvt_f32_i32 v115, v115
  v_pk_mul_f32 v[20:21], v[112:113], v[22:23]
  v_pk_add_f32 v[18:19], v[22:23], v[24:25]
  v_pk_fma_f32 v[20:21], v[114:115], v[24:25], v[20:21]
  v_add_f32 v18, v18, v19
  v_add_f32 v20, v20, v21
  s_cmpk_gt_i32 s69, 0x31
  s_cbranch_scc1 L_p4_4
  s_cmpk_gt_i32 s69, 0x1d
  s_cbranch_scc1 L_p4_3
  s_cmpk_gt_i32 s69, 0xffcd
  s_cbranch_scc1 L_p4_0
  s_waitcnt vmcnt(8)
L_p4_0:
  s_waitcnt vmcnt(9)
L_p4_3:
  s_waitcnt vmcnt(11)
L_p4_4:
  s_waitcnt vmcnt(12)
  buffer_load_dwordx4 v[100:103], v223, s[32:35], 0 offen nt
L_it4:
  s_waitcnt lgkmcnt(0)
  s_add_u32 s44, s78, 0x03030303
  v_msad_u8 v9, s78, v36, 0
  v_msad_u8 v10, s44, v36, 0
  v_msad_u8 v9, s78, v37, v9
  v_msad_u8 v10, s44, v37, v10
  v_msad_u8 v9, s78, v38, v9
  v_msad_u8 v10, s44, v38, v10
  s_mov_b64 exec, 3
  global_store_byte v7, v8, s[30:31]
  global_load_dwordx3 v[36:38], v236, s[30:31] sc1
  v_sub_u32 v9, v9, v10
  v_add_u32 v8, 1, v8
  s_mov_b64 exec, -1
  v_readlane_b32 s66, v9, 0
  v_readlane_b32 s67, v9, 1
  s_add_u32 s78, s78, 0x01010101
  s_lshl1_add_u32 s69, s91, s95
  s_add_u32 s95, s66, s67
  s_mov_b32 s69, 0
  v_perm_b32 v137, v142, v140, s56
  v_perm_b32 v142, v142, v140, s57
  v_perm_b32 v140, v143, v141, s56
  v_perm_b32 v143, v143, v141, s57
  v_dot2_f32_bf16 v22, v137, v44, 0
  v_add_f32_dpp v21, v18, v18 row_ror:8 row_mask:0xf bank_mask:0xc
  v_add_f32_dpp v21, v20, v20 row_ror:8 row_mask:0xf bank_mask:0x3
  v_add_f32_dpp v20, v35, v35 row_half_mirror row_mask:0xf bank_mask:0x5
  v_dot2_f32_bf16 v23, v142, v45, 0
  v_add_f32_dpp v20, v21, v21 row_half_mirror row_mask:0xf bank_mask:0xa
  v_dot2_f32_bf16 v24, v140, v46, 0
  v_dot2_f32_bf16 v25, v143, v47, 0
  v_add_f32_dpp v20, v20, v20 quad_perm:[2,3,0,1] row_mask:0xf bank_mask:0xf
  v_cvt_f32_i32 v68, v68
  v_cvt_f32_i32 v69, v69
  v_add_f32_dpp v20, v20, v20 quad_perm:[1,0,3,2] row_mask:0xf bank_mask:0xf
  v_cndmask_b32_e64 v33, v33, v20, s[52:53]
  v_cvt_f32_i32 v70, v70
  v_cvt_f32_i32 v71, v71
  v_pk_mul_f32 v[20:21], v[68:69], v[22:23]
  v_pk_add_f32 v[18:19], v[22:23], v[24:25]
  v_pk_fma_f32 v[20:21], v[70:71], v[24:25], v[20:21]
  v_add_f32 v18, v18, v19
  v_add_f32 v20, v20, v21
  s_add_u32 m0, s100, 12288
  v_lshrrev_b32 v10, 1, v224
  v_add_u32 v10, v10, v240
  v_mad_u64_u32 v[30:31], s[64:65], v10, 1, v[28:29]
  global_load_lds_dwordx4 v[30:31], off
  s_cmpk_gt_i32 s69, 0x31
  s_cbranch_scc1 L_p5_4
  s_cmpk_gt_i32 s69, 0xffed
  s_cbranch_scc1 L_p5_1
  s_waitcnt vmcnt(7)
L_p5_1:
  s_waitcnt vmcnt(10)
L_p5_4:
  s_waitcnt vmcnt(12)
  buffer_load_dwordx4 v[104:107], v221, s[32:35], s80 offen nt
  v_perm_b32 v141, v146, v144, s56
  v_perm_b32 v146, v146, v144, s57
  v_perm_b32 v144, v147, v145, s56
  v_perm_b32 v147, v147, v145, s57
  v_dot2_f32_bf16 v22, v141, v48, 0
  v_add_f32_dpp v34, v18, v18 row_ror:8 row_mask:0xf bank_mask:0xc
  v_add_f32_dpp v34, v20, v20 row_ror:8 row_mask:0xf bank_mask:0x3
  v_dot2_f32_bf16 v23, v146, v49, 0
  v_dot2_f32_bf16 v24, v144, v50, 0
  v_dot2_f32_bf16 v25, v147, v51, 0
  v_cvt_f32_i32 v72, v72
  v_cvt_f32_i32 v73, v73
  v_cvt_f32_i32 v74, v74
  v_cvt_f32_i32 v75, v75
  v_pk_mul_f32 v[20:21], v[72:73], v[22:23]
  v_pk_add_f32 v[18:19], v[22:23], v[24:25]
  v_pk_fma_f32 v[20:21], v[74:75], v[24:25], v[20:21]
  v_add_f32 v18, v18, v19
  v_add_f32 v20, v20, v21
  s_cmpk_gt_i32 s69, 0x31
  s_cbranch_scc1 L_p6_4
  s_cmpk_gt_i32 s69, 0xb
  s_cbranch_scc1 L_p6_2
  s_waitcnt vmcnt(8)
L_p6_2:
  s_waitcnt vmcnt(11)
L_p6_4:
  s_waitcnt vmcnt(13)
  buffer_load_dwordx4 v[108:111], v222, s[32:35], s80 offen nt
  v_perm_b32 v145, v150, v148, s56
  v_perm_b32 v150, v150, v148, s57
  v_perm_b32 v148, v151, v149, s56
  v_perm_b32 v151, v151, v149, s57
  v_dot2_f32_bf16 v22, v145, v52, 0
  v_add_f32_dpp v21, v18, v18 row_ror:8 row_mask:0xf bank_mask:0xc
  v_add_f32_dpp v21, v20, v20 row_ror:8 row_mask:0xf bank_mask:0x3
  v_add_f32_dpp v20, v34, v34 row_half_mirror row_mask:0xf bank_mask:0x5
  v_dot2_f32_bf16 v23, v150, v53, 0
  v_add_f32_dpp v20, v21, v21 row_half_mirror row_mask:0xf bank_mask:0xa
  v_dot2_f32_bf16 v24, v148, v54, 0
  v_dot2_f32_bf16 v25, v151, v55, 0
  v_add_f32_dpp v20, v20, v20 quad_perm:[2,3,0,1] row_mask:0xf bank_mask:0xf
  v_cvt_f32_i32 v76, v76
  v_cvt_f32_i32 v77, v77
  v_add_f32_dpp v20, v20, v20 quad_perm:[1,0,3,2] row_mask:0xf bank_mask:0xf
  v_cndmask_b32_e64 v32, v32, v20, s[54:55]
  ds_write_b32 v1, v32 offset:0
  v_cvt_f32_i32 v78, v78
  v_cvt_f32_i32 v79, v79
  v_pk_mul_f32 v[20:21], v[76:77], v[22:23]
  v_pk_add_f32 v[18:19], v[22:23], v[24:25]
  v_pk_fma_f32 v[20:21], v[78:79], v[24:25], v[20:21]
  v_add_f32 v18, v18, v19
  v_add_f32 v20, v20, v21
  s_add_u32 m0, s100, 13312
  v_lshrrev_b32 v10, 1, v225
  v_add_u32 v10, v10, v241
  v_mad_u64_u32 v[30:31], s[64:65], v10, 1, v[28:29]
  global_load_lds_dwordx4 v[30:31], off
  s_cmpk_gt_i32 s69, 0x31
  s_cbranch_scc1 L_p7_4
  s_cmpk_gt_i32 s69, 0x1d
  s_cbranch_scc1 L_p7_3
  s_cmpk_gt_i32 s69, 0xffcd
  s_cbranch_scc1 L_p7_0
  s_waitcnt vmcnt(8)
L_p7_0:
  s_waitcnt vmcnt(10)
L_p7_3:
  s_waitcnt vmcnt(13)
L_p7_4:
  s_waitcnt vmcnt(15)
  buffer_load_dwordx4 v[112:115], v223, s[32:35], s80 offen nt
L_it5:
  s_waitcnt lgkmcnt(0)
  s_waitcnt vmcnt(10)
  s_add_u32 s44, s78, 0x03030303
  v_msad_u8 v9, s78, v40, 0
  v_msad_u8 v10, s44, v40, 0
  v_msad_u8 v9, s78, v41, v9
  v_msad_u8 v10, s44, v41, v10
  v_msad_u8 v9, s78, v42, v9
  v_msad_u8 v10, s44, v42, v10
  s_mov_b64 exec, 3
  global_load_dwordx2 v[26:27], v11, s[30:31] sc1
  global_store_byte v7, v8, s[30:31]
  global_load_dwordx3 v[40:42], v237, s[30:31] sc1
  v_sub_u32 v9, v9, v10
  v_add_u32 v8, 1, v8
  s_mov_b64 exec, -1
  v_readlane_b32 s66, v9, 0
  v_readlane_b32 s67, v9, 1
  s_add_u32 s78, s78, 0x01010101
  s_lshl1_add_u32 s69, s91, s95
  s_add_u32 s95, s66, s67
  s_add_u32 s69, s69, s95
  v_dot2_f32_bf16 v22, v137, v56, 0
  v_add_f32_dpp v34, v18, v18 row_ror:8 row_mask:0xf bank_mask:0xc
  v_add_f32_dpp v34, v20, v20 row_ror:8 row_mask:0xf bank_mask:0x3
  v_dot2_f32_bf16 v23, v142, v57, 0
  v_dot2_f32_bf16 v24, v140, v58, 0
  v_dot2_f32_bf16 v25, v143, v59, 0
  v_cvt_f32_i32 v80, v80
  v_cvt_f32_i32 v81, v81
  v_cvt_f32_i32 v82, v82
  v_cvt_f32_i32 v83, v83
  v_pk_mul_f32 v[20:21], v[80:81], v[22:23]
  v_pk_add_f32 v[18:19], v[22:23], v[24:25]
  v_pk_fma_f32 v[20:21], v[82:83], v[24:25], v[20:21]
  v_add_f32 v18, v18, v19
  v_add_f32 v20, v20, v21
  s_cmpk_gt_i32 s69, 0x31
  s_cbranch_scc1 L_p8_4
  s_cmpk_gt_i32 s69, 0xffed
  s_cbranch_scc1 L_p8_1
  s_waitcnt vmcnt(7)
L_p8_1:
  s_waitcnt vmcnt(11)
L_p8_4:
  s_waitcnt vmcnt(12)
  buffer_load_dwordx4 v[68:71], v224, s[32:35], 0 offen nt
  v_dot2_f32_bf16 v22, v141, v60, 0
  v_add_f32_dpp v35, v18, v18 row_ror:8 row_mask:0xf bank_mask:0xc
  v_add_f32_dpp v35, v20, v20 row_ror:8 row_mask:0xf bank_mask:0x3
  v_dot2_f32_bf16 v23, v146, v61, 0
  v_dot2_f32_bf16 v24, v144, v62, 0
  v_dot2_f32_bf16 v25, v147, v63, 0
  v_cvt_f32_i32 v84, v84
  v_cvt_f32_i32 v85, v85
  v_cvt_f32_i32 v86, v86
  v_cvt_f32_i32 v87, v87
  v_pk_mul_f32 v[20:21], v[84:85], v[22:23]
  v_pk_add_f32 v[18:19], v[22:23], v[24:25]
  v_pk_fma_f32 v[20:21], v[86:87], v[24:25], v[20:21]
  v_add_f32 v18, v18, v19
  v_add_f32 v20, v20, v21
  s_add_u32 m0, s100, 14336
  v_lshrrev_b32 v10, 1, v226
  v_add_u32 v10, v10, v242
  v_mad_u64_u32 v[30:31], s[64:65], v10, 1, v[28:29]
  global_load_lds_dwordx4 v[30:31], off
  s_cmpk_gt_i32 s69, 0x31
  s_cbranch_scc1 L_p9_4
  s_cmpk_gt_i32 s69, 0xb
  s_cbranch_scc1 L_p9_2
  s_waitcnt vmcnt(9)
L_p9_2:
  s_waitcnt vmcnt(13)
L_p9_4:
  s_waitcnt vmcnt(14)
  buffer_load_dwordx4 v[72:75], v225, s[32:35], 0 offen nt
  s_waitcnt vmcnt(13)
  ds_read_b64 v[152:153], v12 offset:9216
  ds_read_b64 v[154:155], v12 offset:9344
  ds_read_b64 v[156:157], v12 offset:10240
  ds_read_b64 v[158:159], v12 offset:10368
  ds_read_b64 v[160:161], v12 offset:11264
  ds_read_b64 v[162:163], v12 offset:11392
  v_dot2_f32_bf16 v22, v145, v64, 0
  v_add_f32_dpp v21, v18, v18 row_ror:8 row_mask:0xf bank_mask:0xc
  v_add_f32_dpp v21, v20, v20 row_ror:8 row_mask:0xf bank_mask:0x3
  v_add_f32_dpp v20, v35, v35 row_half_mirror row_mask:0xf bank_mask:0x5
  v_dot2_f32_bf16 v23, v150, v65, 0
  v_add_f32_dpp v20, v21, v21 row_half_mirror row_mask:0xf bank_mask:0xa
  v_dot2_f32_bf16 v24, v148, v66, 0
  v_dot2_f32_bf16 v25, v151, v67, 0
  v_add_f32_dpp v20, v20, v20 quad_perm:[2,3,0,1] row_mask:0xf bank_mask:0xf
  v_cvt_f32_i32 v88, v88
  v_cvt_f32_i32 v89, v89
  v_add_f32_dpp v20, v20, v20 quad_perm:[1,0,3,2] row_mask:0xf bank_mask:0xf
  v_cndmask_b32_e64 v33, v33, v20, s[54:55]
  ds_write_b32 v1, v33 offset:3072
  v_cvt_f32_i32 v90, v90
  v_cvt_f32_i32 v91, v91
  v_pk_mul_f32 v[20:21], v[88:89], v[22:23]
  v_pk_add_f32 v[18:19], v[22:23], v[24:25]
  v_pk_fma_f32 v[20:21], v[90:91], v[24:25], v[20:21]
  v_add_f32 v18, v18, v19
  v_add_f32 v20, v20, v21
  s_cmpk_gt_i32 s69, 0x31
  s_cbranch_scc1 L_p10_4
  s_cmpk_gt_i32 s69, 0x1d
  s_cbranch_scc1 L_p10_3
  s_cmpk_gt_i32 s69, 0xffcd
  s_cbranch_scc1 L_p10_0
  s_waitcnt vmcnt(9)
L_p10_0:
  s_waitcnt vmcnt(10)
L_p10_3:
  s_waitcnt vmcnt(14)
L_p10_4:
  s_waitcnt vmcnt(15)
  buffer_load_dwordx4 v[76:79], v226, s[32:35], 0 offen nt
L_it6:
  s_waitcnt lgkmcnt(0)
  s_waitcnt vmcnt(11)
  s_add_u32 s44, s78, 0x03030303
  v_msad_u8 v9, s78, v36, 0
  v_msad_u8 v10, s44, v36, 0
  v_msad_u8 v9, s78, v37, v9
  v_msad_u8 v10, s44, v37, v10
  v_msad_u8 v9, s78, v38, v9
  v_msad_u8 v10, s44, v38, v10
  s_mov_b64 exec, 3
  global_store_byte v7, v8, s[30:31]
  global_load_dwordx3 v[36:38], v238, s[30:31] sc1
  v_sub_u32 v9, v9, v10
  v_add_u32 v8, 1, v8
  s_mov_b64 exec, -1
  v_readlane_b32 s66, v9, 0
  v_readlane_b32 s67, v9, 1
  s_add_u32 s78, s78, 0x01010101
  s_lshl1_add_u32 s69, s91, s95
  s_add_u32 s95, s66, s67
  s_add_u32 s69, s69, s95
  v_perm_b32 v149, v154, v152, s56
  v_perm_b32 v154, v154, v152, s57
  v_perm_b32 v152, v155, v153, s56
  v_perm_b32 v155, v155, v153, s57
  v_dot2_f32_bf16 v22, v149, v44, 0
  v_add_f32_dpp v35, v18, v18 row_ror:8 row_mask:0xf bank_mask:0xc
  v_add_f32_dpp v35, v20, v20 row_ror:8 row_mask:0xf bank_mask:0x3
  v_dot2_f32_bf16 v23, v154, v45, 0
  v_dot2_f32_bf16 v24, v152, v46, 0
  v_dot2_f32_bf16 v25, v155, v47, 0
  v_cvt_f32_i32 v92, v92
  v_cvt_f32_i32 v93, v93
  v_cvt_f32_i32 v94, v94
  v_cvt_f32_i32 v95, v95
  v_pk_mul_f32 v[20:21], v[92:93], v[22:23]
  v_pk_add_f32 v[18:19], v[22:23], v[24:25]
  v_pk_fma_f32 v[20:21], v[94:95], v[24:25], v[20:21]
  v_add_f32 v18, v18, v19
  v_add_f32 v20, v20, v21
  s_add_u32 m0, s100, 15360
  v_lshrrev_b32 v10, 1, v227
  v_add_u32 v10, v10, v240
  v_mad_u64_u32 v[30:31], s[64:65], v10, 1, v[28:29]
  global_load_lds_dwordx4 v[30:31], off
  s_cmpk_gt_i32 s69, 0x31
  s_cbranch_scc1 L_p11_4
  s_cmpk_gt_i32 s69, 0xffed
  s_cbranch_scc1 L_p11_1
  s_waitcnt vmcnt(7)
L_p11_1:
  s_waitcnt vmcnt(11)
L_p11_4:
  s_waitcnt vmcnt(13)
  buffer_load_dwordx4 v[80:83], v224, s[32:35], s80 offen nt
  v_perm_b32 v153, v158, v156, s56
  v_perm_b32 v158, v158, v156, s57
  v_perm_b32 v156, v159, v157, s56
  v_perm_b32 v159, v159, v157, s57
  v_dot2_f32_bf16 v22, v153, v48, 0
  v_add_f32_dpp v21, v18, v18 row_ror:8 row_mask:0xf bank_mask:0xc
  v_add_f32_dpp v21, v20, v20 row_ror:8 row_mask:0xf bank_mask:0x3
  v_add_f32_dpp v20, v34, v34 row_half_mirror row_mask:0xf bank_mask:0x5
  v_dot2_f32_bf16 v23, v158, v49, 0
  v_add_f32_dpp v20, v21, v21 row_half_mirror row_mask:0xf bank_mask:0xa
  v_dot2_f32_bf16 v24, v156, v50, 0
  v_dot2_f32_bf16 v25, v159, v51, 0
  v_add_f32_dpp v20, v20, v20 quad_perm:[2,3,0,1] row_mask:0xf bank_mask:0xf
  v_cvt_f32_i32 v96, v96
  v_cvt_f32_i32 v97, v97
  v_add_f32_dpp v20, v20, v20 quad_perm:[1,0,3,2] row_mask:0xf bank_mask:0xf
  v_cndmask_b32_e64 v32, v32, v20, s[48:49]
  v_cvt_f32_i32 v98, v98
  v_cvt_f32_i32 v99, v99
  v_pk_mul_f32 v[20:21], v[96:97], v[22:23]
  v_pk_add_f32 v[18:19], v[22:23], v[24:25]
  v_pk_fma_f32 v[20:21], v[98:99], v[24:25], v[20:21]
  v_add_f32 v18, v18, v19
  v_add_f32 v20, v20, v21
  s_cmpk_gt_i32 s69, 0x31
  s_cbranch_scc1 L_p12_4
  s_cmpk_gt_i32 s69, 0xb
  s_cbranch_scc1 L_p12_2
  s_waitcnt vmcnt(8)
L_p12_2:
  s_waitcnt vmcnt(12)
L_p12_4:
  s_waitcnt vmcnt(14)
  buffer_load_dwordx4 v[84:87], v225, s[32:35], s80 offen nt
  v_perm_b32 v157, v162, v160, s56
  v_perm_b32 v162, v162, v160, s57
  v_perm_b32 v160, v163, v161, s56
  v_perm_b32 v163, v163, v161, s57
  v_dot2_f32_bf16 v22, v157, v52, 0
  v_add_f32_dpp v34, v18, v18 row_ror:8 row_mask:0xf bank_mask:0xc
  v_add_f32_dpp v34, v20, v20 row_ror:8 row_mask:0xf bank_mask:0x3
  v_dot2_f32_bf16 v23, v162, v53, 0
  v_dot2_f32_bf16 v24, v160, v54, 0
  v_dot2_f32_bf16 v25, v163, v55, 0
  v_cvt_f32_i32 v100, v100
  v_cvt_f32_i32 v101, v101
  v_cvt_f32_i32 v102, v102
  v_cvt_f32_i32 v103, v103
  v_pk_mul_f32 v[20:21], v[100:101], v[22:23]
  v_pk_add_f32 v[18:19], v[22:23], v[24:25]
  v_pk_fma_f32 v[20:21], v[102:103], v[24:25], v[20:21]
  v_add_f32 v18, v18, v19
  v_add_f32 v20, v20, v21
  s_add_u32 m0, s100, 16384
  v_lshrrev_b32 v10, 1, v228
  v_add_u32 v10, v10, v241
  v_mad_u64_u32 v[30:31], s[64:65], v10, 1, v[28:29]
  global_load_lds_dwordx4 v[30:31], off
  s_cmpk_gt_i32 s69, 0x31
  s_cbranch_scc1 L_p13_4
  s_cmpk_gt_i32 s69, 0x1d
  s_cbranch_scc1 L_p13_3
  s_cmpk_gt_i32 s69, 0xffcd
  s_cbranch_scc1 L_p13_0
  s_waitcnt vmcnt(8)
L_p13_0:
  s_waitcnt vmcnt(10)
L_p13_3:
  s_waitcnt vmcnt(14)
L_p13_4:
  s_waitcnt vmcnt(16)
  buffer_load_dwordx4 v[88:91], v226, s[32:35], s80 offen nt
L_it7:
  s_waitcnt lgkmcnt(0)
  s_waitcnt vmcnt(10)
  s_add_u32 s44, s78, 0x03030303
  v_msad_u8 v9, s78, v40, 0
  v_msad_u8 v10, s44, v40, 0
  v_msad_u8 v9, s78, v41, v9
  v_msad_u8 v10, s44, v41, v10
  v_msad_u8 v9, s78, v42, v9
  v_msad_u8 v10, s44, v42, v10
  s_mov_b64 exec, 3
  global_store_byte v7, v8, s[30:31]
  global_load_dwordx3 v[40:42], v239, s[30:31] sc1
  v_sub_u32 v9, v9, v10
  v_add3_u32 v10, v26, v27, s58
  v_add_u32 v8, 1, v8
  s_mov_b64 exec, -1
  v_readlane_b32 s66, v9, 0
  v_readlane_b32 s67, v9, 1
  v_readlane_b32 s91, v10, 0
  s_add_u32 s78, s78, 0x01010101
  s_lshl1_add_u32 s69, s91, s95
  s_add_u32 s95, s66, s67
  s_add_u32 s69, s69, s95
  v_dot2_f32_bf16 v22, v149, v56, 0
  v_add_f32_dpp v21, v18, v18 row_ror:8 row_mask:0xf bank_mask:0xc
  v_add_f32_dpp v21, v20, v20 row_ror:8 row_mask:0xf bank_mask:0x3
  v_add_f32_dpp v20, v34, v34 row_half_mirror row_mask:0xf bank_mask:0x5
  v_dot2_f32_bf16 v23, v154, v57, 0
  v_add_f32_dpp v20, v21, v21 row_half_mirror row_mask:0xf bank_mask:0xa
  v_dot2_f32_bf16 v24, v152, v58, 0
  v_dot2_f32_bf16 v25, v155, v59, 0
  v_add_f32_dpp v20, v20, v20 quad_perm:[2,3,0,1] row_mask:0xf bank_mask:0xf
  v_cvt_f32_i32 v104, v104
  v_cvt_f32_i32 v105, v105
  v_add_f32_dpp v20, v20, v20 quad_perm:[1,0,3,2] row_mask:0xf bank_mask:0xf
  v_cndmask_b32_e64 v32, v32, v20, s[50:51]
  v_cvt_f32_i32 v106, v106
  v_cvt_f32_i32 v107, v107
  v_pk_mul_f32 v[20:21], v[104:105], v[22:23]
  v_pk_add_f32 v[18:19], v[22:23], v[24:25]
  v_pk_fma_f32 v[20:21], v[106:107], v[24:25], v[20:21]
  v_add_f32 v18, v18, v19
  v_add_f32 v20, v20, v21
  s_cmpk_gt_i32 s69, 0x31
  s_cbranch_scc1 L_p14_4
  s_cmpk_gt_i32 s69, 0xffed
  s_cbranch_scc1 L_p14_1
  s_waitcnt vmcnt(6)
L_p14_1:
  s_waitcnt vmcnt(10)
L_p14_4:
  s_waitcnt vmcnt(11)
  buffer_load_dwordx4 v[92:95], v227, s[32:35], 0 offen nt
  v_dot2_f32_bf16 v22, v153, v60, 0
  v_add_f32_dpp v21, v18, v18 row_ror:8 row_mask:0xf bank_mask:0xc
  v_add_f32_dpp v21, v20, v20 row_ror:8 row_mask:0xf bank_mask:0x3
  v_add_f32_dpp v20, v35, v35 row_half_mirror row_mask:0xf bank_mask:0x5
  v_dot2_f32_bf16 v23, v158, v61, 0
  v_add_f32_dpp v20, v21, v21 row_half_mirror row_mask:0xf bank_mask:0xa
  v_dot2_f32_bf16 v24, v156, v62, 0
  v_dot2_f32_bf16 v25, v159, v63, 0
  v_add_f32_dpp v20, v20, v20 quad_perm:[2,3,0,1] row_mask:0xf bank_mask:0xf
  v_cvt_f32_i32 v108, v108
  v_cvt_f32_i32 v109, v109
  v_add_f32_dpp v20, v20, v20 quad_perm:[1,0,3,2] row_mask:0xf bank_mask:0xf
  v_cndmask_b32_e64 v33, v33, v20, s[48:49]
  v_cvt_f32_i32 v110, v110
  v_cvt_f32_i32 v111, v111
  v_pk_mul_f32 v[20:21], v[108:109], v[22:23]
  v_pk_add_f32 v[18:19], v[22:23], v[24:25]
  v_pk_fma_f32 v[20:21], v[110:111], v[24:25], v[20:21]
  v_add_f32 v18, v18, v19
  v_add_f32 v20, v20, v21
  s_add_u32 m0, s100, 17408
  v_lshrrev_b32 v10, 1, v229
  v_add_u32 v10, v10, v242
  v_mad_u64_u32 v[30:31], s[64:65], v10, 1, v[28:29]
  global_load_lds_dwordx4 v[30:31], off
  s_cmpk_gt_i32 s69, 0x31
  s_cbranch_scc1 L_p15_4
  s_cmpk_gt_i32 s69, 0xb
  s_cbranch_scc1 L_p15_2
  s_waitcnt vmcnt(8)
L_p15_2:
  s_waitcnt vmcnt(12)
L_p15_4:
  s_waitcnt vmcnt(13)
  buffer_load_dwordx4 v[96:99], v228, s[32:35], 0 offen nt
  s_waitcnt vmcnt(12)
  ds_read_b64 v[164:165], v12 offset:12288
  ds_read_b64 v[166:167], v12 offset:12416
  ds_read_b64 v[168:169], v12 offset:13312
  ds_read_b64 v[170:171], v12 offset:13440
  ds_read_b64 v[172:173], v12 offset:14336
  ds_read_b64 v[174:175], v12 offset:14464
  v_dot2_f32_bf16 v22, v157, v64, 0
  v_add_f32_dpp v35, v18, v18 row_ror:8 row_mask:0xf bank_mask:0xc
  v_add_f32_dpp v35, v20, v20 row_ror:8 row_mask:0xf bank_mask:0x3
  v_dot2_f32_bf16 v23, v162, v65, 0
  v_dot2_f32_bf16 v24, v160, v66, 0
  v_dot2_f32_bf16 v25, v163, v67, 0
  v_cvt_f32_i32 v112, v112
  v_cvt_f32_i32 v113, v113
  v_cvt_f32_i32 v114, v114
  v_cvt_f32_i32 v115, v115
  v_pk_mul_f32 v[20:21], v[112:113], v[22:23]
  v_pk_add_f32 v[18:19], v[22:23], v[24:25]
  v_pk_fma_f32 v[20:21], v[114:115], v[24:25], v[20:21]
  v_add_f32 v18, v18, v19
  v_add_f32 v20, v20, v21
  s_cmpk_gt_i32 s69, 0x31
  s_cbranch_scc1 L_p16_4
  s_cmpk_gt_i32 s69, 0x1d
  s_cbranch_scc1 L_p16_3
  s_cmpk_gt_i32 s69, 0xffcd
  s_cbranch_scc1 L_p16_0
  s_waitcnt vmcnt(8)
L_p16_0:
  s_waitcnt vmcnt(9)
L_p16_3:
  s_waitcnt vmcnt(13)
L_p16_4:
  s_waitcnt vmcnt(14)
  buffer_load_dwordx4 v[100:103], v229, s[32:35], 0 offen nt
  v_mov_b32 v9, 1
  ds_write_b32 v6, v9 offset:0
L_it8:
  s_waitcnt lgkmcnt(0)
  s_waitcnt vmcnt(10)
  s_add_u32 s44, s78, 0x03030303
  v_msad_u8 v9, s78, v36, 0
  v_msad_u8 v10, s44, v36, 0
  v_msad_u8 v9, s78, v37, v9
  v_msad_u8 v10, s44, v37, v10
  v_msad_u8 v9, s78, v38, v9
  v_msad_u8 v10, s44, v38, v10
  s_mov_b64 exec, 3
  global_store_byte v7, v8, s[30:31]
  global_load_dwordx3 v[36:38], v236, s[30:31] sc1
  v_sub_u32 v9, v9, v10
  v_add_u32 v8, 1, v8
  s_mov_b64 exec, -1
  v_readlane_b32 s66, v9, 0
  v_readlane_b32 s67, v9, 1
  s_add_u32 s78, s78, 0x01010101
  s_lshl1_add_u32 s69, s91, s95
  s_add_u32 s95, s66, s67
  s_add_u32 s69, s69, s95
  v_perm_b32 v161, v166, v164, s56
  v_perm_b32 v166, v166, v164, s57
  v_perm_b32 v164, v167, v165, s56
  v_perm_b32 v167, v167, v165, s57
  v_dot2_f32_bf16 v22, v161, v44, 0
  v_add_f32_dpp v21, v18, v18 row_ror:8 row_mask:0xf bank_mask:0xc
  v_add_f32_dpp v21, v20, v20 row_ror:8 row_mask:0xf bank_mask:0x3
  v_add_f32_dpp v20, v35, v35 row_half_mirror row_mask:0xf bank_mask:0x5
  v_dot2_f32_bf16 v23, v166, v45, 0
  v_add_f32_dpp v20, v21, v21 row_half_mirror row_mask:0xf bank_mask:0xa
  v_dot2_f32_bf16 v24, v164, v46, 0
  v_dot2_f32_bf16 v25, v167, v47, 0
  v_add_f32_dpp v20, v20, v20 quad_perm:[2,3,0,1] row_mask:0xf bank_mask:0xf
  v_cvt_f32_i32 v68, v68
  v_cvt_f32_i32 v69, v69
  v_add_f32_dpp v20, v20, v20 quad_perm:[1,0,3,2] row_mask:0xf bank_mask:0xf
  v_cndmask_b32_e64 v33, v33, v20, s[50:51]
  v_cvt_f32_i32 v70, v70
  v_cvt_f32_i32 v71, v71
  v_pk_mul_f32 v[20:21], v[68:69], v[22:23]
  v_pk_add_f32 v[18:19], v[22:23], v[24:25]
  v_pk_fma_f32 v[20:21], v[70:71], v[24:25], v[20:21]
  v_add_f32 v18, v18, v19
  v_add_f32 v20, v20, v21
  s_add_u32 m0, s100, 18432
  v_lshrrev_b32 v10, 1, v230
  v_add_u32 v10, v10, v240
  v_mad_u64_u32 v[30:31], s[64:65], v10, 1, v[28:29]
  global_load_lds_dwordx4 v[30:31], off
  s_cmpk_gt_i32 s69, 0x31
  s_cbranch_scc1 L_p17_4
  s_cmpk_gt_i32 s69, 0xffed
  s_cbranch_scc1 L_p17_1
  s_waitcnt vmcnt(7)
L_p17_1:
  s_waitcnt vmcnt(10)
L_p17_4:
  s_waitcnt vmcnt(12)
  buffer_load_dwordx4 v[104:107], v227, s[32:35], s80 offen nt
  v_perm_b32 v165, v170, v168, s56
  v_perm_b32 v170, v170, v168, s57
  v_perm_b32 v168, v171, v169, s56
  v_perm_b32 v171, v171, v169, s57
  v_dot2_f32_bf16 v22, v165, v48, 0
  v_add_f32_dpp v34, v18, v18 row_ror:8 row_mask:0xf bank_mask:0xc
  v_add_f32_dpp v34, v20, v20 row_ror:8 row_mask:0xf bank_mask:0x3
  v_dot2_f32_bf16 v23, v170, v49, 0
  v_dot2_f32_bf16 v24, v168, v50, 0
  v_dot2_f32_bf16 v25, v171, v51, 0
  v_cvt_f32_i32 v72, v72
  v_cvt_f32_i32 v73, v73
  v_cvt_f32_i32 v74, v74
  v_cvt_f32_i32 v75, v75
  v_pk_mul_f32 v[20:21], v[72:73], v[22:23]
  v_pk_add_f32 v[18:19], v[22:23], v[24:25]
  v_pk_fma_f32 v[20:21], v[74:75], v[24:25], v[20:21]
  v_add_f32 v18, v18, v19
  v_add_f32 v20, v20, v21
  s_cmpk_gt_i32 s69, 0x31
  s_cbranch_scc1 L_p18_4
  s_cmpk_gt_i32 s69, 0xb
  s_cbranch_scc1 L_p18_2
  s_waitcnt vmcnt(8)
L_p18_2:
  s_waitcnt vmcnt(11)
L_p18_4:
  s_waitcnt vmcnt(13)
  buffer_load_dwordx4 v[108:111], v228, s[32:35], s80 offen nt
  v_perm_b32 v169, v174, v172, s56
  v_perm_b32 v174, v174, v172, s57
  v_perm_b32 v172, v175, v173, s56
  v_perm_b32 v175, v175, v173, s57
  v_dot2_f32_bf16 v22, v169, v52, 0
  v_add_f32_dpp v21, v18, v18 row_ror:8 row_mask:0xf bank_mask:0xc
  v_add_f32_dpp v21, v20, v20 row_ror:8 row_mask:0xf bank_mask:0x3
  v_add_f32_dpp v20, v34, v34 row_half_mirror row_mask:0xf bank_mask:0x5
  v_dot2_f32_bf16 v23, v174, v53, 0
  v_add_f32_dpp v20, v21, v21 row_half_mirror row_mask:0xf bank_mask:0xa
  v_dot2_f32_bf16 v24, v172, v54, 0
  v_dot2_f32_bf16 v25, v175, v55, 0
  v_add_f32_dpp v20, v20, v20 quad_perm:[2,3,0,1] row_mask:0xf bank_mask:0xf
  v_cvt_f32_i32 v76, v76
  v_cvt_f32_i32 v77, v77
  v_add_f32_dpp v20, v20, v20 quad_perm:[1,0,3,2] row_mask:0xf bank_mask:0xf
  v_cndmask_b32_e64 v32, v32, v20, s[52:53]
  v_cvt_f32_i32 v78, v78
  v_cvt_f32_i32 v79, v79
  v_pk_mul_f32 v[20:21], v[76:77], v[22:23]
  v_pk_add_f32 v[18:19], v[22:23], v[24:25]
  v_pk_fma_f32 v[20:21], v[78:79], v[24:25], v[20:21]
  v_add_f32 v18, v18, v19
  v_add_f32 v20, v20, v21
  s_add_u32 m0, s100, 19456
  v_lshrrev_b32 v10, 1, v231
  v_add_u32 v10, v10, v241
  v_mad_u64_u32 v[30:31], s[64:65], v10, 1, v[28:29]
  global_load_lds_dwordx4 v[30:31], off
  s_cmpk_gt_i32 s69, 0x31
  s_cbranch_scc1 L_p19_4
  s_cmpk_gt_i32 s69, 0x1d
  s_cbranch_scc1 L_p19_3
  s_cmpk_gt_i32 s69, 0xffcd
  s_cbranch_scc1 L_p19_0
  s_waitcnt vmcnt(8)
L_p19_0:
  s_waitcnt vmcnt(10)
L_p19_3:
  s_waitcnt vmcnt(13)
L_p19_4:
  s_waitcnt vmcnt(15)
  buffer_load_dwordx4 v[112:115], v229, s[32:35], s80 offen nt
L_it9:
  s_waitcnt lgkmcnt(0)
  s_waitcnt vmcnt(10)
  s_add_u32 s44, s78, 0x03030303
  v_msad_u8 v9, s78, v40, 0
  v_msad_u8 v10, s44, v40, 0
  v_msad_u8 v9, s78, v41, v9
  v_msad_u8 v10, s44, v41, v10
  v_msad_u8 v9, s78, v42, v9
  v_msad_u8 v10, s44, v42, v10
  s_mov_b64 exec, 3
  global_store_byte v7, v8, s[30:31]
  global_load_dwordx3 v[40:42], v237, s[30:31] sc1
  v_sub_u32 v9, v9, v10
  v_add_u32 v8, 1, v8
  s_mov_b64 exec, -1
  v_readlane_b32 s66, v9, 0
  v_readlane_b32 s67, v9, 1
  s_add_u32 s78, s78, 0x01010101
  s_lshl1_add_u32 s69, s91, s95
  s_add_u32 s95, s66, s67
  s_add_u32 s69, s69, s95
  v_dot2_f32_bf16 v22, v161, v56, 0
  v_add_f32_dpp v34, v18, v18 row_ror:8 row_mask:0xf bank_mask:0xc
  v_add_f32_dpp v34, v20, v20 row_ror:8 row_mask:0xf bank_mask:0x3
  v_dot2_f32_bf16 v23, v166, v57, 0
  v_dot2_f32_bf16 v24, v164, v58, 0
  v_dot2_f32_bf16 v25, v167, v59, 0
  v_cvt_f32_i32 v80, v80
  v_cvt_f32_i32 v81, v81
  v_cvt_f32_i32 v82, v82
  v_cvt_f32_i32 v83, v83
  v_pk_mul_f32 v[20:21], v[80:81], v[22:23]
  v_pk_add_f32 v[18:19], v[22:23], v[24:25]
  v_pk_fma_f32 v[20:21], v[82:83], v[24:25], v[20:21]
  v_add_f32 v18, v18, v19
  v_add_f32 v20, v20, v21
  s_cmpk_gt_i32 s69, 0x31
  s_cbranch_scc1 L_p20_4
  s_cmpk_gt_i32 s69, 0xffed
  s_cbranch_scc1 L_p20_1
  s_waitcnt vmcnt(6)
L_p20_1:
  s_waitcnt vmcnt(10)
L_p20_4:
  s_waitcnt vmcnt(11)
  buffer_load_dwordx4 v[68:71], v230, s[32:35], 0 offen nt
  v_dot2_f32_bf16 v22, v165, v60, 0
  v_add_f32_dpp v35, v18, v18 row_ror:8 row_mask:0xf bank_mask:0xc
  v_add_f32_dpp v35, v20, v20 row_ror:8 row_mask:0xf bank_mask:0x3
  v_dot2_f32_bf16 v23, v170, v61, 0
  v_dot2_f32_bf16 v24, v168, v62, 0
  v_dot2_f32_bf16 v25, v171, v63, 0
  v_cvt_f32_i32 v84, v84
  v_cvt_f32_i32 v85, v85
  v_cvt_f32_i32 v86, v86
  v_cvt_f32_i32 v87, v87
  v_pk_mul_f32 v[20:21], v[84:85], v[22:23]
  v_pk_add_f32 v[18:19], v[22:23], v[24:25]
  v_pk_fma_f32 v[20:21], v[86:87], v[24:25], v[20:21]
  v_add_f32 v18, v18, v19
  v_add_f32 v20, v20, v21
  s_add_u32 m0, s100, 20480
  v_lshrrev_b32 v10, 1, v232
  v_add_u32 v10, v10, v242
  v_mad_u64_u32 v[30:31], s[64:65], v10, 1, v[28:29]
  global_load_lds_dwordx4 v[30:31], off
  s_cmpk_gt_i32 s69, 0x31
  s_cbranch_scc1 L_p21_4
  s_cmpk_gt_i32 s69, 0xb
  s_cbranch_scc1 L_p21_2
  s_waitcnt vmcnt(8)
L_p21_2:
  s_waitcnt vmcnt(12)
L_p21_4:
  s_waitcnt vmcnt(13)
  buffer_load_dwordx4 v[72:75], v231, s[32:35], 0 offen nt
  s_waitcnt vmcnt(12)
  ds_read_b64 v[176:177], v12 offset:15360
  ds_read_b64 v[178:179], v12 offset:15488
  ds_read_b64 v[180:181], v12 offset:16384
  ds_read_b64 v[182:183], v12 offset:16512
  ds_read_b64 v[184:185], v12 offset:17408
  ds_read_b64 v[186:187], v12 offset:17536
  v_dot2_f32_bf16 v22, v169, v64, 0
  v_add_f32_dpp v21, v18, v18 row_ror:8 row_mask:0xf bank_mask:0xc
  v_add_f32_dpp v21, v20, v20 row_ror:8 row_mask:0xf bank_mask:0x3
  v_add_f32_dpp v20, v35, v35 row_half_mirror row_mask:0xf bank_mask:0x5
  v_dot2_f32_bf16 v23, v174, v65, 0
  v_add_f32_dpp v20, v21, v21 row_half_mirror row_mask:0xf bank_mask:0xa
  v_dot2_f32_bf16 v24, v172, v66, 0
  v_dot2_f32_bf16 v25, v175, v67, 0
  v_add_f32_dpp v20, v20, v20 quad_perm:[2,3,0,1] row_mask:0xf bank_mask:0xf
  v_cvt_f32_i32 v88, v88
  v_cvt_f32_i32 v89, v89
  v_add_f32_dpp v20, v20, v20 quad_perm:[1,0,3,2] row_mask:0xf bank_mask:0xf
  v_cndmask_b32_e64 v33, v33, v20, s[52:53]
  v_cvt_f32_i32 v90, v90
  v_cvt_f32_i32 v91, v91
  v_pk_mul_f32 v[20:21], v[88:89], v[22:23]
  v_pk_add_f32 v[18:19], v[22:23], v[24:25]
  v_pk_fma_f32 v[20:21], v[90:91], v[24:25], v[20:21]
  v_add_f32 v18, v18, v19
  v_add_f32 v20, v20, v21
  s_cmpk_gt_i32 s69, 0x31
  s_cbranch_scc1 L_p22_4
  s_cmpk_gt_i32 s69, 0x1d
  s_cbranch_scc1 L_p22_3
  s_cmpk_gt_i32 s69, 0xffcd
  s_cbranch_scc1 L_p22_0
  s_waitcnt vmcnt(8)
L_p22_0:
  s_waitcnt vmcnt(9)
L_p22_3:
  s_waitcnt vmcnt(13)
L_p22_4:
  s_waitcnt vmcnt(14)
  buffer_load_dwordx4 v[76:79], v232, s[32:35], 0 offen nt
L_it10:
  s_waitcnt lgkmcnt(0)
  s_waitcnt vmcnt(10)
  s_add_u32 s44, s78, 0x03030303
  v_msad_u8 v9, s78, v36, 0
  v_msad_u8 v10, s44, v36, 0
  v_msad_u8 v9, s78, v37, v9
  v_msad_u8 v10, s44, v37, v10
  v_msad_u8 v9, s78, v38, v9
  v_msad_u8 v10, s44, v38, v10
  s_mov_b64 exec, 3
  global_store_byte v7, v8, s[30:31]
  global_load_dwordx3 v[36:38], v238, s[30:31] sc1
  v_sub_u32 v9, v9, v10
  v_add_u32 v8, 1, v8
  s_mov_b64 exec, -1
  v_readlane_b32 s66, v9, 0
  v_readlane_b32 s67, v9, 1
  s_add_u32 s78, s78, 0x01010101
  s_lshl1_add_u32 s69, s91, s95
  s_add_u32 s95, s66, s67
  s_add_u32 s69, s69, s95
  v_perm_b32 v173, v178, v176, s56
  v_perm_b32 v178, v178, v176, s57
  v_perm_b32 v176, v179, v177, s56
  v_perm_b32 v179, v179, v177, s57
  v_dot2_f32_bf16 v22, v173, v44, 0
  v_add_f32_dpp v35, v18, v18 row_ror:8 row_mask:0xf bank_mask:0xc
  v_add_f32_dpp v35, v20, v20 row_ror:8 row_mask:0xf bank_mask:0x3
  v_dot2_f32_bf16 v23, v178, v45, 0
  v_dot2_f32_bf16 v24, v176, v46, 0
  v_dot2_f32_bf16 v25, v179, v47, 0
  v_cvt_f32_i32 v92, v92
  v_cvt_f32_i32 v93, v93
  v_cvt_f32_i32 v94, v94
  v_cvt_f32_i32 v95, v95
  v_pk_mul_f32 v[20:21], v[92:93], v[22:23]
  v_pk_add_f32 v[18:19], v[22:23], v[24:25]
  v_pk_fma_f32 v[20:21], v[94:95], v[24:25], v[20:21]
  v_add_f32 v18, v18, v19
  v_add_f32 v20, v20, v21
  s_add_u32 m0, s100, 21504
  v_lshrrev_b32 v10, 1, v233
  v_add_u32 v10, v10, v240
  v_mad_u64_u32 v[30:31], s[64:65], v10, 1, v[28:29]
  global_load_lds_dwordx4 v[30:31], off
  s_cmpk_gt_i32 s69, 0x31
  s_cbranch_scc1 L_p23_4
  s_cmpk_gt_i32 s69, 0xffed
  s_cbranch_scc1 L_p23_1
  s_waitcnt vmcnt(7)
L_p23_1:
  s_waitcnt vmcnt(10)
L_p23_4:
  s_waitcnt vmcnt(12)
  buffer_load_dwordx4 v[80:83], v230, s[32:35], s80 offen nt
  v_perm_b32 v177, v182, v180, s56
  v_perm_b32 v182, v182, v180, s57
  v_perm_b32 v180, v183, v181, s56
  v_perm_b32 v183, v183, v181, s57
  v_dot2_f32_bf16 v22, v177, v48, 0
  v_add_f32_dpp v21, v18, v18 row_ror:8 row_mask:0xf bank_mask:0xc
  v_add_f32_dpp v21, v20, v20 row_ror:8 row_mask:0xf bank_mask:0x3
  v_add_f32_dpp v20, v34, v34 row_half_mirror row_mask:0xf bank_mask:0x5
  v_dot2_f32_bf16 v23, v182, v49, 0
  v_add_f32_dpp v20, v21, v21 row_half_mirror row_mask:0xf bank_mask:0xa
  v_dot2_f32_bf16 v24, v180, v50, 0
  v_dot2_f32_bf16 v25, v183, v51, 0
  v_add_f32_dpp v20, v20, v20 quad_perm:[2,3,0,1] row_mask:0xf bank_mask:0xf
  v_cvt_f32_i32 v96, v96
  v_cvt_f32_i32 v97, v97
  v_add_f32_dpp v20, v20, v20 quad_perm:[1,0,3,2] row_mask:0xf bank_mask:0xf
  v_cndmask_b32_e64 v32, v32, v20, s[54:55]
  ds_write_b32 v1, v32 offset:512
  v_cvt_f32_i32 v98, v98
  v_cvt_f32_i32 v99, v99
  v_pk_mul_f32 v[20:21], v[96:97], v[22:23]
  v_pk_add_f32 v[18:19], v[22:23], v[24:25]
  v_pk_fma_f32 v[20:21], v[98:99], v[24:25], v[20:21]
  v_add_f32 v18, v18, v19
  v_add_f32 v20, v20, v21
  s_cmpk_gt_i32 s69, 0x31
  s_cbranch_scc1 L_p24_4
  s_cmpk_gt_i32 s69, 0xb
  s_cbranch_scc1 L_p24_2
  s_waitcnt vmcnt(8)
L_p24_2:
  s_waitcnt vmcnt(11)
L_p24_4:
  s_waitcnt vmcnt(13)
  buffer_load_dwordx4 v[84:87], v231, s[32:35], s80 offen nt
  v_perm_b32 v181, v186, v184, s56
  v_perm_b32 v186, v186, v184, s57
  v_perm_b32 v184, v187, v185, s56
  v_perm_b32 v187, v187, v185, s57
  v_dot2_f32_bf16 v22, v181, v52, 0
  v_add_f32_dpp v34, v18, v18 row_ror:8 row_mask:0xf bank_mask:0xc
  v_add_f32_dpp v34, v20, v20 row_ror:8 row_mask:0xf bank_mask:0x3
  v_dot2_f32_bf16 v23, v186, v53, 0
  v_dot2_f32_bf16 v24, v184, v54, 0
  v_dot2_f32_bf16 v25, v187, v55, 0
  v_cvt_f32_i32 v100, v100
  v_cvt_f32_i32 v101, v101
  v_cvt_f32_i32 v102, v102
  v_cvt_f32_i32 v103, v103
  v_pk_mul_f32 v[20:21], v[100:101], v[22:23]
  v_pk_add_f32 v[18:19], v[22:23], v[24:25]
  v_pk_fma_f32 v[20:21], v[102:103], v[24:25], v[20:21]
  v_add_f32 v18, v18, v19
  v_add_f32 v20, v20, v21
  s_add_u32 m0, s100, 22528
  v_lshrrev_b32 v10, 1, v234
  v_add_u32 v10, v10, v241
  v_mad_u64_u32 v[30:31], s[64:65], v10, 1, v[28:29]
  global_load_lds_dwordx4 v[30:31], off
  s_cmpk_gt_i32 s69, 0x31
  s_cbranch_scc1 L_p25_4
  s_cmpk_gt_i32 s69, 0x1d
  s_cbranch_scc1 L_p25_3
  s_cmpk_gt_i32 s69, 0xffcd
  s_cbranch_scc1 L_p25_0
  s_waitcnt vmcnt(8)
L_p25_0:
  s_waitcnt vmcnt(10)
L_p25_3:
  s_waitcnt vmcnt(13)
L_p25_4:
  s_waitcnt vmcnt(15)
  buffer_load_dwordx4 v[88:91], v232, s[32:35], s80 offen nt
L_it11:
  s_waitcnt lgkmcnt(0)
  s_waitcnt vmcnt(10)
  s_add_u32 s44, s78, 0x03030303
  v_msad_u8 v9, s78, v40, 0
  v_msad_u8 v10, s44, v40, 0
  v_msad_u8 v9, s78, v41, v9
  v_msad_u8 v10, s44, v41, v10
  v_msad_u8 v9, s78, v42, v9
  v_msad_u8 v10, s44, v42, v10
  s_mov_b64 exec, 3
  global_store_byte v7, v8, s[30:31]
  global_load_dwordx3 v[40:42], v239, s[30:31] sc1
  v_sub_u32 v9, v9, v10
  v_add_u32 v8, 1, v8
  s_mov_b64 exec, -1
  v_readlane_b32 s66, v9, 0
  v_readlane_b32 s67, v9, 1
  s_add_u32 s78, s78, 0x01010101
  s_lshl1_add_u32 s69, s91, s95
  s_add_u32 s95, s66, s67
  s_add_u32 s69, s69, s95
  v_dot2_f32_bf16 v22, v173, v56, 0
  v_add_f32_dpp v21, v18, v18 row_ror:8 row_mask:0xf bank_mask:0xc
  v_add_f32_dpp v21, v20, v20 row_ror:8 row_mask:0xf bank_mask:0x3
  v_add_f32_dpp v20, v34, v34 row_half_mirror row_mask:0xf bank_mask:0x5
  v_dot2_f32_bf16 v23, v178, v57, 0
  v_add_f32_dpp v20, v21, v21 row_half_mirror row_mask:0xf bank_mask:0xa
  v_dot2_f32_bf16 v24, v176, v58, 0
  v_dot2_f32_bf16 v25, v179, v59, 0
  v_add_f32_dpp v20, v20, v20 quad_perm:[2,3,0,1] row_mask:0xf bank_mask:0xf
  v_cvt_f32_i32 v104, v104
  v_cvt_f32_i32 v105, v105
  v_add_f32_dpp v20, v20, v20 quad_perm:[1,0,3,2] row_mask:0xf bank_mask:0xf
  v_cndmask_b32_e64 v32, v32, v20, s[48:49]
  v_cvt_f32_i32 v106, v106
  v_cvt_f32_i32 v107, v107
  v_pk_mul_f32 v[20:21], v[104:105], v[22:23]
  v_pk_add_f32 v[18:19], v[22:23], v[24:25]
  v_pk_fma_f32 v[20:21], v[106:107], v[24:25], v[20:21]
  v_add_f32 v18, v18, v19
  v_add_f32 v20, v20, v21
  s_cmpk_gt_i32 s69, 0x31
  s_cbranch_scc1 L_p26_4
  s_cmpk_gt_i32 s69, 0xffed
  s_cbranch_scc1 L_p26_1
  s_waitcnt vmcnt(6)
L_p26_1:
  s_waitcnt vmcnt(10)
L_p26_4:
  s_waitcnt vmcnt(11)
  buffer_load_dwordx4 v[92:95], v233, s[32:35], 0 offen nt
  v_dot2_f32_bf16 v22, v177, v60, 0
  v_add_f32_dpp v21, v18, v18 row_ror:8 row_mask:0xf bank_mask:0xc
  v_add_f32_dpp v21, v20, v20 row_ror:8 row_mask:0xf bank_mask:0x3
  v_add_f32_dpp v20, v35, v35 row_half_mirror row_mask:0xf bank_mask:0x5
  v_dot2_f32_bf16 v23, v182, v61, 0
  v_add_f32_dpp v20, v21, v21 row_half_mirror row_mask:0xf bank_mask:0xa
  v_dot2_f32_bf16 v24, v180, v62, 0
  v_dot2_f32_bf16 v25, v183, v63, 0
  v_add_f32_dpp v20, v20, v20 quad_perm:[2,3,0,1] row_mask:0xf bank_mask:0xf
  v_cvt_f32_i32 v108, v108
  v_cvt_f32_i32 v109, v109
  v_add_f32_dpp v20, v20, v20 quad_perm:[1,0,3,2] row_mask:0xf bank_mask:0xf
  v_cndmask_b32_e64 v33, v33, v20, s[54:55]
  ds_write_b32 v1, v33 offset:3584
  v_cvt_f32_i32 v110, v110
  v_cvt_f32_i32 v111, v111
  v_pk_mul_f32 v[20:21], v[108:109], v[22:23]
  v_pk_add_f32 v[18:19], v[22:23], v[24:25]
  v_pk_fma_f32 v[20:21], v[110:111], v[24:25], v[20:21]
  v_add_f32 v18, v18, v19
  v_add_f32 v20, v20, v21
  s_add_u32 m0, s100, 23552
  v_lshrrev_b32 v10, 1, v235
  v_add_u32 v10, v10, v242
  v_mad_u64_u32 v[30:31], s[64:65], v10, 1, v[28:29]
  global_load_lds_dwordx4 v[30:31], off
  s_cmpk_gt_i32 s69, 0x31
  s_cbranch_scc1 L_p27_4
  s_cmpk_gt_i32 s69, 0xb
  s_cbranch_scc1 L_p27_2
  s_waitcnt vmcnt(8)
L_p27_2:
  s_waitcnt vmcnt(12)
L_p27_4:
  s_waitcnt vmcnt(13)
  buffer_load_dwordx4 v[96:99], v234, s[32:35], 0 offen nt
  s_waitcnt vmcnt(12)
  ds_read_b64 v[188:189], v12 offset:18432
  ds_read_b64 v[190:191], v12 offset:18560
  ds_read_b64 v[192:193], v12 offset:19456
  ds_read_b64 v[194:195], v12 offset:19584
  ds_read_b64 v[196:197], v12 offset:20480
  ds_read_b64 v[198:199], v12 offset:20608
  v_dot2_f32_bf16 v22, v181, v64, 0
  v_add_f32_dpp v35, v18, v18 row_ror:8 row_mask:0xf bank_mask:0xc
  v_add_f32_dpp v35, v20, v20 row_ror:8 row_mask:0xf bank_mask:0x3
  v_dot2_f32_bf16 v23, v186, v65, 0
  v_dot2_f32_bf16 v24, v184, v66, 0
  v_dot2_f32_bf16 v25, v187, v67, 0
  v_cvt_f32_i32 v112, v112
  v_cvt_f32_i32 v113, v113
  v_cvt_f32_i32 v114, v114
  v_cvt_f32_i32 v115, v115
  v_pk_mul_f32 v[20:21], v[112:113], v[22:23]
  v_pk_add_f32 v[18:19], v[22:23], v[24:25]
  v_pk_fma_f32 v[20:21], v[114:115], v[24:25], v[20:21]
  v_add_f32 v18, v18, v19
  v_add_f32 v20, v20, v21
  s_cmpk_gt_i32 s69, 0x31
  s_cbranch_scc1 L_p28_4
  s_cmpk_gt_i32 s69, 0x1d
  s_cbranch_scc1 L_p28_3
  s_cmpk_gt_i32 s69, 0xffcd
  s_cbranch_scc1 L_p28_0
  s_waitcnt vmcnt(8)
L_p28_0:
  s_waitcnt vmcnt(9)
L_p28_3:
  s_waitcnt vmcnt(13)
L_p28_4:
  s_waitcnt vmcnt(14)
  buffer_load_dwordx4 v[100:103], v235, s[32:35], 0 offen nt
L_it12:
  s_waitcnt lgkmcnt(0)
  s_waitcnt vmcnt(10)
  s_add_u32 s44, s78, 0x03030303
  v_msad_u8 v9, s78, v36, 0
  v_msad_u8 v10, s44, v36, 0
  v_msad_u8 v9, s78, v37, v9
  v_msad_u8 v10, s44, v37, v10
  v_msad_u8 v9, s78, v38, v9
  v_msad_u8 v10, s44, v38, v10
  s_mov_b64 exec, 3
  global_store_byte v7, v8, s[30:31]
  global_load_dwordx3 v[36:38], v236, s[30:31] sc1
  v_sub_u32 v9, v9, v10
  v_add_u32 v8, 1, v8
  s_mov_b64 exec, -1
  v_readlane_b32 s66, v9, 0
  v_readlane_b32 s67, v9, 1
  s_add_u32 s78, s78, 0x01010101
  s_lshl1_add_u32 s69, s91, s95
  s_add_u32 s95, s66, s67
  s_add_u32 s69, s69, s95
  v_perm_b32 v185, v190, v188, s56
  v_perm_b32 v190, v190, v188, s57
  v_perm_b32 v188, v191, v189, s56
  v_perm_b32 v191, v191, v189, s57
  v_dot2_f32_bf16 v22, v185, v44, 0
  v_add_f32_dpp v21, v18, v18 row_ror:8 row_mask:0xf bank_mask:0xc
  v_add_f32_dpp v21, v20, v20 row_ror:8 row_mask:0xf bank_mask:0x3
  v_add_f32_dpp v20, v35, v35 row_half_mirror row_mask:0xf bank_mask:0x5
  v_dot2_f32_bf16 v23, v190, v45, 0
  v_add_f32_dpp v20, v21, v21 row_half_mirror row_mask:0xf bank_mask:0xa
  v_dot2_f32_bf16 v24, v188, v46, 0
  v_dot2_f32_bf16 v25, v191, v47, 0
  v_add_f32_dpp v20, v20, v20 quad_perm:[2,3,0,1] row_mask:0xf bank_mask:0xf
  v_cvt_f32_i32 v68, v68
  v_cvt_f32_i32 v69, v69
  v_add_f32_dpp v20, v20, v20 quad_perm:[1,0,3,2] row_mask:0xf bank_mask:0xf
  v_cndmask_b32_e64 v33, v33, v20, s[48:49]
  v_cvt_f32_i32 v70, v70
  v_cvt_f32_i32 v71, v71
  v_pk_mul_f32 v[20:21], v[68:69], v[22:23]
  v_pk_add_f32 v[18:19], v[22:23], v[24:25]
  v_pk_fma_f32 v[20:21], v[70:71], v[24:25], v[20:21]
  v_add_f32 v18, v18, v19
  v_add_f32 v20, v20, v21
  s_cmpk_gt_i32 s69, 0x31
  s_cbranch_scc1 L_p29_4
  s_cmpk_gt_i32 s69, 0xffed
  s_cbranch_scc1 L_p29_1
  s_waitcnt vmcnt(6)
L_p29_1:
  s_waitcnt vmcnt(9)
L_p29_4:
  s_waitcnt vmcnt(11)
  buffer_load_dwordx4 v[104:107], v233, s[32:35], s80 offen nt
  v_perm_b32 v189, v194, v192, s56
  v_perm_b32 v194, v194, v192, s57
  v_perm_b32 v192, v195, v193, s56
  v_perm_b32 v195, v195, v193, s57
  v_dot2_f32_bf16 v22, v189, v48, 0
  v_add_f32_dpp v34, v18, v18 row_ror:8 row_mask:0xf bank_mask:0xc
  v_add_f32_dpp v34, v20, v20 row_ror:8 row_mask:0xf bank_mask:0x3
  v_dot2_f32_bf16 v23, v194, v49, 0
  v_dot2_f32_bf16 v24, v192, v50, 0
  v_dot2_f32_bf16 v25, v195, v51, 0
  v_cvt_f32_i32 v72, v72
  v_cvt_f32_i32 v73, v73
  v_cvt_f32_i32 v74, v74
  v_cvt_f32_i32 v75, v75
  v_pk_mul_f32 v[20:21], v[72:73], v[22:23]
  v_pk_add_f32 v[18:19], v[22:23], v[24:25]
  v_pk_fma_f32 v[20:21], v[74:75], v[24:25], v[20:21]
  v_add_f32 v18, v18, v19
  v_add_f32 v20, v20, v21
  s_cmpk_gt_i32 s69, 0x31
  s_cbranch_scc1 L_p30_4
  s_cmpk_gt_i32 s69, 0xb
  s_cbranch_scc1 L_p30_2
  s_waitcnt vmcnt(7)
L_p30_2:
  s_waitcnt vmcnt(10)
L_p30_4:
  s_waitcnt vmcnt(12)
  buffer_load_dwordx4 v[108:111], v234, s[32:35], s80 offen nt
  v_perm_b32 v193, v198, v196, s56
  v_perm_b32 v198, v198, v196, s57
  v_perm_b32 v196, v199, v197, s56
  v_perm_b32 v199, v199, v197, s57
  v_dot2_f32_bf16 v22, v193, v52, 0
  v_add_f32_dpp v21, v18, v18 row_ror:8 row_mask:0xf bank_mask:0xc
  v_add_f32_dpp v21, v20, v20 row_ror:8 row_mask:0xf bank_mask:0x3
  v_add_f32_dpp v20, v34, v34 row_half_mirror row_mask:0xf bank_mask:0x5
  v_dot2_f32_bf16 v23, v198, v53, 0
  v_add_f32_dpp v20, v21, v21 row_half_mirror row_mask:0xf bank_mask:0xa
  v_dot2_f32_bf16 v24, v196, v54, 0
  v_dot2_f32_bf16 v25, v199, v55, 0
  v_add_f32_dpp v20, v20, v20 quad_perm:[2,3,0,1] row_mask:0xf bank_mask:0xf
  v_cvt_f32_i32 v76, v76
  v_cvt_f32_i32 v77, v77
  v_add_f32_dpp v20, v20, v20 quad_perm:[1,0,3,2] row_mask:0xf bank_mask:0xf
  v_cndmask_b32_e64 v32, v32, v20, s[50:51]
  v_cvt_f32_i32 v78, v78
  v_cvt_f32_i32 v79, v79
  v_pk_mul_f32 v[20:21], v[76:77], v[22:23]
  v_pk_add_f32 v[18:19], v[22:23], v[24:25]
  v_pk_fma_f32 v[20:21], v[78:79], v[24:25], v[20:21]
  v_add_f32 v18, v18, v19
  v_add_f32 v20, v20, v21
  s_cmpk_gt_i32 s69, 0x31
  s_cbranch_scc1 L_p31_4
  s_cmpk_gt_i32 s69, 0x1d
  s_cbranch_scc1 L_p31_3
  s_cmpk_gt_i32 s69, 0xffcd
  s_cbranch_scc1 L_p31_0
  s_waitcnt vmcnt(6)
L_p31_0:
  s_waitcnt vmcnt(8)
L_p31_3:
  s_waitcnt vmcnt(11)
L_p31_4:
  s_waitcnt vmcnt(13)
  buffer_load_dwordx4 v[112:115], v235, s[32:35], s80 offen nt
L_it13:
  s_waitcnt lgkmcnt(0)
  s_waitcnt vmcnt(8)
  s_add_u32 s44, s78, 0x03030303
  v_msad_u8 v9, s78, v40, 0
  v_msad_u8 v10, s44, v40, 0
  v_msad_u8 v9, s78, v41, v9
  v_msad_u8 v10, s44, v41, v10
  v_msad_u8 v9, s78, v42, v9
  v_msad_u8 v10, s44, v42, v10
  s_mov_b64 exec, 3
  global_load_dwordx2 v[26:27], v11, s[30:31] sc1
  global_store_byte v7, v8, s[30:31]
  global_load_dwordx3 v[40:42], v237, s[30:31] sc1
  v_sub_u32 v9, v9, v10
  v_add_u32 v8, 1, v8
  s_mov_b64 exec, -1
  v_readlane_b32 s66, v9, 0
  v_readlane_b32 s67, v9, 1
  s_add_u32 s78, s78, 0x01010101
  s_lshl1_add_u32 s69, s91, s95
  s_add_u32 s95, s66, s67
  s_add_u32 s69, s69, s95
  v_dot2_f32_bf16 v22, v185, v56, 0
  v_add_f32_dpp v34, v18, v18 row_ror:8 row_mask:0xf bank_mask:0xc
  v_add_f32_dpp v34, v20, v20 row_ror:8 row_mask:0xf bank_mask:0x3
  v_dot2_f32_bf16 v23, v190, v57, 0
  v_dot2_f32_bf16 v24, v188, v58, 0
  v_dot2_f32_bf16 v25, v191, v59, 0
  v_cvt_f32_i32 v80, v80
  v_cvt_f32_i32 v81, v81
  v_cvt_f32_i32 v82, v82
  v_cvt_f32_i32 v83, v83
  v_pk_mul_f32 v[20:21], v[80:81], v[22:23]
  v_pk_add_f32 v[18:19], v[22:23], v[24:25]
  v_pk_fma_f32 v[20:21], v[82:83], v[24:25], v[20:21]
  v_add_f32 v18, v18, v19
  v_add_f32 v20, v20, v21
  s_cmpk_gt_i32 s69, 0x31
  s_cbranch_scc1 L_p32_4
  s_cmpk_gt_i32 s69, 0xffed
  s_cbranch_scc1 L_p32_1
  s_waitcnt vmcnt(6)
L_p32_1:
  s_waitcnt vmcnt(9)
L_p32_4:
  s_waitcnt vmcnt(10)
  buffer_load_dwordx4 v[68:71], v212, s[32:35], s3 offen nt
  v_dot2_f32_bf16 v22, v189, v60, 0
  v_add_f32_dpp v35, v18, v18 row_ror:8 row_mask:0xf bank_mask:0xc
  v_add_f32_dpp v35, v20, v20 row_ror:8 row_mask:0xf bank_mask:0x3
  v_dot2_f32_bf16 v23, v194, v61, 0
  v_dot2_f32_bf16 v24, v192, v62, 0
  v_dot2_f32_bf16 v25, v195, v63, 0
  v_cvt_f32_i32 v84, v84
  v_cvt_f32_i32 v85, v85
  v_cvt_f32_i32 v86, v86
  v_cvt_f32_i32 v87, v87
  v_pk_mul_f32 v[20:21], v[84:85], v[22:23]
  v_pk_add_f32 v[18:19], v[22:23], v[24:25]
  v_pk_fma_f32 v[20:21], v[86:87], v[24:25], v[20:21]
  v_add_f32 v18, v18, v19
  v_add_f32 v20, v20, v21
  s_cmpk_gt_i32 s69, 0x31
  s_cbranch_scc1 L_p33_4
  s_cmpk_gt_i32 s69, 0xb
  s_cbranch_scc1 L_p33_2
  s_waitcnt vmcnt(7)
L_p33_2:
  s_waitcnt vmcnt(10)
L_p33_4:
  s_waitcnt vmcnt(11)
  buffer_load_dwordx4 v[72:75], v213, s[32:35], s3 offen nt
  s_waitcnt vmcnt(10)
  ds_read_b64 v[200:201], v12 offset:21504
  ds_read_b64 v[202:203], v12 offset:21632
  ds_read_b64 v[204:205], v12 offset:22528
  ds_read_b64 v[206:207], v12 offset:22656
  ds_read_b64 v[208:209], v12 offset:23552
  ds_read_b64 v[210:211], v12 offset:23680
  v_dot2_f32_bf16 v22, v193, v64, 0
  v_add_f32_dpp v21, v18, v18 row_ror:8 row_mask:0xf bank_mask:0xc
  v_add_f32_dpp v21, v20, v20 row_ror:8 row_mask:0xf bank_mask:0x3
  v_add_f32_dpp v20, v35, v35 row_half_mirror row_mask:0xf bank_mask:0x5
  v_dot2_f32_bf16 v23, v198, v65, 0
  v_add_f32_dpp v20, v21, v21 row_half_mirror row_mask:0xf bank_mask:0xa
  v_dot2_f32_bf16 v24, v196, v66, 0
  v_dot2_f32_bf16 v25, v199, v67, 0
  v_add_f32_dpp v20, v20, v20 quad_perm:[2,3,0,1] row_mask:0xf bank_mask:0xf
  v_cvt_f32_i32 v88, v88
  v_cvt_f32_i32 v89, v89
  v_add_f32_dpp v20, v20, v20 quad_perm:[1,0,3,2] row_mask:0xf bank_mask:0xf
  v_cndmask_b32_e64 v33, v33, v20, s[50:51]
  v_cvt_f32_i32 v90, v90
  v_cvt_f32_i32 v91, v91
  v_pk_mul_f32 v[20:21], v[88:89], v[22:23]
  v_pk_add_f32 v[18:19], v[22:23], v[24:25]
  v_pk_fma_f32 v[20:21], v[90:91], v[24:25], v[20:21]
  v_add_f32 v18, v18, v19
  v_add_f32 v20, v20, v21
  s_cmpk_gt_i32 s69, 0x31
  s_cbranch_scc1 L_p34_4
  s_cmpk_gt_i32 s69, 0x1d
  s_cbranch_scc1 L_p34_3
  s_cmpk_gt_i32 s69, 0xffcd
  s_cbranch_scc1 L_p34_0
  s_waitcnt vmcnt(7)
L_p34_0:
  s_waitcnt vmcnt(8)
L_p34_3:
  s_waitcnt vmcnt(11)
L_p34_4:
  s_waitcnt vmcnt(12)
  buffer_load_dwordx4 v[76:79], v214, s[32:35], s3 offen nt
L_it14:
  s_waitcnt lgkmcnt(0)
  ds_read_b32 v4, v14 offset:16
  s_waitcnt vmcnt(8)
  s_add_u32 s44, s78, 0x03030303
  v_msad_u8 v9, s78, v36, 0
  v_msad_u8 v10, s44, v36, 0
  v_msad_u8 v9, s78, v37, v9
  v_msad_u8 v10, s44, v37, v10
  v_msad_u8 v9, s78, v38, v9
  v_msad_u8 v10, s44, v38, v10
  s_mov_b64 exec, 3
  global_store_byte v7, v8, s[30:31]
  global_load_dwordx3 v[36:38], v238, s[30:31] sc1
  v_sub_u32 v9, v9, v10
  v_add_u32 v8, 1, v8
  s_mov_b64 exec, -1
  v_readlane_b32 s66, v9, 0
  v_readlane_b32 s67, v9, 1
  s_add_u32 s78, s78, 0x01010101
  s_lshl1_add_u32 s69, s91, s95
  s_add_u32 s95, s66, s67
  s_add_u32 s69, s69, s95
  v_perm_b32 v197, v202, v200, s56
  v_perm_b32 v202, v202, v200, s57
  v_perm_b32 v200, v203, v201, s56
  v_perm_b32 v203, v203, v201, s57
  v_dot2_f32_bf16 v22, v197, v44, 0
  v_add_f32_dpp v35, v18, v18 row_ror:8 row_mask:0xf bank_mask:0xc
  v_add_f32_dpp v35, v20, v20 row_ror:8 row_mask:0xf bank_mask:0x3
  v_dot2_f32_bf16 v23, v202, v45, 0
  v_dot2_f32_bf16 v24, v200, v46, 0
  v_dot2_f32_bf16 v25, v203, v47, 0
  v_cvt_f32_i32 v92, v92
  v_cvt_f32_i32 v93, v93
  v_cvt_f32_i32 v94, v94
  v_cvt_f32_i32 v95, v95
  v_pk_mul_f32 v[20:21], v[92:93], v[22:23]
  v_pk_add_f32 v[18:19], v[22:23], v[24:25]
  v_pk_fma_f32 v[20:21], v[94:95], v[24:25], v[20:21]
  v_add_f32 v18, v18, v19
  v_add_f32 v20, v20, v21
  s_cmpk_gt_i32 s69, 0x31
  s_cbranch_scc1 L_p35_4
  s_cmpk_gt_i32 s69, 0xffed
  s_cbranch_scc1 L_p35_1
  s_waitcnt vmcnt(5)
L_p35_1:
  s_waitcnt vmcnt(9)
L_p35_4:
  s_waitcnt vmcnt(10)
  buffer_load_dwordx4 v[80:83], v215, s[32:35], s3 offen nt
  v_perm_b32 v201, v206, v204, s56
  v_perm_b32 v206, v206, v204, s57
  v_perm_b32 v204, v207, v205, s56
  v_perm_b32 v207, v207, v205, s57
  v_dot2_f32_bf16 v22, v201, v48, 0
  v_add_f32_dpp v21, v18, v18 row_ror:8 row_mask:0xf bank_mask:0xc
  v_add_f32_dpp v21, v20, v20 row_ror:8 row_mask:0xf bank_mask:0x3
  v_add_f32_dpp v20, v34, v34 row_half_mirror row_mask:0xf bank_mask:0x5
  v_dot2_f32_bf16 v23, v206, v49, 0
  v_add_f32_dpp v20, v21, v21 row_half_mirror row_mask:0xf bank_mask:0xa
  v_dot2_f32_bf16 v24, v204, v50, 0
  v_dot2_f32_bf16 v25, v207, v51, 0
  v_add_f32_dpp v20, v20, v20 quad_perm:[2,3,0,1] row_mask:0xf bank_mask:0xf
  v_cvt_f32_i32 v96, v96
  v_cvt_f32_i32 v97, v97
  v_add_f32_dpp v20, v20, v20 quad_perm:[1,0,3,2] row_mask:0xf bank_mask:0xf
  v_cndmask_b32_e64 v32, v32, v20, s[52:53]
  v_cvt_f32_i32 v98, v98
  v_cvt_f32_i32 v99, v99
  v_pk_mul_f32 v[20:21], v[96:97], v[22:23]
  v_pk_add_f32 v[18:19], v[22:23], v[24:25]
  v_pk_fma_f32 v[20:21], v[98:99], v[24:25], v[20:21]
  v_add_f32 v18, v18, v19
  v_add_f32 v20, v20, v21
  s_cmpk_gt_i32 s69, 0x31
  s_cbranch_scc1 L_p36_4
  s_cmpk_gt_i32 s69, 0xb
  s_cbranch_scc1 L_p36_2
  s_waitcnt vmcnt(6)
L_p36_2:
  s_waitcnt vmcnt(10)
L_p36_4:
  s_waitcnt vmcnt(11)
  buffer_load_dwordx4 v[84:87], v216, s[32:35], s3 offen nt
  v_perm_b32 v205, v210, v208, s56
  v_perm_b32 v210, v210, v208, s57
  v_perm_b32 v208, v211, v209, s56
  v_perm_b32 v211, v211, v209, s57
  v_dot2_f32_bf16 v22, v205, v52, 0
  v_add_f32_dpp v34, v18, v18 row_ror:8 row_mask:0xf bank_mask:0xc
  v_add_f32_dpp v34, v20, v20 row_ror:8 row_mask:0xf bank_mask:0x3
  v_dot2_f32_bf16 v23, v210, v53, 0
  v_dot2_f32_bf16 v24, v208, v54, 0
  v_dot2_f32_bf16 v25, v211, v55, 0
  v_cvt_f32_i32 v100, v100
  v_cvt_f32_i32 v101, v101
  v_cvt_f32_i32 v102, v102
  v_cvt_f32_i32 v103, v103
  v_pk_mul_f32 v[20:21], v[100:101], v[22:23]
  v_pk_add_f32 v[18:19], v[22:23], v[24:25]
  v_pk_fma_f32 v[20:21], v[102:103], v[24:25], v[20:21]
  v_add_f32 v18, v18, v19
  v_add_f32 v20, v20, v21
  s_cmpk_gt_i32 s69, 0x31
  s_cbranch_scc1 L_p37_4
  s_cmpk_gt_i32 s69, 0x1d
  s_cbranch_scc1 L_p37_3
  s_cmpk_gt_i32 s69, 0xffcd
  s_cbranch_scc1 L_p37_0
  s_waitcnt vmcnt(6)
L_p37_0:
  s_waitcnt vmcnt(7)
L_p37_3:
  s_waitcnt vmcnt(11)
L_p37_4:
  s_waitcnt vmcnt(12)
  buffer_load_dwordx4 v[88:91], v217, s[32:35], s3 offen nt
L_it15:
  s_mov_b32 s47, 3
L_fq15:
  s_waitcnt lgkmcnt(0)
  v_readfirstlane_b32 s46, v4
  s_cmp_ge_u32 s46, s47
  s_cbranch_scc1 L_fq15_ok
  s_cmp_eq_u32 s94, 0
  s_cbranch_scc1 L_fq15_ok
  s_sub_u32 s94, s94, 1
  ds_read_b32 v4, v14 offset:16
  s_branch L_fq15
L_fq15_ok:
  s_waitcnt vmcnt(7)
  s_add_u32 s44, s78, 0x03030303
  v_msad_u8 v9, s78, v40, 0
  v_msad_u8 v10, s44, v40, 0
  v_msad_u8 v9, s78, v41, v9
  v_msad_u8 v10, s44, v41, v10
  v_msad_u8 v9, s78, v42, v9
  v_msad_u8 v10, s44, v42, v10
  s_mov_b64 exec, 3
  global_store_byte v7, v8, s[30:31]
  global_load_dwordx3 v[40:42], v239, s[30:31] sc1
  v_sub_u32 v9, v9, v10
  v_add3_u32 v10, v26, v27, s58
  v_add_u32 v8, 1, v8
  s_mov_b64 exec, -1
  v_readlane_b32 s66, v9, 0
  v_readlane_b32 s67, v9, 1
  v_readlane_b32 s91, v10, 0
  s_add_u32 s78, s78, 0x01010101
  s_lshl1_add_u32 s69, s91, s95
  s_add_u32 s95, s66, s67
  s_add_u32 s69, s69, s95
  v_dot2_f32_bf16 v22, v197, v56, 0
  v_add_f32_dpp v21, v18, v18 row_ror:8 row_mask:0xf bank_mask:0xc
  v_add_f32_dpp v21, v20, v20 row_ror:8 row_mask:0xf bank_mask:0x3
  v_add_f32_dpp v20, v34, v34 row_half_mirror row_mask:0xf bank_mask:0x5
  v_dot2_f32_bf16 v23, v202, v57, 0
  v_add_f32_dpp v20, v21, v21 row_half_mirror row_mask:0xf bank_mask:0xa
  v_dot2_f32_bf16 v24, v200, v58, 0
  v_dot2_f32_bf16 v25, v203, v59, 0
  v_add_f32_dpp v20, v20, v20 quad_perm:[2,3,0,1] row_mask:0xf bank_mask:0xf
  v_cvt_f32_i32 v104, v104
  v_cvt_f32_i32 v105, v105
  v_add_f32_dpp v20, v20, v20 quad_perm:[1,0,3,2] row_mask:0xf bank_mask:0xf
  v_cndmask_b32_e64 v32, v32, v20, s[54:55]
  ds_write_b32 v1, v32 offset:1024
  v_cvt_f32_i32 v106, v106
  v_cvt_f32_i32 v107, v107
  ds_read_b128 v[44:47], v15 offset:2560
  v_pk_mul_f32 v[20:21], v[104:105], v[22:23]
  v_pk_add_f32 v[18:19], v[22:23], v[24:25]
  v_pk_fma_f32 v[20:21], v[106:107], v[24:25], v[20:21]
  v_add_f32 v18, v18, v19
  v_add_f32 v20, v20, v21
  s_cmpk_gt_i32 s69, 0x31
  s_cbranch_scc1 L_p38_4
  s_cmpk_gt_i32 s69, 0xffed
  s_cbranch_scc1 L_p38_1
  s_waitcnt vmcnt(5)
L_p38_1:
  s_waitcnt vmcnt(8)
L_p38_4:
  s_waitcnt vmcnt(9)
  buffer_load_dwordx4 v[92:95], v218, s[32:35], s3 offen nt
  v_dot2_f32_bf16 v22, v201, v60, 0
  v_add_f32_dpp v21, v18, v18 row_ror:8 row_mask:0xf bank_mask:0xc
  v_add_f32_dpp v21, v20, v20 row_ror:8 row_mask:0xf bank_mask:0x3
  v_add_f32_dpp v20, v35, v35 row_half_mirror row_mask:0xf bank_mask:0x5
  v_dot2_f32_bf16 v23, v206, v61, 0
  v_add_f32_dpp v20, v21, v21 row_half_mirror row_mask:0xf bank_mask:0xa
  v_dot2_f32_bf16 v24, v204, v62, 0
  v_dot2_f32_bf16 v25, v207, v63, 0
  v_add_f32_dpp v20, v20, v20 quad_perm:[2,3,0,1] row_mask:0xf bank_mask:0xf
  v_cvt_f32_i32 v108, v108
  v_cvt_f32_i32 v109, v109
  v_add_f32_dpp v20, v20, v20 quad_perm:[1,0,3,2] row_mask:0xf bank_mask:0xf
  v_cndmask_b32_e64 v33, v33, v20, s[52:53]
  v_cvt_f32_i32 v110, v110
  v_cvt_f32_i32 v111, v111
  ds_read_b128 v[48:51], v16 offset:2560
  v_pk_mul_f32 v[20:21], v[108:109], v[22:23]
  v_pk_add_f32 v[18:19], v[22:23], v[24:25]
  v_pk_fma_f32 v[20:21], v[110:111], v[24:25], v[20:21]
  v_add_f32 v18, v18, v19
  v_add_f32 v20, v20, v21
  s_cmpk_gt_i32 s69, 0x31
  s_cbranch_scc1 L_p39_4
  s_cmpk_gt_i32 s69, 0xb
  s_cbranch_scc1 L_p39_2
  s_waitcnt vmcnt(6)
L_p39_2:
  s_waitcnt vmcnt(9)
L_p39_4:
  s_waitcnt vmcnt(10)
  buffer_load_dwordx4 v[96:99], v219, s[32:35], s3 offen nt
  v_dot2_f32_bf16 v22, v205, v64, 0
  v_add_f32_dpp v35, v18, v18 row_ror:8 row_mask:0xf bank_mask:0xc
  v_add_f32_dpp v35, v20, v20 row_ror:8 row_mask:0xf bank_mask:0x3
  v_dot2_f32_bf16 v23, v210, v65, 0
  v_dot2_f32_bf16 v24, v208, v66, 0
  v_dot2_f32_bf16 v25, v211, v67, 0
  v_cvt_f32_i32 v112, v112
  v_cvt_f32_i32 v113, v113
  v_cvt_f32_i32 v114, v114
  v_cvt_f32_i32 v115, v115
  ds_read_b128 v[52:55], v17 offset:2560
  v_pk_mul_f32 v[20:21], v[112:113], v[22:23]
  v_pk_add_f32 v[18:19], v[22:23], v[24:25]
  v_pk_fma_f32 v[20:21], v[114:115], v[24:25], v[20:21]
  v_add_f32 v18, v18, v19
  v_add_f32 v20, v20, v21
  s_cmpk_gt_i32 s69, 0x31
  s_cbranch_scc1 L_p40_4
  s_cmpk_gt_i32 s69, 0x1d
  s_cbranch_scc1 L_p40_3
  s_cmpk_gt_i32 s69, 0xffcd
  s_cbranch_scc1 L_p40_0
  s_waitcnt vmcnt(6)
L_p40_0:
  s_waitcnt vmcnt(7)
L_p40_3:
  s_waitcnt vmcnt(10)
L_p40_4:
  s_waitcnt vmcnt(11)
  buffer_load_dwordx4 v[100:103], v220, s[32:35], s3 offen nt
  s_nop 0
  v_add_f32_dpp v21, v18, v18 row_ror:8 row_mask:0xf bank_mask:0xc
  v_add_f32_dpp v21, v20, v20 row_ror:8 row_mask:0xf bank_mask:0x3
  v_add_f32_dpp v20, v35, v35 row_half_mirror row_mask:0xf bank_mask:0x5
  s_nop 0
  v_add_f32_dpp v20, v21, v21 row_half_mirror row_mask:0xf bank_mask:0xa
  s_nop 1
  v_add_f32_dpp v20, v20, v20 quad_perm:[2,3,0,1] row_mask:0xf bank_mask:0xf
  s_nop 1
  v_add_f32_dpp v20, v20, v20 quad_perm:[1,0,3,2] row_mask:0xf bank_mask:0xf
  v_cndmask_b32_e64 v33, v33, v20, s[54:55]
  ds_write_b32 v1, v33 offset:4096
  v_mov_b32 v9, 2
  ds_write_b32 v6, v9 offset:0
  v_add_u32 v15, 2048, v15
  v_add_u32 v16, 2048, v16
  v_add_u32 v17, 2048, v17
  s_mov_b32 s43, 2
  s_movk_i32 s101, 6144
  s_mov_b32 s34, 1572864
  s_add_u32 s32, s32, s3
  s_addc_u32 s33, s33, 0
  s_mov_b32 s68, 3
  s_lshl_b32 s44, s68, 2
  s_lshr_b64 s[64:65], s[96:97], s44
  s_and_b32 s64, s64, 15
  s_lshl4_add_u32 s68, s68, s64
  s_mul_i32 s44, s68, 1572864
  s_add_u32 s36, s6, s44
  s_addc_u32 s37, s7, 0
.p2align 6
L_k:
  s_add_u32 s44, s43, 2
  s_min_u32 s47, s44, 16
  v_add_u32 v15, 1024, v15
  v_and_b32 v15, 0xfff, v15
  v_add_u32 v16, 1024, v16
  v_and_b32 v16, 0xfff, v16
  v_add_u32 v17, 1024, v17
  v_and_b32 v17, 0xfff, v17
  v_add_u32 v2, s101, v1
  s_addk_i32 s101, 3072
  s_cmpk_eq_u32 s101, 18432
  s_cselect_b32 s101, 0, s101
  s_waitcnt lgkmcnt(0)
  s_waitcnt vmcnt(8)
  s_add_u32 s44, s78, 0x03030303
  v_msad_u8 v9, s78, v36, 0
  v_msad_u8 v10, s44, v36, 0
  v_msad_u8 v9, s78, v37, v9
  v_msad_u8 v10, s44, v37, v10
  v_msad_u8 v9, s78, v38, v9
  v_msad_u8 v10, s44, v38, v10
  s_mov_b64 exec, 3
  global_store_byte v7, v8, s[30:31]
  global_load_dwordx3 v[36:38], v236, s[30:31] sc1
  v_sub_u32 v9, v9, v10
  v_add_u32 v8, 1, v8
  s_mov_b64 exec, -1
  v_readlane_b32 s66, v9, 0
  v_readlane_b32 s67, v9, 1
  s_add_u32 s78, s78, 0x01010101
  s_lshl1_add_u32 s69, s91, s95
  s_add_u32 s95, s66, s67
  s_add_u32 s69, s69, s95
  v_dot2_f32_bf16 v22, v13, v44, 0
  v_dot2_f32_bf16 v23, v118, v45, 0
  v_dot2_f32_bf16 v24, v116, v46, 0
  v_dot2_f32_bf16 v25, v119, v47, 0
  v_cvt_f32_i32 v68, v68
  v_cvt_f32_i32 v69, v69
  v_cvt_f32_i32 v70, v70
  v_cvt_f32_i32 v71, v71
  v_pk_mul_f32 v[20:21], v[68:69], v[22:23]
  v_pk_add_f32 v[18:19], v[22:23], v[24:25]
  v_pk_fma_f32 v[20:21], v[70:71], v[24:25], v[20:21]
  v_add_f32 v18, v18, v19
  v_add_f32 v20, v20, v21
  s_cmpk_gt_i32 s69, 0x2d
  s_cbranch_scc1 L_p41_4
  s_cmpk_gt_i32 s69, 0xffe9
  s_cbranch_scc1 L_p41_1
  s_waitcnt vmcnt(5)
L_p41_1:
  s_waitcnt vmcnt(8)
L_p41_4:
  s_waitcnt vmcnt(9)
  buffer_load_dwordx4 v[104:107], v221, s[32:35], 0 offen nt
  v_dot2_f32_bf16 v22, v117, v48, 0
  v_add_f32_dpp v34, v18, v18 row_ror:8 row_mask:0xf bank_mask:0xc
  v_add_f32_dpp v34, v20, v20 row_ror:8 row_mask:0xf bank_mask:0x3
  v_dot2_f32_bf16 v23, v122, v49, 0
  v_dot2_f32_bf16 v24, v120, v50, 0
  v_dot2_f32_bf16 v25, v123, v51, 0
  v_cvt_f32_i32 v72, v72
  v_cvt_f32_i32 v73, v73
  v_cvt_f32_i32 v74, v74
  v_cvt_f32_i32 v75, v75
  v_pk_mul_f32 v[20:21], v[72:73], v[22:23]
  v_pk_add_f32 v[18:19], v[22:23], v[24:25]
  v_pk_fma_f32 v[20:21], v[74:75], v[24:25], v[20:21]
  v_add_f32 v18, v18, v19
  v_add_f32 v20, v20, v21
  s_cmpk_gt_i32 s69, 0x2d
  s_cbranch_scc1 L_p42_4
  s_cmpk_gt_i32 s69, 0x7
  s_cbranch_scc1 L_p42_2
  s_waitcnt vmcnt(6)
L_p42_2:
  s_waitcnt vmcnt(9)
L_p42_4:
  s_waitcnt vmcnt(10)
  buffer_load_dwordx4 v[108:111], v222, s[32:35], 0 offen nt
  v_dot2_f32_bf16 v22, v121, v52, 0
  v_add_f32_dpp v21, v18, v18 row_ror:8 row_mask:0xf bank_mask:0xc
  v_add_f32_dpp v21, v20, v20 row_ror:8 row_mask:0xf bank_mask:0x3
  v_add_f32_dpp v20, v34, v34 row_half_mirror row_mask:0xf bank_mask:0x5
  v_dot2_f32_bf16 v23, v126, v53, 0
  v_add_f32_dpp v20, v21, v21 row_half_mirror row_mask:0xf bank_mask:0xa
  v_dot2_f32_bf16 v24, v124, v54, 0
  v_dot2_f32_bf16 v25, v127, v55, 0
  v_add_f32_dpp v20, v20, v20 quad_perm:[2,3,0,1] row_mask:0xf bank_mask:0xf
  v_cvt_f32_i32 v76, v76
  v_cvt_f32_i32 v77, v77
  v_add_f32_dpp v20, v20, v20 quad_perm:[1,0,3,2] row_mask:0xf bank_mask:0xf
  v_cndmask_b32_e64 v32, v32, v20, s[48:49]
  v_cvt_f32_i32 v78, v78
  v_cvt_f32_i32 v79, v79
  v_pk_mul_f32 v[20:21], v[76:77], v[22:23]
  v_pk_add_f32 v[18:19], v[22:23], v[24:25]
  v_pk_fma_f32 v[20:21], v[78:79], v[24:25], v[20:21]
  v_add_f32 v18, v18, v19
  v_add_f32 v20, v20, v21
  s_cmpk_gt_i32 s69, 0x2d
  s_cbranch_scc1 L_p43_4
  s_cmpk_gt_i32 s69, 0x19
  s_cbranch_scc1 L_p43_3
  s_cmpk_gt_i32 s69, 0xffc9
  s_cbranch_scc1 L_p43_0
  s_waitcnt vmcnt(6)
L_p43_0:
  s_waitcnt vmcnt(7)
L_p43_3:
  s_waitcnt vmcnt(10)
L_p43_4:
  s_waitcnt vmcnt(11)
  buffer_load_dwordx4 v[112:115], v223, s[32:35], 0 offen nt
  s_waitcnt vmcnt(8)
  s_add_u32 s44, s78, 0x03030303
  v_msad_u8 v9, s78, v40, 0
  v_msad_u8 v10, s44, v40, 0
  v_msad_u8 v9, s78, v41, v9
  v_msad_u8 v10, s44, v41, v10
  v_msad_u8 v9, s78, v42, v9
  v_msad_u8 v10, s44, v42, v10
  s_mov_b64 exec, 3
  global_store_byte v7, v8, s[30:31]
  global_load_dwordx3 v[40:42], v237, s[30:31] sc1
  v_sub_u32 v9, v9, v10
  v_add_u32 v8, 1, v8
  s_mov_b64 exec, -1
  v_readlane_b32 s66, v9, 0
  v_readlane_b32 s67, v9, 1
  s_add_u32 s78, s78, 0x01010101
  s_lshl1_add_u32 s69, s91, s95
  s_add_u32 s95, s66, s67
  s_add_u32 s69, s69, s95
  v_dot2_f32_bf16 v22, v125, v44, 0
  v_add_f32_dpp v34, v18, v18 row_ror:8 row_mask:0xf bank_mask:0xc
  v_add_f32_dpp v34, v20, v20 row_ror:8 row_mask:0xf bank_mask:0x3
  v_dot2_f32_bf16 v23, v130, v45, 0
  v_dot2_f32_bf16 v24, v128, v46, 0
  v_dot2_f32_bf16 v25, v131, v47, 0
  v_cvt_f32_i32 v80, v80
  v_cvt_f32_i32 v81, v81
  v_cvt_f32_i32 v82, v82
  v_cvt_f32_i32 v83, v83
  v_pk_mul_f32 v[20:21], v[80:81], v[22:23]
  v_pk_add_f32 v[18:19], v[22:23], v[24:25]
  v_pk_fma_f32 v[20:21], v[82:83], v[24:25], v[20:21]
  v_add_f32 v18, v18, v19
  v_add_f32 v20, v20, v21
  s_cmpk_gt_i32 s69, 0x2d
  s_cbranch_scc1 L_p44_4
  s_cmpk_gt_i32 s69, 0xffe9
  s_cbranch_scc1 L_p44_1
  s_waitcnt vmcnt(5)
L_p44_1:
  s_waitcnt vmcnt(8)
L_p44_4:
  s_waitcnt vmcnt(9)
  buffer_load_dwordx4 v[68:71], v224, s[32:35], 0 offen nt
  v_dot2_f32_bf16 v22, v129, v48, 0
  v_add_f32_dpp v21, v18, v18 row_ror:8 row_mask:0xf bank_mask:0xc
  v_add_f32_dpp v21, v20, v20 row_ror:8 row_mask:0xf bank_mask:0x3
  v_add_f32_dpp v20, v34, v34 row_half_mirror row_mask:0xf bank_mask:0x5
  v_dot2_f32_bf16 v23, v134, v49, 0
  v_add_f32_dpp v20, v21, v21 row_half_mirror row_mask:0xf bank_mask:0xa
  v_dot2_f32_bf16 v24, v132, v50, 0
  v_dot2_f32_bf16 v25, v135, v51, 0
  v_add_f32_dpp v20, v20, v20 quad_perm:[2,3,0,1] row_mask:0xf bank_mask:0xf
  v_cvt_f32_i32 v84, v84
  v_cvt_f32_i32 v85, v85
  v_add_f32_dpp v20, v20, v20 quad_perm:[1,0,3,2] row_mask:0xf bank_mask:0xf
  v_cndmask_b32_e64 v32, v32, v20, s[50:51]
  v_cvt_f32_i32 v86, v86
  v_cvt_f32_i32 v87, v87
  v_pk_mul_f32 v[20:21], v[84:85], v[22:23]
  v_pk_add_f32 v[18:19], v[22:23], v[24:25]
  v_pk_fma_f32 v[20:21], v[86:87], v[24:25], v[20:21]
  v_add_f32 v18, v18, v19
  v_add_f32 v20, v20, v21
  s_cmpk_gt_i32 s69, 0x2d
  s_cbranch_scc1 L_p45_4
  s_cmpk_gt_i32 s69, 0x7
  s_cbranch_scc1 L_p45_2
  s_waitcnt vmcnt(6)
L_p45_2:
  s_waitcnt vmcnt(9)
L_p45_4:
  s_waitcnt vmcnt(10)
  buffer_load_dwordx4 v[72:75], v225, s[32:35], 0 offen nt
  v_dot2_f32_bf16 v22, v133, v52, 0
  v_add_f32_dpp v34, v18, v18 row_ror:8 row_mask:0xf bank_mask:0xc
  v_add_f32_dpp v34, v20, v20 row_ror:8 row_mask:0xf bank_mask:0x3
  v_dot2_f32_bf16 v23, v138, v53, 0
  v_dot2_f32_bf16 v24, v136, v54, 0
  v_dot2_f32_bf16 v25, v139, v55, 0
  v_cvt_f32_i32 v88, v88
  v_cvt_f32_i32 v89, v89
  v_cvt_f32_i32 v90, v90
  v_cvt_f32_i32 v91, v91
  v_pk_mul_f32 v[20:21], v[88:89], v[22:23]
  v_pk_add_f32 v[18:19], v[22:23], v[24:25]
  v_pk_fma_f32 v[20:21], v[90:91], v[24:25], v[20:21]
  v_add_f32 v18, v18, v19
  v_add_f32 v20, v20, v21
  s_cmpk_gt_i32 s69, 0x2d
  s_cbranch_scc1 L_p46_4
  s_cmpk_gt_i32 s69, 0x19
  s_cbranch_scc1 L_p46_3
  s_cmpk_gt_i32 s69, 0xffc9
  s_cbranch_scc1 L_p46_0
  s_waitcnt vmcnt(6)
L_p46_0:
  s_waitcnt vmcnt(7)
L_p46_3:
  s_waitcnt vmcnt(10)
L_p46_4:
  s_waitcnt vmcnt(11)
  buffer_load_dwordx4 v[76:79], v226, s[32:35], 0 offen nt
  v_mov_b32 v9, s43
  ds_write_b32 v14, v9 offset:28
  s_waitcnt vmcnt(8)
  s_add_u32 s44, s78, 0x03030303
  v_msad_u8 v9, s78, v36, 0
  v_msad_u8 v10, s44, v36, 0
  v_msad_u8 v9, s78, v37, v9
  v_msad_u8 v10, s44, v37, v10
  v_msad_u8 v9, s78, v38, v9
  v_msad_u8 v10, s44, v38, v10
  s_mov_b64 exec, 3
  global_store_byte v7, v8, s[30:31]
  global_load_dwordx3 v[36:38], v238, s[30:31] sc1
  v_sub_u32 v9, v9, v10
  v_add_u32 v8, 1, v8
  s_mov_b64 exec, -1
  v_readlane_b32 s66, v9, 0
  v_readlane_b32 s67, v9, 1
  s_add_u32 s78, s78, 0x01010101
  s_lshl1_add_u32 s69, s91, s95
  s_add_u32 s95, s66, s67
  s_add_u32 s69, s69, s95
  v_dot2_f32_bf16 v22, v137, v44, 0
  v_add_f32_dpp v21, v18, v18 row_ror:8 row_mask:0xf bank_mask:0xc
  v_add_f32_dpp v21, v20, v20 row_ror:8 row_mask:0xf bank_mask:0x3
  v_add_f32_dpp v20, v34, v34 row_half_mirror row_mask:0xf bank_mask:0x5
  v_dot2_f32_bf16 v23, v142, v45, 0
  v_add_f32_dpp v20, v21, v21 row_half_mirror row_mask:0xf bank_mask:0xa
  v_dot2_f32_bf16 v24, v140, v46, 0
  v_dot2_f32_bf16 v25, v143, v47, 0
  v_add_f32_dpp v20, v20, v20 quad_perm:[2,3,0,1] row_mask:0xf bank_mask:0xf
  v_cvt_f32_i32 v92, v92
  v_cvt_f32_i32 v93, v93
  v_add_f32_dpp v20, v20, v20 quad_perm:[1,0,3,2] row_mask:0xf bank_mask:0xf
  v_cndmask_b32_e64 v32, v32, v20, s[52:53]
  v_cvt_f32_i32 v94, v94
  v_cvt_f32_i32 v95, v95
  v_pk_mul_f32 v[20:21], v[92:93], v[22:23]
  v_pk_add_f32 v[18:19], v[22:23], v[24:25]
  v_pk_fma_f32 v[20:21], v[94:95], v[24:25], v[20:21]
  v_add_f32 v18, v18, v19
  v_add_f32 v20, v20, v21
  s_cmpk_gt_i32 s69, 0x2d
  s_cbranch_scc1 L_p47_4
  s_cmpk_gt_i32 s69, 0xffe9
  s_cbranch_scc1 L_p47_1
  s_waitcnt vmcnt(5)
L_p47_1:
  s_waitcnt vmcnt(8)
L_p47_4:
  s_waitcnt vmcnt(9)
  buffer_load_dwordx4 v[80:83], v227, s[32:35], 0 offen nt
  v_dot2_f32_bf16 v22, v141, v48, 0
  v_add_f32_dpp v34, v18, v18 row_ror:8 row_mask:0xf bank_mask:0xc
  v_add_f32_dpp v34, v20, v20 row_ror:8 row_mask:0xf bank_mask:0x3
  v_dot2_f32_bf16 v23, v146, v49, 0
  v_dot2_f32_bf16 v24, v144, v50, 0
  v_dot2_f32_bf16 v25, v147, v51, 0
  v_cvt_f32_i32 v96, v96
  v_cvt_f32_i32 v97, v97
  v_cvt_f32_i32 v98, v98
  v_cvt_f32_i32 v99, v99
  v_pk_mul_f32 v[20:21], v[96:97], v[22:23]
  v_pk_add_f32 v[18:19], v[22:23], v[24:25]
  v_pk_fma_f32 v[20:21], v[98:99], v[24:25], v[20:21]
  v_add_f32 v18, v18, v19
  v_add_f32 v20, v20, v21
  s_cmpk_gt_i32 s69, 0x2d
  s_cbranch_scc1 L_p48_4
  s_cmpk_gt_i32 s69, 0x7
  s_cbranch_scc1 L_p48_2
  s_waitcnt vmcnt(6)
L_p48_2:
  s_waitcnt vmcnt(9)
L_p48_4:
  s_waitcnt vmcnt(10)
  buffer_load_dwordx4 v[84:87], v228, s[32:35], 0 offen nt
  v_dot2_f32_bf16 v22, v145, v52, 0
  v_add_f32_dpp v21, v18, v18 row_ror:8 row_mask:0xf bank_mask:0xc
  v_add_f32_dpp v21, v20, v20 row_ror:8 row_mask:0xf bank_mask:0x3
  v_add_f32_dpp v20, v34, v34 row_half_mirror row_mask:0xf bank_mask:0x5
  v_dot2_f32_bf16 v23, v150, v53, 0
  v_add_f32_dpp v20, v21, v21 row_half_mirror row_mask:0xf bank_mask:0xa
  v_dot2_f32_bf16 v24, v148, v54, 0
  v_dot2_f32_bf16 v25, v151, v55, 0
  v_add_f32_dpp v20, v20, v20 quad_perm:[2,3,0,1] row_mask:0xf bank_mask:0xf
  v_cvt_f32_i32 v100, v100
  v_cvt_f32_i32 v101, v101
  v_add_f32_dpp v20, v20, v20 quad_perm:[1,0,3,2] row_mask:0xf bank_mask:0xf
  v_cndmask_b32_e64 v32, v32, v20, s[54:55]
  ds_write_b32 v2, v32 offset:0
  v_cvt_f32_i32 v102, v102
  v_cvt_f32_i32 v103, v103
  v_pk_mul_f32 v[20:21], v[100:101], v[22:23]
  v_pk_add_f32 v[18:19], v[22:23], v[24:25]
  v_pk_fma_f32 v[20:21], v[102:103], v[24:25], v[20:21]
  v_add_f32 v18, v18, v19
  v_add_f32 v20, v20, v21
  s_cmpk_gt_i32 s69, 0x2d
  s_cbranch_scc1 L_p49_4
  s_cmpk_gt_i32 s69, 0x19
  s_cbranch_scc1 L_p49_3
  s_cmpk_gt_i32 s69, 0xffc9
  s_cbranch_scc1 L_p49_0
  s_waitcnt vmcnt(6)
L_p49_0:
  s_waitcnt vmcnt(7)
L_p49_3:
  s_waitcnt vmcnt(10)
L_p49_4:
  s_waitcnt vmcnt(11)
  buffer_load_dwordx4 v[88:91], v229, s[32:35], 0 offen nt
  s_waitcnt vmcnt(8)
  s_add_u32 s44, s78, 0x03030303
  v_msad_u8 v9, s78, v40, 0
  v_msad_u8 v10, s44, v40, 0
  v_msad_u8 v9, s78, v41, v9
  v_msad_u8 v10, s44, v41, v10
  v_msad_u8 v9, s78, v42, v9
  v_msad_u8 v10, s44, v42, v10
  s_mov_b64 exec, 3
  global_store_byte v7, v8, s[30:31]
  global_load_dwordx3 v[40:42], v239, s[30:31] sc1
  v_sub_u32 v9, v9, v10
  v_add_u32 v8, 1, v8
  s_mov_b64 exec, -1
  v_readlane_b32 s66, v9, 0
  v_readlane_b32 s67, v9, 1
  s_add_u32 s78, s78, 0x01010101
  s_lshl1_add_u32 s69, s91, s95
  s_add_u32 s95, s66, s67
  s_add_u32 s69, s69, s95
  v_dot2_f32_bf16 v22, v149, v44, 0
  v_add_f32_dpp v34, v18, v18 row_ror:8 row_mask:0xf bank_mask:0xc
  v_add_f32_dpp v34, v20, v20 row_ror:8 row_mask:0xf bank_mask:0x3
  v_dot2_f32_bf16 v23, v154, v45, 0
  v_dot2_f32_bf16 v24, v152, v46, 0
  v_dot2_f32_bf16 v25, v155, v47, 0
  v_cvt_f32_i32 v104, v104
  v_cvt_f32_i32 v105, v105
  v_cvt_f32_i32 v106, v106
  v_cvt_f32_i32 v107, v107
  v_pk_mul_f32 v[20:21], v[104:105], v[22:23]
  v_pk_add_f32 v[18:19], v[22:23], v[24:25]
  v_pk_fma_f32 v[20:21], v[106:107], v[24:25], v[20:21]
  v_add_f32 v18, v18, v19
  v_add_f32 v20, v20, v21
  s_cmpk_gt_i32 s69, 0x2d
  s_cbranch_scc1 L_p50_4
  s_cmpk_gt_i32 s69, 0xffe9
  s_cbranch_scc1 L_p50_1
  s_waitcnt vmcnt(5)
L_p50_1:
  s_waitcnt vmcnt(8)
L_p50_4:
  s_waitcnt vmcnt(9)
  buffer_load_dwordx4 v[92:95], v230, s[32:35], 0 offen nt
  v_dot2_f32_bf16 v22, v153, v48, 0
  v_add_f32_dpp v21, v18, v18 row_ror:8 row_mask:0xf bank_mask:0xc
  v_add_f32_dpp v21, v20, v20 row_ror:8 row_mask:0xf bank_mask:0x3
  v_add_f32_dpp v20, v34, v34 row_half_mirror row_mask:0xf bank_mask:0x5
  v_dot2_f32_bf16 v23, v158, v49, 0
  v_add_f32_dpp v20, v21, v21 row_half_mirror row_mask:0xf bank_mask:0xa
  v_dot2_f32_bf16 v24, v156, v50, 0
  v_dot2_f32_bf16 v25, v159, v51, 0
  v_add_f32_dpp v20, v20, v20 quad_perm:[2,3,0,1] row_mask:0xf bank_mask:0xf
  v_cvt_f32_i32 v108, v108
  v_cvt_f32_i32 v109, v109
  v_add_f32_dpp v20, v20, v20 quad_perm:[1,0,3,2] row_mask:0xf bank_mask:0xf
  v_cndmask_b32_e64 v32, v32, v20, s[48:49]
  v_cvt_f32_i32 v110, v110
  v_cvt_f32_i32 v111, v111
  v_pk_mul_f32 v[20:21], v[108:109], v[22:23]
  v_pk_add_f32 v[18:19], v[22:23], v[24:25]
  v_pk_fma_f32 v[20:21], v[110:111], v[24:25], v[20:21]
  v_add_f32 v18, v18, v19
  v_add_f32 v20, v20, v21
  s_cmpk_gt_i32 s69, 0x2d
  s_cbranch_scc1 L_p51_4
  s_cmpk_gt_i32 s69, 0x7
  s_cbranch_scc1 L_p51_2
  s_waitcnt vmcnt(6)
L_p51_2:
  s_waitcnt vmcnt(9)
L_p51_4:
  s_waitcnt vmcnt(10)
  buffer_load_dwordx4 v[96:99], v231, s[32:35], 0 offen nt
  v_dot2_f32_bf16 v22, v157, v52, 0
  v_add_f32_dpp v34, v18, v18 row_ror:8 row_mask:0xf bank_mask:0xc
  v_add_f32_dpp v34, v20, v20 row_ror:8 row_mask:0xf bank_mask:0x3
  v_dot2_f32_bf16 v23, v162, v53, 0
  v_dot2_f32_bf16 v24, v160, v54, 0
  v_dot2_f32_bf16 v25, v163, v55, 0
  v_cvt_f32_i32 v112, v112
  v_cvt_f32_i32 v113, v113
  v_cvt_f32_i32 v114, v114
  v_cvt_f32_i32 v115, v115
  v_pk_mul_f32 v[20:21], v[112:113], v[22:23]
  v_pk_add_f32 v[18:19], v[22:23], v[24:25]
  v_pk_fma_f32 v[20:21], v[114:115], v[24:25], v[20:21]
  v_add_f32 v18, v18, v19
  v_add_f32 v20, v20, v21
  s_cmpk_gt_i32 s69, 0x2d
  s_cbranch_scc1 L_p52_4
  s_cmpk_gt_i32 s69, 0x19
  s_cbranch_scc1 L_p52_3
  s_cmpk_gt_i32 s69, 0xffc9
  s_cbranch_scc1 L_p52_0
  s_waitcnt vmcnt(6)
L_p52_0:
  s_waitcnt vmcnt(7)
L_p52_3:
  s_waitcnt vmcnt(10)
L_p52_4:
  s_waitcnt vmcnt(11)
  buffer_load_dwordx4 v[100:103], v232, s[32:35], 0 offen nt
  s_waitcnt vmcnt(8)
  s_add_u32 s44, s78, 0x03030303
  v_msad_u8 v9, s78, v36, 0
  v_msad_u8 v10, s44, v36, 0
  v_msad_u8 v9, s78, v37, v9
  v_msad_u8 v10, s44, v37, v10
  v_msad_u8 v9, s78, v38, v9
  v_msad_u8 v10, s44, v38, v10
  s_mov_b64 exec, 3
  global_store_byte v7, v8, s[30:31]
  global_load_dwordx3 v[36:38], v236, s[30:31] sc1
  v_sub_u32 v9, v9, v10
  v_add_u32 v8, 1, v8
  s_mov_b64 exec, -1
  v_readlane_b32 s66, v9, 0
  v_readlane_b32 s67, v9, 1
  s_add_u32 s78, s78, 0x01010101
  s_lshl1_add_u32 s69, s91, s95
  s_add_u32 s95, s66, s67
  s_add_u32 s69, s69, s95
  v_dot2_f32_bf16 v22, v161, v44, 0
  v_add_f32_dpp v21, v18, v18 row_ror:8 row_mask:0xf bank_mask:0xc
  v_add_f32_dpp v21, v20, v20 row_ror:8 row_mask:0xf bank_mask:0x3
  v_add_f32_dpp v20, v34, v34 row_half_mirror row_mask:0xf bank_mask:0x5
  v_dot2_f32_bf16 v23, v166, v45, 0
  v_add_f32_dpp v20, v21, v21 row_half_mirror row_mask:0xf bank_mask:0xa
  v_dot2_f32_bf16 v24, v164, v46, 0
  v_dot2_f32_bf16 v25, v167, v47, 0
  v_add_f32_dpp v20, v20, v20 quad_perm:[2,3,0,1] row_mask:0xf bank_mask:0xf
  v_cvt_f32_i32 v68, v68
  v_cvt_f32_i32 v69, v69
  v_add_f32_dpp v20, v20, v20 quad_perm:[1,0,3,2] row_mask:0xf bank_mask:0xf
  v_cndmask_b32_e64 v32, v32, v20, s[50:51]
  v_cvt_f32_i32 v70, v70
  v_cvt_f32_i32 v71, v71
  v_pk_mul_f32 v[20:21], v[68:69], v[22:23]
  v_pk_add_f32 v[18:19], v[22:23], v[24:25]
  v_pk_fma_f32 v[20:21], v[70:71], v[24:25], v[20:21]
  v_add_f32 v18, v18, v19
  v_add_f32 v20, v20, v21
  s_cmpk_gt_i32 s69, 0x2d
  s_cbranch_scc1 L_p53_4
  s_cmpk_gt_i32 s69, 0xffe9
  s_cbranch_scc1 L_p53_1
  s_waitcnt vmcnt(5)
L_p53_1:
  s_waitcnt vmcnt(8)
L_p53_4:
  s_waitcnt vmcnt(9)
  buffer_load_dwordx4 v[104:107], v233, s[32:35], 0 offen nt
  v_dot2_f32_bf16 v22, v165, v48, 0
  v_add_f32_dpp v34, v18, v18 row_ror:8 row_mask:0xf bank_mask:0xc
  v_add_f32_dpp v34, v20, v20 row_ror:8 row_mask:0xf bank_mask:0x3
  v_dot2_f32_bf16 v23, v170, v49, 0
  v_dot2_f32_bf16 v24, v168, v50, 0
  v_dot2_f32_bf16 v25, v171, v51, 0
  v_cvt_f32_i32 v72, v72
  v_cvt_f32_i32 v73, v73
  v_cvt_f32_i32 v74, v74
  v_cvt_f32_i32 v75, v75
  v_pk_mul_f32 v[20:21], v[72:73], v[22:23]
  v_pk_add_f32 v[18:19], v[22:23], v[24:25]
  v_pk_fma_f32 v[20:21], v[74:75], v[24:25], v[20:21]
  v_add_f32 v18, v18, v19
  v_add_f32 v20, v20, v21
  s_cmpk_gt_i32 s69, 0x2d
  s_cbranch_scc1 L_p54_4
  s_cmpk_gt_i32 s69, 0x7
  s_cbranch_scc1 L_p54_2
  s_waitcnt vmcnt(6)
L_p54_2:
  s_waitcnt vmcnt(9)
L_p54_4:
  s_waitcnt vmcnt(10)
  buffer_load_dwordx4 v[108:111], v234, s[32:35], 0 offen nt
  v_dot2_f32_bf16 v22, v169, v52, 0
  v_add_f32_dpp v21, v18, v18 row_ror:8 row_mask:0xf bank_mask:0xc
  v_add_f32_dpp v21, v20, v20 row_ror:8 row_mask:0xf bank_mask:0x3
  v_add_f32_dpp v20, v34, v34 row_half_mirror row_mask:0xf bank_mask:0x5
  v_dot2_f32_bf16 v23, v174, v53, 0
  v_add_f32_dpp v20, v21, v21 row_half_mirror row_mask:0xf bank_mask:0xa
  v_dot2_f32_bf16 v24, v172, v54, 0
  v_dot2_f32_bf16 v25, v175, v55, 0
  v_add_f32_dpp v20, v20, v20 quad_perm:[2,3,0,1] row_mask:0xf bank_mask:0xf
  v_cvt_f32_i32 v76, v76
  v_cvt_f32_i32 v77, v77
  v_add_f32_dpp v20, v20, v20 quad_perm:[1,0,3,2] row_mask:0xf bank_mask:0xf
  v_cndmask_b32_e64 v32, v32, v20, s[52:53]
  v_cvt_f32_i32 v78, v78
  v_cvt_f32_i32 v79, v79
  v_pk_mul_f32 v[20:21], v[76:77], v[22:23]
  v_pk_add_f32 v[18:19], v[22:23], v[24:25]
  v_pk_fma_f32 v[20:21], v[78:79], v[24:25], v[20:21]
  v_add_f32 v18, v18, v19
  v_add_f32 v20, v20, v21
  s_cmpk_gt_i32 s69, 0x2d
  s_cbranch_scc1 L_p55_4
  s_cmpk_gt_i32 s69, 0x19
  s_cbranch_scc1 L_p55_3
  s_cmpk_gt_i32 s69, 0xffc9
  s_cbranch_scc1 L_p55_0
  s_waitcnt vmcnt(6)
L_p55_0:
  s_waitcnt vmcnt(7)
L_p55_3:
  s_waitcnt vmcnt(10)
L_p55_4:
  s_waitcnt vmcnt(11)
  buffer_load_dwordx4 v[112:115], v235, s[32:35], 0 offen nt
  s_waitcnt vmcnt(8)
  s_add_u32 s44, s78, 0x03030303
  v_msad_u8 v9, s78, v40, 0
  v_msad_u8 v10, s44, v40, 0
  v_msad_u8 v9, s78, v41, v9
  v_msad_u8 v10, s44, v41, v10
  v_msad_u8 v9, s78, v42, v9
  v_msad_u8 v10, s44, v42, v10
  s_mov_b64 exec, 3
  global_load_dwordx2 v[26:27], v11, s[30:31] sc1
  global_store_byte v7, v8, s[30:31]
  global_load_dwordx3 v[40:42], v237, s[30:31] sc1
  v_sub_u32 v9, v9, v10
  v_add_u32 v8, 1, v8
  s_mov_b64 exec, -1
  v_readlane_b32 s66, v9, 0
  v_readlane_b32 s67, v9, 1
  s_add_u32 s78, s78, 0x01010101
  s_lshl1_add_u32 s69, s91, s95
  s_add_u32 s95, s66, s67
  s_add_u32 s69, s69, s95
  v_dot2_f32_bf16 v22, v173, v44, 0
  v_add_f32_dpp v34, v18, v18 row_ror:8 row_mask:0xf bank_mask:0xc
  v_add_f32_dpp v34, v20, v20 row_ror:8 row_mask:0xf bank_mask:0x3
  v_dot2_f32_bf16 v23, v178, v45, 0
  v_dot2_f32_bf16 v24, v176, v46, 0
  v_dot2_f32_bf16 v25, v179, v47, 0
  v_cvt_f32_i32 v80, v80
  v_cvt_f32_i32 v81, v81
  v_cvt_f32_i32 v82, v82
  v_cvt_f32_i32 v83, v83
  v_pk_mul_f32 v[20:21], v[80:81], v[22:23]
  v_pk_add_f32 v[18:19], v[22:23], v[24:25]
  v_pk_fma_f32 v[20:21], v[82:83], v[24:25], v[20:21]
  v_add_f32 v18, v18, v19
  v_add_f32 v20, v20, v21
  s_cmpk_gt_i32 s69, 0x2d
  s_cbranch_scc1 L_p56_4
  s_cmpk_gt_i32 s69, 0xffe9
  s_cbranch_scc1 L_p56_1
  s_waitcnt vmcnt(6)
L_p56_1:
  s_waitcnt vmcnt(9)
L_p56_4:
  s_waitcnt vmcnt(10)
  buffer_load_dwordx4 v[68:71], v212, s[36:39], 0 offen nt
  v_dot2_f32_bf16 v22, v177, v48, 0
  v_add_f32_dpp v21, v18, v18 row_ror:8 row_mask:0xf bank_mask:0xc
  v_add_f32_dpp v21, v20, v20 row_ror:8 row_mask:0xf bank_mask:0x3
  v_add_f32_dpp v20, v34, v34 row_half_mirror row_mask:0xf bank_mask:0x5
  v_dot2_f32_bf16 v23, v182, v49, 0
  v_add_f32_dpp v20, v21, v21 row_half_mirror row_mask:0xf bank_mask:0xa
  v_dot2_f32_bf16 v24, v180, v50, 0
  v_dot2_f32_bf16 v25, v183, v51, 0
  v_add_f32_dpp v20, v20, v20 quad_perm:[2,3,0,1] row_mask:0xf bank_mask:0xf
  v_cvt_f32_i32 v84, v84
  v_cvt_f32_i32 v85, v85
  v_add_f32_dpp v20, v20, v20 quad_perm:[1,0,3,2] row_mask:0xf bank_mask:0xf
  v_cndmask_b32_e64 v32, v32, v20, s[54:55]
  ds_write_b32 v2, v32 offset:512
  v_cvt_f32_i32 v86, v86
  v_cvt_f32_i32 v87, v87
  v_pk_mul_f32 v[20:21], v[84:85], v[22:23]
  v_pk_add_f32 v[18:19], v[22:23], v[24:25]
  v_pk_fma_f32 v[20:21], v[86:87], v[24:25], v[20:21]
  v_add_f32 v18, v18, v19
  v_add_f32 v20, v20, v21
  s_cmpk_gt_i32 s69, 0x2d
  s_cbranch_scc1 L_p57_4
  s_cmpk_gt_i32 s69, 0x7
  s_cbranch_scc1 L_p57_2
  s_waitcnt vmcnt(7)
L_p57_2:
  s_waitcnt vmcnt(10)
L_p57_4:
  s_waitcnt vmcnt(11)
  buffer_load_dwordx4 v[72:75], v213, s[36:39], 0 offen nt
  v_dot2_f32_bf16 v22, v181, v52, 0
  v_add_f32_dpp v34, v18, v18 row_ror:8 row_mask:0xf bank_mask:0xc
  v_add_f32_dpp v34, v20, v20 row_ror:8 row_mask:0xf bank_mask:0x3
  v_dot2_f32_bf16 v23, v186, v53, 0
  v_dot2_f32_bf16 v24, v184, v54, 0
  v_dot2_f32_bf16 v25, v187, v55, 0
  v_cvt_f32_i32 v88, v88
  v_cvt_f32_i32 v89, v89
  v_cvt_f32_i32 v90, v90
  v_cvt_f32_i32 v91, v91
  v_pk_mul_f32 v[20:21], v[88:89], v[22:23]
  v_pk_add_f32 v[18:19], v[22:23], v[24:25]
  v_pk_fma_f32 v[20:21], v[90:91], v[24:25], v[20:21]
  v_add_f32 v18, v18, v19
  v_add_f32 v20, v20, v21
  s_cmpk_gt_i32 s69, 0x2d
  s_cbranch_scc1 L_p58_4
  s_cmpk_gt_i32 s69, 0x19
  s_cbranch_scc1 L_p58_3
  s_cmpk_gt_i32 s69, 0xffc9
  s_cbranch_scc1 L_p58_0
  s_waitcnt vmcnt(7)
L_p58_0:
  s_waitcnt vmcnt(8)
L_p58_3:
  s_waitcnt vmcnt(11)
L_p58_4:
  s_waitcnt vmcnt(12)
  buffer_load_dwordx4 v[76:79], v214, s[36:39], 0 offen nt
  ds_read_b32 v4, v14 offset:16
  s_waitcnt vmcnt(9)
  s_add_u32 s44, s78, 0x03030303
  v_msad_u8 v9, s78, v36, 0
  v_msad_u8 v10, s44, v36, 0
  v_msad_u8 v9, s78, v37, v9
  v_msad_u8 v10, s44, v37, v10
  v_msad_u8 v9, s78, v38, v9
  v_msad_u8 v10, s44, v38, v10
  s_mov_b64 exec, 3
  global_store_byte v7, v8, s[30:31]
  global_load_dwordx3 v[36:38], v238, s[30:31] sc1
  v_sub_u32 v9, v9, v10
  v_add_u32 v8, 1, v8
  s_mov_b64 exec, -1
  v_readlane_b32 s66, v9, 0
  v_readlane_b32 s67, v9, 1
  s_add_u32 s78, s78, 0x01010101
  s_lshl1_add_u32 s69, s91, s95
  s_add_u32 s95, s66, s67
  s_add_u32 s69, s69, s95
  v_dot2_f32_bf16 v22, v185, v44, 0
  v_add_f32_dpp v21, v18, v18 row_ror:8 row_mask:0xf bank_mask:0xc
  v_add_f32_dpp v21, v20, v20 row_ror:8 row_mask:0xf bank_mask:0x3
  v_add_f32_dpp v20, v34, v34 row_half_mirror row_mask:0xf bank_mask:0x5
  v_dot2_f32_bf16 v23, v190, v45, 0
  v_add_f32_dpp v20, v21, v21 row_half_mirror row_mask:0xf bank_mask:0xa
  v_dot2_f32_bf16 v24, v188, v46, 0
  v_dot2_f32_bf16 v25, v191, v47, 0
  v_add_f32_dpp v20, v20, v20 quad_perm:[2,3,0,1] row_mask:0xf bank_mask:0xf
  v_cvt_f32_i32 v92, v92
  v_cvt_f32_i32 v93, v93
  v_add_f32_dpp v20, v20, v20 quad_perm:[1,0,3,2] row_mask:0xf bank_mask:0xf
  v_cndmask_b32_e64 v32, v32, v20, s[48:49]
  v_cvt_f32_i32 v94, v94
  v_cvt_f32_i32 v95, v95
  v_pk_mul_f32 v[20:21], v[92:93], v[22:23]
  v_pk_add_f32 v[18:19], v[22:23], v[24:25]
  v_pk_fma_f32 v[20:21], v[94:95], v[24:25], v[20:21]
  v_add_f32 v18, v18, v19
  v_add_f32 v20, v20, v21
  s_cmpk_gt_i32 s69, 0x2d
  s_cbranch_scc1 L_p59_4
  s_cmpk_gt_i32 s69, 0xffe9
  s_cbranch_scc1 L_p59_1
  s_waitcnt vmcnt(5)
L_p59_1:
  s_waitcnt vmcnt(9)
L_p59_4:
  s_waitcnt vmcnt(10)
  buffer_load_dwordx4 v[80:83], v215, s[36:39], 0 offen nt
  v_dot2_f32_bf16 v22, v189, v48, 0
  v_add_f32_dpp v34, v18, v18 row_ror:8 row_mask:0xf bank_mask:0xc
  v_add_f32_dpp v34, v20, v20 row_ror:8 row_mask:0xf bank_mask:0x3
  v_dot2_f32_bf16 v23, v194, v49, 0
  v_dot2_f32_bf16 v24, v192, v50, 0
  v_dot2_f32_bf16 v25, v195, v51, 0
  v_cvt_f32_i32 v96, v96
  v_cvt_f32_i32 v97, v97
  v_cvt_f32_i32 v98, v98
  v_cvt_f32_i32 v99, v99
  v_pk_mul_f32 v[20:21], v[96:97], v[22:23]
  v_pk_add_f32 v[18:19], v[22:23], v[24:25]
  v_pk_fma_f32 v[20:21], v[98:99], v[24:25], v[20:21]
  v_add_f32 v18, v18, v19
  v_add_f32 v20, v20, v21
  s_cmpk_gt_i32 s69, 0x2d
  s_cbranch_scc1 L_p60_4
  s_cmpk_gt_i32 s69, 0x7
  s_cbranch_scc1 L_p60_2
  s_waitcnt vmcnt(6)
L_p60_2:
  s_waitcnt vmcnt(10)
L_p60_4:
  s_waitcnt vmcnt(11)
  buffer_load_dwordx4 v[84:87], v216, s[36:39], 0 offen nt
  v_dot2_f32_bf16 v22, v193, v52, 0
  v_add_f32_dpp v21, v18, v18 row_ror:8 row_mask:0xf bank_mask:0xc
  v_add_f32_dpp v21, v20, v20 row_ror:8 row_mask:0xf bank_mask:0x3
  v_add_f32_dpp v20, v34, v34 row_half_mirror row_mask:0xf bank_mask:0x5
  v_dot2_f32_bf16 v23, v198, v53, 0
  v_add_f32_dpp v20, v21, v21 row_half_mirror row_mask:0xf bank_mask:0xa
  v_dot2_f32_bf16 v24, v196, v54, 0
  v_dot2_f32_bf16 v25, v199, v55, 0
  v_add_f32_dpp v20, v20, v20 quad_perm:[2,3,0,1] row_mask:0xf bank_mask:0xf
  v_cvt_f32_i32 v100, v100
  v_cvt_f32_i32 v101, v101
  v_add_f32_dpp v20, v20, v20 quad_perm:[1,0,3,2] row_mask:0xf bank_mask:0xf
  v_cndmask_b32_e64 v32, v32, v20, s[50:51]
  v_cvt_f32_i32 v102, v102
  v_cvt_f32_i32 v103, v103
  v_pk_mul_f32 v[20:21], v[100:101], v[22:23]
  v_pk_add_f32 v[18:19], v[22:23], v[24:25]
  v_pk_fma_f32 v[20:21], v[102:103], v[24:25], v[20:21]
  v_add_f32 v18, v18, v19
  v_add_f32 v20, v20, v21
  s_cmpk_gt_i32 s69, 0x2d
  s_cbranch_scc1 L_p61_4
  s_cmpk_gt_i32 s69, 0x19
  s_cbranch_scc1 L_p61_3
  s_cmpk_gt_i32 s69, 0xffc9
  s_cbranch_scc1 L_p61_0
  s_waitcnt vmcnt(6)
L_p61_0:
  s_waitcnt vmcnt(7)
L_p61_3:
  s_waitcnt vmcnt(11)
L_p61_4:
  s_waitcnt vmcnt(12)
  buffer_load_dwordx4 v[88:91], v217, s[36:39], 0 offen nt
L_qn:
  s_waitcnt lgkmcnt(0)
  v_readfirstlane_b32 s46, v4
  s_cmp_ge_u32 s46, s47
  s_cbranch_scc1 L_qn_ok
  s_cmp_eq_u32 s94, 0
  s_cbranch_scc1 L_qn_ok
  s_sub_u32 s94, s94, 1
  ds_read_b32 v4, v14 offset:16
  s_branch L_qn
L_qn_ok:
  s_waitcnt vmcnt(8)
  s_add_u32 s44, s78, 0x03030303
  v_msad_u8 v9, s78, v40, 0
  v_msad_u8 v10, s44, v40, 0
  v_msad_u8 v9, s78, v41, v9
  v_msad_u8 v10, s44, v41, v10
  v_msad_u8 v9, s78, v42, v9
  v_msad_u8 v10, s44, v42, v10
  s_mov_b64 exec, 3
  global_store_byte v7, v8, s[30:31]
  global_load_dwordx3 v[40:42], v239, s[30:31] sc1
  v_sub_u32 v9, v9, v10
  v_add3_u32 v10, v26, v27, s58
  v_add_u32 v8, 1, v8
  s_mov_b64 exec, -1
  v_readlane_b32 s66, v9, 0
  v_readlane_b32 s67, v9, 1
  v_readlane_b32 s91, v10, 0
  s_add_u32 s78, s78, 0x01010101
  s_lshl1_add_u32 s69, s91, s95
  s_add_u32 s95, s66, s67
  s_add_u32 s69, s69, s95
  v_dot2_f32_bf16 v22, v197, v44, 0
  v_add_f32_dpp v34, v18, v18 row_ror:8 row_mask:0xf bank_mask:0xc
  v_add_f32_dpp v34, v20, v20 row_ror:8 row_mask:0xf bank_mask:0x3
  v_dot2_f32_bf16 v23, v202, v45, 0
  v_dot2_f32_bf16 v24, v200, v46, 0
  v_dot2_f32_bf16 v25, v203, v47, 0
  v_cvt_f32_i32 v104, v104
  v_cvt_f32_i32 v105, v105
  v_cvt_f32_i32 v106, v106
  v_cvt_f32_i32 v107, v107
  ds_read_b128 v[44:47], v15 offset:512
  v_pk_mul_f32 v[20:21], v[104:105], v[22:23]
  v_pk_add_f32 v[18:19], v[22:23], v[24:25]
  v_pk_fma_f32 v[20:21], v[106:107], v[24:25], v[20:21]
  v_add_f32 v18, v18, v19
  v_add_f32 v20, v20, v21
  s_cmpk_gt_i32 s69, 0x2d
  s_cbranch_scc1 L_p62_4
  s_cmpk_gt_i32 s69, 0xffe9
  s_cbranch_scc1 L_p62_1
  s_waitcnt vmcnt(5)
L_p62_1:
  s_waitcnt vmcnt(8)
L_p62_4:
  s_waitcnt vmcnt(9)
  buffer_load_dwordx4 v[92:95], v218, s[36:39], 0 offen nt
  v_dot2_f32_bf16 v22, v201, v48, 0
  v_add_f32_dpp v21, v18, v18 row_ror:8 row_mask:0xf bank_mask:0xc
  v_add_f32_dpp v21, v20, v20 row_ror:8 row_mask:0xf bank_mask:0x3
  v_add_f32_dpp v20, v34, v34 row_half_mirror row_mask:0xf bank_mask:0x5
  v_dot2_f32_bf16 v23, v206, v49, 0
  v_add_f32_dpp v20, v21, v21 row_half_mirror row_mask:0xf bank_mask:0xa
  v_dot2_f32_bf16 v24, v204, v50, 0
  v_dot2_f32_bf16 v25, v207, v51, 0
  v_add_f32_dpp v20, v20, v20 quad_perm:[2,3,0,1] row_mask:0xf bank_mask:0xf
  v_cvt_f32_i32 v108, v108
  v_cvt_f32_i32 v109, v109
  v_add_f32_dpp v20, v20, v20 quad_perm:[1,0,3,2] row_mask:0xf bank_mask:0xf
  v_cndmask_b32_e64 v32, v32, v20, s[52:53]
  v_cvt_f32_i32 v110, v110
  v_cvt_f32_i32 v111, v111
  ds_read_b128 v[48:51], v16 offset:512
  v_pk_mul_f32 v[20:21], v[108:109], v[22:23]
  v_pk_add_f32 v[18:19], v[22:23], v[24:25]
  v_pk_fma_f32 v[20:21], v[110:111], v[24:25], v[20:21]
  v_add_f32 v18, v18, v19
  v_add_f32 v20, v20, v21
  s_cmpk_gt_i32 s69, 0x2d
  s_cbranch_scc1 L_p63_4
  s_cmpk_gt_i32 s69, 0x7
  s_cbranch_scc1 L_p63_2
  s_waitcnt vmcnt(6)
L_p63_2:
  s_waitcnt vmcnt(9)
L_p63_4:
  s_waitcnt vmcnt(10)
  buffer_load_dwordx4 v[96:99], v219, s[36:39], 0 offen nt
  v_dot2_f32_bf16 v22, v205, v52, 0
  v_add_f32_dpp v34, v18, v18 row_ror:8 row_mask:0xf bank_mask:0xc
  v_add_f32_dpp v34, v20, v20 row_ror:8 row_mask:0xf bank_mask:0x3
  v_dot2_f32_bf16 v23, v210, v53, 0
  v_dot2_f32_bf16 v24, v208, v54, 0
  v_dot2_f32_bf16 v25, v211, v55, 0
  v_cvt_f32_i32 v112, v112
  v_cvt_f32_i32 v113, v113
  v_cvt_f32_i32 v114, v114
  v_cvt_f32_i32 v115, v115
  ds_read_b128 v[52:55], v17 offset:512
  v_pk_mul_f32 v[20:21], v[112:113], v[22:23]
  v_pk_add_f32 v[18:19], v[22:23], v[24:25]
  v_pk_fma_f32 v[20:21], v[114:115], v[24:25], v[20:21]
  v_add_f32 v18, v18, v19
  v_add_f32 v20, v20, v21
  s_cmpk_gt_i32 s69, 0x2d
  s_cbranch_scc1 L_p64_4
  s_cmpk_gt_i32 s69, 0x19
  s_cbranch_scc1 L_p64_3
  s_cmpk_gt_i32 s69, 0xffc9
  s_cbranch_scc1 L_p64_0
  s_waitcnt vmcnt(6)
L_p64_0:
  s_waitcnt vmcnt(7)
L_p64_3:
  s_waitcnt vmcnt(10)
L_p64_4:
  s_waitcnt vmcnt(11)
  buffer_load_dwordx4 v[100:103], v220, s[36:39], 0 offen nt
  s_nop 0
  v_add_f32_dpp v21, v18, v18 row_ror:8 row_mask:0xf bank_mask:0xc
  v_add_f32_dpp v21, v20, v20 row_ror:8 row_mask:0xf bank_mask:0x3
  v_add_f32_dpp v20, v34, v34 row_half_mirror row_mask:0xf bank_mask:0x5
  s_nop 0
  v_add_f32_dpp v20, v21, v21 row_half_mirror row_mask:0xf bank_mask:0xa
  s_nop 1
  v_add_f32_dpp v20, v20, v20 quad_perm:[2,3,0,1] row_mask:0xf bank_mask:0xf
  s_nop 1
  v_add_f32_dpp v20, v20, v20 quad_perm:[1,0,3,2] row_mask:0xf bank_mask:0xf
  v_cndmask_b32_e64 v32, v32, v20, s[54:55]
  ds_write_b32 v2, v32 offset:1024
  s_add_u32 s43, s43, 1
  v_mov_b32 v4, s43
  ds_write_b32 v6, v4 offset:0
  s_mov_b64 s[32:33], s[36:37]
  s_add_u32 s68, s43, 1
  s_sub_u32 s45, s68, 16
  s_lshl_b32 s46, s45, 2
  s_lshr_b64 s[64:65], s[92:93], s46
  s_and_b32 s46, s64, 15
  s_cmp_lt_u32 s68, 16
  s_cselect_b32 s68, s68, s46
  s_cselect_b32 s70, s6, s12
  s_cselect_b32 s71, s7, s13
  s_lshl_b32 s44, s68, 2
  s_lshr_b64 s[64:65], s[96:97], s44
  s_and_b32 s64, s64, 15
  s_lshl4_add_u32 s68, s68, s64
  s_mul_i32 s44, s68, 1572864
  s_add_u32 s36, s70, s44
  s_addc_u32 s37, s71, 0
  s_cmp_lt_u32 s43, 16
  s_cbranch_scc1 L_k
L_vpre:
  s_cmp_eq_u32 s41, 0
  s_cselect_b32 s44, 1, -1
  s_cselect_b32 s45, 0, -1
  s_mulk_i32 s44, 512
  s_add_u32 s82, s82, s44
  s_addc_u32 s83, s83, s45
  s_load_dword s98, s[82:83], 16
  v_lshrrev_b32 v116, 4, v0
  v_and_b32 v119, 15, v0
  v_and_or_b32 v120, v0, 7, 16
  v_lshl_add_u32 v119, v119, 4, v116
  v_mul_u32_u24 v119, 683, v119
  v_lshrrev_b32 v119, 11, v119
  v_lshlrev_b32 v119, 2, v119
  v_lshl_add_u32 v120, v120, 4, v116
  v_mul_u32_u24 v120, 683, v120
  v_lshrrev_b32 v120, 11, v120
  v_lshlrev_b32 v120, 2, v120
  s_mov_b64 vcc, 0
  s_mov_b32 s43, 0
  s_lshl_b32 s68, s43, 2
  s_lshr_b64 s[64:65], s[92:93], s68
  s_and_b32 s68, s64, 15
  s_add_u32 s47, s68, 1
  ds_read_b32 v4, v14 offset:20
L_a0:
  s_waitcnt lgkmcnt(0)
  v_readfirstlane_b32 s46, v4
  s_cmp_ge_u32 s46, s47
  s_cbranch_scc1 L_a0_ok
  s_cmp_eq_u32 s94, 0
  s_cbranch_scc1 L_a0_ok
  s_sub_u32 s94, s94, 1
  ds_read_b32 v4, v14 offset:20
  s_branch L_a0
L_a0_ok:
  v_lshl_add_u32 v121, s68, 9, v119
  v_lshl_add_u32 v122, s68, 9, v120
  ds_read_b32 v116, v121 offset:37376
  ds_read_b32 v117, v122 offset:37376
.p2align 6
L_v:
  s_add_u32 s45, s43, 1
  s_min_u32 s45, s45, 15
  s_lshl_b32 s68, s45, 2
  s_lshr_b64 s[64:65], s[92:93], s68
  s_and_b32 s68, s64, 15
  s_add_u32 s47, s68, 1
  v_lshl_add_u32 v121, s68, 9, v119
  v_lshl_add_u32 v122, s68, 9, v120
  s_waitcnt lgkmcnt(0)
  s_waitcnt vmcnt(8)
  s_add_u32 s44, s78, 0x03030303
  v_msad_u8 v9, s78, v36, 0
  v_msad_u8 v10, s44, v36, 0
  v_msad_u8 v9, s78, v37, v9
  v_msad_u8 v10, s44, v37, v10
  v_msad_u8 v9, s78, v38, v9
  v_msad_u8 v10, s44, v38, v10
  s_mov_b64 exec, 3
  global_store_byte v7, v8, s[30:31]
  global_load_dwordx3 v[36:38], v236, s[30:31] sc1
  v_sub_u32 v9, v9, v10
  v_add_u32 v8, 1, v8
  s_mov_b64 exec, -1
  v_readlane_b32 s66, v9, 0
  v_readlane_b32 s67, v9, 1
  s_add_u32 s78, s78, 0x01010101
  s_lshl1_add_u32 s69, s91, s95
  s_add_u32 s95, s66, s67
  s_add_u32 s69, s69, s95
  v_mov_b32_dpp v18, v116 row_newbcast:0 row_mask:0xf bank_mask:0xf
  v_cvt_f32_i32 v68, v68
  v_cvt_f32_i32 v69, v69
  v_cvt_f32_i32 v70, v70
  v_cvt_f32_i32 v71, v71
  v_pk_mul_f32 v[44:45], v[68:69], v[18:19] op_sel_hi:[1,0]
  v_pk_mul_f32 v[46:47], v[70:71], v[18:19] op_sel_hi:[1,0]
  s_cmpk_gt_i32 s69, 0x35
  s_cbranch_scc1 L_p65_4
  s_cmpk_gt_i32 s69, 0xfff1
  s_cbranch_scc1 L_p65_1
  s_waitcnt vmcnt(5)
L_p65_1:
  s_waitcnt vmcnt(8)
L_p65_4:
  s_waitcnt vmcnt(9)
  buffer_load_dwordx4 v[104:107], v221, s[32:35], 0 offen nt
  v_mov_b32_dpp v18, v116 row_newbcast:1 row_mask:0xf bank_mask:0xf
  v_cvt_f32_i32 v72, v72
  v_cvt_f32_i32 v73, v73
  v_cvt_f32_i32 v74, v74
  v_cvt_f32_i32 v75, v75
  v_pk_mul_f32 v[48:49], v[72:73], v[18:19] op_sel_hi:[1,0]
  v_pk_mul_f32 v[50:51], v[74:75], v[18:19] op_sel_hi:[1,0]
  s_cmpk_gt_i32 s69, 0x35
  s_cbranch_scc1 L_p66_4
  s_cmpk_gt_i32 s69, 0xf
  s_cbranch_scc1 L_p66_2
  s_waitcnt vmcnt(6)
L_p66_2:
  s_waitcnt vmcnt(9)
L_p66_4:
  s_waitcnt vmcnt(10)
  buffer_load_dwordx4 v[108:111], v222, s[32:35], 0 offen nt
  v_mov_b32_dpp v18, v116 row_newbcast:2 row_mask:0xf bank_mask:0xf
  v_cvt_f32_i32 v76, v76
  v_cvt_f32_i32 v77, v77
  v_cvt_f32_i32 v78, v78
  v_cvt_f32_i32 v79, v79
  v_pk_mul_f32 v[52:53], v[76:77], v[18:19] op_sel_hi:[1,0]
  v_pk_mul_f32 v[54:55], v[78:79], v[18:19] op_sel_hi:[1,0]
  s_cmpk_gt_i32 s69, 0x35
  s_cbranch_scc1 L_p67_4
  s_cmpk_gt_i32 s69, 0x21
  s_cbranch_scc1 L_p67_3
  s_cmpk_gt_i32 s69, 0xffd1
  s_cbranch_scc1 L_p67_0
  s_waitcnt vmcnt(6)
L_p67_0:
  s_waitcnt vmcnt(7)
L_p67_3:
  s_waitcnt vmcnt(10)
L_p67_4:
  s_waitcnt vmcnt(11)
  buffer_load_dwordx4 v[112:115], v223, s[32:35], 0 offen nt
  s_waitcnt vmcnt(8)
  s_add_u32 s44, s78, 0x03030303
  v_msad_u8 v9, s78, v40, 0
  v_msad_u8 v10, s44, v40, 0
  v_msad_u8 v9, s78, v41, v9
  v_msad_u8 v10, s44, v41, v10
  v_msad_u8 v9, s78, v42, v9
  v_msad_u8 v10, s44, v42, v10
  s_mov_b64 exec, 3
  global_store_byte v7, v8, s[30:31]
  global_load_dwordx3 v[40:42], v237, s[30:31] sc1
  v_sub_u32 v9, v9, v10
  v_add_u32 v8, 1, v8
  s_mov_b64 exec, -1
  v_readlane_b32 s66, v9, 0
  v_readlane_b32 s67, v9, 1
  s_add_u32 s78, s78, 0x01010101
  s_lshl1_add_u32 s69, s91, s95
  s_add_u32 s95, s66, s67
  s_add_u32 s69, s69, s95
  v_mov_b32_dpp v18, v116 row_newbcast:3 row_mask:0xf bank_mask:0xf
  v_cvt_f32_i32 v80, v80
  v_cvt_f32_i32 v81, v81
  v_cvt_f32_i32 v82, v82
  v_cvt_f32_i32 v83, v83
  v_pk_fma_f32 v[44:45], v[80:81], v[18:19], v[44:45] op_sel_hi:[1,0,1]
  v_pk_fma_f32 v[46:47], v[82:83], v[18:19], v[46:47] op_sel_hi:[1,0,1]
  s_cmpk_gt_i32 s69, 0x35
  s_cbranch_scc1 L_p68_4
  s_cmpk_gt_i32 s69, 0xfff1
  s_cbranch_scc1 L_p68_1
  s_waitcnt vmcnt(5)
L_p68_1:
  s_waitcnt vmcnt(8)
L_p68_4:
  s_waitcnt vmcnt(9)
  buffer_load_dwordx4 v[68:71], v224, s[32:35], 0 offen nt
  v_mov_b32_dpp v18, v116 row_newbcast:4 row_mask:0xf bank_mask:0xf
  v_cvt_f32_i32 v84, v84
  v_cvt_f32_i32 v85, v85
  v_cvt_f32_i32 v86, v86
  v_cvt_f32_i32 v87, v87
  v_pk_fma_f32 v[48:49], v[84:85], v[18:19], v[48:49] op_sel_hi:[1,0,1]
  v_pk_fma_f32 v[50:51], v[86:87], v[18:19], v[50:51] op_sel_hi:[1,0,1]
  s_cmpk_gt_i32 s69, 0x35
  s_cbranch_scc1 L_p69_4
  s_cmpk_gt_i32 s69, 0xf
  s_cbranch_scc1 L_p69_2
  s_waitcnt vmcnt(6)
L_p69_2:
  s_waitcnt vmcnt(9)
L_p69_4:
  s_waitcnt vmcnt(10)
  buffer_load_dwordx4 v[72:75], v225, s[32:35], 0 offen nt
  v_mov_b32_dpp v18, v116 row_newbcast:5 row_mask:0xf bank_mask:0xf
  v_cvt_f32_i32 v88, v88
  v_cvt_f32_i32 v89, v89
  v_cvt_f32_i32 v90, v90
  v_cvt_f32_i32 v91, v91
  v_pk_fma_f32 v[52:53], v[88:89], v[18:19], v[52:53] op_sel_hi:[1,0,1]
  v_pk_fma_f32 v[54:55], v[90:91], v[18:19], v[54:55] op_sel_hi:[1,0,1]
  s_cmpk_gt_i32 s69, 0x35
  s_cbranch_scc1 L_p70_4
  s_cmpk_gt_i32 s69, 0x21
  s_cbranch_scc1 L_p70_3
  s_cmpk_gt_i32 s69, 0xffd1
  s_cbranch_scc1 L_p70_0
  s_waitcnt vmcnt(6)
L_p70_0:
  s_waitcnt vmcnt(7)
L_p70_3:
  s_waitcnt vmcnt(10)
L_p70_4:
  s_waitcnt vmcnt(11)
  buffer_load_dwordx4 v[76:79], v226, s[32:35], 0 offen nt
  v_add_u32_e64 v9, s43, 16
  ds_write_b32 v14, v9 offset:28
  s_waitcnt vmcnt(8)
  s_add_u32 s44, s78, 0x03030303
  v_msad_u8 v9, s78, v36, 0
  v_msad_u8 v10, s44, v36, 0
  v_msad_u8 v9, s78, v37, v9
  v_msad_u8 v10, s44, v37, v10
  v_msad_u8 v9, s78, v38, v9
  v_msad_u8 v10, s44, v38, v10
  s_mov_b64 exec, 3
  global_store_byte v7, v8, s[30:31]
  global_load_dwordx3 v[36:38], v238, s[30:31] sc1
  v_sub_u32 v9, v9, v10
  v_add_u32 v8, 1, v8
  s_mov_b64 exec, -1
  v_readlane_b32 s66, v9, 0
  v_readlane_b32 s67, v9, 1
  s_add_u32 s78, s78, 0x01010101
  s_lshl1_add_u32 s69, s91, s95
  s_add_u32 s95, s66, s67
  s_add_u32 s69, s69, s95
  v_mov_b32_dpp v18, v116 row_newbcast:6 row_mask:0xf bank_mask:0xf
  v_cvt_f32_i32 v92, v92
  v_cvt_f32_i32 v93, v93
  v_cvt_f32_i32 v94, v94
  v_cvt_f32_i32 v95, v95
  v_pk_fma_f32 v[44:45], v[92:93], v[18:19], v[44:45] op_sel_hi:[1,0,1]
  v_pk_fma_f32 v[46:47], v[94:95], v[18:19], v[46:47] op_sel_hi:[1,0,1]
  s_cmpk_gt_i32 s69, 0x35
  s_cbranch_scc1 L_p71_4
  s_cmpk_gt_i32 s69, 0xfff1
  s_cbranch_scc1 L_p71_1
  s_waitcnt vmcnt(5)
L_p71_1:
  s_waitcnt vmcnt(8)
L_p71_4:
  s_waitcnt vmcnt(9)
  buffer_load_dwordx4 v[80:83], v227, s[32:35], 0 offen nt
  v_mov_b32_dpp v18, v116 row_newbcast:7 row_mask:0xf bank_mask:0xf
  v_cvt_f32_i32 v96, v96
  v_cvt_f32_i32 v97, v97
  v_cvt_f32_i32 v98, v98
  v_cvt_f32_i32 v99, v99
  v_pk_fma_f32 v[48:49], v[96:97], v[18:19], v[48:49] op_sel_hi:[1,0,1]
  v_pk_fma_f32 v[50:51], v[98:99], v[18:19], v[50:51] op_sel_hi:[1,0,1]
  s_cmpk_gt_i32 s69, 0x35
  s_cbranch_scc1 L_p72_4
  s_cmpk_gt_i32 s69, 0xf
  s_cbranch_scc1 L_p72_2
  s_waitcnt vmcnt(6)
L_p72_2:
  s_waitcnt vmcnt(9)
L_p72_4:
  s_waitcnt vmcnt(10)
  buffer_load_dwordx4 v[84:87], v228, s[32:35], 0 offen nt
  v_mov_b32_dpp v18, v116 row_newbcast:8 row_mask:0xf bank_mask:0xf
  v_cvt_f32_i32 v100, v100
  v_cvt_f32_i32 v101, v101
  v_cvt_f32_i32 v102, v102
  v_cvt_f32_i32 v103, v103
  v_pk_fma_f32 v[52:53], v[100:101], v[18:19], v[52:53] op_sel_hi:[1,0,1]
  v_pk_fma_f32 v[54:55], v[102:103], v[18:19], v[54:55] op_sel_hi:[1,0,1]
  s_cmpk_gt_i32 s69, 0x35
  s_cbranch_scc1 L_p73_4
  s_cmpk_gt_i32 s69, 0x21
  s_cbranch_scc1 L_p73_3
  s_cmpk_gt_i32 s69, 0xffd1
  s_cbranch_scc1 L_p73_0
  s_waitcnt vmcnt(6)
L_p73_0:
  s_waitcnt vmcnt(7)
L_p73_3:
  s_waitcnt vmcnt(10)
L_p73_4:
  s_waitcnt vmcnt(11)
  buffer_load_dwordx4 v[88:91], v229, s[32:35], 0 offen nt
  s_waitcnt vmcnt(8)
  s_add_u32 s44, s78, 0x03030303
  v_msad_u8 v9, s78, v40, 0
  v_msad_u8 v10, s44, v40, 0
  v_msad_u8 v9, s78, v41, v9
  v_msad_u8 v10, s44, v41, v10
  v_msad_u8 v9, s78, v42, v9
  v_msad_u8 v10, s44, v42, v10
  s_mov_b64 exec, 3
  global_store_byte v7, v8, s[30:31]
  global_load_dwordx3 v[40:42], v239, s[30:31] sc1
  v_sub_u32 v9, v9, v10
  v_add_u32 v8, 1, v8
  s_mov_b64 exec, -1
  v_readlane_b32 s66, v9, 0
  v_readlane_b32 s67, v9, 1
  s_add_u32 s78, s78, 0x01010101
  s_lshl1_add_u32 s69, s91, s95
  s_add_u32 s95, s66, s67
  s_add_u32 s69, s69, s95
  v_mov_b32_dpp v18, v116 row_newbcast:9 row_mask:0xf bank_mask:0xf
  v_cvt_f32_i32 v104, v104
  v_cvt_f32_i32 v105, v105
  v_cvt_f32_i32 v106, v106
  v_cvt_f32_i32 v107, v107
  v_pk_fma_f32 v[44:45], v[104:105], v[18:19], v[44:45] op_sel_hi:[1,0,1]
  v_pk_fma_f32 v[46:47], v[106:107], v[18:19], v[46:47] op_sel_hi:[1,0,1]
  s_cmpk_gt_i32 s69, 0x35
  s_cbranch_scc1 L_p74_4
  s_cmpk_gt_i32 s69, 0xfff1
  s_cbranch_scc1 L_p74_1
  s_waitcnt vmcnt(5)
L_p74_1:
  s_waitcnt vmcnt(8)
L_p74_4:
  s_waitcnt vmcnt(9)
  buffer_load_dwordx4 v[92:95], v230, s[32:35], 0 offen nt
  v_mov_b32_dpp v18, v116 row_newbcast:10 row_mask:0xf bank_mask:0xf
  v_cvt_f32_i32 v108, v108
  v_cvt_f32_i32 v109, v109
  v_cvt_f32_i32 v110, v110
  v_cvt_f32_i32 v111, v111
  v_pk_fma_f32 v[48:49], v[108:109], v[18:19], v[48:49] op_sel_hi:[1,0,1]
  v_pk_fma_f32 v[50:51], v[110:111], v[18:19], v[50:51] op_sel_hi:[1,0,1]
  s_cmpk_gt_i32 s69, 0x35
  s_cbranch_scc1 L_p75_4
  s_cmpk_gt_i32 s69, 0xf
  s_cbranch_scc1 L_p75_2
  s_waitcnt vmcnt(6)
L_p75_2:
  s_waitcnt vmcnt(9)
L_p75_4:
  s_waitcnt vmcnt(10)
  buffer_load_dwordx4 v[96:99], v231, s[32:35], 0 offen nt
  v_mov_b32_dpp v18, v116 row_newbcast:11 row_mask:0xf bank_mask:0xf
  v_cvt_f32_i32 v112, v112
  v_cvt_f32_i32 v113, v113
  v_cvt_f32_i32 v114, v114
  v_cvt_f32_i32 v115, v115
  v_pk_fma_f32 v[52:53], v[112:113], v[18:19], v[52:53] op_sel_hi:[1,0,1]
  v_pk_fma_f32 v[54:55], v[114:115], v[18:19], v[54:55] op_sel_hi:[1,0,1]
  s_cmpk_gt_i32 s69, 0x35
  s_cbranch_scc1 L_p76_4
  s_cmpk_gt_i32 s69, 0x21
  s_cbranch_scc1 L_p76_3
  s_cmpk_gt_i32 s69, 0xffd1
  s_cbranch_scc1 L_p76_0
  s_waitcnt vmcnt(6)
L_p76_0:
  s_waitcnt vmcnt(7)
L_p76_3:
  s_waitcnt vmcnt(10)
L_p76_4:
  s_waitcnt vmcnt(11)
  buffer_load_dwordx4 v[100:103], v232, s[32:35], 0 offen nt
  s_waitcnt vmcnt(8)
  s_add_u32 s44, s78, 0x03030303
  v_msad_u8 v9, s78, v36, 0
  v_msad_u8 v10, s44, v36, 0
  v_msad_u8 v9, s78, v37, v9
  v_msad_u8 v10, s44, v37, v10
  v_msad_u8 v9, s78, v38, v9
  v_msad_u8 v10, s44, v38, v10
  s_mov_b64 exec, 3
  global_store_byte v7, v8, s[30:31]
  global_load_dwordx3 v[36:38], v236, s[30:31] sc1
  v_sub_u32 v9, v9, v10
  v_add_u32 v8, 1, v8
  s_mov_b64 exec, -1
  v_readlane_b32 s66, v9, 0
  v_readlane_b32 s67, v9, 1
  s_add_u32 s78, s78, 0x01010101
  s_lshl1_add_u32 s69, s91, s95
  s_add_u32 s95, s66, s67
  s_add_u32 s69, s69, s95
  v_mov_b32_dpp v18, v116 row_newbcast:12 row_mask:0xf bank_mask:0xf
  v_cvt_f32_i32 v68, v68
  v_cvt_f32_i32 v69, v69
  v_cvt_f32_i32 v70, v70
  v_cvt_f32_i32 v71, v71
  v_pk_fma_f32 v[44:45], v[68:69], v[18:19], v[44:45] op_sel_hi:[1,0,1]
  v_pk_fma_f32 v[46:47], v[70:71], v[18:19], v[46:47] op_sel_hi:[1,0,1]
  s_cmpk_gt_i32 s69, 0x35
  s_cbranch_scc1 L_p77_4
  s_cmpk_gt_i32 s69, 0xfff1
  s_cbranch_scc1 L_p77_1
  s_waitcnt vmcnt(5)
L_p77_1:
  s_waitcnt vmcnt(8)
L_p77_4:
  s_waitcnt vmcnt(9)
  buffer_load_dwordx4 v[104:107], v233, s[32:35], 0 offen nt
  v_mov_b32_dpp v18, v116 row_newbcast:13 row_mask:0xf bank_mask:0xf
  v_cvt_f32_i32 v72, v72
  v_cvt_f32_i32 v73, v73
  v_cvt_f32_i32 v74, v74
  v_cvt_f32_i32 v75, v75
  v_pk_fma_f32 v[48:49], v[72:73], v[18:19], v[48:49] op_sel_hi:[1,0,1]
  v_pk_fma_f32 v[50:51], v[74:75], v[18:19], v[50:51] op_sel_hi:[1,0,1]
  s_cmpk_gt_i32 s69, 0x35
  s_cbranch_scc1 L_p78_4
  s_cmpk_gt_i32 s69, 0xf
  s_cbranch_scc1 L_p78_2
  s_waitcnt vmcnt(6)
L_p78_2:
  s_waitcnt vmcnt(9)
L_p78_4:
  s_waitcnt vmcnt(10)
  buffer_load_dwordx4 v[108:111], v234, s[32:35], 0 offen nt
  v_mov_b32_dpp v18, v116 row_newbcast:14 row_mask:0xf bank_mask:0xf
  v_cvt_f32_i32 v76, v76
  v_cvt_f32_i32 v77, v77
  v_cvt_f32_i32 v78, v78
  v_cvt_f32_i32 v79, v79
  v_pk_fma_f32 v[52:53], v[76:77], v[18:19], v[52:53] op_sel_hi:[1,0,1]
  v_pk_fma_f32 v[54:55], v[78:79], v[18:19], v[54:55] op_sel_hi:[1,0,1]
  s_cmpk_gt_i32 s69, 0x35
  s_cbranch_scc1 L_p79_4
  s_cmpk_gt_i32 s69, 0x21
  s_cbranch_scc1 L_p79_3
  s_cmpk_gt_i32 s69, 0xffd1
  s_cbranch_scc1 L_p79_0
  s_waitcnt vmcnt(6)
L_p79_0:
  s_waitcnt vmcnt(7)
L_p79_3:
  s_waitcnt vmcnt(10)
L_p79_4:
  s_waitcnt vmcnt(11)
  buffer_load_dwordx4 v[112:115], v235, s[32:35], 0 offen nt
  s_cbranch_vccnz L_vtail
  ds_read_b32 v4, v14 offset:20
  s_waitcnt vmcnt(8)
  s_add_u32 s44, s78, 0x03030303
  v_msad_u8 v9, s78, v40, 0
  v_msad_u8 v10, s44, v40, 0
  v_msad_u8 v9, s78, v41, v9
  v_msad_u8 v10, s44, v41, v10
  v_msad_u8 v9, s78, v42, v9
  v_msad_u8 v10, s44, v42, v10
  s_mov_b64 exec, 3
  global_load_dwordx2 v[26:27], v11, s[30:31] sc1
  global_store_byte v7, v8, s[30:31]
  global_load_dwordx3 v[40:42], v237, s[30:31] sc1
  v_sub_u32 v9, v9, v10
  v_add_u32 v8, 1, v8
  s_mov_b64 exec, -1
  v_readlane_b32 s66, v9, 0
  v_readlane_b32 s67, v9, 1
  s_add_u32 s78, s78, 0x01010101
  s_lshl1_add_u32 s69, s91, s95
  s_add_u32 s95, s66, s67
  s_add_u32 s69, s69, s95
  v_mov_b32_dpp v18, v116 row_newbcast:15 row_mask:0xf bank_mask:0xf
  v_cvt_f32_i32 v80, v80
  v_cvt_f32_i32 v81, v81
  v_cvt_f32_i32 v82, v82
  v_cvt_f32_i32 v83, v83
  v_pk_fma_f32 v[44:45], v[80:81], v[18:19], v[44:45] op_sel_hi:[1,0,1]
  v_pk_fma_f32 v[46:47], v[82:83], v[18:19], v[46:47] op_sel_hi:[1,0,1]
  s_cmpk_gt_i32 s69, 0x35
  s_cbranch_scc1 L_p80_4
  s_cmpk_gt_i32 s69, 0xfff1
  s_cbranch_scc1 L_p80_1
  s_waitcnt vmcnt(6)
L_p80_1:
  s_waitcnt vmcnt(9)
L_p80_4:
  s_waitcnt vmcnt(10)
  buffer_load_dwordx4 v[68:71], v212, s[36:39], 0 offen nt
  v_mov_b32_dpp v18, v117 row_newbcast:0 row_mask:0xf bank_mask:0xf
  v_cvt_f32_i32 v84, v84
  v_cvt_f32_i32 v85, v85
  v_cvt_f32_i32 v86, v86
  v_cvt_f32_i32 v87, v87
  v_pk_fma_f32 v[48:49], v[84:85], v[18:19], v[48:49] op_sel_hi:[1,0,1]
  v_pk_fma_f32 v[50:51], v[86:87], v[18:19], v[50:51] op_sel_hi:[1,0,1]
  s_cmpk_gt_i32 s69, 0x35
  s_cbranch_scc1 L_p81_4
  s_cmpk_gt_i32 s69, 0xf
  s_cbranch_scc1 L_p81_2
  s_waitcnt vmcnt(7)
L_p81_2:
  s_waitcnt vmcnt(10)
L_p81_4:
  s_waitcnt vmcnt(11)
  buffer_load_dwordx4 v[72:75], v213, s[36:39], 0 offen nt
  v_mov_b32_dpp v18, v117 row_newbcast:1 row_mask:0xf bank_mask:0xf
  v_cvt_f32_i32 v88, v88
  v_cvt_f32_i32 v89, v89
  v_cvt_f32_i32 v90, v90
  v_cvt_f32_i32 v91, v91
  v_pk_fma_f32 v[52:53], v[88:89], v[18:19], v[52:53] op_sel_hi:[1,0,1]
  v_pk_fma_f32 v[54:55], v[90:91], v[18:19], v[54:55] op_sel_hi:[1,0,1]
  s_cmpk_gt_i32 s69, 0x35
  s_cbranch_scc1 L_p82_4
  s_cmpk_gt_i32 s69, 0x21
  s_cbranch_scc1 L_p82_3
  s_cmpk_gt_i32 s69, 0xffd1
  s_cbranch_scc1 L_p82_0
  s_waitcnt vmcnt(7)
L_p82_0:
  s_waitcnt vmcnt(8)
L_p82_3:
  s_waitcnt vmcnt(11)
L_p82_4:
  s_waitcnt vmcnt(12)
  buffer_load_dwordx4 v[76:79], v214, s[36:39], 0 offen nt
L_an:
  s_waitcnt lgkmcnt(0)
  v_readfirstlane_b32 s46, v4
  s_cmp_ge_u32 s46, s47
  s_cbranch_scc1 L_an_ok
  s_cmp_eq_u32 s94, 0
  s_cbranch_scc1 L_an_ok
  s_sub_u32 s94, s94, 1
  ds_read_b32 v4, v14 offset:20
  s_branch L_an
L_an_ok:
  ds_read_b32 v116, v121 offset:37376
  ds_read_b32 v118, v122 offset:37376
  v_add_u32_e64 v9, s43, 16
  ds_write_b32 v14, v9 offset:24
  s_waitcnt vmcnt(9)
  s_add_u32 s44, s78, 0x03030303
  v_msad_u8 v9, s78, v36, 0
  v_msad_u8 v10, s44, v36, 0
  v_msad_u8 v9, s78, v37, v9
  v_msad_u8 v10, s44, v37, v10
  v_msad_u8 v9, s78, v38, v9
  v_msad_u8 v10, s44, v38, v10
  s_mov_b64 exec, 3
  global_store_byte v7, v8, s[30:31]
  global_load_dwordx3 v[36:38], v238, s[30:31] sc1
  v_sub_u32 v9, v9, v10
  v_add_u32 v8, 1, v8
  s_mov_b64 exec, -1
  v_readlane_b32 s66, v9, 0
  v_readlane_b32 s67, v9, 1
  s_add_u32 s78, s78, 0x01010101
  s_lshl1_add_u32 s69, s91, s95
  s_add_u32 s95, s66, s67
  s_add_u32 s69, s69, s95
  v_mov_b32_dpp v18, v117 row_newbcast:2 row_mask:0xf bank_mask:0xf
  v_cvt_f32_i32 v92, v92
  v_cvt_f32_i32 v93, v93
  v_cvt_f32_i32 v94, v94
  v_cvt_f32_i32 v95, v95
  v_pk_fma_f32 v[44:45], v[92:93], v[18:19], v[44:45] op_sel_hi:[1,0,1]
  v_pk_fma_f32 v[46:47], v[94:95], v[18:19], v[46:47] op_sel_hi:[1,0,1]
  s_cmpk_gt_i32 s69, 0x35
  s_cbranch_scc1 L_p83_4
  s_cmpk_gt_i32 s69, 0xfff1
  s_cbranch_scc1 L_p83_1
  s_waitcnt vmcnt(5)
L_p83_1:
  s_waitcnt vmcnt(9)
L_p83_4:
  s_waitcnt vmcnt(10)
  buffer_load_dwordx4 v[80:83], v215, s[36:39], 0 offen nt
  v_mov_b32_dpp v18, v117 row_newbcast:3 row_mask:0xf bank_mask:0xf
  v_cvt_f32_i32 v96, v96
  v_cvt_f32_i32 v97, v97
  v_cvt_f32_i32 v98, v98
  v_cvt_f32_i32 v99, v99
  v_pk_fma_f32 v[48:49], v[96:97], v[18:19], v[48:49] op_sel_hi:[1,0,1]
  v_pk_fma_f32 v[50:51], v[98:99], v[18:19], v[50:51] op_sel_hi:[1,0,1]
  s_cmpk_gt_i32 s69, 0x35
  s_cbranch_scc1 L_p84_4
  s_cmpk_gt_i32 s69, 0xf
  s_cbranch_scc1 L_p84_2
  s_waitcnt vmcnt(6)
L_p84_2:
  s_waitcnt vmcnt(10)
L_p84_4:
  s_waitcnt vmcnt(11)
  buffer_load_dwordx4 v[84:87], v216, s[36:39], 0 offen nt
  v_mov_b32_dpp v18, v117 row_newbcast:4 row_mask:0xf bank_mask:0xf
  v_cvt_f32_i32 v100, v100
  v_cvt_f32_i32 v101, v101
  v_cvt_f32_i32 v102, v102
  v_cvt_f32_i32 v103, v103
  v_pk_fma_f32 v[52:53], v[100:101], v[18:19], v[52:53] op_sel_hi:[1,0,1]
  v_pk_fma_f32 v[54:55], v[102:103], v[18:19], v[54:55] op_sel_hi:[1,0,1]
  s_cmpk_gt_i32 s69, 0x35
  s_cbranch_scc1 L_p85_4
  s_cmpk_gt_i32 s69, 0x21
  s_cbranch_scc1 L_p85_3
  s_cmpk_gt_i32 s69, 0xffd1
  s_cbranch_scc1 L_p85_0
  s_waitcnt vmcnt(6)
L_p85_0:
  s_waitcnt vmcnt(7)
L_p85_3:
  s_waitcnt vmcnt(11)
L_p85_4:
  s_waitcnt vmcnt(12)
  buffer_load_dwordx4 v[88:91], v217, s[36:39], 0 offen nt
  s_waitcnt vmcnt(8)
  s_add_u32 s44, s78, 0x03030303
  v_msad_u8 v9, s78, v40, 0
  v_msad_u8 v10, s44, v40, 0
  v_msad_u8 v9, s78, v41, v9
  v_msad_u8 v10, s44, v41, v10
  v_msad_u8 v9, s78, v42, v9
  v_msad_u8 v10, s44, v42, v10
  s_mov_b64 exec, 3
  global_store_byte v7, v8, s[30:31]
  global_load_dwordx3 v[40:42], v239, s[30:31] sc1
  v_sub_u32 v9, v9, v10
  v_add3_u32 v10, v26, v27, s58
  v_add_u32 v8, 1, v8
  s_mov_b64 exec, -1
  v_readlane_b32 s66, v9, 0
  v_readlane_b32 s67, v9, 1
  v_readlane_b32 s91, v10, 0
  s_add_u32 s78, s78, 0x01010101
  s_lshl1_add_u32 s69, s91, s95
  s_add_u32 s95, s66, s67
  s_add_u32 s69, s69, s95
  v_mov_b32_dpp v18, v117 row_newbcast:5 row_mask:0xf bank_mask:0xf
  v_cvt_f32_i32 v104, v104
  v_cvt_f32_i32 v105, v105
  v_cvt_f32_i32 v106, v106
  v_cvt_f32_i32 v107, v107
  v_pk_fma_f32 v[44:45], v[104:105], v[18:19], v[44:45] op_sel_hi:[1,0,1]
  v_pk_fma_f32 v[46:47], v[106:107], v[18:19], v[46:47] op_sel_hi:[1,0,1]
  s_cmpk_gt_i32 s69, 0x35
  s_cbranch_scc1 L_p86_4
  s_cmpk_gt_i32 s69, 0xfff1
  s_cbranch_scc1 L_p86_1
  s_waitcnt vmcnt(5)
L_p86_1:
  s_waitcnt vmcnt(8)
L_p86_4:
  s_waitcnt vmcnt(9)
  buffer_load_dwordx4 v[92:95], v218, s[36:39], 0 offen nt
  v_mov_b32_dpp v18, v117 row_newbcast:6 row_mask:0xf bank_mask:0xf
  v_cvt_f32_i32 v108, v108
  v_cvt_f32_i32 v109, v109
  v_cvt_f32_i32 v110, v110
  v_cvt_f32_i32 v111, v111
  v_pk_fma_f32 v[48:49], v[108:109], v[18:19], v[48:49] op_sel_hi:[1,0,1]
  v_pk_fma_f32 v[50:51], v[110:111], v[18:19], v[50:51] op_sel_hi:[1,0,1]
  s_cmpk_gt_i32 s69, 0x35
  s_cbranch_scc1 L_p87_4
  s_cmpk_gt_i32 s69, 0xf
  s_cbranch_scc1 L_p87_2
  s_waitcnt vmcnt(6)
L_p87_2:
  s_waitcnt vmcnt(9)
L_p87_4:
  s_waitcnt vmcnt(10)
  buffer_load_dwordx4 v[96:99], v219, s[36:39], 0 offen nt
  v_mov_b32_dpp v18, v117 row_newbcast:7 row_mask:0xf bank_mask:0xf
  v_cvt_f32_i32 v112, v112
  v_cvt_f32_i32 v113, v113
  v_cvt_f32_i32 v114, v114
  v_cvt_f32_i32 v115, v115
  v_pk_fma_f32 v[52:53], v[112:113], v[18:19], v[52:53] op_sel_hi:[1,0,1]
  v_pk_fma_f32 v[54:55], v[114:115], v[18:19], v[54:55] op_sel_hi:[1,0,1]
  s_cmpk_gt_i32 s69, 0x35
  s_cbranch_scc1 L_p88_4
  s_cmpk_gt_i32 s69, 0x21
  s_cbranch_scc1 L_p88_3
  s_cmpk_gt_i32 s69, 0xffd1
  s_cbranch_scc1 L_p88_0
  s_waitcnt vmcnt(6)
L_p88_0:
  s_waitcnt vmcnt(7)
L_p88_3:
  s_waitcnt vmcnt(10)
L_p88_4:
  s_waitcnt vmcnt(11)
  buffer_load_dwordx4 v[100:103], v220, s[36:39], 0 offen nt
  s_add_u32 s43, s43, 1
  v_permlane32_swap_b32 v44, v46
  v_permlane32_swap_b32 v45, v47
  v_permlane32_swap_b32 v48, v50
  v_permlane32_swap_b32 v49, v51
  v_permlane32_swap_b32 v52, v54
  v_permlane32_swap_b32 v53, v55
  v_add_f32 v44, v44, v50
  v_add_f32 v45, v45, v51
  v_add_f32 v48, v48, v54
  v_add_f32 v49, v49, v55
  v_add_f32 v52, v52, v46
  v_add_f32 v53, v53, v47
  s_add_u32 s44, s43, 16
  s_cmp_eq_u32 s43, 15
  s_cselect_b64 vcc, -1, 0
  v_mov_b32 v4, s44
  v_permlane16_swap_b32 v44, v45
  v_permlane16_swap_b32 v48, v49
  v_permlane16_swap_b32 v52, v53
  v_add_f32 v44, v44, v53
  v_add_f32 v48, v48, v45
  v_add_f32 v52, v52, v49
  s_waitcnt lgkmcnt(0)
  ds_write_b32 v3, v44 offset:0
  ds_write_b32 v3, v48 offset:256
  ds_write_b32 v3, v52 offset:512
  ds_write_b32 v6, v4 offset:0
  v_mov_b32 v117, v118
  v_add_u32 v3, 3072, v3
  s_mov_b64 s[32:33], s[36:37]
  s_add_u32 s45, s43, 1
  s_min_u32 s45, s45, 15
  s_lshl_b32 s68, s45, 2
  s_lshr_b64 s[64:65], s[92:93], s68
  s_and_b32 s68, s64, 15
  s_lshl_b32 s44, s68, 2
  s_lshr_b64 s[64:65], s[96:97], s44
  s_and_b32 s64, s64, 15
  s_lshl4_add_u32 s68, s68, s64
  s_mul_i32 s44, s68, 1572864
  s_add_u32 s36, s12, s44
  s_addc_u32 s37, s13, 0
  s_branch L_v
L_vtail:
  s_mul_i32 s44, s98, 1572864
  s_add_u32 s36, s12, s44
  s_addc_u32 s37, s13, 0
  s_cmp_eq_u32 s41, 0
  s_cselect_b32 s44, 43, -16
  s_cselect_b32 s44, s44, -43
  s_cselect_b32 s45, 0, -1
  s_mulk_i32 s44, 768
  s_add_u32 s36, s36, s44
  s_addc_u32 s37, s37, s45
  s_cmpk_gt_i32 s69, 0x11
  s_cselect_b32 s38, 0, s38
  s_mov_b32 exec_lo, 0x11111111
  s_mov_b32 exec_hi, 0x11111111
  buffer_load_dword v145, v233, s[36:39], 0 offen
  buffer_load_dword v146, v234, s[36:39], 0 offen
  buffer_load_dword v147, v235, s[36:39], 0 offen
  s_mov_b64 exec, -1
  s_waitcnt vmcnt(13)
  v_mov_b32_dpp v18, v116 row_newbcast:15 row_mask:0xf bank_mask:0xf
  v_cvt_f32_i32 v80, v80
  v_cvt_f32_i32 v81, v81
  v_cvt_f32_i32 v82, v82
  v_cvt_f32_i32 v83, v83
  v_pk_fma_f32 v[44:45], v[80:81], v[18:19], v[44:45] op_sel_hi:[1,0,1]
  v_pk_fma_f32 v[46:47], v[82:83], v[18:19], v[46:47] op_sel_hi:[1,0,1]
  s_waitcnt vmcnt(12)
  v_mov_b32_dpp v18, v117 row_newbcast:0 row_mask:0xf bank_mask:0xf
  v_cvt_f32_i32 v84, v84
  v_cvt_f32_i32 v85, v85
  v_cvt_f32_i32 v86, v86
  v_cvt_f32_i32 v87, v87
  v_pk_fma_f32 v[48:49], v[84:85], v[18:19], v[48:49] op_sel_hi:[1,0,1]
  v_pk_fma_f32 v[50:51], v[86:87], v[18:19], v[50:51] op_sel_hi:[1,0,1]
  s_waitcnt vmcnt(11)
  v_mov_b32_dpp v18, v117 row_newbcast:1 row_mask:0xf bank_mask:0xf
  v_cvt_f32_i32 v88, v88
  v_cvt_f32_i32 v89, v89
  v_cvt_f32_i32 v90, v90
  v_cvt_f32_i32 v91, v91
  v_pk_fma_f32 v[52:53], v[88:89], v[18:19], v[52:53] op_sel_hi:[1,0,1]
  v_pk_fma_f32 v[54:55], v[90:91], v[18:19], v[54:55] op_sel_hi:[1,0,1]
  s_waitcnt vmcnt(9)
  v_mov_b32_dpp v18, v117 row_newbcast:2 row_mask:0xf bank_mask:0xf
  v_cvt_f32_i32 v92, v92
  v_cvt_f32_i32 v93, v93
  v_cvt_f32_i32 v94, v94
  v_cvt_f32_i32 v95, v95
  v_pk_fma_f32 v[44:45], v[92:93], v[18:19], v[44:45] op_sel_hi:[1,0,1]
  v_pk_fma_f32 v[46:47], v[94:95], v[18:19], v[46:47] op_sel_hi:[1,0,1]
  s_waitcnt vmcnt(8)
  v_mov_b32_dpp v18, v117 row_newbcast:3 row_mask:0xf bank_mask:0xf
  v_cvt_f32_i32 v96, v96
  v_cvt_f32_i32 v97, v97
  v_cvt_f32_i32 v98, v98
  v_cvt_f32_i32 v99, v99
  v_pk_fma_f32 v[48:49], v[96:97], v[18:19], v[48:49] op_sel_hi:[1,0,1]
  v_pk_fma_f32 v[50:51], v[98:99], v[18:19], v[50:51] op_sel_hi:[1,0,1]
  s_waitcnt vmcnt(7)
  v_mov_b32_dpp v18, v117 row_newbcast:4 row_mask:0xf bank_mask:0xf
  v_cvt_f32_i32 v100, v100
  v_cvt_f32_i32 v101, v101
  v_cvt_f32_i32 v102, v102
  v_cvt_f32_i32 v103, v103
  v_pk_fma_f32 v[52:53], v[100:101], v[18:19], v[52:53] op_sel_hi:[1,0,1]
  v_pk_fma_f32 v[54:55], v[102:103], v[18:19], v[54:55] op_sel_hi:[1,0,1]
  s_waitcnt vmcnt(5)
  v_mov_b32_dpp v18, v117 row_newbcast:5 row_mask:0xf bank_mask:0xf
  v_cvt_f32_i32 v104, v104
  v_cvt_f32_i32 v105, v105
  v_cvt_f32_i32 v106, v106
  v_cvt_f32_i32 v107, v107
  v_pk_fma_f32 v[44:45], v[104:105], v[18:19], v[44:45] op_sel_hi:[1,0,1]
  v_pk_fma_f32 v[46:47], v[106:107], v[18:19], v[46:47] op_sel_hi:[1,0,1]
  s_waitcnt vmcnt(4)
  v_mov_b32_dpp v18, v117 row_newbcast:6 row_mask:0xf bank_mask:0xf
  v_cvt_f32_i32 v108, v108
  v_cvt_f32_i32 v109, v109
  v_cvt_f32_i32 v110, v110
  v_cvt_f32_i32 v111, v111
  v_pk_fma_f32 v[48:49], v[108:109], v[18:19], v[48:49] op_sel_hi:[1,0,1]
  v_pk_fma_f32 v[50:51], v[110:111], v[18:19], v[50:51] op_sel_hi:[1,0,1]
  v_permlane32_swap_b32 v44, v46
  v_permlane32_swap_b32 v45, v47
  v_permlane32_swap_b32 v48, v50
  v_permlane32_swap_b32 v49, v51
  v_add_f32 v44, v44, v50
  v_add_f32 v45, v45, v51
  s_waitcnt vmcnt(3)
  v_mov_b32_dpp v18, v117 row_newbcast:7 row_mask:0xf bank_mask:0xf
  v_cvt_f32_i32 v112, v112
  v_cvt_f32_i32 v113, v113
  v_cvt_f32_i32 v114, v114
  v_cvt_f32_i32 v115, v115
  v_pk_fma_f32 v[52:53], v[112:113], v[18:19], v[52:53] op_sel_hi:[1,0,1]
  v_pk_fma_f32 v[54:55], v[114:115], v[18:19], v[54:55] op_sel_hi:[1,0,1]
  v_permlane16_swap_b32 v44, v45
  s_nop 0
  v_permlane32_swap_b32 v52, v54
  v_permlane32_swap_b32 v53, v55
  v_add_f32 v48, v48, v54
  v_add_f32 v49, v49, v55
  v_add_f32 v52, v52, v46
  v_add_f32 v53, v53, v47
  v_permlane16_swap_b32 v48, v49
  v_add_f32 v48, v48, v45
  v_permlane16_swap_b32 v52, v53
  ds_write_b32 v3, v48 offset:256
  v_add_f32 v44, v44, v53
  v_add_f32 v52, v52, v49
  ds_write_b32 v3, v44 offset:0
  ds_write_b32 v3, v52 offset:512
  s_waitcnt lgkmcnt(0)
  s_barrier
  s_endpgm
L_helper:
  s_getreg_b32 s81, hwreg(HW_REG_HW_ID, 13, 2)
  s_getreg_b32 s79, hwreg(HW_REG_HW_ID, 8, 4)
  s_getreg_b32 s46, hwreg(HW_REG_XCC_ID, 0, 3)
  s_mul_i32 s46, s46, 4352
  s_add_u32 s46, s46, 8126464
  v_lshrrev_b32 v24, 1, v20
  v_lshl_add_u32 v42, v24, 8, s46
  v_and_b32 v24, 1, v20
  v_lshl_add_u32 v42, v24, 4, v42
  s_mov_b64 exec, 0x3ffff
  global_store_dwordx4 v42, v[48:51], s[30:31]
  s_mov_b64 exec, -1
  s_add_u32 s68, s42, 32
  s_mul_i32 s44, s68, 384
  s_add_u32 s32, s4, s44
  s_addc_u32 s33, s5, 0
  global_load_dwordx2 v[68:69], v26, s[32:33]
  global_load_dwordx2 v[70:71], v27, s[32:33]
  s_setprio 0
  s_getpc_b64 s[82:83]
L_pc89:
  s_lshl_b32 s44, s2, 6
  s_add_u32 s44, s44, L_order-L_pc89
  s_add_u32 s82, s82, s44
  s_addc_u32 s83, s83, 0
  s_load_dwordx2 s[92:93], s[82:83], 0
  s_load_dwordx2 s[96:97], s[82:83], 8
  s_mov_b32 s94, 4000000
  s_and_b32 s41, s2, 7
  s_lshl_b32 s41, s41, 1
  s_bitcmp1_b32 s2, 3
  s_addc_u32 s41, s41, 0
  s_load_dword s3, s[82:83], 24
  s_load_dwordx2 s[98:99], s[82:83], 16
  s_waitcnt vmcnt(0)
  ds_write_b32 v14, v38 offset:24
  s_waitcnt lgkmcnt(0)
  v_min_u32 v22, 2, v20
  v_lshlrev_b32 v23, 3, v22
  v_bfe_u32 v23, s99, v23, 8
  v_mul_u32_u24 v36, 4352, v23
  v_add_u32 v36, 7340032, v36
  v_and_b32 v23, 15, v23
  v_lshlrev_b32 v37, 4, v23
  v_lshl_add_u32 v22, v22, 4, s42
  v_mul_u32_u24 v45, 4352, v22
  v_add_u32 v45, 7340032, v45
  s_and_b32 s45, s81, 2
  s_lshl_b32 s44, s45, 9
  s_add_u32 s44, s44, s46
  v_add_u32 v44, s44, v20
  s_lshl_b32 s45, s45, 1
  s_add_u32 s46, s46, s45
  s_add_u32 s46, s46, 2048
  v_mov_b32 v43, s46
  v_mul_u32_u24 v39, 384, v20
  v_add_u32 v39, 7864320, v39
  v_mov_b32 v40, 0
  s_mov_b32 s47, 0
  s_mov_b32 s90, 0
  s_mov_b32 s80, 0
  v_add_u32 v33, 0, v20
  s_and_b32 s44, s41, 1
  v_add_u32 v23, s44, v33
  v_cmp_le_u32 vcc, 43, v23
  s_add_u32 s45, s44, 42
  v_mov_b32 v24, s45
  v_cndmask_b32 v24, 0, v24, vcc
  v_cmp_le_u32 vcc, 86, v23
  v_add_u32 v22, v33, v24
  s_sub_u32 s45, 43, s44
  v_mov_b32 v24, s45
  v_cndmask_b32 v24, 0, v24, vcc
  s_mul_i32 s44, s44, 43
  s_lshr_b32 s45, s41, 1
  s_lshl_b32 s45, s45, 8
  s_add_u32 s44, s44, s45
  v_add3_u32 v22, v22, v24, s44
  v_and_b32 v33, 255, v22
  v_lshlrev_b32 v33, 1, v33
  v_add_u32 v34, 64, v20
  s_and_b32 s44, s41, 1
  v_add_u32 v23, s44, v34
  v_cmp_le_u32 vcc, 43, v23
  s_add_u32 s45, s44, 42
  v_mov_b32 v24, s45
  v_cndmask_b32 v24, 0, v24, vcc
  v_cmp_le_u32 vcc, 86, v23
  v_add_u32 v22, v34, v24
  s_sub_u32 s45, 43, s44
  v_mov_b32 v24, s45
  v_cndmask_b32 v24, 0, v24, vcc
  s_mul_i32 s44, s44, 43
  s_lshr_b32 s45, s41, 1
  s_lshl_b32 s45, s45, 8
  s_add_u32 s44, s44, s45
  v_add3_u32 v22, v22, v24, s44
  v_and_b32 v34, 255, v22
  v_lshlrev_b32 v34, 1, v34
  v_lshlrev_b32 v46, 2, v20
  v_mul_u32_u24 v199, 12, v20
  v_add_u32 v199, 45568, v199
  s_mov_b32 s101, 0
  v_mov_b32 v47, 118912
  v_mov_b32 v51, -1
  v_mov_b32 v60, 0
  v_mov_b32 v61, 0
  v_mov_b32 v62, 0
  v_mov_b32 v63, 0
  v_mov_b32 v64, 0
  v_mov_b32 v65, 0
  v_mov_b32 v66, 0
  v_mov_b32 v67, 0
  s_and_b32 s45, s2, 7
  s_lshl_b32 s45, s45, 9
  v_and_b32 v22, 31, v20
  v_lshl_add_u32 v22, v22, 4, s45
  v_lshrrev_b32 v23, 5, v20
  v_lshl_add_u32 v22, v23, 16, v22
  v_lshlrev_b32 v23, 2, v23
  s_lshr_b32 s44, s96, 0
  v_bfe_u32 v24, s44, v23, 4
  v_lshl_add_u32 v188, v24, 12, v22
  v_add_u32 v22, 0x20000, v22
  s_lshr_b32 s44, s96, 8
  v_bfe_u32 v24, s44, v23, 4
  v_lshl_add_u32 v189, v24, 12, v22
  v_add_u32 v22, 0x20000, v22
  s_lshr_b32 s44, s96, 16
  v_bfe_u32 v24, s44, v23, 4
  v_lshl_add_u32 v190, v24, 12, v22
  v_add_u32 v22, 0x20000, v22
  s_lshr_b32 s44, s96, 24
  v_bfe_u32 v24, s44, v23, 4
  v_lshl_add_u32 v191, v24, 12, v22
  v_add_u32 v22, 0x20000, v22
  s_lshr_b32 s44, s97, 0
  v_bfe_u32 v24, s44, v23, 4
  v_lshl_add_u32 v192, v24, 12, v22
  v_add_u32 v22, 0x20000, v22
  s_lshr_b32 s44, s97, 8
  v_bfe_u32 v24, s44, v23, 4
  v_lshl_add_u32 v193, v24, 12, v22
  v_add_u32 v22, 0x20000, v22
  s_lshr_b32 s44, s97, 16
  v_bfe_u32 v24, s44, v23, 4
  v_lshl_add_u32 v194, v24, 12, v22
  v_add_u32 v22, 0x20000, v22
  s_lshr_b32 s44, s97, 24
  v_bfe_u32 v24, s44, v23, 4
  v_lshl_add_u32 v195, v24, 12, v22
  s_mov_b32 s69, 0
  s_movk_i32 m0, 4608
  s_branch L_hq_nl
L_hk:
  s_sub_u32 s47, s43, 1
L_hsw:
  ds_read_b128 v[104:107], v14 offset:0
  s_waitcnt lgkmcnt(0)
  v_min_u32 v104, v104, v105
  v_min3_u32 v104, v104, v106, v107
  s_nop 0
  v_readfirstlane_b32 s46, v104
  s_cmp_ge_u32 s46, s47
  s_cbranch_scc1 L_hsw_ok
  s_cmp_eq_u32 s94, 0
  s_cbranch_scc1 L_hsw_ok
  s_sub_u32 s94, s94, 1
  s_sleep 1
  s_branch L_hsw
L_hsw_ok:
  s_bitcmp1_b32 s80, s47
  s_cbranch_scc0 L_fas
  s_mul_i32 s44, s47, 384
  s_add_u32 s44, s44, 7864320
  s_movk_i32 s78, 1
  s_atomic_add s78, s[30:31], s44 glc
L_fas:
  s_cmp_lt_u32 s43, 5
  s_cbranch_scc1 L_hs_done
  s_add_u32 s68, s69, 2
  s_min_u32 s68, s68, s47
L_hs:
  ds_read_u16_d16_hi v60, v33 offset:4608
  ds_read_u16_d16_hi v61, v34 offset:4608
  ds_read_u16_d16_hi v62, v33 offset:12800
  ds_read_u16_d16_hi v63, v34 offset:12800
  ds_read_u16_d16_hi v64, v33 offset:20992
  ds_read_u16_d16_hi v65, v34 offset:20992
  ds_read_u16_d16_hi v66, v33 offset:29184
  ds_read_u16_d16_hi v67, v34 offset:29184
  v_add_u32 v200, s101, v199
  v_add_u32 v201, 1536, v200
  s_addk_i32 s101, 3072
  s_cmpk_eq_u32 s101, 18432
  s_cselect_b32 s101, 0, s101
  s_add_u32 s69, s69, 1
  s_waitcnt lgkmcnt(4)
  ds_read2_b32 v[76:77], v200 offset0:0 offset1:1
  ds_read_b32 v72, v200 offset:8
  ds_read2_b32 v[78:79], v200 offset0:192 offset1:193
  ds_read_b32 v73, v200 offset:776
  ds_read2_b32 v[80:81], v201 offset0:0 offset1:1
  ds_read_b32 v74, v201 offset:8
  ds_read2_b32 v[82:83], v201 offset0:192 offset1:193
  ds_read_b32 v75, v201 offset:776
  s_waitcnt lgkmcnt(0)
  v_add_f32 v76, v76, v77
  v_add_f32 v78, v78, v79
  v_add_f32 v80, v80, v81
  v_add_f32 v82, v82, v83
  v_add_f32 v72, v72, v76
  v_add_f32 v73, v73, v78
  v_add_f32 v74, v74, v80
  v_add_f32 v75, v75, v82
  v_fma_f32 v72, -v62, v74, v72
  v_fma_f32 v73, -v63, v75, v73
  v_mul_f32 v74, s67, v60
  v_mul_f32 v75, s67, v61
  v_mul_f32 v72, v72, v74
  v_mul_f32 v73, v73, v75
  v_max_f32 v48, v72, v73
  s_nop 1
  v_max_f32_dpp v48, v48, v48 row_ror:8 row_mask:0xf bank_mask:0xf
  s_nop 1
  v_max_f32_dpp v48, v48, v48 row_ror:4 row_mask:0xf bank_mask:0xf
  s_nop 1
  v_max_f32_dpp v48, v48, v48 row_ror:2 row_mask:0xf bank_mask:0xf
  s_nop 1
  v_max_f32_dpp v48, v48, v48 row_ror:1 row_mask:0xf bank_mask:0xf
  v_mov_b32 v22, v48
  s_nop 1
  v_permlane16_swap_b32 v48, v22
  v_max_f32 v48, v48, v22
  v_mov_b32 v22, v48
  s_nop 1
  v_permlane32_swap_b32 v48, v22
  v_max_f32 v48, v48, v22
  v_sub_f32 v72, v72, v48
  v_sub_f32 v73, v73, v48
  v_exp_f32 v72, v72
  v_exp_f32 v73, v73
  s_nop 0
  v_add_f32 v49, v72, v73
  v_mul_f32 v72, v72, v64
  v_mul_f32 v73, v73, v65
  v_mul_f32 v50, v72, v66
  v_fmac_f32 v50, v73, v67
  ds_write_b32 v46, v72 offset:37376
  ds_write_b32 v46, v73 offset:37632
  s_nop 1
  v_add_f32_dpp v49, v49, v49 row_ror:8 row_mask:0xf bank_mask:0xf
  s_nop 1
  v_add_f32_dpp v49, v49, v49 row_ror:4 row_mask:0xf bank_mask:0xf
  s_nop 1
  v_add_f32_dpp v49, v49, v49 row_ror:2 row_mask:0xf bank_mask:0xf
  s_nop 1
  v_add_f32_dpp v49, v49, v49 row_ror:1 row_mask:0xf bank_mask:0xf
  v_mov_b32 v22, v49
  s_nop 1
  v_permlane16_swap_b32 v49, v22
  v_add_f32 v49, v49, v22
  v_mov_b32 v22, v49
  s_nop 1
  v_permlane32_swap_b32 v49, v22
  v_add_f32 v49, v49, v22
  s_nop 1
  v_add_f32_dpp v50, v50, v50 row_ror:8 row_mask:0xf bank_mask:0xf
  s_nop 1
  v_add_f32_dpp v50, v50, v50 row_ror:4 row_mask:0xf bank_mask:0xf
  s_nop 1
  v_add_f32_dpp v50, v50, v50 row_ror:2 row_mask:0xf bank_mask:0xf
  s_nop 1
  v_add_f32_dpp v50, v50, v50 row_ror:1 row_mask:0xf bank_mask:0xf
  v_mov_b32 v22, v50
  s_nop 1
  v_permlane16_swap_b32 v50, v22
  v_add_f32 v50, v50, v22
  v_mov_b32 v22, v50
  s_nop 1
  v_permlane32_swap_b32 v50, v22
  v_add_f32 v50, v50, v22
  v_mov_b32 v22, s69
  ds_write_b128 v47, v[48:51]
  ds_write_b32 v14, v22 offset:20
  v_add_u32 v46, 512, v46
  v_add_u32 v47, 16, v47
  v_add_u32 v33, 512, v33
  v_add_u32 v34, 512, v34
  s_cmp_lt_u32 s69, s68
  s_cbranch_scc1 L_hs
L_hs_done:
  s_bitcmp1_b32 s80, s47
  s_cbranch_scc0 L_fbs
  s_waitcnt vmcnt(0) lgkmcnt(0)
  v_readlane_b32 s46, v40, s47
  s_sub_u32 s78, s78, s46
  s_bfe_u32 s46, s78, 0x80000
  s_min_u32 s46, s46, 15
  s_lshl_b32 s46, s46, 1
  s_sub_u32 s46, s46, 15
  s_cmp_gt_i32 s46, 0
  s_cselect_b32 s44, 2, 10
  s_mul_i32 s46, s46, s44
  s_add_u32 s46, s46, 8
  s_ashr_i32 s46, s46, 4
  v_mov_b32 v42, s46
  s_mov_b64 exec, 1
  global_store_dword v43, v42, s[30:31]
  s_mov_b64 exec, -1
L_fbs:
  s_cmp_eq_u32 s47, 1
  s_cbranch_scc0 L_el
  s_bitcmp0_b32 s81, 0
  s_cbranch_scc0 L_el
  s_mov_b64 exec, 0xffff
  global_load_ubyte v42, v44, s[30:31] sc1
  s_waitcnt vmcnt(0)
  v_cmp_ne_u32 s[64:65], 0, v42
  s_lshr_b32 s44, s64, s79
  s_bcnt1_i32_b32 s44, s44
  s_sub_u32 s45, s44, 1
  s_cmp_lt_u32 s45, 7
  s_cbranch_scc0 L_el
  s_lshl_b32 s80, 0x10204081, s45
  s_and_b32 s80, s80, 0x7d555554
  s_mov_b32 exec_lo, s80
  global_load_dword v40, v39, s[30:31] sc1
L_el:
  s_mov_b64 exec, -1
L_hq:
  s_add_u32 s43, s43, 1
  s_cmp_gt_u32 s43, 16
  s_cbranch_scc1 L_hq_nl
  s_waitcnt vmcnt(0)
  v_lshlrev_b32 v76, 16, v68
  v_and_b32 v77, s66, v68
  v_lshlrev_b32 v78, 16, v69
  v_and_b32 v79, s66, v69
  v_lshlrev_b32 v80, 16, v70
  v_and_b32 v81, s66, v70
  v_lshlrev_b32 v82, 16, v71
  v_and_b32 v83, s66, v71
  v_mul_f32 v76, v76, v52
  v_mul_f32 v77, v77, v53
  v_mul_f32 v78, v78, v54
  v_mul_f32 v79, v79, v55
  v_mul_f32 v80, v80, v56
  v_mul_f32 v81, v81, v57
  v_mul_f32 v82, v82, v58
  v_mul_f32 v83, v83, v59
  v_cvt_pk_bf16_f32 v84, v76, v80
  v_cvt_pk_bf16_f32 v85, v77, v81
  v_cvt_pk_bf16_f32 v86, v78, v82
  v_cvt_pk_bf16_f32 v87, v79, v83
  v_lshlrev_b32 v76, 16, v84
  v_and_b32 v80, s66, v84
  v_lshlrev_b32 v77, 16, v85
  v_and_b32 v81, s66, v85
  v_lshlrev_b32 v78, 16, v86
  v_and_b32 v82, s66, v86
  v_lshlrev_b32 v79, 16, v87
  v_and_b32 v83, s66, v87
  v_fma_f32 v76, v80, v30, v76
  v_fma_f32 v77, v81, v30, v77
  v_fma_f32 v78, v82, v30, v78
  v_fma_f32 v79, v83, v30, v79
  v_cvt_pk_bf16_f32 v84, v76, v77
  v_cvt_pk_bf16_f32 v85, v78, v79
  v_xor_b32 v86, v31, v84
  v_xor_b32 v87, v31, v85
  v_mov_b32 v22, s43
  ds_write_b16 v28, v84 offset:512
  ds_write_b16_d16_hi v28, v84 offset:516
  ds_write_b16 v28, v85 offset:520
  ds_write_b16_d16_hi v28, v85 offset:524
  ds_write_b16 v29, v86 offset:514
  ds_write_b16_d16_hi v29, v86 offset:518
  ds_write_b16 v29, v87 offset:522
  ds_write_b16_d16_hi v29, v87 offset:526
  ds_write_b32 v14, v22 offset:16
  v_add_u32 v28, 1024, v28
  v_add_u32 v29, 1024, v29
  v_and_b32 v28, 0xfff, v28
  v_and_b32 v29, 0xfff, v29
  s_cmp_eq_u32 s43, 16
  s_cbranch_scc1 L_hq_nl
  s_lshl_b32 s44, s43, 2
  s_lshr_b64 s[64:65], s[96:97], s44
  s_and_b32 s64, s64, 15
  s_lshl4_add_u32 s68, s43, s64
  s_mul_i32 s44, s68, 384
  s_add_u32 s32, s4, s44
  s_addc_u32 s33, s5, 0
  global_load_dwordx2 v[68:69], v26, s[32:33]
  global_load_dwordx2 v[70:71], v27, s[32:33]
L_hq_nl:
  s_sub_u32 s44, s43, 4
  s_cmp_lt_u32 s44, 2
  s_cbranch_scc0 L_sc_done
  global_load_lds_dwordx4 v188, s[8:9]
  s_addk_i32 m0, 1024
  s_waitcnt vmcnt(3)
  global_load_lds_dwordx4 v189, s[8:9]
  s_addk_i32 m0, 1024
  s_waitcnt vmcnt(3)
  global_load_lds_dwordx4 v190, s[8:9]
  s_addk_i32 m0, 1024
  s_waitcnt vmcnt(3)
  global_load_lds_dwordx4 v191, s[8:9]
  s_addk_i32 m0, 1024
  s_waitcnt vmcnt(3)
  global_load_lds_dwordx4 v192, s[8:9]
  s_addk_i32 m0, 1024
  s_waitcnt vmcnt(3)
  global_load_lds_dwordx4 v193, s[8:9]
  s_addk_i32 m0, 1024
  s_waitcnt vmcnt(3)
  global_load_lds_dwordx4 v194, s[8:9]
  s_addk_i32 m0, 1024
  s_waitcnt vmcnt(3)
  global_load_lds_dwordx4 v195, s[8:9]
  s_addk_i32 m0, 1024
  s_mov_b64 s[8:9], s[10:11]
  s_mov_b64 s[10:11], s[14:15]
  s_mov_b64 s[14:15], s[16:17]
  s_waitcnt vmcnt(3)
  global_load_lds_dwordx4 v188, s[8:9]
  s_addk_i32 m0, 1024
  s_waitcnt vmcnt(3)
  global_load_lds_dwordx4 v189, s[8:9]
  s_addk_i32 m0, 1024
  s_waitcnt vmcnt(3)
  global_load_lds_dwordx4 v190, s[8:9]
  s_addk_i32 m0, 1024
  s_waitcnt vmcnt(3)
  global_load_lds_dwordx4 v191, s[8:9]
  s_addk_i32 m0, 1024
  s_waitcnt vmcnt(3)
  global_load_lds_dwordx4 v192, s[8:9]
  s_addk_i32 m0, 1024
  s_waitcnt vmcnt(3)
  global_load_lds_dwordx4 v193, s[8:9]
  s_addk_i32 m0, 1024
  s_waitcnt vmcnt(3)
  global_load_lds_dwordx4 v194, s[8:9]
  s_addk_i32 m0, 1024
  s_waitcnt vmcnt(3)
  global_load_lds_dwordx4 v195, s[8:9]
  s_addk_i32 m0, 1024
  s_mov_b64 s[8:9], s[10:11]
  s_mov_b64 s[10:11], s[14:15]
  s_mov_b64 s[14:15], s[16:17]
  s_cmp_eq_u32 s43, 5
  s_cbranch_scc0 L_sc_done
  s_waitcnt vmcnt(0)
L_sc_done:
  s_cmp_eq_u32 s43, 16
  s_cbranch_scc0 L_hq_skip
  s_cmp_eq_u32 s3, 0
  s_cbranch_scc0 L_hq_skip
  s_mov_b64 exec, 7
  global_store_dword v45, v14, s[30:31] sc1
  s_waitcnt vmcnt(0)
  s_mov_b64 exec, 1
  global_store_dword v37, v38, s[28:29] sc1
  s_mov_b64 exec, -1
L_hq_skip:
  s_waitcnt lgkmcnt(0)
  s_cmp_lt_u32 s43, 18
  s_cbranch_scc1 L_hk
  v_and_b32 v24, 15, v20
  v_lshlrev_b32 v24, 1, v24
  global_load_ushort v25, v24, s[82:83] offset:32
  s_mov_b32 s43, 0
  v_min_u32 v28, 23, v20
  v_lshlrev_b32 v28, 4, v28
  v_lshlrev_b32 v22, 1, v28
  v_subrev_u32 v196, 256, v22
  v_add_u32 v197, 512, v22
  v_min_u32 v197, v196, v197
  v_add_u32 v197, 64000, v197
  v_subrev_u32 v196, 512, v22
  v_add_u32 v198, 256, v22
  v_min_u32 v198, v196, v198
  v_add_u32 v198, 64000, v198
  v_add_u32 v196, 64000, v22
  v_add_u32 v28, 113152, v28
  v_lshlrev_b32 v32, 4, v20
  v_add_u32 v30, 113152, v32
  v_cmp_gt_u32 vcc, 24, v20
  v_lshrrev_b32 v21, 1, v35
  s_mul_i32 s44, s98, 384
  s_add_u32 s26, s26, s44
  s_addc_u32 s27, s27, 0
  v_mov_b32 v31, s2
  v_mul_u32_u24 v31, 6144, v31
  v_add_u32 v31, 8388608, v31
  v_add_u32 v23, 0, v32
  v_add_u32 v188, v23, v31
  v_add_u32 v23, 1024, v32
  v_add_u32 v189, v23, v31
  v_add_u32 v23, 2048, v32
  v_add_u32 v190, v23, v31
  v_add_u32 v23, 3072, v32
  v_add_u32 v191, v23, v31
  v_add_u32 v23, 4096, v32
  v_add_u32 v192, v23, v31
  v_add_u32 v23, 5120, v32
  v_add_u32 v193, v23, v31
  s_mov_b32 s45, 14
  s_lshl_b32 s68, s45, 2
  s_lshr_b64 s[64:65], s[92:93], s68
  s_and_b32 s68, s64, 15
  v_lshl_add_u32 v23, s68, 4, v32
  v_cndmask_b32 v23, v23, v32, vcc
  v_add_u32 v23, 5376, v23
  v_add_u32 v168, v23, v31
  s_waitcnt vmcnt(0)
  v_lshrrev_b32 v31, 4, v25
  v_mul_u32_u24 v31, 6144, v31
  v_add_u32 v31, 8388608, v31
  v_and_b32 v25, 15, v25
  v_mul_u32_u24 v25, 384, v25
  s_lshl4_add_u32 s44, s3, 5760
  v_mov_b32 v23, s44
  v_add_u32 v187, v23, v31
  v_add_u32_dpp v23, v25, v21 row_newbcast:0 row_mask:0xf bank_mask:0xf
  v_mov_b32_dpp v29, v31 row_newbcast:0 row_mask:0xf bank_mask:0xf
  v_add_u32 v172, v23, v29
  v_add_u32_dpp v23, v25, v21 row_newbcast:1 row_mask:0xf bank_mask:0xf
  v_mov_b32_dpp v29, v31 row_newbcast:1 row_mask:0xf bank_mask:0xf
  v_add_u32 v173, v23, v29
  v_add_u32_dpp v23, v25, v21 row_newbcast:2 row_mask:0xf bank_mask:0xf
  v_mov_b32_dpp v29, v31 row_newbcast:2 row_mask:0xf bank_mask:0xf
  v_add_u32 v174, v23, v29
  v_add_u32_dpp v23, v25, v21 row_newbcast:3 row_mask:0xf bank_mask:0xf
  v_mov_b32_dpp v29, v31 row_newbcast:3 row_mask:0xf bank_mask:0xf
  v_add_u32 v175, v23, v29
  v_add_u32_dpp v23, v25, v21 row_newbcast:4 row_mask:0xf bank_mask:0xf
  v_mov_b32_dpp v29, v31 row_newbcast:4 row_mask:0xf bank_mask:0xf
  v_add_u32 v176, v23, v29
  v_add_u32_dpp v23, v25, v21 row_newbcast:5 row_mask:0xf bank_mask:0xf
  v_mov_b32_dpp v29, v31 row_newbcast:5 row_mask:0xf bank_mask:0xf
  v_add_u32 v177, v23, v29
  v_add_u32_dpp v23, v25, v21 row_newbcast:6 row_mask:0xf bank_mask:0xf
  v_mov_b32_dpp v29, v31 row_newbcast:6 row_mask:0xf bank_mask:0xf
  v_add_u32 v178, v23, v29
  v_add_u32_dpp v23, v25, v21 row_newbcast:7 row_mask:0xf bank_mask:0xf
  v_mov_b32_dpp v29, v31 row_newbcast:7 row_mask:0xf bank_mask:0xf
  v_add_u32 v179, v23, v29
  v_add_u32_dpp v23, v25, v21 row_newbcast:8 row_mask:0xf bank_mask:0xf
  v_mov_b32_dpp v29, v31 row_newbcast:8 row_mask:0xf bank_mask:0xf
  v_add_u32 v180, v23, v29
  v_add_u32_dpp v23, v25, v21 row_newbcast:9 row_mask:0xf bank_mask:0xf
  v_mov_b32_dpp v29, v31 row_newbcast:9 row_mask:0xf bank_mask:0xf
  v_add_u32 v181, v23, v29
  v_add_u32_dpp v23, v25, v21 row_newbcast:10 row_mask:0xf bank_mask:0xf
  v_mov_b32_dpp v29, v31 row_newbcast:10 row_mask:0xf bank_mask:0xf
  v_add_u32 v182, v23, v29
  v_add_u32_dpp v23, v25, v21 row_newbcast:11 row_mask:0xf bank_mask:0xf
  v_mov_b32_dpp v29, v31 row_newbcast:11 row_mask:0xf bank_mask:0xf
  v_add_u32 v183, v23, v29
  v_add_u32_dpp v23, v25, v21 row_newbcast:12 row_mask:0xf bank_mask:0xf
  v_mov_b32_dpp v29, v31 row_newbcast:12 row_mask:0xf bank_mask:0xf
  v_add_u32 v184, v23, v29
  v_add_u32_dpp v23, v25, v21 row_newbcast:13 row_mask:0xf bank_mask:0xf
  v_mov_b32_dpp v29, v31 row_newbcast:13 row_mask:0xf bank_mask:0xf
  v_add_u32 v185, v23, v29
  v_add_u32_dpp v23, v25, v21 row_newbcast:14 row_mask:0xf bank_mask:0xf
  v_mov_b32_dpp v29, v31 row_newbcast:14 row_mask:0xf bank_mask:0xf
  v_add_u32 v186, v23, v29
  v_mov_b32 v108, -1
  v_mov_b32 v109, -1
  v_mov_b32 v110, -1
  v_mov_b32 v111, -1
  s_lshl4_add_u32 s44, s3, 118912
  v_mov_b32 v23, s44
  ds_write_b128 v28, v[108:111] offset:5376
  ds_write_b32 v23, v38 offset:12
L_hp:
  s_min_u32 s44, s3, 13
  s_cmp_eq_u32 s44, s43
  s_cbranch_scc0 L_hc_ok
L_hc:
  global_load_dword v104, v37, s[28:29] sc1
  s_waitcnt vmcnt(0)
  v_cmp_ne_u32 s[64:65], 1, v104
  s_cmp_eq_u64 s[64:65], 0
  s_cbranch_scc1 L_hc_ok
  s_cmp_eq_u32 s94, 0
  s_cbranch_scc1 L_hc_ok
  s_sub_u32 s94, s94, 1
  s_sleep 64
  s_branch L_hc
L_hc_ok:
  s_lshl_b32 s68, s43, 2
  s_lshr_b64 s[64:65], s[92:93], s68
  s_and_b32 s68, s64, 15
  s_lshl4_add_u32 s44, s68, 118912
  v_mov_b32 v23, s44
  s_cmp_eq_u32 s43, 14
  s_cbranch_scc0 L_hp_mid
  ds_read_b128 v[144:147], v30 offset:0
  ds_read_b128 v[148:151], v30 offset:1024
  ds_read_b128 v[152:155], v30 offset:2048
  ds_read_b128 v[156:159], v30 offset:3072
  ds_read_b128 v[160:163], v30 offset:4096
  ds_read_b128 v[164:167], v30 offset:5120
L_hm:
  ds_read_b32 v104, v14 offset:24
  s_waitcnt lgkmcnt(0)
  v_readfirstlane_b32 s46, v104
  s_cmp_ge_u32 s46, 30
  s_cbranch_scc1 L_hm_ok
  s_cmp_eq_u32 s94, 0
  s_cbranch_scc1 L_hm_ok
  s_sub_u32 s94, s94, 1
  s_sleep 1
  s_branch L_hm
L_hm_ok:
  global_store_dwordx4 v188, v[144:147], s[30:31] sc1
  global_store_dwordx4 v189, v[148:151], s[30:31] sc1
  global_store_dwordx4 v190, v[152:155], s[30:31] sc1
  global_store_dwordx4 v191, v[156:159], s[30:31] sc1
  global_store_dwordx4 v192, v[160:163], s[30:31] sc1
  s_mov_b32 exec_hi, 0xffffff
  global_store_dwordx4 v193, v[164:167], s[30:31] sc1
  s_mov_b64 exec, 7
  s_waitcnt vmcnt(0)
  global_atomic_add v36, v38, s[30:31] sc1
  s_mov_b64 exec, -1
L_hp_mid:
  s_add_u32 s43, s43, 1
  s_add_u32 s47, s43, 16
L_hpw:
  ds_read_b128 v[104:107], v14 offset:0
  s_waitcnt lgkmcnt(0)
  v_min_u32 v104, v104, v105
  v_min3_u32 v104, v104, v106, v107
  s_nop 0
  v_readfirstlane_b32 s46, v104
  s_cmp_ge_u32 s46, s47
  s_cbranch_scc1 L_hpw_ok
  s_cmp_eq_u32 s94, 0
  s_cbranch_scc1 L_hpw_ok
  s_sub_u32 s94, s94, 1
  s_sleep 1
  s_branch L_hpw
L_hpw_ok:
  s_bitcmp1_b32 s80, s47
  s_cbranch_scc0 L_fap
  s_mul_i32 s44, s47, 384
  s_add_u32 s44, s44, 7864320
  s_movk_i32 s78, 1
  s_atomic_add s78, s[30:31], s44 glc
L_fap:
  ds_read_b128 v[72:75], v196 offset:0
  ds_read_b128 v[76:79], v196 offset:16
  ds_read_b128 v[80:83], v197 offset:768
  ds_read_b128 v[84:87], v197 offset:784
  ds_read_b128 v[88:91], v198 offset:1536
  ds_read_b128 v[92:95], v198 offset:1552
  ds_read_b128 v[96:99], v196 offset:2304
  ds_read_b128 v[100:103], v196 offset:2320
  ds_read_b128 v[48:51], v23
  s_waitcnt lgkmcnt(0)
  v_pk_add_f32 v[72:73], v[72:73], v[80:81]
  v_pk_add_f32 v[88:89], v[88:89], v[96:97]
  v_pk_add_f32 v[74:75], v[74:75], v[82:83]
  v_pk_add_f32 v[90:91], v[90:91], v[98:99]
  v_pk_add_f32 v[76:77], v[76:77], v[84:85]
  v_pk_add_f32 v[92:93], v[92:93], v[100:101]
  v_pk_add_f32 v[78:79], v[78:79], v[86:87]
  v_pk_add_f32 v[94:95], v[94:95], v[102:103]
  v_pk_add_f32 v[72:73], v[72:73], v[88:89]
  v_pk_add_f32 v[74:75], v[74:75], v[90:91]
  v_pk_add_f32 v[76:77], v[76:77], v[92:93]
  v_pk_add_f32 v[78:79], v[78:79], v[94:95]
  v_pk_add_f32 v[72:73], v[72:73], v[50:51] op_sel_hi:[1,0] neg_lo:[0,1] neg_hi:[0,1]
  v_pk_add_f32 v[74:75], v[74:75], v[50:51] op_sel_hi:[1,0] neg_lo:[0,1] neg_hi:[0,1]
  v_pk_add_f32 v[76:77], v[76:77], v[50:51] op_sel_hi:[1,0] neg_lo:[0,1] neg_hi:[0,1]
  v_pk_add_f32 v[78:79], v[78:79], v[50:51] op_sel_hi:[1,0] neg_lo:[0,1] neg_hi:[0,1]
  v_max3_f32 v25, |v72|, |v73|, |v74|
  v_max3_f32 v25, v25, |v75|, |v76|
  v_max3_f32 v25, v25, |v77|, |v78|
  v_max_f32_e64 v25, v25, |v79|
  s_nop 1
  v_max_f32_dpp v25, v25, v25 row_ror:8 row_mask:0xf bank_mask:0xf
  s_nop 1
  v_max_f32_dpp v25, v25, v25 row_ror:4 row_mask:0xf bank_mask:0xf
  s_nop 1
  v_max_f32_dpp v25, v25, v25 row_ror:2 row_mask:0xf bank_mask:0xf
  s_nop 1
  v_max_f32_dpp v25, v25, v25 row_ror:1 row_mask:0xf bank_mask:0xf
  v_mov_b32 v29, v25
  s_nop 1
  v_permlane16_swap_b32 v25, v29
  v_max_f32 v25, v25, v29
  v_mov_b32 v29, v25
  s_nop 1
  v_permlane32_swap_b32 v25, v29
  v_max_f32 v25, v25, v29
  v_frexp_exp_i32_f32 v25, v25
  v_sub_u32 v29, 14, v25
  v_add_u32 v51, 242, v25
  v_ldexp_f32 v72, v72, v29
  v_ldexp_f32 v73, v73, v29
  v_ldexp_f32 v74, v74, v29
  v_ldexp_f32 v75, v75, v29
  v_ldexp_f32 v76, v76, v29
  v_ldexp_f32 v77, v77, v29
  v_ldexp_f32 v78, v78, v29
  v_ldexp_f32 v79, v79, v29
  v_cvt_pk_f16_f32 v108, v72, v73
  v_cvt_pk_f16_f32 v109, v74, v75
  v_cvt_pk_f16_f32 v110, v76, v77
  v_cvt_pk_f16_f32 v111, v78, v79
  v_min_u32 v108, -2, v108
  v_min_u32 v109, -2, v109
  v_min_u32 v110, -2, v110
  v_min_u32 v111, -2, v111
  s_cmp_eq_u32 s43, 15
  s_cbranch_scc1 L_hp_last
  ds_write_b32 v23, v51 offset:12
  v_add_u32 v196, 3072, v196
  v_add_u32 v197, 3072, v197
  v_add_u32 v198, 3072, v198
  ds_write_b128 v28, v[108:111]
  v_add_u32 v28, 384, v28
  s_bitcmp1_b32 s80, s47
  s_cbranch_scc0 L_fbp
  s_waitcnt vmcnt(0) lgkmcnt(0)
  v_readlane_b32 s46, v40, s47
  s_sub_u32 s78, s78, s46
  s_bfe_u32 s46, s78, 0x80000
  s_min_u32 s46, s46, 15
  s_lshl_b32 s46, s46, 1
  s_sub_u32 s46, s46, 15
  s_cmp_gt_i32 s46, 0
  s_cselect_b32 s44, 2, 10
  s_mul_i32 s46, s46, s44
  s_add_u32 s46, s46, 8
  s_ashr_i32 s46, s46, 4
  v_mov_b32 v42, s46
  s_mov_b64 exec, 1
  global_store_dword v43, v42, s[30:31]
  s_mov_b64 exec, -1
L_fbp:
  s_branch L_hp
L_hp_last:
  v_cndmask_b32 v108, v48, v108, vcc
  v_cndmask_b32 v109, v49, v109, vcc
  v_cndmask_b32 v110, v50, v110, vcc
  v_cndmask_b32 v111, v51, v111, vcc
  s_mov_b64 exec, 0x1ffffff
  global_store_dwordx4 v168, v[108:111], s[30:31] sc1
  s_mov_b64 exec, -1
  v_subrev_u32 v196, 256, v35
  v_add_u32 v197, 512, v35
  v_min_u32 v197, v196, v197
  v_add_u32 v197, 110080, v197
  v_subrev_u32 v196, 512, v35
  v_add_u32 v198, 256, v35
  v_min_u32 v198, v196, v198
  v_add_u32 v198, 110080, v198
  v_add_u32 v196, 110080, v35
L_hn:
  ds_read_b32 v104, v14 offset:28
  s_waitcnt lgkmcnt(0)
  v_readfirstlane_b32 s46, v104
  s_cmp_ge_u32 s46, 31
  s_cbranch_scc1 L_hn_ok
  s_cmp_eq_u32 s94, 0
  s_cbranch_scc1 L_hn_ok
  s_sub_u32 s94, s94, 1
  s_sleep 1
  s_branch L_hn
L_hn_ok:
  s_mov_b64 exec, 1
L_hw:
  global_atomic_add v68, v36, v14, s[30:31] sc0 sc1
  s_waitcnt vmcnt(0)
  v_readfirstlane_b32 s46, v68
  s_cmp_ge_u32 s46, 16
  s_cbranch_scc1 L_hw_ok
  s_cmp_eq_u32 s94, 0
  s_cbranch_scc1 L_hw_ok
  s_sub_u32 s94, s94, 1
  s_branch L_hw
L_hw_ok:
  s_mov_b64 exec, -1
L_hg:
  global_load_dwordx4 v[52:55], v187, s[30:31] sc1
  global_load_dwordx2 v[112:113], v172, s[30:31] sc1
  global_load_dwordx2 v[114:115], v173, s[30:31] sc1
  global_load_dwordx2 v[116:117], v174, s[30:31] sc1
  global_load_dwordx2 v[118:119], v175, s[30:31] sc1
  global_load_dwordx2 v[120:121], v176, s[30:31] sc1
  global_load_dwordx2 v[122:123], v177, s[30:31] sc1
  global_load_dwordx2 v[124:125], v178, s[30:31] sc1
  global_load_dwordx2 v[126:127], v179, s[30:31] sc1
  global_load_dwordx2 v[128:129], v180, s[30:31] sc1
  global_load_dwordx2 v[130:131], v181, s[30:31] sc1
  global_load_dwordx2 v[132:133], v182, s[30:31] sc1
  global_load_dwordx2 v[134:135], v183, s[30:31] sc1
  global_load_dwordx2 v[136:137], v184, s[30:31] sc1
  global_load_dwordx2 v[138:139], v185, s[30:31] sc1
  global_load_dwordx2 v[140:141], v186, s[30:31] sc1
  s_waitcnt vmcnt(15)
  v_mov_b32 v23, v55
  v_mov_b32 v24, v52
  s_nop 1
  v_max_f32_dpp v24, v24, v24 row_ror:8 row_mask:0xf bank_mask:0xf
  s_nop 1
  v_max_f32_dpp v24, v24, v24 row_ror:4 row_mask:0xf bank_mask:0xf
  s_nop 1
  v_max_f32_dpp v24, v24, v24 row_ror:2 row_mask:0xf bank_mask:0xf
  s_nop 1
  v_max_f32_dpp v24, v24, v24 row_ror:1 row_mask:0xf bank_mask:0xf
  v_sub_f32 v24, v52, v24
  v_exp_f32 v24, v24
  v_subrev_u32 v55, 256, v55
  v_mul_f32 v25, v24, v53
  s_nop 1
  v_add_f32_dpp v25, v25, v25 row_ror:8 row_mask:0xf bank_mask:0xf
  s_nop 1
  v_add_f32_dpp v25, v25, v25 row_ror:4 row_mask:0xf bank_mask:0xf
  s_nop 1
  v_add_f32_dpp v25, v25, v25 row_ror:2 row_mask:0xf bank_mask:0xf
  s_nop 1
  v_add_f32_dpp v25, v25, v25 row_ror:1 row_mask:0xf bank_mask:0xf
  v_rcp_f32 v25, v25
  s_nop 0
  v_mul_f32 v24, v24, v25
  v_ldexp_f32 v25, v24, v55
  v_mul_f32_e64 v54, v24, -v54
  v_readlane_b32 s63, v24, 15
  v_readlane_b32 s44, v54, 15
  v_readlane_b32 s48, v25, 0
  v_readlane_b32 s49, v25, 1
  v_readlane_b32 s50, v25, 2
  v_readlane_b32 s51, v25, 3
  v_readlane_b32 s52, v25, 4
  v_readlane_b32 s53, v25, 5
  v_readlane_b32 s54, v25, 6
  v_readlane_b32 s55, v25, 7
  v_readlane_b32 s56, v25, 8
  v_readlane_b32 s57, v25, 9
  v_readlane_b32 s58, v25, 10
  v_readlane_b32 s59, v25, 11
  v_readlane_b32 s60, v25, 12
  v_readlane_b32 s61, v25, 13
  v_readlane_b32 s62, v25, 14
  v_mov_b32 v108, s44
  v_mov_b32 v109, s44
  v_mov_b32 v110, s44
  v_mov_b32 v111, s44
  s_waitcnt vmcnt(14)
  v_max3_u32 v23, v23, v112, v113
  v_fma_mix_f32 v108, v112, s48, v108 op_sel:[0,0,0] op_sel_hi:[1,0,0]
  v_fma_mix_f32 v109, v112, s48, v109 op_sel:[1,0,0] op_sel_hi:[1,0,0]
  v_fma_mix_f32 v110, v113, s48, v110 op_sel:[0,0,0] op_sel_hi:[1,0,0]
  v_fma_mix_f32 v111, v113, s48, v111 op_sel:[1,0,0] op_sel_hi:[1,0,0]
  s_waitcnt vmcnt(13)
  v_max3_u32 v23, v23, v114, v115
  v_fma_mix_f32 v108, v114, s49, v108 op_sel:[0,0,0] op_sel_hi:[1,0,0]
  v_fma_mix_f32 v109, v114, s49, v109 op_sel:[1,0,0] op_sel_hi:[1,0,0]
  v_fma_mix_f32 v110, v115, s49, v110 op_sel:[0,0,0] op_sel_hi:[1,0,0]
  v_fma_mix_f32 v111, v115, s49, v111 op_sel:[1,0,0] op_sel_hi:[1,0,0]
  s_waitcnt vmcnt(12)
  v_max3_u32 v23, v23, v116, v117
  v_fma_mix_f32 v108, v116, s50, v108 op_sel:[0,0,0] op_sel_hi:[1,0,0]
  v_fma_mix_f32 v109, v116, s50, v109 op_sel:[1,0,0] op_sel_hi:[1,0,0]
  v_fma_mix_f32 v110, v117, s50, v110 op_sel:[0,0,0] op_sel_hi:[1,0,0]
  v_fma_mix_f32 v111, v117, s50, v111 op_sel:[1,0,0] op_sel_hi:[1,0,0]
  s_waitcnt vmcnt(11)
  v_max3_u32 v23, v23, v118, v119
  v_fma_mix_f32 v108, v118, s51, v108 op_sel:[0,0,0] op_sel_hi:[1,0,0]
  v_fma_mix_f32 v109, v118, s51, v109 op_sel:[1,0,0] op_sel_hi:[1,0,0]
  v_fma_mix_f32 v110, v119, s51, v110 op_sel:[0,0,0] op_sel_hi:[1,0,0]
  v_fma_mix_f32 v111, v119, s51, v111 op_sel:[1,0,0] op_sel_hi:[1,0,0]
  s_waitcnt vmcnt(10)
  v_max3_u32 v23, v23, v120, v121
  v_fma_mix_f32 v108, v120, s52, v108 op_sel:[0,0,0] op_sel_hi:[1,0,0]
  v_fma_mix_f32 v109, v120, s52, v109 op_sel:[1,0,0] op_sel_hi:[1,0,0]
  v_fma_mix_f32 v110, v121, s52, v110 op_sel:[0,0,0] op_sel_hi:[1,0,0]
  v_fma_mix_f32 v111, v121, s52, v111 op_sel:[1,0,0] op_sel_hi:[1,0,0]
  s_waitcnt vmcnt(9)
  v_max3_u32 v23, v23, v122, v123
  v_fma_mix_f32 v108, v122, s53, v108 op_sel:[0,0,0] op_sel_hi:[1,0,0]
  v_fma_mix_f32 v109, v122, s53, v109 op_sel:[1,0,0] op_sel_hi:[1,0,0]
  v_fma_mix_f32 v110, v123, s53, v110 op_sel:[0,0,0] op_sel_hi:[1,0,0]
  v_fma_mix_f32 v111, v123, s53, v111 op_sel:[1,0,0] op_sel_hi:[1,0,0]
  s_waitcnt vmcnt(8)
  v_max3_u32 v23, v23, v124, v125
  v_fma_mix_f32 v108, v124, s54, v108 op_sel:[0,0,0] op_sel_hi:[1,0,0]
  v_fma_mix_f32 v109, v124, s54, v109 op_sel:[1,0,0] op_sel_hi:[1,0,0]
  v_fma_mix_f32 v110, v125, s54, v110 op_sel:[0,0,0] op_sel_hi:[1,0,0]
  v_fma_mix_f32 v111, v125, s54, v111 op_sel:[1,0,0] op_sel_hi:[1,0,0]
  s_waitcnt vmcnt(7)
  v_max3_u32 v23, v23, v126, v127
  v_fma_mix_f32 v108, v126, s55, v108 op_sel:[0,0,0] op_sel_hi:[1,0,0]
  v_fma_mix_f32 v109, v126, s55, v109 op_sel:[1,0,0] op_sel_hi:[1,0,0]
  v_fma_mix_f32 v110, v127, s55, v110 op_sel:[0,0,0] op_sel_hi:[1,0,0]
  v_fma_mix_f32 v111, v127, s55, v111 op_sel:[1,0,0] op_sel_hi:[1,0,0]
  s_waitcnt vmcnt(6)
  v_max3_u32 v23, v23, v128, v129
  v_fma_mix_f32 v108, v128, s56, v108 op_sel:[0,0,0] op_sel_hi:[1,0,0]
  v_fma_mix_f32 v109, v128, s56, v109 op_sel:[1,0,0] op_sel_hi:[1,0,0]
  v_fma_mix_f32 v110, v129, s56, v110 op_sel:[0,0,0] op_sel_hi:[1,0,0]
  v_fma_mix_f32 v111, v129, s56, v111 op_sel:[1,0,0] op_sel_hi:[1,0,0]
  s_waitcnt vmcnt(5)
  v_max3_u32 v23, v23, v130, v131
  v_fma_mix_f32 v108, v130, s57, v108 op_sel:[0,0,0] op_sel_hi:[1,0,0]
  v_fma_mix_f32 v109, v130, s57, v109 op_sel:[1,0,0] op_sel_hi:[1,0,0]
  v_fma_mix_f32 v110, v131, s57, v110 op_sel:[0,0,0] op_sel_hi:[1,0,0]
  v_fma_mix_f32 v111, v131, s57, v111 op_sel:[1,0,0] op_sel_hi:[1,0,0]
  s_waitcnt vmcnt(4)
  v_max3_u32 v23, v23, v132, v133
  v_fma_mix_f32 v108, v132, s58, v108 op_sel:[0,0,0] op_sel_hi:[1,0,0]
  v_fma_mix_f32 v109, v132, s58, v109 op_sel:[1,0,0] op_sel_hi:[1,0,0]
  v_fma_mix_f32 v110, v133, s58, v110 op_sel:[0,0,0] op_sel_hi:[1,0,0]
  v_fma_mix_f32 v111, v133, s58, v111 op_sel:[1,0,0] op_sel_hi:[1,0,0]
  s_waitcnt vmcnt(3)
  v_max3_u32 v23, v23, v134, v135
  v_fma_mix_f32 v108, v134, s59, v108 op_sel:[0,0,0] op_sel_hi:[1,0,0]
  v_fma_mix_f32 v109, v134, s59, v109 op_sel:[1,0,0] op_sel_hi:[1,0,0]
  v_fma_mix_f32 v110, v135, s59, v110 op_sel:[0,0,0] op_sel_hi:[1,0,0]
  v_fma_mix_f32 v111, v135, s59, v111 op_sel:[1,0,0] op_sel_hi:[1,0,0]
  s_waitcnt vmcnt(2)
  v_max3_u32 v23, v23, v136, v137
  v_fma_mix_f32 v108, v136, s60, v108 op_sel:[0,0,0] op_sel_hi:[1,0,0]
  v_fma_mix_f32 v109, v136, s60, v109 op_sel:[1,0,0] op_sel_hi:[1,0,0]
  v_fma_mix_f32 v110, v137, s60, v110 op_sel:[0,0,0] op_sel_hi:[1,0,0]
  v_fma_mix_f32 v111, v137, s60, v111 op_sel:[1,0,0] op_sel_hi:[1,0,0]
  s_waitcnt vmcnt(1)
  v_max3_u32 v23, v23, v138, v139
  v_fma_mix_f32 v108, v138, s61, v108 op_sel:[0,0,0] op_sel_hi:[1,0,0]
  v_fma_mix_f32 v109, v138, s61, v109 op_sel:[1,0,0] op_sel_hi:[1,0,0]
  v_fma_mix_f32 v110, v139, s61, v110 op_sel:[0,0,0] op_sel_hi:[1,0,0]
  v_fma_mix_f32 v111, v139, s61, v111 op_sel:[1,0,0] op_sel_hi:[1,0,0]
  s_waitcnt vmcnt(0)
  v_max3_u32 v23, v23, v140, v141
  v_cmp_eq_u32 s[64:65], -1, v23
  v_fma_mix_f32 v108, v140, s62, v108 op_sel:[0,0,0] op_sel_hi:[1,0,0]
  v_fma_mix_f32 v109, v140, s62, v109 op_sel:[1,0,0] op_sel_hi:[1,0,0]
  v_fma_mix_f32 v110, v141, s62, v110 op_sel:[0,0,0] op_sel_hi:[1,0,0]
  v_fma_mix_f32 v111, v141, s62, v111 op_sel:[1,0,0] op_sel_hi:[1,0,0]
  s_cmp_eq_u64 s[64:65], 0
  s_cbranch_scc1 L_hg_ok
  s_cmp_eq_u32 s94, 0
  s_cbranch_scc1 L_hg_ok
  s_sub_u32 s94, s94, 1
  s_branch L_hg
L_hg_ok:
  v_mov_b32 v168, s63
  s_mov_b32 exec_hi, 0xffff
  s_barrier
  ds_read_b128 v[72:75], v196 offset:0
  ds_read_b128 v[76:79], v197 offset:768
  ds_read_b128 v[80:83], v198 offset:1536
  ds_read_b128 v[84:87], v196 offset:2304
  s_waitcnt lgkmcnt(3)
  v_pk_fma_f32 v[108:109], v[72:73], v[168:169], v[108:109] op_sel_hi:[1,0,1]
  v_pk_fma_f32 v[110:111], v[74:75], v[168:169], v[110:111] op_sel_hi:[1,0,1]
  s_waitcnt lgkmcnt(2)
  v_pk_fma_f32 v[108:109], v[76:77], v[168:169], v[108:109] op_sel_hi:[1,0,1]
  v_pk_fma_f32 v[110:111], v[78:79], v[168:169], v[110:111] op_sel_hi:[1,0,1]
  s_waitcnt lgkmcnt(1)
  v_pk_fma_f32 v[108:109], v[80:81], v[168:169], v[108:109] op_sel_hi:[1,0,1]
  v_pk_fma_f32 v[110:111], v[82:83], v[168:169], v[110:111] op_sel_hi:[1,0,1]
  s_waitcnt lgkmcnt(0)
  v_pk_fma_f32 v[108:109], v[84:85], v[168:169], v[108:109] op_sel_hi:[1,0,1]
  v_pk_fma_f32 v[110:111], v[86:87], v[168:169], v[110:111] op_sel_hi:[1,0,1]
  v_cvt_pk_bf16_f32 v108, v108, v109
  v_cvt_pk_bf16_f32 v109, v110, v111
  global_store_dwordx2 v21, v[108:109], s[26:27]
L_end:
  s_endpgm
.p2align 6
.type L_order,@object
L_order:
  .long 0x76afedcb, 0x45321098, 0x500000, 0x300, 0x40, 0x231500, 0x4, 0x0
  .long 0x2e001e, 0x4e003e, 0x6e005e, 0x8d007e, 0xae009e, 0xce00be, 0xee00de, 0xf00fe
  .long 0x96afedcb, 0x74321058, 0x700000, 0x700, 0x70, 0x271700, 0x7, 0x0
  .long 0x270007, 0x470037, 0x670057, 0x870077, 0xa70097, 0xc700b7, 0xe700d7, 0x1f00f7
  .long 0x765aedfb, 0xc4321098, 0xd00000, 0xf00, 0xc0, 0x2f1d00, 0xc, 0x0
  .long 0x110001, 0x410031, 0x610051, 0x810071, 0xa10091, 0xc100b1, 0xe100d1, 0x2f00f1
  .long 0x785fedcb, 0x6432109a, 0x900000, 0x200, 0x60, 0x221900, 0x6, 0x0
  .long 0x160006, 0x460026, 0x660056, 0x860076, 0xa60096, 0xc600b6, 0xe600d6, 0x3f00f6
  .long 0x765faecb, 0xd4321098, 0xf00000, 0xd00, 0xd0, 0x2d1f00, 0xd, 0x0
  .long 0x120002, 0x320022, 0x620052, 0x820072, 0xa20092, 0xc200b2, 0xe200d2, 0x4f00f2
  .long 0x765fedca, 0xb4321098, 0x800000, 0xf00, 0xb0, 0x2f1800, 0xb, 0x0
  .long 0x100000, 0x300020, 0x600040, 0x800070, 0xa00090, 0xc000b0, 0xe000d0, 0x5f00f0
  .long 0x76afedcb, 0x24351098, 0x400000, 0x0, 0x20, 0x201400, 0x2, 0x0
  .long 0x1c000c, 0x3c002c, 0x5c004c, 0x8c007c, 0xac009c, 0xcc00bc, 0xea00dc, 0x6f00fc
  .long 0x76afedcb, 0x14325098, 0x400000, 0x400, 0x10, 0x241400, 0x1, 0x0
  .long 0x1b000b, 0x3b002b, 0x5b004b, 0x8b006b, 0xab009b, 0xcb00bb, 0xeb00db, 0x7f00fb
  .long 0x76afedcb, 0x35421098, 0x500000, 0x300, 0x30, 0x231500, 0x3, 0x0
  .long 0x1d000d, 0x3d002d, 0x5d004d, 0x7d006d, 0xad009d, 0xcd00bd, 0xed00dd, 0x8f00fd
  .long 0x76afedcb, 0x94321058, 0x700000, 0x700, 0x90, 0x271700, 0x9, 0x0
  .long 0x170009, 0x390029, 0x590049, 0x790069, 0xa90089, 0xc900b9, 0xe900d9, 0x9f00f9
  .long 0x765aedcb, 0xf4321098, 0xd00000, 0xf00, 0xf0, 0x2f1d00, 0xf, 0x0
  .long 0x140004, 0x340021, 0x540044, 0x740064, 0x940084, 0xc400b4, 0xe400d4, 0xaf00f4
  .long 0x765fedcb, 0x8432109a, 0x900000, 0x200, 0x80, 0x221900, 0x8, 0x0
  .long 0x180008, 0x360028, 0x580048, 0x780068, 0x980088, 0xc800a8, 0xe800d8, 0xbf00f8
  .long 0x765fadcb, 0xe4321098, 0xf00000, 0xd00, 0xe0, 0x2d1f00, 0xe, 0x0
  .long 0x130003, 0x330023, 0x530042, 0x730063, 0x930083, 0xb300a3, 0xe300d3, 0xcf00f3
  .long 0x765fedcb, 0xa4321098, 0x800000, 0xf00, 0xaf, 0x18002f, 0xa, 0x0
  .long 0x500024, 0x14400a4, 0x2b40234, 0x6f40674, 0x7830703, 0xc1408c2, 0xd630c94, 0xdf0de3
  .long 0x76afedcb, 0x4351298, 0x400000, 0x0, 0x0, 0x201400, 0x0, 0x0
  .long 0x1a000a, 0x3a002a, 0x5a004a, 0x7a006a, 0x9a008a, 0xba00aa, 0xda00ca, 0xef00fa
  .long 0x76afedcb, 0x54321098, 0x400000, 0x400, 0x54, 0x240014, 0x5, 0x0
  .long 0x7b006c, 0x1cc00ec, 0x4be043e, 0x58d050d, 0x7de075e, 0xe1c084d, 0xe9c0e2e, 0xff0eae
  .long 0x765fadce, 0xb4321098, 0x11911111, 0x11111e11, 0xb1, 0x2e1901, 0xb, 0x0
  .long 0x1200110, 0x1400130, 0x1600150, 0x1800170, 0x1a00190, 0x1c001b0, 0x1e001d0, 0x10f01f0
  .long 0x76afedcb, 0x94321058, 0x11b11111, 0x11111011, 0x91, 0x201b01, 0x9, 0x0
  .long 0x1290109, 0x1490139, 0x1690159, 0x1890179, 0x1a90199, 0x1c901b9, 0x1e901d9, 0x11f01f9
  .long 0x765fedcb, 0x8432109a, 0x11a11111, 0x11111111, 0x81, 0x211a01, 0x8, 0x0
  .long 0x1180108, 0x1480138, 0x1680158, 0x1880178, 0x1a70198, 0x1c801b8, 0x1e801d8, 0x12f01f8
  .long 0x765feadb, 0xc4321098, 0x11811111, 0x11111e11, 0xc1, 0x2e1801, 0xc, 0x0
  .long 0x1110101, 0x1410121, 0x1610151, 0x1810171, 0x1a10191, 0x1c101b1, 0x1e101d1, 0x13f01f1
  .long 0x765aedcb, 0xf4321098, 0x11e11111, 0x11111f11, 0xf1, 0x2f1e01, 0xf, 0x0
  .long 0x1140104, 0x1340124, 0x1640154, 0x1840174, 0x1a40194, 0x1c401b4, 0x1e401d4, 0x14f01f4
  .long 0x76afedcb, 0x45321098, 0x11311111, 0x11111811, 0x41, 0x281301, 0x4, 0x0
  .long 0x11e010e, 0x13e012e, 0x16e014e, 0x18e017e, 0x1ae019e, 0x1ce01be, 0x1ee01dd, 0x15f01fe
  .long 0x7a5fedcb, 0x64321098, 0x11811111, 0x11111311, 0x61, 0x231801, 0x6, 0x0
  .long 0x1160106, 0x1360126, 0x1560146, 0x1860176, 0x1a60196, 0x1c601b6, 0x1e601d6, 0x16f01f6
  .long 0x76afedcb, 0x14325098, 0x11011111, 0x11111311, 0x11, 0x231001, 0x1, 0x0
  .long 0x11b010b, 0x13b012b, 0x15b014b, 0x18b016b, 0x1ab019b, 0x1cb01bb, 0x1eb01db, 0x17f01fa
  .long 0x765fadcb, 0xe4321098, 0x11911111, 0x11111e11, 0xe1, 0x2e1901, 0xe, 0x0
  .long 0x1130100, 0x1330123, 0x1530143, 0x1730163, 0x1a30193, 0x1c301b3, 0x1e301d3, 0x18f01f3
  .long 0x76afedcb, 0x54321098, 0x11b11111, 0x11111011, 0x5b, 0x20011b, 0x5, 0x0
  .long 0x3090119, 0x5450389, 0xc2505c5, 0xd650ca5, 0xe750de5, 0xf380ef5, 0xfb80f55, 0x19f0fd5
  .long 0x865fedcb, 0x7432109a, 0x11a11111, 0x11111111, 0x71, 0x211a01, 0x7, 0x0
  .long 0x1170107, 0x1370127, 0x1570147, 0x1770167, 0x1970187, 0x1c701b7, 0x1e701d7, 0x1af01f7
  .long 0x765feacb, 0xd4321098, 0x11811111, 0x11111e11, 0xd1, 0x2e1801, 0xd, 0x0
  .long 0x1120102, 0x1310122, 0x1520142, 0x1720162, 0x1920182, 0x1c201a2, 0x1e201d2, 0x1bf01f2
  .long 0x76afedcb, 0x24351098, 0x11411111, 0x11111711, 0x21, 0x271401, 0x2, 0x0
  .long 0x11c010c, 0x13c012c, 0x15c014c, 0x17c016c, 0x19c018c, 0x1bc01ac, 0x1ec01dc, 0x1cf01fc
  .long 0x76afedcb, 0x35421098, 0x11311111, 0x11111811, 0x31, 0x281301, 0x3, 0x0
  .long 0x11d010d, 0x13d012d, 0x15d014d, 0x17d016d, 0x19d018d, 0x1bd01ad, 0x1ed01cd, 0x1df01fd
  .long 0x765fedcb, 0xa4321098, 0x11811111, 0x11111311, 0xa3, 0x180123, 0xa, 0x0
  .long 0x850005, 0x1750166, 0x62501f5, 0x74506a5, 0xbd507c5, 0xd350d15, 0xdb50d95, 0x1ef0e55
  .long 0x76afedcb, 0x4325198, 0x11011111, 0x11111311, 0x1, 0x231001, 0x0, 0x0
  .long 0x11a010a, 0x13a012a, 0x15a014a, 0x17a016a, 0x19a018a, 0x1ba01aa, 0x1da01ca, 0x1ff01ea
  .long 0x76afedcb, 0x45321098, 0x22222222, 0x22222a22, 0x42, 0x2a1202, 0x4, 0x0
  .long 0x22e021e, 0x24e023e, 0x26e025e, 0x28b027e, 0x2ae029e, 0x2ce02be, 0x2ee02de, 0x20f02fe
  .long 0x7a5fedcb, 0x64321098, 0x22c22222, 0x22222622, 0x62, 0x261c02, 0x6, 0x0
  .long 0x2260206, 0x2460236, 0x2660256, 0x2860276, 0x2a60296, 0x2c602b6, 0x2e602d6, 0x21f02f6
  .long 0x76afedcb, 0x54321098, 0x22922222, 0x22222522, 0x59, 0x250219, 0x5, 0x0
  .long 0xb50035, 0x1850105, 0x2f502a8, 0x3550315, 0x3d50395, 0x6650575, 0x94506e5, 0x22f09c5
  .long 0x765aedcb, 0xf4321098, 0x22f22222, 0x22222f22, 0xf2, 0x2f1f02, 0xf, 0x0
  .long 0x2140204, 0x2440224, 0x2640254, 0x2840274, 0x2a40294, 0x2c402b2, 0x2e402d4, 0x23f02f4
  .long 0x76afedcb, 0x24351098, 0x22222222, 0x22222522, 0x22, 0x251202, 0x2, 0x0
  .long 0x21c020c, 0x23c022c, 0x26c025c, 0x28c027c, 0x2ac029c, 0x2ca02bc, 0x2ec02dc, 0x24f02fc
  .long 0x965fedcb, 0x743210a8, 0x22722222, 0x22222022, 0x72, 0x201702, 0x7, 0x0
  .long 0x2170207, 0x2370227, 0x2670247, 0x2870277, 0x2a70297, 0x2c702b7, 0x2e702d7, 0x25f02f7
  .long 0x765fadce, 0xb4321098, 0x22a22222, 0x22222e22, 0xb2, 0x2e1a02, 0xb, 0x0
  .long 0x2100200, 0x2300220, 0x2500240, 0x2800270, 0x2a00290, 0x2c002b0, 0x2e002d0, 0x26f02f0
  .long 0x76afedcb, 0x34521098, 0x22222222, 0x22222822, 0x32, 0x281202, 0x3, 0x0
  .long 0x21d020d, 0x23d022d, 0x25d024d, 0x28d026d, 0x2ad029d, 0x2cd02bd, 0x2ed02dd, 0x27f02fd
  .long 0x76afedcb, 0x15324098, 0x22222222, 0x22222a22, 0x12, 0x2a1202, 0x1, 0x0
  .long 0x21b020b, 0x23b022b, 0x25b024b, 0x27b026b, 0x2ab029b, 0x2cb02bb, 0x2eb02db, 0x28f02fb
  .long 0x765fedcb, 0xa4321098, 0x22c22222, 0x22222622, 0xa6, 0x1c0226, 0xa, 0x0
  .long 0x3650216, 0x42503e5, 0x73504a5, 0x7750755, 0x7d507b5, 0xb4507f5, 0xd050bc5, 0x29f0d85
  .long 0x76afedcb, 0x84321095, 0x22922222, 0x22222522, 0x82, 0x251902, 0x8, 0x0
  .long 0x2180208, 0x2380228, 0x2580248, 0x2780268, 0x2980288, 0x2c802b8, 0x2e802d8, 0x2af02f8
  .long 0x765aefcb, 0xd4321098, 0x22f22222, 0x22222f22, 0xd2, 0x2f1f02, 0xd, 0x0
  .long 0x2120202, 0x2320222, 0x2520242, 0x2720262, 0x2920282, 0x2c202a2, 0x2e202d2, 0x2bf02f2
  .long 0x76afedcb, 0x4351298, 0x22222222, 0x22222522, 0x2, 0x251202, 0x0, 0x0
  .long 0x21a020a, 0x23a022a, 0x25a024a, 0x27a026a, 0x29a028a, 0x2ba02aa, 0x2ea02da, 0x2cf02fa
  .long 0x765fedcb, 0x943210a8, 0x22722222, 0x22222022, 0x92, 0x201702, 0x9, 0x0
  .long 0x2190209, 0x2390229, 0x2570249, 0x2790269, 0x2990289, 0x2b902a9, 0x2e902c9, 0x2df02f9
  .long 0x765fadcb, 0xe4321098, 0x22a22222, 0x22222e22, 0xe2, 0x2e1a02, 0xe, 0x0
  .long 0x2130203, 0x2330223, 0x2530243, 0x2730260, 0x2930283, 0x2b302a3, 0x2d302c3, 0x2ef02f3
  .long 0x765fedab, 0xc4321098, 0x22922222, 0x22222d22, 0xc2, 0x2d1902, 0xc, 0x0
  .long 0x2110201, 0x2310221, 0x2510241, 0x2710261, 0x2910281, 0x2b102a1, 0x2d102c1, 0x2ff02e1
  .long 0x76afedcb, 0x84321059, 0x33b33333, 0x33333133, 0x83, 0x211b03, 0x8, 0x0
  .long 0x3280318, 0x3480338, 0x3680358, 0x3880378, 0x3a80398, 0x3c803b8, 0x3e803d8, 0x30f03f8
  .long 0x765aedcb, 0xf4321098, 0x33933333, 0x33333e33, 0xf3, 0x2e1903, 0xf, 0x0
  .long 0x3240304, 0x3440334, 0x3640354, 0x3840374, 0x3a40394, 0x3c403b4, 0x3e403d4, 0x31f03f4
  .long 0x76afedcb, 0x4321598, 0x33033333, 0x33333233, 0x3, 0x221003, 0x0, 0x0
  .long 0x31a030a, 0x34a033a, 0x36a035a, 0x38a037a, 0x3aa039a, 0x3ca03ba, 0x3ea03da, 0x32f03fa
  .long 0x765fedac, 0xb4321098, 0x33a33333, 0x33333b33, 0xb3, 0x2b1a03, 0xb, 0x0
  .long 0x3100300, 0x3400320, 0x3600350, 0x3800370, 0x3a00390, 0x3c003b0, 0x3e003d0, 0x33f03f0
  .long 0x76afedcb, 0x24531098, 0x33133333, 0x33333a33, 0x23, 0x2a1103, 0x2, 0x0
  .long 0x31c030c, 0x33c032c, 0x36c035c, 0x38c037c, 0x3ac039c, 0x3cc03bc, 0x3ec03dc, 0x34f03fc
  .long 0xa65fedcb, 0x74321098, 0x33933333, 0x33333133, 0x73, 0x211903, 0x7, 0x0
  .long 0x3170307, 0x3370327, 0x3670347, 0x3870377, 0x3a70397, 0x3c703b7, 0x3e703d6, 0x35f03f7
  .long 0x76afedcb, 0x15324098, 0x33333333, 0x33333633, 0x13, 0x261303, 0x1, 0x0
  .long 0x31b030b, 0x33b032b, 0x35b034b, 0x38b037b, 0x3ab039b, 0x3cb03bb, 0x3eb03db, 0x36f03fb
  .long 0x765fadcb, 0xe4321098, 0x33e33333, 0x33333a33, 0xe3, 0x2a1e03, 0xe, 0x0
  .long 0x3130303, 0x3330323, 0x3530343, 0x3830363, 0x3a30393, 0x3c303b3, 0x3e303d3, 0x37f03f2
  .long 0x76afedcb, 0x94321058, 0x33b33333, 0x33333133, 0x93, 0x211b03, 0x9, 0x0
  .long 0x3190308, 0x3390329, 0x3590349, 0x3790369, 0x3a90399, 0x3c903b9, 0x3e903d9, 0x38f03f9
  .long 0x765fedcb, 0xa4321098, 0x33933333, 0x33333e33, 0xae, 0x19032e, 0xa, 0x0
  .long 0x1320103, 0x1b20183, 0x2e30263, 0x4740314, 0x82304f4, 0xd5208a3, 0xe420dd2, 0x39f0ec2
  .long 0x76afedcb, 0x54321098, 0x33033333, 0x33333233, 0x50, 0x220310, 0x5, 0x0
  .long 0x1fb017b, 0x65e032a, 0x73c06de, 0xaeb07bc, 0xc6a0c4d, 0xd0c0ccd, 0xf1e0d8c, 0x3af0f9e
  .long 0x765fedab, 0xc4321098, 0x33a33333, 0x33333b33, 0xc3, 0x2b1a03, 0xc, 0x0
  .long 0x3110301, 0x3300321, 0x3510341, 0x3710361, 0x3910381, 0x3c103a1, 0x3e103d1, 0x3bf03f1
  .long 0x76afedcb, 0x34521098, 0x33133333, 0x33333a33, 0x33, 0x2a1103, 0x3, 0x0
  .long 0x31d030d, 0x33d032d, 0x35d034c, 0x37d036d, 0x39d038d, 0x3bd03ad, 0x3ed03dd, 0x3cf03fd
  .long 0xa75fedcb, 0x64321098, 0x33933333, 0x33333133, 0x63, 0x211903, 0x6, 0x0
  .long 0x3160306, 0x3360326, 0x3560346, 0x3760366, 0x3960386, 0x3b603a6, 0x3e603c6, 0x3df03f6
  .long 0x76afedcb, 0x45321098, 0x33333333, 0x33333633, 0x43, 0x261303, 0x4, 0x0
  .long 0x31e030e, 0x33e032e, 0x35e034e, 0x37e036b, 0x39e038e, 0x3be03ae, 0x3de03ce, 0x3ef03fe
  .long 0x765faecb, 0xd4321098, 0x33e33333, 0x33333a33, 0xd3, 0x2a1e03, 0xd, 0x0
  .long 0x3120302, 0x3320322, 0x3520342, 0x3720362, 0x3920382, 0x3b203a2, 0x3d203c2, 0x3ff03e2
  .long 0x765fedcb, 0x8432109a, 0x44a44444, 0x44444944, 0x84, 0x291a04, 0x8, 0x0
  .long 0x4280418, 0x4480438, 0x4680458, 0x4870478, 0x4a80498, 0x4c804b8, 0x4e804d8, 0x40f04f8
  .long 0x76afedcb, 0x4521398, 0x44544444, 0x44444544, 0x4, 0x251504, 0x0, 0x0
  .long 0x42a040a, 0x44a043a, 0x46a045a, 0x48a047a, 0x4aa049a, 0x4ca04ba, 0x4ea04da, 0x41f04fa
  .long 0x76afedcb, 0x24351098, 0x44344444, 0x44444644, 0x24, 0x261304, 0x2, 0x0
  .long 0x41c040c, 0x44c043c, 0x46c045c, 0x48c047c, 0x4ac049c, 0x4cc04bc, 0x4ec04dc, 0x42f04fc
  .long 0x76afedcb, 0x45321098, 0x44444444, 0x44444a44, 0x44, 0x2a1404, 0x4, 0x0
  .long 0x41e040e, 0x44e042e, 0x46e045e, 0x48e047e, 0x4ae049e, 0x4ce04bb, 0x4ee04de, 0x43f04fe
  .long 0x765fadce, 0xb4321098, 0x44744444, 0x44444b44, 0xb4, 0x2b1704, 0xb, 0x0
  .long 0x4100400, 0x4300420, 0x4600450, 0x4800470, 0x4a00490, 0x4c004b0, 0x4e004d0, 0x44f04f0
  .long 0x765feacb, 0xd4321098, 0x44644444, 0x44444c44, 0xd4, 0x2c1604, 0xd, 0x0
  .long 0x4120402, 0x4320422, 0x4620442, 0x4820472, 0x4a20492, 0x4c204b2, 0x4e204d2, 0x45f04f2
  .long 0x79afedcb, 0x64321058, 0x44744444, 0x44444744, 0x64, 0x271704, 0x6, 0x0
  .long 0x4160406, 0x4360426, 0x4560446, 0x4860476, 0x4a60496, 0x4c604b6, 0x4e604d6, 0x46f04f6
  .long 0x765aedcb, 0xf4321098, 0x44644444, 0x44444e44, 0xf4, 0x2e1604, 0xf, 0x0
  .long 0x4140404, 0x4340424, 0x4540444, 0x4840464, 0x4a40494, 0x4c404b4, 0x4e404d4, 0x47f04f1
  .long 0x865fedcb, 0x7432109a, 0x44a44444, 0x44444944, 0x74, 0x291a04, 0x7, 0x0
  .long 0x4170407, 0x4370427, 0x4570447, 0x4770467, 0x4a70497, 0x4c704b7, 0x4e704d7, 0x48f04f7
  .long 0x76afedcb, 0x34521098, 0x44544444, 0x44444544, 0x34, 0x251504, 0x3, 0x0
  .long 0x41a040d, 0x43d042d, 0x45d044d, 0x47d046d, 0x4ad048d, 0x4cd04bd, 0x4ed04dd, 0x49f04fd
  .long 0x76afedcb, 0x54321098, 0x44344444, 0x44444644, 0x53, 0x260413, 0x5, 0x0
  .long 0x1de015e, 0x3ee036e, 0x81b042c, 0x89b087e, 0x93d08fe, 0xd4e09bd, 0xf0d0dce, 0x4af0f8d
  .long 0x76afedcb, 0x15324098, 0x44444444, 0x44444a44, 0x14, 0x2a1404, 0x1, 0x0
  .long 0x41b040b, 0x43b042b, 0x45b044b, 0x47b046b, 0x49b048b, 0x4cb04ab, 0x4eb04db, 0x4bf04fb
  .long 0x765fadcb, 0xe4321098, 0x44744444, 0x44444b44, 0xe4, 0x2b1704, 0xe, 0x0
  .long 0x4130403, 0x4330423, 0x4530440, 0x4730463, 0x4930483, 0x4b304a3, 0x4e304d3, 0x4cf04f3
  .long 0x765fedcb, 0xa4321098, 0x44644444, 0x44444c44, 0xac, 0x16042c, 0xa, 0x0
  .long 0x5230452, 0x76405a3, 0x94207e4, 0xb1109c2, 0xb910b34, 0xc030bb4, 0xf740c83, 0x4df0ff4
  .long 0x76afedcb, 0x94321058, 0x44744444, 0x44444744, 0x94, 0x271704, 0x9, 0x0
  .long 0x4190409, 0x4390429, 0x4590449, 0x4790466, 0x4990489, 0x4b904a9, 0x4d904c9, 0x4ef04f9
  .long 0x765aedfb, 0xc4321098, 0x44644444, 0x44444e44, 0xc4, 0x2e1604, 0xc, 0x0
  .long 0x4110401, 0x4310421, 0x4510441, 0x4710461, 0x4910481, 0x4b104a1, 0x4d104c1, 0x4ff04e1
  .long 0x76afedcb, 0x34521098, 0x55455555, 0x55555855, 0x35, 0x281405, 0x3, 0x0
  .long 0x52d051d, 0x54d053d, 0x56d055d, 0x58c057d, 0x5ad059d, 0x5cd05bd, 0x5ed05dd, 0x50f05fd
  .long 0x765fedcb, 0x943210a8, 0x55f55555, 0x55555a55, 0x95, 0x2a1f05, 0x9, 0x0
  .long 0x5290509, 0x5490539, 0x5690559, 0x5890579, 0x5a90596, 0x5c905b9, 0x5e905d9, 0x51f05f9
  .long 0x765fadeb, 0xc4321098, 0x55755555, 0x55555c55, 0xc5, 0x2c1705, 0xc, 0x0
  .long 0x5110501, 0x5410531, 0x5610551, 0x5810571, 0x5a10591, 0x5c105b1, 0x5e105d1, 0x52f05f1
  .long 0x765feacd, 0xb4321098, 0x55c55555, 0x55555d55, 0xb5, 0x2d1c05, 0xb, 0x0
  .long 0x5100500, 0x5400520, 0x5600550, 0x5800570, 0x5a00590, 0x5c005b0, 0x5e005d0, 0x53f05f0
  .long 0xa65fedcb, 0x74321098, 0x55b55555, 0x55555455, 0x75, 0x241b05, 0x7, 0x0
  .long 0x5170507, 0x5370527, 0x5670557, 0x5870577, 0x5a70597, 0x5c705b7, 0x5e705d7, 0x54f05f7
  .long 0x76afedcb, 0x84321095, 0x55f55555, 0x55555755, 0x85, 0x271f05, 0x8, 0x0
  .long 0x5180508, 0x5380528, 0x5680548, 0x5880578, 0x5a80598, 0x5c805b8, 0x5e805d8, 0x55f05f8
  .long 0x76afedcb, 0x4325198, 0x55255555, 0x55555255, 0x5, 0x221205, 0x0, 0x0
  .long 0x51a050a, 0x53a052a, 0x55a054a, 0x58a057a, 0x5aa059a, 0x5ca05ba, 0x5ea05da, 0x56f05fa
  .long 0x765aedcb, 0xf4321098, 0x55955555, 0x55555d55, 0xf5, 0x2d1905, 0xf, 0x0
  .long 0x5140504, 0x5340524, 0x5540544, 0x5840564, 0x5a40594, 0x5c405b4, 0x5e405d4, 0x57f05f4
  .long 0x76afedcb, 0x24531098, 0x55455555, 0x55555855, 0x25, 0x281405, 0x2, 0x0
  .long 0x51c050c, 0x53c052c, 0x55c054c, 0x57c056c, 0x5ac059c, 0x5cc05bc, 0x5ec05dc, 0x58f05fc
  .long 0x795fedcb, 0x643210a8, 0x55f55555, 0x55555a55, 0x65, 0x2a1f05, 0x6, 0x0
  .long 0x5160506, 0x5360526, 0x5560546, 0x5760566, 0x5a60586, 0x5c605b6, 0x5e605d6, 0x59f05f6
  .long 0x765fadcb, 0xe4321098, 0x55755555, 0x55555c55, 0xe5, 0x2c1705, 0xe, 0x0
  .long 0x5130503, 0x5330521, 0x5530543, 0x5730563, 0x5930583, 0x5c305b3, 0x5e305d3, 0x5af05f3
  .long 0x765feacb, 0xd4321098, 0x55c55555, 0x55555d55, 0xd5, 0x2d1c05, 0xd, 0x0
  .long 0x5120502, 0x5300522, 0x5520542, 0x5720562, 0x5920582, 0x5c205a2, 0x5e205d2, 0x5bf05f2
  .long 0x765fedcb, 0xa4321098, 0x55b55555, 0x55555455, 0xa4, 0x1b0524, 0xa, 0x0
  .long 0xf50075, 0x6350547, 0x81506b5, 0x8950855, 0xb6508d5, 0xc290be5, 0xf050ca9, 0x5cf0f85
  .long 0x76afedcb, 0x54321098, 0x55f55555, 0x55555755, 0x5f, 0x27051f, 0x5, 0x0
  .long 0xc50045, 0x2b50235, 0x5580515, 0x8650595, 0xd2508e5, 0xdf50d75, 0xe850e05, 0x5df0fa5
  .long 0x76afedcb, 0x14325098, 0x55255555, 0x55555255, 0x15, 0x221205, 0x1, 0x0
  .long 0x51b050b, 0x53b052b, 0x55b054b, 0x57b056a, 0x59b058b, 0x5bb05ab, 0x5db05cb, 0x5ef05fb
  .long 0x76afedcb, 0x45321098, 0x55255555, 0x55555855, 0x45, 0x281205, 0x4, 0x0
  .long 0x51e050e, 0x53e052e, 0x55e054e, 0x57e056e, 0x59e058e, 0x5be05ae, 0x5de05ce, 0x5ff05ee
  .long 0x76afedcb, 0x24351098, 0x66166666, 0x66666566, 0x26, 0x251106, 0x2, 0x0
  .long 0x62c061c, 0x64c063c, 0x66c065c, 0x68c067c, 0x6ac069c, 0x6cc06bc, 0x6ec06dc, 0x60f06fc
  .long 0x765feacd, 0xb4321098, 0x66a66666, 0x66666b66, 0xb6, 0x2b1a06, 0xb, 0x0
  .long 0x6200600, 0x6400630, 0x6600650, 0x6800670, 0x6a00690, 0x6c006b0, 0x6e006d0, 0x61f06f0
  .long 0x76afedcb, 0x94321058, 0x66e66666, 0x66666366, 0x96, 0x231e06, 0x9, 0x0
  .long 0x6190609, 0x6490639, 0x6690659, 0x6890679, 0x6a70699, 0x6c906b9, 0x6e906d9, 0x62f06f9
  .long 0x76afedcb, 0x4325198, 0x66166666, 0x66666466, 0x6, 0x241106, 0x0, 0x0
  .long 0x61a060a, 0x64a062a, 0x66a065a, 0x68a067a, 0x6aa069a, 0x6ca06ba, 0x6ea06da, 0x63f06fa
  .long 0x76afedcb, 0x84321095, 0x66566666, 0x66666966, 0x86, 0x291506, 0x8, 0x0
  .long 0x6180608, 0x6380628, 0x6680658, 0x6880678, 0x6a80698, 0x6c606b8, 0x6e806d8, 0x64f06f8
  .long 0x76afedcb, 0x45321098, 0x66066666, 0x66666566, 0x46, 0x251006, 0x4, 0x0
  .long 0x61e060e, 0x63e062e, 0x66e064e, 0x68e067e, 0x6ae069e, 0x6ce06be, 0x6ee06dd, 0x65f06fe
  .long 0x765fedcb, 0xa4321098, 0x66966666, 0x66666a66, 0xaa, 0x19062a, 0xa, 0x0
  .long 0x2850205, 0x3730345, 0x3f303c5, 0x4b50435, 0x5990519, 0x92506e3, 0xb5209a5, 0x66f0ed4
  .long 0x765aedfb, 0xc4321098, 0x66866666, 0x66666f66, 0xc6, 0x2f1806, 0xc, 0x0
  .long 0x6110601, 0x6310621, 0x6510641, 0x6810661, 0x6a10691, 0x6c106b1, 0x6e106d1, 0x67f06f1
  .long 0x76afedcb, 0x54321098, 0x66166666, 0x66666566, 0x51, 0x250611, 0x5, 0x0
  .long 0x3cd034d, 0x63b060c, 0x91e06bb, 0xa2d099e, 0xb6d0aad, 0xbdc0b7e, 0xbfe0bed, 0x68f0e5d
  .long 0x765feacb, 0xd4321098, 0x66a66666, 0x66666b66, 0xd6, 0x2b1a06, 0xd, 0x0
  .long 0x6100602, 0x6320622, 0x6520642, 0x6720662, 0x6a20682, 0x6c206b2, 0x6e206d2, 0x69f06f2
  .long 0x96afedcb, 0x74321058, 0x66e66666, 0x66666366, 0x76, 0x231e06, 0x7, 0x0
  .long 0x6170607, 0x6370627, 0x6570647, 0x6770667, 0x6970687, 0x6c706b7, 0x6e706d7, 0x6af06f7
  .long 0x76afedcb, 0x14325098, 0x66166666, 0x66666466, 0x16, 0x241106, 0x1, 0x0
  .long 0x61b060b, 0x63a062b, 0x65b064b, 0x67b066b, 0x69b068b, 0x6cb06ab, 0x6eb06db, 0x6bf06fb
  .long 0x78afedcb, 0x64321095, 0x66566666, 0x66666966, 0x66, 0x291506, 0x6, 0x0
  .long 0x6160606, 0x6360626, 0x6560646, 0x6760666, 0x6960686, 0x6b606a6, 0x6e606d6, 0x6cf06f6
  .long 0x76afedcb, 0x35421098, 0x66066666, 0x66666566, 0x36, 0x251006, 0x3, 0x0
  .long 0x61d060d, 0x63d062d, 0x65d064d, 0x67d066d, 0x69d068d, 0x6bd06ad, 0x6ed06cd, 0x6df06fd
  .long 0x765fadcb, 0xe4321098, 0x66966666, 0x66666a66, 0xe6, 0x2a1906, 0xe, 0x0
  .long 0x6130603, 0x6330623, 0x6530643, 0x6730663, 0x6930683, 0x6b306a3, 0x6d306c3, 0x6ef06f3
  .long 0x765aedcb, 0xf4321098, 0x66866666, 0x66666f66, 0xf6, 0x2f1806, 0xf, 0x0
  .long 0x6140604, 0x6340624, 0x6540644, 0x6710664, 0x6940684, 0x6b406a4, 0x6d406c4, 0x6ff06e4
  .long 0x765fadcb, 0xe4321098, 0x77d77777, 0x77777f77, 0xe7, 0x2f1d07, 0xe, 0x0
  .long 0x7230713, 0x7430733, 0x7630753, 0x7800773, 0x7a30793, 0x7c307b3, 0x7e307d3, 0x70f07f3
  .long 0x76afedcb, 0x4321598, 0x77277777, 0x77777177, 0x7, 0x211207, 0x0, 0x0
  .long 0x72a070a, 0x74a073a, 0x76a075a, 0x78a077a, 0x7aa079a, 0x7ca07ba, 0x7ea07da, 0x71f07fa
  .long 0x765fedcb, 0xa4321098, 0x77877777, 0x77777d77, 0xad, 0x18072d, 0xa, 0x0
  .long 0xc30043, 0x53202f1, 0x5b20574, 0x96307a1, 0xa0409e3, 0xa840a13, 0xf520a93, 0x72f0fd2
  .long 0x76afedcb, 0x24351098, 0x77077777, 0x77777677, 0x27, 0x261007, 0x2, 0x0
  .long 0x71c070c, 0x74c072c, 0x76c075c, 0x78c077c, 0x7ac079c, 0x7cc07bb, 0x7ec07dc, 0x73f07fc
  .long 0x56afedcb, 0x74321098, 0x77677777, 0x77777377, 0x77, 0x231607, 0x7, 0x0
  .long 0x7170707, 0x7370727, 0x7670757, 0x7870777, 0x7a70797, 0x7c607b7, 0x7e707d7, 0x74f07f7
  .long 0x76afedcb, 0x45321098, 0x77477777, 0x77777677, 0x47, 0x261407, 0x4, 0x0
  .long 0x71e070e, 0x73e072e, 0x76e074e, 0x78e077e, 0x7ae079e, 0x7ce07be, 0x7ee07dd, 0x75f07fe
  .long 0x765aefcb, 0xd4321098, 0x77e77777, 0x77777c77, 0xd7, 0x2c1e07, 0xd, 0x0
  .long 0x7120702, 0x7320722, 0x7520742, 0x7820772, 0x7a20792, 0x7c207b2, 0x7e207d2, 0x76f07f2
  .long 0x76afedcb, 0x94321058, 0x77c77777, 0x77777677, 0x97, 0x261c07, 0x9, 0x0
  .long 0x7190709, 0x7390729, 0x7590749, 0x7890769, 0x7a90799, 0x7c907b9, 0x7e907d9, 0x77f07f8
  .long 0x765fadce, 0xb4321098, 0x77d77777, 0x77777f77, 0xb7, 0x2f1d07, 0xb, 0x0
  .long 0x7100700, 0x7300720, 0x7500740, 0x7700760, 0x7a00790, 0x7c007b0, 0x7e007d0, 0x78f07f0
  .long 0x76afedcb, 0x54321098, 0x77277777, 0x77777177, 0x52, 0x210712, 0x5, 0x0
  .long 0x24c020e, 0x28e027d, 0x56b02cc, 0x5fe05eb, 0xa3e071a, 0xc5e0abe, 0xdad0cde, 0x79f0f2a
  .long 0x765fedab, 0xc4321098, 0x77877777, 0x77777d77, 0xc7, 0x2d1807, 0xc, 0x0
  .long 0x7110701, 0x7310721, 0x7510741, 0x7710761, 0x7910781, 0x7c107b1, 0x7e107d1, 0x7af07f1
  .long 0x76afedcb, 0x14352098, 0x77077777, 0x77777677, 0x17, 0x261007, 0x1, 0x0
  .long 0x71b070b, 0x73b072b, 0x75b074b, 0x77b076b, 0x79b078b, 0x7cb07ab, 0x7eb07db, 0x7bf07fb
  .long 0x57afedcb, 0x64321098, 0x77677777, 0x77777377, 0x67, 0x231607, 0x6, 0x0
  .long 0x7160706, 0x7360726, 0x7560746, 0x7760766, 0x7960786, 0x7b607a6, 0x7e607d6, 0x7cf07f6
  .long 0x76afedcb, 0x35421098, 0x77477777, 0x77777677, 0x37, 0x261407, 0x3, 0x0
  .long 0x71d070d, 0x73d072d, 0x75d074d, 0x77d076d, 0x79d078d, 0x7bd07ad, 0x7ed07cd, 0x7df07fd
  .long 0x765aedcb, 0xf4321098, 0x77e77777, 0x77777c77, 0xf7, 0x2c1e07, 0xf, 0x0
  .long 0x7140704, 0x7340724, 0x7540744, 0x7740762, 0x7940784, 0x7b407a4, 0x7d407c4, 0x7ef07f4
  .long 0x76afedcb, 0x84321059, 0x77c77777, 0x77777677, 0x87, 0x261c07, 0x8, 0x0
  .long 0x7180708, 0x7380728, 0x7580748, 0x7780768, 0x7980788, 0x7b807a8, 0x7d807c8, 0x7ff07e8
  .long 0x765aedcb, 0xf4321098, 0x88e88888, 0x88888b88, 0xf8, 0x2b1e08, 0xf, 0x0
  .long 0x8240814, 0x8440834, 0x8640854, 0x8810874, 0x8a40894, 0x8c408b4, 0x8e408d4, 0x80f08f4
  .long 0x76afedcb, 0x14325098, 0x88388888, 0x88888488, 0x18, 0x241308, 0x1, 0x0
  .long 0x82b080b, 0x84b083b, 0x86b085b, 0x88b087b, 0x8ab089a, 0x8cb08bb, 0x8eb08db, 0x81f08fb
  .long 0x765fadcb, 0xe4321098, 0x88688888, 0x88888e88, 0xe8, 0x2e1608, 0xe, 0x0
  .long 0x8130803, 0x8430833, 0x8630853, 0x8830873, 0x8a00893, 0x8c308b3, 0x8e308d3, 0x82f08f3
  .long 0x96afedcb, 0x74321058, 0x88788888, 0x88888888, 0x78, 0x281708, 0x7, 0x0
  .long 0x8170807, 0x8470827, 0x8670857, 0x8870877, 0x8a70897, 0x8c708b7, 0x8e708d7, 0x83f08f7
  .long 0x76afedcb, 0x34521098, 0x88488888, 0x88888788, 0x38, 0x271408, 0x3, 0x0
  .long 0x81d080d, 0x83d082d, 0x86d085d, 0x88d087d, 0x8ad089d, 0x8cd08bd, 0x8ed08dd, 0x84f08fd
  .long 0x76afedcb, 0x54321098, 0x88e88888, 0x88888488, 0x5e, 0x24081e, 0x5, 0x0
  .long 0x3750145, 0x62903f5, 0x76506a9, 0x80507e5, 0x8c50885, 0xa1508d6, 0xc350a95, 0x85f0cb5
  .long 0x765fedcb, 0x8432109a, 0x88f88888, 0x88888988, 0x88, 0x291f08, 0x8, 0x0
  .long 0x8180808, 0x8380828, 0x8580848, 0x8880878, 0x8a80898, 0x8c808b8, 0x8e808d8, 0x86f08f8
  .long 0x76afedcb, 0x45321098, 0x88388888, 0x88888788, 0x48, 0x271308, 0x4, 0x0
  .long 0x81e080e, 0x83e082e, 0x85e084e, 0x88e086e, 0x8ae089e, 0x8ce08be, 0x8ee08de, 0x87f08fc
  .long 0x765aedfb, 0xc4321098, 0x88e88888, 0x88888b88, 0xc8, 0x2b1e08, 0xc, 0x0
  .long 0x8110801, 0x8310821, 0x8510841, 0x8710861, 0x8a10891, 0x8c108b1, 0x8e108d1, 0x88f08f1
  .long 0x76afedcb, 0x4325198, 0x88388888, 0x88888488, 0x8, 0x241308, 0x0, 0x0
  .long 0x81a080a, 0x83a082a, 0x85a084a, 0x87a086a, 0x8aa088a, 0x8ca08ba, 0x8ea08da, 0x89f08fa
  .long 0x765fadce, 0xb4321098, 0x88688888, 0x88888e88, 0xb8, 0x2e1608, 0xb, 0x0
  .long 0x8100800, 0x8300820, 0x8500840, 0x8700860, 0x8900880, 0x8c008b0, 0x8e008d0, 0x8af08f0
  .long 0x76afedcb, 0x94321058, 0x88788888, 0x88888888, 0x98, 0x281708, 0x9, 0x0
  .long 0x8190809, 0x8370829, 0x8590849, 0x8790869, 0x8990889, 0x8c908a9, 0x8e908d9, 0x8bf08f9
  .long 0x765feacb, 0xd4321098, 0x88e88888, 0x88888f88, 0xd8, 0x2f1e08, 0xd, 0x0
  .long 0x8120802, 0x8320822, 0x8520842, 0x8720862, 0x8920882, 0x8b208a2, 0x8e208d2, 0x8cf08f2
  .long 0x75afedcb, 0x64321098, 0x88e88888, 0x88888488, 0x68, 0x241e08, 0x6, 0x0
  .long 0x8160806, 0x8360826, 0x8560846, 0x8760866, 0x8960886, 0x8b608a6, 0x8e608c6, 0x8df08f6
  .long 0x765fedcb, 0xa4321098, 0x88f88888, 0x88888988, 0xa9, 0x1f0829, 0xa, 0x0
  .long 0x4880408, 0x6c50645, 0xa350868, 0xc550ab5, 0xcd50c75, 0xe250cf5, 0xf150ea5, 0x8ef0f95
  .long 0x76afedcb, 0x25341098, 0x88388888, 0x88888788, 0x28, 0x271308, 0x2, 0x0
  .long 0x81c080c, 0x83c082c, 0x85c084c, 0x87c086c, 0x89c088c, 0x8bc08ac, 0x8dc08cc, 0x8ff08ec
  .long 0x78afedcb, 0x64321095, 0x99799999, 0x99999099, 0x69, 0x201709, 0x6, 0x0
  .long 0x9260916, 0x9460936, 0x9660956, 0x9860976, 0x9a60996, 0x9c609b6, 0x9e609d6, 0x90f09f6
  .long 0x76afedcb, 0x45321098, 0x99199999, 0x99999899, 0x49, 0x281109, 0x4, 0x0
  .long 0x92e090e, 0x94e093e, 0x96e095e, 0x98e097e, 0x9ae099c, 0x9ce09be, 0x9ee09de, 0x91f09fe
  .long 0x76afedcb, 0x14325098, 0x99599999, 0x99999a99, 0x19, 0x2a1509, 0x1, 0x0
  .long 0x91b090b, 0x94b093b, 0x96b095b, 0x98b097b, 0x9ab099b, 0x9cb09bb, 0x9eb09db, 0x92f09fb
  .long 0x76afedcb, 0x4521398, 0x99399999, 0x99999599, 0x9, 0x251309, 0x0, 0x0
  .long 0x91a090a, 0x94a092a, 0x96a095a, 0x98a097a, 0x9aa099a, 0x9ca09ba, 0x9ea09da, 0x93f09fa
  .long 0x765feacb, 0xd4321098, 0x99999999, 0x99999c99, 0xd9, 0x2c1909, 0xd, 0x0
  .long 0x9120902, 0x9320922, 0x9620952, 0x9820972, 0x9a20992, 0x9c009b2, 0x9e209d2, 0x94f09f2
  .long 0x765aedcb, 0xf4321098, 0x99c99999, 0x99999b99, 0xf9, 0x2b1c09, 0xf, 0x0
  .long 0x9140904, 0x9340924, 0x9640944, 0x9840974, 0x9a40994, 0x9c409b4, 0x9e409d4, 0x95f09f4
  .long 0x765fadcb, 0xe4321098, 0x99599999, 0x99999d99, 0xe9, 0x2d1509, 0xe, 0x0
  .long 0x9130903, 0x9330923, 0x9530943, 0x9830973, 0x9a30993, 0x9c309b3, 0x9e109d3, 0x96f09f3
  .long 0x76afedcb, 0x94321058, 0x99d99999, 0x99999599, 0x99, 0x251d09, 0x9, 0x0
  .long 0x9190909, 0x9390929, 0x9590949, 0x9890969, 0x9a90999, 0x9c909b9, 0x9e909d9, 0x97f09f7
  .long 0x76afedcb, 0x84321095, 0x99799999, 0x99999099, 0x89, 0x201709, 0x8, 0x0
  .long 0x9180906, 0x9380928, 0x9580948, 0x9780968, 0x9a80998, 0x9c809b8, 0x9e809d8, 0x98f09f8
  .long 0x76afedcb, 0x25341098, 0x99199999, 0x99999899, 0x29, 0x281109, 0x2, 0x0
  .long 0x91c090c, 0x93c092c, 0x95c094c, 0x97c096c, 0x9ac098c, 0x9cc09bc, 0x9ec09dc, 0x99f09fc
  .long 0x76afedcb, 0x54321098, 0x99599999, 0x99999a99, 0x55, 0x2a0915, 0x5, 0x0
  .long 0x8e000e, 0x49d041d, 0x6c80648, 0x965092b, 0xb5509e5, 0xeb80e38, 0xf750ed5, 0x9af0ff5
  .long 0x76afedcb, 0x34521098, 0x99399999, 0x99999599, 0x39, 0x251309, 0x3, 0x0
  .long 0x91d090d, 0x93a092d, 0x95d094d, 0x97d096d, 0x99d098d, 0x9cd09ad, 0x9ed09dd, 0x9bf09fd
  .long 0x765feacd, 0xb4321098, 0x99999999, 0x99999c99, 0xb9, 0x2c1909, 0xb, 0x0
  .long 0x9100900, 0x9300920, 0x9500940, 0x9700960, 0x9900980, 0x9b009a0, 0x9e009d0, 0x9cf09f0
  .long 0x765fedcb, 0xa4321098, 0x99c99999, 0x99999b99, 0xab, 0x1c092b, 0xa, 0x0
  .long 0x3b10331, 0x4c30443, 0x6920612, 0x8840804, 0xa610954, 0xd240ce2, 0xef30e73, 0x9df0fa3
  .long 0x765fadeb, 0xc4321098, 0x99599999, 0x99999d99, 0xc9, 0x2d1509, 0xc, 0x0
  .long 0x9110901, 0x9310921, 0x9510941, 0x9710961, 0x9910981, 0x9b109a1, 0x9d109c1, 0x9ef09f1
  .long 0x96afedcb, 0x74321058, 0x99d99999, 0x99999599, 0x79, 0x251d09, 0x7, 0x0
  .long 0x9170907, 0x9370927, 0x9570947, 0x9770967, 0x9970987, 0x9b709a7, 0x9d709c7, 0x9ff09e7
  .long 0x765aedcb, 0xf4321098, 0xaa6aaaaa, 0xaaaaadaa, 0xfa, 0x2d160a, 0xf, 0x0
  .long 0xa240a14, 0xa440a34, 0xa640a54, 0xa820a74, 0xaa40a94, 0xac40ab4, 0xae40ad4, 0xa0f0af4
  .long 0x765fadce, 0xb4321098, 0xaaeaaaaa, 0xaaaaadaa, 0xba, 0x2d1e0a, 0xb, 0x0
  .long 0xa200a00, 0xa400a30, 0xa600a50, 0xa800a70, 0xaa00a90, 0xac00ab0, 0xae00ad0, 0xa1f0af0
  .long 0x76afedcb, 0x34521098, 0xaa1aaaaa, 0xaaaaa7aa, 0x3a, 0x27110a, 0x3, 0x0
  .long 0xa1d0a0d, 0xa4d0a3d, 0xa6d0a5d, 0xa8d0a7d, 0xaac0a9d, 0xacd0abd, 0xaed0add, 0xa2f0afd
  .long 0x76afedcb, 0x45321098, 0xaa2aaaaa, 0xaaaaa9aa, 0x4a, 0x29120a, 0x4, 0x0
  .long 0xa1e0a0e, 0xa4e0a2e, 0xa6e0a5e, 0xa8e0a7e, 0xaae0a9e, 0xace0aba, 0xaee0ade, 0xa3f0afe
  .long 0x765fedcb, 0xa4321098, 0xaaaaaaaa, 0xaaaaa8aa, 0xa8, 0x1a0a28, 0xa, 0x0
  .long 0x1d50155, 0x5050275, 0x5f50585, 0x8b50835, 0x9950915, 0xda50ac5, 0xee50e65, 0xa4f0f25
  .long 0x86afedcb, 0x74321095, 0xaadaaaaa, 0xaaaaa2aa, 0x7a, 0x221d0a, 0x7, 0x0
  .long 0xa170a07, 0xa370a27, 0xa670a47, 0xa870a77, 0xaa70a97, 0xac70ab7, 0xae70ad7, 0xa5f0af7
  .long 0x765fedab, 0xc4321098, 0xaa6aaaaa, 0xaaaaabaa, 0xca, 0x2b160a, 0xc, 0x0
  .long 0xa110a01, 0xa310a21, 0xa510a41, 0xa810a71, 0xaa10a91, 0xac10ab1, 0xae10ad1, 0xa6f0af1
  .long 0x765fedcb, 0x943210a8, 0xaaaaaaaa, 0xaaaaa1aa, 0x9a, 0x211a0a, 0x9, 0x0
  .long 0xa190a09, 0xa390a29, 0xa590a49, 0xa890a69, 0xaa90a99, 0xac90ab9, 0xae90ad9, 0xa7f0af6
  .long 0x765aefcb, 0xd4321098, 0xaa6aaaaa, 0xaaaaadaa, 0xda, 0x2d160a, 0xd, 0x0
  .long 0xa120a02, 0xa320a22, 0xa520a42, 0xa720a62, 0xaa20a92, 0xac20ab2, 0xae20ad2, 0xa8f0af2
  .long 0x765fadcb, 0xe4321098, 0xaaeaaaaa, 0xaaaaadaa, 0xea, 0x2d1e0a, 0xe, 0x0
  .long 0xa100a03, 0xa330a23, 0xa530a43, 0xa730a63, 0xaa30a83, 0xac30ab3, 0xae30ad3, 0xa9f0af3
  .long 0x76afedcb, 0x24531098, 0xaa1aaaaa, 0xaaaaa7aa, 0x2a, 0x27110a, 0x2, 0x0
  .long 0xa1c0a0c, 0xa3c0a2c, 0xa5c0a4c, 0xa7c0a6c, 0xa9c0a8c, 0xacc0abc, 0xaec0adc, 0xaaf0afc
  .long 0x76afedcb, 0x5321498, 0xaa2aaaaa, 0xaaaaa9aa, 0xa, 0x29120a, 0x0, 0x0
  .long 0xa1a0a0a, 0xa3a0a2a, 0xa5a0a4a, 0xa7a0a6a, 0xa9a0a8a, 0xaca0aaa, 0xaea0ada, 0xabf0afa
  .long 0x76afedcb, 0x54321098, 0xaaaaaaaa, 0xaaaaa8aa, 0x5a, 0x280a1a, 0x5, 0x0
  .long 0x1a50125, 0x2e50265, 0x3b50335, 0x4850405, 0x6950615, 0xa750a45, 0xd550af5, 0xacf0dd5
  .long 0x76afedcb, 0x84321095, 0xaadaaaaa, 0xaaaaa2aa, 0x8a, 0x221d0a, 0x8, 0x0
  .long 0xa180a08, 0xa380a28, 0xa570a48, 0xa780a68, 0xa980a88, 0xab80aa8, 0xae80ac8, 0xadf0af8
  .long 0x76afedcb, 0x14325098, 0xaa0aaaaa, 0xaaaaa1aa, 0x1a, 0x21100a, 0x1, 0x0
  .long 0xa1b0a0b, 0xa3b0a2b, 0xa5b0a4b, 0xa7b0a6b, 0xa9b0a8b, 0xabb0aab, 0xadb0acb, 0xaef0afb
  .long 0x795fedcb, 0x643210a8, 0xaaaaaaaa, 0xaaaaa1aa, 0x6a, 0x211a0a, 0x6, 0x0
  .long 0xa160a06, 0xa360a26, 0xa560a46, 0xa760a66, 0xa960a86, 0xab60aa6, 0xad60ac6, 0xaff0ae6
  .long 0x765fedcb, 0xa4321098, 0xbb8bbbbb, 0xbbbbb7bb, 0xa7, 0x180b27, 0xa, 0x0
  .long 0x950015, 0x46501c5, 0x55504e5, 0x84505d5, 0x8f50875, 0xaa50a25, 0xf350b86, 0xb0f0fb5
  .long 0x765fedac, 0xb4321098, 0xbbdbbbbb, 0xbbbbbcbb, 0xbb, 0x2c1d0b, 0xb, 0x0
  .long 0xb200b00, 0xb400b30, 0xb600b50, 0xb800b70, 0xba00b90, 0xbc00bb0, 0xbe00bd0, 0xb1f0bf0
  .long 0x765fedcb, 0x943210a8, 0xbbcbbbbb, 0xbbbbb0bb, 0x9b, 0x201c0b, 0x9, 0x0
  .long 0xb190b09, 0xb490b39, 0xb690b59, 0xb890b79, 0xba70b99, 0xbc90bb9, 0xbe90bd9, 0xb2f0bf9
  .long 0x765afdcb, 0xe4321098, 0xbb6bbbbb, 0xbbbbbcbb, 0xeb, 0x2c160b, 0xe, 0x0
  .long 0xb130b03, 0xb430b23, 0xb630b53, 0xb830b73, 0xba30b93, 0xbc30bb3, 0xbe30bd3, 0xb3f0bf3
  .long 0x76afedcb, 0x84321095, 0xbb8bbbbb, 0xbbbbb6bb, 0x8b, 0x26180b, 0x8, 0x0
  .long 0xb180b08, 0xb380b28, 0xb680b58, 0xb880b78, 0xba80b98, 0xbc80bb8, 0xbe80bd8, 0xb4f0bf8
  .long 0x765feacb, 0xd4321098, 0xbb5bbbbb, 0xbbbbbabb, 0xdb, 0x2a150b, 0xd, 0x0
  .long 0xb120b02, 0xb320b22, 0xb620b42, 0xb820b72, 0xba20b92, 0xbc20bb2, 0xbe20bd2, 0xb5f0bf2
  .long 0x76afedcb, 0x34521098, 0xbb1bbbbb, 0xbbbbb4bb, 0x3b, 0x24110b, 0x3, 0x0
  .long 0xb1d0b0d, 0xb3d0b2d, 0xb5d0b4d, 0xb8d0b7d, 0xbad0b9d, 0xbcd0bbd, 0xbeb0bdd, 0xb6f0bfd
  .long 0x76afedcb, 0x5321498, 0xbb1bbbbb, 0xbbbbb2bb, 0xb, 0x22110b, 0x0, 0x0
  .long 0xb1a0b0a, 0xb3a0b2a, 0xb5a0b4a, 0xb8a0b6a, 0xbaa0b9a, 0xbca0bba, 0xbea0bda, 0xb7f0bfa
  .long 0x7a5fedcb, 0x64321098, 0xbb8bbbbb, 0xbbbbb7bb, 0x6b, 0x27180b, 0x6, 0x0
  .long 0xb160b06, 0xb360b26, 0xb560b46, 0xb760b66, 0xba60b96, 0xbc60bb6, 0xbe60bd6, 0xb8f0bf6
  .long 0x765fedab, 0xc4321098, 0xbbdbbbbb, 0xbbbbbcbb, 0xcb, 0x2c1d0b, 0xc, 0x0
  .long 0xb100b01, 0xb310b21, 0xb510b41, 0xb710b61, 0xba10b81, 0xbc10bb1, 0xbe10bd1, 0xb9f0bf1
  .long 0x965fedcb, 0x743210a8, 0xbbcbbbbb, 0xbbbbb0bb, 0x7b, 0x201c0b, 0x7, 0x0
  .long 0xb170b07, 0xb370b27, 0xb570b47, 0xb770b67, 0xb970b87, 0xbc70bb7, 0xbe70bd7, 0xbaf0bf7
  .long 0x765aedcb, 0xf4321098, 0xbb6bbbbb, 0xbbbbbcbb, 0xfb, 0x2c160b, 0xf, 0x0
  .long 0xb140b04, 0xb330b24, 0xb540b44, 0xb740b64, 0xb940b84, 0xbc40ba4, 0xbe40bd4, 0xbbf0bf4
  .long 0x76afedcb, 0x54321098, 0xbb8bbbbb, 0xbbbbb6bb, 0x58, 0x260b18, 0x5, 0x0
  .long 0xd50055, 0x1650135, 0x1e501b5, 0x6f50675, 0x7a50725, 0xb480b05, 0xc150b85, 0xbcf0c95
  .long 0x76afedcb, 0x24351098, 0xbb1bbbbb, 0xbbbbb3bb, 0x2b, 0x23110b, 0x2, 0x0
  .long 0xb1c0b0c, 0xb3c0b2c, 0xb5c0b4c, 0xb7c0b6c, 0xb9c0b8c, 0xbbc0bac, 0xbec0bcc, 0xbdf0bfc
  .long 0x76afedcb, 0x14523098, 0xbb1bbbbb, 0xbbbbb4bb, 0x1b, 0x24110b, 0x1, 0x0
  .long 0xb1b0b0b, 0xb3b0b2b, 0xb5b0b4b, 0xb7b0b6b, 0xb9b0b8b, 0xbbb0bab, 0xbdb0bcb, 0xbef0bfb
  .long 0x76afedcb, 0x45321098, 0xbb1bbbbb, 0xbbbbb2bb, 0x4b, 0x22110b, 0x4, 0x0
  .long 0xb1e0b0e, 0xb3e0b2e, 0xb5e0b4e, 0xb7a0b6e, 0xb9e0b8e, 0xbbe0bae, 0xbde0bce, 0xbff0bee
  .long 0x765fadce, 0xb4321098, 0xcccccccc, 0xcccccccc, 0xbc, 0x2c1c0c, 0xb, 0x0
  .long 0xc200c10, 0xc400c30, 0xc600c50, 0xc800c70, 0xca00c90, 0xcc00cb0, 0xce00cd0, 0xc0f0cf0
  .long 0x765aedfb, 0xc4321098, 0xcc8ccccc, 0xcccccfcc, 0xcc, 0x2f180c, 0xc, 0x0
  .long 0xc210c01, 0xc410c31, 0xc610c51, 0xc810c71, 0xca10c91, 0xcc10cb1, 0xce10cd1, 0xc1f0cf1
  .long 0x765fedcb, 0x843210a9, 0xccbccccc, 0xccccc4cc, 0x8c, 0x241b0c, 0x8, 0x0
  .long 0xc180c08, 0xc480c38, 0xc680c58, 0xc880c78, 0xca80c98, 0xcc80cb8, 0xce80cd8, 0xc2f0cf8
  .long 0x765fedcb, 0xa4321098, 0xcceccccc, 0xccccc1cc, 0xa1, 0x1e0c21, 0xa, 0x0
  .long 0x1a80128, 0x3570305, 0x3d70385, 0x7950715, 0xae50a79, 0xc450af9, 0xcb70c65, 0xc3f0cc5
  .long 0x76afedcb, 0x34521098, 0xcc0ccccc, 0xccccc1cc, 0x3c, 0x21100c, 0x3, 0x0
  .long 0xc1d0c0d, 0xc3d0c2d, 0xc6d0c5d, 0xc8d0c7d, 0xcad0c9d, 0xccb0cbd, 0xced0cdd, 0xc4f0cfd
  .long 0x76afedcb, 0x25341098, 0xcc2ccccc, 0xccccc9cc, 0x2c, 0x29120c, 0x2, 0x0
  .long 0xc1c0c0c, 0xc3c0c2c, 0xc6c0c4c, 0xc8c0c7c, 0xcac0c9c, 0xccc0cbc, 0xcec0cdc, 0xc5f0cfc
  .long 0x76afedcb, 0x4321598, 0xcc0ccccc, 0xccccc1cc, 0xc, 0x21100c, 0x0, 0x0
  .long 0xc1a0c0a, 0xc3a0c2a, 0xc5a0c4a, 0xc8a0c7a, 0xcaa0c9a, 0xcca0cba, 0xcea0cda, 0xc6f0cfa
  .long 0x76afedcb, 0x54321098, 0xcc7ccccc, 0xccccc9cc, 0x57, 0x290c17, 0x5, 0x0
  .long 0x990019, 0x2d50255, 0x4690445, 0x4e904c5, 0x5a50525, 0x8b90839, 0x9880908, 0xc7f0cf6
  .long 0x765fadcb, 0xe4321098, 0xcccccccc, 0xcccccccc, 0xec, 0x2c1c0c, 0xe, 0x0
  .long 0xc130c00, 0xc330c23, 0xc530c43, 0xc730c63, 0xca30c93, 0xcc30cb3, 0xce30cd3, 0xc8f0cf3
  .long 0x765aedcb, 0xf4321098, 0xcc8ccccc, 0xcccccfcc, 0xfc, 0x2f180c, 0xf, 0x0
  .long 0xc110c04, 0xc340c24, 0xc540c44, 0xc740c64, 0xca40c84, 0xcc40cb4, 0xce40cd4, 0xc9f0cf4
  .long 0x765fedcb, 0x943210a8, 0xccbccccc, 0xccccc4cc, 0x9c, 0x241b0c, 0x9, 0x0
  .long 0xc190c09, 0xc390c28, 0xc590c49, 0xc790c69, 0xc990c89, 0xcc90cb9, 0xce90cd9, 0xcaf0cf9
  .long 0xa65fedcb, 0x74321098, 0xcceccccc, 0xccccc1cc, 0x7c, 0x211e0c, 0x7, 0x0
  .long 0xc170c07, 0xc370c27, 0xc570c47, 0xc770c67, 0xc970c87, 0xcc70ca7, 0xce70cd7, 0xcbf0cf7
  .long 0x76afedcb, 0x14523098, 0xcc0ccccc, 0xccccc1cc, 0x1c, 0x21100c, 0x1, 0x0
  .long 0xc1b0c0b, 0xc3b0c2b, 0xc5b0c4b, 0xc7b0c6b, 0xc9b0c8b, 0xcbb0cab, 0xceb0cdb, 0xccf0cfb
  .long 0x76afedcb, 0x45321098, 0xcc2ccccc, 0xccccc9cc, 0x4c, 0x29120c, 0x4, 0x0
  .long 0xc1e0c0e, 0xc3e0c2e, 0xc5c0c4e, 0xc7e0c6e, 0xc9e0c8e, 0xcbe0cae, 0xcee0cce, 0xcdf0cfe
  .long 0x765feacb, 0xd4321098, 0xcc6ccccc, 0xcccccbcc, 0xdc, 0x2b160c, 0xd, 0x0
  .long 0xc120c02, 0xc320c22, 0xc520c42, 0xc720c62, 0xc920c82, 0xcb20ca2, 0xcd20cc2, 0xcef0cf2
  .long 0x75afedcb, 0x64321098, 0xcc7ccccc, 0xccccc9cc, 0x6c, 0x29170c, 0x6, 0x0
  .long 0xc160c06, 0xc360c26, 0xc560c46, 0xc760c66, 0xc960c86, 0xcb60ca6, 0xcd60cc6, 0xcff0ce6
  .long 0x76afedcb, 0x24351098, 0xdd0ddddd, 0xddddd6dd, 0x2d, 0x26100d, 0x2, 0x0
  .long 0xd2c0d1c, 0xd4c0d3c, 0xd6c0d5c, 0xd8b0d7c, 0xdac0d9c, 0xdcc0dbc, 0xdec0ddc, 0xd0f0dfc
  .long 0x56afedcb, 0x74321098, 0xdd6ddddd, 0xddddd3dd, 0x7d, 0x23160d, 0x7, 0x0
  .long 0xd270d07, 0xd470d37, 0xd670d57, 0xd870d77, 0xda70d97, 0xdc70db7, 0xde70dd7, 0xd1f0df7
  .long 0x765aedcb, 0xf4321098, 0xddfddddd, 0xdddddbdd, 0xfd, 0x2b1f0d, 0xf, 0x0
  .long 0xd140d04, 0xd440d34, 0xd640d54, 0xd840d74, 0xda40d94, 0xdc40db4, 0xde40dd4, 0xd2f0df4
  .long 0x76afedcb, 0x94321058, 0xdddddddd, 0xddddd3dd, 0x9d, 0x231d0d, 0x9, 0x0
  .long 0xd190d09, 0xd490d29, 0xd690d59, 0xd890d79, 0xda90d99, 0xdc90db6, 0xde90dd9, 0xd3f0df9
  .long 0x76afedcb, 0x45321098, 0xdd3ddddd, 0xddddd0dd, 0x4d, 0x20130d, 0x4, 0x0
  .long 0xd1e0d0e, 0xd3e0d2e, 0xd6e0d5e, 0xd8e0d7e, 0xdae0d9e, 0xdca0dbe, 0xdee0dde, 0xd4f0dfe
  .long 0x765feadb, 0xc4321098, 0xddaddddd, 0xdddddedd, 0xcd, 0x2e1a0d, 0xc, 0x0
  .long 0xd110d01, 0xd310d21, 0xd610d41, 0xd810d71, 0xda10d91, 0xdc10db1, 0xde10dd1, 0xd5f0df1
  .long 0x765fadce, 0xb4321098, 0xddbddddd, 0xdddddfdd, 0xbd, 0x2f1b0d, 0xb, 0x0
  .long 0xd100d00, 0xd300d20, 0xd500d40, 0xd800d70, 0xda00d90, 0xdc00db0, 0xde00dd0, 0xd6f0df0
  .long 0x765fedcb, 0xa4321098, 0xddfddddd, 0xddddd0dd, 0xa0, 0x1f0d20, 0xa, 0x0
  .long 0xe50065, 0x1950115, 0x2d90259, 0x9850905, 0xba90b29, 0xdc50d45, 0xe350df8, 0xd7f0eb5
  .long 0x76afedcb, 0x14352098, 0xdd0ddddd, 0xddddd6dd, 0x1d, 0x26100d, 0x1, 0x0
  .long 0xd1b0d0b, 0xd3b0d2b, 0xd5b0d4b, 0xd7b0d6b, 0xdab0d9b, 0xdcb0dbb, 0xdeb0ddb, 0xd8f0dfb
  .long 0x76afedcb, 0x54321098, 0xdd6ddddd, 0xddddd3dd, 0x56, 0x230d16, 0x5, 0x0
  .long 0x4750455, 0x4f504d5, 0x7c70747, 0x8a50825, 0xa650a05, 0xb350a85, 0xce50bb5, 0xd9f0d17
  .long 0x76afedcb, 0x34521098, 0xdd2ddddd, 0xddddd8dd, 0x3d, 0x28120d, 0x3, 0x0
  .long 0xd1d0d0d, 0xd3d0d2d, 0xd5d0d4d, 0xd7d0d6d, 0xd9d0d8d, 0xdcd0dbd, 0xded0ddd, 0xdaf0dfd
  .long 0x79afedcb, 0x64321058, 0xdddddddd, 0xddddd3dd, 0x6d, 0x231d0d, 0x6, 0x0
  .long 0xd160d06, 0xd360d26, 0xd560d46, 0xd760d66, 0xd960d86, 0xdc60da6, 0xde60dd6, 0xdbf0df6
  .long 0x76afedcb, 0x5321498, 0xdd3ddddd, 0xddddd0dd, 0xd, 0x20130d, 0x0, 0x0
  .long 0xd1a0d0a, 0xd3a0d2a, 0xd5a0d4a, 0xd7a0d6a, 0xd9a0d8a, 0xdba0daa, 0xdea0dda, 0xdcf0dfa
  .long 0x765feacb, 0xd4321098, 0xddaddddd, 0xdddddedd, 0xdd, 0x2e1a0d, 0xd, 0x0
  .long 0xd120d02, 0xd320d22, 0xd510d42, 0xd720d62, 0xd920d82, 0xdb20da2, 0xde20dc2, 0xddf0df2
  .long 0x765fadcb, 0xe4321098, 0xddbddddd, 0xdddddfdd, 0xed, 0x2f1b0d, 0xe, 0x0
  .long 0xd130d03, 0xd330d23, 0xd530d43, 0xd730d60, 0xd930d83, 0xdb30da3, 0xdd30dc3, 0xdef0df3
  .long 0x765fedcb, 0x8432109a, 0xddfddddd, 0xddddd0dd, 0x8d, 0x201f0d, 0x8, 0x0
  .long 0xd180d08, 0xd380d28, 0xd580d48, 0xd780d68, 0xd980d88, 0xdb80da8, 0xdd80dc8, 0xdff0de8
  .long 0x7a5fedcb, 0x64321098, 0xeefeeeee, 0xeeeee2ee, 0x6e, 0x221f0e, 0x6, 0x0
  .long 0xe260e16, 0xe460e36, 0xe660e56, 0xe860e76, 0xea60e96, 0xec60eb6, 0xee60ed6, 0xe0f0ef6
  .long 0x76afedcb, 0x4351298, 0xee4eeeee, 0xeeeee2ee, 0xe, 0x22140e, 0x0, 0x0
  .long 0xe2a0e0a, 0xe4a0e3a, 0xe6a0e5a, 0xe8a0e7a, 0xeaa0e9a, 0xeca0eba, 0xeea0eda, 0xe1f0efa
  .long 0x76afedcb, 0x45321098, 0xee4eeeee, 0xeeeee9ee, 0x4e, 0x29140e, 0x4, 0x0
  .long 0xe1e0e0e, 0xe4e0e3e, 0xe6e0e5e, 0xe8e0e7e, 0xeab0e9e, 0xece0ebe, 0xeee0ede, 0xe2f0efe
  .long 0x76afedcb, 0x84321095, 0xee5eeeee, 0xeeeee0ee, 0x8e, 0x20150e, 0x8, 0x0
  .long 0xe180e08, 0xe480e28, 0xe680e58, 0xe880e78, 0xea80e98, 0xec80eb7, 0xee80ed8, 0xe3f0ef8
  .long 0x765feadb, 0xc4321098, 0xeeceeeee, 0xeeeeeeee, 0xce, 0x2e1c0e, 0xc, 0x0
  .long 0xe110e01, 0xe310e21, 0xe610e51, 0xe810e71, 0xea10e91, 0xec10eb1, 0xee10ed1, 0xe4f0ef1
  .long 0x76afedcb, 0x34521098, 0xee1eeeee, 0xeeeee3ee, 0x3e, 0x23110e, 0x3, 0x0
  .long 0xe1d0e0d, 0xe3d0e2d, 0xe6d0e4d, 0xe8d0e7d, 0xead0e9d, 0xecd0ebd, 0xeed0edd, 0xe5f0efd
  .long 0x76afedcb, 0x54321098, 0xeedeeeee, 0xeeeee8ee, 0x5d, 0x280e1d, 0x5, 0x0
  .long 0xa50025, 0x7850705, 0x9f90979, 0xad80a58, 0xb950b15, 0xdb90d39, 0xf450ee9, 0xe6f0fc5
  .long 0x765fadce, 0xb4321098, 0xeebeeeee, 0xeeeeebee, 0xbe, 0x2b1b0e, 0xb, 0x0
  .long 0xe100e00, 0xe300e20, 0xe500e40, 0xe800e60, 0xea00e90, 0xec00eb0, 0xee00ed0, 0xe7f0ef0
  .long 0x765fedcb, 0xa4321098, 0xeefeeeee, 0xeeeee2ee, 0xa2, 0x1f0e22, 0xa, 0x0
  .long 0xb80038, 0x3a50325, 0x5e50565, 0xad50a55, 0xbf50b75, 0xe150e06, 0xf490e95, 0xe8f0fc9
  .long 0x76afedcb, 0x24351098, 0xee4eeeee, 0xeeeee2ee, 0x2e, 0x22140e, 0x2, 0x0
  .long 0xe1a0e0c, 0xe3c0e2c, 0xe5c0e4c, 0xe7c0e6c, 0xeac0e8c, 0xecc0ebc, 0xeec0edc, 0xe9f0efc
  .long 0x76afedcb, 0x15324098, 0xee4eeeee, 0xeeeee9ee, 0x1e, 0x29140e, 0x1, 0x0
  .long 0xe1b0e0b, 0xe3b0e2b, 0xe5b0e4b, 0xe7b0e6b, 0xe9b0e8b, 0xecb0ebb, 0xeeb0edb, 0xeaf0efb
  .long 0x86afedcb, 0x74321095, 0xee5eeeee, 0xeeeee0ee, 0x7e, 0x20150e, 0x7, 0x0
  .long 0xe170e07, 0xe370e27, 0xe570e47, 0xe770e67, 0xe970e87, 0xec70ea7, 0xee70ed7, 0xebf0ef7
  .long 0x765feacb, 0xd4321098, 0xeeceeeee, 0xeeeeeeee, 0xde, 0x2e1c0e, 0xd, 0x0
  .long 0xe120e02, 0xe320e22, 0xe520e41, 0xe720e62, 0xe920e82, 0xeb20ea2, 0xee20ed2, 0xecf0ef2
  .long 0x765aedcb, 0xf4321098, 0xee5eeeee, 0xeeeeeaee, 0xfe, 0x2a150e, 0xf, 0x0
  .long 0xe140e04, 0xe340e24, 0xe540e44, 0xe740e64, 0xe940e84, 0xeb40ea4, 0xee40ec4, 0xedf0ef4
  .long 0x76afedcb, 0x94321058, 0xeedeeeee, 0xeeeee8ee, 0x9e, 0x281d0e, 0x9, 0x0
  .long 0xe190e09, 0xe390e29, 0xe590e49, 0xe790e69, 0xe990e89, 0xeb90ea9, 0xed90ec9, 0xeef0ef9
  .long 0x765fadcb, 0xe4321098, 0xeebeeeee, 0xeeeeebee, 0xee, 0x2b1b0e, 0xe, 0x0
  .long 0xe130e03, 0xe330e23, 0xe530e43, 0xe700e63, 0xe930e83, 0xeb30ea3, 0xed30ec3, 0xeff0ee3
  .long 0x76afedcb, 0x34521098, 0xff3fffff, 0xfffff4ff, 0x3f, 0x24130f, 0x3, 0x0
  .long 0xf2d0f1d, 0xf4d0f3d, 0xf6d0f5d, 0xf8b0f7d, 0xfad0f9d, 0xfcd0fbd, 0xfed0fdd, 0xf0f0ffd
  .long 0x76afedcb, 0x25341098, 0xff0fffff, 0xfffff9ff, 0x2f, 0x29100f, 0x2, 0x0
  .long 0xf2c0f0c, 0xf4c0f3c, 0xf6c0f5c, 0xf8c0f7c, 0xfac0f9c, 0xfcc0fbc, 0xfec0fdc, 0xf1f0ffc
  .long 0x76afedcb, 0x4321598, 0xff2fffff, 0xfffff8ff, 0xf, 0x28120f, 0x0, 0x0
  .long 0xf1a0f0a, 0xf4a0f3a, 0xf6a0f5a, 0xf8a0f7a, 0xfaa0f9a, 0xfca0fba, 0xfea0fda, 0xf2f0ffa
  .long 0x86afedcb, 0x74321095, 0xffbfffff, 0xfffff7ff, 0x7f, 0x271b0f, 0x7, 0x0
  .long 0xf170f07, 0xf470f27, 0xf670f57, 0xf870f77, 0xfa70f97, 0xfc70fb7, 0xfe70fd7, 0xf3f0ff7
  .long 0x795fedcb, 0x643210a8, 0xffdfffff, 0xfffff2ff, 0x6f, 0x221d0f, 0x6, 0x0
  .long 0xf160f06, 0xf360f26, 0xf660f56, 0xf860f76, 0xfa60f96, 0xfc60fb6, 0xfe60fd6, 0xf4f0ff6
  .long 0x765feacb, 0xd4321098, 0xffbfffff, 0xfffffdff, 0xdf, 0x2d1b0f, 0xd, 0x0
  .long 0xf120f02, 0xf320f22, 0xf620f42, 0xf820f72, 0xfa20f92, 0xfc20fb2, 0xfe20fd1, 0xf5f0ff2
  .long 0x76afedcb, 0x54321098, 0xffcfffff, 0xfffff5ff, 0x5c, 0x250f1c, 0x5, 0x0
  .long 0x2950215, 0x5b50535, 0x7f90779, 0x9d50955, 0xba50b25, 0xc850c05, 0xec50e45, 0xf6f0fe5
  .long 0x765aedcf, 0xb4321098, 0xff5fffff, 0xfffffcff, 0xbf, 0x2c150f, 0xb, 0x0
  .long 0xf100f00, 0xf300f20, 0xf500f40, 0xf800f60, 0xfa00f90, 0xfc00fb0, 0xfe00fd0, 0xf7f0ff0
  .long 0x76afedcb, 0x14523098, 0xff3fffff, 0xfffff4ff, 0x1f, 0x24130f, 0x1, 0x0
  .long 0xf1b0f0b, 0xf3b0f2b, 0xf5b0f4b, 0xf7b0f6b, 0xfab0f9b, 0xfcb0fbb, 0xfeb0fdb, 0xf8f0ffb
  .long 0x76afedcb, 0x45321098, 0xff0fffff, 0xfffff9ff, 0x4f, 0x29100f, 0x4, 0x0
  .long 0xf1c0f0e, 0xf3e0f2e, 0xf5e0f4e, 0xf7e0f6e, 0xfae0f8e, 0xfce0fbe, 0xfee0fde, 0xf9f0ffe
  .long 0x765fadcb, 0xe4321098, 0xffffffff, 0xfffffbff, 0xef, 0x2b1f0f, 0xe, 0x0
  .long 0xf130f03, 0xf330f23, 0xf530f43, 0xf730f63, 0xf930f83, 0xfc30fb3, 0xfe30fd3, 0xfaf0ff3
  .long 0x76afedcb, 0x84321095, 0xffbfffff, 0xfffff7ff, 0x8f, 0x271b0f, 0x8, 0x0
  .long 0xf180f08, 0xf370f28, 0xf580f48, 0xf780f68, 0xf980f88, 0xfc80fa8, 0xfe80fd8, 0xfbf0ff8
  .long 0x765fedcb, 0x943210a8, 0xffdfffff, 0xfffff2ff, 0x9f, 0x221d0f, 0x9, 0x0
  .long 0xf190f09, 0xf390f29, 0xf590f46, 0xf790f69, 0xf990f89, 0xfb90fa9, 0xfe90fd9, 0xfcf0ff9
  .long 0x765feadb, 0xc4321098, 0xffbfffff, 0xfffffdff, 0xcf, 0x2d1b0f, 0xc, 0x0
  .long 0xf110f01, 0xf310f21, 0xf510f41, 0xf710f61, 0xf910f81, 0xfb10fa1, 0xfe10fc1, 0xfdf0ff1
  .long 0x765fedcb, 0xa4321098, 0xffcfffff, 0xfffff5ff, 0xa5, 0x1c0f25, 0xa, 0x0
  .long 0x2450225, 0x2c502a5, 0x4950415, 0x6550605, 0x6d50685, 0x9750935, 0x9f509b5, 0xfef0f65
  .long 0x765aedcb, 0xf4321098, 0xff5fffff, 0xfffffcff, 0xff, 0x2c150f, 0xf, 0x0
  .long 0xf140f04, 0xf340f24, 0xf540f44, 0xf700f64, 0xf940f84, 0xfb40fa4, 0xfd40fc4, 0xfff0fe4
L_order_end:
.section .rodata,"a"
.p2align 6
.amdhsa_kernel standalone__kv_cache_quant_pre_rope_vs_post_rope__sampling_kernel
  .amdhsa_next_free_vgpr 243
  .amdhsa_next_free_sgpr 102
  .amdhsa_accum_offset 244
  .amdhsa_group_segment_fixed_size 0
  .amdhsa_kernarg_size 112
  .amdhsa_user_sgpr_count 2
  .amdhsa_user_sgpr_kernarg_segment_ptr 1
  .amdhsa_system_sgpr_workgroup_id_x 1
.end_amdhsa_kernel
```

```asm
; @launch grid=(256,1,1) block=(320,1,1) lds=162304
.amdgcn_target "amdgcn-amd-amdhsa--gfx950"
.text
.globl standalone__kv_cache_quant_pre_rope_vs_post_rope__sampling_kernel
.p2align 12
.type L_pad,@object
L_pad:
.fill 832, 4, 0xbf810000
.p2align 8
.type standalone__kv_cache_quant_pre_rope_vs_post_rope__sampling_kernel,@function
standalone__kv_cache_quant_pre_rope_vs_post_rope__sampling_kernel:
  s_cmpk_ge_u32 s2, 0x100
  s_cbranch_scc1 L_end
  s_load_dwordx16 s[4:19], s[0:1], 0
  s_load_dwordx8 s[20:27], s[0:1], 64
  s_load_dwordx4 s[28:31], s[0:1], 96
  v_readfirstlane_b32 s40, v0
  s_lshr_b32 s42, s2, 4
  s_cmp_lg_u32 s40, 0
  s_cbranch_scc1 L_s0
  s_setprio 3
  s_getpc_b64 s[64:65]
L_pc0:
  s_and_b32 s44, s2, 56
  v_and_b32 v20, 63, v0
  v_lshl_add_u32 v1, v20, 6, s44
  v_lshlrev_b32 v1, 4, v1
  v_min_u32 v1, L_order_end-L_pc0-1028, v1
  s_bfm_b64 exec, 43, 0
  global_load_dword v2, v1, s[64:65] offset:1024
  s_mov_b64 exec, -1
  v_min_u32 v21, 47, v20
  v_add_u32 v22, 24, v21
  v_subrev_u32 v23, 24, v21
  v_min_u32 v27, v22, v23
  s_mul_i32 s44, s42, 48
  v_add_lshl_u32 v22, v21, s44, 3
  v_add_lshl_u32 v23, v27, s44, 3
  v_lshlrev_b32 v26, 3, v21
  s_and_b32 s44, s2, 7
  s_lshr_b32 s45, s2, 3
  s_mul_i32 s68, s44, 96
  s_add_u32 s68, s68, s45
  v_and_b32 v3, 15, v21
  v_lshl_add_u32 v3, s68, 4, v3
  v_and_b32 v4, 48, v21
  v_lshl_add_u32 v3, v4, 5, v3
  v_lshlrev_b32 v3, 6, v3
  s_mul_i32 s68, s44, 98304
  v_subrev_u32 v12, s68, v3
  s_and_b32 s68, s45, 3
  s_lshl4_add_u32 s44, s68, s44
  s_lshr_b32 s45, s45, 2
  s_lshl_b32 s45, s45, 8
  s_add_u32 s44, s44, s45
  v_and_b32 v4, 7, v20
  v_lshl_add_u32 v4, s44, 3, v4
  v_and_b32 v5, 24, v20
  v_lshl_add_u32 v4, v5, 6, v4
  v_and_b32 v5, 32, v20
  v_lshl_add_u32 v4, v5, 1, v4
  v_lshlrev_b32 v4, 6, v4
  s_waitcnt lgkmcnt(0)
  global_load_dwordx2 v[108:109], v22, s[4:5]
  global_load_dwordx2 v[110:111], v23, s[4:5]
  global_load_dwordx2 v[104:105], v26, s[18:19]
  global_load_dwordx2 v[106:107], v26, s[20:21]
  v_lshlrev_b32 v27, 3, v27
  s_add_u32 s68, s42, 16
  s_mul_i32 s44, s68, 384
  s_add_u32 s32, s4, s44
  s_addc_u32 s33, s5, 0
  global_load_dwordx2 v[68:69], v26, s[32:33]
  global_load_dwordx2 v[70:71], v27, s[32:33]
  global_load_dword v5, v3, s[22:23]
  global_load_dword v6, v3, s[24:25]
  global_load_dword v7, v4, s[8:9]
  global_load_dword v8, v4, s[10:11]
  global_load_dword v9, v4, s[14:15]
  global_load_dword v10, v4, s[16:17]
  global_load_dword v11, v12, s[4:5]
  v_mov_b32 v14, 0
  v_cmp_gt_u32 vcc, 24, v21
  v_mov_b32 v48, 0
  v_mov_b32 v49, 0
  v_mov_b32 v50, 0
  v_mov_b32 v51, 0
  ds_write_b128 v14, v[48:51] offset:0
  ds_write_b128 v14, v[48:51] offset:16
  s_waitcnt lgkmcnt(0)
  s_barrier
  s_mov_b32 s66, 0xffff0000
  s_mov_b32 s67, 0x3dd53b95
  v_cndmask_b32_e64 v30, 1.0, -1.0, vcc
  v_lshlrev_b32 v35, 4, v21
  v_mov_b32 v28, v35
  v_lshlrev_b32 v29, 1, v27
  v_mov_b32 v22, 0x80008000
  v_cndmask_b32 v31, v14, v22, vcc
  v_mov_b32 v38, 1
  s_mov_b32 s43, 1
  s_waitcnt vmcnt(9)
  v_lshlrev_b32 v52, 16, v104
  v_and_b32 v53, s66, v104
  v_lshlrev_b32 v54, 16, v105
  v_and_b32 v55, s66, v105
  v_lshlrev_b32 v56, 16, v106
  v_and_b32 v57, s66, v106
  v_lshlrev_b32 v58, 16, v107
  v_and_b32 v59, s66, v107
L_hr:
  v_lshlrev_b32 v76, 16, v108
  v_and_b32 v77, s66, v108
  v_lshlrev_b32 v78, 16, v109
  v_and_b32 v79, s66, v109
  v_lshlrev_b32 v80, 16, v110
  v_and_b32 v81, s66, v110
  v_lshlrev_b32 v82, 16, v111
  v_and_b32 v83, s66, v111
  v_mul_f32 v76, v76, v52
  v_mul_f32 v77, v77, v53
  v_mul_f32 v78, v78, v54
  v_mul_f32 v79, v79, v55
  v_mul_f32 v80, v80, v56
  v_mul_f32 v81, v81, v57
  v_mul_f32 v82, v82, v58
  v_mul_f32 v83, v83, v59
  v_cvt_pk_bf16_f32 v84, v76, v80
  v_cvt_pk_bf16_f32 v85, v77, v81
  v_cvt_pk_bf16_f32 v86, v78, v82
  v_cvt_pk_bf16_f32 v87, v79, v83
  v_lshlrev_b32 v76, 16, v84
  v_and_b32 v80, s66, v84
  v_lshlrev_b32 v77, 16, v85
  v_and_b32 v81, s66, v85
  v_lshlrev_b32 v78, 16, v86
  v_and_b32 v82, s66, v86
  v_lshlrev_b32 v79, 16, v87
  v_and_b32 v83, s66, v87
  v_fma_f32 v76, v80, v30, v76
  v_fma_f32 v77, v81, v30, v77
  v_fma_f32 v78, v82, v30, v78
  v_fma_f32 v79, v83, v30, v79
  v_cvt_pk_bf16_f32 v84, v76, v77
  v_cvt_pk_bf16_f32 v85, v78, v79
  v_xor_b32 v86, v31, v84
  v_xor_b32 v87, v31, v85
  v_mov_b32 v22, s43
  ds_write_b16 v28, v84 offset:512
  ds_write_b16_d16_hi v28, v84 offset:516
  ds_write_b16 v28, v85 offset:520
  ds_write_b16_d16_hi v28, v85 offset:524
  ds_write_b16 v29, v86 offset:514
  ds_write_b16_d16_hi v29, v86 offset:518
  ds_write_b16 v29, v87 offset:522
  ds_write_b16_d16_hi v29, v87 offset:526
  ds_write_b32 v14, v22 offset:16
  v_add_u32 v28, 1024, v28
  v_add_u32 v29, 1024, v29
  v_and_b32 v28, 0xfff, v28
  v_and_b32 v29, 0xfff, v29
  s_cmp_eq_u32 s43, 2
  s_cbranch_scc1 L_helper
  s_mov_b32 s43, 2
  s_waitcnt vmcnt(7) lgkmcnt(0)
  v_mov_b32 v108, v68
  v_mov_b32 v109, v69
  v_mov_b32 v110, v70
  v_mov_b32 v111, v71
  s_branch L_hr
L_s0:
  v_subrev_u32 v0, 64, v0
  s_sub_u32 s40, s40, 64
  s_and_b32 s44, s2, 7
  s_lshl_b32 s44, s44, 8
  s_bfe_u32 s41, s2, 0x10003
  s_mul_i32 s45, s41, 43
  s_add_u32 s44, s44, s45
  s_mulk_i32 s44, 768
  v_lshl_add_u32 v212, v0, 4, s44
  v_add_u32 v213, 4096, v212
  v_add_u32 v214, 8192, v212
  v_add_u32 v215, 12288, v212
  v_add_u32 v216, 16384, v212
  v_add_u32 v217, 20480, v212
  v_add_u32 v218, 24576, v212
  s_lshr_b32 s40, s40, 6
  v_lshrrev_b32 v25, 4, v0
  v_and_b32 v24, 15, v0
  v_mul_u32_u24 v20, 11, v25
  v_lshrrev_b32 v20, 5, v20
  v_mad_i32_i24 v20, v20, -3, v25
  v_lshlrev_b32 v21, 4, v24
  v_lshl_add_u32 v15, v20, 8, v21
  v_add_u32 v20, 256, v15
  v_subrev_u32 v21, 512, v15
  v_min_u32 v16, v20, v21
  v_add_u32 v20, 512, v15
  v_subrev_u32 v21, 256, v15
  v_min_u32 v17, v20, v21
  v_cmp_gt_u32 vcc, 8, v24
  v_lshlrev_b32 v23, 3, v24
  v_lshrrev_b32 v22, 1, v15
  v_add3_u32 v20, v22, v23, 64
  v_subrev_u32 v21, 384, v20
  v_min_u32 v20, v20, v21
  v_sub_u32 v20, v20, v22
  v_cndmask_b32 v240, v20, v23, vcc
  v_lshrrev_b32 v22, 1, v16
  v_add3_u32 v20, v22, v23, 64
  v_subrev_u32 v21, 384, v20
  v_min_u32 v20, v20, v21
  v_sub_u32 v20, v20, v22
  v_cndmask_b32 v241, v20, v23, vcc
  v_lshrrev_b32 v22, 1, v17
  v_add3_u32 v20, v22, v23, 64
  v_subrev_u32 v21, 384, v20
  v_min_u32 v20, v20, v21
  v_sub_u32 v20, v20, v22
  v_cndmask_b32 v242, v20, v23, vcc
  s_mul_i32 s100, s40, 24576
  s_add_u32 s100, s100, 64000
  s_mul_i32 s44, s42, 1572864
  s_mov_b32 s34, 51904512
  s_mov_b32 s35, 0x20000
  s_mov_b32 s80, 25165824
  s_mov_b32 s3, 50331648
  s_waitcnt lgkmcnt(0)
  s_add_u32 s32, s6, s44
  s_addc_u32 s33, s7, 0
  v_mov_b32 v21, s22
  v_mov_b32 v28, s24
  v_cndmask_b32 v28, v28, v21, vcc
  v_mov_b32 v21, s23
  v_mov_b32 v29, s25
  v_cndmask_b32 v29, v29, v21, vcc
  s_add_u32 m0, s100, 0
  v_lshrrev_b32 v10, 1, v212
  v_add_u32 v10, v10, v240
  v_mad_u64_u32 v[30:31], s[64:65], v10, 1, v[28:29]
  global_load_lds_dwordx4 v[30:31], off
  buffer_load_dwordx4 v[68:71], v212, s[32:35], 0 offen nt
  buffer_load_dwordx4 v[72:75], v213, s[32:35], 0 offen nt
  s_add_u32 m0, s100, 1024
  v_lshrrev_b32 v10, 1, v213
  v_add_u32 v10, v10, v241
  v_mad_u64_u32 v[30:31], s[64:65], v10, 1, v[28:29]
  global_load_lds_dwordx4 v[30:31], off
  buffer_load_dwordx4 v[76:79], v214, s[32:35], 0 offen nt
  buffer_load_dwordx4 v[80:83], v212, s[32:35], s80 offen nt
  s_add_u32 m0, s100, 2048
  v_lshrrev_b32 v10, 1, v214
  v_add_u32 v10, v10, v242
  v_mad_u64_u32 v[30:31], s[64:65], v10, 1, v[28:29]
  global_load_lds_dwordx4 v[30:31], off
  buffer_load_dwordx4 v[84:87], v213, s[32:35], s80 offen nt
  s_barrier
  s_getpc_b64 s[82:83]
L_pc1:
  s_lshl_b32 s44, s2, 6
  s_add_u32 s44, s44, L_order-L_pc1
  s_add_u32 s82, s82, s44
  s_addc_u32 s83, s83, 0
  s_load_dwordx2 s[92:93], s[82:83], 0
  s_load_dwordx2 s[96:97], s[82:83], 8
  s_mov_b32 s94, 4000000
  s_mul_i32 s44, s41, 768
  s_add_u32 s44, s44, 32256
  v_add_u32 v20, s44, v212
  v_add_u32 v21, 65280, v212
  s_mul_i32 s45, s41, 3
  v_add_u32 v22, s45, v25
  v_cmp_ge_u32 s[48:49], v22, 17
  v_cmp_ge_u32 s[50:51], v22, 1
  v_cmp_ge_u32 s[52:53], v22, 18
  v_cmp_ge_u32 s[54:55], v22, 2
  v_add_u32 v235, 94208, v21
  v_add_u32 v234, 90112, v21
  v_add_u32 v233, 86016, v21
  v_add_u32 v232, 81920, v21
  v_add_u32 v231, 77824, v21
  v_add_u32 v230, 73728, v21
  v_add_u32 v229, 69632, v21
  v_cndmask_b32_e64 v228, v20, v21, s[54:55]
  v_add_u32 v228, 65536, v228
  v_cndmask_b32_e64 v227, v20, v21, s[52:53]
  v_add_u32 v227, 61440, v227
  v_add_u32 v226, 57344, v20
  v_add_u32 v225, 53248, v20
  v_add_u32 v224, 49152, v20
  v_add_u32 v223, 45056, v20
  v_add_u32 v222, 40960, v20
  v_add_u32 v221, 36864, v20
  v_cndmask_b32_e64 v220, v212, v20, s[50:51]
  v_add_u32 v220, 32768, v220
  v_cndmask_b32_e64 v219, v212, v20, s[48:49]
  v_add_u32 v219, 28672, v219
  v_lshrrev_b32 v22, 6, v0
  v_bfe_u32 v23, v0, 4, 2
  v_mov_b32 v14, 0
  v_and_b32 v20, 2, v0
  v_lshl_add_u32 v1, v20, 5, v25
  v_and_b32 v20, 1, v0
  v_lshl_add_u32 v1, v20, 5, v1
  v_and_b32 v20, 4, v0
  v_lshl_add_u32 v1, v20, 2, v1
  v_and_b32 v20, 8, v0
  v_mad_u32_u24 v1, v20, 48, v1
  v_lshlrev_b32 v1, 2, v1
  v_add_u32 v1, 45568, v1
  v_lshl_add_u32 v21, v24, 2, v23
  v_mul_u32_u24 v20, 192, v22
  v_add_lshl_u32 v3, v20, v21, 2
  v_add_u32 v3, 64000, v3
  v_lshlrev_b32 v6, 2, v22
  v_mov_b32 v32, 0
  v_mov_b32 v34, 0
  v_mov_b32 v33, 0
  v_mov_b32 v35, 0
  s_mov_b32 s48, 0x11111111
  s_mov_b32 s49, s48
  s_mov_b32 s50, 0x22222222
  s_mov_b32 s51, s50
  s_mov_b32 s52, 0x44444444
  s_mov_b32 s53, s52
  s_mov_b32 s54, 0x88888888
  s_mov_b32 s55, s54
  s_mov_b32 s56, 0x05040100
  s_mov_b32 s57, 0x07060302
  s_mov_b32 s38, 1572864
  s_mov_b32 s39, 0x20000
  v_lshlrev_b32 v21, 8, v23
  v_add_u32 v21, s100, v21
  v_lshl_add_u32 v12, v24, 3, v21
  s_getreg_b32 s81, hwreg(HW_REG_HW_ID, 13, 2)
  s_getreg_b32 s79, hwreg(HW_REG_HW_ID, 8, 4)
  s_getreg_b32 s46, hwreg(HW_REG_XCC_ID, 0, 3)
  s_mul_i32 s46, s46, 4352
  s_add_u32 s46, s46, 8126464
  s_add_u32 s44, s46, 2048
  v_mov_b32 v11, s44
  s_and_b32 s45, s81, 2
  s_lshl_b32 s45, s45, 9
  s_lshl_b32 s44, s40, 8
  s_add_u32 s44, s44, s45
  s_add_u32 s44, s44, s46
  s_add_u32 s44, s44, s79
  s_and_b32 s81, s81, 1
  s_lshl_b32 s81, s81, 4
  s_add_u32 s44, s44, s81
  v_mov_b32 v7, s44
  s_xor_b32 s45, s45, 1024
  s_add_u32 s46, s46, s45
  v_and_b32 v8, 1, v0
  v_lshl_add_u32 v8, v8, 4, s46
  v_bfe_u32 v21, v0, 1, 2
  v_mad_u32_u24 v21, v21, 4, v22
  v_add_u32 v9, 0, v21
  v_and_b32 v9, 3, v9
  v_lshl_add_u32 v236, v9, 8, v8
  v_add_u32 v9, 1, v21
  v_and_b32 v9, 3, v9
  v_lshl_add_u32 v237, v9, 8, v8
  v_add_u32 v9, 2, v21
  v_and_b32 v9, 3, v9
  v_lshl_add_u32 v238, v9, 8, v8
  v_add_u32 v9, 3, v21
  v_and_b32 v9, 3, v9
  v_lshl_add_u32 v239, v9, 8, v8
  s_mov_b32 s78, 0xfefefeff
  v_mov_b32 v36, 0
  v_mov_b32 v37, 0
  v_mov_b32 v38, 0
  v_mov_b32 v39, 0
  v_mov_b32 v40, 0
  v_mov_b32 v41, 0
  v_mov_b32 v42, 0
  v_mov_b32 v43, 0
  v_mov_b32 v26, 0
  v_mov_b32 v27, 0
  v_mov_b32 v8, 3
  s_cmp_lt_u32 s40, 4
  s_cselect_b64 s[60:61], 1, 0
  s_getreg_b32 s58, hwreg(HW_REG_XCC_ID, 0, 1)
  s_mul_i32 s58, s58, -6
  s_add_u32 s58, s58, 3
  s_mov_b32 s91, s58
  s_mov_b32 s69, 0
  s_mov_b32 s95, 0
  buffer_load_dwordx4 v[88:91], v214, s[32:35], s80 offen nt
  s_add_u32 m0, s100, 3072
  v_lshrrev_b32 v10, 1, v215
  v_add_u32 v10, v10, v240
  v_mad_u64_u32 v[30:31], s[64:65], v10, 1, v[28:29]
  s_waitcnt vmcnt(8)
  global_load_lds_dwordx4 v[30:31], off
  s_waitcnt vmcnt(8)
  buffer_load_dwordx4 v[92:95], v215, s[32:35], 0 offen nt
  s_add_u32 m0, s100, 4096
  v_lshrrev_b32 v10, 1, v216
  v_add_u32 v10, v10, v241
  v_mad_u64_u32 v[30:31], s[64:65], v10, 1, v[28:29]
  s_waitcnt vmcnt(8)
  global_load_lds_dwordx4 v[30:31], off
  s_waitcnt vmcnt(8)
  buffer_load_dwordx4 v[96:99], v216, s[32:35], 0 offen nt
  s_mov_b32 s47, 1
  ds_read_b32 v4, v14 offset:16
L_fqz:
  s_waitcnt lgkmcnt(0)
  v_readfirstlane_b32 s46, v4
  s_cmp_ge_u32 s46, s47
  s_cbranch_scc1 L_fqz_ok
  s_cmp_eq_u32 s94, 0
  s_cbranch_scc1 L_fqz_ok
  s_sub_u32 s94, s94, 1
  ds_read_b32 v4, v14 offset:16
  s_branch L_fqz
L_fqz_ok:
  ds_read_b128 v[44:47], v15 offset:512
  ds_read_b128 v[48:51], v16 offset:512
  ds_read_b128 v[52:55], v17 offset:512
  s_add_u32 m0, s100, 5120
  v_lshrrev_b32 v10, 1, v217
  v_add_u32 v10, v10, v242
  v_mad_u64_u32 v[30:31], s[64:65], v10, 1, v[28:29]
  s_waitcnt vmcnt(8)
  global_load_lds_dwordx4 v[30:31], off
  s_waitcnt vmcnt(7)
  ds_read_b64 v[116:117], v12 offset:0
  ds_read_b64 v[118:119], v12 offset:128
  ds_read_b64 v[120:121], v12 offset:1024
  ds_read_b64 v[122:123], v12 offset:1152
  ds_read_b64 v[124:125], v12 offset:2048
  ds_read_b64 v[126:127], v12 offset:2176
  buffer_load_dwordx4 v[100:103], v217, s[32:35], 0 offen nt
L_it0:
  s_mov_b32 s47, 2
  ds_read_b32 v4, v14 offset:16
L_fq0:
  s_waitcnt lgkmcnt(0)
  v_readfirstlane_b32 s46, v4
  s_cmp_ge_u32 s46, s47
  s_cbranch_scc1 L_fq0_ok
  s_cmp_eq_u32 s94, 0
  s_cbranch_scc1 L_fq0_ok
  s_sub_u32 s94, s94, 1
  ds_read_b32 v4, v14 offset:16
  s_branch L_fq0
L_fq0_ok:
  ds_read_b128 v[56:59], v15 offset:1536
  ds_read_b128 v[60:63], v16 offset:1536
  ds_read_b128 v[64:67], v17 offset:1536
  v_perm_b32 v13, v118, v116, s56
  v_perm_b32 v118, v118, v116, s57
  v_perm_b32 v116, v119, v117, s56
  v_perm_b32 v119, v119, v117, s57
  v_dot2_f32_bf16 v22, v13, v44, 0
  v_dot2_f32_bf16 v23, v118, v45, 0
  v_dot2_f32_bf16 v24, v116, v46, 0
  v_dot2_f32_bf16 v25, v119, v47, 0
  v_cvt_f32_i32 v68, v68
  v_cvt_f32_i32 v69, v69
  v_cvt_f32_i32 v70, v70
  v_cvt_f32_i32 v71, v71
  v_pk_mul_f32 v[20:21], v[68:69], v[22:23]
  v_pk_add_f32 v[18:19], v[22:23], v[24:25]
  v_pk_fma_f32 v[20:21], v[70:71], v[24:25], v[20:21]
  v_add_f32 v18, v18, v19
  v_add_f32 v20, v20, v21
  s_add_u32 m0, s100, 6144
  v_lshrrev_b32 v10, 1, v218
  v_add_u32 v10, v10, v240
  v_mad_u64_u32 v[30:31], s[64:65], v10, 1, v[28:29]
  global_load_lds_dwordx4 v[30:31], off
  s_waitcnt vmcnt(8)
  buffer_load_dwordx4 v[104:107], v215, s[32:35], s80 offen nt
  v_perm_b32 v117, v122, v120, s56
  v_perm_b32 v122, v122, v120, s57
  v_perm_b32 v120, v123, v121, s56
  v_perm_b32 v123, v123, v121, s57
  v_dot2_f32_bf16 v22, v117, v48, 0
  v_add_f32_dpp v34, v18, v18 row_ror:8 row_mask:0xf bank_mask:0xc
  v_add_f32_dpp v34, v20, v20 row_ror:8 row_mask:0xf bank_mask:0x3
  v_dot2_f32_bf16 v23, v122, v49, 0
  v_dot2_f32_bf16 v24, v120, v50, 0
  v_dot2_f32_bf16 v25, v123, v51, 0
  v_cvt_f32_i32 v72, v72
  v_cvt_f32_i32 v73, v73
  v_cvt_f32_i32 v74, v74
  v_cvt_f32_i32 v75, v75
  v_pk_mul_f32 v[20:21], v[72:73], v[22:23]
  v_pk_add_f32 v[18:19], v[22:23], v[24:25]
  v_pk_fma_f32 v[20:21], v[74:75], v[24:25], v[20:21]
  v_add_f32 v18, v18, v19
  v_add_f32 v20, v20, v21
  s_waitcnt vmcnt(8)
  buffer_load_dwordx4 v[108:111], v216, s[32:35], s80 offen nt
  v_perm_b32 v121, v126, v124, s56
  v_perm_b32 v126, v126, v124, s57
  v_perm_b32 v124, v127, v125, s56
  v_perm_b32 v127, v127, v125, s57
  v_dot2_f32_bf16 v22, v121, v52, 0
  v_add_f32_dpp v21, v18, v18 row_ror:8 row_mask:0xf bank_mask:0xc
  v_add_f32_dpp v21, v20, v20 row_ror:8 row_mask:0xf bank_mask:0x3
  v_add_f32_dpp v20, v34, v34 row_half_mirror row_mask:0xf bank_mask:0x5
  v_dot2_f32_bf16 v23, v126, v53, 0
  v_add_f32_dpp v20, v21, v21 row_half_mirror row_mask:0xf bank_mask:0xa
  v_dot2_f32_bf16 v24, v124, v54, 0
  v_dot2_f32_bf16 v25, v127, v55, 0
  v_add_f32_dpp v20, v20, v20 quad_perm:[2,3,0,1] row_mask:0xf bank_mask:0xf
  v_cvt_f32_i32 v76, v76
  v_cvt_f32_i32 v77, v77
  v_add_f32_dpp v20, v20, v20 quad_perm:[1,0,3,2] row_mask:0xf bank_mask:0xf
  v_cndmask_b32_e64 v32, v32, v20, s[48:49]
  v_cvt_f32_i32 v78, v78
  v_cvt_f32_i32 v79, v79
  v_pk_mul_f32 v[20:21], v[76:77], v[22:23]
  v_pk_add_f32 v[18:19], v[22:23], v[24:25]
  v_pk_fma_f32 v[20:21], v[78:79], v[24:25], v[20:21]
  v_add_f32 v18, v18, v19
  v_add_f32 v20, v20, v21
  s_add_u32 m0, s100, 7168
  v_lshrrev_b32 v10, 1, v219
  v_add_u32 v10, v10, v241
  v_mad_u64_u32 v[30:31], s[64:65], v10, 1, v[28:29]
  s_waitcnt vmcnt(8)
  global_load_lds_dwordx4 v[30:31], off
  s_waitcnt vmcnt(8)
  buffer_load_dwordx4 v[112:115], v217, s[32:35], s80 offen nt
L_it1:
  s_waitcnt lgkmcnt(0)
  v_dot2_f32_bf16 v22, v13, v56, 0
  v_add_f32_dpp v34, v18, v18 row_ror:8 row_mask:0xf bank_mask:0xc
  v_add_f32_dpp v34, v20, v20 row_ror:8 row_mask:0xf bank_mask:0x3
  v_dot2_f32_bf16 v23, v118, v57, 0
  v_dot2_f32_bf16 v24, v116, v58, 0
  v_dot2_f32_bf16 v25, v119, v59, 0
  v_cvt_f32_i32 v80, v80
  v_cvt_f32_i32 v81, v81
  v_cvt_f32_i32 v82, v82
  v_cvt_f32_i32 v83, v83
  v_pk_mul_f32 v[20:21], v[80:81], v[22:23]
  v_pk_add_f32 v[18:19], v[22:23], v[24:25]
  v_pk_fma_f32 v[20:21], v[82:83], v[24:25], v[20:21]
  v_add_f32 v18, v18, v19
  v_add_f32 v20, v20, v21
  s_waitcnt vmcnt(8)
  buffer_load_dwordx4 v[68:71], v218, s[32:35], 0 offen nt
  v_dot2_f32_bf16 v22, v117, v60, 0
  v_add_f32_dpp v35, v18, v18 row_ror:8 row_mask:0xf bank_mask:0xc
  v_add_f32_dpp v35, v20, v20 row_ror:8 row_mask:0xf bank_mask:0x3
  v_dot2_f32_bf16 v23, v122, v61, 0
  v_dot2_f32_bf16 v24, v120, v62, 0
  v_dot2_f32_bf16 v25, v123, v63, 0
  v_cvt_f32_i32 v84, v84
  v_cvt_f32_i32 v85, v85
  v_cvt_f32_i32 v86, v86
  v_cvt_f32_i32 v87, v87
  v_pk_mul_f32 v[20:21], v[84:85], v[22:23]
  v_pk_add_f32 v[18:19], v[22:23], v[24:25]
  v_pk_fma_f32 v[20:21], v[86:87], v[24:25], v[20:21]
  v_add_f32 v18, v18, v19
  v_add_f32 v20, v20, v21
  s_add_u32 m0, s100, 8192
  v_lshrrev_b32 v10, 1, v220
  v_add_u32 v10, v10, v242
  v_mad_u64_u32 v[30:31], s[64:65], v10, 1, v[28:29]
  s_waitcnt vmcnt(8)
  global_load_lds_dwordx4 v[30:31], off
  s_waitcnt vmcnt(8)
  buffer_load_dwordx4 v[72:75], v219, s[32:35], 0 offen nt
  ds_read_b64 v[128:129], v12 offset:3072
  ds_read_b64 v[130:131], v12 offset:3200
  ds_read_b64 v[132:133], v12 offset:4096
  ds_read_b64 v[134:135], v12 offset:4224
  ds_read_b64 v[136:137], v12 offset:5120
  ds_read_b64 v[138:139], v12 offset:5248
  v_dot2_f32_bf16 v22, v121, v64, 0
  v_add_f32_dpp v21, v18, v18 row_ror:8 row_mask:0xf bank_mask:0xc
  v_add_f32_dpp v21, v20, v20 row_ror:8 row_mask:0xf bank_mask:0x3
  v_add_f32_dpp v20, v35, v35 row_half_mirror row_mask:0xf bank_mask:0x5
  v_dot2_f32_bf16 v23, v126, v65, 0
  v_add_f32_dpp v20, v21, v21 row_half_mirror row_mask:0xf bank_mask:0xa
  v_dot2_f32_bf16 v24, v124, v66, 0
  v_dot2_f32_bf16 v25, v127, v67, 0
  v_add_f32_dpp v20, v20, v20 quad_perm:[2,3,0,1] row_mask:0xf bank_mask:0xf
  v_cvt_f32_i32 v88, v88
  v_cvt_f32_i32 v89, v89
  v_add_f32_dpp v20, v20, v20 quad_perm:[1,0,3,2] row_mask:0xf bank_mask:0xf
  v_cndmask_b32_e64 v33, v33, v20, s[48:49]
  v_cvt_f32_i32 v90, v90
  v_cvt_f32_i32 v91, v91
  v_pk_mul_f32 v[20:21], v[88:89], v[22:23]
  v_pk_add_f32 v[18:19], v[22:23], v[24:25]
  v_pk_fma_f32 v[20:21], v[90:91], v[24:25], v[20:21]
  v_add_f32 v18, v18, v19
  v_add_f32 v20, v20, v21
  s_waitcnt vmcnt(8)
  buffer_load_dwordx4 v[76:79], v220, s[32:35], 0 offen nt
L_it2:
  s_waitcnt lgkmcnt(0)
  ds_read_b32 v4, v14 offset:24
  v_perm_b32 v125, v130, v128, s56
  v_perm_b32 v130, v130, v128, s57
  v_perm_b32 v128, v131, v129, s56
  v_perm_b32 v131, v131, v129, s57
  v_dot2_f32_bf16 v22, v125, v44, 0
  v_add_f32_dpp v35, v18, v18 row_ror:8 row_mask:0xf bank_mask:0xc
  v_add_f32_dpp v35, v20, v20 row_ror:8 row_mask:0xf bank_mask:0x3
  v_dot2_f32_bf16 v23, v130, v45, 0
  v_dot2_f32_bf16 v24, v128, v46, 0
  v_dot2_f32_bf16 v25, v131, v47, 0
  v_cvt_f32_i32 v92, v92
  v_cvt_f32_i32 v93, v93
  v_cvt_f32_i32 v94, v94
  v_cvt_f32_i32 v95, v95
  v_pk_mul_f32 v[20:21], v[92:93], v[22:23]
  v_pk_add_f32 v[18:19], v[22:23], v[24:25]
  v_pk_fma_f32 v[20:21], v[94:95], v[24:25], v[20:21]
  v_add_f32 v18, v18, v19
  v_add_f32 v20, v20, v21
  s_add_u32 m0, s100, 9216
  v_lshrrev_b32 v10, 1, v221
  v_add_u32 v10, v10, v240
  v_mad_u64_u32 v[30:31], s[64:65], v10, 1, v[28:29]
  s_waitcnt vmcnt(8)
  global_load_lds_dwordx4 v[30:31], off
  s_waitcnt vmcnt(8)
  buffer_load_dwordx4 v[80:83], v218, s[32:35], s80 offen nt
  v_perm_b32 v129, v134, v132, s56
  v_perm_b32 v134, v134, v132, s57
  v_perm_b32 v132, v135, v133, s56
  v_perm_b32 v135, v135, v133, s57
  v_dot2_f32_bf16 v22, v129, v48, 0
  v_add_f32_dpp v21, v18, v18 row_ror:8 row_mask:0xf bank_mask:0xc
  v_add_f32_dpp v21, v20, v20 row_ror:8 row_mask:0xf bank_mask:0x3
  v_add_f32_dpp v20, v34, v34 row_half_mirror row_mask:0xf bank_mask:0x5
  v_dot2_f32_bf16 v23, v134, v49, 0
  v_add_f32_dpp v20, v21, v21 row_half_mirror row_mask:0xf bank_mask:0xa
  v_dot2_f32_bf16 v24, v132, v50, 0
  v_dot2_f32_bf16 v25, v135, v51, 0
  v_add_f32_dpp v20, v20, v20 quad_perm:[2,3,0,1] row_mask:0xf bank_mask:0xf
  v_cvt_f32_i32 v96, v96
  v_cvt_f32_i32 v97, v97
  v_add_f32_dpp v20, v20, v20 quad_perm:[1,0,3,2] row_mask:0xf bank_mask:0xf
  v_cndmask_b32_e64 v32, v32, v20, s[50:51]
  v_cvt_f32_i32 v98, v98
  v_cvt_f32_i32 v99, v99
  v_pk_mul_f32 v[20:21], v[96:97], v[22:23]
  v_pk_add_f32 v[18:19], v[22:23], v[24:25]
  v_pk_fma_f32 v[20:21], v[98:99], v[24:25], v[20:21]
  v_add_f32 v18, v18, v19
  v_add_f32 v20, v20, v21
  s_waitcnt vmcnt(8)
  buffer_load_dwordx4 v[84:87], v219, s[32:35], s80 offen nt
  v_perm_b32 v133, v138, v136, s56
  v_perm_b32 v138, v138, v136, s57
  v_perm_b32 v136, v139, v137, s56
  v_perm_b32 v139, v139, v137, s57
  v_dot2_f32_bf16 v22, v133, v52, 0
  v_add_f32_dpp v34, v18, v18 row_ror:8 row_mask:0xf bank_mask:0xc
  v_add_f32_dpp v34, v20, v20 row_ror:8 row_mask:0xf bank_mask:0x3
  v_dot2_f32_bf16 v23, v138, v53, 0
  v_dot2_f32_bf16 v24, v136, v54, 0
  v_dot2_f32_bf16 v25, v139, v55, 0
  v_cvt_f32_i32 v100, v100
  v_cvt_f32_i32 v101, v101
  v_cvt_f32_i32 v102, v102
  v_cvt_f32_i32 v103, v103
  v_pk_mul_f32 v[20:21], v[100:101], v[22:23]
  v_pk_add_f32 v[18:19], v[22:23], v[24:25]
  v_pk_fma_f32 v[20:21], v[102:103], v[24:25], v[20:21]
  v_add_f32 v18, v18, v19
  v_add_f32 v20, v20, v21
  s_add_u32 m0, s100, 10240
  v_lshrrev_b32 v10, 1, v222
  v_add_u32 v10, v10, v241
  v_mad_u64_u32 v[30:31], s[64:65], v10, 1, v[28:29]
  s_waitcnt vmcnt(8)
  global_load_lds_dwordx4 v[30:31], off
  s_waitcnt vmcnt(8)
  buffer_load_dwordx4 v[88:91], v220, s[32:35], s80 offen nt
L_it3:
  s_mov_b32 s47, 1
L_fc:
  s_waitcnt lgkmcnt(0)
  v_readfirstlane_b32 s46, v4
  s_cmp_ge_u32 s46, s47
  s_cbranch_scc1 L_fc_ok
  s_cmp_eq_u32 s94, 0
  s_cbranch_scc1 L_fc_ok
  s_sub_u32 s94, s94, 1
  ds_read_b32 v4, v14 offset:24
  s_branch L_fc
L_fc_ok:
  s_add_u32 s44, s78, 0x03030303
  v_msad_u8 v9, s78, v40, 0
  v_msad_u8 v10, s44, v40, 0
  v_msad_u8 v9, s78, v41, v9
  v_msad_u8 v10, s44, v41, v10
  v_msad_u8 v9, s78, v42, v9
  v_msad_u8 v10, s44, v42, v10
  s_mov_b64 exec, 3
  global_store_byte v7, v8, s[30:31]
  global_load_dwordx3 v[40:42], v239, s[30:31] sc1
  v_sub_u32 v9, v9, v10
  v_add_u32 v8, 1, v8
  s_mov_b64 exec, -1
  v_readlane_b32 s66, v9, 0
  v_readlane_b32 s67, v9, 1
  s_add_u32 s78, s78, 0x01010101
  s_lshl1_add_u32 s69, s91, s95
  s_add_u32 s95, s66, s67
  s_mov_b32 s69, 0
  v_dot2_f32_bf16 v22, v125, v56, 0
  v_add_f32_dpp v21, v18, v18 row_ror:8 row_mask:0xf bank_mask:0xc
  v_add_f32_dpp v21, v20, v20 row_ror:8 row_mask:0xf bank_mask:0x3
  v_add_f32_dpp v20, v34, v34 row_half_mirror row_mask:0xf bank_mask:0x5
  v_dot2_f32_bf16 v23, v130, v57, 0
  v_add_f32_dpp v20, v21, v21 row_half_mirror row_mask:0xf bank_mask:0xa
  v_dot2_f32_bf16 v24, v128, v58, 0
  v_dot2_f32_bf16 v25, v131, v59, 0
  v_add_f32_dpp v20, v20, v20 quad_perm:[2,3,0,1] row_mask:0xf bank_mask:0xf
  v_cvt_f32_i32 v104, v104
  v_cvt_f32_i32 v105, v105
  v_add_f32_dpp v20, v20, v20 quad_perm:[1,0,3,2] row_mask:0xf bank_mask:0xf
  v_cndmask_b32_e64 v32, v32, v20, s[52:53]
  v_cvt_f32_i32 v106, v106
  v_cvt_f32_i32 v107, v107
  v_pk_mul_f32 v[20:21], v[104:105], v[22:23]
  v_pk_add_f32 v[18:19], v[22:23], v[24:25]
  v_pk_fma_f32 v[20:21], v[106:107], v[24:25], v[20:21]
  v_add_f32 v18, v18, v19
  v_add_f32 v20, v20, v21
  s_cmpk_gt_i32 s69, 0x31
  s_cbranch_scc1 L_p2_4
  s_cmpk_gt_i32 s69, 0xffed
  s_cbranch_scc1 L_p2_1
  s_waitcnt vmcnt(6)
L_p2_1:
  s_waitcnt vmcnt(8)
L_p2_4:
  s_waitcnt vmcnt(9)
  buffer_load_dwordx4 v[92:95], v221, s[32:35], 0 offen nt
  v_dot2_f32_bf16 v22, v129, v60, 0
  v_add_f32_dpp v21, v18, v18 row_ror:8 row_mask:0xf bank_mask:0xc
  v_add_f32_dpp v21, v20, v20 row_ror:8 row_mask:0xf bank_mask:0x3
  v_add_f32_dpp v20, v35, v35 row_half_mirror row_mask:0xf bank_mask:0x5
  v_dot2_f32_bf16 v23, v134, v61, 0
  v_add_f32_dpp v20, v21, v21 row_half_mirror row_mask:0xf bank_mask:0xa
  v_dot2_f32_bf16 v24, v132, v62, 0
  v_dot2_f32_bf16 v25, v135, v63, 0
  v_add_f32_dpp v20, v20, v20 quad_perm:[2,3,0,1] row_mask:0xf bank_mask:0xf
  v_cvt_f32_i32 v108, v108
  v_cvt_f32_i32 v109, v109
  v_add_f32_dpp v20, v20, v20 quad_perm:[1,0,3,2] row_mask:0xf bank_mask:0xf
  v_cndmask_b32_e64 v33, v33, v20, s[50:51]
  v_cvt_f32_i32 v110, v110
  v_cvt_f32_i32 v111, v111
  v_pk_mul_f32 v[20:21], v[108:109], v[22:23]
  v_pk_add_f32 v[18:19], v[22:23], v[24:25]
  v_pk_fma_f32 v[20:21], v[110:111], v[24:25], v[20:21]
  v_add_f32 v18, v18, v19
  v_add_f32 v20, v20, v21
  s_add_u32 m0, s100, 11264
  v_lshrrev_b32 v10, 1, v223
  v_add_u32 v10, v10, v242
  v_mad_u64_u32 v[30:31], s[64:65], v10, 1, v[28:29]
  global_load_lds_dwordx4 v[30:31], off
  s_cmpk_gt_i32 s69, 0x31
  s_cbranch_scc1 L_p3_4
  s_cmpk_gt_i32 s69, 0xb
  s_cbranch_scc1 L_p3_2
  s_waitcnt vmcnt(8)
L_p3_2:
  s_waitcnt vmcnt(10)
L_p3_4:
  s_waitcnt vmcnt(11)
  buffer_load_dwordx4 v[96:99], v222, s[32:35], 0 offen nt
  s_waitcnt vmcnt(11)
  ds_read_b64 v[140:141], v12 offset:6144
  ds_read_b64 v[142:143], v12 offset:6272
  ds_read_b64 v[144:145], v12 offset:7168
  ds_read_b64 v[146:147], v12 offset:7296
  ds_read_b64 v[148:149], v12 offset:8192
  ds_read_b64 v[150:151], v12 offset:8320
  v_dot2_f32_bf16 v22, v133, v64, 0
  v_add_f32_dpp v35, v18, v18 row_ror:8 row_mask:0xf bank_mask:0xc
  v_add_f32_dpp v35, v20, v20 row_ror:8 row_mask:0xf bank_mask:0x3
  v_dot2_f32_bf16 v23, v138, v65, 0
  v_dot2_f32_bf16 v24, v136, v66, 0
  v_dot2_f32_bf16 v25, v139, v67, 0
  v_cvt_f32_i32 v112, v112
  v_cvt_f32_i32 v113, v113
  v_cvt_f32_i32 v114, v114
  v_cvt_f32_i32 v115, v115
  v_pk_mul_f32 v[20:21], v[112:113], v[22:23]
  v_pk_add_f32 v[18:19], v[22:23], v[24:25]
  v_pk_fma_f32 v[20:21], v[114:115], v[24:25], v[20:21]
  v_add_f32 v18, v18, v19
  v_add_f32 v20, v20, v21
  s_cmpk_gt_i32 s69, 0x31
  s_cbranch_scc1 L_p4_4
  s_cmpk_gt_i32 s69, 0x1d
  s_cbranch_scc1 L_p4_3
  s_cmpk_gt_i32 s69, 0xffcd
  s_cbranch_scc1 L_p4_0
  s_waitcnt vmcnt(8)
L_p4_0:
  s_waitcnt vmcnt(9)
L_p4_3:
  s_waitcnt vmcnt(11)
L_p4_4:
  s_waitcnt vmcnt(12)
  buffer_load_dwordx4 v[100:103], v223, s[32:35], 0 offen nt
L_it4:
  s_waitcnt lgkmcnt(0)
  s_add_u32 s44, s78, 0x03030303
  v_msad_u8 v9, s78, v36, 0
  v_msad_u8 v10, s44, v36, 0
  v_msad_u8 v9, s78, v37, v9
  v_msad_u8 v10, s44, v37, v10
  v_msad_u8 v9, s78, v38, v9
  v_msad_u8 v10, s44, v38, v10
  s_mov_b64 exec, 3
  global_store_byte v7, v8, s[30:31]
  global_load_dwordx3 v[36:38], v236, s[30:31] sc1
  v_sub_u32 v9, v9, v10
  v_add_u32 v8, 1, v8
  s_mov_b64 exec, -1
  v_readlane_b32 s66, v9, 0
  v_readlane_b32 s67, v9, 1
  s_add_u32 s78, s78, 0x01010101
  s_lshl1_add_u32 s69, s91, s95
  s_add_u32 s95, s66, s67
  s_mov_b32 s69, 0
  v_perm_b32 v137, v142, v140, s56
  v_perm_b32 v142, v142, v140, s57
  v_perm_b32 v140, v143, v141, s56
  v_perm_b32 v143, v143, v141, s57
  v_dot2_f32_bf16 v22, v137, v44, 0
  v_add_f32_dpp v21, v18, v18 row_ror:8 row_mask:0xf bank_mask:0xc
  v_add_f32_dpp v21, v20, v20 row_ror:8 row_mask:0xf bank_mask:0x3
  v_add_f32_dpp v20, v35, v35 row_half_mirror row_mask:0xf bank_mask:0x5
  v_dot2_f32_bf16 v23, v142, v45, 0
  v_add_f32_dpp v20, v21, v21 row_half_mirror row_mask:0xf bank_mask:0xa
  v_dot2_f32_bf16 v24, v140, v46, 0
  v_dot2_f32_bf16 v25, v143, v47, 0
  v_add_f32_dpp v20, v20, v20 quad_perm:[2,3,0,1] row_mask:0xf bank_mask:0xf
  v_cvt_f32_i32 v68, v68
  v_cvt_f32_i32 v69, v69
  v_add_f32_dpp v20, v20, v20 quad_perm:[1,0,3,2] row_mask:0xf bank_mask:0xf
  v_cndmask_b32_e64 v33, v33, v20, s[52:53]
  v_cvt_f32_i32 v70, v70
  v_cvt_f32_i32 v71, v71
  v_pk_mul_f32 v[20:21], v[68:69], v[22:23]
  v_pk_add_f32 v[18:19], v[22:23], v[24:25]
  v_pk_fma_f32 v[20:21], v[70:71], v[24:25], v[20:21]
  v_add_f32 v18, v18, v19
  v_add_f32 v20, v20, v21
  s_add_u32 m0, s100, 12288
  v_lshrrev_b32 v10, 1, v224
  v_add_u32 v10, v10, v240
  v_mad_u64_u32 v[30:31], s[64:65], v10, 1, v[28:29]
  global_load_lds_dwordx4 v[30:31], off
  s_cmpk_gt_i32 s69, 0x31
  s_cbranch_scc1 L_p5_4
  s_cmpk_gt_i32 s69, 0xffed
  s_cbranch_scc1 L_p5_1
  s_waitcnt vmcnt(7)
L_p5_1:
  s_waitcnt vmcnt(10)
L_p5_4:
  s_waitcnt vmcnt(12)
  buffer_load_dwordx4 v[104:107], v221, s[32:35], s80 offen nt
  v_perm_b32 v141, v146, v144, s56
  v_perm_b32 v146, v146, v144, s57
  v_perm_b32 v144, v147, v145, s56
  v_perm_b32 v147, v147, v145, s57
  v_dot2_f32_bf16 v22, v141, v48, 0
  v_add_f32_dpp v34, v18, v18 row_ror:8 row_mask:0xf bank_mask:0xc
  v_add_f32_dpp v34, v20, v20 row_ror:8 row_mask:0xf bank_mask:0x3
  v_dot2_f32_bf16 v23, v146, v49, 0
  v_dot2_f32_bf16 v24, v144, v50, 0
  v_dot2_f32_bf16 v25, v147, v51, 0
  v_cvt_f32_i32 v72, v72
  v_cvt_f32_i32 v73, v73
  v_cvt_f32_i32 v74, v74
  v_cvt_f32_i32 v75, v75
  v_pk_mul_f32 v[20:21], v[72:73], v[22:23]
  v_pk_add_f32 v[18:19], v[22:23], v[24:25]
  v_pk_fma_f32 v[20:21], v[74:75], v[24:25], v[20:21]
  v_add_f32 v18, v18, v19
  v_add_f32 v20, v20, v21
  s_cmpk_gt_i32 s69, 0x31
  s_cbranch_scc1 L_p6_4
  s_cmpk_gt_i32 s69, 0xb
  s_cbranch_scc1 L_p6_2
  s_waitcnt vmcnt(8)
L_p6_2:
  s_waitcnt vmcnt(11)
L_p6_4:
  s_waitcnt vmcnt(13)
  buffer_load_dwordx4 v[108:111], v222, s[32:35], s80 offen nt
  v_perm_b32 v145, v150, v148, s56
  v_perm_b32 v150, v150, v148, s57
  v_perm_b32 v148, v151, v149, s56
  v_perm_b32 v151, v151, v149, s57
  v_dot2_f32_bf16 v22, v145, v52, 0
  v_add_f32_dpp v21, v18, v18 row_ror:8 row_mask:0xf bank_mask:0xc
  v_add_f32_dpp v21, v20, v20 row_ror:8 row_mask:0xf bank_mask:0x3
  v_add_f32_dpp v20, v34, v34 row_half_mirror row_mask:0xf bank_mask:0x5
  v_dot2_f32_bf16 v23, v150, v53, 0
  v_add_f32_dpp v20, v21, v21 row_half_mirror row_mask:0xf bank_mask:0xa
  v_dot2_f32_bf16 v24, v148, v54, 0
  v_dot2_f32_bf16 v25, v151, v55, 0
  v_add_f32_dpp v20, v20, v20 quad_perm:[2,3,0,1] row_mask:0xf bank_mask:0xf
  v_cvt_f32_i32 v76, v76
  v_cvt_f32_i32 v77, v77
  v_add_f32_dpp v20, v20, v20 quad_perm:[1,0,3,2] row_mask:0xf bank_mask:0xf
  v_cndmask_b32_e64 v32, v32, v20, s[54:55]
  ds_write_b32 v1, v32 offset:0
  v_cvt_f32_i32 v78, v78
  v_cvt_f32_i32 v79, v79
  v_pk_mul_f32 v[20:21], v[76:77], v[22:23]
  v_pk_add_f32 v[18:19], v[22:23], v[24:25]
  v_pk_fma_f32 v[20:21], v[78:79], v[24:25], v[20:21]
  v_add_f32 v18, v18, v19
  v_add_f32 v20, v20, v21
  s_add_u32 m0, s100, 13312
  v_lshrrev_b32 v10, 1, v225
  v_add_u32 v10, v10, v241
  v_mad_u64_u32 v[30:31], s[64:65], v10, 1, v[28:29]
  global_load_lds_dwordx4 v[30:31], off
  s_cmpk_gt_i32 s69, 0x31
  s_cbranch_scc1 L_p7_4
  s_cmpk_gt_i32 s69, 0x1d
  s_cbranch_scc1 L_p7_3
  s_cmpk_gt_i32 s69, 0xffcd
  s_cbranch_scc1 L_p7_0
  s_waitcnt vmcnt(8)
L_p7_0:
  s_waitcnt vmcnt(10)
L_p7_3:
  s_waitcnt vmcnt(13)
L_p7_4:
  s_waitcnt vmcnt(15)
  buffer_load_dwordx4 v[112:115], v223, s[32:35], s80 offen nt
L_it5:
  s_waitcnt lgkmcnt(0)
  s_waitcnt vmcnt(10)
  s_add_u32 s44, s78, 0x03030303
  v_msad_u8 v9, s78, v40, 0
  v_msad_u8 v10, s44, v40, 0
  v_msad_u8 v9, s78, v41, v9
  v_msad_u8 v10, s44, v41, v10
  v_msad_u8 v9, s78, v42, v9
  v_msad_u8 v10, s44, v42, v10
  s_mov_b64 exec, 3
  global_load_dwordx2 v[26:27], v11, s[30:31] sc1
  global_store_byte v7, v8, s[30:31]
  global_load_dwordx3 v[40:42], v237, s[30:31] sc1
  v_sub_u32 v9, v9, v10
  v_add_u32 v8, 1, v8
  s_mov_b64 exec, -1
  v_readlane_b32 s66, v9, 0
  v_readlane_b32 s67, v9, 1
  s_add_u32 s78, s78, 0x01010101
  s_lshl1_add_u32 s69, s91, s95
  s_add_u32 s95, s66, s67
  s_add_u32 s69, s69, s95
  v_dot2_f32_bf16 v22, v137, v56, 0
  v_add_f32_dpp v34, v18, v18 row_ror:8 row_mask:0xf bank_mask:0xc
  v_add_f32_dpp v34, v20, v20 row_ror:8 row_mask:0xf bank_mask:0x3
  v_dot2_f32_bf16 v23, v142, v57, 0
  v_dot2_f32_bf16 v24, v140, v58, 0
  v_dot2_f32_bf16 v25, v143, v59, 0
  v_cvt_f32_i32 v80, v80
  v_cvt_f32_i32 v81, v81
  v_cvt_f32_i32 v82, v82
  v_cvt_f32_i32 v83, v83
  v_pk_mul_f32 v[20:21], v[80:81], v[22:23]
  v_pk_add_f32 v[18:19], v[22:23], v[24:25]
  v_pk_fma_f32 v[20:21], v[82:83], v[24:25], v[20:21]
  v_add_f32 v18, v18, v19
  v_add_f32 v20, v20, v21
  s_cmpk_gt_i32 s69, 0x31
  s_cbranch_scc1 L_p8_4
  s_cmpk_gt_i32 s69, 0xffed
  s_cbranch_scc1 L_p8_1
  s_waitcnt vmcnt(7)
L_p8_1:
  s_waitcnt vmcnt(11)
L_p8_4:
  s_waitcnt vmcnt(12)
  buffer_load_dwordx4 v[68:71], v224, s[32:35], 0 offen nt
  v_dot2_f32_bf16 v22, v141, v60, 0
  v_add_f32_dpp v35, v18, v18 row_ror:8 row_mask:0xf bank_mask:0xc
  v_add_f32_dpp v35, v20, v20 row_ror:8 row_mask:0xf bank_mask:0x3
  v_dot2_f32_bf16 v23, v146, v61, 0
  v_dot2_f32_bf16 v24, v144, v62, 0
  v_dot2_f32_bf16 v25, v147, v63, 0
  v_cvt_f32_i32 v84, v84
  v_cvt_f32_i32 v85, v85
  v_cvt_f32_i32 v86, v86
  v_cvt_f32_i32 v87, v87
  v_pk_mul_f32 v[20:21], v[84:85], v[22:23]
  v_pk_add_f32 v[18:19], v[22:23], v[24:25]
  v_pk_fma_f32 v[20:21], v[86:87], v[24:25], v[20:21]
  v_add_f32 v18, v18, v19
  v_add_f32 v20, v20, v21
  s_add_u32 m0, s100, 14336
  v_lshrrev_b32 v10, 1, v226
  v_add_u32 v10, v10, v242
  v_mad_u64_u32 v[30:31], s[64:65], v10, 1, v[28:29]
  global_load_lds_dwordx4 v[30:31], off
  s_cmpk_gt_i32 s69, 0x31
  s_cbranch_scc1 L_p9_4
  s_cmpk_gt_i32 s69, 0xb
  s_cbranch_scc1 L_p9_2
  s_waitcnt vmcnt(9)
L_p9_2:
  s_waitcnt vmcnt(13)
L_p9_4:
  s_waitcnt vmcnt(14)
  buffer_load_dwordx4 v[72:75], v225, s[32:35], 0 offen nt
  s_waitcnt vmcnt(13)
  ds_read_b64 v[152:153], v12 offset:9216
  ds_read_b64 v[154:155], v12 offset:9344
  ds_read_b64 v[156:157], v12 offset:10240
  ds_read_b64 v[158:159], v12 offset:10368
  ds_read_b64 v[160:161], v12 offset:11264
  ds_read_b64 v[162:163], v12 offset:11392
  v_dot2_f32_bf16 v22, v145, v64, 0
  v_add_f32_dpp v21, v18, v18 row_ror:8 row_mask:0xf bank_mask:0xc
  v_add_f32_dpp v21, v20, v20 row_ror:8 row_mask:0xf bank_mask:0x3
  v_add_f32_dpp v20, v35, v35 row_half_mirror row_mask:0xf bank_mask:0x5
  v_dot2_f32_bf16 v23, v150, v65, 0
  v_add_f32_dpp v20, v21, v21 row_half_mirror row_mask:0xf bank_mask:0xa
  v_dot2_f32_bf16 v24, v148, v66, 0
  v_dot2_f32_bf16 v25, v151, v67, 0
  v_add_f32_dpp v20, v20, v20 quad_perm:[2,3,0,1] row_mask:0xf bank_mask:0xf
  v_cvt_f32_i32 v88, v88
  v_cvt_f32_i32 v89, v89
  v_add_f32_dpp v20, v20, v20 quad_perm:[1,0,3,2] row_mask:0xf bank_mask:0xf
  v_cndmask_b32_e64 v33, v33, v20, s[54:55]
  ds_write_b32 v1, v33 offset:3072
  v_cvt_f32_i32 v90, v90
  v_cvt_f32_i32 v91, v91
  v_pk_mul_f32 v[20:21], v[88:89], v[22:23]
  v_pk_add_f32 v[18:19], v[22:23], v[24:25]
  v_pk_fma_f32 v[20:21], v[90:91], v[24:25], v[20:21]
  v_add_f32 v18, v18, v19
  v_add_f32 v20, v20, v21
  s_cmpk_gt_i32 s69, 0x31
  s_cbranch_scc1 L_p10_4
  s_cmpk_gt_i32 s69, 0x1d
  s_cbranch_scc1 L_p10_3
  s_cmpk_gt_i32 s69, 0xffcd
  s_cbranch_scc1 L_p10_0
  s_waitcnt vmcnt(9)
L_p10_0:
  s_waitcnt vmcnt(10)
L_p10_3:
  s_waitcnt vmcnt(14)
L_p10_4:
  s_waitcnt vmcnt(15)
  buffer_load_dwordx4 v[76:79], v226, s[32:35], 0 offen nt
L_it6:
  s_waitcnt lgkmcnt(0)
  s_waitcnt vmcnt(11)
  s_add_u32 s44, s78, 0x03030303
  v_msad_u8 v9, s78, v36, 0
  v_msad_u8 v10, s44, v36, 0
  v_msad_u8 v9, s78, v37, v9
  v_msad_u8 v10, s44, v37, v10
  v_msad_u8 v9, s78, v38, v9
  v_msad_u8 v10, s44, v38, v10
  s_mov_b64 exec, 3
  global_store_byte v7, v8, s[30:31]
  global_load_dwordx3 v[36:38], v238, s[30:31] sc1
  v_sub_u32 v9, v9, v10
  v_add_u32 v8, 1, v8
  s_mov_b64 exec, -1
  v_readlane_b32 s66, v9, 0
  v_readlane_b32 s67, v9, 1
  s_add_u32 s78, s78, 0x01010101
  s_lshl1_add_u32 s69, s91, s95
  s_add_u32 s95, s66, s67
  s_add_u32 s69, s69, s95
  v_perm_b32 v149, v154, v152, s56
  v_perm_b32 v154, v154, v152, s57
  v_perm_b32 v152, v155, v153, s56
  v_perm_b32 v155, v155, v153, s57
  v_dot2_f32_bf16 v22, v149, v44, 0
  v_add_f32_dpp v35, v18, v18 row_ror:8 row_mask:0xf bank_mask:0xc
  v_add_f32_dpp v35, v20, v20 row_ror:8 row_mask:0xf bank_mask:0x3
  v_dot2_f32_bf16 v23, v154, v45, 0
  v_dot2_f32_bf16 v24, v152, v46, 0
  v_dot2_f32_bf16 v25, v155, v47, 0
  v_cvt_f32_i32 v92, v92
  v_cvt_f32_i32 v93, v93
  v_cvt_f32_i32 v94, v94
  v_cvt_f32_i32 v95, v95
  v_pk_mul_f32 v[20:21], v[92:93], v[22:23]
  v_pk_add_f32 v[18:19], v[22:23], v[24:25]
  v_pk_fma_f32 v[20:21], v[94:95], v[24:25], v[20:21]
  v_add_f32 v18, v18, v19
  v_add_f32 v20, v20, v21
  s_add_u32 m0, s100, 15360
  v_lshrrev_b32 v10, 1, v227
  v_add_u32 v10, v10, v240
  v_mad_u64_u32 v[30:31], s[64:65], v10, 1, v[28:29]
  global_load_lds_dwordx4 v[30:31], off
  s_cmpk_gt_i32 s69, 0x31
  s_cbranch_scc1 L_p11_4
  s_cmpk_gt_i32 s69, 0xffed
  s_cbranch_scc1 L_p11_1
  s_waitcnt vmcnt(7)
L_p11_1:
  s_waitcnt vmcnt(11)
L_p11_4:
  s_waitcnt vmcnt(13)
  buffer_load_dwordx4 v[80:83], v224, s[32:35], s80 offen nt
  v_perm_b32 v153, v158, v156, s56
  v_perm_b32 v158, v158, v156, s57
  v_perm_b32 v156, v159, v157, s56
  v_perm_b32 v159, v159, v157, s57
  v_dot2_f32_bf16 v22, v153, v48, 0
  v_add_f32_dpp v21, v18, v18 row_ror:8 row_mask:0xf bank_mask:0xc
  v_add_f32_dpp v21, v20, v20 row_ror:8 row_mask:0xf bank_mask:0x3
  v_add_f32_dpp v20, v34, v34 row_half_mirror row_mask:0xf bank_mask:0x5
  v_dot2_f32_bf16 v23, v158, v49, 0
  v_add_f32_dpp v20, v21, v21 row_half_mirror row_mask:0xf bank_mask:0xa
  v_dot2_f32_bf16 v24, v156, v50, 0
  v_dot2_f32_bf16 v25, v159, v51, 0
  v_add_f32_dpp v20, v20, v20 quad_perm:[2,3,0,1] row_mask:0xf bank_mask:0xf
  v_cvt_f32_i32 v96, v96
  v_cvt_f32_i32 v97, v97
  v_add_f32_dpp v20, v20, v20 quad_perm:[1,0,3,2] row_mask:0xf bank_mask:0xf
  v_cndmask_b32_e64 v32, v32, v20, s[48:49]
  v_cvt_f32_i32 v98, v98
  v_cvt_f32_i32 v99, v99
  v_pk_mul_f32 v[20:21], v[96:97], v[22:23]
  v_pk_add_f32 v[18:19], v[22:23], v[24:25]
  v_pk_fma_f32 v[20:21], v[98:99], v[24:25], v[20:21]
  v_add_f32 v18, v18, v19
  v_add_f32 v20, v20, v21
  s_cmpk_gt_i32 s69, 0x31
  s_cbranch_scc1 L_p12_4
  s_cmpk_gt_i32 s69, 0xb
  s_cbranch_scc1 L_p12_2
  s_waitcnt vmcnt(8)
L_p12_2:
  s_waitcnt vmcnt(12)
L_p12_4:
  s_waitcnt vmcnt(14)
  buffer_load_dwordx4 v[84:87], v225, s[32:35], s80 offen nt
  v_perm_b32 v157, v162, v160, s56
  v_perm_b32 v162, v162, v160, s57
  v_perm_b32 v160, v163, v161, s56
  v_perm_b32 v163, v163, v161, s57
  v_dot2_f32_bf16 v22, v157, v52, 0
  v_add_f32_dpp v34, v18, v18 row_ror:8 row_mask:0xf bank_mask:0xc
  v_add_f32_dpp v34, v20, v20 row_ror:8 row_mask:0xf bank_mask:0x3
  v_dot2_f32_bf16 v23, v162, v53, 0
  v_dot2_f32_bf16 v24, v160, v54, 0
  v_dot2_f32_bf16 v25, v163, v55, 0
  v_cvt_f32_i32 v100, v100
  v_cvt_f32_i32 v101, v101
  v_cvt_f32_i32 v102, v102
  v_cvt_f32_i32 v103, v103
  v_pk_mul_f32 v[20:21], v[100:101], v[22:23]
  v_pk_add_f32 v[18:19], v[22:23], v[24:25]
  v_pk_fma_f32 v[20:21], v[102:103], v[24:25], v[20:21]
  v_add_f32 v18, v18, v19
  v_add_f32 v20, v20, v21
  s_add_u32 m0, s100, 16384
  v_lshrrev_b32 v10, 1, v228
  v_add_u32 v10, v10, v241
  v_mad_u64_u32 v[30:31], s[64:65], v10, 1, v[28:29]
  global_load_lds_dwordx4 v[30:31], off
  s_cmpk_gt_i32 s69, 0x31
  s_cbranch_scc1 L_p13_4
  s_cmpk_gt_i32 s69, 0x1d
  s_cbranch_scc1 L_p13_3
  s_cmpk_gt_i32 s69, 0xffcd
  s_cbranch_scc1 L_p13_0
  s_waitcnt vmcnt(8)
L_p13_0:
  s_waitcnt vmcnt(10)
L_p13_3:
  s_waitcnt vmcnt(14)
L_p13_4:
  s_waitcnt vmcnt(16)
  buffer_load_dwordx4 v[88:91], v226, s[32:35], s80 offen nt
L_it7:
  s_waitcnt lgkmcnt(0)
  s_waitcnt vmcnt(10)
  s_add_u32 s44, s78, 0x03030303
  v_msad_u8 v9, s78, v40, 0
  v_msad_u8 v10, s44, v40, 0
  v_msad_u8 v9, s78, v41, v9
  v_msad_u8 v10, s44, v41, v10
  v_msad_u8 v9, s78, v42, v9
  v_msad_u8 v10, s44, v42, v10
  s_mov_b64 exec, 3
  global_store_byte v7, v8, s[30:31]
  global_load_dwordx3 v[40:42], v239, s[30:31] sc1
  v_sub_u32 v9, v9, v10
  v_add3_u32 v10, v26, v27, s58
  v_add_u32 v8, 1, v8
  s_mov_b64 exec, -1
  v_readlane_b32 s66, v9, 0
  v_readlane_b32 s67, v9, 1
  v_readlane_b32 s91, v10, 0
  s_add_u32 s78, s78, 0x01010101
  s_lshl1_add_u32 s69, s91, s95
  s_add_u32 s95, s66, s67
  s_add_u32 s69, s69, s95
  v_dot2_f32_bf16 v22, v149, v56, 0
  v_add_f32_dpp v21, v18, v18 row_ror:8 row_mask:0xf bank_mask:0xc
  v_add_f32_dpp v21, v20, v20 row_ror:8 row_mask:0xf bank_mask:0x3
  v_add_f32_dpp v20, v34, v34 row_half_mirror row_mask:0xf bank_mask:0x5
  v_dot2_f32_bf16 v23, v154, v57, 0
  v_add_f32_dpp v20, v21, v21 row_half_mirror row_mask:0xf bank_mask:0xa
  v_dot2_f32_bf16 v24, v152, v58, 0
  v_dot2_f32_bf16 v25, v155, v59, 0
  v_add_f32_dpp v20, v20, v20 quad_perm:[2,3,0,1] row_mask:0xf bank_mask:0xf
  v_cvt_f32_i32 v104, v104
  v_cvt_f32_i32 v105, v105
  v_add_f32_dpp v20, v20, v20 quad_perm:[1,0,3,2] row_mask:0xf bank_mask:0xf
  v_cndmask_b32_e64 v32, v32, v20, s[50:51]
  v_cvt_f32_i32 v106, v106
  v_cvt_f32_i32 v107, v107
  v_pk_mul_f32 v[20:21], v[104:105], v[22:23]
  v_pk_add_f32 v[18:19], v[22:23], v[24:25]
  v_pk_fma_f32 v[20:21], v[106:107], v[24:25], v[20:21]
  v_add_f32 v18, v18, v19
  v_add_f32 v20, v20, v21
  s_cmpk_gt_i32 s69, 0x31
  s_cbranch_scc1 L_p14_4
  s_cmpk_gt_i32 s69, 0xffed
  s_cbranch_scc1 L_p14_1
  s_waitcnt vmcnt(6)
L_p14_1:
  s_waitcnt vmcnt(10)
L_p14_4:
  s_waitcnt vmcnt(11)
  buffer_load_dwordx4 v[92:95], v227, s[32:35], 0 offen nt
  v_dot2_f32_bf16 v22, v153, v60, 0
  v_add_f32_dpp v21, v18, v18 row_ror:8 row_mask:0xf bank_mask:0xc
  v_add_f32_dpp v21, v20, v20 row_ror:8 row_mask:0xf bank_mask:0x3
  v_add_f32_dpp v20, v35, v35 row_half_mirror row_mask:0xf bank_mask:0x5
  v_dot2_f32_bf16 v23, v158, v61, 0
  v_add_f32_dpp v20, v21, v21 row_half_mirror row_mask:0xf bank_mask:0xa
  v_dot2_f32_bf16 v24, v156, v62, 0
  v_dot2_f32_bf16 v25, v159, v63, 0
  v_add_f32_dpp v20, v20, v20 quad_perm:[2,3,0,1] row_mask:0xf bank_mask:0xf
  v_cvt_f32_i32 v108, v108
  v_cvt_f32_i32 v109, v109
  v_add_f32_dpp v20, v20, v20 quad_perm:[1,0,3,2] row_mask:0xf bank_mask:0xf
  v_cndmask_b32_e64 v33, v33, v20, s[48:49]
  v_cvt_f32_i32 v110, v110
  v_cvt_f32_i32 v111, v111
  v_pk_mul_f32 v[20:21], v[108:109], v[22:23]
  v_pk_add_f32 v[18:19], v[22:23], v[24:25]
  v_pk_fma_f32 v[20:21], v[110:111], v[24:25], v[20:21]
  v_add_f32 v18, v18, v19
  v_add_f32 v20, v20, v21
  s_add_u32 m0, s100, 17408
  v_lshrrev_b32 v10, 1, v229
  v_add_u32 v10, v10, v242
  v_mad_u64_u32 v[30:31], s[64:65], v10, 1, v[28:29]
  global_load_lds_dwordx4 v[30:31], off
  s_cmpk_gt_i32 s69, 0x31
  s_cbranch_scc1 L_p15_4
  s_cmpk_gt_i32 s69, 0xb
  s_cbranch_scc1 L_p15_2
  s_waitcnt vmcnt(8)
L_p15_2:
  s_waitcnt vmcnt(12)
L_p15_4:
  s_waitcnt vmcnt(13)
  buffer_load_dwordx4 v[96:99], v228, s[32:35], 0 offen nt
  s_waitcnt vmcnt(12)
  ds_read_b64 v[164:165], v12 offset:12288
  ds_read_b64 v[166:167], v12 offset:12416
  ds_read_b64 v[168:169], v12 offset:13312
  ds_read_b64 v[170:171], v12 offset:13440
  ds_read_b64 v[172:173], v12 offset:14336
  ds_read_b64 v[174:175], v12 offset:14464
  v_dot2_f32_bf16 v22, v157, v64, 0
  v_add_f32_dpp v35, v18, v18 row_ror:8 row_mask:0xf bank_mask:0xc
  v_add_f32_dpp v35, v20, v20 row_ror:8 row_mask:0xf bank_mask:0x3
  v_dot2_f32_bf16 v23, v162, v65, 0
  v_dot2_f32_bf16 v24, v160, v66, 0
  v_dot2_f32_bf16 v25, v163, v67, 0
  v_cvt_f32_i32 v112, v112
  v_cvt_f32_i32 v113, v113
  v_cvt_f32_i32 v114, v114
  v_cvt_f32_i32 v115, v115
  v_pk_mul_f32 v[20:21], v[112:113], v[22:23]
  v_pk_add_f32 v[18:19], v[22:23], v[24:25]
  v_pk_fma_f32 v[20:21], v[114:115], v[24:25], v[20:21]
  v_add_f32 v18, v18, v19
  v_add_f32 v20, v20, v21
  s_cmpk_gt_i32 s69, 0x31
  s_cbranch_scc1 L_p16_4
  s_cmpk_gt_i32 s69, 0x1d
  s_cbranch_scc1 L_p16_3
  s_cmpk_gt_i32 s69, 0xffcd
  s_cbranch_scc1 L_p16_0
  s_waitcnt vmcnt(8)
L_p16_0:
  s_waitcnt vmcnt(9)
L_p16_3:
  s_waitcnt vmcnt(13)
L_p16_4:
  s_waitcnt vmcnt(14)
  buffer_load_dwordx4 v[100:103], v229, s[32:35], 0 offen nt
  v_mov_b32 v9, 1
  ds_write_b32 v6, v9 offset:0
L_it8:
  s_waitcnt lgkmcnt(0)
  s_waitcnt vmcnt(10)
  s_add_u32 s44, s78, 0x03030303
  v_msad_u8 v9, s78, v36, 0
  v_msad_u8 v10, s44, v36, 0
  v_msad_u8 v9, s78, v37, v9
  v_msad_u8 v10, s44, v37, v10
  v_msad_u8 v9, s78, v38, v9
  v_msad_u8 v10, s44, v38, v10
  s_mov_b64 exec, 3
  global_store_byte v7, v8, s[30:31]
  global_load_dwordx3 v[36:38], v236, s[30:31] sc1
  v_sub_u32 v9, v9, v10
  v_add_u32 v8, 1, v8
  s_mov_b64 exec, -1
  v_readlane_b32 s66, v9, 0
  v_readlane_b32 s67, v9, 1
  s_add_u32 s78, s78, 0x01010101
  s_lshl1_add_u32 s69, s91, s95
  s_add_u32 s95, s66, s67
  s_add_u32 s69, s69, s95
  v_perm_b32 v161, v166, v164, s56
  v_perm_b32 v166, v166, v164, s57
  v_perm_b32 v164, v167, v165, s56
  v_perm_b32 v167, v167, v165, s57
  v_dot2_f32_bf16 v22, v161, v44, 0
  v_add_f32_dpp v21, v18, v18 row_ror:8 row_mask:0xf bank_mask:0xc
  v_add_f32_dpp v21, v20, v20 row_ror:8 row_mask:0xf bank_mask:0x3
  v_add_f32_dpp v20, v35, v35 row_half_mirror row_mask:0xf bank_mask:0x5
  v_dot2_f32_bf16 v23, v166, v45, 0
  v_add_f32_dpp v20, v21, v21 row_half_mirror row_mask:0xf bank_mask:0xa
  v_dot2_f32_bf16 v24, v164, v46, 0
  v_dot2_f32_bf16 v25, v167, v47, 0
  v_add_f32_dpp v20, v20, v20 quad_perm:[2,3,0,1] row_mask:0xf bank_mask:0xf
  v_cvt_f32_i32 v68, v68
  v_cvt_f32_i32 v69, v69
  v_add_f32_dpp v20, v20, v20 quad_perm:[1,0,3,2] row_mask:0xf bank_mask:0xf
  v_cndmask_b32_e64 v33, v33, v20, s[50:51]
  v_cvt_f32_i32 v70, v70
  v_cvt_f32_i32 v71, v71
  v_pk_mul_f32 v[20:21], v[68:69], v[22:23]
  v_pk_add_f32 v[18:19], v[22:23], v[24:25]
  v_pk_fma_f32 v[20:21], v[70:71], v[24:25], v[20:21]
  v_add_f32 v18, v18, v19
  v_add_f32 v20, v20, v21
  s_add_u32 m0, s100, 18432
  v_lshrrev_b32 v10, 1, v230
  v_add_u32 v10, v10, v240
  v_mad_u64_u32 v[30:31], s[64:65], v10, 1, v[28:29]
  global_load_lds_dwordx4 v[30:31], off
  s_cmpk_gt_i32 s69, 0x31
  s_cbranch_scc1 L_p17_4
  s_cmpk_gt_i32 s69, 0xffed
  s_cbranch_scc1 L_p17_1
  s_waitcnt vmcnt(7)
L_p17_1:
  s_waitcnt vmcnt(10)
L_p17_4:
  s_waitcnt vmcnt(12)
  buffer_load_dwordx4 v[104:107], v227, s[32:35], s80 offen nt
  v_perm_b32 v165, v170, v168, s56
  v_perm_b32 v170, v170, v168, s57
  v_perm_b32 v168, v171, v169, s56
  v_perm_b32 v171, v171, v169, s57
  v_dot2_f32_bf16 v22, v165, v48, 0
  v_add_f32_dpp v34, v18, v18 row_ror:8 row_mask:0xf bank_mask:0xc
  v_add_f32_dpp v34, v20, v20 row_ror:8 row_mask:0xf bank_mask:0x3
  v_dot2_f32_bf16 v23, v170, v49, 0
  v_dot2_f32_bf16 v24, v168, v50, 0
  v_dot2_f32_bf16 v25, v171, v51, 0
  v_cvt_f32_i32 v72, v72
  v_cvt_f32_i32 v73, v73
  v_cvt_f32_i32 v74, v74
  v_cvt_f32_i32 v75, v75
  v_pk_mul_f32 v[20:21], v[72:73], v[22:23]
  v_pk_add_f32 v[18:19], v[22:23], v[24:25]
  v_pk_fma_f32 v[20:21], v[74:75], v[24:25], v[20:21]
  v_add_f32 v18, v18, v19
  v_add_f32 v20, v20, v21
  s_cmpk_gt_i32 s69, 0x31
  s_cbranch_scc1 L_p18_4
  s_cmpk_gt_i32 s69, 0xb
  s_cbranch_scc1 L_p18_2
  s_waitcnt vmcnt(8)
L_p18_2:
  s_waitcnt vmcnt(11)
L_p18_4:
  s_waitcnt vmcnt(13)
  buffer_load_dwordx4 v[108:111], v228, s[32:35], s80 offen nt
  v_perm_b32 v169, v174, v172, s56
  v_perm_b32 v174, v174, v172, s57
  v_perm_b32 v172, v175, v173, s56
  v_perm_b32 v175, v175, v173, s57
  v_dot2_f32_bf16 v22, v169, v52, 0
  v_add_f32_dpp v21, v18, v18 row_ror:8 row_mask:0xf bank_mask:0xc
  v_add_f32_dpp v21, v20, v20 row_ror:8 row_mask:0xf bank_mask:0x3
  v_add_f32_dpp v20, v34, v34 row_half_mirror row_mask:0xf bank_mask:0x5
  v_dot2_f32_bf16 v23, v174, v53, 0
  v_add_f32_dpp v20, v21, v21 row_half_mirror row_mask:0xf bank_mask:0xa
  v_dot2_f32_bf16 v24, v172, v54, 0
  v_dot2_f32_bf16 v25, v175, v55, 0
  v_add_f32_dpp v20, v20, v20 quad_perm:[2,3,0,1] row_mask:0xf bank_mask:0xf
  v_cvt_f32_i32 v76, v76
  v_cvt_f32_i32 v77, v77
  v_add_f32_dpp v20, v20, v20 quad_perm:[1,0,3,2] row_mask:0xf bank_mask:0xf
  v_cndmask_b32_e64 v32, v32, v20, s[52:53]
  v_cvt_f32_i32 v78, v78
  v_cvt_f32_i32 v79, v79
  v_pk_mul_f32 v[20:21], v[76:77], v[22:23]
  v_pk_add_f32 v[18:19], v[22:23], v[24:25]
  v_pk_fma_f32 v[20:21], v[78:79], v[24:25], v[20:21]
  v_add_f32 v18, v18, v19
  v_add_f32 v20, v20, v21
  s_add_u32 m0, s100, 19456
  v_lshrrev_b32 v10, 1, v231
  v_add_u32 v10, v10, v241
  v_mad_u64_u32 v[30:31], s[64:65], v10, 1, v[28:29]
  global_load_lds_dwordx4 v[30:31], off
  s_cmpk_gt_i32 s69, 0x31
  s_cbranch_scc1 L_p19_4
  s_cmpk_gt_i32 s69, 0x1d
  s_cbranch_scc1 L_p19_3
  s_cmpk_gt_i32 s69, 0xffcd
  s_cbranch_scc1 L_p19_0
  s_waitcnt vmcnt(8)
L_p19_0:
  s_waitcnt vmcnt(10)
L_p19_3:
  s_waitcnt vmcnt(13)
L_p19_4:
  s_waitcnt vmcnt(15)
  buffer_load_dwordx4 v[112:115], v229, s[32:35], s80 offen nt
L_it9:
  s_waitcnt lgkmcnt(0)
  s_waitcnt vmcnt(10)
  s_add_u32 s44, s78, 0x03030303
  v_msad_u8 v9, s78, v40, 0
  v_msad_u8 v10, s44, v40, 0
  v_msad_u8 v9, s78, v41, v9
  v_msad_u8 v10, s44, v41, v10
  v_msad_u8 v9, s78, v42, v9
  v_msad_u8 v10, s44, v42, v10
  s_mov_b64 exec, 3
  global_store_byte v7, v8, s[30:31]
  global_load_dwordx3 v[40:42], v237, s[30:31] sc1
  v_sub_u32 v9, v9, v10
  v_add_u32 v8, 1, v8
  s_mov_b64 exec, -1
  v_readlane_b32 s66, v9, 0
  v_readlane_b32 s67, v9, 1
  s_add_u32 s78, s78, 0x01010101
  s_lshl1_add_u32 s69, s91, s95
  s_add_u32 s95, s66, s67
  s_add_u32 s69, s69, s95
  v_dot2_f32_bf16 v22, v161, v56, 0
  v_add_f32_dpp v34, v18, v18 row_ror:8 row_mask:0xf bank_mask:0xc
  v_add_f32_dpp v34, v20, v20 row_ror:8 row_mask:0xf bank_mask:0x3
  v_dot2_f32_bf16 v23, v166, v57, 0
  v_dot2_f32_bf16 v24, v164, v58, 0
  v_dot2_f32_bf16 v25, v167, v59, 0
  v_cvt_f32_i32 v80, v80
  v_cvt_f32_i32 v81, v81
  v_cvt_f32_i32 v82, v82
  v_cvt_f32_i32 v83, v83
  v_pk_mul_f32 v[20:21], v[80:81], v[22:23]
  v_pk_add_f32 v[18:19], v[22:23], v[24:25]
  v_pk_fma_f32 v[20:21], v[82:83], v[24:25], v[20:21]
  v_add_f32 v18, v18, v19
  v_add_f32 v20, v20, v21
  s_cmpk_gt_i32 s69, 0x31
  s_cbranch_scc1 L_p20_4
  s_cmpk_gt_i32 s69, 0xffed
  s_cbranch_scc1 L_p20_1
  s_waitcnt vmcnt(6)
L_p20_1:
  s_waitcnt vmcnt(10)
L_p20_4:
  s_waitcnt vmcnt(11)
  buffer_load_dwordx4 v[68:71], v230, s[32:35], 0 offen nt
  v_dot2_f32_bf16 v22, v165, v60, 0
  v_add_f32_dpp v35, v18, v18 row_ror:8 row_mask:0xf bank_mask:0xc
  v_add_f32_dpp v35, v20, v20 row_ror:8 row_mask:0xf bank_mask:0x3
  v_dot2_f32_bf16 v23, v170, v61, 0
  v_dot2_f32_bf16 v24, v168, v62, 0
  v_dot2_f32_bf16 v25, v171, v63, 0
  v_cvt_f32_i32 v84, v84
  v_cvt_f32_i32 v85, v85
  v_cvt_f32_i32 v86, v86
  v_cvt_f32_i32 v87, v87
  v_pk_mul_f32 v[20:21], v[84:85], v[22:23]
  v_pk_add_f32 v[18:19], v[22:23], v[24:25]
  v_pk_fma_f32 v[20:21], v[86:87], v[24:25], v[20:21]
  v_add_f32 v18, v18, v19
  v_add_f32 v20, v20, v21
  s_add_u32 m0, s100, 20480
  v_lshrrev_b32 v10, 1, v232
  v_add_u32 v10, v10, v242
  v_mad_u64_u32 v[30:31], s[64:65], v10, 1, v[28:29]
  global_load_lds_dwordx4 v[30:31], off
  s_cmpk_gt_i32 s69, 0x31
  s_cbranch_scc1 L_p21_4
  s_cmpk_gt_i32 s69, 0xb
  s_cbranch_scc1 L_p21_2
  s_waitcnt vmcnt(8)
L_p21_2:
  s_waitcnt vmcnt(12)
L_p21_4:
  s_waitcnt vmcnt(13)
  buffer_load_dwordx4 v[72:75], v231, s[32:35], 0 offen nt
  s_waitcnt vmcnt(12)
  ds_read_b64 v[176:177], v12 offset:15360
  ds_read_b64 v[178:179], v12 offset:15488
  ds_read_b64 v[180:181], v12 offset:16384
  ds_read_b64 v[182:183], v12 offset:16512
  ds_read_b64 v[184:185], v12 offset:17408
  ds_read_b64 v[186:187], v12 offset:17536
  v_dot2_f32_bf16 v22, v169, v64, 0
  v_add_f32_dpp v21, v18, v18 row_ror:8 row_mask:0xf bank_mask:0xc
  v_add_f32_dpp v21, v20, v20 row_ror:8 row_mask:0xf bank_mask:0x3
  v_add_f32_dpp v20, v35, v35 row_half_mirror row_mask:0xf bank_mask:0x5
  v_dot2_f32_bf16 v23, v174, v65, 0
  v_add_f32_dpp v20, v21, v21 row_half_mirror row_mask:0xf bank_mask:0xa
  v_dot2_f32_bf16 v24, v172, v66, 0
  v_dot2_f32_bf16 v25, v175, v67, 0
  v_add_f32_dpp v20, v20, v20 quad_perm:[2,3,0,1] row_mask:0xf bank_mask:0xf
  v_cvt_f32_i32 v88, v88
  v_cvt_f32_i32 v89, v89
  v_add_f32_dpp v20, v20, v20 quad_perm:[1,0,3,2] row_mask:0xf bank_mask:0xf
  v_cndmask_b32_e64 v33, v33, v20, s[52:53]
  v_cvt_f32_i32 v90, v90
  v_cvt_f32_i32 v91, v91
  v_pk_mul_f32 v[20:21], v[88:89], v[22:23]
  v_pk_add_f32 v[18:19], v[22:23], v[24:25]
  v_pk_fma_f32 v[20:21], v[90:91], v[24:25], v[20:21]
  v_add_f32 v18, v18, v19
  v_add_f32 v20, v20, v21
  s_cmpk_gt_i32 s69, 0x31
  s_cbranch_scc1 L_p22_4
  s_cmpk_gt_i32 s69, 0x1d
  s_cbranch_scc1 L_p22_3
  s_cmpk_gt_i32 s69, 0xffcd
  s_cbranch_scc1 L_p22_0
  s_waitcnt vmcnt(8)
L_p22_0:
  s_waitcnt vmcnt(9)
L_p22_3:
  s_waitcnt vmcnt(13)
L_p22_4:
  s_waitcnt vmcnt(14)
  buffer_load_dwordx4 v[76:79], v232, s[32:35], 0 offen nt
L_it10:
  s_waitcnt lgkmcnt(0)
  s_waitcnt vmcnt(10)
  s_add_u32 s44, s78, 0x03030303
  v_msad_u8 v9, s78, v36, 0
  v_msad_u8 v10, s44, v36, 0
  v_msad_u8 v9, s78, v37, v9
  v_msad_u8 v10, s44, v37, v10
  v_msad_u8 v9, s78, v38, v9
  v_msad_u8 v10, s44, v38, v10
  s_mov_b64 exec, 3
  global_store_byte v7, v8, s[30:31]
  global_load_dwordx3 v[36:38], v238, s[30:31] sc1
  v_sub_u32 v9, v9, v10
  v_add_u32 v8, 1, v8
  s_mov_b64 exec, -1
  v_readlane_b32 s66, v9, 0
  v_readlane_b32 s67, v9, 1
  s_add_u32 s78, s78, 0x01010101
  s_lshl1_add_u32 s69, s91, s95
  s_add_u32 s95, s66, s67
  s_add_u32 s69, s69, s95
  v_perm_b32 v173, v178, v176, s56
  v_perm_b32 v178, v178, v176, s57
  v_perm_b32 v176, v179, v177, s56
  v_perm_b32 v179, v179, v177, s57
  v_dot2_f32_bf16 v22, v173, v44, 0
  v_add_f32_dpp v35, v18, v18 row_ror:8 row_mask:0xf bank_mask:0xc
  v_add_f32_dpp v35, v20, v20 row_ror:8 row_mask:0xf bank_mask:0x3
  v_dot2_f32_bf16 v23, v178, v45, 0
  v_dot2_f32_bf16 v24, v176, v46, 0
  v_dot2_f32_bf16 v25, v179, v47, 0
  v_cvt_f32_i32 v92, v92
  v_cvt_f32_i32 v93, v93
  v_cvt_f32_i32 v94, v94
  v_cvt_f32_i32 v95, v95
  v_pk_mul_f32 v[20:21], v[92:93], v[22:23]
  v_pk_add_f32 v[18:19], v[22:23], v[24:25]
  v_pk_fma_f32 v[20:21], v[94:95], v[24:25], v[20:21]
  v_add_f32 v18, v18, v19
  v_add_f32 v20, v20, v21
  s_add_u32 m0, s100, 21504
  v_lshrrev_b32 v10, 1, v233
  v_add_u32 v10, v10, v240
  v_mad_u64_u32 v[30:31], s[64:65], v10, 1, v[28:29]
  global_load_lds_dwordx4 v[30:31], off
  s_cmpk_gt_i32 s69, 0x31
  s_cbranch_scc1 L_p23_4
  s_cmpk_gt_i32 s69, 0xffed
  s_cbranch_scc1 L_p23_1
  s_waitcnt vmcnt(7)
L_p23_1:
  s_waitcnt vmcnt(10)
L_p23_4:
  s_waitcnt vmcnt(12)
  buffer_load_dwordx4 v[80:83], v230, s[32:35], s80 offen nt
  v_perm_b32 v177, v182, v180, s56
  v_perm_b32 v182, v182, v180, s57
  v_perm_b32 v180, v183, v181, s56
  v_perm_b32 v183, v183, v181, s57
  v_dot2_f32_bf16 v22, v177, v48, 0
  v_add_f32_dpp v21, v18, v18 row_ror:8 row_mask:0xf bank_mask:0xc
  v_add_f32_dpp v21, v20, v20 row_ror:8 row_mask:0xf bank_mask:0x3
  v_add_f32_dpp v20, v34, v34 row_half_mirror row_mask:0xf bank_mask:0x5
  v_dot2_f32_bf16 v23, v182, v49, 0
  v_add_f32_dpp v20, v21, v21 row_half_mirror row_mask:0xf bank_mask:0xa
  v_dot2_f32_bf16 v24, v180, v50, 0
  v_dot2_f32_bf16 v25, v183, v51, 0
  v_add_f32_dpp v20, v20, v20 quad_perm:[2,3,0,1] row_mask:0xf bank_mask:0xf
  v_cvt_f32_i32 v96, v96
  v_cvt_f32_i32 v97, v97
  v_add_f32_dpp v20, v20, v20 quad_perm:[1,0,3,2] row_mask:0xf bank_mask:0xf
  v_cndmask_b32_e64 v32, v32, v20, s[54:55]
  ds_write_b32 v1, v32 offset:512
  v_cvt_f32_i32 v98, v98
  v_cvt_f32_i32 v99, v99
  v_pk_mul_f32 v[20:21], v[96:97], v[22:23]
  v_pk_add_f32 v[18:19], v[22:23], v[24:25]
  v_pk_fma_f32 v[20:21], v[98:99], v[24:25], v[20:21]
  v_add_f32 v18, v18, v19
  v_add_f32 v20, v20, v21
  s_cmpk_gt_i32 s69, 0x31
  s_cbranch_scc1 L_p24_4
  s_cmpk_gt_i32 s69, 0xb
  s_cbranch_scc1 L_p24_2
  s_waitcnt vmcnt(8)
L_p24_2:
  s_waitcnt vmcnt(11)
L_p24_4:
  s_waitcnt vmcnt(13)
  buffer_load_dwordx4 v[84:87], v231, s[32:35], s80 offen nt
  v_perm_b32 v181, v186, v184, s56
  v_perm_b32 v186, v186, v184, s57
  v_perm_b32 v184, v187, v185, s56
  v_perm_b32 v187, v187, v185, s57
  v_dot2_f32_bf16 v22, v181, v52, 0
  v_add_f32_dpp v34, v18, v18 row_ror:8 row_mask:0xf bank_mask:0xc
  v_add_f32_dpp v34, v20, v20 row_ror:8 row_mask:0xf bank_mask:0x3
  v_dot2_f32_bf16 v23, v186, v53, 0
  v_dot2_f32_bf16 v24, v184, v54, 0
  v_dot2_f32_bf16 v25, v187, v55, 0
  v_cvt_f32_i32 v100, v100
  v_cvt_f32_i32 v101, v101
  v_cvt_f32_i32 v102, v102
  v_cvt_f32_i32 v103, v103
  v_pk_mul_f32 v[20:21], v[100:101], v[22:23]
  v_pk_add_f32 v[18:19], v[22:23], v[24:25]
  v_pk_fma_f32 v[20:21], v[102:103], v[24:25], v[20:21]
  v_add_f32 v18, v18, v19
  v_add_f32 v20, v20, v21
  s_add_u32 m0, s100, 22528
  v_lshrrev_b32 v10, 1, v234
  v_add_u32 v10, v10, v241
  v_mad_u64_u32 v[30:31], s[64:65], v10, 1, v[28:29]
  global_load_lds_dwordx4 v[30:31], off
  s_cmpk_gt_i32 s69, 0x31
  s_cbranch_scc1 L_p25_4
  s_cmpk_gt_i32 s69, 0x1d
  s_cbranch_scc1 L_p25_3
  s_cmpk_gt_i32 s69, 0xffcd
  s_cbranch_scc1 L_p25_0
  s_waitcnt vmcnt(8)
L_p25_0:
  s_waitcnt vmcnt(10)
L_p25_3:
  s_waitcnt vmcnt(13)
L_p25_4:
  s_waitcnt vmcnt(15)
  buffer_load_dwordx4 v[88:91], v232, s[32:35], s80 offen nt
L_it11:
  s_waitcnt lgkmcnt(0)
  s_waitcnt vmcnt(10)
  s_add_u32 s44, s78, 0x03030303
  v_msad_u8 v9, s78, v40, 0
  v_msad_u8 v10, s44, v40, 0
  v_msad_u8 v9, s78, v41, v9
  v_msad_u8 v10, s44, v41, v10
  v_msad_u8 v9, s78, v42, v9
  v_msad_u8 v10, s44, v42, v10
  s_mov_b64 exec, 3
  global_store_byte v7, v8, s[30:31]
  global_load_dwordx3 v[40:42], v239, s[30:31] sc1
  v_sub_u32 v9, v9, v10
  v_add_u32 v8, 1, v8
  s_mov_b64 exec, -1
  v_readlane_b32 s66, v9, 0
  v_readlane_b32 s67, v9, 1
  s_add_u32 s78, s78, 0x01010101
  s_lshl1_add_u32 s69, s91, s95
  s_add_u32 s95, s66, s67
  s_add_u32 s69, s69, s95
  v_dot2_f32_bf16 v22, v173, v56, 0
  v_add_f32_dpp v21, v18, v18 row_ror:8 row_mask:0xf bank_mask:0xc
  v_add_f32_dpp v21, v20, v20 row_ror:8 row_mask:0xf bank_mask:0x3
  v_add_f32_dpp v20, v34, v34 row_half_mirror row_mask:0xf bank_mask:0x5
  v_dot2_f32_bf16 v23, v178, v57, 0
  v_add_f32_dpp v20, v21, v21 row_half_mirror row_mask:0xf bank_mask:0xa
  v_dot2_f32_bf16 v24, v176, v58, 0
  v_dot2_f32_bf16 v25, v179, v59, 0
  v_add_f32_dpp v20, v20, v20 quad_perm:[2,3,0,1] row_mask:0xf bank_mask:0xf
  v_cvt_f32_i32 v104, v104
  v_cvt_f32_i32 v105, v105
  v_add_f32_dpp v20, v20, v20 quad_perm:[1,0,3,2] row_mask:0xf bank_mask:0xf
  v_cndmask_b32_e64 v32, v32, v20, s[48:49]
  v_cvt_f32_i32 v106, v106
  v_cvt_f32_i32 v107, v107
  v_pk_mul_f32 v[20:21], v[104:105], v[22:23]
  v_pk_add_f32 v[18:19], v[22:23], v[24:25]
  v_pk_fma_f32 v[20:21], v[106:107], v[24:25], v[20:21]
  v_add_f32 v18, v18, v19
  v_add_f32 v20, v20, v21
  s_cmpk_gt_i32 s69, 0x31
  s_cbranch_scc1 L_p26_4
  s_cmpk_gt_i32 s69, 0xffed
  s_cbranch_scc1 L_p26_1
  s_waitcnt vmcnt(6)
L_p26_1:
  s_waitcnt vmcnt(10)
L_p26_4:
  s_waitcnt vmcnt(11)
  buffer_load_dwordx4 v[92:95], v233, s[32:35], 0 offen nt
  v_dot2_f32_bf16 v22, v177, v60, 0
  v_add_f32_dpp v21, v18, v18 row_ror:8 row_mask:0xf bank_mask:0xc
  v_add_f32_dpp v21, v20, v20 row_ror:8 row_mask:0xf bank_mask:0x3
  v_add_f32_dpp v20, v35, v35 row_half_mirror row_mask:0xf bank_mask:0x5
  v_dot2_f32_bf16 v23, v182, v61, 0
  v_add_f32_dpp v20, v21, v21 row_half_mirror row_mask:0xf bank_mask:0xa
  v_dot2_f32_bf16 v24, v180, v62, 0
  v_dot2_f32_bf16 v25, v183, v63, 0
  v_add_f32_dpp v20, v20, v20 quad_perm:[2,3,0,1] row_mask:0xf bank_mask:0xf
  v_cvt_f32_i32 v108, v108
  v_cvt_f32_i32 v109, v109
  v_add_f32_dpp v20, v20, v20 quad_perm:[1,0,3,2] row_mask:0xf bank_mask:0xf
  v_cndmask_b32_e64 v33, v33, v20, s[54:55]
  ds_write_b32 v1, v33 offset:3584
  v_cvt_f32_i32 v110, v110
  v_cvt_f32_i32 v111, v111
  v_pk_mul_f32 v[20:21], v[108:109], v[22:23]
  v_pk_add_f32 v[18:19], v[22:23], v[24:25]
  v_pk_fma_f32 v[20:21], v[110:111], v[24:25], v[20:21]
  v_add_f32 v18, v18, v19
  v_add_f32 v20, v20, v21
  s_add_u32 m0, s100, 23552
  v_lshrrev_b32 v10, 1, v235
  v_add_u32 v10, v10, v242
  v_mad_u64_u32 v[30:31], s[64:65], v10, 1, v[28:29]
  global_load_lds_dwordx4 v[30:31], off
  s_cmpk_gt_i32 s69, 0x31
  s_cbranch_scc1 L_p27_4
  s_cmpk_gt_i32 s69, 0xb
  s_cbranch_scc1 L_p27_2
  s_waitcnt vmcnt(8)
L_p27_2:
  s_waitcnt vmcnt(12)
L_p27_4:
  s_waitcnt vmcnt(13)
  buffer_load_dwordx4 v[96:99], v234, s[32:35], 0 offen nt
  s_waitcnt vmcnt(12)
  ds_read_b64 v[188:189], v12 offset:18432
  ds_read_b64 v[190:191], v12 offset:18560
  ds_read_b64 v[192:193], v12 offset:19456
  ds_read_b64 v[194:195], v12 offset:19584
  ds_read_b64 v[196:197], v12 offset:20480
  ds_read_b64 v[198:199], v12 offset:20608
  v_dot2_f32_bf16 v22, v181, v64, 0
  v_add_f32_dpp v35, v18, v18 row_ror:8 row_mask:0xf bank_mask:0xc
  v_add_f32_dpp v35, v20, v20 row_ror:8 row_mask:0xf bank_mask:0x3
  v_dot2_f32_bf16 v23, v186, v65, 0
  v_dot2_f32_bf16 v24, v184, v66, 0
  v_dot2_f32_bf16 v25, v187, v67, 0
  v_cvt_f32_i32 v112, v112
  v_cvt_f32_i32 v113, v113
  v_cvt_f32_i32 v114, v114
  v_cvt_f32_i32 v115, v115
  v_pk_mul_f32 v[20:21], v[112:113], v[22:23]
  v_pk_add_f32 v[18:19], v[22:23], v[24:25]
  v_pk_fma_f32 v[20:21], v[114:115], v[24:25], v[20:21]
  v_add_f32 v18, v18, v19
  v_add_f32 v20, v20, v21
  s_cmpk_gt_i32 s69, 0x31
  s_cbranch_scc1 L_p28_4
  s_cmpk_gt_i32 s69, 0x1d
  s_cbranch_scc1 L_p28_3
  s_cmpk_gt_i32 s69, 0xffcd
  s_cbranch_scc1 L_p28_0
  s_waitcnt vmcnt(8)
L_p28_0:
  s_waitcnt vmcnt(9)
L_p28_3:
  s_waitcnt vmcnt(13)
L_p28_4:
  s_waitcnt vmcnt(14)
  buffer_load_dwordx4 v[100:103], v235, s[32:35], 0 offen nt
L_it12:
  s_waitcnt lgkmcnt(0)
  s_waitcnt vmcnt(10)
  s_add_u32 s44, s78, 0x03030303
  v_msad_u8 v9, s78, v36, 0
  v_msad_u8 v10, s44, v36, 0
  v_msad_u8 v9, s78, v37, v9
  v_msad_u8 v10, s44, v37, v10
  v_msad_u8 v9, s78, v38, v9
  v_msad_u8 v10, s44, v38, v10
  s_mov_b64 exec, 3
  global_store_byte v7, v8, s[30:31]
  global_load_dwordx3 v[36:38], v236, s[30:31] sc1
  v_sub_u32 v9, v9, v10
  v_add_u32 v8, 1, v8
  s_mov_b64 exec, -1
  v_readlane_b32 s66, v9, 0
  v_readlane_b32 s67, v9, 1
  s_add_u32 s78, s78, 0x01010101
  s_lshl1_add_u32 s69, s91, s95
  s_add_u32 s95, s66, s67
  s_add_u32 s69, s69, s95
  v_perm_b32 v185, v190, v188, s56
  v_perm_b32 v190, v190, v188, s57
  v_perm_b32 v188, v191, v189, s56
  v_perm_b32 v191, v191, v189, s57
  v_dot2_f32_bf16 v22, v185, v44, 0
  v_add_f32_dpp v21, v18, v18 row_ror:8 row_mask:0xf bank_mask:0xc
  v_add_f32_dpp v21, v20, v20 row_ror:8 row_mask:0xf bank_mask:0x3
  v_add_f32_dpp v20, v35, v35 row_half_mirror row_mask:0xf bank_mask:0x5
  v_dot2_f32_bf16 v23, v190, v45, 0
  v_add_f32_dpp v20, v21, v21 row_half_mirror row_mask:0xf bank_mask:0xa
  v_dot2_f32_bf16 v24, v188, v46, 0
  v_dot2_f32_bf16 v25, v191, v47, 0
  v_add_f32_dpp v20, v20, v20 quad_perm:[2,3,0,1] row_mask:0xf bank_mask:0xf
  v_cvt_f32_i32 v68, v68
  v_cvt_f32_i32 v69, v69
  v_add_f32_dpp v20, v20, v20 quad_perm:[1,0,3,2] row_mask:0xf bank_mask:0xf
  v_cndmask_b32_e64 v33, v33, v20, s[48:49]
  v_cvt_f32_i32 v70, v70
  v_cvt_f32_i32 v71, v71
  v_pk_mul_f32 v[20:21], v[68:69], v[22:23]
  v_pk_add_f32 v[18:19], v[22:23], v[24:25]
  v_pk_fma_f32 v[20:21], v[70:71], v[24:25], v[20:21]
  v_add_f32 v18, v18, v19
  v_add_f32 v20, v20, v21
  s_cmpk_gt_i32 s69, 0x31
  s_cbranch_scc1 L_p29_4
  s_cmpk_gt_i32 s69, 0xffed
  s_cbranch_scc1 L_p29_1
  s_waitcnt vmcnt(6)
L_p29_1:
  s_waitcnt vmcnt(9)
L_p29_4:
  s_waitcnt vmcnt(11)
  buffer_load_dwordx4 v[104:107], v233, s[32:35], s80 offen nt
  v_perm_b32 v189, v194, v192, s56
  v_perm_b32 v194, v194, v192, s57
  v_perm_b32 v192, v195, v193, s56
  v_perm_b32 v195, v195, v193, s57
  v_dot2_f32_bf16 v22, v189, v48, 0
  v_add_f32_dpp v34, v18, v18 row_ror:8 row_mask:0xf bank_mask:0xc
  v_add_f32_dpp v34, v20, v20 row_ror:8 row_mask:0xf bank_mask:0x3
  v_dot2_f32_bf16 v23, v194, v49, 0
  v_dot2_f32_bf16 v24, v192, v50, 0
  v_dot2_f32_bf16 v25, v195, v51, 0
  v_cvt_f32_i32 v72, v72
  v_cvt_f32_i32 v73, v73
  v_cvt_f32_i32 v74, v74
  v_cvt_f32_i32 v75, v75
  v_pk_mul_f32 v[20:21], v[72:73], v[22:23]
  v_pk_add_f32 v[18:19], v[22:23], v[24:25]
  v_pk_fma_f32 v[20:21], v[74:75], v[24:25], v[20:21]
  v_add_f32 v18, v18, v19
  v_add_f32 v20, v20, v21
  s_cmpk_gt_i32 s69, 0x31
  s_cbranch_scc1 L_p30_4
  s_cmpk_gt_i32 s69, 0xb
  s_cbranch_scc1 L_p30_2
  s_waitcnt vmcnt(7)
L_p30_2:
  s_waitcnt vmcnt(10)
L_p30_4:
  s_waitcnt vmcnt(12)
  buffer_load_dwordx4 v[108:111], v234, s[32:35], s80 offen nt
  v_perm_b32 v193, v198, v196, s56
  v_perm_b32 v198, v198, v196, s57
  v_perm_b32 v196, v199, v197, s56
  v_perm_b32 v199, v199, v197, s57
  v_dot2_f32_bf16 v22, v193, v52, 0
  v_add_f32_dpp v21, v18, v18 row_ror:8 row_mask:0xf bank_mask:0xc
  v_add_f32_dpp v21, v20, v20 row_ror:8 row_mask:0xf bank_mask:0x3
  v_add_f32_dpp v20, v34, v34 row_half_mirror row_mask:0xf bank_mask:0x5
  v_dot2_f32_bf16 v23, v198, v53, 0
  v_add_f32_dpp v20, v21, v21 row_half_mirror row_mask:0xf bank_mask:0xa
  v_dot2_f32_bf16 v24, v196, v54, 0
  v_dot2_f32_bf16 v25, v199, v55, 0
  v_add_f32_dpp v20, v20, v20 quad_perm:[2,3,0,1] row_mask:0xf bank_mask:0xf
  v_cvt_f32_i32 v76, v76
  v_cvt_f32_i32 v77, v77
  v_add_f32_dpp v20, v20, v20 quad_perm:[1,0,3,2] row_mask:0xf bank_mask:0xf
  v_cndmask_b32_e64 v32, v32, v20, s[50:51]
  v_cvt_f32_i32 v78, v78
  v_cvt_f32_i32 v79, v79
  v_pk_mul_f32 v[20:21], v[76:77], v[22:23]
  v_pk_add_f32 v[18:19], v[22:23], v[24:25]
  v_pk_fma_f32 v[20:21], v[78:79], v[24:25], v[20:21]
  v_add_f32 v18, v18, v19
  v_add_f32 v20, v20, v21
  s_cmpk_gt_i32 s69, 0x31
  s_cbranch_scc1 L_p31_4
  s_cmpk_gt_i32 s69, 0x1d
  s_cbranch_scc1 L_p31_3
  s_cmpk_gt_i32 s69, 0xffcd
  s_cbranch_scc1 L_p31_0
  s_waitcnt vmcnt(6)
L_p31_0:
  s_waitcnt vmcnt(8)
L_p31_3:
  s_waitcnt vmcnt(11)
L_p31_4:
  s_waitcnt vmcnt(13)
  buffer_load_dwordx4 v[112:115], v235, s[32:35], s80 offen nt
L_it13:
  s_waitcnt lgkmcnt(0)
  s_waitcnt vmcnt(8)
  s_add_u32 s44, s78, 0x03030303
  v_msad_u8 v9, s78, v40, 0
  v_msad_u8 v10, s44, v40, 0
  v_msad_u8 v9, s78, v41, v9
  v_msad_u8 v10, s44, v41, v10
  v_msad_u8 v9, s78, v42, v9
  v_msad_u8 v10, s44, v42, v10
  s_mov_b64 exec, 3
  global_load_dwordx2 v[26:27], v11, s[30:31] sc1
  global_store_byte v7, v8, s[30:31]
  global_load_dwordx3 v[40:42], v237, s[30:31] sc1
  v_sub_u32 v9, v9, v10
  v_add_u32 v8, 1, v8
  s_mov_b64 exec, -1
  v_readlane_b32 s66, v9, 0
  v_readlane_b32 s67, v9, 1
  s_add_u32 s78, s78, 0x01010101
  s_lshl1_add_u32 s69, s91, s95
  s_add_u32 s95, s66, s67
  s_add_u32 s69, s69, s95
  v_dot2_f32_bf16 v22, v185, v56, 0
  v_add_f32_dpp v34, v18, v18 row_ror:8 row_mask:0xf bank_mask:0xc
  v_add_f32_dpp v34, v20, v20 row_ror:8 row_mask:0xf bank_mask:0x3
  v_dot2_f32_bf16 v23, v190, v57, 0
  v_dot2_f32_bf16 v24, v188, v58, 0
  v_dot2_f32_bf16 v25, v191, v59, 0
  v_cvt_f32_i32 v80, v80
  v_cvt_f32_i32 v81, v81
  v_cvt_f32_i32 v82, v82
  v_cvt_f32_i32 v83, v83
  v_pk_mul_f32 v[20:21], v[80:81], v[22:23]
  v_pk_add_f32 v[18:19], v[22:23], v[24:25]
  v_pk_fma_f32 v[20:21], v[82:83], v[24:25], v[20:21]
  v_add_f32 v18, v18, v19
  v_add_f32 v20, v20, v21
  s_cmpk_gt_i32 s69, 0x31
  s_cbranch_scc1 L_p32_4
  s_cmpk_gt_i32 s69, 0xffed
  s_cbranch_scc1 L_p32_1
  s_waitcnt vmcnt(6)
L_p32_1:
  s_waitcnt vmcnt(9)
L_p32_4:
  s_waitcnt vmcnt(10)
  buffer_load_dwordx4 v[68:71], v212, s[32:35], s3 offen nt
  v_dot2_f32_bf16 v22, v189, v60, 0
  v_add_f32_dpp v35, v18, v18 row_ror:8 row_mask:0xf bank_mask:0xc
  v_add_f32_dpp v35, v20, v20 row_ror:8 row_mask:0xf bank_mask:0x3
  v_dot2_f32_bf16 v23, v194, v61, 0
  v_dot2_f32_bf16 v24, v192, v62, 0
  v_dot2_f32_bf16 v25, v195, v63, 0
  v_cvt_f32_i32 v84, v84
  v_cvt_f32_i32 v85, v85
  v_cvt_f32_i32 v86, v86
  v_cvt_f32_i32 v87, v87
  v_pk_mul_f32 v[20:21], v[84:85], v[22:23]
  v_pk_add_f32 v[18:19], v[22:23], v[24:25]
  v_pk_fma_f32 v[20:21], v[86:87], v[24:25], v[20:21]
  v_add_f32 v18, v18, v19
  v_add_f32 v20, v20, v21
  s_cmpk_gt_i32 s69, 0x31
  s_cbranch_scc1 L_p33_4
  s_cmpk_gt_i32 s69, 0xb
  s_cbranch_scc1 L_p33_2
  s_waitcnt vmcnt(7)
L_p33_2:
  s_waitcnt vmcnt(10)
L_p33_4:
  s_waitcnt vmcnt(11)
  buffer_load_dwordx4 v[72:75], v213, s[32:35], s3 offen nt
  s_waitcnt vmcnt(10)
  ds_read_b64 v[200:201], v12 offset:21504
  ds_read_b64 v[202:203], v12 offset:21632
  ds_read_b64 v[204:205], v12 offset:22528
  ds_read_b64 v[206:207], v12 offset:22656
  ds_read_b64 v[208:209], v12 offset:23552
  ds_read_b64 v[210:211], v12 offset:23680
  v_dot2_f32_bf16 v22, v193, v64, 0
  v_add_f32_dpp v21, v18, v18 row_ror:8 row_mask:0xf bank_mask:0xc
  v_add_f32_dpp v21, v20, v20 row_ror:8 row_mask:0xf bank_mask:0x3
  v_add_f32_dpp v20, v35, v35 row_half_mirror row_mask:0xf bank_mask:0x5
  v_dot2_f32_bf16 v23, v198, v65, 0
  v_add_f32_dpp v20, v21, v21 row_half_mirror row_mask:0xf bank_mask:0xa
  v_dot2_f32_bf16 v24, v196, v66, 0
  v_dot2_f32_bf16 v25, v199, v67, 0
  v_add_f32_dpp v20, v20, v20 quad_perm:[2,3,0,1] row_mask:0xf bank_mask:0xf
  v_cvt_f32_i32 v88, v88
  v_cvt_f32_i32 v89, v89
  v_add_f32_dpp v20, v20, v20 quad_perm:[1,0,3,2] row_mask:0xf bank_mask:0xf
  v_cndmask_b32_e64 v33, v33, v20, s[50:51]
  v_cvt_f32_i32 v90, v90
  v_cvt_f32_i32 v91, v91
  v_pk_mul_f32 v[20:21], v[88:89], v[22:23]
  v_pk_add_f32 v[18:19], v[22:23], v[24:25]
  v_pk_fma_f32 v[20:21], v[90:91], v[24:25], v[20:21]
  v_add_f32 v18, v18, v19
  v_add_f32 v20, v20, v21
  s_cmpk_gt_i32 s69, 0x31
  s_cbranch_scc1 L_p34_4
  s_cmpk_gt_i32 s69, 0x1d
  s_cbranch_scc1 L_p34_3
  s_cmpk_gt_i32 s69, 0xffcd
  s_cbranch_scc1 L_p34_0
  s_waitcnt vmcnt(7)
L_p34_0:
  s_waitcnt vmcnt(8)
L_p34_3:
  s_waitcnt vmcnt(11)
L_p34_4:
  s_waitcnt vmcnt(12)
  buffer_load_dwordx4 v[76:79], v214, s[32:35], s3 offen nt
L_it14:
  s_waitcnt lgkmcnt(0)
  ds_read_b32 v4, v14 offset:16
  s_waitcnt vmcnt(8)
  s_add_u32 s44, s78, 0x03030303
  v_msad_u8 v9, s78, v36, 0
  v_msad_u8 v10, s44, v36, 0
  v_msad_u8 v9, s78, v37, v9
  v_msad_u8 v10, s44, v37, v10
  v_msad_u8 v9, s78, v38, v9
  v_msad_u8 v10, s44, v38, v10
  s_mov_b64 exec, 3
  global_store_byte v7, v8, s[30:31]
  global_load_dwordx3 v[36:38], v238, s[30:31] sc1
  v_sub_u32 v9, v9, v10
  v_add_u32 v8, 1, v8
  s_mov_b64 exec, -1
  v_readlane_b32 s66, v9, 0
  v_readlane_b32 s67, v9, 1
  s_add_u32 s78, s78, 0x01010101
  s_lshl1_add_u32 s69, s91, s95
  s_add_u32 s95, s66, s67
  s_add_u32 s69, s69, s95
  v_perm_b32 v197, v202, v200, s56
  v_perm_b32 v202, v202, v200, s57
  v_perm_b32 v200, v203, v201, s56
  v_perm_b32 v203, v203, v201, s57
  v_dot2_f32_bf16 v22, v197, v44, 0
  v_add_f32_dpp v35, v18, v18 row_ror:8 row_mask:0xf bank_mask:0xc
  v_add_f32_dpp v35, v20, v20 row_ror:8 row_mask:0xf bank_mask:0x3
  v_dot2_f32_bf16 v23, v202, v45, 0
  v_dot2_f32_bf16 v24, v200, v46, 0
  v_dot2_f32_bf16 v25, v203, v47, 0
  v_cvt_f32_i32 v92, v92
  v_cvt_f32_i32 v93, v93
  v_cvt_f32_i32 v94, v94
  v_cvt_f32_i32 v95, v95
  v_pk_mul_f32 v[20:21], v[92:93], v[22:23]
  v_pk_add_f32 v[18:19], v[22:23], v[24:25]
  v_pk_fma_f32 v[20:21], v[94:95], v[24:25], v[20:21]
  v_add_f32 v18, v18, v19
  v_add_f32 v20, v20, v21
  s_cmpk_gt_i32 s69, 0x31
  s_cbranch_scc1 L_p35_4
  s_cmpk_gt_i32 s69, 0xffed
  s_cbranch_scc1 L_p35_1
  s_waitcnt vmcnt(5)
L_p35_1:
  s_waitcnt vmcnt(9)
L_p35_4:
  s_waitcnt vmcnt(10)
  buffer_load_dwordx4 v[80:83], v215, s[32:35], s3 offen nt
  v_perm_b32 v201, v206, v204, s56
  v_perm_b32 v206, v206, v204, s57
  v_perm_b32 v204, v207, v205, s56
  v_perm_b32 v207, v207, v205, s57
  v_dot2_f32_bf16 v22, v201, v48, 0
  v_add_f32_dpp v21, v18, v18 row_ror:8 row_mask:0xf bank_mask:0xc
  v_add_f32_dpp v21, v20, v20 row_ror:8 row_mask:0xf bank_mask:0x3
  v_add_f32_dpp v20, v34, v34 row_half_mirror row_mask:0xf bank_mask:0x5
  v_dot2_f32_bf16 v23, v206, v49, 0
  v_add_f32_dpp v20, v21, v21 row_half_mirror row_mask:0xf bank_mask:0xa
  v_dot2_f32_bf16 v24, v204, v50, 0
  v_dot2_f32_bf16 v25, v207, v51, 0
  v_add_f32_dpp v20, v20, v20 quad_perm:[2,3,0,1] row_mask:0xf bank_mask:0xf
  v_cvt_f32_i32 v96, v96
  v_cvt_f32_i32 v97, v97
  v_add_f32_dpp v20, v20, v20 quad_perm:[1,0,3,2] row_mask:0xf bank_mask:0xf
  v_cndmask_b32_e64 v32, v32, v20, s[52:53]
  v_cvt_f32_i32 v98, v98
  v_cvt_f32_i32 v99, v99
  v_pk_mul_f32 v[20:21], v[96:97], v[22:23]
  v_pk_add_f32 v[18:19], v[22:23], v[24:25]
  v_pk_fma_f32 v[20:21], v[98:99], v[24:25], v[20:21]
  v_add_f32 v18, v18, v19
  v_add_f32 v20, v20, v21
  s_cmpk_gt_i32 s69, 0x31
  s_cbranch_scc1 L_p36_4
  s_cmpk_gt_i32 s69, 0xb
  s_cbranch_scc1 L_p36_2
  s_waitcnt vmcnt(6)
L_p36_2:
  s_waitcnt vmcnt(10)
L_p36_4:
  s_waitcnt vmcnt(11)
  buffer_load_dwordx4 v[84:87], v216, s[32:35], s3 offen nt
  v_perm_b32 v205, v210, v208, s56
  v_perm_b32 v210, v210, v208, s57
  v_perm_b32 v208, v211, v209, s56
  v_perm_b32 v211, v211, v209, s57
  v_dot2_f32_bf16 v22, v205, v52, 0
  v_add_f32_dpp v34, v18, v18 row_ror:8 row_mask:0xf bank_mask:0xc
  v_add_f32_dpp v34, v20, v20 row_ror:8 row_mask:0xf bank_mask:0x3
  v_dot2_f32_bf16 v23, v210, v53, 0
  v_dot2_f32_bf16 v24, v208, v54, 0
  v_dot2_f32_bf16 v25, v211, v55, 0
  v_cvt_f32_i32 v100, v100
  v_cvt_f32_i32 v101, v101
  v_cvt_f32_i32 v102, v102
  v_cvt_f32_i32 v103, v103
  v_pk_mul_f32 v[20:21], v[100:101], v[22:23]
  v_pk_add_f32 v[18:19], v[22:23], v[24:25]
  v_pk_fma_f32 v[20:21], v[102:103], v[24:25], v[20:21]
  v_add_f32 v18, v18, v19
  v_add_f32 v20, v20, v21
  s_cmpk_gt_i32 s69, 0x31
  s_cbranch_scc1 L_p37_4
  s_cmpk_gt_i32 s69, 0x1d
  s_cbranch_scc1 L_p37_3
  s_cmpk_gt_i32 s69, 0xffcd
  s_cbranch_scc1 L_p37_0
  s_waitcnt vmcnt(6)
L_p37_0:
  s_waitcnt vmcnt(7)
L_p37_3:
  s_waitcnt vmcnt(11)
L_p37_4:
  s_waitcnt vmcnt(12)
  buffer_load_dwordx4 v[88:91], v217, s[32:35], s3 offen nt
L_it15:
  s_mov_b32 s47, 3
L_fq15:
  s_waitcnt lgkmcnt(0)
  v_readfirstlane_b32 s46, v4
  s_cmp_ge_u32 s46, s47
  s_cbranch_scc1 L_fq15_ok
  s_cmp_eq_u32 s94, 0
  s_cbranch_scc1 L_fq15_ok
  s_sub_u32 s94, s94, 1
  ds_read_b32 v4, v14 offset:16
  s_branch L_fq15
L_fq15_ok:
  s_waitcnt vmcnt(7)
  s_add_u32 s44, s78, 0x03030303
  v_msad_u8 v9, s78, v40, 0
  v_msad_u8 v10, s44, v40, 0
  v_msad_u8 v9, s78, v41, v9
  v_msad_u8 v10, s44, v41, v10
  v_msad_u8 v9, s78, v42, v9
  v_msad_u8 v10, s44, v42, v10
  s_mov_b64 exec, 3
  global_store_byte v7, v8, s[30:31]
  global_load_dwordx3 v[40:42], v239, s[30:31] sc1
  v_sub_u32 v9, v9, v10
  v_add3_u32 v10, v26, v27, s58
  v_add_u32 v8, 1, v8
  s_mov_b64 exec, -1
  v_readlane_b32 s66, v9, 0
  v_readlane_b32 s67, v9, 1
  v_readlane_b32 s91, v10, 0
  s_add_u32 s78, s78, 0x01010101
  s_lshl1_add_u32 s69, s91, s95
  s_add_u32 s95, s66, s67
  s_add_u32 s69, s69, s95
  v_dot2_f32_bf16 v22, v197, v56, 0
  v_add_f32_dpp v21, v18, v18 row_ror:8 row_mask:0xf bank_mask:0xc
  v_add_f32_dpp v21, v20, v20 row_ror:8 row_mask:0xf bank_mask:0x3
  v_add_f32_dpp v20, v34, v34 row_half_mirror row_mask:0xf bank_mask:0x5
  v_dot2_f32_bf16 v23, v202, v57, 0
  v_add_f32_dpp v20, v21, v21 row_half_mirror row_mask:0xf bank_mask:0xa
  v_dot2_f32_bf16 v24, v200, v58, 0
  v_dot2_f32_bf16 v25, v203, v59, 0
  v_add_f32_dpp v20, v20, v20 quad_perm:[2,3,0,1] row_mask:0xf bank_mask:0xf
  v_cvt_f32_i32 v104, v104
  v_cvt_f32_i32 v105, v105
  v_add_f32_dpp v20, v20, v20 quad_perm:[1,0,3,2] row_mask:0xf bank_mask:0xf
  v_cndmask_b32_e64 v32, v32, v20, s[54:55]
  ds_write_b32 v1, v32 offset:1024
  v_cvt_f32_i32 v106, v106
  v_cvt_f32_i32 v107, v107
  ds_read_b128 v[44:47], v15 offset:2560
  v_pk_mul_f32 v[20:21], v[104:105], v[22:23]
  v_pk_add_f32 v[18:19], v[22:23], v[24:25]
  v_pk_fma_f32 v[20:21], v[106:107], v[24:25], v[20:21]
  v_add_f32 v18, v18, v19
  v_add_f32 v20, v20, v21
  s_cmpk_gt_i32 s69, 0x31
  s_cbranch_scc1 L_p38_4
  s_cmpk_gt_i32 s69, 0xffed
  s_cbranch_scc1 L_p38_1
  s_waitcnt vmcnt(5)
L_p38_1:
  s_waitcnt vmcnt(8)
L_p38_4:
  s_waitcnt vmcnt(9)
  buffer_load_dwordx4 v[92:95], v218, s[32:35], s3 offen nt
  v_dot2_f32_bf16 v22, v201, v60, 0
  v_add_f32_dpp v21, v18, v18 row_ror:8 row_mask:0xf bank_mask:0xc
  v_add_f32_dpp v21, v20, v20 row_ror:8 row_mask:0xf bank_mask:0x3
  v_add_f32_dpp v20, v35, v35 row_half_mirror row_mask:0xf bank_mask:0x5
  v_dot2_f32_bf16 v23, v206, v61, 0
  v_add_f32_dpp v20, v21, v21 row_half_mirror row_mask:0xf bank_mask:0xa
  v_dot2_f32_bf16 v24, v204, v62, 0
  v_dot2_f32_bf16 v25, v207, v63, 0
  v_add_f32_dpp v20, v20, v20 quad_perm:[2,3,0,1] row_mask:0xf bank_mask:0xf
  v_cvt_f32_i32 v108, v108
  v_cvt_f32_i32 v109, v109
  v_add_f32_dpp v20, v20, v20 quad_perm:[1,0,3,2] row_mask:0xf bank_mask:0xf
  v_cndmask_b32_e64 v33, v33, v20, s[52:53]
  v_cvt_f32_i32 v110, v110
  v_cvt_f32_i32 v111, v111
  ds_read_b128 v[48:51], v16 offset:2560
  v_pk_mul_f32 v[20:21], v[108:109], v[22:23]
  v_pk_add_f32 v[18:19], v[22:23], v[24:25]
  v_pk_fma_f32 v[20:21], v[110:111], v[24:25], v[20:21]
  v_add_f32 v18, v18, v19
  v_add_f32 v20, v20, v21
  s_cmpk_gt_i32 s69, 0x31
  s_cbranch_scc1 L_p39_4
  s_cmpk_gt_i32 s69, 0xb
  s_cbranch_scc1 L_p39_2
  s_waitcnt vmcnt(6)
L_p39_2:
  s_waitcnt vmcnt(9)
L_p39_4:
  s_waitcnt vmcnt(10)
  buffer_load_dwordx4 v[96:99], v219, s[32:35], s3 offen nt
  v_dot2_f32_bf16 v22, v205, v64, 0
  v_add_f32_dpp v35, v18, v18 row_ror:8 row_mask:0xf bank_mask:0xc
  v_add_f32_dpp v35, v20, v20 row_ror:8 row_mask:0xf bank_mask:0x3
  v_dot2_f32_bf16 v23, v210, v65, 0
  v_dot2_f32_bf16 v24, v208, v66, 0
  v_dot2_f32_bf16 v25, v211, v67, 0
  v_cvt_f32_i32 v112, v112
  v_cvt_f32_i32 v113, v113
  v_cvt_f32_i32 v114, v114
  v_cvt_f32_i32 v115, v115
  ds_read_b128 v[52:55], v17 offset:2560
  v_pk_mul_f32 v[20:21], v[112:113], v[22:23]
  v_pk_add_f32 v[18:19], v[22:23], v[24:25]
  v_pk_fma_f32 v[20:21], v[114:115], v[24:25], v[20:21]
  v_add_f32 v18, v18, v19
  v_add_f32 v20, v20, v21
  s_cmpk_gt_i32 s69, 0x31
  s_cbranch_scc1 L_p40_4
  s_cmpk_gt_i32 s69, 0x1d
  s_cbranch_scc1 L_p40_3
  s_cmpk_gt_i32 s69, 0xffcd
  s_cbranch_scc1 L_p40_0
  s_waitcnt vmcnt(6)
L_p40_0:
  s_waitcnt vmcnt(7)
L_p40_3:
  s_waitcnt vmcnt(10)
L_p40_4:
  s_waitcnt vmcnt(11)
  buffer_load_dwordx4 v[100:103], v220, s[32:35], s3 offen nt
  s_nop 0
  v_add_f32_dpp v21, v18, v18 row_ror:8 row_mask:0xf bank_mask:0xc
  v_add_f32_dpp v21, v20, v20 row_ror:8 row_mask:0xf bank_mask:0x3
  v_add_f32_dpp v20, v35, v35 row_half_mirror row_mask:0xf bank_mask:0x5
  s_nop 0
  v_add_f32_dpp v20, v21, v21 row_half_mirror row_mask:0xf bank_mask:0xa
  s_nop 1
  v_add_f32_dpp v20, v20, v20 quad_perm:[2,3,0,1] row_mask:0xf bank_mask:0xf
  s_nop 1
  v_add_f32_dpp v20, v20, v20 quad_perm:[1,0,3,2] row_mask:0xf bank_mask:0xf
  v_cndmask_b32_e64 v33, v33, v20, s[54:55]
  ds_write_b32 v1, v33 offset:4096
  v_mov_b32 v9, 2
  ds_write_b32 v6, v9 offset:0
  v_add_u32 v15, 2048, v15
  v_add_u32 v16, 2048, v16
  v_add_u32 v17, 2048, v17
  s_mov_b32 s43, 2
  s_movk_i32 s101, 6144
  s_mov_b32 s34, 1572864
  s_add_u32 s32, s32, s3
  s_addc_u32 s33, s33, 0
  s_mov_b32 s68, 3
  s_lshl_b32 s44, s68, 2
  s_lshr_b64 s[64:65], s[96:97], s44
  s_and_b32 s64, s64, 15
  s_lshl4_add_u32 s68, s68, s64
  s_mul_i32 s44, s68, 1572864
  s_add_u32 s36, s6, s44
  s_addc_u32 s37, s7, 0
.p2align 6
L_k:
  s_add_u32 s44, s43, 2
  s_min_u32 s47, s44, 16
  v_add_u32 v15, 1024, v15
  v_and_b32 v15, 0xfff, v15
  v_add_u32 v16, 1024, v16
  v_and_b32 v16, 0xfff, v16
  v_add_u32 v17, 1024, v17
  v_and_b32 v17, 0xfff, v17
  v_add_u32 v2, s101, v1
  s_addk_i32 s101, 3072
  s_cmpk_eq_u32 s101, 18432
  s_cselect_b32 s101, 0, s101
  s_waitcnt lgkmcnt(0)
  s_waitcnt vmcnt(8)
  s_add_u32 s44, s78, 0x03030303
  v_msad_u8 v9, s78, v36, 0
  v_msad_u8 v10, s44, v36, 0
  v_msad_u8 v9, s78, v37, v9
  v_msad_u8 v10, s44, v37, v10
  v_msad_u8 v9, s78, v38, v9
  v_msad_u8 v10, s44, v38, v10
  s_mov_b64 exec, 3
  global_store_byte v7, v8, s[30:31]
  global_load_dwordx3 v[36:38], v236, s[30:31] sc1
  v_sub_u32 v9, v9, v10
  v_add_u32 v8, 1, v8
  s_mov_b64 exec, -1
  v_readlane_b32 s66, v9, 0
  v_readlane_b32 s67, v9, 1
  s_add_u32 s78, s78, 0x01010101
  s_lshl1_add_u32 s69, s91, s95
  s_add_u32 s95, s66, s67
  s_add_u32 s69, s69, s95
  v_dot2_f32_bf16 v22, v13, v44, 0
  v_dot2_f32_bf16 v23, v118, v45, 0
  v_dot2_f32_bf16 v24, v116, v46, 0
  v_dot2_f32_bf16 v25, v119, v47, 0
  v_cvt_f32_i32 v68, v68
  v_cvt_f32_i32 v69, v69
  v_cvt_f32_i32 v70, v70
  v_cvt_f32_i32 v71, v71
  v_pk_mul_f32 v[20:21], v[68:69], v[22:23]
  v_pk_add_f32 v[18:19], v[22:23], v[24:25]
  v_pk_fma_f32 v[20:21], v[70:71], v[24:25], v[20:21]
  v_add_f32 v18, v18, v19
  v_add_f32 v20, v20, v21
  s_cmpk_gt_i32 s69, 0x2d
  s_cbranch_scc1 L_p41_4
  s_cmpk_gt_i32 s69, 0xffe9
  s_cbranch_scc1 L_p41_1
  s_waitcnt vmcnt(5)
L_p41_1:
  s_waitcnt vmcnt(8)
L_p41_4:
  s_waitcnt vmcnt(9)
  buffer_load_dwordx4 v[104:107], v221, s[32:35], 0 offen nt
  v_dot2_f32_bf16 v22, v117, v48, 0
  v_add_f32_dpp v34, v18, v18 row_ror:8 row_mask:0xf bank_mask:0xc
  v_add_f32_dpp v34, v20, v20 row_ror:8 row_mask:0xf bank_mask:0x3
  v_dot2_f32_bf16 v23, v122, v49, 0
  v_dot2_f32_bf16 v24, v120, v50, 0
  v_dot2_f32_bf16 v25, v123, v51, 0
  v_cvt_f32_i32 v72, v72
  v_cvt_f32_i32 v73, v73
  v_cvt_f32_i32 v74, v74
  v_cvt_f32_i32 v75, v75
  v_pk_mul_f32 v[20:21], v[72:73], v[22:23]
  v_pk_add_f32 v[18:19], v[22:23], v[24:25]
  v_pk_fma_f32 v[20:21], v[74:75], v[24:25], v[20:21]
  v_add_f32 v18, v18, v19
  v_add_f32 v20, v20, v21
  s_cmpk_gt_i32 s69, 0x2d
  s_cbranch_scc1 L_p42_4
  s_cmpk_gt_i32 s69, 0x7
  s_cbranch_scc1 L_p42_2
  s_waitcnt vmcnt(6)
L_p42_2:
  s_waitcnt vmcnt(9)
L_p42_4:
  s_waitcnt vmcnt(10)
  buffer_load_dwordx4 v[108:111], v222, s[32:35], 0 offen nt
  v_dot2_f32_bf16 v22, v121, v52, 0
  v_add_f32_dpp v21, v18, v18 row_ror:8 row_mask:0xf bank_mask:0xc
  v_add_f32_dpp v21, v20, v20 row_ror:8 row_mask:0xf bank_mask:0x3
  v_add_f32_dpp v20, v34, v34 row_half_mirror row_mask:0xf bank_mask:0x5
  v_dot2_f32_bf16 v23, v126, v53, 0
  v_add_f32_dpp v20, v21, v21 row_half_mirror row_mask:0xf bank_mask:0xa
  v_dot2_f32_bf16 v24, v124, v54, 0
  v_dot2_f32_bf16 v25, v127, v55, 0
  v_add_f32_dpp v20, v20, v20 quad_perm:[2,3,0,1] row_mask:0xf bank_mask:0xf
  v_cvt_f32_i32 v76, v76
  v_cvt_f32_i32 v77, v77
  v_add_f32_dpp v20, v20, v20 quad_perm:[1,0,3,2] row_mask:0xf bank_mask:0xf
  v_cndmask_b32_e64 v32, v32, v20, s[48:49]
  v_cvt_f32_i32 v78, v78
  v_cvt_f32_i32 v79, v79
  v_pk_mul_f32 v[20:21], v[76:77], v[22:23]
  v_pk_add_f32 v[18:19], v[22:23], v[24:25]
  v_pk_fma_f32 v[20:21], v[78:79], v[24:25], v[20:21]
  v_add_f32 v18, v18, v19
  v_add_f32 v20, v20, v21
  s_cmpk_gt_i32 s69, 0x2d
  s_cbranch_scc1 L_p43_4
  s_cmpk_gt_i32 s69, 0x19
  s_cbranch_scc1 L_p43_3
  s_cmpk_gt_i32 s69, 0xffc9
  s_cbranch_scc1 L_p43_0
  s_waitcnt vmcnt(6)
L_p43_0:
  s_waitcnt vmcnt(7)
L_p43_3:
  s_waitcnt vmcnt(10)
L_p43_4:
  s_waitcnt vmcnt(11)
  buffer_load_dwordx4 v[112:115], v223, s[32:35], 0 offen nt
  s_waitcnt vmcnt(8)
  s_add_u32 s44, s78, 0x03030303
  v_msad_u8 v9, s78, v40, 0
  v_msad_u8 v10, s44, v40, 0
  v_msad_u8 v9, s78, v41, v9
  v_msad_u8 v10, s44, v41, v10
  v_msad_u8 v9, s78, v42, v9
  v_msad_u8 v10, s44, v42, v10
  s_mov_b64 exec, 3
  global_store_byte v7, v8, s[30:31]
  global_load_dwordx3 v[40:42], v237, s[30:31] sc1
  v_sub_u32 v9, v9, v10
  v_add_u32 v8, 1, v8
  s_mov_b64 exec, -1
  v_readlane_b32 s66, v9, 0
  v_readlane_b32 s67, v9, 1
  s_add_u32 s78, s78, 0x01010101
  s_lshl1_add_u32 s69, s91, s95
  s_add_u32 s95, s66, s67
  s_add_u32 s69, s69, s95
  v_dot2_f32_bf16 v22, v125, v44, 0
  v_add_f32_dpp v34, v18, v18 row_ror:8 row_mask:0xf bank_mask:0xc
  v_add_f32_dpp v34, v20, v20 row_ror:8 row_mask:0xf bank_mask:0x3
  v_dot2_f32_bf16 v23, v130, v45, 0
  v_dot2_f32_bf16 v24, v128, v46, 0
  v_dot2_f32_bf16 v25, v131, v47, 0
  v_cvt_f32_i32 v80, v80
  v_cvt_f32_i32 v81, v81
  v_cvt_f32_i32 v82, v82
  v_cvt_f32_i32 v83, v83
  v_pk_mul_f32 v[20:21], v[80:81], v[22:23]
  v_pk_add_f32 v[18:19], v[22:23], v[24:25]
  v_pk_fma_f32 v[20:21], v[82:83], v[24:25], v[20:21]
  v_add_f32 v18, v18, v19
  v_add_f32 v20, v20, v21
  s_cmpk_gt_i32 s69, 0x2d
  s_cbranch_scc1 L_p44_4
  s_cmpk_gt_i32 s69, 0xffe9
  s_cbranch_scc1 L_p44_1
  s_waitcnt vmcnt(5)
L_p44_1:
  s_waitcnt vmcnt(8)
L_p44_4:
  s_waitcnt vmcnt(9)
  buffer_load_dwordx4 v[68:71], v224, s[32:35], 0 offen nt
  v_dot2_f32_bf16 v22, v129, v48, 0
  v_add_f32_dpp v21, v18, v18 row_ror:8 row_mask:0xf bank_mask:0xc
  v_add_f32_dpp v21, v20, v20 row_ror:8 row_mask:0xf bank_mask:0x3
  v_add_f32_dpp v20, v34, v34 row_half_mirror row_mask:0xf bank_mask:0x5
  v_dot2_f32_bf16 v23, v134, v49, 0
  v_add_f32_dpp v20, v21, v21 row_half_mirror row_mask:0xf bank_mask:0xa
  v_dot2_f32_bf16 v24, v132, v50, 0
  v_dot2_f32_bf16 v25, v135, v51, 0
  v_add_f32_dpp v20, v20, v20 quad_perm:[2,3,0,1] row_mask:0xf bank_mask:0xf
  v_cvt_f32_i32 v84, v84
  v_cvt_f32_i32 v85, v85
  v_add_f32_dpp v20, v20, v20 quad_perm:[1,0,3,2] row_mask:0xf bank_mask:0xf
  v_cndmask_b32_e64 v32, v32, v20, s[50:51]
  v_cvt_f32_i32 v86, v86
  v_cvt_f32_i32 v87, v87
  v_pk_mul_f32 v[20:21], v[84:85], v[22:23]
  v_pk_add_f32 v[18:19], v[22:23], v[24:25]
  v_pk_fma_f32 v[20:21], v[86:87], v[24:25], v[20:21]
  v_add_f32 v18, v18, v19
  v_add_f32 v20, v20, v21
  s_cmpk_gt_i32 s69, 0x2d
  s_cbranch_scc1 L_p45_4
  s_cmpk_gt_i32 s69, 0x7
  s_cbranch_scc1 L_p45_2
  s_waitcnt vmcnt(6)
L_p45_2:
  s_waitcnt vmcnt(9)
L_p45_4:
  s_waitcnt vmcnt(10)
  buffer_load_dwordx4 v[72:75], v225, s[32:35], 0 offen nt
  v_dot2_f32_bf16 v22, v133, v52, 0
  v_add_f32_dpp v34, v18, v18 row_ror:8 row_mask:0xf bank_mask:0xc
  v_add_f32_dpp v34, v20, v20 row_ror:8 row_mask:0xf bank_mask:0x3
  v_dot2_f32_bf16 v23, v138, v53, 0
  v_dot2_f32_bf16 v24, v136, v54, 0
  v_dot2_f32_bf16 v25, v139, v55, 0
  v_cvt_f32_i32 v88, v88
  v_cvt_f32_i32 v89, v89
  v_cvt_f32_i32 v90, v90
  v_cvt_f32_i32 v91, v91
  v_pk_mul_f32 v[20:21], v[88:89], v[22:23]
  v_pk_add_f32 v[18:19], v[22:23], v[24:25]
  v_pk_fma_f32 v[20:21], v[90:91], v[24:25], v[20:21]
  v_add_f32 v18, v18, v19
  v_add_f32 v20, v20, v21
  s_cmpk_gt_i32 s69, 0x2d
  s_cbranch_scc1 L_p46_4
  s_cmpk_gt_i32 s69, 0x19
  s_cbranch_scc1 L_p46_3
  s_cmpk_gt_i32 s69, 0xffc9
  s_cbranch_scc1 L_p46_0
  s_waitcnt vmcnt(6)
L_p46_0:
  s_waitcnt vmcnt(7)
L_p46_3:
  s_waitcnt vmcnt(10)
L_p46_4:
  s_waitcnt vmcnt(11)
  buffer_load_dwordx4 v[76:79], v226, s[32:35], 0 offen nt
  v_mov_b32 v9, s43
  ds_write_b32 v14, v9 offset:28
  s_waitcnt vmcnt(8)
  s_add_u32 s44, s78, 0x03030303
  v_msad_u8 v9, s78, v36, 0
  v_msad_u8 v10, s44, v36, 0
  v_msad_u8 v9, s78, v37, v9
  v_msad_u8 v10, s44, v37, v10
  v_msad_u8 v9, s78, v38, v9
  v_msad_u8 v10, s44, v38, v10
  s_mov_b64 exec, 3
  global_store_byte v7, v8, s[30:31]
  global_load_dwordx3 v[36:38], v238, s[30:31] sc1
  v_sub_u32 v9, v9, v10
  v_add_u32 v8, 1, v8
  s_mov_b64 exec, -1
  v_readlane_b32 s66, v9, 0
  v_readlane_b32 s67, v9, 1
  s_add_u32 s78, s78, 0x01010101
  s_lshl1_add_u32 s69, s91, s95
  s_add_u32 s95, s66, s67
  s_add_u32 s69, s69, s95
  v_dot2_f32_bf16 v22, v137, v44, 0
  v_add_f32_dpp v21, v18, v18 row_ror:8 row_mask:0xf bank_mask:0xc
  v_add_f32_dpp v21, v20, v20 row_ror:8 row_mask:0xf bank_mask:0x3
  v_add_f32_dpp v20, v34, v34 row_half_mirror row_mask:0xf bank_mask:0x5
  v_dot2_f32_bf16 v23, v142, v45, 0
  v_add_f32_dpp v20, v21, v21 row_half_mirror row_mask:0xf bank_mask:0xa
  v_dot2_f32_bf16 v24, v140, v46, 0
  v_dot2_f32_bf16 v25, v143, v47, 0
  v_add_f32_dpp v20, v20, v20 quad_perm:[2,3,0,1] row_mask:0xf bank_mask:0xf
  v_cvt_f32_i32 v92, v92
  v_cvt_f32_i32 v93, v93
  v_add_f32_dpp v20, v20, v20 quad_perm:[1,0,3,2] row_mask:0xf bank_mask:0xf
  v_cndmask_b32_e64 v32, v32, v20, s[52:53]
  v_cvt_f32_i32 v94, v94
  v_cvt_f32_i32 v95, v95
  v_pk_mul_f32 v[20:21], v[92:93], v[22:23]
  v_pk_add_f32 v[18:19], v[22:23], v[24:25]
  v_pk_fma_f32 v[20:21], v[94:95], v[24:25], v[20:21]
  v_add_f32 v18, v18, v19
  v_add_f32 v20, v20, v21
  s_cmpk_gt_i32 s69, 0x2d
  s_cbranch_scc1 L_p47_4
  s_cmpk_gt_i32 s69, 0xffe9
  s_cbranch_scc1 L_p47_1
  s_waitcnt vmcnt(5)
L_p47_1:
  s_waitcnt vmcnt(8)
L_p47_4:
  s_waitcnt vmcnt(9)
  buffer_load_dwordx4 v[80:83], v227, s[32:35], 0 offen nt
  v_dot2_f32_bf16 v22, v141, v48, 0
  v_add_f32_dpp v34, v18, v18 row_ror:8 row_mask:0xf bank_mask:0xc
  v_add_f32_dpp v34, v20, v20 row_ror:8 row_mask:0xf bank_mask:0x3
  v_dot2_f32_bf16 v23, v146, v49, 0
  v_dot2_f32_bf16 v24, v144, v50, 0
  v_dot2_f32_bf16 v25, v147, v51, 0
  v_cvt_f32_i32 v96, v96
  v_cvt_f32_i32 v97, v97
  v_cvt_f32_i32 v98, v98
  v_cvt_f32_i32 v99, v99
  v_pk_mul_f32 v[20:21], v[96:97], v[22:23]
  v_pk_add_f32 v[18:19], v[22:23], v[24:25]
  v_pk_fma_f32 v[20:21], v[98:99], v[24:25], v[20:21]
  v_add_f32 v18, v18, v19
  v_add_f32 v20, v20, v21
  s_cmpk_gt_i32 s69, 0x2d
  s_cbranch_scc1 L_p48_4
  s_cmpk_gt_i32 s69, 0x7
  s_cbranch_scc1 L_p48_2
  s_waitcnt vmcnt(6)
L_p48_2:
  s_waitcnt vmcnt(9)
L_p48_4:
  s_waitcnt vmcnt(10)
  buffer_load_dwordx4 v[84:87], v228, s[32:35], 0 offen nt
  v_dot2_f32_bf16 v22, v145, v52, 0
  v_add_f32_dpp v21, v18, v18 row_ror:8 row_mask:0xf bank_mask:0xc
  v_add_f32_dpp v21, v20, v20 row_ror:8 row_mask:0xf bank_mask:0x3
  v_add_f32_dpp v20, v34, v34 row_half_mirror row_mask:0xf bank_mask:0x5
  v_dot2_f32_bf16 v23, v150, v53, 0
  v_add_f32_dpp v20, v21, v21 row_half_mirror row_mask:0xf bank_mask:0xa
  v_dot2_f32_bf16 v24, v148, v54, 0
  v_dot2_f32_bf16 v25, v151, v55, 0
  v_add_f32_dpp v20, v20, v20 quad_perm:[2,3,0,1] row_mask:0xf bank_mask:0xf
  v_cvt_f32_i32 v100, v100
  v_cvt_f32_i32 v101, v101
  v_add_f32_dpp v20, v20, v20 quad_perm:[1,0,3,2] row_mask:0xf bank_mask:0xf
  v_cndmask_b32_e64 v32, v32, v20, s[54:55]
  ds_write_b32 v2, v32 offset:0
  v_cvt_f32_i32 v102, v102
  v_cvt_f32_i32 v103, v103
  v_pk_mul_f32 v[20:21], v[100:101], v[22:23]
  v_pk_add_f32 v[18:19], v[22:23], v[24:25]
  v_pk_fma_f32 v[20:21], v[102:103], v[24:25], v[20:21]
  v_add_f32 v18, v18, v19
  v_add_f32 v20, v20, v21
  s_cmpk_gt_i32 s69, 0x2d
  s_cbranch_scc1 L_p49_4
  s_cmpk_gt_i32 s69, 0x19
  s_cbranch_scc1 L_p49_3
  s_cmpk_gt_i32 s69, 0xffc9
  s_cbranch_scc1 L_p49_0
  s_waitcnt vmcnt(6)
L_p49_0:
  s_waitcnt vmcnt(7)
L_p49_3:
  s_waitcnt vmcnt(10)
L_p49_4:
  s_waitcnt vmcnt(11)
  buffer_load_dwordx4 v[88:91], v229, s[32:35], 0 offen nt
  s_waitcnt vmcnt(8)
  s_add_u32 s44, s78, 0x03030303
  v_msad_u8 v9, s78, v40, 0
  v_msad_u8 v10, s44, v40, 0
  v_msad_u8 v9, s78, v41, v9
  v_msad_u8 v10, s44, v41, v10
  v_msad_u8 v9, s78, v42, v9
  v_msad_u8 v10, s44, v42, v10
  s_mov_b64 exec, 3
  global_store_byte v7, v8, s[30:31]
  global_load_dwordx3 v[40:42], v239, s[30:31] sc1
  v_sub_u32 v9, v9, v10
  v_add_u32 v8, 1, v8
  s_mov_b64 exec, -1
  v_readlane_b32 s66, v9, 0
  v_readlane_b32 s67, v9, 1
  s_add_u32 s78, s78, 0x01010101
  s_lshl1_add_u32 s69, s91, s95
  s_add_u32 s95, s66, s67
  s_add_u32 s69, s69, s95
  v_dot2_f32_bf16 v22, v149, v44, 0
  v_add_f32_dpp v34, v18, v18 row_ror:8 row_mask:0xf bank_mask:0xc
  v_add_f32_dpp v34, v20, v20 row_ror:8 row_mask:0xf bank_mask:0x3
  v_dot2_f32_bf16 v23, v154, v45, 0
  v_dot2_f32_bf16 v24, v152, v46, 0
  v_dot2_f32_bf16 v25, v155, v47, 0
  v_cvt_f32_i32 v104, v104
  v_cvt_f32_i32 v105, v105
  v_cvt_f32_i32 v106, v106
  v_cvt_f32_i32 v107, v107
  v_pk_mul_f32 v[20:21], v[104:105], v[22:23]
  v_pk_add_f32 v[18:19], v[22:23], v[24:25]
  v_pk_fma_f32 v[20:21], v[106:107], v[24:25], v[20:21]
  v_add_f32 v18, v18, v19
  v_add_f32 v20, v20, v21
  s_cmpk_gt_i32 s69, 0x2d
  s_cbranch_scc1 L_p50_4
  s_cmpk_gt_i32 s69, 0xffe9
  s_cbranch_scc1 L_p50_1
  s_waitcnt vmcnt(5)
L_p50_1:
  s_waitcnt vmcnt(8)
L_p50_4:
  s_waitcnt vmcnt(9)
  buffer_load_dwordx4 v[92:95], v230, s[32:35], 0 offen nt
  v_dot2_f32_bf16 v22, v153, v48, 0
  v_add_f32_dpp v21, v18, v18 row_ror:8 row_mask:0xf bank_mask:0xc
  v_add_f32_dpp v21, v20, v20 row_ror:8 row_mask:0xf bank_mask:0x3
  v_add_f32_dpp v20, v34, v34 row_half_mirror row_mask:0xf bank_mask:0x5
  v_dot2_f32_bf16 v23, v158, v49, 0
  v_add_f32_dpp v20, v21, v21 row_half_mirror row_mask:0xf bank_mask:0xa
  v_dot2_f32_bf16 v24, v156, v50, 0
  v_dot2_f32_bf16 v25, v159, v51, 0
  v_add_f32_dpp v20, v20, v20 quad_perm:[2,3,0,1] row_mask:0xf bank_mask:0xf
  v_cvt_f32_i32 v108, v108
  v_cvt_f32_i32 v109, v109
  v_add_f32_dpp v20, v20, v20 quad_perm:[1,0,3,2] row_mask:0xf bank_mask:0xf
  v_cndmask_b32_e64 v32, v32, v20, s[48:49]
  v_cvt_f32_i32 v110, v110
  v_cvt_f32_i32 v111, v111
  v_pk_mul_f32 v[20:21], v[108:109], v[22:23]
  v_pk_add_f32 v[18:19], v[22:23], v[24:25]
  v_pk_fma_f32 v[20:21], v[110:111], v[24:25], v[20:21]
  v_add_f32 v18, v18, v19
  v_add_f32 v20, v20, v21
  s_cmpk_gt_i32 s69, 0x2d
  s_cbranch_scc1 L_p51_4
  s_cmpk_gt_i32 s69, 0x7
  s_cbranch_scc1 L_p51_2
  s_waitcnt vmcnt(6)
L_p51_2:
  s_waitcnt vmcnt(9)
L_p51_4:
  s_waitcnt vmcnt(10)
  buffer_load_dwordx4 v[96:99], v231, s[32:35], 0 offen nt
  v_dot2_f32_bf16 v22, v157, v52, 0
  v_add_f32_dpp v34, v18, v18 row_ror:8 row_mask:0xf bank_mask:0xc
  v_add_f32_dpp v34, v20, v20 row_ror:8 row_mask:0xf bank_mask:0x3
  v_dot2_f32_bf16 v23, v162, v53, 0
  v_dot2_f32_bf16 v24, v160, v54, 0
  v_dot2_f32_bf16 v25, v163, v55, 0
  v_cvt_f32_i32 v112, v112
  v_cvt_f32_i32 v113, v113
  v_cvt_f32_i32 v114, v114
  v_cvt_f32_i32 v115, v115
  v_pk_mul_f32 v[20:21], v[112:113], v[22:23]
  v_pk_add_f32 v[18:19], v[22:23], v[24:25]
  v_pk_fma_f32 v[20:21], v[114:115], v[24:25], v[20:21]
  v_add_f32 v18, v18, v19
  v_add_f32 v20, v20, v21
  s_cmpk_gt_i32 s69, 0x2d
  s_cbranch_scc1 L_p52_4
  s_cmpk_gt_i32 s69, 0x19
  s_cbranch_scc1 L_p52_3
  s_cmpk_gt_i32 s69, 0xffc9
  s_cbranch_scc1 L_p52_0
  s_waitcnt vmcnt(6)
L_p52_0:
  s_waitcnt vmcnt(7)
L_p52_3:
  s_waitcnt vmcnt(10)
L_p52_4:
  s_waitcnt vmcnt(11)
  buffer_load_dwordx4 v[100:103], v232, s[32:35], 0 offen nt
  s_waitcnt vmcnt(8)
  s_add_u32 s44, s78, 0x03030303
  v_msad_u8 v9, s78, v36, 0
  v_msad_u8 v10, s44, v36, 0
  v_msad_u8 v9, s78, v37, v9
  v_msad_u8 v10, s44, v37, v10
  v_msad_u8 v9, s78, v38, v9
  v_msad_u8 v10, s44, v38, v10
  s_mov_b64 exec, 3
  global_store_byte v7, v8, s[30:31]
  global_load_dwordx3 v[36:38], v236, s[30:31] sc1
  v_sub_u32 v9, v9, v10
  v_add_u32 v8, 1, v8
  s_mov_b64 exec, -1
  v_readlane_b32 s66, v9, 0
  v_readlane_b32 s67, v9, 1
  s_add_u32 s78, s78, 0x01010101
  s_lshl1_add_u32 s69, s91, s95
  s_add_u32 s95, s66, s67
  s_add_u32 s69, s69, s95
  v_dot2_f32_bf16 v22, v161, v44, 0
  v_add_f32_dpp v21, v18, v18 row_ror:8 row_mask:0xf bank_mask:0xc
  v_add_f32_dpp v21, v20, v20 row_ror:8 row_mask:0xf bank_mask:0x3
  v_add_f32_dpp v20, v34, v34 row_half_mirror row_mask:0xf bank_mask:0x5
  v_dot2_f32_bf16 v23, v166, v45, 0
  v_add_f32_dpp v20, v21, v21 row_half_mirror row_mask:0xf bank_mask:0xa
  v_dot2_f32_bf16 v24, v164, v46, 0
  v_dot2_f32_bf16 v25, v167, v47, 0
  v_add_f32_dpp v20, v20, v20 quad_perm:[2,3,0,1] row_mask:0xf bank_mask:0xf
  v_cvt_f32_i32 v68, v68
  v_cvt_f32_i32 v69, v69
  v_add_f32_dpp v20, v20, v20 quad_perm:[1,0,3,2] row_mask:0xf bank_mask:0xf
  v_cndmask_b32_e64 v32, v32, v20, s[50:51]
  v_cvt_f32_i32 v70, v70
  v_cvt_f32_i32 v71, v71
  v_pk_mul_f32 v[20:21], v[68:69], v[22:23]
  v_pk_add_f32 v[18:19], v[22:23], v[24:25]
  v_pk_fma_f32 v[20:21], v[70:71], v[24:25], v[20:21]
  v_add_f32 v18, v18, v19
  v_add_f32 v20, v20, v21
  s_cmpk_gt_i32 s69, 0x2d
  s_cbranch_scc1 L_p53_4
  s_cmpk_gt_i32 s69, 0xffe9
  s_cbranch_scc1 L_p53_1
  s_waitcnt vmcnt(5)
L_p53_1:
  s_waitcnt vmcnt(8)
L_p53_4:
  s_waitcnt vmcnt(9)
  buffer_load_dwordx4 v[104:107], v233, s[32:35], 0 offen nt
  v_dot2_f32_bf16 v22, v165, v48, 0
  v_add_f32_dpp v34, v18, v18 row_ror:8 row_mask:0xf bank_mask:0xc
  v_add_f32_dpp v34, v20, v20 row_ror:8 row_mask:0xf bank_mask:0x3
  v_dot2_f32_bf16 v23, v170, v49, 0
  v_dot2_f32_bf16 v24, v168, v50, 0
  v_dot2_f32_bf16 v25, v171, v51, 0
  v_cvt_f32_i32 v72, v72
  v_cvt_f32_i32 v73, v73
  v_cvt_f32_i32 v74, v74
  v_cvt_f32_i32 v75, v75
  v_pk_mul_f32 v[20:21], v[72:73], v[22:23]
  v_pk_add_f32 v[18:19], v[22:23], v[24:25]
  v_pk_fma_f32 v[20:21], v[74:75], v[24:25], v[20:21]
  v_add_f32 v18, v18, v19
  v_add_f32 v20, v20, v21
  s_cmpk_gt_i32 s69, 0x2d
  s_cbranch_scc1 L_p54_4
  s_cmpk_gt_i32 s69, 0x7
  s_cbranch_scc1 L_p54_2
  s_waitcnt vmcnt(6)
L_p54_2:
  s_waitcnt vmcnt(9)
L_p54_4:
  s_waitcnt vmcnt(10)
  buffer_load_dwordx4 v[108:111], v234, s[32:35], 0 offen nt
  v_dot2_f32_bf16 v22, v169, v52, 0
  v_add_f32_dpp v21, v18, v18 row_ror:8 row_mask:0xf bank_mask:0xc
  v_add_f32_dpp v21, v20, v20 row_ror:8 row_mask:0xf bank_mask:0x3
  v_add_f32_dpp v20, v34, v34 row_half_mirror row_mask:0xf bank_mask:0x5
  v_dot2_f32_bf16 v23, v174, v53, 0
  v_add_f32_dpp v20, v21, v21 row_half_mirror row_mask:0xf bank_mask:0xa
  v_dot2_f32_bf16 v24, v172, v54, 0
  v_dot2_f32_bf16 v25, v175, v55, 0
  v_add_f32_dpp v20, v20, v20 quad_perm:[2,3,0,1] row_mask:0xf bank_mask:0xf
  v_cvt_f32_i32 v76, v76
  v_cvt_f32_i32 v77, v77
  v_add_f32_dpp v20, v20, v20 quad_perm:[1,0,3,2] row_mask:0xf bank_mask:0xf
  v_cndmask_b32_e64 v32, v32, v20, s[52:53]
  v_cvt_f32_i32 v78, v78
  v_cvt_f32_i32 v79, v79
  v_pk_mul_f32 v[20:21], v[76:77], v[22:23]
  v_pk_add_f32 v[18:19], v[22:23], v[24:25]
  v_pk_fma_f32 v[20:21], v[78:79], v[24:25], v[20:21]
  v_add_f32 v18, v18, v19
  v_add_f32 v20, v20, v21
  s_cmpk_gt_i32 s69, 0x2d
  s_cbranch_scc1 L_p55_4
  s_cmpk_gt_i32 s69, 0x19
  s_cbranch_scc1 L_p55_3
  s_cmpk_gt_i32 s69, 0xffc9
  s_cbranch_scc1 L_p55_0
  s_waitcnt vmcnt(6)
L_p55_0:
  s_waitcnt vmcnt(7)
L_p55_3:
  s_waitcnt vmcnt(10)
L_p55_4:
  s_waitcnt vmcnt(11)
  buffer_load_dwordx4 v[112:115], v235, s[32:35], 0 offen nt
  s_waitcnt vmcnt(8)
  s_add_u32 s44, s78, 0x03030303
  v_msad_u8 v9, s78, v40, 0
  v_msad_u8 v10, s44, v40, 0
  v_msad_u8 v9, s78, v41, v9
  v_msad_u8 v10, s44, v41, v10
  v_msad_u8 v9, s78, v42, v9
  v_msad_u8 v10, s44, v42, v10
  s_mov_b64 exec, 3
  global_load_dwordx2 v[26:27], v11, s[30:31] sc1
  global_store_byte v7, v8, s[30:31]
  global_load_dwordx3 v[40:42], v237, s[30:31] sc1
  v_sub_u32 v9, v9, v10
  v_add_u32 v8, 1, v8
  s_mov_b64 exec, -1
  v_readlane_b32 s66, v9, 0
  v_readlane_b32 s67, v9, 1
  s_add_u32 s78, s78, 0x01010101
  s_lshl1_add_u32 s69, s91, s95
  s_add_u32 s95, s66, s67
  s_add_u32 s69, s69, s95
  v_dot2_f32_bf16 v22, v173, v44, 0
  v_add_f32_dpp v34, v18, v18 row_ror:8 row_mask:0xf bank_mask:0xc
  v_add_f32_dpp v34, v20, v20 row_ror:8 row_mask:0xf bank_mask:0x3
  v_dot2_f32_bf16 v23, v178, v45, 0
  v_dot2_f32_bf16 v24, v176, v46, 0
  v_dot2_f32_bf16 v25, v179, v47, 0
  v_cvt_f32_i32 v80, v80
  v_cvt_f32_i32 v81, v81
  v_cvt_f32_i32 v82, v82
  v_cvt_f32_i32 v83, v83
  v_pk_mul_f32 v[20:21], v[80:81], v[22:23]
  v_pk_add_f32 v[18:19], v[22:23], v[24:25]
  v_pk_fma_f32 v[20:21], v[82:83], v[24:25], v[20:21]
  v_add_f32 v18, v18, v19
  v_add_f32 v20, v20, v21
  s_cmpk_gt_i32 s69, 0x2d
  s_cbranch_scc1 L_p56_4
  s_cmpk_gt_i32 s69, 0xffe9
  s_cbranch_scc1 L_p56_1
  s_waitcnt vmcnt(6)
L_p56_1:
  s_waitcnt vmcnt(9)
L_p56_4:
  s_waitcnt vmcnt(10)
  buffer_load_dwordx4 v[68:71], v212, s[36:39], 0 offen nt
  v_dot2_f32_bf16 v22, v177, v48, 0
  v_add_f32_dpp v21, v18, v18 row_ror:8 row_mask:0xf bank_mask:0xc
  v_add_f32_dpp v21, v20, v20 row_ror:8 row_mask:0xf bank_mask:0x3
  v_add_f32_dpp v20, v34, v34 row_half_mirror row_mask:0xf bank_mask:0x5
  v_dot2_f32_bf16 v23, v182, v49, 0
  v_add_f32_dpp v20, v21, v21 row_half_mirror row_mask:0xf bank_mask:0xa
  v_dot2_f32_bf16 v24, v180, v50, 0
  v_dot2_f32_bf16 v25, v183, v51, 0
  v_add_f32_dpp v20, v20, v20 quad_perm:[2,3,0,1] row_mask:0xf bank_mask:0xf
  v_cvt_f32_i32 v84, v84
  v_cvt_f32_i32 v85, v85
  v_add_f32_dpp v20, v20, v20 quad_perm:[1,0,3,2] row_mask:0xf bank_mask:0xf
  v_cndmask_b32_e64 v32, v32, v20, s[54:55]
  ds_write_b32 v2, v32 offset:512
  v_cvt_f32_i32 v86, v86
  v_cvt_f32_i32 v87, v87
  v_pk_mul_f32 v[20:21], v[84:85], v[22:23]
  v_pk_add_f32 v[18:19], v[22:23], v[24:25]
  v_pk_fma_f32 v[20:21], v[86:87], v[24:25], v[20:21]
  v_add_f32 v18, v18, v19
  v_add_f32 v20, v20, v21
  s_cmpk_gt_i32 s69, 0x2d
  s_cbranch_scc1 L_p57_4
  s_cmpk_gt_i32 s69, 0x7
  s_cbranch_scc1 L_p57_2
  s_waitcnt vmcnt(7)
L_p57_2:
  s_waitcnt vmcnt(10)
L_p57_4:
  s_waitcnt vmcnt(11)
  buffer_load_dwordx4 v[72:75], v213, s[36:39], 0 offen nt
  v_dot2_f32_bf16 v22, v181, v52, 0
  v_add_f32_dpp v34, v18, v18 row_ror:8 row_mask:0xf bank_mask:0xc
  v_add_f32_dpp v34, v20, v20 row_ror:8 row_mask:0xf bank_mask:0x3
  v_dot2_f32_bf16 v23, v186, v53, 0
  v_dot2_f32_bf16 v24, v184, v54, 0
  v_dot2_f32_bf16 v25, v187, v55, 0
  v_cvt_f32_i32 v88, v88
  v_cvt_f32_i32 v89, v89
  v_cvt_f32_i32 v90, v90
  v_cvt_f32_i32 v91, v91
  v_pk_mul_f32 v[20:21], v[88:89], v[22:23]
  v_pk_add_f32 v[18:19], v[22:23], v[24:25]
  v_pk_fma_f32 v[20:21], v[90:91], v[24:25], v[20:21]
  v_add_f32 v18, v18, v19
  v_add_f32 v20, v20, v21
  s_cmpk_gt_i32 s69, 0x2d
  s_cbranch_scc1 L_p58_4
  s_cmpk_gt_i32 s69, 0x19
  s_cbranch_scc1 L_p58_3
  s_cmpk_gt_i32 s69, 0xffc9
  s_cbranch_scc1 L_p58_0
  s_waitcnt vmcnt(7)
L_p58_0:
  s_waitcnt vmcnt(8)
L_p58_3:
  s_waitcnt vmcnt(11)
L_p58_4:
  s_waitcnt vmcnt(12)
  buffer_load_dwordx4 v[76:79], v214, s[36:39], 0 offen nt
  ds_read_b32 v4, v14 offset:16
  s_waitcnt vmcnt(9)
  s_add_u32 s44, s78, 0x03030303
  v_msad_u8 v9, s78, v36, 0
  v_msad_u8 v10, s44, v36, 0
  v_msad_u8 v9, s78, v37, v9
  v_msad_u8 v10, s44, v37, v10
  v_msad_u8 v9, s78, v38, v9
  v_msad_u8 v10, s44, v38, v10
  s_mov_b64 exec, 3
  global_store_byte v7, v8, s[30:31]
  global_load_dwordx3 v[36:38], v238, s[30:31] sc1
  v_sub_u32 v9, v9, v10
  v_add_u32 v8, 1, v8
  s_mov_b64 exec, -1
  v_readlane_b32 s66, v9, 0
  v_readlane_b32 s67, v9, 1
  s_add_u32 s78, s78, 0x01010101
  s_lshl1_add_u32 s69, s91, s95
  s_add_u32 s95, s66, s67
  s_add_u32 s69, s69, s95
  v_dot2_f32_bf16 v22, v185, v44, 0
  v_add_f32_dpp v21, v18, v18 row_ror:8 row_mask:0xf bank_mask:0xc
  v_add_f32_dpp v21, v20, v20 row_ror:8 row_mask:0xf bank_mask:0x3
  v_add_f32_dpp v20, v34, v34 row_half_mirror row_mask:0xf bank_mask:0x5
  v_dot2_f32_bf16 v23, v190, v45, 0
  v_add_f32_dpp v20, v21, v21 row_half_mirror row_mask:0xf bank_mask:0xa
  v_dot2_f32_bf16 v24, v188, v46, 0
  v_dot2_f32_bf16 v25, v191, v47, 0
  v_add_f32_dpp v20, v20, v20 quad_perm:[2,3,0,1] row_mask:0xf bank_mask:0xf
  v_cvt_f32_i32 v92, v92
  v_cvt_f32_i32 v93, v93
  v_add_f32_dpp v20, v20, v20 quad_perm:[1,0,3,2] row_mask:0xf bank_mask:0xf
  v_cndmask_b32_e64 v32, v32, v20, s[48:49]
  v_cvt_f32_i32 v94, v94
  v_cvt_f32_i32 v95, v95
  v_pk_mul_f32 v[20:21], v[92:93], v[22:23]
  v_pk_add_f32 v[18:19], v[22:23], v[24:25]
  v_pk_fma_f32 v[20:21], v[94:95], v[24:25], v[20:21]
  v_add_f32 v18, v18, v19
  v_add_f32 v20, v20, v21
  s_cmpk_gt_i32 s69, 0x2d
  s_cbranch_scc1 L_p59_4
  s_cmpk_gt_i32 s69, 0xffe9
  s_cbranch_scc1 L_p59_1
  s_waitcnt vmcnt(5)
L_p59_1:
  s_waitcnt vmcnt(9)
L_p59_4:
  s_waitcnt vmcnt(10)
  buffer_load_dwordx4 v[80:83], v215, s[36:39], 0 offen nt
  v_dot2_f32_bf16 v22, v189, v48, 0
  v_add_f32_dpp v34, v18, v18 row_ror:8 row_mask:0xf bank_mask:0xc
  v_add_f32_dpp v34, v20, v20 row_ror:8 row_mask:0xf bank_mask:0x3
  v_dot2_f32_bf16 v23, v194, v49, 0
  v_dot2_f32_bf16 v24, v192, v50, 0
  v_dot2_f32_bf16 v25, v195, v51, 0
  v_cvt_f32_i32 v96, v96
  v_cvt_f32_i32 v97, v97
  v_cvt_f32_i32 v98, v98
  v_cvt_f32_i32 v99, v99
  v_pk_mul_f32 v[20:21], v[96:97], v[22:23]
  v_pk_add_f32 v[18:19], v[22:23], v[24:25]
  v_pk_fma_f32 v[20:21], v[98:99], v[24:25], v[20:21]
  v_add_f32 v18, v18, v19
  v_add_f32 v20, v20, v21
  s_cmpk_gt_i32 s69, 0x2d
  s_cbranch_scc1 L_p60_4
  s_cmpk_gt_i32 s69, 0x7
  s_cbranch_scc1 L_p60_2
  s_waitcnt vmcnt(6)
L_p60_2:
  s_waitcnt vmcnt(10)
L_p60_4:
  s_waitcnt vmcnt(11)
  buffer_load_dwordx4 v[84:87], v216, s[36:39], 0 offen nt
  v_dot2_f32_bf16 v22, v193, v52, 0
  v_add_f32_dpp v21, v18, v18 row_ror:8 row_mask:0xf bank_mask:0xc
  v_add_f32_dpp v21, v20, v20 row_ror:8 row_mask:0xf bank_mask:0x3
  v_add_f32_dpp v20, v34, v34 row_half_mirror row_mask:0xf bank_mask:0x5
  v_dot2_f32_bf16 v23, v198, v53, 0
  v_add_f32_dpp v20, v21, v21 row_half_mirror row_mask:0xf bank_mask:0xa
  v_dot2_f32_bf16 v24, v196, v54, 0
  v_dot2_f32_bf16 v25, v199, v55, 0
  v_add_f32_dpp v20, v20, v20 quad_perm:[2,3,0,1] row_mask:0xf bank_mask:0xf
  v_cvt_f32_i32 v100, v100
  v_cvt_f32_i32 v101, v101
  v_add_f32_dpp v20, v20, v20 quad_perm:[1,0,3,2] row_mask:0xf bank_mask:0xf
  v_cndmask_b32_e64 v32, v32, v20, s[50:51]
  v_cvt_f32_i32 v102, v102
  v_cvt_f32_i32 v103, v103
  v_pk_mul_f32 v[20:21], v[100:101], v[22:23]
  v_pk_add_f32 v[18:19], v[22:23], v[24:25]
  v_pk_fma_f32 v[20:21], v[102:103], v[24:25], v[20:21]
  v_add_f32 v18, v18, v19
  v_add_f32 v20, v20, v21
  s_cmpk_gt_i32 s69, 0x2d
  s_cbranch_scc1 L_p61_4
  s_cmpk_gt_i32 s69, 0x19
  s_cbranch_scc1 L_p61_3
  s_cmpk_gt_i32 s69, 0xffc9
  s_cbranch_scc1 L_p61_0
  s_waitcnt vmcnt(6)
L_p61_0:
  s_waitcnt vmcnt(7)
L_p61_3:
  s_waitcnt vmcnt(11)
L_p61_4:
  s_waitcnt vmcnt(12)
  buffer_load_dwordx4 v[88:91], v217, s[36:39], 0 offen nt
L_qn:
  s_waitcnt lgkmcnt(0)
  v_readfirstlane_b32 s46, v4
  s_cmp_ge_u32 s46, s47
  s_cbranch_scc1 L_qn_ok
  s_cmp_eq_u32 s94, 0
  s_cbranch_scc1 L_qn_ok
  s_sub_u32 s94, s94, 1
  ds_read_b32 v4, v14 offset:16
  s_branch L_qn
L_qn_ok:
  s_waitcnt vmcnt(8)
  s_add_u32 s44, s78, 0x03030303
  v_msad_u8 v9, s78, v40, 0
  v_msad_u8 v10, s44, v40, 0
  v_msad_u8 v9, s78, v41, v9
  v_msad_u8 v10, s44, v41, v10
  v_msad_u8 v9, s78, v42, v9
  v_msad_u8 v10, s44, v42, v10
  s_mov_b64 exec, 3
  global_store_byte v7, v8, s[30:31]
  global_load_dwordx3 v[40:42], v239, s[30:31] sc1
  v_sub_u32 v9, v9, v10
  v_add3_u32 v10, v26, v27, s58
  v_add_u32 v8, 1, v8
  s_mov_b64 exec, -1
  v_readlane_b32 s66, v9, 0
  v_readlane_b32 s67, v9, 1
  v_readlane_b32 s91, v10, 0
  s_add_u32 s78, s78, 0x01010101
  s_lshl1_add_u32 s69, s91, s95
  s_add_u32 s95, s66, s67
  s_add_u32 s69, s69, s95
  v_dot2_f32_bf16 v22, v197, v44, 0
  v_add_f32_dpp v34, v18, v18 row_ror:8 row_mask:0xf bank_mask:0xc
  v_add_f32_dpp v34, v20, v20 row_ror:8 row_mask:0xf bank_mask:0x3
  v_dot2_f32_bf16 v23, v202, v45, 0
  v_dot2_f32_bf16 v24, v200, v46, 0
  v_dot2_f32_bf16 v25, v203, v47, 0
  v_cvt_f32_i32 v104, v104
  v_cvt_f32_i32 v105, v105
  v_cvt_f32_i32 v106, v106
  v_cvt_f32_i32 v107, v107
  ds_read_b128 v[44:47], v15 offset:512
  v_pk_mul_f32 v[20:21], v[104:105], v[22:23]
  v_pk_add_f32 v[18:19], v[22:23], v[24:25]
  v_pk_fma_f32 v[20:21], v[106:107], v[24:25], v[20:21]
  v_add_f32 v18, v18, v19
  v_add_f32 v20, v20, v21
  s_cmpk_gt_i32 s69, 0x2d
  s_cbranch_scc1 L_p62_4
  s_cmpk_gt_i32 s69, 0xffe9
  s_cbranch_scc1 L_p62_1
  s_waitcnt vmcnt(5)
L_p62_1:
  s_waitcnt vmcnt(8)
L_p62_4:
  s_waitcnt vmcnt(9)
  buffer_load_dwordx4 v[92:95], v218, s[36:39], 0 offen nt
  v_dot2_f32_bf16 v22, v201, v48, 0
  v_add_f32_dpp v21, v18, v18 row_ror:8 row_mask:0xf bank_mask:0xc
  v_add_f32_dpp v21, v20, v20 row_ror:8 row_mask:0xf bank_mask:0x3
  v_add_f32_dpp v20, v34, v34 row_half_mirror row_mask:0xf bank_mask:0x5
  v_dot2_f32_bf16 v23, v206, v49, 0
  v_add_f32_dpp v20, v21, v21 row_half_mirror row_mask:0xf bank_mask:0xa
  v_dot2_f32_bf16 v24, v204, v50, 0
  v_dot2_f32_bf16 v25, v207, v51, 0
  v_add_f32_dpp v20, v20, v20 quad_perm:[2,3,0,1] row_mask:0xf bank_mask:0xf
  v_cvt_f32_i32 v108, v108
  v_cvt_f32_i32 v109, v109
  v_add_f32_dpp v20, v20, v20 quad_perm:[1,0,3,2] row_mask:0xf bank_mask:0xf
  v_cndmask_b32_e64 v32, v32, v20, s[52:53]
  v_cvt_f32_i32 v110, v110
  v_cvt_f32_i32 v111, v111
  ds_read_b128 v[48:51], v16 offset:512
  v_pk_mul_f32 v[20:21], v[108:109], v[22:23]
  v_pk_add_f32 v[18:19], v[22:23], v[24:25]
  v_pk_fma_f32 v[20:21], v[110:111], v[24:25], v[20:21]
  v_add_f32 v18, v18, v19
  v_add_f32 v20, v20, v21
  s_cmpk_gt_i32 s69, 0x2d
  s_cbranch_scc1 L_p63_4
  s_cmpk_gt_i32 s69, 0x7
  s_cbranch_scc1 L_p63_2
  s_waitcnt vmcnt(6)
L_p63_2:
  s_waitcnt vmcnt(9)
L_p63_4:
  s_waitcnt vmcnt(10)
  buffer_load_dwordx4 v[96:99], v219, s[36:39], 0 offen nt
  v_dot2_f32_bf16 v22, v205, v52, 0
  v_add_f32_dpp v34, v18, v18 row_ror:8 row_mask:0xf bank_mask:0xc
  v_add_f32_dpp v34, v20, v20 row_ror:8 row_mask:0xf bank_mask:0x3
  v_dot2_f32_bf16 v23, v210, v53, 0
  v_dot2_f32_bf16 v24, v208, v54, 0
  v_dot2_f32_bf16 v25, v211, v55, 0
  v_cvt_f32_i32 v112, v112
  v_cvt_f32_i32 v113, v113
  v_cvt_f32_i32 v114, v114
  v_cvt_f32_i32 v115, v115
  ds_read_b128 v[52:55], v17 offset:512
  v_pk_mul_f32 v[20:21], v[112:113], v[22:23]
  v_pk_add_f32 v[18:19], v[22:23], v[24:25]
  v_pk_fma_f32 v[20:21], v[114:115], v[24:25], v[20:21]
  v_add_f32 v18, v18, v19
  v_add_f32 v20, v20, v21
  s_cmpk_gt_i32 s69, 0x2d
  s_cbranch_scc1 L_p64_4
  s_cmpk_gt_i32 s69, 0x19
  s_cbranch_scc1 L_p64_3
  s_cmpk_gt_i32 s69, 0xffc9
  s_cbranch_scc1 L_p64_0
  s_waitcnt vmcnt(6)
L_p64_0:
  s_waitcnt vmcnt(7)
L_p64_3:
  s_waitcnt vmcnt(10)
L_p64_4:
  s_waitcnt vmcnt(11)
  buffer_load_dwordx4 v[100:103], v220, s[36:39], 0 offen nt
  s_nop 0
  v_add_f32_dpp v21, v18, v18 row_ror:8 row_mask:0xf bank_mask:0xc
  v_add_f32_dpp v21, v20, v20 row_ror:8 row_mask:0xf bank_mask:0x3
  v_add_f32_dpp v20, v34, v34 row_half_mirror row_mask:0xf bank_mask:0x5
  s_nop 0
  v_add_f32_dpp v20, v21, v21 row_half_mirror row_mask:0xf bank_mask:0xa
  s_nop 1
  v_add_f32_dpp v20, v20, v20 quad_perm:[2,3,0,1] row_mask:0xf bank_mask:0xf
  s_nop 1
  v_add_f32_dpp v20, v20, v20 quad_perm:[1,0,3,2] row_mask:0xf bank_mask:0xf
  v_cndmask_b32_e64 v32, v32, v20, s[54:55]
  ds_write_b32 v2, v32 offset:1024
  s_add_u32 s43, s43, 1
  v_mov_b32 v4, s43
  ds_write_b32 v6, v4 offset:0
  s_mov_b64 s[32:33], s[36:37]
  s_add_u32 s68, s43, 1
  s_sub_u32 s45, s68, 16
  s_lshl_b32 s46, s45, 2
  s_lshr_b64 s[64:65], s[92:93], s46
  s_and_b32 s46, s64, 15
  s_cmp_lt_u32 s68, 16
  s_cselect_b32 s68, s68, s46
  s_cselect_b32 s70, s6, s12
  s_cselect_b32 s71, s7, s13
  s_lshl_b32 s44, s68, 2
  s_lshr_b64 s[64:65], s[96:97], s44
  s_and_b32 s64, s64, 15
  s_lshl4_add_u32 s68, s68, s64
  s_mul_i32 s44, s68, 1572864
  s_add_u32 s36, s70, s44
  s_addc_u32 s37, s71, 0
  s_cmp_lt_u32 s43, 16
  s_cbranch_scc1 L_k
L_vpre:
  s_cmp_eq_u32 s41, 0
  s_cselect_b32 s44, 1, -1
  s_cselect_b32 s45, 0, -1
  s_mulk_i32 s44, 512
  s_add_u32 s82, s82, s44
  s_addc_u32 s83, s83, s45
  s_load_dword s98, s[82:83], 16
  v_lshrrev_b32 v116, 4, v0
  v_and_b32 v119, 15, v0
  v_and_or_b32 v120, v0, 7, 16
  v_lshl_add_u32 v119, v119, 4, v116
  v_mul_u32_u24 v119, 683, v119
  v_lshrrev_b32 v119, 11, v119
  v_lshlrev_b32 v119, 2, v119
  v_lshl_add_u32 v120, v120, 4, v116
  v_mul_u32_u24 v120, 683, v120
  v_lshrrev_b32 v120, 11, v120
  v_lshlrev_b32 v120, 2, v120
  s_mov_b64 vcc, 0
  s_mov_b32 s43, 0
  s_lshl_b32 s68, s43, 2
  s_lshr_b64 s[64:65], s[92:93], s68
  s_and_b32 s68, s64, 15
  s_add_u32 s47, s68, 1
  ds_read_b32 v4, v14 offset:20
L_a0:
  s_waitcnt lgkmcnt(0)
  v_readfirstlane_b32 s46, v4
  s_cmp_ge_u32 s46, s47
  s_cbranch_scc1 L_a0_ok
  s_cmp_eq_u32 s94, 0
  s_cbranch_scc1 L_a0_ok
  s_sub_u32 s94, s94, 1
  ds_read_b32 v4, v14 offset:20
  s_branch L_a0
L_a0_ok:
  v_lshl_add_u32 v121, s68, 9, v119
  v_lshl_add_u32 v122, s68, 9, v120
  ds_read_b32 v116, v121 offset:37376
  ds_read_b32 v117, v122 offset:37376
.p2align 6
L_v:
  s_add_u32 s45, s43, 1
  s_min_u32 s45, s45, 15
  s_lshl_b32 s68, s45, 2
  s_lshr_b64 s[64:65], s[92:93], s68
  s_and_b32 s68, s64, 15
  s_add_u32 s47, s68, 1
  v_lshl_add_u32 v121, s68, 9, v119
  v_lshl_add_u32 v122, s68, 9, v120
  s_waitcnt lgkmcnt(0)
  s_waitcnt vmcnt(8)
  s_add_u32 s44, s78, 0x03030303
  v_msad_u8 v9, s78, v36, 0
  v_msad_u8 v10, s44, v36, 0
  v_msad_u8 v9, s78, v37, v9
  v_msad_u8 v10, s44, v37, v10
  v_msad_u8 v9, s78, v38, v9
  v_msad_u8 v10, s44, v38, v10
  s_mov_b64 exec, 3
  global_store_byte v7, v8, s[30:31]
  global_load_dwordx3 v[36:38], v236, s[30:31] sc1
  v_sub_u32 v9, v9, v10
  v_add_u32 v8, 1, v8
  s_mov_b64 exec, -1
  v_readlane_b32 s66, v9, 0
  v_readlane_b32 s67, v9, 1
  s_add_u32 s78, s78, 0x01010101
  s_lshl1_add_u32 s69, s91, s95
  s_add_u32 s95, s66, s67
  s_add_u32 s69, s69, s95
  v_mov_b32_dpp v18, v116 row_newbcast:0 row_mask:0xf bank_mask:0xf
  v_cvt_f32_i32 v68, v68
  v_cvt_f32_i32 v69, v69
  v_cvt_f32_i32 v70, v70
  v_cvt_f32_i32 v71, v71
  v_pk_mul_f32 v[44:45], v[68:69], v[18:19] op_sel_hi:[1,0]
  v_pk_mul_f32 v[46:47], v[70:71], v[18:19] op_sel_hi:[1,0]
  s_cmpk_gt_i32 s69, 0x35
  s_cbranch_scc1 L_p65_4
  s_cmpk_gt_i32 s69, 0xfff1
  s_cbranch_scc1 L_p65_1
  s_waitcnt vmcnt(5)
L_p65_1:
  s_waitcnt vmcnt(8)
L_p65_4:
  s_waitcnt vmcnt(9)
  buffer_load_dwordx4 v[104:107], v221, s[32:35], 0 offen nt
  v_mov_b32_dpp v18, v116 row_newbcast:1 row_mask:0xf bank_mask:0xf
  v_cvt_f32_i32 v72, v72
  v_cvt_f32_i32 v73, v73
  v_cvt_f32_i32 v74, v74
  v_cvt_f32_i32 v75, v75
  v_pk_mul_f32 v[48:49], v[72:73], v[18:19] op_sel_hi:[1,0]
  v_pk_mul_f32 v[50:51], v[74:75], v[18:19] op_sel_hi:[1,0]
  s_cmpk_gt_i32 s69, 0x35
  s_cbranch_scc1 L_p66_4
  s_cmpk_gt_i32 s69, 0xf
  s_cbranch_scc1 L_p66_2
  s_waitcnt vmcnt(6)
L_p66_2:
  s_waitcnt vmcnt(9)
L_p66_4:
  s_waitcnt vmcnt(10)
  buffer_load_dwordx4 v[108:111], v222, s[32:35], 0 offen nt
  v_mov_b32_dpp v18, v116 row_newbcast:2 row_mask:0xf bank_mask:0xf
  v_cvt_f32_i32 v76, v76
  v_cvt_f32_i32 v77, v77
  v_cvt_f32_i32 v78, v78
  v_cvt_f32_i32 v79, v79
  v_pk_mul_f32 v[52:53], v[76:77], v[18:19] op_sel_hi:[1,0]
  v_pk_mul_f32 v[54:55], v[78:79], v[18:19] op_sel_hi:[1,0]
  s_cmpk_gt_i32 s69, 0x35
  s_cbranch_scc1 L_p67_4
  s_cmpk_gt_i32 s69, 0x21
  s_cbranch_scc1 L_p67_3
  s_cmpk_gt_i32 s69, 0xffd1
  s_cbranch_scc1 L_p67_0
  s_waitcnt vmcnt(6)
L_p67_0:
  s_waitcnt vmcnt(7)
L_p67_3:
  s_waitcnt vmcnt(10)
L_p67_4:
  s_waitcnt vmcnt(11)
  buffer_load_dwordx4 v[112:115], v223, s[32:35], 0 offen nt
  s_waitcnt vmcnt(8)
  s_add_u32 s44, s78, 0x03030303
  v_msad_u8 v9, s78, v40, 0
  v_msad_u8 v10, s44, v40, 0
  v_msad_u8 v9, s78, v41, v9
  v_msad_u8 v10, s44, v41, v10
  v_msad_u8 v9, s78, v42, v9
  v_msad_u8 v10, s44, v42, v10
  s_mov_b64 exec, 3
  global_store_byte v7, v8, s[30:31]
  global_load_dwordx3 v[40:42], v237, s[30:31] sc1
  v_sub_u32 v9, v9, v10
  v_add_u32 v8, 1, v8
  s_mov_b64 exec, -1
  v_readlane_b32 s66, v9, 0
  v_readlane_b32 s67, v9, 1
  s_add_u32 s78, s78, 0x01010101
  s_lshl1_add_u32 s69, s91, s95
  s_add_u32 s95, s66, s67
  s_add_u32 s69, s69, s95
  v_mov_b32_dpp v18, v116 row_newbcast:3 row_mask:0xf bank_mask:0xf
  v_cvt_f32_i32 v80, v80
  v_cvt_f32_i32 v81, v81
  v_cvt_f32_i32 v82, v82
  v_cvt_f32_i32 v83, v83
  v_pk_fma_f32 v[44:45], v[80:81], v[18:19], v[44:45] op_sel_hi:[1,0,1]
  v_pk_fma_f32 v[46:47], v[82:83], v[18:19], v[46:47] op_sel_hi:[1,0,1]
  s_cmpk_gt_i32 s69, 0x35
  s_cbranch_scc1 L_p68_4
  s_cmpk_gt_i32 s69, 0xfff1
  s_cbranch_scc1 L_p68_1
  s_waitcnt vmcnt(5)
L_p68_1:
  s_waitcnt vmcnt(8)
L_p68_4:
  s_waitcnt vmcnt(9)
  buffer_load_dwordx4 v[68:71], v224, s[32:35], 0 offen nt
  v_mov_b32_dpp v18, v116 row_newbcast:4 row_mask:0xf bank_mask:0xf
  v_cvt_f32_i32 v84, v84
  v_cvt_f32_i32 v85, v85
  v_cvt_f32_i32 v86, v86
  v_cvt_f32_i32 v87, v87
  v_pk_fma_f32 v[48:49], v[84:85], v[18:19], v[48:49] op_sel_hi:[1,0,1]
  v_pk_fma_f32 v[50:51], v[86:87], v[18:19], v[50:51] op_sel_hi:[1,0,1]
  s_cmpk_gt_i32 s69, 0x35
  s_cbranch_scc1 L_p69_4
  s_cmpk_gt_i32 s69, 0xf
  s_cbranch_scc1 L_p69_2
  s_waitcnt vmcnt(6)
L_p69_2:
  s_waitcnt vmcnt(9)
L_p69_4:
  s_waitcnt vmcnt(10)
  buffer_load_dwordx4 v[72:75], v225, s[32:35], 0 offen nt
  v_mov_b32_dpp v18, v116 row_newbcast:5 row_mask:0xf bank_mask:0xf
  v_cvt_f32_i32 v88, v88
  v_cvt_f32_i32 v89, v89
  v_cvt_f32_i32 v90, v90
  v_cvt_f32_i32 v91, v91
  v_pk_fma_f32 v[52:53], v[88:89], v[18:19], v[52:53] op_sel_hi:[1,0,1]
  v_pk_fma_f32 v[54:55], v[90:91], v[18:19], v[54:55] op_sel_hi:[1,0,1]
  s_cmpk_gt_i32 s69, 0x35
  s_cbranch_scc1 L_p70_4
  s_cmpk_gt_i32 s69, 0x21
  s_cbranch_scc1 L_p70_3
  s_cmpk_gt_i32 s69, 0xffd1
  s_cbranch_scc1 L_p70_0
  s_waitcnt vmcnt(6)
L_p70_0:
  s_waitcnt vmcnt(7)
L_p70_3:
  s_waitcnt vmcnt(10)
L_p70_4:
  s_waitcnt vmcnt(11)
  buffer_load_dwordx4 v[76:79], v226, s[32:35], 0 offen nt
  v_add_u32_e64 v9, s43, 16
  ds_write_b32 v14, v9 offset:28
  s_waitcnt vmcnt(8)
  s_add_u32 s44, s78, 0x03030303
  v_msad_u8 v9, s78, v36, 0
  v_msad_u8 v10, s44, v36, 0
  v_msad_u8 v9, s78, v37, v9
  v_msad_u8 v10, s44, v37, v10
  v_msad_u8 v9, s78, v38, v9
  v_msad_u8 v10, s44, v38, v10
  s_mov_b64 exec, 3
  global_store_byte v7, v8, s[30:31]
  global_load_dwordx3 v[36:38], v238, s[30:31] sc1
  v_sub_u32 v9, v9, v10
  v_add_u32 v8, 1, v8
  s_mov_b64 exec, -1
  v_readlane_b32 s66, v9, 0
  v_readlane_b32 s67, v9, 1
  s_add_u32 s78, s78, 0x01010101
  s_lshl1_add_u32 s69, s91, s95
  s_add_u32 s95, s66, s67
  s_add_u32 s69, s69, s95
  v_mov_b32_dpp v18, v116 row_newbcast:6 row_mask:0xf bank_mask:0xf
  v_cvt_f32_i32 v92, v92
  v_cvt_f32_i32 v93, v93
  v_cvt_f32_i32 v94, v94
  v_cvt_f32_i32 v95, v95
  v_pk_fma_f32 v[44:45], v[92:93], v[18:19], v[44:45] op_sel_hi:[1,0,1]
  v_pk_fma_f32 v[46:47], v[94:95], v[18:19], v[46:47] op_sel_hi:[1,0,1]
  s_cmpk_gt_i32 s69, 0x35
  s_cbranch_scc1 L_p71_4
  s_cmpk_gt_i32 s69, 0xfff1
  s_cbranch_scc1 L_p71_1
  s_waitcnt vmcnt(5)
L_p71_1:
  s_waitcnt vmcnt(8)
L_p71_4:
  s_waitcnt vmcnt(9)
  buffer_load_dwordx4 v[80:83], v227, s[32:35], 0 offen nt
  v_mov_b32_dpp v18, v116 row_newbcast:7 row_mask:0xf bank_mask:0xf
  v_cvt_f32_i32 v96, v96
  v_cvt_f32_i32 v97, v97
  v_cvt_f32_i32 v98, v98
  v_cvt_f32_i32 v99, v99
  v_pk_fma_f32 v[48:49], v[96:97], v[18:19], v[48:49] op_sel_hi:[1,0,1]
  v_pk_fma_f32 v[50:51], v[98:99], v[18:19], v[50:51] op_sel_hi:[1,0,1]
  s_cmpk_gt_i32 s69, 0x35
  s_cbranch_scc1 L_p72_4
  s_cmpk_gt_i32 s69, 0xf
  s_cbranch_scc1 L_p72_2
  s_waitcnt vmcnt(6)
L_p72_2:
  s_waitcnt vmcnt(9)
L_p72_4:
  s_waitcnt vmcnt(10)
  buffer_load_dwordx4 v[84:87], v228, s[32:35], 0 offen nt
  v_mov_b32_dpp v18, v116 row_newbcast:8 row_mask:0xf bank_mask:0xf
  v_cvt_f32_i32 v100, v100
  v_cvt_f32_i32 v101, v101
  v_cvt_f32_i32 v102, v102
  v_cvt_f32_i32 v103, v103
  v_pk_fma_f32 v[52:53], v[100:101], v[18:19], v[52:53] op_sel_hi:[1,0,1]
  v_pk_fma_f32 v[54:55], v[102:103], v[18:19], v[54:55] op_sel_hi:[1,0,1]
  s_cmpk_gt_i32 s69, 0x35
  s_cbranch_scc1 L_p73_4
  s_cmpk_gt_i32 s69, 0x21
  s_cbranch_scc1 L_p73_3
  s_cmpk_gt_i32 s69, 0xffd1
  s_cbranch_scc1 L_p73_0
  s_waitcnt vmcnt(6)
L_p73_0:
  s_waitcnt vmcnt(7)
L_p73_3:
  s_waitcnt vmcnt(10)
L_p73_4:
  s_waitcnt vmcnt(11)
  buffer_load_dwordx4 v[88:91], v229, s[32:35], 0 offen nt
  s_waitcnt vmcnt(8)
  s_add_u32 s44, s78, 0x03030303
  v_msad_u8 v9, s78, v40, 0
  v_msad_u8 v10, s44, v40, 0
  v_msad_u8 v9, s78, v41, v9
  v_msad_u8 v10, s44, v41, v10
  v_msad_u8 v9, s78, v42, v9
  v_msad_u8 v10, s44, v42, v10
  s_mov_b64 exec, 3
  global_store_byte v7, v8, s[30:31]
  global_load_dwordx3 v[40:42], v239, s[30:31] sc1
  v_sub_u32 v9, v9, v10
  v_add_u32 v8, 1, v8
  s_mov_b64 exec, -1
  v_readlane_b32 s66, v9, 0
  v_readlane_b32 s67, v9, 1
  s_add_u32 s78, s78, 0x01010101
  s_lshl1_add_u32 s69, s91, s95
  s_add_u32 s95, s66, s67
  s_add_u32 s69, s69, s95
  v_mov_b32_dpp v18, v116 row_newbcast:9 row_mask:0xf bank_mask:0xf
  v_cvt_f32_i32 v104, v104
  v_cvt_f32_i32 v105, v105
  v_cvt_f32_i32 v106, v106
  v_cvt_f32_i32 v107, v107
  v_pk_fma_f32 v[44:45], v[104:105], v[18:19], v[44:45] op_sel_hi:[1,0,1]
  v_pk_fma_f32 v[46:47], v[106:107], v[18:19], v[46:47] op_sel_hi:[1,0,1]
  s_cmpk_gt_i32 s69, 0x35
  s_cbranch_scc1 L_p74_4
  s_cmpk_gt_i32 s69, 0xfff1
  s_cbranch_scc1 L_p74_1
  s_waitcnt vmcnt(5)
L_p74_1:
  s_waitcnt vmcnt(8)
L_p74_4:
  s_waitcnt vmcnt(9)
  buffer_load_dwordx4 v[92:95], v230, s[32:35], 0 offen nt
  v_mov_b32_dpp v18, v116 row_newbcast:10 row_mask:0xf bank_mask:0xf
  v_cvt_f32_i32 v108, v108
  v_cvt_f32_i32 v109, v109
  v_cvt_f32_i32 v110, v110
  v_cvt_f32_i32 v111, v111
  v_pk_fma_f32 v[48:49], v[108:109], v[18:19], v[48:49] op_sel_hi:[1,0,1]
  v_pk_fma_f32 v[50:51], v[110:111], v[18:19], v[50:51] op_sel_hi:[1,0,1]
  s_cmpk_gt_i32 s69, 0x35
  s_cbranch_scc1 L_p75_4
  s_cmpk_gt_i32 s69, 0xf
  s_cbranch_scc1 L_p75_2
  s_waitcnt vmcnt(6)
L_p75_2:
  s_waitcnt vmcnt(9)
L_p75_4:
  s_waitcnt vmcnt(10)
  buffer_load_dwordx4 v[96:99], v231, s[32:35], 0 offen nt
  v_mov_b32_dpp v18, v116 row_newbcast:11 row_mask:0xf bank_mask:0xf
  v_cvt_f32_i32 v112, v112
  v_cvt_f32_i32 v113, v113
  v_cvt_f32_i32 v114, v114
  v_cvt_f32_i32 v115, v115
  v_pk_fma_f32 v[52:53], v[112:113], v[18:19], v[52:53] op_sel_hi:[1,0,1]
  v_pk_fma_f32 v[54:55], v[114:115], v[18:19], v[54:55] op_sel_hi:[1,0,1]
  s_cmpk_gt_i32 s69, 0x35
  s_cbranch_scc1 L_p76_4
  s_cmpk_gt_i32 s69, 0x21
  s_cbranch_scc1 L_p76_3
  s_cmpk_gt_i32 s69, 0xffd1
  s_cbranch_scc1 L_p76_0
  s_waitcnt vmcnt(6)
L_p76_0:
  s_waitcnt vmcnt(7)
L_p76_3:
  s_waitcnt vmcnt(10)
L_p76_4:
  s_waitcnt vmcnt(11)
  buffer_load_dwordx4 v[100:103], v232, s[32:35], 0 offen nt
  s_waitcnt vmcnt(8)
  s_add_u32 s44, s78, 0x03030303
  v_msad_u8 v9, s78, v36, 0
  v_msad_u8 v10, s44, v36, 0
  v_msad_u8 v9, s78, v37, v9
  v_msad_u8 v10, s44, v37, v10
  v_msad_u8 v9, s78, v38, v9
  v_msad_u8 v10, s44, v38, v10
  s_mov_b64 exec, 3
  global_store_byte v7, v8, s[30:31]
  global_load_dwordx3 v[36:38], v236, s[30:31] sc1
  v_sub_u32 v9, v9, v10
  v_add_u32 v8, 1, v8
  s_mov_b64 exec, -1
  v_readlane_b32 s66, v9, 0
  v_readlane_b32 s67, v9, 1
  s_add_u32 s78, s78, 0x01010101
  s_lshl1_add_u32 s69, s91, s95
  s_add_u32 s95, s66, s67
  s_add_u32 s69, s69, s95
  v_mov_b32_dpp v18, v116 row_newbcast:12 row_mask:0xf bank_mask:0xf
  v_cvt_f32_i32 v68, v68
  v_cvt_f32_i32 v69, v69
  v_cvt_f32_i32 v70, v70
  v_cvt_f32_i32 v71, v71
  v_pk_fma_f32 v[44:45], v[68:69], v[18:19], v[44:45] op_sel_hi:[1,0,1]
  v_pk_fma_f32 v[46:47], v[70:71], v[18:19], v[46:47] op_sel_hi:[1,0,1]
  s_cmpk_gt_i32 s69, 0x35
  s_cbranch_scc1 L_p77_4
  s_cmpk_gt_i32 s69, 0xfff1
  s_cbranch_scc1 L_p77_1
  s_waitcnt vmcnt(5)
L_p77_1:
  s_waitcnt vmcnt(8)
L_p77_4:
  s_waitcnt vmcnt(9)
  buffer_load_dwordx4 v[104:107], v233, s[32:35], 0 offen nt
  v_mov_b32_dpp v18, v116 row_newbcast:13 row_mask:0xf bank_mask:0xf
  v_cvt_f32_i32 v72, v72
  v_cvt_f32_i32 v73, v73
  v_cvt_f32_i32 v74, v74
  v_cvt_f32_i32 v75, v75
  v_pk_fma_f32 v[48:49], v[72:73], v[18:19], v[48:49] op_sel_hi:[1,0,1]
  v_pk_fma_f32 v[50:51], v[74:75], v[18:19], v[50:51] op_sel_hi:[1,0,1]
  s_cmpk_gt_i32 s69, 0x35
  s_cbranch_scc1 L_p78_4
  s_cmpk_gt_i32 s69, 0xf
  s_cbranch_scc1 L_p78_2
  s_waitcnt vmcnt(6)
L_p78_2:
  s_waitcnt vmcnt(9)
L_p78_4:
  s_waitcnt vmcnt(10)
  buffer_load_dwordx4 v[108:111], v234, s[32:35], 0 offen nt
  v_mov_b32_dpp v18, v116 row_newbcast:14 row_mask:0xf bank_mask:0xf
  v_cvt_f32_i32 v76, v76
  v_cvt_f32_i32 v77, v77
  v_cvt_f32_i32 v78, v78
  v_cvt_f32_i32 v79, v79
  v_pk_fma_f32 v[52:53], v[76:77], v[18:19], v[52:53] op_sel_hi:[1,0,1]
  v_pk_fma_f32 v[54:55], v[78:79], v[18:19], v[54:55] op_sel_hi:[1,0,1]
  s_cmpk_gt_i32 s69, 0x35
  s_cbranch_scc1 L_p79_4
  s_cmpk_gt_i32 s69, 0x21
  s_cbranch_scc1 L_p79_3
  s_cmpk_gt_i32 s69, 0xffd1
  s_cbranch_scc1 L_p79_0
  s_waitcnt vmcnt(6)
L_p79_0:
  s_waitcnt vmcnt(7)
L_p79_3:
  s_waitcnt vmcnt(10)
L_p79_4:
  s_waitcnt vmcnt(11)
  buffer_load_dwordx4 v[112:115], v235, s[32:35], 0 offen nt
  s_cbranch_vccnz L_vtail
  ds_read_b32 v4, v14 offset:20
  s_waitcnt vmcnt(8)
  s_add_u32 s44, s78, 0x03030303
  v_msad_u8 v9, s78, v40, 0
  v_msad_u8 v10, s44, v40, 0
  v_msad_u8 v9, s78, v41, v9
  v_msad_u8 v10, s44, v41, v10
  v_msad_u8 v9, s78, v42, v9
  v_msad_u8 v10, s44, v42, v10
  s_mov_b64 exec, 3
  global_load_dwordx2 v[26:27], v11, s[30:31] sc1
  global_store_byte v7, v8, s[30:31]
  global_load_dwordx3 v[40:42], v237, s[30:31] sc1
  v_sub_u32 v9, v9, v10
  v_add_u32 v8, 1, v8
  s_mov_b64 exec, -1
  v_readlane_b32 s66, v9, 0
  v_readlane_b32 s67, v9, 1
  s_add_u32 s78, s78, 0x01010101
  s_lshl1_add_u32 s69, s91, s95
  s_add_u32 s95, s66, s67
  s_add_u32 s69, s69, s95
  v_mov_b32_dpp v18, v116 row_newbcast:15 row_mask:0xf bank_mask:0xf
  v_cvt_f32_i32 v80, v80
  v_cvt_f32_i32 v81, v81
  v_cvt_f32_i32 v82, v82
  v_cvt_f32_i32 v83, v83
  v_pk_fma_f32 v[44:45], v[80:81], v[18:19], v[44:45] op_sel_hi:[1,0,1]
  v_pk_fma_f32 v[46:47], v[82:83], v[18:19], v[46:47] op_sel_hi:[1,0,1]
  s_cmpk_gt_i32 s69, 0x35
  s_cbranch_scc1 L_p80_4
  s_cmpk_gt_i32 s69, 0xfff1
  s_cbranch_scc1 L_p80_1
  s_waitcnt vmcnt(6)
L_p80_1:
  s_waitcnt vmcnt(9)
L_p80_4:
  s_waitcnt vmcnt(10)
  buffer_load_dwordx4 v[68:71], v212, s[36:39], 0 offen nt
  v_mov_b32_dpp v18, v117 row_newbcast:0 row_mask:0xf bank_mask:0xf
  v_cvt_f32_i32 v84, v84
  v_cvt_f32_i32 v85, v85
  v_cvt_f32_i32 v86, v86
  v_cvt_f32_i32 v87, v87
  v_pk_fma_f32 v[48:49], v[84:85], v[18:19], v[48:49] op_sel_hi:[1,0,1]
  v_pk_fma_f32 v[50:51], v[86:87], v[18:19], v[50:51] op_sel_hi:[1,0,1]
  s_cmpk_gt_i32 s69, 0x35
  s_cbranch_scc1 L_p81_4
  s_cmpk_gt_i32 s69, 0xf
  s_cbranch_scc1 L_p81_2
  s_waitcnt vmcnt(7)
L_p81_2:
  s_waitcnt vmcnt(10)
L_p81_4:
  s_waitcnt vmcnt(11)
  buffer_load_dwordx4 v[72:75], v213, s[36:39], 0 offen nt
  v_mov_b32_dpp v18, v117 row_newbcast:1 row_mask:0xf bank_mask:0xf
  v_cvt_f32_i32 v88, v88
  v_cvt_f32_i32 v89, v89
  v_cvt_f32_i32 v90, v90
  v_cvt_f32_i32 v91, v91
  v_pk_fma_f32 v[52:53], v[88:89], v[18:19], v[52:53] op_sel_hi:[1,0,1]
  v_pk_fma_f32 v[54:55], v[90:91], v[18:19], v[54:55] op_sel_hi:[1,0,1]
  s_cmpk_gt_i32 s69, 0x35
  s_cbranch_scc1 L_p82_4
  s_cmpk_gt_i32 s69, 0x21
  s_cbranch_scc1 L_p82_3
  s_cmpk_gt_i32 s69, 0xffd1
  s_cbranch_scc1 L_p82_0
  s_waitcnt vmcnt(7)
L_p82_0:
  s_waitcnt vmcnt(8)
L_p82_3:
  s_waitcnt vmcnt(11)
L_p82_4:
  s_waitcnt vmcnt(12)
  buffer_load_dwordx4 v[76:79], v214, s[36:39], 0 offen nt
L_an:
  s_waitcnt lgkmcnt(0)
  v_readfirstlane_b32 s46, v4
  s_cmp_ge_u32 s46, s47
  s_cbranch_scc1 L_an_ok
  s_cmp_eq_u32 s94, 0
  s_cbranch_scc1 L_an_ok
  s_sub_u32 s94, s94, 1
  ds_read_b32 v4, v14 offset:20
  s_branch L_an
L_an_ok:
  ds_read_b32 v116, v121 offset:37376
  ds_read_b32 v118, v122 offset:37376
  v_add_u32_e64 v9, s43, 16
  ds_write_b32 v14, v9 offset:24
  s_waitcnt vmcnt(9)
  s_add_u32 s44, s78, 0x03030303
  v_msad_u8 v9, s78, v36, 0
  v_msad_u8 v10, s44, v36, 0
  v_msad_u8 v9, s78, v37, v9
  v_msad_u8 v10, s44, v37, v10
  v_msad_u8 v9, s78, v38, v9
  v_msad_u8 v10, s44, v38, v10
  s_mov_b64 exec, 3
  global_store_byte v7, v8, s[30:31]
  global_load_dwordx3 v[36:38], v238, s[30:31] sc1
  v_sub_u32 v9, v9, v10
  v_add_u32 v8, 1, v8
  s_mov_b64 exec, -1
  v_readlane_b32 s66, v9, 0
  v_readlane_b32 s67, v9, 1
  s_add_u32 s78, s78, 0x01010101
  s_lshl1_add_u32 s69, s91, s95
  s_add_u32 s95, s66, s67
  s_add_u32 s69, s69, s95
  v_mov_b32_dpp v18, v117 row_newbcast:2 row_mask:0xf bank_mask:0xf
  v_cvt_f32_i32 v92, v92
  v_cvt_f32_i32 v93, v93
  v_cvt_f32_i32 v94, v94
  v_cvt_f32_i32 v95, v95
  v_pk_fma_f32 v[44:45], v[92:93], v[18:19], v[44:45] op_sel_hi:[1,0,1]
  v_pk_fma_f32 v[46:47], v[94:95], v[18:19], v[46:47] op_sel_hi:[1,0,1]
  s_cmpk_gt_i32 s69, 0x35
  s_cbranch_scc1 L_p83_4
  s_cmpk_gt_i32 s69, 0xfff1
  s_cbranch_scc1 L_p83_1
  s_waitcnt vmcnt(5)
L_p83_1:
  s_waitcnt vmcnt(9)
L_p83_4:
  s_waitcnt vmcnt(10)
  buffer_load_dwordx4 v[80:83], v215, s[36:39], 0 offen nt
  v_mov_b32_dpp v18, v117 row_newbcast:3 row_mask:0xf bank_mask:0xf
  v_cvt_f32_i32 v96, v96
  v_cvt_f32_i32 v97, v97
  v_cvt_f32_i32 v98, v98
  v_cvt_f32_i32 v99, v99
  v_pk_fma_f32 v[48:49], v[96:97], v[18:19], v[48:49] op_sel_hi:[1,0,1]
  v_pk_fma_f32 v[50:51], v[98:99], v[18:19], v[50:51] op_sel_hi:[1,0,1]
  s_cmpk_gt_i32 s69, 0x35
  s_cbranch_scc1 L_p84_4
  s_cmpk_gt_i32 s69, 0xf
  s_cbranch_scc1 L_p84_2
  s_waitcnt vmcnt(6)
L_p84_2:
  s_waitcnt vmcnt(10)
L_p84_4:
  s_waitcnt vmcnt(11)
  buffer_load_dwordx4 v[84:87], v216, s[36:39], 0 offen nt
  v_mov_b32_dpp v18, v117 row_newbcast:4 row_mask:0xf bank_mask:0xf
  v_cvt_f32_i32 v100, v100
  v_cvt_f32_i32 v101, v101
  v_cvt_f32_i32 v102, v102
  v_cvt_f32_i32 v103, v103
  v_pk_fma_f32 v[52:53], v[100:101], v[18:19], v[52:53] op_sel_hi:[1,0,1]
  v_pk_fma_f32 v[54:55], v[102:103], v[18:19], v[54:55] op_sel_hi:[1,0,1]
  s_cmpk_gt_i32 s69, 0x35
  s_cbranch_scc1 L_p85_4
  s_cmpk_gt_i32 s69, 0x21
  s_cbranch_scc1 L_p85_3
  s_cmpk_gt_i32 s69, 0xffd1
  s_cbranch_scc1 L_p85_0
  s_waitcnt vmcnt(6)
L_p85_0:
  s_waitcnt vmcnt(7)
L_p85_3:
  s_waitcnt vmcnt(11)
L_p85_4:
  s_waitcnt vmcnt(12)
  buffer_load_dwordx4 v[88:91], v217, s[36:39], 0 offen nt
  s_waitcnt vmcnt(8)
  s_add_u32 s44, s78, 0x03030303
  v_msad_u8 v9, s78, v40, 0
  v_msad_u8 v10, s44, v40, 0
  v_msad_u8 v9, s78, v41, v9
  v_msad_u8 v10, s44, v41, v10
  v_msad_u8 v9, s78, v42, v9
  v_msad_u8 v10, s44, v42, v10
  s_mov_b64 exec, 3
  global_store_byte v7, v8, s[30:31]
  global_load_dwordx3 v[40:42], v239, s[30:31] sc1
  v_sub_u32 v9, v9, v10
  v_add3_u32 v10, v26, v27, s58
  v_add_u32 v8, 1, v8
  s_mov_b64 exec, -1
  v_readlane_b32 s66, v9, 0
  v_readlane_b32 s67, v9, 1
  v_readlane_b32 s91, v10, 0
  s_add_u32 s78, s78, 0x01010101
  s_lshl1_add_u32 s69, s91, s95
  s_add_u32 s95, s66, s67
  s_add_u32 s69, s69, s95
  v_mov_b32_dpp v18, v117 row_newbcast:5 row_mask:0xf bank_mask:0xf
  v_cvt_f32_i32 v104, v104
  v_cvt_f32_i32 v105, v105
  v_cvt_f32_i32 v106, v106
  v_cvt_f32_i32 v107, v107
  v_pk_fma_f32 v[44:45], v[104:105], v[18:19], v[44:45] op_sel_hi:[1,0,1]
  v_pk_fma_f32 v[46:47], v[106:107], v[18:19], v[46:47] op_sel_hi:[1,0,1]
  s_cmpk_gt_i32 s69, 0x35
  s_cbranch_scc1 L_p86_4
  s_cmpk_gt_i32 s69, 0xfff1
  s_cbranch_scc1 L_p86_1
  s_waitcnt vmcnt(5)
L_p86_1:
  s_waitcnt vmcnt(8)
L_p86_4:
  s_waitcnt vmcnt(9)
  buffer_load_dwordx4 v[92:95], v218, s[36:39], 0 offen nt
  v_mov_b32_dpp v18, v117 row_newbcast:6 row_mask:0xf bank_mask:0xf
  v_cvt_f32_i32 v108, v108
  v_cvt_f32_i32 v109, v109
  v_cvt_f32_i32 v110, v110
  v_cvt_f32_i32 v111, v111
  v_pk_fma_f32 v[48:49], v[108:109], v[18:19], v[48:49] op_sel_hi:[1,0,1]
  v_pk_fma_f32 v[50:51], v[110:111], v[18:19], v[50:51] op_sel_hi:[1,0,1]
  s_cmpk_gt_i32 s69, 0x35
  s_cbranch_scc1 L_p87_4
  s_cmpk_gt_i32 s69, 0xf
  s_cbranch_scc1 L_p87_2
  s_waitcnt vmcnt(6)
L_p87_2:
  s_waitcnt vmcnt(9)
L_p87_4:
  s_waitcnt vmcnt(10)
  buffer_load_dwordx4 v[96:99], v219, s[36:39], 0 offen nt
  v_mov_b32_dpp v18, v117 row_newbcast:7 row_mask:0xf bank_mask:0xf
  v_cvt_f32_i32 v112, v112
  v_cvt_f32_i32 v113, v113
  v_cvt_f32_i32 v114, v114
  v_cvt_f32_i32 v115, v115
  v_pk_fma_f32 v[52:53], v[112:113], v[18:19], v[52:53] op_sel_hi:[1,0,1]
  v_pk_fma_f32 v[54:55], v[114:115], v[18:19], v[54:55] op_sel_hi:[1,0,1]
  s_cmpk_gt_i32 s69, 0x35
  s_cbranch_scc1 L_p88_4
  s_cmpk_gt_i32 s69, 0x21
  s_cbranch_scc1 L_p88_3
  s_cmpk_gt_i32 s69, 0xffd1
  s_cbranch_scc1 L_p88_0
  s_waitcnt vmcnt(6)
L_p88_0:
  s_waitcnt vmcnt(7)
L_p88_3:
  s_waitcnt vmcnt(10)
L_p88_4:
  s_waitcnt vmcnt(11)
  buffer_load_dwordx4 v[100:103], v220, s[36:39], 0 offen nt
  s_add_u32 s43, s43, 1
  v_permlane32_swap_b32 v44, v46
  v_permlane32_swap_b32 v45, v47
  v_permlane32_swap_b32 v48, v50
  v_permlane32_swap_b32 v49, v51
  v_permlane32_swap_b32 v52, v54
  v_permlane32_swap_b32 v53, v55
  v_add_f32 v44, v44, v50
  v_add_f32 v45, v45, v51
  v_add_f32 v48, v48, v54
  v_add_f32 v49, v49, v55
  v_add_f32 v52, v52, v46
  v_add_f32 v53, v53, v47
  s_add_u32 s44, s43, 16
  s_cmp_eq_u32 s43, 15
  s_cselect_b64 vcc, -1, 0
  v_mov_b32 v4, s44
  v_permlane16_swap_b32 v44, v45
  v_permlane16_swap_b32 v48, v49
  v_permlane16_swap_b32 v52, v53
  v_add_f32 v44, v44, v53
  v_add_f32 v48, v48, v45
  v_add_f32 v52, v52, v49
  s_waitcnt lgkmcnt(0)
  ds_write_b32 v3, v44 offset:0
  ds_write_b32 v3, v48 offset:256
  ds_write_b32 v3, v52 offset:512
  ds_write_b32 v6, v4 offset:0
  v_mov_b32 v117, v118
  v_add_u32 v3, 3072, v3
  s_mov_b64 s[32:33], s[36:37]
  s_add_u32 s45, s43, 1
  s_min_u32 s45, s45, 15
  s_lshl_b32 s68, s45, 2
  s_lshr_b64 s[64:65], s[92:93], s68
  s_and_b32 s68, s64, 15
  s_lshl_b32 s44, s68, 2
  s_lshr_b64 s[64:65], s[96:97], s44
  s_and_b32 s64, s64, 15
  s_lshl4_add_u32 s68, s68, s64
  s_mul_i32 s44, s68, 1572864
  s_add_u32 s36, s12, s44
  s_addc_u32 s37, s13, 0
  s_branch L_v
L_vtail:
  s_mul_i32 s44, s98, 1572864
  s_add_u32 s36, s12, s44
  s_addc_u32 s37, s13, 0
  s_cmp_eq_u32 s41, 0
  s_cselect_b32 s44, 43, -16
  s_cselect_b32 s44, s44, -43
  s_cselect_b32 s45, 0, -1
  s_mulk_i32 s44, 768
  s_add_u32 s36, s36, s44
  s_addc_u32 s37, s37, s45
  s_cmpk_gt_i32 s69, 0x11
  s_cselect_b32 s38, 0, s38
  s_mov_b32 exec_lo, 0x11111111
  s_mov_b32 exec_hi, 0x11111111
  buffer_load_dword v145, v233, s[36:39], 0 offen
  buffer_load_dword v146, v234, s[36:39], 0 offen
  buffer_load_dword v147, v235, s[36:39], 0 offen
  s_mov_b64 exec, -1
  s_waitcnt vmcnt(13)
  v_mov_b32_dpp v18, v116 row_newbcast:15 row_mask:0xf bank_mask:0xf
  v_cvt_f32_i32 v80, v80
  v_cvt_f32_i32 v81, v81
  v_cvt_f32_i32 v82, v82
  v_cvt_f32_i32 v83, v83
  v_pk_fma_f32 v[44:45], v[80:81], v[18:19], v[44:45] op_sel_hi:[1,0,1]
  v_pk_fma_f32 v[46:47], v[82:83], v[18:19], v[46:47] op_sel_hi:[1,0,1]
  s_waitcnt vmcnt(12)
  v_mov_b32_dpp v18, v117 row_newbcast:0 row_mask:0xf bank_mask:0xf
  v_cvt_f32_i32 v84, v84
  v_cvt_f32_i32 v85, v85
  v_cvt_f32_i32 v86, v86
  v_cvt_f32_i32 v87, v87
  v_pk_fma_f32 v[48:49], v[84:85], v[18:19], v[48:49] op_sel_hi:[1,0,1]
  v_pk_fma_f32 v[50:51], v[86:87], v[18:19], v[50:51] op_sel_hi:[1,0,1]
  s_waitcnt vmcnt(11)
  v_mov_b32_dpp v18, v117 row_newbcast:1 row_mask:0xf bank_mask:0xf
  v_cvt_f32_i32 v88, v88
  v_cvt_f32_i32 v89, v89
  v_cvt_f32_i32 v90, v90
  v_cvt_f32_i32 v91, v91
  v_pk_fma_f32 v[52:53], v[88:89], v[18:19], v[52:53] op_sel_hi:[1,0,1]
  v_pk_fma_f32 v[54:55], v[90:91], v[18:19], v[54:55] op_sel_hi:[1,0,1]
  s_waitcnt vmcnt(9)
  v_mov_b32_dpp v18, v117 row_newbcast:2 row_mask:0xf bank_mask:0xf
  v_cvt_f32_i32 v92, v92
  v_cvt_f32_i32 v93, v93
  v_cvt_f32_i32 v94, v94
  v_cvt_f32_i32 v95, v95
  v_pk_fma_f32 v[44:45], v[92:93], v[18:19], v[44:45] op_sel_hi:[1,0,1]
  v_pk_fma_f32 v[46:47], v[94:95], v[18:19], v[46:47] op_sel_hi:[1,0,1]
  s_waitcnt vmcnt(8)
  v_mov_b32_dpp v18, v117 row_newbcast:3 row_mask:0xf bank_mask:0xf
  v_cvt_f32_i32 v96, v96
  v_cvt_f32_i32 v97, v97
  v_cvt_f32_i32 v98, v98
  v_cvt_f32_i32 v99, v99
  v_pk_fma_f32 v[48:49], v[96:97], v[18:19], v[48:49] op_sel_hi:[1,0,1]
  v_pk_fma_f32 v[50:51], v[98:99], v[18:19], v[50:51] op_sel_hi:[1,0,1]
  s_waitcnt vmcnt(7)
  v_mov_b32_dpp v18, v117 row_newbcast:4 row_mask:0xf bank_mask:0xf
  v_cvt_f32_i32 v100, v100
  v_cvt_f32_i32 v101, v101
  v_cvt_f32_i32 v102, v102
  v_cvt_f32_i32 v103, v103
  v_pk_fma_f32 v[52:53], v[100:101], v[18:19], v[52:53] op_sel_hi:[1,0,1]
  v_pk_fma_f32 v[54:55], v[102:103], v[18:19], v[54:55] op_sel_hi:[1,0,1]
  s_waitcnt vmcnt(5)
  v_mov_b32_dpp v18, v117 row_newbcast:5 row_mask:0xf bank_mask:0xf
  v_cvt_f32_i32 v104, v104
  v_cvt_f32_i32 v105, v105
  v_cvt_f32_i32 v106, v106
  v_cvt_f32_i32 v107, v107
  v_pk_fma_f32 v[44:45], v[104:105], v[18:19], v[44:45] op_sel_hi:[1,0,1]
  v_pk_fma_f32 v[46:47], v[106:107], v[18:19], v[46:47] op_sel_hi:[1,0,1]
  s_waitcnt vmcnt(4)
  v_mov_b32_dpp v18, v117 row_newbcast:6 row_mask:0xf bank_mask:0xf
  v_cvt_f32_i32 v108, v108
  v_cvt_f32_i32 v109, v109
  v_cvt_f32_i32 v110, v110
  v_cvt_f32_i32 v111, v111
  v_pk_fma_f32 v[48:49], v[108:109], v[18:19], v[48:49] op_sel_hi:[1,0,1]
  v_pk_fma_f32 v[50:51], v[110:111], v[18:19], v[50:51] op_sel_hi:[1,0,1]
  v_permlane32_swap_b32 v44, v46
  v_permlane32_swap_b32 v45, v47
  v_permlane32_swap_b32 v48, v50
  v_permlane32_swap_b32 v49, v51
  v_add_f32 v44, v44, v50
  v_add_f32 v45, v45, v51
  s_waitcnt vmcnt(3)
  v_mov_b32_dpp v18, v117 row_newbcast:7 row_mask:0xf bank_mask:0xf
  v_cvt_f32_i32 v112, v112
  v_cvt_f32_i32 v113, v113
  v_cvt_f32_i32 v114, v114
  v_cvt_f32_i32 v115, v115
  v_pk_fma_f32 v[52:53], v[112:113], v[18:19], v[52:53] op_sel_hi:[1,0,1]
  v_pk_fma_f32 v[54:55], v[114:115], v[18:19], v[54:55] op_sel_hi:[1,0,1]
  v_permlane16_swap_b32 v44, v45
  s_nop 0
  v_permlane32_swap_b32 v52, v54
  v_permlane32_swap_b32 v53, v55
  v_add_f32 v48, v48, v54
  v_add_f32 v49, v49, v55
  v_add_f32 v52, v52, v46
  v_add_f32 v53, v53, v47
  v_permlane16_swap_b32 v48, v49
  v_add_f32 v48, v48, v45
  v_permlane16_swap_b32 v52, v53
  ds_write_b32 v3, v48 offset:256
  v_add_f32 v44, v44, v53
  v_add_f32 v52, v52, v49
  ds_write_b32 v3, v44 offset:0
  ds_write_b32 v3, v52 offset:512
  s_waitcnt lgkmcnt(0)
  s_barrier
  s_endpgm
L_helper:
  s_getreg_b32 s81, hwreg(HW_REG_HW_ID, 13, 2)
  s_getreg_b32 s79, hwreg(HW_REG_HW_ID, 8, 4)
  s_getreg_b32 s46, hwreg(HW_REG_XCC_ID, 0, 3)
  s_mul_i32 s46, s46, 4352
  s_add_u32 s46, s46, 8126464
  v_lshrrev_b32 v24, 1, v20
  v_lshl_add_u32 v42, v24, 8, s46
  v_and_b32 v24, 1, v20
  v_lshl_add_u32 v42, v24, 4, v42
  s_mov_b64 exec, 0x3ffff
  global_store_dwordx4 v42, v[48:51], s[30:31]
  s_mov_b64 exec, -1
  s_add_u32 s68, s42, 32
  s_mul_i32 s44, s68, 384
  s_add_u32 s32, s4, s44
  s_addc_u32 s33, s5, 0
  global_load_dwordx2 v[68:69], v26, s[32:33]
  global_load_dwordx2 v[70:71], v27, s[32:33]
  s_setprio 0
  s_getpc_b64 s[82:83]
L_pc89:
  s_lshl_b32 s44, s2, 6
  s_add_u32 s44, s44, L_order-L_pc89
  s_add_u32 s82, s82, s44
  s_addc_u32 s83, s83, 0
  s_load_dwordx2 s[92:93], s[82:83], 0
  s_load_dwordx2 s[96:97], s[82:83], 8
  s_mov_b32 s94, 4000000
  s_and_b32 s41, s2, 7
  s_lshl_b32 s41, s41, 1
  s_bitcmp1_b32 s2, 3
  s_addc_u32 s41, s41, 0
  s_load_dword s3, s[82:83], 24
  s_load_dwordx2 s[98:99], s[82:83], 16
  s_waitcnt vmcnt(0)
  ds_write_b32 v14, v38 offset:24
  s_waitcnt lgkmcnt(0)
  v_min_u32 v22, 2, v20
  v_lshlrev_b32 v23, 3, v22
  v_bfe_u32 v23, s99, v23, 8
  v_mul_u32_u24 v36, 4352, v23
  v_add_u32 v36, 7340032, v36
  v_and_b32 v23, 15, v23
  v_lshlrev_b32 v37, 4, v23
  v_lshl_add_u32 v22, v22, 4, s42
  v_mul_u32_u24 v45, 4352, v22
  v_add_u32 v45, 7340032, v45
  s_and_b32 s45, s81, 2
  s_lshl_b32 s44, s45, 9
  s_add_u32 s44, s44, s46
  v_add_u32 v44, s44, v20
  s_lshl_b32 s45, s45, 1
  s_add_u32 s46, s46, s45
  s_add_u32 s46, s46, 2048
  v_mov_b32 v43, s46
  v_mul_u32_u24 v39, 384, v20
  v_add_u32 v39, 7864320, v39
  v_mov_b32 v40, 0
  s_mov_b32 s47, 0
  s_mov_b32 s90, 0
  s_mov_b32 s80, 0
  v_add_u32 v33, 0, v20
  s_and_b32 s44, s41, 1
  v_add_u32 v23, s44, v33
  v_cmp_le_u32 vcc, 43, v23
  s_add_u32 s45, s44, 42
  v_mov_b32 v24, s45
  v_cndmask_b32 v24, 0, v24, vcc
  v_cmp_le_u32 vcc, 86, v23
  v_add_u32 v22, v33, v24
  s_sub_u32 s45, 43, s44
  v_mov_b32 v24, s45
  v_cndmask_b32 v24, 0, v24, vcc
  s_mul_i32 s44, s44, 43
  s_lshr_b32 s45, s41, 1
  s_lshl_b32 s45, s45, 8
  s_add_u32 s44, s44, s45
  v_add3_u32 v22, v22, v24, s44
  v_and_b32 v33, 255, v22
  v_lshlrev_b32 v33, 1, v33
  v_add_u32 v34, 64, v20
  s_and_b32 s44, s41, 1
  v_add_u32 v23, s44, v34
  v_cmp_le_u32 vcc, 43, v23
  s_add_u32 s45, s44, 42
  v_mov_b32 v24, s45
  v_cndmask_b32 v24, 0, v24, vcc
  v_cmp_le_u32 vcc, 86, v23
  v_add_u32 v22, v34, v24
  s_sub_u32 s45, 43, s44
  v_mov_b32 v24, s45
  v_cndmask_b32 v24, 0, v24, vcc
  s_mul_i32 s44, s44, 43
  s_lshr_b32 s45, s41, 1
  s_lshl_b32 s45, s45, 8
  s_add_u32 s44, s44, s45
  v_add3_u32 v22, v22, v24, s44
  v_and_b32 v34, 255, v22
  v_lshlrev_b32 v34, 1, v34
  v_lshlrev_b32 v46, 2, v20
  v_mul_u32_u24 v199, 12, v20
  v_add_u32 v199, 45568, v199
  s_mov_b32 s101, 0
  v_mov_b32 v47, 118912
  v_mov_b32 v51, -1
  v_mov_b32 v60, 0
  v_mov_b32 v61, 0
  v_mov_b32 v62, 0
  v_mov_b32 v63, 0
  v_mov_b32 v64, 0
  v_mov_b32 v65, 0
  v_mov_b32 v66, 0
  v_mov_b32 v67, 0
  s_and_b32 s45, s2, 7
  s_lshl_b32 s45, s45, 9
  v_and_b32 v22, 31, v20
  v_lshl_add_u32 v22, v22, 4, s45
  v_lshrrev_b32 v23, 5, v20
  v_lshl_add_u32 v22, v23, 16, v22
  v_lshlrev_b32 v23, 2, v23
  s_lshr_b32 s44, s96, 0
  v_bfe_u32 v24, s44, v23, 4
  v_lshl_add_u32 v188, v24, 12, v22
  v_add_u32 v22, 0x20000, v22
  s_lshr_b32 s44, s96, 8
  v_bfe_u32 v24, s44, v23, 4
  v_lshl_add_u32 v189, v24, 12, v22
  v_add_u32 v22, 0x20000, v22
  s_lshr_b32 s44, s96, 16
  v_bfe_u32 v24, s44, v23, 4
  v_lshl_add_u32 v190, v24, 12, v22
  v_add_u32 v22, 0x20000, v22
  s_lshr_b32 s44, s96, 24
  v_bfe_u32 v24, s44, v23, 4
  v_lshl_add_u32 v191, v24, 12, v22
  v_add_u32 v22, 0x20000, v22
  s_lshr_b32 s44, s97, 0
  v_bfe_u32 v24, s44, v23, 4
  v_lshl_add_u32 v192, v24, 12, v22
  v_add_u32 v22, 0x20000, v22
  s_lshr_b32 s44, s97, 8
  v_bfe_u32 v24, s44, v23, 4
  v_lshl_add_u32 v193, v24, 12, v22
  v_add_u32 v22, 0x20000, v22
  s_lshr_b32 s44, s97, 16
  v_bfe_u32 v24, s44, v23, 4
  v_lshl_add_u32 v194, v24, 12, v22
  v_add_u32 v22, 0x20000, v22
  s_lshr_b32 s44, s97, 24
  v_bfe_u32 v24, s44, v23, 4
  v_lshl_add_u32 v195, v24, 12, v22
  s_mov_b32 s69, 0
  s_movk_i32 m0, 4608
  s_branch L_hq_nl
L_hk:
  s_sub_u32 s47, s43, 1
L_hsw:
  ds_read_b128 v[104:107], v14 offset:0
  s_waitcnt lgkmcnt(0)
  v_min_u32 v104, v104, v105
  v_min3_u32 v104, v104, v106, v107
  s_nop 0
  v_readfirstlane_b32 s46, v104
  s_cmp_ge_u32 s46, s47
  s_cbranch_scc1 L_hsw_ok
  s_cmp_eq_u32 s94, 0
  s_cbranch_scc1 L_hsw_ok
  s_sub_u32 s94, s94, 1
  s_sleep 1
  s_branch L_hsw
L_hsw_ok:
  s_bitcmp1_b32 s80, s47
  s_cbranch_scc0 L_fas
  s_mul_i32 s44, s47, 384
  s_add_u32 s44, s44, 7864320
  s_movk_i32 s78, 1
  s_atomic_add s78, s[30:31], s44 glc
L_fas:
  s_cmp_lt_u32 s43, 5
  s_cbranch_scc1 L_hs_done
  s_add_u32 s68, s69, 2
  s_min_u32 s68, s68, s47
L_hs:
  ds_read_u16_d16_hi v60, v33 offset:4608
  ds_read_u16_d16_hi v61, v34 offset:4608
  ds_read_u16_d16_hi v62, v33 offset:12800
  ds_read_u16_d16_hi v63, v34 offset:12800
  ds_read_u16_d16_hi v64, v33 offset:20992
  ds_read_u16_d16_hi v65, v34 offset:20992
  ds_read_u16_d16_hi v66, v33 offset:29184
  ds_read_u16_d16_hi v67, v34 offset:29184
  v_add_u32 v200, s101, v199
  v_add_u32 v201, 1536, v200
  s_addk_i32 s101, 3072
  s_cmpk_eq_u32 s101, 18432
  s_cselect_b32 s101, 0, s101
  s_add_u32 s69, s69, 1
  s_waitcnt lgkmcnt(4)
  ds_read2_b32 v[76:77], v200 offset0:0 offset1:1
  ds_read_b32 v72, v200 offset:8
  ds_read2_b32 v[78:79], v200 offset0:192 offset1:193
  ds_read_b32 v73, v200 offset:776
  ds_read2_b32 v[80:81], v201 offset0:0 offset1:1
  ds_read_b32 v74, v201 offset:8
  ds_read2_b32 v[82:83], v201 offset0:192 offset1:193
  ds_read_b32 v75, v201 offset:776
  s_waitcnt lgkmcnt(0)
  v_add_f32 v76, v76, v77
  v_add_f32 v78, v78, v79
  v_add_f32 v80, v80, v81
  v_add_f32 v82, v82, v83
  v_add_f32 v72, v72, v76
  v_add_f32 v73, v73, v78
  v_add_f32 v74, v74, v80
  v_add_f32 v75, v75, v82
  v_fma_f32 v72, -v62, v74, v72
  v_fma_f32 v73, -v63, v75, v73
  v_mul_f32 v74, s67, v60
  v_mul_f32 v75, s67, v61
  v_mul_f32 v72, v72, v74
  v_mul_f32 v73, v73, v75
  v_max_f32 v48, v72, v73
  s_nop 1
  v_max_f32_dpp v48, v48, v48 row_ror:8 row_mask:0xf bank_mask:0xf
  s_nop 1
  v_max_f32_dpp v48, v48, v48 row_ror:4 row_mask:0xf bank_mask:0xf
  s_nop 1
  v_max_f32_dpp v48, v48, v48 row_ror:2 row_mask:0xf bank_mask:0xf
  s_nop 1
  v_max_f32_dpp v48, v48, v48 row_ror:1 row_mask:0xf bank_mask:0xf
  v_mov_b32 v22, v48
  s_nop 1
  v_permlane16_swap_b32 v48, v22
  v_max_f32 v48, v48, v22
  v_mov_b32 v22, v48
  s_nop 1
  v_permlane32_swap_b32 v48, v22
  v_max_f32 v48, v48, v22
  v_sub_f32 v72, v72, v48
  v_sub_f32 v73, v73, v48
  v_exp_f32 v72, v72
  v_exp_f32 v73, v73
  s_nop 0
  v_add_f32 v49, v72, v73
  v_mul_f32 v72, v72, v64
  v_mul_f32 v73, v73, v65
  v_mul_f32 v50, v72, v66
  v_fmac_f32 v50, v73, v67
  ds_write_b32 v46, v72 offset:37376
  ds_write_b32 v46, v73 offset:37632
  s_nop 1
  v_add_f32_dpp v49, v49, v49 row_ror:8 row_mask:0xf bank_mask:0xf
  s_nop 1
  v_add_f32_dpp v49, v49, v49 row_ror:4 row_mask:0xf bank_mask:0xf
  s_nop 1
  v_add_f32_dpp v49, v49, v49 row_ror:2 row_mask:0xf bank_mask:0xf
  s_nop 1
  v_add_f32_dpp v49, v49, v49 row_ror:1 row_mask:0xf bank_mask:0xf
  v_mov_b32 v22, v49
  s_nop 1
  v_permlane16_swap_b32 v49, v22
  v_add_f32 v49, v49, v22
  v_mov_b32 v22, v49
  s_nop 1
  v_permlane32_swap_b32 v49, v22
  v_add_f32 v49, v49, v22
  s_nop 1
  v_add_f32_dpp v50, v50, v50 row_ror:8 row_mask:0xf bank_mask:0xf
  s_nop 1
  v_add_f32_dpp v50, v50, v50 row_ror:4 row_mask:0xf bank_mask:0xf
  s_nop 1
  v_add_f32_dpp v50, v50, v50 row_ror:2 row_mask:0xf bank_mask:0xf
  s_nop 1
  v_add_f32_dpp v50, v50, v50 row_ror:1 row_mask:0xf bank_mask:0xf
  v_mov_b32 v22, v50
  s_nop 1
  v_permlane16_swap_b32 v50, v22
  v_add_f32 v50, v50, v22
  v_mov_b32 v22, v50
  s_nop 1
  v_permlane32_swap_b32 v50, v22
  v_add_f32 v50, v50, v22
  v_mov_b32 v22, s69
  ds_write_b128 v47, v[48:51]
  ds_write_b32 v14, v22 offset:20
  v_add_u32 v46, 512, v46
  v_add_u32 v47, 16, v47
  v_add_u32 v33, 512, v33
  v_add_u32 v34, 512, v34
  s_cmp_lt_u32 s69, s68
  s_cbranch_scc1 L_hs
L_hs_done:
  s_bitcmp1_b32 s80, s47
  s_cbranch_scc0 L_fbs
  s_waitcnt vmcnt(0) lgkmcnt(0)
  v_readlane_b32 s46, v40, s47
  s_sub_u32 s78, s78, s46
  s_bfe_u32 s46, s78, 0x80000
  s_min_u32 s46, s46, 15
  s_lshl_b32 s46, s46, 1
  s_sub_u32 s46, s46, 15
  s_cmp_gt_i32 s46, 0
  s_cselect_b32 s44, 2, 10
  s_mul_i32 s46, s46, s44
  s_add_u32 s46, s46, 8
  s_ashr_i32 s46, s46, 4
  v_mov_b32 v42, s46
  s_mov_b64 exec, 1
  global_store_dword v43, v42, s[30:31]
  s_mov_b64 exec, -1
L_fbs:
  s_cmp_eq_u32 s47, 1
  s_cbranch_scc0 L_el
  s_bitcmp0_b32 s81, 0
  s_cbranch_scc0 L_el
  s_mov_b64 exec, 0xffff
  global_load_ubyte v42, v44, s[30:31] sc1
  s_waitcnt vmcnt(0)
  v_cmp_ne_u32 s[64:65], 0, v42
  s_lshr_b32 s44, s64, s79
  s_bcnt1_i32_b32 s44, s44
  s_sub_u32 s45, s44, 1
  s_cmp_lt_u32 s45, 7
  s_cbranch_scc0 L_el
  s_lshl_b32 s80, 0x10204081, s45
  s_and_b32 s80, s80, 0x7d555554
  s_mov_b32 exec_lo, s80
  global_load_dword v40, v39, s[30:31] sc1
L_el:
  s_mov_b64 exec, -1
L_hq:
  s_add_u32 s43, s43, 1
  s_cmp_gt_u32 s43, 16
  s_cbranch_scc1 L_hq_nl
  s_waitcnt vmcnt(0)
  v_lshlrev_b32 v76, 16, v68
  v_and_b32 v77, s66, v68
  v_lshlrev_b32 v78, 16, v69
  v_and_b32 v79, s66, v69
  v_lshlrev_b32 v80, 16, v70
  v_and_b32 v81, s66, v70
  v_lshlrev_b32 v82, 16, v71
  v_and_b32 v83, s66, v71
  v_mul_f32 v76, v76, v52
  v_mul_f32 v77, v77, v53
  v_mul_f32 v78, v78, v54
  v_mul_f32 v79, v79, v55
  v_mul_f32 v80, v80, v56
  v_mul_f32 v81, v81, v57
  v_mul_f32 v82, v82, v58
  v_mul_f32 v83, v83, v59
  v_cvt_pk_bf16_f32 v84, v76, v80
  v_cvt_pk_bf16_f32 v85, v77, v81
  v_cvt_pk_bf16_f32 v86, v78, v82
  v_cvt_pk_bf16_f32 v87, v79, v83
  v_lshlrev_b32 v76, 16, v84
  v_and_b32 v80, s66, v84
  v_lshlrev_b32 v77, 16, v85
  v_and_b32 v81, s66, v85
  v_lshlrev_b32 v78, 16, v86
  v_and_b32 v82, s66, v86
  v_lshlrev_b32 v79, 16, v87
  v_and_b32 v83, s66, v87
  v_fma_f32 v76, v80, v30, v76
  v_fma_f32 v77, v81, v30, v77
  v_fma_f32 v78, v82, v30, v78
  v_fma_f32 v79, v83, v30, v79
  v_cvt_pk_bf16_f32 v84, v76, v77
  v_cvt_pk_bf16_f32 v85, v78, v79
  v_xor_b32 v86, v31, v84
  v_xor_b32 v87, v31, v85
  v_mov_b32 v22, s43
  ds_write_b16 v28, v84 offset:512
  ds_write_b16_d16_hi v28, v84 offset:516
  ds_write_b16 v28, v85 offset:520
  ds_write_b16_d16_hi v28, v85 offset:524
  ds_write_b16 v29, v86 offset:514
  ds_write_b16_d16_hi v29, v86 offset:518
  ds_write_b16 v29, v87 offset:522
  ds_write_b16_d16_hi v29, v87 offset:526
  ds_write_b32 v14, v22 offset:16
  v_add_u32 v28, 1024, v28
  v_add_u32 v29, 1024, v29
  v_and_b32 v28, 0xfff, v28
  v_and_b32 v29, 0xfff, v29
  s_cmp_eq_u32 s43, 16
  s_cbranch_scc1 L_hq_nl
  s_lshl_b32 s44, s43, 2
  s_lshr_b64 s[64:65], s[96:97], s44
  s_and_b32 s64, s64, 15
  s_lshl4_add_u32 s68, s43, s64
  s_mul_i32 s44, s68, 384
  s_add_u32 s32, s4, s44
  s_addc_u32 s33, s5, 0
  global_load_dwordx2 v[68:69], v26, s[32:33]
  global_load_dwordx2 v[70:71], v27, s[32:33]
L_hq_nl:
  s_sub_u32 s44, s43, 4
  s_cmp_lt_u32 s44, 2
  s_cbranch_scc0 L_sc_done
  global_load_lds_dwordx4 v188, s[8:9]
  s_addk_i32 m0, 1024
  s_waitcnt vmcnt(3)
  global_load_lds_dwordx4 v189, s[8:9]
  s_addk_i32 m0, 1024
  s_waitcnt vmcnt(3)
  global_load_lds_dwordx4 v190, s[8:9]
  s_addk_i32 m0, 1024
  s_waitcnt vmcnt(3)
  global_load_lds_dwordx4 v191, s[8:9]
  s_addk_i32 m0, 1024
  s_waitcnt vmcnt(3)
  global_load_lds_dwordx4 v192, s[8:9]
  s_addk_i32 m0, 1024
  s_waitcnt vmcnt(3)
  global_load_lds_dwordx4 v193, s[8:9]
  s_addk_i32 m0, 1024
  s_waitcnt vmcnt(3)
  global_load_lds_dwordx4 v194, s[8:9]
  s_addk_i32 m0, 1024
  s_waitcnt vmcnt(3)
  global_load_lds_dwordx4 v195, s[8:9]
  s_addk_i32 m0, 1024
  s_mov_b64 s[8:9], s[10:11]
  s_mov_b64 s[10:11], s[14:15]
  s_mov_b64 s[14:15], s[16:17]
  s_waitcnt vmcnt(3)
  global_load_lds_dwordx4 v188, s[8:9]
  s_addk_i32 m0, 1024
  s_waitcnt vmcnt(3)
  global_load_lds_dwordx4 v189, s[8:9]
  s_addk_i32 m0, 1024
  s_waitcnt vmcnt(3)
  global_load_lds_dwordx4 v190, s[8:9]
  s_addk_i32 m0, 1024
  s_waitcnt vmcnt(3)
  global_load_lds_dwordx4 v191, s[8:9]
  s_addk_i32 m0, 1024
  s_waitcnt vmcnt(3)
  global_load_lds_dwordx4 v192, s[8:9]
  s_addk_i32 m0, 1024
  s_waitcnt vmcnt(3)
  global_load_lds_dwordx4 v193, s[8:9]
  s_addk_i32 m0, 1024
  s_waitcnt vmcnt(3)
  global_load_lds_dwordx4 v194, s[8:9]
  s_addk_i32 m0, 1024
  s_waitcnt vmcnt(3)
  global_load_lds_dwordx4 v195, s[8:9]
  s_addk_i32 m0, 1024
  s_mov_b64 s[8:9], s[10:11]
  s_mov_b64 s[10:11], s[14:15]
  s_mov_b64 s[14:15], s[16:17]
  s_cmp_eq_u32 s43, 5
  s_cbranch_scc0 L_sc_done
  s_waitcnt vmcnt(0)
L_sc_done:
  s_cmp_eq_u32 s43, 16
  s_cbranch_scc0 L_hq_skip
  s_cmp_eq_u32 s3, 0
  s_cbranch_scc0 L_hq_skip
  s_mov_b64 exec, 7
  global_store_dword v45, v14, s[30:31] sc1
  s_waitcnt vmcnt(0)
  s_mov_b64 exec, 1
  global_store_dword v37, v38, s[28:29] sc1
  s_mov_b64 exec, -1
L_hq_skip:
  s_waitcnt lgkmcnt(0)
  s_cmp_lt_u32 s43, 18
  s_cbranch_scc1 L_hk
  v_and_b32 v24, 15, v20
  v_lshlrev_b32 v24, 1, v24
  global_load_ushort v25, v24, s[82:83] offset:32
  s_mov_b32 s43, 0
  v_min_u32 v28, 23, v20
  v_lshlrev_b32 v28, 4, v28
  v_lshlrev_b32 v22, 1, v28
  v_subrev_u32 v196, 256, v22
  v_add_u32 v197, 512, v22
  v_min_u32 v197, v196, v197
  v_add_u32 v197, 64000, v197
  v_subrev_u32 v196, 512, v22
  v_add_u32 v198, 256, v22
  v_min_u32 v198, v196, v198
  v_add_u32 v198, 64000, v198
  v_add_u32 v196, 64000, v22
  v_add_u32 v28, 113152, v28
  v_lshlrev_b32 v32, 4, v20
  v_add_u32 v30, 113152, v32
  v_cmp_gt_u32 vcc, 24, v20
  v_lshrrev_b32 v21, 1, v35
  s_mul_i32 s44, s98, 384
  s_add_u32 s26, s26, s44
  s_addc_u32 s27, s27, 0
  v_mov_b32 v31, s2
  v_mul_u32_u24 v31, 6144, v31
  v_add_u32 v31, 8388608, v31
  v_add_u32 v23, 0, v32
  v_add_u32 v188, v23, v31
  v_add_u32 v23, 1024, v32
  v_add_u32 v189, v23, v31
  v_add_u32 v23, 2048, v32
  v_add_u32 v190, v23, v31
  v_add_u32 v23, 3072, v32
  v_add_u32 v191, v23, v31
  v_add_u32 v23, 4096, v32
  v_add_u32 v192, v23, v31
  v_add_u32 v23, 5120, v32
  v_add_u32 v193, v23, v31
  s_mov_b32 s45, 14
  s_lshl_b32 s68, s45, 2
  s_lshr_b64 s[64:65], s[92:93], s68
  s_and_b32 s68, s64, 15
  v_lshl_add_u32 v23, s68, 4, v32
  v_cndmask_b32 v23, v23, v32, vcc
  v_add_u32 v23, 5376, v23
  v_add_u32 v168, v23, v31
  s_waitcnt vmcnt(0)
  v_lshrrev_b32 v31, 4, v25
  v_mul_u32_u24 v31, 6144, v31
  v_add_u32 v31, 8388608, v31
  v_and_b32 v25, 15, v25
  v_mul_u32_u24 v25, 384, v25
  s_lshl4_add_u32 s44, s3, 5760
  v_mov_b32 v23, s44
  v_add_u32 v187, v23, v31
  v_add_u32_dpp v23, v25, v21 row_newbcast:0 row_mask:0xf bank_mask:0xf
  v_mov_b32_dpp v29, v31 row_newbcast:0 row_mask:0xf bank_mask:0xf
  v_add_u32 v172, v23, v29
  v_add_u32_dpp v23, v25, v21 row_newbcast:1 row_mask:0xf bank_mask:0xf
  v_mov_b32_dpp v29, v31 row_newbcast:1 row_mask:0xf bank_mask:0xf
  v_add_u32 v173, v23, v29
  v_add_u32_dpp v23, v25, v21 row_newbcast:2 row_mask:0xf bank_mask:0xf
  v_mov_b32_dpp v29, v31 row_newbcast:2 row_mask:0xf bank_mask:0xf
  v_add_u32 v174, v23, v29
  v_add_u32_dpp v23, v25, v21 row_newbcast:3 row_mask:0xf bank_mask:0xf
  v_mov_b32_dpp v29, v31 row_newbcast:3 row_mask:0xf bank_mask:0xf
  v_add_u32 v175, v23, v29
  v_add_u32_dpp v23, v25, v21 row_newbcast:4 row_mask:0xf bank_mask:0xf
  v_mov_b32_dpp v29, v31 row_newbcast:4 row_mask:0xf bank_mask:0xf
  v_add_u32 v176, v23, v29
  v_add_u32_dpp v23, v25, v21 row_newbcast:5 row_mask:0xf bank_mask:0xf
  v_mov_b32_dpp v29, v31 row_newbcast:5 row_mask:0xf bank_mask:0xf
  v_add_u32 v177, v23, v29
  v_add_u32_dpp v23, v25, v21 row_newbcast:6 row_mask:0xf bank_mask:0xf
  v_mov_b32_dpp v29, v31 row_newbcast:6 row_mask:0xf bank_mask:0xf
  v_add_u32 v178, v23, v29
  v_add_u32_dpp v23, v25, v21 row_newbcast:7 row_mask:0xf bank_mask:0xf
  v_mov_b32_dpp v29, v31 row_newbcast:7 row_mask:0xf bank_mask:0xf
  v_add_u32 v179, v23, v29
  v_add_u32_dpp v23, v25, v21 row_newbcast:8 row_mask:0xf bank_mask:0xf
  v_mov_b32_dpp v29, v31 row_newbcast:8 row_mask:0xf bank_mask:0xf
  v_add_u32 v180, v23, v29
  v_add_u32_dpp v23, v25, v21 row_newbcast:9 row_mask:0xf bank_mask:0xf
  v_mov_b32_dpp v29, v31 row_newbcast:9 row_mask:0xf bank_mask:0xf
  v_add_u32 v181, v23, v29
  v_add_u32_dpp v23, v25, v21 row_newbcast:10 row_mask:0xf bank_mask:0xf
  v_mov_b32_dpp v29, v31 row_newbcast:10 row_mask:0xf bank_mask:0xf
  v_add_u32 v182, v23, v29
  v_add_u32_dpp v23, v25, v21 row_newbcast:11 row_mask:0xf bank_mask:0xf
  v_mov_b32_dpp v29, v31 row_newbcast:11 row_mask:0xf bank_mask:0xf
  v_add_u32 v183, v23, v29
  v_add_u32_dpp v23, v25, v21 row_newbcast:12 row_mask:0xf bank_mask:0xf
  v_mov_b32_dpp v29, v31 row_newbcast:12 row_mask:0xf bank_mask:0xf
  v_add_u32 v184, v23, v29
  v_add_u32_dpp v23, v25, v21 row_newbcast:13 row_mask:0xf bank_mask:0xf
  v_mov_b32_dpp v29, v31 row_newbcast:13 row_mask:0xf bank_mask:0xf
  v_add_u32 v185, v23, v29
  v_add_u32_dpp v23, v25, v21 row_newbcast:14 row_mask:0xf bank_mask:0xf
  v_mov_b32_dpp v29, v31 row_newbcast:14 row_mask:0xf bank_mask:0xf
  v_add_u32 v186, v23, v29
  v_mov_b32 v108, -1
  v_mov_b32 v109, -1
  v_mov_b32 v110, -1
  v_mov_b32 v111, -1
  s_lshl4_add_u32 s44, s3, 118912
  v_mov_b32 v23, s44
  ds_write_b128 v28, v[108:111] offset:5376
  ds_write_b32 v23, v38 offset:12
L_hp:
  s_min_u32 s44, s3, 13
  s_cmp_eq_u32 s44, s43
  s_cbranch_scc0 L_hc_ok
L_hc:
  global_load_dword v104, v37, s[28:29] sc1
  s_waitcnt vmcnt(0)
  v_cmp_ne_u32 s[64:65], 1, v104
  s_cmp_eq_u64 s[64:65], 0
  s_cbranch_scc1 L_hc_ok
  s_cmp_eq_u32 s94, 0
  s_cbranch_scc1 L_hc_ok
  s_sub_u32 s94, s94, 1
  s_sleep 64
  s_branch L_hc
L_hc_ok:
  s_lshl_b32 s68, s43, 2
  s_lshr_b64 s[64:65], s[92:93], s68
  s_and_b32 s68, s64, 15
  s_lshl4_add_u32 s44, s68, 118912
  v_mov_b32 v23, s44
  s_cmp_eq_u32 s43, 14
  s_cbranch_scc0 L_hp_mid
  ds_read_b128 v[144:147], v30 offset:0
  ds_read_b128 v[148:151], v30 offset:1024
  ds_read_b128 v[152:155], v30 offset:2048
  ds_read_b128 v[156:159], v30 offset:3072
  ds_read_b128 v[160:163], v30 offset:4096
  ds_read_b128 v[164:167], v30 offset:5120
L_hm:
  ds_read_b32 v104, v14 offset:24
  s_waitcnt lgkmcnt(0)
  v_readfirstlane_b32 s46, v104
  s_cmp_ge_u32 s46, 30
  s_cbranch_scc1 L_hm_ok
  s_cmp_eq_u32 s94, 0
  s_cbranch_scc1 L_hm_ok
  s_sub_u32 s94, s94, 1
  s_sleep 1
  s_branch L_hm
L_hm_ok:
  global_store_dwordx4 v188, v[144:147], s[30:31] sc1
  global_store_dwordx4 v189, v[148:151], s[30:31] sc1
  global_store_dwordx4 v190, v[152:155], s[30:31] sc1
  global_store_dwordx4 v191, v[156:159], s[30:31] sc1
  global_store_dwordx4 v192, v[160:163], s[30:31] sc1
  s_mov_b32 exec_hi, 0xffffff
  global_store_dwordx4 v193, v[164:167], s[30:31] sc1
  s_mov_b64 exec, 7
  s_waitcnt vmcnt(0)
  global_atomic_add v36, v38, s[30:31] sc1
  s_mov_b64 exec, -1
L_hp_mid:
  s_add_u32 s43, s43, 1
  s_add_u32 s47, s43, 16
L_hpw:
  ds_read_b128 v[104:107], v14 offset:0
  s_waitcnt lgkmcnt(0)
  v_min_u32 v104, v104, v105
  v_min3_u32 v104, v104, v106, v107
  s_nop 0
  v_readfirstlane_b32 s46, v104
  s_cmp_ge_u32 s46, s47
  s_cbranch_scc1 L_hpw_ok
  s_cmp_eq_u32 s94, 0
  s_cbranch_scc1 L_hpw_ok
  s_sub_u32 s94, s94, 1
  s_sleep 1
  s_branch L_hpw
L_hpw_ok:
  s_bitcmp1_b32 s80, s47
  s_cbranch_scc0 L_fap
  s_mul_i32 s44, s47, 384
  s_add_u32 s44, s44, 7864320
  s_movk_i32 s78, 1
  s_atomic_add s78, s[30:31], s44 glc
L_fap:
  ds_read_b128 v[72:75], v196 offset:0
  ds_read_b128 v[76:79], v196 offset:16
  ds_read_b128 v[80:83], v197 offset:768
  ds_read_b128 v[84:87], v197 offset:784
  ds_read_b128 v[88:91], v198 offset:1536
  ds_read_b128 v[92:95], v198 offset:1552
  ds_read_b128 v[96:99], v196 offset:2304
  ds_read_b128 v[100:103], v196 offset:2320
  ds_read_b128 v[48:51], v23
  s_waitcnt lgkmcnt(0)
  v_pk_add_f32 v[72:73], v[72:73], v[80:81]
  v_pk_add_f32 v[88:89], v[88:89], v[96:97]
  v_pk_add_f32 v[74:75], v[74:75], v[82:83]
  v_pk_add_f32 v[90:91], v[90:91], v[98:99]
  v_pk_add_f32 v[76:77], v[76:77], v[84:85]
  v_pk_add_f32 v[92:93], v[92:93], v[100:101]
  v_pk_add_f32 v[78:79], v[78:79], v[86:87]
  v_pk_add_f32 v[94:95], v[94:95], v[102:103]
  v_pk_add_f32 v[72:73], v[72:73], v[88:89]
  v_pk_add_f32 v[74:75], v[74:75], v[90:91]
  v_pk_add_f32 v[76:77], v[76:77], v[92:93]
  v_pk_add_f32 v[78:79], v[78:79], v[94:95]
  v_pk_add_f32 v[72:73], v[72:73], v[50:51] op_sel_hi:[1,0] neg_lo:[0,1] neg_hi:[0,1]
  v_pk_add_f32 v[74:75], v[74:75], v[50:51] op_sel_hi:[1,0] neg_lo:[0,1] neg_hi:[0,1]
  v_pk_add_f32 v[76:77], v[76:77], v[50:51] op_sel_hi:[1,0] neg_lo:[0,1] neg_hi:[0,1]
  v_pk_add_f32 v[78:79], v[78:79], v[50:51] op_sel_hi:[1,0] neg_lo:[0,1] neg_hi:[0,1]
  v_max3_f32 v25, |v72|, |v73|, |v74|
  v_max3_f32 v25, v25, |v75|, |v76|
  v_max3_f32 v25, v25, |v77|, |v78|
  v_max_f32_e64 v25, v25, |v79|
  s_nop 1
  v_max_f32_dpp v25, v25, v25 row_ror:8 row_mask:0xf bank_mask:0xf
  s_nop 1
  v_max_f32_dpp v25, v25, v25 row_ror:4 row_mask:0xf bank_mask:0xf
  s_nop 1
  v_max_f32_dpp v25, v25, v25 row_ror:2 row_mask:0xf bank_mask:0xf
  s_nop 1
  v_max_f32_dpp v25, v25, v25 row_ror:1 row_mask:0xf bank_mask:0xf
  v_mov_b32 v29, v25
  s_nop 1
  v_permlane16_swap_b32 v25, v29
  v_max_f32 v25, v25, v29
  v_mov_b32 v29, v25
  s_nop 1
  v_permlane32_swap_b32 v25, v29
  v_max_f32 v25, v25, v29
  v_frexp_exp_i32_f32 v25, v25
  v_sub_u32 v29, 14, v25
  v_add_u32 v51, 242, v25
  v_ldexp_f32 v72, v72, v29
  v_ldexp_f32 v73, v73, v29
  v_ldexp_f32 v74, v74, v29
  v_ldexp_f32 v75, v75, v29
  v_ldexp_f32 v76, v76, v29
  v_ldexp_f32 v77, v77, v29
  v_ldexp_f32 v78, v78, v29
  v_ldexp_f32 v79, v79, v29
  v_cvt_pk_f16_f32 v108, v72, v73
  v_cvt_pk_f16_f32 v109, v74, v75
  v_cvt_pk_f16_f32 v110, v76, v77
  v_cvt_pk_f16_f32 v111, v78, v79
  v_min_u32 v108, -2, v108
  v_min_u32 v109, -2, v109
  v_min_u32 v110, -2, v110
  v_min_u32 v111, -2, v111
  s_cmp_eq_u32 s43, 15
  s_cbranch_scc1 L_hp_last
  ds_write_b32 v23, v51 offset:12
  v_add_u32 v196, 3072, v196
  v_add_u32 v197, 3072, v197
  v_add_u32 v198, 3072, v198
  ds_write_b128 v28, v[108:111]
  v_add_u32 v28, 384, v28
  s_bitcmp1_b32 s80, s47
  s_cbranch_scc0 L_fbp
  s_waitcnt vmcnt(0) lgkmcnt(0)
  v_readlane_b32 s46, v40, s47
  s_sub_u32 s78, s78, s46
  s_bfe_u32 s46, s78, 0x80000
  s_min_u32 s46, s46, 15
  s_lshl_b32 s46, s46, 1
  s_sub_u32 s46, s46, 15
  s_cmp_gt_i32 s46, 0
  s_cselect_b32 s44, 2, 10
  s_mul_i32 s46, s46, s44
  s_add_u32 s46, s46, 8
  s_ashr_i32 s46, s46, 4
  v_mov_b32 v42, s46
  s_mov_b64 exec, 1
  global_store_dword v43, v42, s[30:31]
  s_mov_b64 exec, -1
L_fbp:
  s_branch L_hp
L_hp_last:
  v_cndmask_b32 v108, v48, v108, vcc
  v_cndmask_b32 v109, v49, v109, vcc
  v_cndmask_b32 v110, v50, v110, vcc
  v_cndmask_b32 v111, v51, v111, vcc
  s_mov_b64 exec, 0x1ffffff
  global_store_dwordx4 v168, v[108:111], s[30:31] sc1
  s_mov_b64 exec, -1
  v_subrev_u32 v196, 256, v35
  v_add_u32 v197, 512, v35
  v_min_u32 v197, v196, v197
  v_add_u32 v197, 110080, v197
  v_subrev_u32 v196, 512, v35
  v_add_u32 v198, 256, v35
  v_min_u32 v198, v196, v198
  v_add_u32 v198, 110080, v198
  v_add_u32 v196, 110080, v35
L_hn:
  ds_read_b32 v104, v14 offset:28
  s_waitcnt lgkmcnt(0)
  v_readfirstlane_b32 s46, v104
  s_cmp_ge_u32 s46, 31
  s_cbranch_scc1 L_hn_ok
  s_cmp_eq_u32 s94, 0
  s_cbranch_scc1 L_hn_ok
  s_sub_u32 s94, s94, 1
  s_sleep 1
  s_branch L_hn
L_hn_ok:
  s_mov_b64 exec, 1
L_hw:
  global_atomic_add v68, v36, v14, s[30:31] sc0 sc1
  s_waitcnt vmcnt(0)
  v_readfirstlane_b32 s46, v68
  s_cmp_ge_u32 s46, 16
  s_cbranch_scc1 L_hw_ok
  s_cmp_eq_u32 s94, 0
  s_cbranch_scc1 L_hw_ok
  s_sub_u32 s94, s94, 1
  s_branch L_hw
L_hw_ok:
  s_mov_b64 exec, -1
L_hg:
  global_load_dwordx4 v[52:55], v187, s[30:31] sc1
  global_load_dwordx2 v[112:113], v172, s[30:31] sc1
  global_load_dwordx2 v[114:115], v173, s[30:31] sc1
  global_load_dwordx2 v[116:117], v174, s[30:31] sc1
  global_load_dwordx2 v[118:119], v175, s[30:31] sc1
  global_load_dwordx2 v[120:121], v176, s[30:31] sc1
  global_load_dwordx2 v[122:123], v177, s[30:31] sc1
  global_load_dwordx2 v[124:125], v178, s[30:31] sc1
  global_load_dwordx2 v[126:127], v179, s[30:31] sc1
  global_load_dwordx2 v[128:129], v180, s[30:31] sc1
  global_load_dwordx2 v[130:131], v181, s[30:31] sc1
  global_load_dwordx2 v[132:133], v182, s[30:31] sc1
  global_load_dwordx2 v[134:135], v183, s[30:31] sc1
  global_load_dwordx2 v[136:137], v184, s[30:31] sc1
  global_load_dwordx2 v[138:139], v185, s[30:31] sc1
  global_load_dwordx2 v[140:141], v186, s[30:31] sc1
  s_waitcnt vmcnt(15)
  v_mov_b32 v23, v55
  v_mov_b32 v24, v52
  s_nop 1
  v_max_f32_dpp v24, v24, v24 row_ror:8 row_mask:0xf bank_mask:0xf
  s_nop 1
  v_max_f32_dpp v24, v24, v24 row_ror:4 row_mask:0xf bank_mask:0xf
  s_nop 1
  v_max_f32_dpp v24, v24, v24 row_ror:2 row_mask:0xf bank_mask:0xf
  s_nop 1
  v_max_f32_dpp v24, v24, v24 row_ror:1 row_mask:0xf bank_mask:0xf
  v_sub_f32 v24, v52, v24
  v_exp_f32 v24, v24
  v_subrev_u32 v55, 256, v55
  v_mul_f32 v25, v24, v53
  s_nop 1
  v_add_f32_dpp v25, v25, v25 row_ror:8 row_mask:0xf bank_mask:0xf
  s_nop 1
  v_add_f32_dpp v25, v25, v25 row_ror:4 row_mask:0xf bank_mask:0xf
  s_nop 1
  v_add_f32_dpp v25, v25, v25 row_ror:2 row_mask:0xf bank_mask:0xf
  s_nop 1
  v_add_f32_dpp v25, v25, v25 row_ror:1 row_mask:0xf bank_mask:0xf
  v_rcp_f32 v25, v25
  s_nop 0
  v_mul_f32 v24, v24, v25
  v_ldexp_f32 v25, v24, v55
  v_mul_f32_e64 v54, v24, -v54
  v_readlane_b32 s63, v24, 15
  v_readlane_b32 s44, v54, 15
  v_readlane_b32 s48, v25, 0
  v_readlane_b32 s49, v25, 1
  v_readlane_b32 s50, v25, 2
  v_readlane_b32 s51, v25, 3
  v_readlane_b32 s52, v25, 4
  v_readlane_b32 s53, v25, 5
  v_readlane_b32 s54, v25, 6
  v_readlane_b32 s55, v25, 7
  v_readlane_b32 s56, v25, 8
  v_readlane_b32 s57, v25, 9
  v_readlane_b32 s58, v25, 10
  v_readlane_b32 s59, v25, 11
  v_readlane_b32 s60, v25, 12
  v_readlane_b32 s61, v25, 13
  v_readlane_b32 s62, v25, 14
  v_mov_b32 v108, s44
  v_mov_b32 v109, s44
  v_mov_b32 v110, s44
  v_mov_b32 v111, s44
  s_waitcnt vmcnt(14)
  v_max3_u32 v23, v23, v112, v113
  v_fma_mix_f32 v108, v112, s48, v108 op_sel:[0,0,0] op_sel_hi:[1,0,0]
  v_fma_mix_f32 v109, v112, s48, v109 op_sel:[1,0,0] op_sel_hi:[1,0,0]
  v_fma_mix_f32 v110, v113, s48, v110 op_sel:[0,0,0] op_sel_hi:[1,0,0]
  v_fma_mix_f32 v111, v113, s48, v111 op_sel:[1,0,0] op_sel_hi:[1,0,0]
  s_waitcnt vmcnt(13)
  v_max3_u32 v23, v23, v114, v115
  v_fma_mix_f32 v108, v114, s49, v108 op_sel:[0,0,0] op_sel_hi:[1,0,0]
  v_fma_mix_f32 v109, v114, s49, v109 op_sel:[1,0,0] op_sel_hi:[1,0,0]
  v_fma_mix_f32 v110, v115, s49, v110 op_sel:[0,0,0] op_sel_hi:[1,0,0]
  v_fma_mix_f32 v111, v115, s49, v111 op_sel:[1,0,0] op_sel_hi:[1,0,0]
  s_waitcnt vmcnt(12)
  v_max3_u32 v23, v23, v116, v117
  v_fma_mix_f32 v108, v116, s50, v108 op_sel:[0,0,0] op_sel_hi:[1,0,0]
  v_fma_mix_f32 v109, v116, s50, v109 op_sel:[1,0,0] op_sel_hi:[1,0,0]
  v_fma_mix_f32 v110, v117, s50, v110 op_sel:[0,0,0] op_sel_hi:[1,0,0]
  v_fma_mix_f32 v111, v117, s50, v111 op_sel:[1,0,0] op_sel_hi:[1,0,0]
  s_waitcnt vmcnt(11)
  v_max3_u32 v23, v23, v118, v119
  v_fma_mix_f32 v108, v118, s51, v108 op_sel:[0,0,0] op_sel_hi:[1,0,0]
  v_fma_mix_f32 v109, v118, s51, v109 op_sel:[1,0,0] op_sel_hi:[1,0,0]
  v_fma_mix_f32 v110, v119, s51, v110 op_sel:[0,0,0] op_sel_hi:[1,0,0]
  v_fma_mix_f32 v111, v119, s51, v111 op_sel:[1,0,0] op_sel_hi:[1,0,0]
  s_waitcnt vmcnt(10)
  v_max3_u32 v23, v23, v120, v121
  v_fma_mix_f32 v108, v120, s52, v108 op_sel:[0,0,0] op_sel_hi:[1,0,0]
  v_fma_mix_f32 v109, v120, s52, v109 op_sel:[1,0,0] op_sel_hi:[1,0,0]
  v_fma_mix_f32 v110, v121, s52, v110 op_sel:[0,0,0] op_sel_hi:[1,0,0]
  v_fma_mix_f32 v111, v121, s52, v111 op_sel:[1,0,0] op_sel_hi:[1,0,0]
  s_waitcnt vmcnt(9)
  v_max3_u32 v23, v23, v122, v123
  v_fma_mix_f32 v108, v122, s53, v108 op_sel:[0,0,0] op_sel_hi:[1,0,0]
  v_fma_mix_f32 v109, v122, s53, v109 op_sel:[1,0,0] op_sel_hi:[1,0,0]
  v_fma_mix_f32 v110, v123, s53, v110 op_sel:[0,0,0] op_sel_hi:[1,0,0]
  v_fma_mix_f32 v111, v123, s53, v111 op_sel:[1,0,0] op_sel_hi:[1,0,0]
  s_waitcnt vmcnt(8)
  v_max3_u32 v23, v23, v124, v125
  v_fma_mix_f32 v108, v124, s54, v108 op_sel:[0,0,0] op_sel_hi:[1,0,0]
  v_fma_mix_f32 v109, v124, s54, v109 op_sel:[1,0,0] op_sel_hi:[1,0,0]
  v_fma_mix_f32 v110, v125, s54, v110 op_sel:[0,0,0] op_sel_hi:[1,0,0]
  v_fma_mix_f32 v111, v125, s54, v111 op_sel:[1,0,0] op_sel_hi:[1,0,0]
  s_waitcnt vmcnt(7)
  v_max3_u32 v23, v23, v126, v127
  v_fma_mix_f32 v108, v126, s55, v108 op_sel:[0,0,0] op_sel_hi:[1,0,0]
  v_fma_mix_f32 v109, v126, s55, v109 op_sel:[1,0,0] op_sel_hi:[1,0,0]
  v_fma_mix_f32 v110, v127, s55, v110 op_sel:[0,0,0] op_sel_hi:[1,0,0]
  v_fma_mix_f32 v111, v127, s55, v111 op_sel:[1,0,0] op_sel_hi:[1,0,0]
  s_waitcnt vmcnt(6)
  v_max3_u32 v23, v23, v128, v129
  v_fma_mix_f32 v108, v128, s56, v108 op_sel:[0,0,0] op_sel_hi:[1,0,0]
  v_fma_mix_f32 v109, v128, s56, v109 op_sel:[1,0,0] op_sel_hi:[1,0,0]
  v_fma_mix_f32 v110, v129, s56, v110 op_sel:[0,0,0] op_sel_hi:[1,0,0]
  v_fma_mix_f32 v111, v129, s56, v111 op_sel:[1,0,0] op_sel_hi:[1,0,0]
  s_waitcnt vmcnt(5)
  v_max3_u32 v23, v23, v130, v131
  v_fma_mix_f32 v108, v130, s57, v108 op_sel:[0,0,0] op_sel_hi:[1,0,0]
  v_fma_mix_f32 v109, v130, s57, v109 op_sel:[1,0,0] op_sel_hi:[1,0,0]
  v_fma_mix_f32 v110, v131, s57, v110 op_sel:[0,0,0] op_sel_hi:[1,0,0]
  v_fma_mix_f32 v111, v131, s57, v111 op_sel:[1,0,0] op_sel_hi:[1,0,0]
  s_waitcnt vmcnt(4)
  v_max3_u32 v23, v23, v132, v133
  v_fma_mix_f32 v108, v132, s58, v108 op_sel:[0,0,0] op_sel_hi:[1,0,0]
  v_fma_mix_f32 v109, v132, s58, v109 op_sel:[1,0,0] op_sel_hi:[1,0,0]
  v_fma_mix_f32 v110, v133, s58, v110 op_sel:[0,0,0] op_sel_hi:[1,0,0]
  v_fma_mix_f32 v111, v133, s58, v111 op_sel:[1,0,0] op_sel_hi:[1,0,0]
  s_waitcnt vmcnt(3)
  v_max3_u32 v23, v23, v134, v135
  v_fma_mix_f32 v108, v134, s59, v108 op_sel:[0,0,0] op_sel_hi:[1,0,0]
  v_fma_mix_f32 v109, v134, s59, v109 op_sel:[1,0,0] op_sel_hi:[1,0,0]
  v_fma_mix_f32 v110, v135, s59, v110 op_sel:[0,0,0] op_sel_hi:[1,0,0]
  v_fma_mix_f32 v111, v135, s59, v111 op_sel:[1,0,0] op_sel_hi:[1,0,0]
  s_waitcnt vmcnt(2)
  v_max3_u32 v23, v23, v136, v137
  v_fma_mix_f32 v108, v136, s60, v108 op_sel:[0,0,0] op_sel_hi:[1,0,0]
  v_fma_mix_f32 v109, v136, s60, v109 op_sel:[1,0,0] op_sel_hi:[1,0,0]
  v_fma_mix_f32 v110, v137, s60, v110 op_sel:[0,0,0] op_sel_hi:[1,0,0]
  v_fma_mix_f32 v111, v137, s60, v111 op_sel:[1,0,0] op_sel_hi:[1,0,0]
  s_waitcnt vmcnt(1)
  v_max3_u32 v23, v23, v138, v139
  v_fma_mix_f32 v108, v138, s61, v108 op_sel:[0,0,0] op_sel_hi:[1,0,0]
  v_fma_mix_f32 v109, v138, s61, v109 op_sel:[1,0,0] op_sel_hi:[1,0,0]
  v_fma_mix_f32 v110, v139, s61, v110 op_sel:[0,0,0] op_sel_hi:[1,0,0]
  v_fma_mix_f32 v111, v139, s61, v111 op_sel:[1,0,0] op_sel_hi:[1,0,0]
  s_waitcnt vmcnt(0)
  v_max3_u32 v23, v23, v140, v141
  v_cmp_eq_u32 s[64:65], -1, v23
  v_fma_mix_f32 v108, v140, s62, v108 op_sel:[0,0,0] op_sel_hi:[1,0,0]
  v_fma_mix_f32 v109, v140, s62, v109 op_sel:[1,0,0] op_sel_hi:[1,0,0]
  v_fma_mix_f32 v110, v141, s62, v110 op_sel:[0,0,0] op_sel_hi:[1,0,0]
  v_fma_mix_f32 v111, v141, s62, v111 op_sel:[1,0,0] op_sel_hi:[1,0,0]
  s_cmp_eq_u64 s[64:65], 0
  s_cbranch_scc1 L_hg_ok
  s_cmp_eq_u32 s94, 0
  s_cbranch_scc1 L_hg_ok
  s_sub_u32 s94, s94, 1
  s_branch L_hg
L_hg_ok:
  v_mov_b32 v168, s63
  s_mov_b32 exec_hi, 0xffff
  s_barrier
  ds_read_b128 v[72:75], v196 offset:0
  ds_read_b128 v[76:79], v197 offset:768
  ds_read_b128 v[80:83], v198 offset:1536
  ds_read_b128 v[84:87], v196 offset:2304
  s_waitcnt lgkmcnt(3)
  v_pk_fma_f32 v[108:109], v[72:73], v[168:169], v[108:109] op_sel_hi:[1,0,1]
  v_pk_fma_f32 v[110:111], v[74:75], v[168:169], v[110:111] op_sel_hi:[1,0,1]
  s_waitcnt lgkmcnt(2)
  v_pk_fma_f32 v[108:109], v[76:77], v[168:169], v[108:109] op_sel_hi:[1,0,1]
  v_pk_fma_f32 v[110:111], v[78:79], v[168:169], v[110:111] op_sel_hi:[1,0,1]
  s_waitcnt lgkmcnt(1)
  v_pk_fma_f32 v[108:109], v[80:81], v[168:169], v[108:109] op_sel_hi:[1,0,1]
  v_pk_fma_f32 v[110:111], v[82:83], v[168:169], v[110:111] op_sel_hi:[1,0,1]
  s_waitcnt lgkmcnt(0)
  v_pk_fma_f32 v[108:109], v[84:85], v[168:169], v[108:109] op_sel_hi:[1,0,1]
  v_pk_fma_f32 v[110:111], v[86:87], v[168:169], v[110:111] op_sel_hi:[1,0,1]
  v_cvt_pk_bf16_f32 v108, v108, v109
  v_cvt_pk_bf16_f32 v109, v110, v111
  global_store_dwordx2 v21, v[108:109], s[26:27]
L_end:
  s_endpgm
.p2align 6
.type L_order,@object
L_order:
  .long 0x76afedcb, 0x45321098, 0x500000, 0x300, 0x40, 0x251300, 0x4, 0x0
  .long 0x2e001e, 0x4e003e, 0x6e005e, 0x8d007e, 0xae009e, 0xce00be, 0xee00de, 0xf00fe
  .long 0x96afedcb, 0x74321058, 0x700000, 0x700, 0x70, 0x271700, 0x7, 0x0
  .long 0x270007, 0x470037, 0x670057, 0x870077, 0xa70097, 0xc700b7, 0xe700d7, 0x1f00f7
  .long 0x765aedfb, 0xc4321098, 0xd00000, 0xf00, 0xc0, 0x2d1f00, 0xc, 0x0
  .long 0x110001, 0x410031, 0x610051, 0x810071, 0xa10091, 0xc100b1, 0xe100d1, 0x2f00f1
  .long 0x785fedcb, 0x6432109a, 0x900000, 0x200, 0x60, 0x291200, 0x6, 0x0
  .long 0x160006, 0x460026, 0x660056, 0x860076, 0xa60096, 0xc600b6, 0xe600d6, 0x3f00f6
  .long 0x765faecb, 0xd4321098, 0xf00000, 0xd00, 0xd0, 0x2f1d00, 0xd, 0x0
  .long 0x120002, 0x320022, 0x620052, 0x820072, 0xa20092, 0xc200b2, 0xe200d2, 0x4f00f2
  .long 0x765fedca, 0xb4321098, 0x800000, 0xf00, 0xb0, 0x281f00, 0xb, 0x0
  .long 0x100000, 0x300020, 0x600040, 0x800070, 0xa00090, 0xc000b0, 0xe000d0, 0x5f00f0
  .long 0x76afedcb, 0x24351098, 0x400000, 0x0, 0x20, 0x241000, 0x2, 0x0
  .long 0x1c000c, 0x3c002c, 0x5c004c, 0x8c007c, 0xac009c, 0xcc00bc, 0xea00dc, 0x6f00fc
  .long 0x76afedcb, 0x14325098, 0x400000, 0x400, 0x10, 0x241400, 0x1, 0x0
  .long 0x1b000b, 0x3b002b, 0x5b004b, 0x8b006b, 0xab009b, 0xcb00bb, 0xeb00db, 0x7f00fb
  .long 0x76afedcb, 0x35421098, 0x500000, 0x300, 0x30, 0x251300, 0x3, 0x0
  .long 0x1d000d, 0x3d002d, 0x5d004d, 0x7d006d, 0xad009d, 0xcd00bd, 0xed00dd, 0x8f00fd
  .long 0x76afedcb, 0x94321058, 0x700000, 0x700, 0x90, 0x271700, 0x9, 0x0
  .long 0x170009, 0x390029, 0x590049, 0x790069, 0xa90089, 0xc900b9, 0xe900d9, 0x9f00f9
  .long 0x765aedcb, 0xf4321098, 0xd00000, 0xf00, 0xf0, 0x2d1f00, 0xf, 0x0
  .long 0x140004, 0x340021, 0x540044, 0x740064, 0x940084, 0xc400b4, 0xe400d4, 0xaf00f4
  .long 0x765fedcb, 0x8432109a, 0x900000, 0x200, 0x80, 0x291200, 0x8, 0x0
  .long 0x180008, 0x360028, 0x580048, 0x780068, 0x980088, 0xc800a8, 0xe800d8, 0xbf00f8
  .long 0x765fadcb, 0xe4321098, 0xf00000, 0xd00, 0xe0, 0x2f1d00, 0xe, 0x0
  .long 0x130003, 0x330023, 0x530042, 0x730063, 0x930083, 0xb300a3, 0xe300d3, 0xcf00f3
  .long 0x765fedcb, 0xa4321098, 0x800000, 0xf00, 0xaf, 0x28001f, 0xa, 0x0
  .long 0x500024, 0x14400a4, 0x2b40234, 0x6f40674, 0x7830703, 0xc1408c2, 0xd630c94, 0xdf0de3
  .long 0x76afedcb, 0x4351298, 0x400000, 0x0, 0x0, 0x241000, 0x0, 0x0
  .long 0x1a000a, 0x3a002a, 0x5a004a, 0x7a006a, 0x9a008a, 0xba00aa, 0xda00ca, 0xef00fa
  .long 0x76afedcb, 0x54321098, 0x400000, 0x400, 0x54, 0x140024, 0x5, 0x0
  .long 0x7b006c, 0x1cc00ec, 0x4be043e, 0x58d050d, 0x7de075e, 0xe1c084d, 0xe9c0e2e, 0xff0eae
  .long 0x765fadce, 0xb4321098, 0x11911111, 0x11111e11, 0xb1, 0x291e01, 0xb, 0x0
  .long 0x1200110, 0x1400130, 0x1600150, 0x1800170, 0x1a00190, 0x1c001b0, 0x1e001d0, 0x10f01f0
  .long 0x76afedcb, 0x94321058, 0x11b11111, 0x11111011, 0x91, 0x2b1001, 0x9, 0x0
  .long 0x1290109, 0x1490139, 0x1690159, 0x1890179, 0x1a90199, 0x1c901b9, 0x1e901d9, 0x11f01f9
  .long 0x765fedcb, 0x8432109a, 0x11a11111, 0x11111111, 0x81, 0x2a1101, 0x8, 0x0
  .long 0x1180108, 0x1480138, 0x1680158, 0x1880178, 0x1a70198, 0x1c801b8, 0x1e801d8, 0x12f01f8
  .long 0x765feadb, 0xc4321098, 0x11811111, 0x11111e11, 0xc1, 0x281e01, 0xc, 0x0
  .long 0x1110101, 0x1410121, 0x1610151, 0x1810171, 0x1a10191, 0x1c101b1, 0x1e101d1, 0x13f01f1
  .long 0x765aedcb, 0xf4321098, 0x11e11111, 0x11111f11, 0xf1, 0x2e1f01, 0xf, 0x0
  .long 0x1140104, 0x1340124, 0x1640154, 0x1840174, 0x1a40194, 0x1c401b4, 0x1e401d4, 0x14f01f4
  .long 0x76afedcb, 0x45321098, 0x11311111, 0x11111811, 0x41, 0x231801, 0x4, 0x0
  .long 0x11e010e, 0x13e012e, 0x16e014e, 0x18e017e, 0x1ae019e, 0x1ce01be, 0x1ee01dd, 0x15f01fe
  .long 0x7a5fedcb, 0x64321098, 0x11811111, 0x11111311, 0x61, 0x281301, 0x6, 0x0
  .long 0x1160106, 0x1360126, 0x1560146, 0x1860176, 0x1a60196, 0x1c601b6, 0x1e601d6, 0x16f01f6
  .long 0x76afedcb, 0x14325098, 0x11011111, 0x11111311, 0x11, 0x201301, 0x1, 0x0
  .long 0x11b010b, 0x13b012b, 0x15b014b, 0x18b016b, 0x1ab019b, 0x1cb01bb, 0x1eb01db, 0x17f01fa
  .long 0x765fadcb, 0xe4321098, 0x11911111, 0x11111e11, 0xe1, 0x291e01, 0xe, 0x0
  .long 0x1130100, 0x1330123, 0x1530143, 0x1730163, 0x1a30193, 0x1c301b3, 0x1e301d3, 0x18f01f3
  .long 0x76afedcb, 0x54321098, 0x11b11111, 0x11111011, 0x5b, 0x10012b, 0x5, 0x0
  .long 0x3090119, 0x5450389, 0xc2505c5, 0xd650ca5, 0xe750de5, 0xf380ef5, 0xfb80f55, 0x19f0fd5
  .long 0x865fedcb, 0x7432109a, 0x11a11111, 0x11111111, 0x71, 0x2a1101, 0x7, 0x0
  .long 0x1170107, 0x1370127, 0x1570147, 0x1770167, 0x1970187, 0x1c701b7, 0x1e701d7, 0x1af01f7
  .long 0x765feacb, 0xd4321098, 0x11811111, 0x11111e11, 0xd1, 0x281e01, 0xd, 0x0
  .long 0x1120102, 0x1310122, 0x1520142, 0x1720162, 0x1920182, 0x1c201a2, 0x1e201d2, 0x1bf01f2
  .long 0x76afedcb, 0x24351098, 0x11411111, 0x11111711, 0x21, 0x241701, 0x2, 0x0
  .long 0x11c010c, 0x13c012c, 0x15c014c, 0x17c016c, 0x19c018c, 0x1bc01ac, 0x1ec01dc, 0x1cf01fc
  .long 0x76afedcb, 0x35421098, 0x11311111, 0x11111811, 0x31, 0x231801, 0x3, 0x0
  .long 0x11d010d, 0x13d012d, 0x15d014d, 0x17d016d, 0x19d018d, 0x1bd01ad, 0x1ed01cd, 0x1df01fd
  .long 0x765fedcb, 0xa4321098, 0x11811111, 0x11111311, 0xa3, 0x280113, 0xa, 0x0
  .long 0x850005, 0x1750166, 0x62501f5, 0x74506a5, 0xbd507c5, 0xd350d15, 0xdb50d95, 0x1ef0e55
  .long 0x76afedcb, 0x4325198, 0x11011111, 0x11111311, 0x1, 0x201301, 0x0, 0x0
  .long 0x11a010a, 0x13a012a, 0x15a014a, 0x17a016a, 0x19a018a, 0x1ba01aa, 0x1da01ca, 0x1ff01ea
  .long 0x76afedcb, 0x45321098, 0x22222222, 0x22222a22, 0x42, 0x221a02, 0x4, 0x0
  .long 0x22e021e, 0x24e023e, 0x26e025e, 0x28b027e, 0x2ae029e, 0x2ce02be, 0x2ee02de, 0x20f02fe
  .long 0x7a5fedcb, 0x64321098, 0x22c22222, 0x22222622, 0x62, 0x2c1602, 0x6, 0x0
  .long 0x2260206, 0x2460236, 0x2660256, 0x2860276, 0x2a60296, 0x2c602b6, 0x2e602d6, 0x21f02f6
  .long 0x76afedcb, 0x54321098, 0x22922222, 0x22222522, 0x59, 0x150229, 0x5, 0x0
  .long 0xb50035, 0x1850105, 0x2f502a8, 0x3550315, 0x3d50395, 0x6650575, 0x94506e5, 0x22f09c5
  .long 0x765aedcb, 0xf4321098, 0x22f22222, 0x22222f22, 0xf2, 0x2f1f02, 0xf, 0x0
  .long 0x2140204, 0x2440224, 0x2640254, 0x2840274, 0x2a40294, 0x2c402b2, 0x2e402d4, 0x23f02f4
  .long 0x76afedcb, 0x24351098, 0x22222222, 0x22222522, 0x22, 0x221502, 0x2, 0x0
  .long 0x21c020c, 0x23c022c, 0x26c025c, 0x28c027c, 0x2ac029c, 0x2ca02bc, 0x2ec02dc, 0x24f02fc
  .long 0x965fedcb, 0x743210a8, 0x22722222, 0x22222022, 0x72, 0x271002, 0x7, 0x0
  .long 0x2170207, 0x2370227, 0x2670247, 0x2870277, 0x2a70297, 0x2c702b7, 0x2e702d7, 0x25f02f7
  .long 0x765fadce, 0xb4321098, 0x22a22222, 0x22222e22, 0xb2, 0x2a1e02, 0xb, 0x0
  .long 0x2100200, 0x2300220, 0x2500240, 0x2800270, 0x2a00290, 0x2c002b0, 0x2e002d0, 0x26f02f0
  .long 0x76afedcb, 0x34521098, 0x22222222, 0x22222822, 0x32, 0x221802, 0x3, 0x0
  .long 0x21d020d, 0x23d022d, 0x25d024d, 0x28d026d, 0x2ad029d, 0x2cd02bd, 0x2ed02dd, 0x27f02fd
  .long 0x76afedcb, 0x15324098, 0x22222222, 0x22222a22, 0x12, 0x221a02, 0x1, 0x0
  .long 0x21b020b, 0x23b022b, 0x25b024b, 0x27b026b, 0x2ab029b, 0x2cb02bb, 0x2eb02db, 0x28f02fb
  .long 0x765fedcb, 0xa4321098, 0x22c22222, 0x22222622, 0xa6, 0x2c0216, 0xa, 0x0
  .long 0x3650216, 0x42503e5, 0x73504a5, 0x7750755, 0x7d507b5, 0xb4507f5, 0xd050bc5, 0x29f0d85
  .long 0x76afedcb, 0x84321095, 0x22922222, 0x22222522, 0x82, 0x291502, 0x8, 0x0
  .long 0x2180208, 0x2380228, 0x2580248, 0x2780268, 0x2980288, 0x2c802b8, 0x2e802d8, 0x2af02f8
  .long 0x765aefcb, 0xd4321098, 0x22f22222, 0x22222f22, 0xd2, 0x2f1f02, 0xd, 0x0
  .long 0x2120202, 0x2320222, 0x2520242, 0x2720262, 0x2920282, 0x2c202a2, 0x2e202d2, 0x2bf02f2
  .long 0x76afedcb, 0x4351298, 0x22222222, 0x22222522, 0x2, 0x221502, 0x0, 0x0
  .long 0x21a020a, 0x23a022a, 0x25a024a, 0x27a026a, 0x29a028a, 0x2ba02aa, 0x2ea02da, 0x2cf02fa
  .long 0x765fedcb, 0x943210a8, 0x22722222, 0x22222022, 0x92, 0x271002, 0x9, 0x0
  .long 0x2190209, 0x2390229, 0x2570249, 0x2790269, 0x2990289, 0x2b902a9, 0x2e902c9, 0x2df02f9
  .long 0x765fadcb, 0xe4321098, 0x22a22222, 0x22222e22, 0xe2, 0x2a1e02, 0xe, 0x0
  .long 0x2130203, 0x2330223, 0x2530243, 0x2730260, 0x2930283, 0x2b302a3, 0x2d302c3, 0x2ef02f3
  .long 0x765fedab, 0xc4321098, 0x22922222, 0x22222d22, 0xc2, 0x291d02, 0xc, 0x0
  .long 0x2110201, 0x2310221, 0x2510241, 0x2710261, 0x2910281, 0x2b102a1, 0x2d102c1, 0x2ff02e1
  .long 0x76afedcb, 0x84321059, 0x33b33333, 0x33333133, 0x83, 0x2b1103, 0x8, 0x0
  .long 0x3280318, 0x3480338, 0x3680358, 0x3880378, 0x3a80398, 0x3c803b8, 0x3e803d8, 0x30f03f8
  .long 0x765aedcb, 0xf4321098, 0x33933333, 0x33333e33, 0xf3, 0x291e03, 0xf, 0x0
  .long 0x3240304, 0x3440334, 0x3640354, 0x3840374, 0x3a40394, 0x3c403b4, 0x3e403d4, 0x31f03f4
  .long 0x76afedcb, 0x4321598, 0x33033333, 0x33333233, 0x3, 0x201203, 0x0, 0x0
  .long 0x31a030a, 0x34a033a, 0x36a035a, 0x38a037a, 0x3aa039a, 0x3ca03ba, 0x3ea03da, 0x32f03fa
  .long 0x765fedac, 0xb4321098, 0x33a33333, 0x33333b33, 0xb3, 0x2a1b03, 0xb, 0x0
  .long 0x3100300, 0x3400320, 0x3600350, 0x3800370, 0x3a00390, 0x3c003b0, 0x3e003d0, 0x33f03f0
  .long 0x76afedcb, 0x24531098, 0x33133333, 0x33333a33, 0x23, 0x211a03, 0x2, 0x0
  .long 0x31c030c, 0x33c032c, 0x36c035c, 0x38c037c, 0x3ac039c, 0x3cc03bc, 0x3ec03dc, 0x34f03fc
  .long 0xa65fedcb, 0x74321098, 0x33933333, 0x33333133, 0x73, 0x291103, 0x7, 0x0
  .long 0x3170307, 0x3370327, 0x3670347, 0x3870377, 0x3a70397, 0x3c703b7, 0x3e703d6, 0x35f03f7
  .long 0x76afedcb, 0x15324098, 0x33333333, 0x33333633, 0x13, 0x231603, 0x1, 0x0
  .long 0x31b030b, 0x33b032b, 0x35b034b, 0x38b037b, 0x3ab039b, 0x3cb03bb, 0x3eb03db, 0x36f03fb
  .long 0x765fadcb, 0xe4321098, 0x33e33333, 0x33333a33, 0xe3, 0x2e1a03, 0xe, 0x0
  .long 0x3130303, 0x3330323, 0x3530343, 0x3830363, 0x3a30393, 0x3c303b3, 0x3e303d3, 0x37f03f2
  .long 0x76afedcb, 0x94321058, 0x33b33333, 0x33333133, 0x93, 0x2b1103, 0x9, 0x0
  .long 0x3190308, 0x3390329, 0x3590349, 0x3790369, 0x3a90399, 0x3c903b9, 0x3e903d9, 0x38f03f9
  .long 0x765fedcb, 0xa4321098, 0x33933333, 0x33333e33, 0xae, 0x29031e, 0xa, 0x0
  .long 0x1320103, 0x1b20183, 0x2e30263, 0x4740314, 0x82304f4, 0xd5208a3, 0xe420dd2, 0x39f0ec2
  .long 0x76afedcb, 0x54321098, 0x33033333, 0x33333233, 0x50, 0x120320, 0x5, 0x0
  .long 0x1fb017b, 0x65e032a, 0x73c06de, 0xaeb07bc, 0xc6a0c4d, 0xd0c0ccd, 0xf1e0d8c, 0x3af0f9e
  .long 0x765fedab, 0xc4321098, 0x33a33333, 0x33333b33, 0xc3, 0x2a1b03, 0xc, 0x0
  .long 0x3110301, 0x3300321, 0x3510341, 0x3710361, 0x3910381, 0x3c103a1, 0x3e103d1, 0x3bf03f1
  .long 0x76afedcb, 0x34521098, 0x33133333, 0x33333a33, 0x33, 0x211a03, 0x3, 0x0
  .long 0x31d030d, 0x33d032d, 0x35d034c, 0x37d036d, 0x39d038d, 0x3bd03ad, 0x3ed03dd, 0x3cf03fd
  .long 0xa75fedcb, 0x64321098, 0x33933333, 0x33333133, 0x63, 0x291103, 0x6, 0x0
  .long 0x3160306, 0x3360326, 0x3560346, 0x3760366, 0x3960386, 0x3b603a6, 0x3e603c6, 0x3df03f6
  .long 0x76afedcb, 0x45321098, 0x33333333, 0x33333633, 0x43, 0x231603, 0x4, 0x0
  .long 0x31e030e, 0x33e032e, 0x35e034e, 0x37e036b, 0x39e038e, 0x3be03ae, 0x3de03ce, 0x3ef03fe
  .long 0x765faecb, 0xd4321098, 0x33e33333, 0x33333a33, 0xd3, 0x2e1a03, 0xd, 0x0
  .long 0x3120302, 0x3320322, 0x3520342, 0x3720362, 0x3920382, 0x3b203a2, 0x3d203c2, 0x3ff03e2
  .long 0x765fedcb, 0x8432109a, 0x44a44444, 0x44444944, 0x84, 0x2a1904, 0x8, 0x0
  .long 0x4280418, 0x4480438, 0x4680458, 0x4870478, 0x4a80498, 0x4c804b8, 0x4e804d8, 0x40f04f8
  .long 0x76afedcb, 0x4521398, 0x44544444, 0x44444544, 0x4, 0x251504, 0x0, 0x0
  .long 0x42a040a, 0x44a043a, 0x46a045a, 0x48a047a, 0x4aa049a, 0x4ca04ba, 0x4ea04da, 0x41f04fa
  .long 0x76afedcb, 0x24351098, 0x44344444, 0x44444644, 0x24, 0x231604, 0x2, 0x0
  .long 0x41c040c, 0x44c043c, 0x46c045c, 0x48c047c, 0x4ac049c, 0x4cc04bc, 0x4ec04dc, 0x42f04fc
  .long 0x76afedcb, 0x45321098, 0x44444444, 0x44444a44, 0x44, 0x241a04, 0x4, 0x0
  .long 0x41e040e, 0x44e042e, 0x46e045e, 0x48e047e, 0x4ae049e, 0x4ce04bb, 0x4ee04de, 0x43f04fe
  .long 0x765fadce, 0xb4321098, 0x44744444, 0x44444b44, 0xb4, 0x271b04, 0xb, 0x0
  .long 0x4100400, 0x4300420, 0x4600450, 0x4800470, 0x4a00490, 0x4c004b0, 0x4e004d0, 0x44f04f0
  .long 0x765feacb, 0xd4321098, 0x44644444, 0x44444c44, 0xd4, 0x261c04, 0xd, 0x0
  .long 0x4120402, 0x4320422, 0x4620442, 0x4820472, 0x4a20492, 0x4c204b2, 0x4e204d2, 0x45f04f2
  .long 0x79afedcb, 0x64321058, 0x44744444, 0x44444744, 0x64, 0x271704, 0x6, 0x0
  .long 0x4160406, 0x4360426, 0x4560446, 0x4860476, 0x4a60496, 0x4c604b6, 0x4e604d6, 0x46f04f6
  .long 0x765aedcb, 0xf4321098, 0x44644444, 0x44444e44, 0xf4, 0x261e04, 0xf, 0x0
  .long 0x4140404, 0x4340424, 0x4540444, 0x4840464, 0x4a40494, 0x4c404b4, 0x4e404d4, 0x47f04f1
  .long 0x865fedcb, 0x7432109a, 0x44a44444, 0x44444944, 0x74, 0x2a1904, 0x7, 0x0
  .long 0x4170407, 0x4370427, 0x4570447, 0x4770467, 0x4a70497, 0x4c704b7, 0x4e704d7, 0x48f04f7
  .long 0x76afedcb, 0x34521098, 0x44544444, 0x44444544, 0x34, 0x251504, 0x3, 0x0
  .long 0x41a040d, 0x43d042d, 0x45d044d, 0x47d046d, 0x4ad048d, 0x4cd04bd, 0x4ed04dd, 0x49f04fd
  .long 0x76afedcb, 0x54321098, 0x44344444, 0x44444644, 0x53, 0x160423, 0x5, 0x0
  .long 0x1de015e, 0x3ee036e, 0x81b042c, 0x89b087e, 0x93d08fe, 0xd4e09bd, 0xf0d0dce, 0x4af0f8d
  .long 0x76afedcb, 0x15324098, 0x44444444, 0x44444a44, 0x14, 0x241a04, 0x1, 0x0
  .long 0x41b040b, 0x43b042b, 0x45b044b, 0x47b046b, 0x49b048b, 0x4cb04ab, 0x4eb04db, 0x4bf04fb
  .long 0x765fadcb, 0xe4321098, 0x44744444, 0x44444b44, 0xe4, 0x271b04, 0xe, 0x0
  .long 0x4130403, 0x4330423, 0x4530440, 0x4730463, 0x4930483, 0x4b304a3, 0x4e304d3, 0x4cf04f3
  .long 0x765fedcb, 0xa4321098, 0x44644444, 0x44444c44, 0xac, 0x26041c, 0xa, 0x0
  .long 0x5230452, 0x76405a3, 0x94207e4, 0xb1109c2, 0xb910b34, 0xc030bb4, 0xf740c83, 0x4df0ff4
  .long 0x76afedcb, 0x94321058, 0x44744444, 0x44444744, 0x94, 0x271704, 0x9, 0x0
  .long 0x4190409, 0x4390429, 0x4590449, 0x4790466, 0x4990489, 0x4b904a9, 0x4d904c9, 0x4ef04f9
  .long 0x765aedfb, 0xc4321098, 0x44644444, 0x44444e44, 0xc4, 0x261e04, 0xc, 0x0
  .long 0x4110401, 0x4310421, 0x4510441, 0x4710461, 0x4910481, 0x4b104a1, 0x4d104c1, 0x4ff04e1
  .long 0x76afedcb, 0x34521098, 0x55455555, 0x55555855, 0x35, 0x241805, 0x3, 0x0
  .long 0x52d051d, 0x54d053d, 0x56d055d, 0x58c057d, 0x5ad059d, 0x5cd05bd, 0x5ed05dd, 0x50f05fd
  .long 0x765fedcb, 0x943210a8, 0x55f55555, 0x55555a55, 0x95, 0x2f1a05, 0x9, 0x0
  .long 0x5290509, 0x5490539, 0x5690559, 0x5890579, 0x5a90596, 0x5c905b9, 0x5e905d9, 0x51f05f9
  .long 0x765fadeb, 0xc4321098, 0x55755555, 0x55555c55, 0xc5, 0x271c05, 0xc, 0x0
  .long 0x5110501, 0x5410531, 0x5610551, 0x5810571, 0x5a10591, 0x5c105b1, 0x5e105d1, 0x52f05f1
  .long 0x765feacd, 0xb4321098, 0x55c55555, 0x55555d55, 0xb5, 0x2c1d05, 0xb, 0x0
  .long 0x5100500, 0x5400520, 0x5600550, 0x5800570, 0x5a00590, 0x5c005b0, 0x5e005d0, 0x53f05f0
  .long 0xa65fedcb, 0x74321098, 0x55b55555, 0x55555455, 0x75, 0x2b1405, 0x7, 0x0
  .long 0x5170507, 0x5370527, 0x5670557, 0x5870577, 0x5a70597, 0x5c705b7, 0x5e705d7, 0x54f05f7
  .long 0x76afedcb, 0x84321095, 0x55f55555, 0x55555755, 0x85, 0x2f1705, 0x8, 0x0
  .long 0x5180508, 0x5380528, 0x5680548, 0x5880578, 0x5a80598, 0x5c805b8, 0x5e805d8, 0x55f05f8
  .long 0x76afedcb, 0x4325198, 0x55255555, 0x55555255, 0x5, 0x221205, 0x0, 0x0
  .long 0x51a050a, 0x53a052a, 0x55a054a, 0x58a057a, 0x5aa059a, 0x5ca05ba, 0x5ea05da, 0x56f05fa
  .long 0x765aedcb, 0xf4321098, 0x55955555, 0x55555d55, 0xf5, 0x291d05, 0xf, 0x0
  .long 0x5140504, 0x5340524, 0x5540544, 0x5840564, 0x5a40594, 0x5c405b4, 0x5e405d4, 0x57f05f4
  .long 0x76afedcb, 0x24531098, 0x55455555, 0x55555855, 0x25, 0x241805, 0x2, 0x0
  .long 0x51c050c, 0x53c052c, 0x55c054c, 0x57c056c, 0x5ac059c, 0x5cc05bc, 0x5ec05dc, 0x58f05fc
  .long 0x795fedcb, 0x643210a8, 0x55f55555, 0x55555a55, 0x65, 0x2f1a05, 0x6, 0x0
  .long 0x5160506, 0x5360526, 0x5560546, 0x5760566, 0x5a60586, 0x5c605b6, 0x5e605d6, 0x59f05f6
  .long 0x765fadcb, 0xe4321098, 0x55755555, 0x55555c55, 0xe5, 0x271c05, 0xe, 0x0
  .long 0x5130503, 0x5330521, 0x5530543, 0x5730563, 0x5930583, 0x5c305b3, 0x5e305d3, 0x5af05f3
  .long 0x765feacb, 0xd4321098, 0x55c55555, 0x55555d55, 0xd5, 0x2c1d05, 0xd, 0x0
  .long 0x5120502, 0x5300522, 0x5520542, 0x5720562, 0x5920582, 0x5c205a2, 0x5e205d2, 0x5bf05f2
  .long 0x765fedcb, 0xa4321098, 0x55b55555, 0x55555455, 0xa4, 0x2b0514, 0xa, 0x0
  .long 0xf50075, 0x6350547, 0x81506b5, 0x8950855, 0xb6508d5, 0xc290be5, 0xf050ca9, 0x5cf0f85
  .long 0x76afedcb, 0x54321098, 0x55f55555, 0x55555755, 0x5f, 0x17052f, 0x5, 0x0
  .long 0xc50045, 0x2b50235, 0x5580515, 0x8650595, 0xd2508e5, 0xdf50d75, 0xe850e05, 0x5df0fa5
  .long 0x76afedcb, 0x14325098, 0x55255555, 0x55555255, 0x15, 0x221205, 0x1, 0x0
  .long 0x51b050b, 0x53b052b, 0x55b054b, 0x57b056a, 0x59b058b, 0x5bb05ab, 0x5db05cb, 0x5ef05fb
  .long 0x76afedcb, 0x45321098, 0x55255555, 0x55555855, 0x45, 0x221805, 0x4, 0x0
  .long 0x51e050e, 0x53e052e, 0x55e054e, 0x57e056e, 0x59e058e, 0x5be05ae, 0x5de05ce, 0x5ff05ee
  .long 0x76afedcb, 0x24351098, 0x66166666, 0x66666566, 0x26, 0x211506, 0x2, 0x0
  .long 0x62c061c, 0x64c063c, 0x66c065c, 0x68c067c, 0x6ac069c, 0x6cc06bc, 0x6ec06dc, 0x60f06fc
  .long 0x765feacd, 0xb4321098, 0x66a66666, 0x66666b66, 0xb6, 0x2a1b06, 0xb, 0x0
  .long 0x6200600, 0x6400630, 0x6600650, 0x6800670, 0x6a00690, 0x6c006b0, 0x6e006d0, 0x61f06f0
  .long 0x76afedcb, 0x94321058, 0x66e66666, 0x66666366, 0x96, 0x2e1306, 0x9, 0x0
  .long 0x6190609, 0x6490639, 0x6690659, 0x6890679, 0x6a70699, 0x6c906b9, 0x6e906d9, 0x62f06f9
  .long 0x76afedcb, 0x4325198, 0x66166666, 0x66666466, 0x6, 0x211406, 0x0, 0x0
  .long 0x61a060a, 0x64a062a, 0x66a065a, 0x68a067a, 0x6aa069a, 0x6ca06ba, 0x6ea06da, 0x63f06fa
  .long 0x76afedcb, 0x84321095, 0x66566666, 0x66666966, 0x86, 0x251906, 0x8, 0x0
  .long 0x6180608, 0x6380628, 0x6680658, 0x6880678, 0x6a80698, 0x6c606b8, 0x6e806d8, 0x64f06f8
  .long 0x76afedcb, 0x45321098, 0x66066666, 0x66666566, 0x46, 0x201506, 0x4, 0x0
  .long 0x61e060e, 0x63e062e, 0x66e064e, 0x68e067e, 0x6ae069e, 0x6ce06be, 0x6ee06dd, 0x65f06fe
  .long 0x765fedcb, 0xa4321098, 0x66966666, 0x66666a66, 0xaa, 0x29061a, 0xa, 0x0
  .long 0x2850205, 0x3730345, 0x3f303c5, 0x4b50435, 0x5990519, 0x92506e3, 0xb5209a5, 0x66f0ed4
  .long 0x765aedfb, 0xc4321098, 0x66866666, 0x66666f66, 0xc6, 0x281f06, 0xc, 0x0
  .long 0x6110601, 0x6310621, 0x6510641, 0x6810661, 0x6a10691, 0x6c106b1, 0x6e106d1, 0x67f06f1
  .long 0x76afedcb, 0x54321098, 0x66166666, 0x66666566, 0x51, 0x150621, 0x5, 0x0
  .long 0x3cd034d, 0x63b060c, 0x91e06bb, 0xa2d099e, 0xb6d0aad, 0xbdc0b7e, 0xbfe0bed, 0x68f0e5d
  .long 0x765feacb, 0xd4321098, 0x66a66666, 0x66666b66, 0xd6, 0x2a1b06, 0xd, 0x0
  .long 0x6100602, 0x6320622, 0x6520642, 0x6720662, 0x6a20682, 0x6c206b2, 0x6e206d2, 0x69f06f2
  .long 0x96afedcb, 0x74321058, 0x66e66666, 0x66666366, 0x76, 0x2e1306, 0x7, 0x0
  .long 0x6170607, 0x6370627, 0x6570647, 0x6770667, 0x6970687, 0x6c706b7, 0x6e706d7, 0x6af06f7
  .long 0x76afedcb, 0x14325098, 0x66166666, 0x66666466, 0x16, 0x211406, 0x1, 0x0
  .long 0x61b060b, 0x63a062b, 0x65b064b, 0x67b066b, 0x69b068b, 0x6cb06ab, 0x6eb06db, 0x6bf06fb
  .long 0x78afedcb, 0x64321095, 0x66566666, 0x66666966, 0x66, 0x251906, 0x6, 0x0
  .long 0x6160606, 0x6360626, 0x6560646, 0x6760666, 0x6960686, 0x6b606a6, 0x6e606d6, 0x6cf06f6
  .long 0x76afedcb, 0x35421098, 0x66066666, 0x66666566, 0x36, 0x201506, 0x3, 0x0
  .long 0x61d060d, 0x63d062d, 0x65d064d, 0x67d066d, 0x69d068d, 0x6bd06ad, 0x6ed06cd, 0x6df06fd
  .long 0x765fadcb, 0xe4321098, 0x66966666, 0x66666a66, 0xe6, 0x291a06, 0xe, 0x0
  .long 0x6130603, 0x6330623, 0x6530643, 0x6730663, 0x6930683, 0x6b306a3, 0x6d306c3, 0x6ef06f3
  .long 0x765aedcb, 0xf4321098, 0x66866666, 0x66666f66, 0xf6, 0x281f06, 0xf, 0x0
  .long 0x6140604, 0x6340624, 0x6540644, 0x6710664, 0x6940684, 0x6b406a4, 0x6d406c4, 0x6ff06e4
  .long 0x765fadcb, 0xe4321098, 0x77d77777, 0x77777f77, 0xe7, 0x2d1f07, 0xe, 0x0
  .long 0x7230713, 0x7430733, 0x7630753, 0x7800773, 0x7a30793, 0x7c307b3, 0x7e307d3, 0x70f07f3
  .long 0x76afedcb, 0x4321598, 0x77277777, 0x77777177, 0x7, 0x221107, 0x0, 0x0
  .long 0x72a070a, 0x74a073a, 0x76a075a, 0x78a077a, 0x7aa079a, 0x7ca07ba, 0x7ea07da, 0x71f07fa
  .long 0x765fedcb, 0xa4321098, 0x77877777, 0x77777d77, 0xad, 0x28071d, 0xa, 0x0
  .long 0xc30043, 0x53202f1, 0x5b20574, 0x96307a1, 0xa0409e3, 0xa840a13, 0xf520a93, 0x72f0fd2
  .long 0x76afedcb, 0x24351098, 0x77077777, 0x77777677, 0x27, 0x201607, 0x2, 0x0
  .long 0x71c070c, 0x74c072c, 0x76c075c, 0x78c077c, 0x7ac079c, 0x7cc07bb, 0x7ec07dc, 0x73f07fc
  .long 0x56afedcb, 0x74321098, 0x77677777, 0x77777377, 0x77, 0x261307, 0x7, 0x0
  .long 0x7170707, 0x7370727, 0x7670757, 0x7870777, 0x7a70797, 0x7c607b7, 0x7e707d7, 0x74f07f7
  .long 0x76afedcb, 0x45321098, 0x77477777, 0x77777677, 0x47, 0x241607, 0x4, 0x0
  .long 0x71e070e, 0x73e072e, 0x76e074e, 0x78e077e, 0x7ae079e, 0x7ce07be, 0x7ee07dd, 0x75f07fe
  .long 0x765aefcb, 0xd4321098, 0x77e77777, 0x77777c77, 0xd7, 0x2e1c07, 0xd, 0x0
  .long 0x7120702, 0x7320722, 0x7520742, 0x7820772, 0x7a20792, 0x7c207b2, 0x7e207d2, 0x76f07f2
  .long 0x76afedcb, 0x94321058, 0x77c77777, 0x77777677, 0x97, 0x2c1607, 0x9, 0x0
  .long 0x7190709, 0x7390729, 0x7590749, 0x7890769, 0x7a90799, 0x7c907b9, 0x7e907d9, 0x77f07f8
  .long 0x765fadce, 0xb4321098, 0x77d77777, 0x77777f77, 0xb7, 0x2d1f07, 0xb, 0x0
  .long 0x7100700, 0x7300720, 0x7500740, 0x7700760, 0x7a00790, 0x7c007b0, 0x7e007d0, 0x78f07f0
  .long 0x76afedcb, 0x54321098, 0x77277777, 0x77777177, 0x52, 0x110722, 0x5, 0x0
  .long 0x24c020e, 0x28e027d, 0x56b02cc, 0x5fe05eb, 0xa3e071a, 0xc5e0abe, 0xdad0cde, 0x79f0f2a
  .long 0x765fedab, 0xc4321098, 0x77877777, 0x77777d77, 0xc7, 0x281d07, 0xc, 0x0
  .long 0x7110701, 0x7310721, 0x7510741, 0x7710761, 0x7910781, 0x7c107b1, 0x7e107d1, 0x7af07f1
  .long 0x76afedcb, 0x14352098, 0x77077777, 0x77777677, 0x17, 0x201607, 0x1, 0x0
  .long 0x71b070b, 0x73b072b, 0x75b074b, 0x77b076b, 0x79b078b, 0x7cb07ab, 0x7eb07db, 0x7bf07fb
  .long 0x57afedcb, 0x64321098, 0x77677777, 0x77777377, 0x67, 0x261307, 0x6, 0x0
  .long 0x7160706, 0x7360726, 0x7560746, 0x7760766, 0x7960786, 0x7b607a6, 0x7e607d6, 0x7cf07f6
  .long 0x76afedcb, 0x35421098, 0x77477777, 0x77777677, 0x37, 0x241607, 0x3, 0x0
  .long 0x71d070d, 0x73d072d, 0x75d074d, 0x77d076d, 0x79d078d, 0x7bd07ad, 0x7ed07cd, 0x7df07fd
  .long 0x765aedcb, 0xf4321098, 0x77e77777, 0x77777c77, 0xf7, 0x2e1c07, 0xf, 0x0
  .long 0x7140704, 0x7340724, 0x7540744, 0x7740762, 0x7940784, 0x7b407a4, 0x7d407c4, 0x7ef07f4
  .long 0x76afedcb, 0x84321059, 0x77c77777, 0x77777677, 0x87, 0x2c1607, 0x8, 0x0
  .long 0x7180708, 0x7380728, 0x7580748, 0x7780768, 0x7980788, 0x7b807a8, 0x7d807c8, 0x7ff07e8
  .long 0x765aedcb, 0xf4321098, 0x88e88888, 0x88888b88, 0xf8, 0x2e1b08, 0xf, 0x0
  .long 0x8240814, 0x8440834, 0x8640854, 0x8810874, 0x8a40894, 0x8c408b4, 0x8e408d4, 0x80f08f4
  .long 0x76afedcb, 0x14325098, 0x88388888, 0x88888488, 0x18, 0x231408, 0x1, 0x0
  .long 0x82b080b, 0x84b083b, 0x86b085b, 0x88b087b, 0x8ab089a, 0x8cb08bb, 0x8eb08db, 0x81f08fb
  .long 0x765fadcb, 0xe4321098, 0x88688888, 0x88888e88, 0xe8, 0x261e08, 0xe, 0x0
  .long 0x8130803, 0x8430833, 0x8630853, 0x8830873, 0x8a00893, 0x8c308b3, 0x8e308d3, 0x82f08f3
  .long 0x96afedcb, 0x74321058, 0x88788888, 0x88888888, 0x78, 0x271808, 0x7, 0x0
  .long 0x8170807, 0x8470827, 0x8670857, 0x8870877, 0x8a70897, 0x8c708b7, 0x8e708d7, 0x83f08f7
  .long 0x76afedcb, 0x34521098, 0x88488888, 0x88888788, 0x38, 0x241708, 0x3, 0x0
  .long 0x81d080d, 0x83d082d, 0x86d085d, 0x88d087d, 0x8ad089d, 0x8cd08bd, 0x8ed08dd, 0x84f08fd
  .long 0x76afedcb, 0x54321098, 0x88e88888, 0x88888488, 0x5e, 0x14082e, 0x5, 0x0
  .long 0x3750145, 0x62903f5, 0x76506a9, 0x80507e5, 0x8c50885, 0xa1508d6, 0xc350a95, 0x85f0cb5
  .long 0x765fedcb, 0x8432109a, 0x88f88888, 0x88888988, 0x88, 0x2f1908, 0x8, 0x0
  .long 0x8180808, 0x8380828, 0x8580848, 0x8880878, 0x8a80898, 0x8c808b8, 0x8e808d8, 0x86f08f8
  .long 0x76afedcb, 0x45321098, 0x88388888, 0x88888788, 0x48, 0x231708, 0x4, 0x0
  .long 0x81e080e, 0x83e082e, 0x85e084e, 0x88e086e, 0x8ae089e, 0x8ce08be, 0x8ee08de, 0x87f08fc
  .long 0x765aedfb, 0xc4321098, 0x88e88888, 0x88888b88, 0xc8, 0x2e1b08, 0xc, 0x0
  .long 0x8110801, 0x8310821, 0x8510841, 0x8710861, 0x8a10891, 0x8c108b1, 0x8e108d1, 0x88f08f1
  .long 0x76afedcb, 0x4325198, 0x88388888, 0x88888488, 0x8, 0x231408, 0x0, 0x0
  .long 0x81a080a, 0x83a082a, 0x85a084a, 0x87a086a, 0x8aa088a, 0x8ca08ba, 0x8ea08da, 0x89f08fa
  .long 0x765fadce, 0xb4321098, 0x88688888, 0x88888e88, 0xb8, 0x261e08, 0xb, 0x0
  .long 0x8100800, 0x8300820, 0x8500840, 0x8700860, 0x8900880, 0x8c008b0, 0x8e008d0, 0x8af08f0
  .long 0x76afedcb, 0x94321058, 0x88788888, 0x88888888, 0x98, 0x271808, 0x9, 0x0
  .long 0x8190809, 0x8370829, 0x8590849, 0x8790869, 0x8990889, 0x8c908a9, 0x8e908d9, 0x8bf08f9
  .long 0x765feacb, 0xd4321098, 0x88e88888, 0x88888f88, 0xd8, 0x2e1f08, 0xd, 0x0
  .long 0x8120802, 0x8320822, 0x8520842, 0x8720862, 0x8920882, 0x8b208a2, 0x8e208d2, 0x8cf08f2
  .long 0x75afedcb, 0x64321098, 0x88e88888, 0x88888488, 0x68, 0x2e1408, 0x6, 0x0
  .long 0x8160806, 0x8360826, 0x8560846, 0x8760866, 0x8960886, 0x8b608a6, 0x8e608c6, 0x8df08f6
  .long 0x765fedcb, 0xa4321098, 0x88f88888, 0x88888988, 0xa9, 0x2f0819, 0xa, 0x0
  .long 0x4880408, 0x6c50645, 0xa350868, 0xc550ab5, 0xcd50c75, 0xe250cf5, 0xf150ea5, 0x8ef0f95
  .long 0x76afedcb, 0x25341098, 0x88388888, 0x88888788, 0x28, 0x231708, 0x2, 0x0
  .long 0x81c080c, 0x83c082c, 0x85c084c, 0x87c086c, 0x89c088c, 0x8bc08ac, 0x8dc08cc, 0x8ff08ec
  .long 0x78afedcb, 0x64321095, 0x99799999, 0x99999099, 0x69, 0x271009, 0x6, 0x0
  .long 0x9260916, 0x9460936, 0x9660956, 0x9860976, 0x9a60996, 0x9c609b6, 0x9e609d6, 0x90f09f6
  .long 0x76afedcb, 0x45321098, 0x99199999, 0x99999899, 0x49, 0x211809, 0x4, 0x0
  .long 0x92e090e, 0x94e093e, 0x96e095e, 0x98e097e, 0x9ae099c, 0x9ce09be, 0x9ee09de, 0x91f09fe
  .long 0x76afedcb, 0x14325098, 0x99599999, 0x99999a99, 0x19, 0x251a09, 0x1, 0x0
  .long 0x91b090b, 0x94b093b, 0x96b095b, 0x98b097b, 0x9ab099b, 0x9cb09bb, 0x9eb09db, 0x92f09fb
  .long 0x76afedcb, 0x4521398, 0x99399999, 0x99999599, 0x9, 0x231509, 0x0, 0x0
  .long 0x91a090a, 0x94a092a, 0x96a095a, 0x98a097a, 0x9aa099a, 0x9ca09ba, 0x9ea09da, 0x93f09fa
  .long 0x765feacb, 0xd4321098, 0x99999999, 0x99999c99, 0xd9, 0x291c09, 0xd, 0x0
  .long 0x9120902, 0x9320922, 0x9620952, 0x9820972, 0x9a20992, 0x9c009b2, 0x9e209d2, 0x94f09f2
  .long 0x765aedcb, 0xf4321098, 0x99c99999, 0x99999b99, 0xf9, 0x2c1b09, 0xf, 0x0
  .long 0x9140904, 0x9340924, 0x9640944, 0x9840974, 0x9a40994, 0x9c409b4, 0x9e409d4, 0x95f09f4
  .long 0x765fadcb, 0xe4321098, 0x99599999, 0x99999d99, 0xe9, 0x251d09, 0xe, 0x0
  .long 0x9130903, 0x9330923, 0x9530943, 0x9830973, 0x9a30993, 0x9c309b3, 0x9e109d3, 0x96f09f3
  .long 0x76afedcb, 0x94321058, 0x99d99999, 0x99999599, 0x99, 0x2d1509, 0x9, 0x0
  .long 0x9190909, 0x9390929, 0x9590949, 0x9890969, 0x9a90999, 0x9c909b9, 0x9e909d9, 0x97f09f7
  .long 0x76afedcb, 0x84321095, 0x99799999, 0x99999099, 0x89, 0x271009, 0x8, 0x0
  .long 0x9180906, 0x9380928, 0x9580948, 0x9780968, 0x9a80998, 0x9c809b8, 0x9e809d8, 0x98f09f8
  .long 0x76afedcb, 0x25341098, 0x99199999, 0x99999899, 0x29, 0x211809, 0x2, 0x0
  .long 0x91c090c, 0x93c092c, 0x95c094c, 0x97c096c, 0x9ac098c, 0x9cc09bc, 0x9ec09dc, 0x99f09fc
  .long 0x76afedcb, 0x54321098, 0x99599999, 0x99999a99, 0x55, 0x1a0925, 0x5, 0x0
  .long 0x8e000e, 0x49d041d, 0x6c80648, 0x965092b, 0xb5509e5, 0xeb80e38, 0xf750ed5, 0x9af0ff5
  .long 0x76afedcb, 0x34521098, 0x99399999, 0x99999599, 0x39, 0x231509, 0x3, 0x0
  .long 0x91d090d, 0x93a092d, 0x95d094d, 0x97d096d, 0x99d098d, 0x9cd09ad, 0x9ed09dd, 0x9bf09fd
  .long 0x765feacd, 0xb4321098, 0x99999999, 0x99999c99, 0xb9, 0x291c09, 0xb, 0x0
  .long 0x9100900, 0x9300920, 0x9500940, 0x9700960, 0x9900980, 0x9b009a0, 0x9e009d0, 0x9cf09f0
  .long 0x765fedcb, 0xa4321098, 0x99c99999, 0x99999b99, 0xab, 0x2c091b, 0xa, 0x0
  .long 0x3b10331, 0x4c30443, 0x6920612, 0x8840804, 0xa610954, 0xd240ce2, 0xef30e73, 0x9df0fa3
  .long 0x765fadeb, 0xc4321098, 0x99599999, 0x99999d99, 0xc9, 0x251d09, 0xc, 0x0
  .long 0x9110901, 0x9310921, 0x9510941, 0x9710961, 0x9910981, 0x9b109a1, 0x9d109c1, 0x9ef09f1
  .long 0x96afedcb, 0x74321058, 0x99d99999, 0x99999599, 0x79, 0x2d1509, 0x7, 0x0
  .long 0x9170907, 0x9370927, 0x9570947, 0x9770967, 0x9970987, 0x9b709a7, 0x9d709c7, 0x9ff09e7
  .long 0x765aedcb, 0xf4321098, 0xaa6aaaaa, 0xaaaaadaa, 0xfa, 0x261d0a, 0xf, 0x0
  .long 0xa240a14, 0xa440a34, 0xa640a54, 0xa820a74, 0xaa40a94, 0xac40ab4, 0xae40ad4, 0xa0f0af4
  .long 0x765fadce, 0xb4321098, 0xaaeaaaaa, 0xaaaaadaa, 0xba, 0x2e1d0a, 0xb, 0x0
  .long 0xa200a00, 0xa400a30, 0xa600a50, 0xa800a70, 0xaa00a90, 0xac00ab0, 0xae00ad0, 0xa1f0af0
  .long 0x76afedcb, 0x34521098, 0xaa1aaaaa, 0xaaaaa7aa, 0x3a, 0x21170a, 0x3, 0x0
  .long 0xa1d0a0d, 0xa4d0a3d, 0xa6d0a5d, 0xa8d0a7d, 0xaac0a9d, 0xacd0abd, 0xaed0add, 0xa2f0afd
  .long 0x76afedcb, 0x45321098, 0xaa2aaaaa, 0xaaaaa9aa, 0x4a, 0x22190a, 0x4, 0x0
  .long 0xa1e0a0e, 0xa4e0a2e, 0xa6e0a5e, 0xa8e0a7e, 0xaae0a9e, 0xace0aba, 0xaee0ade, 0xa3f0afe
  .long 0x765fedcb, 0xa4321098, 0xaaaaaaaa, 0xaaaaa8aa, 0xa8, 0x2a0a18, 0xa, 0x0
  .long 0x1d50155, 0x5050275, 0x5f50585, 0x8b50835, 0x9950915, 0xda50ac5, 0xee50e65, 0xa4f0f25
  .long 0x86afedcb, 0x74321095, 0xaadaaaaa, 0xaaaaa2aa, 0x7a, 0x2d120a, 0x7, 0x0
  .long 0xa170a07, 0xa370a27, 0xa670a47, 0xa870a77, 0xaa70a97, 0xac70ab7, 0xae70ad7, 0xa5f0af7
  .long 0x765fedab, 0xc4321098, 0xaa6aaaaa, 0xaaaaabaa, 0xca, 0x261b0a, 0xc, 0x0
  .long 0xa110a01, 0xa310a21, 0xa510a41, 0xa810a71, 0xaa10a91, 0xac10ab1, 0xae10ad1, 0xa6f0af1
  .long 0x765fedcb, 0x943210a8, 0xaaaaaaaa, 0xaaaaa1aa, 0x9a, 0x2a110a, 0x9, 0x0
  .long 0xa190a09, 0xa390a29, 0xa590a49, 0xa890a69, 0xaa90a99, 0xac90ab9, 0xae90ad9, 0xa7f0af6
  .long 0x765aefcb, 0xd4321098, 0xaa6aaaaa, 0xaaaaadaa, 0xda, 0x261d0a, 0xd, 0x0
  .long 0xa120a02, 0xa320a22, 0xa520a42, 0xa720a62, 0xaa20a92, 0xac20ab2, 0xae20ad2, 0xa8f0af2
  .long 0x765fadcb, 0xe4321098, 0xaaeaaaaa, 0xaaaaadaa, 0xea, 0x2e1d0a, 0xe, 0x0
  .long 0xa100a03, 0xa330a23, 0xa530a43, 0xa730a63, 0xaa30a83, 0xac30ab3, 0xae30ad3, 0xa9f0af3
  .long 0x76afedcb, 0x24531098, 0xaa1aaaaa, 0xaaaaa7aa, 0x2a, 0x21170a, 0x2, 0x0
  .long 0xa1c0a0c, 0xa3c0a2c, 0xa5c0a4c, 0xa7c0a6c, 0xa9c0a8c, 0xacc0abc, 0xaec0adc, 0xaaf0afc
  .long 0x76afedcb, 0x5321498, 0xaa2aaaaa, 0xaaaaa9aa, 0xa, 0x22190a, 0x0, 0x0
  .long 0xa1a0a0a, 0xa3a0a2a, 0xa5a0a4a, 0xa7a0a6a, 0xa9a0a8a, 0xaca0aaa, 0xaea0ada, 0xabf0afa
  .long 0x76afedcb, 0x54321098, 0xaaaaaaaa, 0xaaaaa8aa, 0x5a, 0x180a2a, 0x5, 0x0
  .long 0x1a50125, 0x2e50265, 0x3b50335, 0x4850405, 0x6950615, 0xa750a45, 0xd550af5, 0xacf0dd5
  .long 0x76afedcb, 0x84321095, 0xaadaaaaa, 0xaaaaa2aa, 0x8a, 0x2d120a, 0x8, 0x0
  .long 0xa180a08, 0xa380a28, 0xa570a48, 0xa780a68, 0xa980a88, 0xab80aa8, 0xae80ac8, 0xadf0af8
  .long 0x76afedcb, 0x14325098, 0xaa0aaaaa, 0xaaaaa1aa, 0x1a, 0x20110a, 0x1, 0x0
  .long 0xa1b0a0b, 0xa3b0a2b, 0xa5b0a4b, 0xa7b0a6b, 0xa9b0a8b, 0xabb0aab, 0xadb0acb, 0xaef0afb
  .long 0x795fedcb, 0x643210a8, 0xaaaaaaaa, 0xaaaaa1aa, 0x6a, 0x2a110a, 0x6, 0x0
  .long 0xa160a06, 0xa360a26, 0xa560a46, 0xa760a66, 0xa960a86, 0xab60aa6, 0xad60ac6, 0xaff0ae6
  .long 0x765fedcb, 0xa4321098, 0xbb8bbbbb, 0xbbbbb7bb, 0xa7, 0x280b17, 0xa, 0x0
  .long 0x950015, 0x46501c5, 0x55504e5, 0x84505d5, 0x8f50875, 0xaa50a25, 0xf350b86, 0xb0f0fb5
  .long 0x765fedac, 0xb4321098, 0xbbdbbbbb, 0xbbbbbcbb, 0xbb, 0x2d1c0b, 0xb, 0x0
  .long 0xb200b00, 0xb400b30, 0xb600b50, 0xb800b70, 0xba00b90, 0xbc00bb0, 0xbe00bd0, 0xb1f0bf0
  .long 0x765fedcb, 0x943210a8, 0xbbcbbbbb, 0xbbbbb0bb, 0x9b, 0x2c100b, 0x9, 0x0
  .long 0xb190b09, 0xb490b39, 0xb690b59, 0xb890b79, 0xba70b99, 0xbc90bb9, 0xbe90bd9, 0xb2f0bf9
  .long 0x765afdcb, 0xe4321098, 0xbb6bbbbb, 0xbbbbbcbb, 0xeb, 0x261c0b, 0xe, 0x0
  .long 0xb130b03, 0xb430b23, 0xb630b53, 0xb830b73, 0xba30b93, 0xbc30bb3, 0xbe30bd3, 0xb3f0bf3
  .long 0x76afedcb, 0x84321095, 0xbb8bbbbb, 0xbbbbb6bb, 0x8b, 0x28160b, 0x8, 0x0
  .long 0xb180b08, 0xb380b28, 0xb680b58, 0xb880b78, 0xba80b98, 0xbc80bb8, 0xbe80bd8, 0xb4f0bf8
  .long 0x765feacb, 0xd4321098, 0xbb5bbbbb, 0xbbbbbabb, 0xdb, 0x251a0b, 0xd, 0x0
  .long 0xb120b02, 0xb320b22, 0xb620b42, 0xb820b72, 0xba20b92, 0xbc20bb2, 0xbe20bd2, 0xb5f0bf2
  .long 0x76afedcb, 0x34521098, 0xbb1bbbbb, 0xbbbbb4bb, 0x3b, 0x21140b, 0x3, 0x0
  .long 0xb1d0b0d, 0xb3d0b2d, 0xb5d0b4d, 0xb8d0b7d, 0xbad0b9d, 0xbcd0bbd, 0xbeb0bdd, 0xb6f0bfd
  .long 0x76afedcb, 0x5321498, 0xbb1bbbbb, 0xbbbbb2bb, 0xb, 0x21120b, 0x0, 0x0
  .long 0xb1a0b0a, 0xb3a0b2a, 0xb5a0b4a, 0xb8a0b6a, 0xbaa0b9a, 0xbca0bba, 0xbea0bda, 0xb7f0bfa
  .long 0x7a5fedcb, 0x64321098, 0xbb8bbbbb, 0xbbbbb7bb, 0x6b, 0x28170b, 0x6, 0x0
  .long 0xb160b06, 0xb360b26, 0xb560b46, 0xb760b66, 0xba60b96, 0xbc60bb6, 0xbe60bd6, 0xb8f0bf6
  .long 0x765fedab, 0xc4321098, 0xbbdbbbbb, 0xbbbbbcbb, 0xcb, 0x2d1c0b, 0xc, 0x0
  .long 0xb100b01, 0xb310b21, 0xb510b41, 0xb710b61, 0xba10b81, 0xbc10bb1, 0xbe10bd1, 0xb9f0bf1
  .long 0x965fedcb, 0x743210a8, 0xbbcbbbbb, 0xbbbbb0bb, 0x7b, 0x2c100b, 0x7, 0x0
  .long 0xb170b07, 0xb370b27, 0xb570b47, 0xb770b67, 0xb970b87, 0xbc70bb7, 0xbe70bd7, 0xbaf0bf7
  .long 0x765aedcb, 0xf4321098, 0xbb6bbbbb, 0xbbbbbcbb, 0xfb, 0x261c0b, 0xf, 0x0
  .long 0xb140b04, 0xb330b24, 0xb540b44, 0xb740b64, 0xb940b84, 0xbc40ba4, 0xbe40bd4, 0xbbf0bf4
  .long 0x76afedcb, 0x54321098, 0xbb8bbbbb, 0xbbbbb6bb, 0x58, 0x160b28, 0x5, 0x0
  .long 0xd50055, 0x1650135, 0x1e501b5, 0x6f50675, 0x7a50725, 0xb480b05, 0xc150b85, 0xbcf0c95
  .long 0x76afedcb, 0x24351098, 0xbb1bbbbb, 0xbbbbb3bb, 0x2b, 0x21130b, 0x2, 0x0
  .long 0xb1c0b0c, 0xb3c0b2c, 0xb5c0b4c, 0xb7c0b6c, 0xb9c0b8c, 0xbbc0bac, 0xbec0bcc, 0xbdf0bfc
  .long 0x76afedcb, 0x14523098, 0xbb1bbbbb, 0xbbbbb4bb, 0x1b, 0x21140b, 0x1, 0x0
  .long 0xb1b0b0b, 0xb3b0b2b, 0xb5b0b4b, 0xb7b0b6b, 0xb9b0b8b, 0xbbb0bab, 0xbdb0bcb, 0xbef0bfb
  .long 0x76afedcb, 0x45321098, 0xbb1bbbbb, 0xbbbbb2bb, 0x4b, 0x21120b, 0x4, 0x0
  .long 0xb1e0b0e, 0xb3e0b2e, 0xb5e0b4e, 0xb7a0b6e, 0xb9e0b8e, 0xbbe0bae, 0xbde0bce, 0xbff0bee
  .long 0x765fadce, 0xb4321098, 0xcccccccc, 0xcccccccc, 0xbc, 0x2c1c0c, 0xb, 0x0
  .long 0xc200c10, 0xc400c30, 0xc600c50, 0xc800c70, 0xca00c90, 0xcc00cb0, 0xce00cd0, 0xc0f0cf0
  .long 0x765aedfb, 0xc4321098, 0xcc8ccccc, 0xcccccfcc, 0xcc, 0x281f0c, 0xc, 0x0
  .long 0xc210c01, 0xc410c31, 0xc610c51, 0xc810c71, 0xca10c91, 0xcc10cb1, 0xce10cd1, 0xc1f0cf1
  .long 0x765fedcb, 0x843210a9, 0xccbccccc, 0xccccc4cc, 0x8c, 0x2b140c, 0x8, 0x0
  .long 0xc180c08, 0xc480c38, 0xc680c58, 0xc880c78, 0xca80c98, 0xcc80cb8, 0xce80cd8, 0xc2f0cf8
  .long 0x765fedcb, 0xa4321098, 0xcceccccc, 0xccccc1cc, 0xa1, 0x2e0c11, 0xa, 0x0
  .long 0x1a80128, 0x3570305, 0x3d70385, 0x7950715, 0xae50a79, 0xc450af9, 0xcb70c65, 0xc3f0cc5
  .long 0x76afedcb, 0x34521098, 0xcc0ccccc, 0xccccc1cc, 0x3c, 0x20110c, 0x3, 0x0
  .long 0xc1d0c0d, 0xc3d0c2d, 0xc6d0c5d, 0xc8d0c7d, 0xcad0c9d, 0xccb0cbd, 0xced0cdd, 0xc4f0cfd
  .long 0x76afedcb, 0x25341098, 0xcc2ccccc, 0xccccc9cc, 0x2c, 0x22190c, 0x2, 0x0
  .long 0xc1c0c0c, 0xc3c0c2c, 0xc6c0c4c, 0xc8c0c7c, 0xcac0c9c, 0xccc0cbc, 0xcec0cdc, 0xc5f0cfc
  .long 0x76afedcb, 0x4321598, 0xcc0ccccc, 0xccccc1cc, 0xc, 0x20110c, 0x0, 0x0
  .long 0xc1a0c0a, 0xc3a0c2a, 0xc5a0c4a, 0xc8a0c7a, 0xcaa0c9a, 0xcca0cba, 0xcea0cda, 0xc6f0cfa
  .long 0x76afedcb, 0x54321098, 0xcc7ccccc, 0xccccc9cc, 0x57, 0x190c27, 0x5, 0x0
  .long 0x990019, 0x2d50255, 0x4690445, 0x4e904c5, 0x5a50525, 0x8b90839, 0x9880908, 0xc7f0cf6
  .long 0x765fadcb, 0xe4321098, 0xcccccccc, 0xcccccccc, 0xec, 0x2c1c0c, 0xe, 0x0
  .long 0xc130c00, 0xc330c23, 0xc530c43, 0xc730c63, 0xca30c93, 0xcc30cb3, 0xce30cd3, 0xc8f0cf3
  .long 0x765aedcb, 0xf4321098, 0xcc8ccccc, 0xcccccfcc, 0xfc, 0x281f0c, 0xf, 0x0
  .long 0xc110c04, 0xc340c24, 0xc540c44, 0xc740c64, 0xca40c84, 0xcc40cb4, 0xce40cd4, 0xc9f0cf4
  .long 0x765fedcb, 0x943210a8, 0xccbccccc, 0xccccc4cc, 0x9c, 0x2b140c, 0x9, 0x0
  .long 0xc190c09, 0xc390c28, 0xc590c49, 0xc790c69, 0xc990c89, 0xcc90cb9, 0xce90cd9, 0xcaf0cf9
  .long 0xa65fedcb, 0x74321098, 0xcceccccc, 0xccccc1cc, 0x7c, 0x2e110c, 0x7, 0x0
  .long 0xc170c07, 0xc370c27, 0xc570c47, 0xc770c67, 0xc970c87, 0xcc70ca7, 0xce70cd7, 0xcbf0cf7
  .long 0x76afedcb, 0x14523098, 0xcc0ccccc, 0xccccc1cc, 0x1c, 0x20110c, 0x1, 0x0
  .long 0xc1b0c0b, 0xc3b0c2b, 0xc5b0c4b, 0xc7b0c6b, 0xc9b0c8b, 0xcbb0cab, 0xceb0cdb, 0xccf0cfb
  .long 0x76afedcb, 0x45321098, 0xcc2ccccc, 0xccccc9cc, 0x4c, 0x22190c, 0x4, 0x0
  .long 0xc1e0c0e, 0xc3e0c2e, 0xc5c0c4e, 0xc7e0c6e, 0xc9e0c8e, 0xcbe0cae, 0xcee0cce, 0xcdf0cfe
  .long 0x765feacb, 0xd4321098, 0xcc6ccccc, 0xcccccbcc, 0xdc, 0x261b0c, 0xd, 0x0
  .long 0xc120c02, 0xc320c22, 0xc520c42, 0xc720c62, 0xc920c82, 0xcb20ca2, 0xcd20cc2, 0xcef0cf2
  .long 0x75afedcb, 0x64321098, 0xcc7ccccc, 0xccccc9cc, 0x6c, 0x27190c, 0x6, 0x0
  .long 0xc160c06, 0xc360c26, 0xc560c46, 0xc760c66, 0xc960c86, 0xcb60ca6, 0xcd60cc6, 0xcff0ce6
  .long 0x76afedcb, 0x24351098, 0xdd0ddddd, 0xddddd6dd, 0x2d, 0x20160d, 0x2, 0x0
  .long 0xd2c0d1c, 0xd4c0d3c, 0xd6c0d5c, 0xd8b0d7c, 0xdac0d9c, 0xdcc0dbc, 0xdec0ddc, 0xd0f0dfc
  .long 0x56afedcb, 0x74321098, 0xdd6ddddd, 0xddddd3dd, 0x7d, 0x26130d, 0x7, 0x0
  .long 0xd270d07, 0xd470d37, 0xd670d57, 0xd870d77, 0xda70d97, 0xdc70db7, 0xde70dd7, 0xd1f0df7
  .long 0x765aedcb, 0xf4321098, 0xddfddddd, 0xdddddbdd, 0xfd, 0x2f1b0d, 0xf, 0x0
  .long 0xd140d04, 0xd440d34, 0xd640d54, 0xd840d74, 0xda40d94, 0xdc40db4, 0xde40dd4, 0xd2f0df4
  .long 0x76afedcb, 0x94321058, 0xdddddddd, 0xddddd3dd, 0x9d, 0x2d130d, 0x9, 0x0
  .long 0xd190d09, 0xd490d29, 0xd690d59, 0xd890d79, 0xda90d99, 0xdc90db6, 0xde90dd9, 0xd3f0df9
  .long 0x76afedcb, 0x45321098, 0xdd3ddddd, 0xddddd0dd, 0x4d, 0x23100d, 0x4, 0x0
  .long 0xd1e0d0e, 0xd3e0d2e, 0xd6e0d5e, 0xd8e0d7e, 0xdae0d9e, 0xdca0dbe, 0xdee0dde, 0xd4f0dfe
  .long 0x765feadb, 0xc4321098, 0xddaddddd, 0xdddddedd, 0xcd, 0x2a1e0d, 0xc, 0x0
  .long 0xd110d01, 0xd310d21, 0xd610d41, 0xd810d71, 0xda10d91, 0xdc10db1, 0xde10dd1, 0xd5f0df1
  .long 0x765fadce, 0xb4321098, 0xddbddddd, 0xdddddfdd, 0xbd, 0x2b1f0d, 0xb, 0x0
  .long 0xd100d00, 0xd300d20, 0xd500d40, 0xd800d70, 0xda00d90, 0xdc00db0, 0xde00dd0, 0xd6f0df0
  .long 0x765fedcb, 0xa4321098, 0xddfddddd, 0xddddd0dd, 0xa0, 0x2f0d10, 0xa, 0x0
  .long 0xe50065, 0x1950115, 0x2d90259, 0x9850905, 0xba90b29, 0xdc50d45, 0xe350df8, 0xd7f0eb5
  .long 0x76afedcb, 0x14352098, 0xdd0ddddd, 0xddddd6dd, 0x1d, 0x20160d, 0x1, 0x0
  .long 0xd1b0d0b, 0xd3b0d2b, 0xd5b0d4b, 0xd7b0d6b, 0xdab0d9b, 0xdcb0dbb, 0xdeb0ddb, 0xd8f0dfb
  .long 0x76afedcb, 0x54321098, 0xdd6ddddd, 0xddddd3dd, 0x56, 0x130d26, 0x5, 0x0
  .long 0x4750455, 0x4f504d5, 0x7c70747, 0x8a50825, 0xa650a05, 0xb350a85, 0xce50bb5, 0xd9f0d17
  .long 0x76afedcb, 0x34521098, 0xdd2ddddd, 0xddddd8dd, 0x3d, 0x22180d, 0x3, 0x0
  .long 0xd1d0d0d, 0xd3d0d2d, 0xd5d0d4d, 0xd7d0d6d, 0xd9d0d8d, 0xdcd0dbd, 0xded0ddd, 0xdaf0dfd
  .long 0x79afedcb, 0x64321058, 0xdddddddd, 0xddddd3dd, 0x6d, 0x2d130d, 0x6, 0x0
  .long 0xd160d06, 0xd360d26, 0xd560d46, 0xd760d66, 0xd960d86, 0xdc60da6, 0xde60dd6, 0xdbf0df6
  .long 0x76afedcb, 0x5321498, 0xdd3ddddd, 0xddddd0dd, 0xd, 0x23100d, 0x0, 0x0
  .long 0xd1a0d0a, 0xd3a0d2a, 0xd5a0d4a, 0xd7a0d6a, 0xd9a0d8a, 0xdba0daa, 0xdea0dda, 0xdcf0dfa
  .long 0x765feacb, 0xd4321098, 0xddaddddd, 0xdddddedd, 0xdd, 0x2a1e0d, 0xd, 0x0
  .long 0xd120d02, 0xd320d22, 0xd510d42, 0xd720d62, 0xd920d82, 0xdb20da2, 0xde20dc2, 0xddf0df2
  .long 0x765fadcb, 0xe4321098, 0xddbddddd, 0xdddddfdd, 0xed, 0x2b1f0d, 0xe, 0x0
  .long 0xd130d03, 0xd330d23, 0xd530d43, 0xd730d60, 0xd930d83, 0xdb30da3, 0xdd30dc3, 0xdef0df3
  .long 0x765fedcb, 0x8432109a, 0xddfddddd, 0xddddd0dd, 0x8d, 0x2f100d, 0x8, 0x0
  .long 0xd180d08, 0xd380d28, 0xd580d48, 0xd780d68, 0xd980d88, 0xdb80da8, 0xdd80dc8, 0xdff0de8
  .long 0x7a5fedcb, 0x64321098, 0xeefeeeee, 0xeeeee2ee, 0x6e, 0x2f120e, 0x6, 0x0
  .long 0xe260e16, 0xe460e36, 0xe660e56, 0xe860e76, 0xea60e96, 0xec60eb6, 0xee60ed6, 0xe0f0ef6
  .long 0x76afedcb, 0x4351298, 0xee4eeeee, 0xeeeee2ee, 0xe, 0x24120e, 0x0, 0x0
  .long 0xe2a0e0a, 0xe4a0e3a, 0xe6a0e5a, 0xe8a0e7a, 0xeaa0e9a, 0xeca0eba, 0xeea0eda, 0xe1f0efa
  .long 0x76afedcb, 0x45321098, 0xee4eeeee, 0xeeeee9ee, 0x4e, 0x24190e, 0x4, 0x0
  .long 0xe1e0e0e, 0xe4e0e3e, 0xe6e0e5e, 0xe8e0e7e, 0xeab0e9e, 0xece0ebe, 0xeee0ede, 0xe2f0efe
  .long 0x76afedcb, 0x84321095, 0xee5eeeee, 0xeeeee0ee, 0x8e, 0x25100e, 0x8, 0x0
  .long 0xe180e08, 0xe480e28, 0xe680e58, 0xe880e78, 0xea80e98, 0xec80eb7, 0xee80ed8, 0xe3f0ef8
  .long 0x765feadb, 0xc4321098, 0xeeceeeee, 0xeeeeeeee, 0xce, 0x2c1e0e, 0xc, 0x0
  .long 0xe110e01, 0xe310e21, 0xe610e51, 0xe810e71, 0xea10e91, 0xec10eb1, 0xee10ed1, 0xe4f0ef1
  .long 0x76afedcb, 0x34521098, 0xee1eeeee, 0xeeeee3ee, 0x3e, 0x21130e, 0x3, 0x0
  .long 0xe1d0e0d, 0xe3d0e2d, 0xe6d0e4d, 0xe8d0e7d, 0xead0e9d, 0xecd0ebd, 0xeed0edd, 0xe5f0efd
  .long 0x76afedcb, 0x54321098, 0xeedeeeee, 0xeeeee8ee, 0x5d, 0x180e2d, 0x5, 0x0
  .long 0xa50025, 0x7850705, 0x9f90979, 0xad80a58, 0xb950b15, 0xdb90d39, 0xf450ee9, 0xe6f0fc5
  .long 0x765fadce, 0xb4321098, 0xeebeeeee, 0xeeeeebee, 0xbe, 0x2b1b0e, 0xb, 0x0
  .long 0xe100e00, 0xe300e20, 0xe500e40, 0xe800e60, 0xea00e90, 0xec00eb0, 0xee00ed0, 0xe7f0ef0
  .long 0x765fedcb, 0xa4321098, 0xeefeeeee, 0xeeeee2ee, 0xa2, 0x2f0e12, 0xa, 0x0
  .long 0xb80038, 0x3a50325, 0x5e50565, 0xad50a55, 0xbf50b75, 0xe150e06, 0xf490e95, 0xe8f0fc9
  .long 0x76afedcb, 0x24351098, 0xee4eeeee, 0xeeeee2ee, 0x2e, 0x24120e, 0x2, 0x0
  .long 0xe1a0e0c, 0xe3c0e2c, 0xe5c0e4c, 0xe7c0e6c, 0xeac0e8c, 0xecc0ebc, 0xeec0edc, 0xe9f0efc
  .long 0x76afedcb, 0x15324098, 0xee4eeeee, 0xeeeee9ee, 0x1e, 0x24190e, 0x1, 0x0
  .long 0xe1b0e0b, 0xe3b0e2b, 0xe5b0e4b, 0xe7b0e6b, 0xe9b0e8b, 0xecb0ebb, 0xeeb0edb, 0xeaf0efb
  .long 0x86afedcb, 0x74321095, 0xee5eeeee, 0xeeeee0ee, 0x7e, 0x25100e, 0x7, 0x0
  .long 0xe170e07, 0xe370e27, 0xe570e47, 0xe770e67, 0xe970e87, 0xec70ea7, 0xee70ed7, 0xebf0ef7
  .long 0x765feacb, 0xd4321098, 0xeeceeeee, 0xeeeeeeee, 0xde, 0x2c1e0e, 0xd, 0x0
  .long 0xe120e02, 0xe320e22, 0xe520e41, 0xe720e62, 0xe920e82, 0xeb20ea2, 0xee20ed2, 0xecf0ef2
  .long 0x765aedcb, 0xf4321098, 0xee5eeeee, 0xeeeeeaee, 0xfe, 0x251a0e, 0xf, 0x0
  .long 0xe140e04, 0xe340e24, 0xe540e44, 0xe740e64, 0xe940e84, 0xeb40ea4, 0xee40ec4, 0xedf0ef4
  .long 0x76afedcb, 0x94321058, 0xeedeeeee, 0xeeeee8ee, 0x9e, 0x2d180e, 0x9, 0x0
  .long 0xe190e09, 0xe390e29, 0xe590e49, 0xe790e69, 0xe990e89, 0xeb90ea9, 0xed90ec9, 0xeef0ef9
  .long 0x765fadcb, 0xe4321098, 0xeebeeeee, 0xeeeeebee, 0xee, 0x2b1b0e, 0xe, 0x0
  .long 0xe130e03, 0xe330e23, 0xe530e43, 0xe700e63, 0xe930e83, 0xeb30ea3, 0xed30ec3, 0xeff0ee3
  .long 0x76afedcb, 0x34521098, 0xff3fffff, 0xfffff4ff, 0x3f, 0x23140f, 0x3, 0x0
  .long 0xf2d0f1d, 0xf4d0f3d, 0xf6d0f5d, 0xf8b0f7d, 0xfad0f9d, 0xfcd0fbd, 0xfed0fdd, 0xf0f0ffd
  .long 0x76afedcb, 0x25341098, 0xff0fffff, 0xfffff9ff, 0x2f, 0x20190f, 0x2, 0x0
  .long 0xf2c0f0c, 0xf4c0f3c, 0xf6c0f5c, 0xf8c0f7c, 0xfac0f9c, 0xfcc0fbc, 0xfec0fdc, 0xf1f0ffc
  .long 0x76afedcb, 0x4321598, 0xff2fffff, 0xfffff8ff, 0xf, 0x22180f, 0x0, 0x0
  .long 0xf1a0f0a, 0xf4a0f3a, 0xf6a0f5a, 0xf8a0f7a, 0xfaa0f9a, 0xfca0fba, 0xfea0fda, 0xf2f0ffa
  .long 0x86afedcb, 0x74321095, 0xffbfffff, 0xfffff7ff, 0x7f, 0x2b170f, 0x7, 0x0
  .long 0xf170f07, 0xf470f27, 0xf670f57, 0xf870f77, 0xfa70f97, 0xfc70fb7, 0xfe70fd7, 0xf3f0ff7
  .long 0x795fedcb, 0x643210a8, 0xffdfffff, 0xfffff2ff, 0x6f, 0x2d120f, 0x6, 0x0
  .long 0xf160f06, 0xf360f26, 0xf660f56, 0xf860f76, 0xfa60f96, 0xfc60fb6, 0xfe60fd6, 0xf4f0ff6
  .long 0x765feacb, 0xd4321098, 0xffbfffff, 0xfffffdff, 0xdf, 0x2b1d0f, 0xd, 0x0
  .long 0xf120f02, 0xf320f22, 0xf620f42, 0xf820f72, 0xfa20f92, 0xfc20fb2, 0xfe20fd1, 0xf5f0ff2
  .long 0x76afedcb, 0x54321098, 0xffcfffff, 0xfffff5ff, 0x5c, 0x150f2c, 0x5, 0x0
  .long 0x2950215, 0x5b50535, 0x7f90779, 0x9d50955, 0xba50b25, 0xc850c05, 0xec50e45, 0xf6f0fe5
  .long 0x765aedcf, 0xb4321098, 0xff5fffff, 0xfffffcff, 0xbf, 0x251c0f, 0xb, 0x0
  .long 0xf100f00, 0xf300f20, 0xf500f40, 0xf800f60, 0xfa00f90, 0xfc00fb0, 0xfe00fd0, 0xf7f0ff0
  .long 0x76afedcb, 0x14523098, 0xff3fffff, 0xfffff4ff, 0x1f, 0x23140f, 0x1, 0x0
  .long 0xf1b0f0b, 0xf3b0f2b, 0xf5b0f4b, 0xf7b0f6b, 0xfab0f9b, 0xfcb0fbb, 0xfeb0fdb, 0xf8f0ffb
  .long 0x76afedcb, 0x45321098, 0xff0fffff, 0xfffff9ff, 0x4f, 0x20190f, 0x4, 0x0
  .long 0xf1c0f0e, 0xf3e0f2e, 0xf5e0f4e, 0xf7e0f6e, 0xfae0f8e, 0xfce0fbe, 0xfee0fde, 0xf9f0ffe
  .long 0x765fadcb, 0xe4321098, 0xffffffff, 0xfffffbff, 0xef, 0x2f1b0f, 0xe, 0x0
  .long 0xf130f03, 0xf330f23, 0xf530f43, 0xf730f63, 0xf930f83, 0xfc30fb3, 0xfe30fd3, 0xfaf0ff3
  .long 0x76afedcb, 0x84321095, 0xffbfffff, 0xfffff7ff, 0x8f, 0x2b170f, 0x8, 0x0
  .long 0xf180f08, 0xf370f28, 0xf580f48, 0xf780f68, 0xf980f88, 0xfc80fa8, 0xfe80fd8, 0xfbf0ff8
  .long 0x765fedcb, 0x943210a8, 0xffdfffff, 0xfffff2ff, 0x9f, 0x2d120f, 0x9, 0x0
  .long 0xf190f09, 0xf390f29, 0xf590f46, 0xf790f69, 0xf990f89, 0xfb90fa9, 0xfe90fd9, 0xfcf0ff9
  .long 0x765feadb, 0xc4321098, 0xffbfffff, 0xfffffdff, 0xcf, 0x2b1d0f, 0xc, 0x0
  .long 0xf110f01, 0xf310f21, 0xf510f41, 0xf710f61, 0xf910f81, 0xfb10fa1, 0xfe10fc1, 0xfdf0ff1
  .long 0x765fedcb, 0xa4321098, 0xffcfffff, 0xfffff5ff, 0xa5, 0x2c0f15, 0xa, 0x0
  .long 0x2450225, 0x2c502a5, 0x4950415, 0x6550605, 0x6d50685, 0x9750935, 0x9f509b5, 0xfef0f65
  .long 0x765aedcb, 0xf4321098, 0xff5fffff, 0xfffffcff, 0xff, 0x251c0f, 0xf, 0x0
  .long 0xf140f04, 0xf340f24, 0xf540f44, 0xf700f64, 0xf940f84, 0xfb40fa4, 0xfd40fc4, 0xfff0fe4
L_order_end:
.section .rodata,"a"
.p2align 6
.amdhsa_kernel standalone__kv_cache_quant_pre_rope_vs_post_rope__sampling_kernel
  .amdhsa_next_free_vgpr 243
  .amdhsa_next_free_sgpr 102
  .amdhsa_accum_offset 244
  .amdhsa_group_segment_fixed_size 0
  .amdhsa_kernarg_size 112
  .amdhsa_user_sgpr_count 2
  .amdhsa_user_sgpr_kernarg_segment_ptr 1
  .amdhsa_system_sgpr_workgroup_id_x 1
.end_amdhsa_kernel
```

```asm
; @launch grid=(256,1,1) block=(320,1,1) lds=162304
.amdgcn_target "amdgcn-amd-amdhsa--gfx950"
.text
.globl standalone__kv_cache_quant_pre_rope_vs_post_rope__sampling_kernel
.p2align 12
.type L_pad,@object
L_pad:
.fill 832, 4, 0xbf810000
.p2align 8
.type standalone__kv_cache_quant_pre_rope_vs_post_rope__sampling_kernel,@function
standalone__kv_cache_quant_pre_rope_vs_post_rope__sampling_kernel:
  s_cmpk_ge_u32 s2, 0x100
  s_cbranch_scc1 L_end
  s_load_dwordx16 s[4:19], s[0:1], 0
  s_load_dwordx8 s[20:27], s[0:1], 64
  s_load_dwordx4 s[28:31], s[0:1], 96
  v_readfirstlane_b32 s40, v0
  s_lshr_b32 s42, s2, 4
  s_cmp_lg_u32 s40, 0
  s_cbranch_scc1 L_s0
  s_setprio 3
  s_getpc_b64 s[64:65]
L_pc0:
  s_and_b32 s44, s2, 56
  v_and_b32 v20, 63, v0
  v_lshl_add_u32 v1, v20, 6, s44
  v_lshlrev_b32 v1, 4, v1
  v_min_u32 v1, L_order_end-L_pc0-1028, v1
  s_bfm_b64 exec, 43, 0
  global_load_dword v2, v1, s[64:65] offset:1024
  s_mov_b64 exec, -1
  v_min_u32 v21, 47, v20
  v_add_u32 v22, 24, v21
  v_subrev_u32 v23, 24, v21
  v_min_u32 v27, v22, v23
  s_mul_i32 s44, s42, 48
  v_add_lshl_u32 v22, v21, s44, 3
  v_add_lshl_u32 v23, v27, s44, 3
  v_lshlrev_b32 v26, 3, v21
  s_and_b32 s44, s2, 7
  s_lshr_b32 s45, s2, 3
  s_mul_i32 s68, s44, 96
  s_add_u32 s68, s68, s45
  v_and_b32 v3, 15, v21
  v_lshl_add_u32 v3, s68, 4, v3
  v_and_b32 v4, 48, v21
  v_lshl_add_u32 v3, v4, 5, v3
  v_lshlrev_b32 v3, 6, v3
  s_mul_i32 s68, s44, 98304
  v_subrev_u32 v12, s68, v3
  s_and_b32 s68, s45, 3
  s_lshl4_add_u32 s44, s68, s44
  s_lshr_b32 s45, s45, 2
  s_lshl_b32 s45, s45, 8
  s_add_u32 s44, s44, s45
  v_and_b32 v4, 7, v20
  v_lshl_add_u32 v4, s44, 3, v4
  v_and_b32 v5, 24, v20
  v_lshl_add_u32 v4, v5, 6, v4
  v_and_b32 v5, 32, v20
  v_lshl_add_u32 v4, v5, 1, v4
  v_lshlrev_b32 v4, 6, v4
  s_waitcnt lgkmcnt(0)
  global_load_dwordx2 v[108:109], v22, s[4:5]
  global_load_dwordx2 v[110:111], v23, s[4:5]
  global_load_dwordx2 v[104:105], v26, s[18:19]
  global_load_dwordx2 v[106:107], v26, s[20:21]
  v_lshlrev_b32 v27, 3, v27
  s_add_u32 s68, s42, 16
  s_mul_i32 s44, s68, 384
  s_add_u32 s32, s4, s44
  s_addc_u32 s33, s5, 0
  global_load_dwordx2 v[68:69], v26, s[32:33]
  global_load_dwordx2 v[70:71], v27, s[32:33]
  global_load_dword v5, v3, s[22:23]
  global_load_dword v6, v3, s[24:25]
  global_load_dword v7, v4, s[8:9]
  global_load_dword v8, v4, s[10:11]
  global_load_dword v9, v4, s[14:15]
  global_load_dword v10, v4, s[16:17]
  global_load_dword v11, v12, s[4:5]
  v_mov_b32 v14, 0
  v_cmp_gt_u32 vcc, 24, v21
  v_mov_b32 v48, 0
  v_mov_b32 v49, 0
  v_mov_b32 v50, 0
  v_mov_b32 v51, 0
  ds_write_b128 v14, v[48:51] offset:0
  ds_write_b128 v14, v[48:51] offset:16
  s_waitcnt lgkmcnt(0)
  s_barrier
  s_mov_b32 s66, 0xffff0000
  s_mov_b32 s67, 0x3dd53b95
  v_cndmask_b32_e64 v30, 1.0, -1.0, vcc
  v_lshlrev_b32 v35, 4, v21
  v_mov_b32 v28, v35
  v_lshlrev_b32 v29, 1, v27
  v_mov_b32 v22, 0x80008000
  v_cndmask_b32 v31, v14, v22, vcc
  v_mov_b32 v38, 1
  s_mov_b32 s43, 1
  s_waitcnt vmcnt(9)
  v_lshlrev_b32 v52, 16, v104
  v_and_b32 v53, s66, v104
  v_lshlrev_b32 v54, 16, v105
  v_and_b32 v55, s66, v105
  v_lshlrev_b32 v56, 16, v106
  v_and_b32 v57, s66, v106
  v_lshlrev_b32 v58, 16, v107
  v_and_b32 v59, s66, v107
L_hr:
  v_lshlrev_b32 v76, 16, v108
  v_and_b32 v77, s66, v108
  v_lshlrev_b32 v78, 16, v109
  v_and_b32 v79, s66, v109
  v_lshlrev_b32 v80, 16, v110
  v_and_b32 v81, s66, v110
  v_lshlrev_b32 v82, 16, v111
  v_and_b32 v83, s66, v111
  v_mul_f32 v76, v76, v52
  v_mul_f32 v77, v77, v53
  v_mul_f32 v78, v78, v54
  v_mul_f32 v79, v79, v55
  v_mul_f32 v80, v80, v56
  v_mul_f32 v81, v81, v57
  v_mul_f32 v82, v82, v58
  v_mul_f32 v83, v83, v59
  v_cvt_pk_bf16_f32 v84, v76, v80
  v_cvt_pk_bf16_f32 v85, v77, v81
  v_cvt_pk_bf16_f32 v86, v78, v82
  v_cvt_pk_bf16_f32 v87, v79, v83
  v_lshlrev_b32 v76, 16, v84
  v_and_b32 v80, s66, v84
  v_lshlrev_b32 v77, 16, v85
  v_and_b32 v81, s66, v85
  v_lshlrev_b32 v78, 16, v86
  v_and_b32 v82, s66, v86
  v_lshlrev_b32 v79, 16, v87
  v_and_b32 v83, s66, v87
  v_fma_f32 v76, v80, v30, v76
  v_fma_f32 v77, v81, v30, v77
  v_fma_f32 v78, v82, v30, v78
  v_fma_f32 v79, v83, v30, v79
  v_cvt_pk_bf16_f32 v84, v76, v77
  v_cvt_pk_bf16_f32 v85, v78, v79
  v_xor_b32 v86, v31, v84
  v_xor_b32 v87, v31, v85
  v_mov_b32 v22, s43
  ds_write_b16 v28, v84 offset:512
  ds_write_b16_d16_hi v28, v84 offset:516
  ds_write_b16 v28, v85 offset:520
  ds_write_b16_d16_hi v28, v85 offset:524
  ds_write_b16 v29, v86 offset:514
  ds_write_b16_d16_hi v29, v86 offset:518
  ds_write_b16 v29, v87 offset:522
  ds_write_b16_d16_hi v29, v87 offset:526
  ds_write_b32 v14, v22 offset:16
  v_add_u32 v28, 1024, v28
  v_add_u32 v29, 1024, v29
  v_and_b32 v28, 0xfff, v28
  v_and_b32 v29, 0xfff, v29
  s_cmp_eq_u32 s43, 2
  s_cbranch_scc1 L_helper
  s_mov_b32 s43, 2
  s_waitcnt vmcnt(7) lgkmcnt(0)
  v_mov_b32 v108, v68
  v_mov_b32 v109, v69
  v_mov_b32 v110, v70
  v_mov_b32 v111, v71
  s_branch L_hr
L_s0:
  v_subrev_u32 v0, 64, v0
  s_sub_u32 s40, s40, 64
  s_and_b32 s44, s2, 7
  s_lshl_b32 s44, s44, 8
  s_bfe_u32 s41, s2, 0x10003
  s_mul_i32 s45, s41, 43
  s_add_u32 s44, s44, s45
  s_mulk_i32 s44, 768
  v_lshl_add_u32 v212, v0, 4, s44
  v_add_u32 v213, 4096, v212
  v_add_u32 v214, 8192, v212
  v_add_u32 v215, 12288, v212
  v_add_u32 v216, 16384, v212
  v_add_u32 v217, 20480, v212
  v_add_u32 v218, 24576, v212
  s_lshr_b32 s40, s40, 6
  v_lshrrev_b32 v25, 4, v0
  v_and_b32 v24, 15, v0
  v_mul_u32_u24 v20, 11, v25
  v_lshrrev_b32 v20, 5, v20
  v_mad_i32_i24 v20, v20, -3, v25
  v_lshlrev_b32 v21, 4, v24
  v_lshl_add_u32 v15, v20, 8, v21
  v_add_u32 v20, 256, v15
  v_subrev_u32 v21, 512, v15
  v_min_u32 v16, v20, v21
  v_add_u32 v20, 512, v15
  v_subrev_u32 v21, 256, v15
  v_min_u32 v17, v20, v21
  v_cmp_gt_u32 vcc, 8, v24
  v_lshlrev_b32 v23, 3, v24
  v_lshrrev_b32 v22, 1, v15
  v_add3_u32 v20, v22, v23, 64
  v_subrev_u32 v21, 384, v20
  v_min_u32 v20, v20, v21
  v_sub_u32 v20, v20, v22
  v_cndmask_b32 v240, v20, v23, vcc
  v_lshrrev_b32 v22, 1, v16
  v_add3_u32 v20, v22, v23, 64
  v_subrev_u32 v21, 384, v20
  v_min_u32 v20, v20, v21
  v_sub_u32 v20, v20, v22
  v_cndmask_b32 v241, v20, v23, vcc
  v_lshrrev_b32 v22, 1, v17
  v_add3_u32 v20, v22, v23, 64
  v_subrev_u32 v21, 384, v20
  v_min_u32 v20, v20, v21
  v_sub_u32 v20, v20, v22
  v_cndmask_b32 v242, v20, v23, vcc
  s_mul_i32 s100, s40, 24576
  s_add_u32 s100, s100, 64000
  s_mul_i32 s44, s42, 1572864
  s_mov_b32 s34, 51904512
  s_mov_b32 s35, 0x20000
  s_mov_b32 s80, 25165824
  s_mov_b32 s3, 50331648
  s_waitcnt lgkmcnt(0)
  s_add_u32 s32, s6, s44
  s_addc_u32 s33, s7, 0
  v_mov_b32 v21, s22
  v_mov_b32 v28, s24
  v_cndmask_b32 v28, v28, v21, vcc
  v_mov_b32 v21, s23
  v_mov_b32 v29, s25
  v_cndmask_b32 v29, v29, v21, vcc
  s_add_u32 m0, s100, 0
  v_lshrrev_b32 v10, 1, v212
  v_add_u32 v10, v10, v240
  v_mad_u64_u32 v[30:31], s[64:65], v10, 1, v[28:29]
  global_load_lds_dwordx4 v[30:31], off
  buffer_load_dwordx4 v[68:71], v212, s[32:35], 0 offen nt
  buffer_load_dwordx4 v[72:75], v213, s[32:35], 0 offen nt
  s_add_u32 m0, s100, 1024
  v_lshrrev_b32 v10, 1, v213
  v_add_u32 v10, v10, v241
  v_mad_u64_u32 v[30:31], s[64:65], v10, 1, v[28:29]
  global_load_lds_dwordx4 v[30:31], off
  buffer_load_dwordx4 v[76:79], v214, s[32:35], 0 offen nt
  buffer_load_dwordx4 v[80:83], v212, s[32:35], s80 offen nt
  s_add_u32 m0, s100, 2048
  v_lshrrev_b32 v10, 1, v214
  v_add_u32 v10, v10, v242
  v_mad_u64_u32 v[30:31], s[64:65], v10, 1, v[28:29]
  global_load_lds_dwordx4 v[30:31], off
  buffer_load_dwordx4 v[84:87], v213, s[32:35], s80 offen nt
  s_barrier
  s_getpc_b64 s[82:83]
L_pc1:
  s_lshl_b32 s44, s2, 6
  s_add_u32 s44, s44, L_order-L_pc1
  s_add_u32 s82, s82, s44
  s_addc_u32 s83, s83, 0
  s_load_dwordx2 s[92:93], s[82:83], 0
  s_load_dwordx2 s[96:97], s[82:83], 8
  s_mov_b32 s94, 4000000
  s_mul_i32 s44, s41, 768
  s_add_u32 s44, s44, 32256
  v_add_u32 v20, s44, v212
  v_add_u32 v21, 65280, v212
  s_mul_i32 s45, s41, 3
  v_add_u32 v22, s45, v25
  v_cmp_ge_u32 s[48:49], v22, 17
  v_cmp_ge_u32 s[50:51], v22, 1
  v_cmp_ge_u32 s[52:53], v22, 18
  v_cmp_ge_u32 s[54:55], v22, 2
  v_add_u32 v235, 94208, v21
  v_add_u32 v234, 90112, v21
  v_add_u32 v233, 86016, v21
  v_add_u32 v232, 81920, v21
  v_add_u32 v231, 77824, v21
  v_add_u32 v230, 73728, v21
  v_add_u32 v229, 69632, v21
  v_cndmask_b32_e64 v228, v20, v21, s[54:55]
  v_add_u32 v228, 65536, v228
  v_cndmask_b32_e64 v227, v20, v21, s[52:53]
  v_add_u32 v227, 61440, v227
  v_add_u32 v226, 57344, v20
  v_add_u32 v225, 53248, v20
  v_add_u32 v224, 49152, v20
  v_add_u32 v223, 45056, v20
  v_add_u32 v222, 40960, v20
  v_add_u32 v221, 36864, v20
  v_cndmask_b32_e64 v220, v212, v20, s[50:51]
  v_add_u32 v220, 32768, v220
  v_cndmask_b32_e64 v219, v212, v20, s[48:49]
  v_add_u32 v219, 28672, v219
  v_lshrrev_b32 v22, 6, v0
  v_bfe_u32 v23, v0, 4, 2
  v_mov_b32 v14, 0
  v_and_b32 v20, 2, v0
  v_lshl_add_u32 v1, v20, 5, v25
  v_and_b32 v20, 1, v0
  v_lshl_add_u32 v1, v20, 5, v1
  v_and_b32 v20, 4, v0
  v_lshl_add_u32 v1, v20, 2, v1
  v_and_b32 v20, 8, v0
  v_mad_u32_u24 v1, v20, 48, v1
  v_lshlrev_b32 v1, 2, v1
  v_add_u32 v1, 45568, v1
  v_lshl_add_u32 v21, v24, 2, v23
  v_mul_u32_u24 v20, 192, v22
  v_add_lshl_u32 v3, v20, v21, 2
  v_add_u32 v3, 64000, v3
  v_lshlrev_b32 v6, 2, v22
  v_mov_b32 v32, 0
  v_mov_b32 v34, 0
  v_mov_b32 v33, 0
  v_mov_b32 v35, 0
  s_mov_b32 s48, 0x11111111
  s_mov_b32 s49, s48
  s_mov_b32 s50, 0x22222222
  s_mov_b32 s51, s50
  s_mov_b32 s52, 0x44444444
  s_mov_b32 s53, s52
  s_mov_b32 s54, 0x88888888
  s_mov_b32 s55, s54
  s_mov_b32 s56, 0x05040100
  s_mov_b32 s57, 0x07060302
  s_mov_b32 s38, 1572864
  s_mov_b32 s39, 0x20000
  v_lshlrev_b32 v21, 8, v23
  v_add_u32 v21, s100, v21
  v_lshl_add_u32 v12, v24, 3, v21
  s_getreg_b32 s81, hwreg(HW_REG_HW_ID, 13, 2)
  s_getreg_b32 s79, hwreg(HW_REG_HW_ID, 8, 4)
  s_getreg_b32 s46, hwreg(HW_REG_XCC_ID, 0, 3)
  s_mul_i32 s46, s46, 4352
  s_add_u32 s46, s46, 8126464
  s_add_u32 s44, s46, 2048
  v_mov_b32 v11, s44
  s_and_b32 s45, s81, 2
  s_lshl_b32 s45, s45, 9
  s_lshl_b32 s44, s40, 8
  s_add_u32 s44, s44, s45
  s_add_u32 s44, s44, s46
  s_add_u32 s44, s44, s79
  s_and_b32 s81, s81, 1
  s_lshl_b32 s81, s81, 4
  s_add_u32 s44, s44, s81
  v_mov_b32 v7, s44
  s_xor_b32 s45, s45, 1024
  s_add_u32 s46, s46, s45
  v_and_b32 v8, 1, v0
  v_lshl_add_u32 v8, v8, 4, s46
  v_bfe_u32 v21, v0, 1, 2
  v_mad_u32_u24 v21, v21, 4, v22
  v_add_u32 v9, 0, v21
  v_and_b32 v9, 3, v9
  v_lshl_add_u32 v236, v9, 8, v8
  v_add_u32 v9, 1, v21
  v_and_b32 v9, 3, v9
  v_lshl_add_u32 v237, v9, 8, v8
  v_add_u32 v9, 2, v21
  v_and_b32 v9, 3, v9
  v_lshl_add_u32 v238, v9, 8, v8
  v_add_u32 v9, 3, v21
  v_and_b32 v9, 3, v9
  v_lshl_add_u32 v239, v9, 8, v8
  s_mov_b32 s78, 0xfefefeff
  v_mov_b32 v36, 0
  v_mov_b32 v37, 0
  v_mov_b32 v38, 0
  v_mov_b32 v39, 0
  v_mov_b32 v40, 0
  v_mov_b32 v41, 0
  v_mov_b32 v42, 0
  v_mov_b32 v43, 0
  v_mov_b32 v26, 0
  v_mov_b32 v27, 0
  v_mov_b32 v8, 3
  s_cmp_lt_u32 s40, 4
  s_cselect_b64 s[60:61], 1, 0
  s_getreg_b32 s58, hwreg(HW_REG_XCC_ID, 0, 1)
  s_mul_i32 s58, s58, -4
  s_add_u32 s58, s58, 2
  s_mov_b32 s91, s58
  s_mov_b32 s69, 0
  s_mov_b32 s95, 0
  buffer_load_dwordx4 v[88:91], v214, s[32:35], s80 offen nt
  s_add_u32 m0, s100, 3072
  v_lshrrev_b32 v10, 1, v215
  v_add_u32 v10, v10, v240
  v_mad_u64_u32 v[30:31], s[64:65], v10, 1, v[28:29]
  s_waitcnt vmcnt(8)
  global_load_lds_dwordx4 v[30:31], off
  s_waitcnt vmcnt(8)
  buffer_load_dwordx4 v[92:95], v215, s[32:35], 0 offen nt
  s_add_u32 m0, s100, 4096
  v_lshrrev_b32 v10, 1, v216
  v_add_u32 v10, v10, v241
  v_mad_u64_u32 v[30:31], s[64:65], v10, 1, v[28:29]
  s_waitcnt vmcnt(8)
  global_load_lds_dwordx4 v[30:31], off
  s_waitcnt vmcnt(8)
  buffer_load_dwordx4 v[96:99], v216, s[32:35], 0 offen nt
  s_mov_b32 s47, 1
  ds_read_b32 v4, v14 offset:16
L_fqz:
  s_waitcnt lgkmcnt(0)
  v_readfirstlane_b32 s46, v4
  s_cmp_ge_u32 s46, s47
  s_cbranch_scc1 L_fqz_ok
  s_cmp_eq_u32 s94, 0
  s_cbranch_scc1 L_fqz_ok
  s_sub_u32 s94, s94, 1
  ds_read_b32 v4, v14 offset:16
  s_branch L_fqz
L_fqz_ok:
  ds_read_b128 v[44:47], v15 offset:512
  ds_read_b128 v[48:51], v16 offset:512
  ds_read_b128 v[52:55], v17 offset:512
  s_add_u32 m0, s100, 5120
  v_lshrrev_b32 v10, 1, v217
  v_add_u32 v10, v10, v242
  v_mad_u64_u32 v[30:31], s[64:65], v10, 1, v[28:29]
  s_waitcnt vmcnt(8)
  global_load_lds_dwordx4 v[30:31], off
  s_waitcnt vmcnt(7)
  ds_read_b64 v[116:117], v12 offset:0
  ds_read_b64 v[118:119], v12 offset:128
  ds_read_b64 v[120:121], v12 offset:1024
  ds_read_b64 v[122:123], v12 offset:1152
  ds_read_b64 v[124:125], v12 offset:2048
  ds_read_b64 v[126:127], v12 offset:2176
  buffer_load_dwordx4 v[100:103], v217, s[32:35], 0 offen nt
L_it0:
  s_mov_b32 s47, 2
  ds_read_b32 v4, v14 offset:16
L_fq0:
  s_waitcnt lgkmcnt(0)
  v_readfirstlane_b32 s46, v4
  s_cmp_ge_u32 s46, s47
  s_cbranch_scc1 L_fq0_ok
  s_cmp_eq_u32 s94, 0
  s_cbranch_scc1 L_fq0_ok
  s_sub_u32 s94, s94, 1
  ds_read_b32 v4, v14 offset:16
  s_branch L_fq0
L_fq0_ok:
  ds_read_b128 v[56:59], v15 offset:1536
  ds_read_b128 v[60:63], v16 offset:1536
  ds_read_b128 v[64:67], v17 offset:1536
  v_perm_b32 v13, v118, v116, s56
  v_perm_b32 v118, v118, v116, s57
  v_perm_b32 v116, v119, v117, s56
  v_perm_b32 v119, v119, v117, s57
  v_dot2_f32_bf16 v22, v13, v44, 0
  v_dot2_f32_bf16 v23, v118, v45, 0
  v_dot2_f32_bf16 v24, v116, v46, 0
  v_dot2_f32_bf16 v25, v119, v47, 0
  v_cvt_f32_i32 v68, v68
  v_cvt_f32_i32 v69, v69
  v_cvt_f32_i32 v70, v70
  v_cvt_f32_i32 v71, v71
  v_pk_mul_f32 v[20:21], v[68:69], v[22:23]
  v_pk_add_f32 v[18:19], v[22:23], v[24:25]
  v_pk_fma_f32 v[20:21], v[70:71], v[24:25], v[20:21]
  v_add_f32 v18, v18, v19
  v_add_f32 v20, v20, v21
  s_add_u32 m0, s100, 6144
  v_lshrrev_b32 v10, 1, v218
  v_add_u32 v10, v10, v240
  v_mad_u64_u32 v[30:31], s[64:65], v10, 1, v[28:29]
  global_load_lds_dwordx4 v[30:31], off
  s_waitcnt vmcnt(8)
  buffer_load_dwordx4 v[104:107], v215, s[32:35], s80 offen nt
  v_perm_b32 v117, v122, v120, s56
  v_perm_b32 v122, v122, v120, s57
  v_perm_b32 v120, v123, v121, s56
  v_perm_b32 v123, v123, v121, s57
  v_dot2_f32_bf16 v22, v117, v48, 0
  v_add_f32_dpp v34, v18, v18 row_ror:8 row_mask:0xf bank_mask:0xc
  v_add_f32_dpp v34, v20, v20 row_ror:8 row_mask:0xf bank_mask:0x3
  v_dot2_f32_bf16 v23, v122, v49, 0
  v_dot2_f32_bf16 v24, v120, v50, 0
  v_dot2_f32_bf16 v25, v123, v51, 0
  v_cvt_f32_i32 v72, v72
  v_cvt_f32_i32 v73, v73
  v_cvt_f32_i32 v74, v74
  v_cvt_f32_i32 v75, v75
  v_pk_mul_f32 v[20:21], v[72:73], v[22:23]
  v_pk_add_f32 v[18:19], v[22:23], v[24:25]
  v_pk_fma_f32 v[20:21], v[74:75], v[24:25], v[20:21]
  v_add_f32 v18, v18, v19
  v_add_f32 v20, v20, v21
  s_waitcnt vmcnt(8)
  buffer_load_dwordx4 v[108:111], v216, s[32:35], s80 offen nt
  v_perm_b32 v121, v126, v124, s56
  v_perm_b32 v126, v126, v124, s57
  v_perm_b32 v124, v127, v125, s56
  v_perm_b32 v127, v127, v125, s57
  v_dot2_f32_bf16 v22, v121, v52, 0
  v_add_f32_dpp v21, v18, v18 row_ror:8 row_mask:0xf bank_mask:0xc
  v_add_f32_dpp v21, v20, v20 row_ror:8 row_mask:0xf bank_mask:0x3
  v_add_f32_dpp v20, v34, v34 row_half_mirror row_mask:0xf bank_mask:0x5
  v_dot2_f32_bf16 v23, v126, v53, 0
  v_add_f32_dpp v20, v21, v21 row_half_mirror row_mask:0xf bank_mask:0xa
  v_dot2_f32_bf16 v24, v124, v54, 0
  v_dot2_f32_bf16 v25, v127, v55, 0
  v_add_f32_dpp v20, v20, v20 quad_perm:[2,3,0,1] row_mask:0xf bank_mask:0xf
  v_cvt_f32_i32 v76, v76
  v_cvt_f32_i32 v77, v77
  v_add_f32_dpp v20, v20, v20 quad_perm:[1,0,3,2] row_mask:0xf bank_mask:0xf
  v_cndmask_b32_e64 v32, v32, v20, s[48:49]
  v_cvt_f32_i32 v78, v78
  v_cvt_f32_i32 v79, v79
  v_pk_mul_f32 v[20:21], v[76:77], v[22:23]
  v_pk_add_f32 v[18:19], v[22:23], v[24:25]
  v_pk_fma_f32 v[20:21], v[78:79], v[24:25], v[20:21]
  v_add_f32 v18, v18, v19
  v_add_f32 v20, v20, v21
  s_add_u32 m0, s100, 7168
  v_lshrrev_b32 v10, 1, v219
  v_add_u32 v10, v10, v241
  v_mad_u64_u32 v[30:31], s[64:65], v10, 1, v[28:29]
  s_waitcnt vmcnt(8)
  global_load_lds_dwordx4 v[30:31], off
  s_waitcnt vmcnt(8)
  buffer_load_dwordx4 v[112:115], v217, s[32:35], s80 offen nt
L_it1:
  s_waitcnt lgkmcnt(0)
  v_dot2_f32_bf16 v22, v13, v56, 0
  v_add_f32_dpp v34, v18, v18 row_ror:8 row_mask:0xf bank_mask:0xc
  v_add_f32_dpp v34, v20, v20 row_ror:8 row_mask:0xf bank_mask:0x3
  v_dot2_f32_bf16 v23, v118, v57, 0
  v_dot2_f32_bf16 v24, v116, v58, 0
  v_dot2_f32_bf16 v25, v119, v59, 0
  v_cvt_f32_i32 v80, v80
  v_cvt_f32_i32 v81, v81
  v_cvt_f32_i32 v82, v82
  v_cvt_f32_i32 v83, v83
  v_pk_mul_f32 v[20:21], v[80:81], v[22:23]
  v_pk_add_f32 v[18:19], v[22:23], v[24:25]
  v_pk_fma_f32 v[20:21], v[82:83], v[24:25], v[20:21]
  v_add_f32 v18, v18, v19
  v_add_f32 v20, v20, v21
  s_waitcnt vmcnt(8)
  buffer_load_dwordx4 v[68:71], v218, s[32:35], 0 offen nt
  v_dot2_f32_bf16 v22, v117, v60, 0
  v_add_f32_dpp v35, v18, v18 row_ror:8 row_mask:0xf bank_mask:0xc
  v_add_f32_dpp v35, v20, v20 row_ror:8 row_mask:0xf bank_mask:0x3
  v_dot2_f32_bf16 v23, v122, v61, 0
  v_dot2_f32_bf16 v24, v120, v62, 0
  v_dot2_f32_bf16 v25, v123, v63, 0
  v_cvt_f32_i32 v84, v84
  v_cvt_f32_i32 v85, v85
  v_cvt_f32_i32 v86, v86
  v_cvt_f32_i32 v87, v87
  v_pk_mul_f32 v[20:21], v[84:85], v[22:23]
  v_pk_add_f32 v[18:19], v[22:23], v[24:25]
  v_pk_fma_f32 v[20:21], v[86:87], v[24:25], v[20:21]
  v_add_f32 v18, v18, v19
  v_add_f32 v20, v20, v21
  s_add_u32 m0, s100, 8192
  v_lshrrev_b32 v10, 1, v220
  v_add_u32 v10, v10, v242
  v_mad_u64_u32 v[30:31], s[64:65], v10, 1, v[28:29]
  s_waitcnt vmcnt(8)
  global_load_lds_dwordx4 v[30:31], off
  s_waitcnt vmcnt(8)
  buffer_load_dwordx4 v[72:75], v219, s[32:35], 0 offen nt
  ds_read_b64 v[128:129], v12 offset:3072
  ds_read_b64 v[130:131], v12 offset:3200
  ds_read_b64 v[132:133], v12 offset:4096
  ds_read_b64 v[134:135], v12 offset:4224
  ds_read_b64 v[136:137], v12 offset:5120
  ds_read_b64 v[138:139], v12 offset:5248
  v_dot2_f32_bf16 v22, v121, v64, 0
  v_add_f32_dpp v21, v18, v18 row_ror:8 row_mask:0xf bank_mask:0xc
  v_add_f32_dpp v21, v20, v20 row_ror:8 row_mask:0xf bank_mask:0x3
  v_add_f32_dpp v20, v35, v35 row_half_mirror row_mask:0xf bank_mask:0x5
  v_dot2_f32_bf16 v23, v126, v65, 0
  v_add_f32_dpp v20, v21, v21 row_half_mirror row_mask:0xf bank_mask:0xa
  v_dot2_f32_bf16 v24, v124, v66, 0
  v_dot2_f32_bf16 v25, v127, v67, 0
  v_add_f32_dpp v20, v20, v20 quad_perm:[2,3,0,1] row_mask:0xf bank_mask:0xf
  v_cvt_f32_i32 v88, v88
  v_cvt_f32_i32 v89, v89
  v_add_f32_dpp v20, v20, v20 quad_perm:[1,0,3,2] row_mask:0xf bank_mask:0xf
  v_cndmask_b32_e64 v33, v33, v20, s[48:49]
  v_cvt_f32_i32 v90, v90
  v_cvt_f32_i32 v91, v91
  v_pk_mul_f32 v[20:21], v[88:89], v[22:23]
  v_pk_add_f32 v[18:19], v[22:23], v[24:25]
  v_pk_fma_f32 v[20:21], v[90:91], v[24:25], v[20:21]
  v_add_f32 v18, v18, v19
  v_add_f32 v20, v20, v21
  s_waitcnt vmcnt(8)
  buffer_load_dwordx4 v[76:79], v220, s[32:35], 0 offen nt
L_it2:
  s_waitcnt lgkmcnt(0)
  ds_read_b32 v4, v14 offset:24
  v_perm_b32 v125, v130, v128, s56
  v_perm_b32 v130, v130, v128, s57
  v_perm_b32 v128, v131, v129, s56
  v_perm_b32 v131, v131, v129, s57
  v_dot2_f32_bf16 v22, v125, v44, 0
  v_add_f32_dpp v35, v18, v18 row_ror:8 row_mask:0xf bank_mask:0xc
  v_add_f32_dpp v35, v20, v20 row_ror:8 row_mask:0xf bank_mask:0x3
  v_dot2_f32_bf16 v23, v130, v45, 0
  v_dot2_f32_bf16 v24, v128, v46, 0
  v_dot2_f32_bf16 v25, v131, v47, 0
  v_cvt_f32_i32 v92, v92
  v_cvt_f32_i32 v93, v93
  v_cvt_f32_i32 v94, v94
  v_cvt_f32_i32 v95, v95
  v_pk_mul_f32 v[20:21], v[92:93], v[22:23]
  v_pk_add_f32 v[18:19], v[22:23], v[24:25]
  v_pk_fma_f32 v[20:21], v[94:95], v[24:25], v[20:21]
  v_add_f32 v18, v18, v19
  v_add_f32 v20, v20, v21
  s_add_u32 m0, s100, 9216
  v_lshrrev_b32 v10, 1, v221
  v_add_u32 v10, v10, v240
  v_mad_u64_u32 v[30:31], s[64:65], v10, 1, v[28:29]
  s_waitcnt vmcnt(8)
  global_load_lds_dwordx4 v[30:31], off
  s_waitcnt vmcnt(8)
  buffer_load_dwordx4 v[80:83], v218, s[32:35], s80 offen nt
  v_perm_b32 v129, v134, v132, s56
  v_perm_b32 v134, v134, v132, s57
  v_perm_b32 v132, v135, v133, s56
  v_perm_b32 v135, v135, v133, s57
  v_dot2_f32_bf16 v22, v129, v48, 0
  v_add_f32_dpp v21, v18, v18 row_ror:8 row_mask:0xf bank_mask:0xc
  v_add_f32_dpp v21, v20, v20 row_ror:8 row_mask:0xf bank_mask:0x3
  v_add_f32_dpp v20, v34, v34 row_half_mirror row_mask:0xf bank_mask:0x5
  v_dot2_f32_bf16 v23, v134, v49, 0
  v_add_f32_dpp v20, v21, v21 row_half_mirror row_mask:0xf bank_mask:0xa
  v_dot2_f32_bf16 v24, v132, v50, 0
  v_dot2_f32_bf16 v25, v135, v51, 0
  v_add_f32_dpp v20, v20, v20 quad_perm:[2,3,0,1] row_mask:0xf bank_mask:0xf
  v_cvt_f32_i32 v96, v96
  v_cvt_f32_i32 v97, v97
  v_add_f32_dpp v20, v20, v20 quad_perm:[1,0,3,2] row_mask:0xf bank_mask:0xf
  v_cndmask_b32_e64 v32, v32, v20, s[50:51]
  v_cvt_f32_i32 v98, v98
  v_cvt_f32_i32 v99, v99
  v_pk_mul_f32 v[20:21], v[96:97], v[22:23]
  v_pk_add_f32 v[18:19], v[22:23], v[24:25]
  v_pk_fma_f32 v[20:21], v[98:99], v[24:25], v[20:21]
  v_add_f32 v18, v18, v19
  v_add_f32 v20, v20, v21
  s_waitcnt vmcnt(8)
  buffer_load_dwordx4 v[84:87], v219, s[32:35], s80 offen nt
  v_perm_b32 v133, v138, v136, s56
  v_perm_b32 v138, v138, v136, s57
  v_perm_b32 v136, v139, v137, s56
  v_perm_b32 v139, v139, v137, s57
  v_dot2_f32_bf16 v22, v133, v52, 0
  v_add_f32_dpp v34, v18, v18 row_ror:8 row_mask:0xf bank_mask:0xc
  v_add_f32_dpp v34, v20, v20 row_ror:8 row_mask:0xf bank_mask:0x3
  v_dot2_f32_bf16 v23, v138, v53, 0
  v_dot2_f32_bf16 v24, v136, v54, 0
  v_dot2_f32_bf16 v25, v139, v55, 0
  v_cvt_f32_i32 v100, v100
  v_cvt_f32_i32 v101, v101
  v_cvt_f32_i32 v102, v102
  v_cvt_f32_i32 v103, v103
  v_pk_mul_f32 v[20:21], v[100:101], v[22:23]
  v_pk_add_f32 v[18:19], v[22:23], v[24:25]
  v_pk_fma_f32 v[20:21], v[102:103], v[24:25], v[20:21]
  v_add_f32 v18, v18, v19
  v_add_f32 v20, v20, v21
  s_add_u32 m0, s100, 10240
  v_lshrrev_b32 v10, 1, v222
  v_add_u32 v10, v10, v241
  v_mad_u64_u32 v[30:31], s[64:65], v10, 1, v[28:29]
  s_waitcnt vmcnt(8)
  global_load_lds_dwordx4 v[30:31], off
  s_waitcnt vmcnt(8)
  buffer_load_dwordx4 v[88:91], v220, s[32:35], s80 offen nt
L_it3:
  s_mov_b32 s47, 1
L_fc:
  s_waitcnt lgkmcnt(0)
  v_readfirstlane_b32 s46, v4
  s_cmp_ge_u32 s46, s47
  s_cbranch_scc1 L_fc_ok
  s_cmp_eq_u32 s94, 0
  s_cbranch_scc1 L_fc_ok
  s_sub_u32 s94, s94, 1
  ds_read_b32 v4, v14 offset:24
  s_branch L_fc
L_fc_ok:
  s_add_u32 s44, s78, 0x03030303
  v_msad_u8 v9, s78, v40, 0
  v_msad_u8 v10, s44, v40, 0
  v_msad_u8 v9, s78, v41, v9
  v_msad_u8 v10, s44, v41, v10
  v_msad_u8 v9, s78, v42, v9
  v_msad_u8 v10, s44, v42, v10
  s_mov_b64 exec, 3
  global_store_byte v7, v8, s[30:31]
  global_load_dwordx3 v[40:42], v239, s[30:31] sc1
  v_sub_u32 v9, v9, v10
  v_add_u32 v8, 1, v8
  s_mov_b64 exec, -1
  v_readlane_b32 s66, v9, 0
  v_readlane_b32 s67, v9, 1
  s_add_u32 s78, s78, 0x01010101
  s_lshl1_add_u32 s69, s91, s95
  s_add_u32 s95, s66, s67
  s_mov_b32 s69, 0
  v_dot2_f32_bf16 v22, v125, v56, 0
  v_add_f32_dpp v21, v18, v18 row_ror:8 row_mask:0xf bank_mask:0xc
  v_add_f32_dpp v21, v20, v20 row_ror:8 row_mask:0xf bank_mask:0x3
  v_add_f32_dpp v20, v34, v34 row_half_mirror row_mask:0xf bank_mask:0x5
  v_dot2_f32_bf16 v23, v130, v57, 0
  v_add_f32_dpp v20, v21, v21 row_half_mirror row_mask:0xf bank_mask:0xa
  v_dot2_f32_bf16 v24, v128, v58, 0
  v_dot2_f32_bf16 v25, v131, v59, 0
  v_add_f32_dpp v20, v20, v20 quad_perm:[2,3,0,1] row_mask:0xf bank_mask:0xf
  v_cvt_f32_i32 v104, v104
  v_cvt_f32_i32 v105, v105
  v_add_f32_dpp v20, v20, v20 quad_perm:[1,0,3,2] row_mask:0xf bank_mask:0xf
  v_cndmask_b32_e64 v32, v32, v20, s[52:53]
  v_cvt_f32_i32 v106, v106
  v_cvt_f32_i32 v107, v107
  v_pk_mul_f32 v[20:21], v[104:105], v[22:23]
  v_pk_add_f32 v[18:19], v[22:23], v[24:25]
  v_pk_fma_f32 v[20:21], v[106:107], v[24:25], v[20:21]
  v_add_f32 v18, v18, v19
  v_add_f32 v20, v20, v21
  s_cmpk_gt_i32 s69, 0x31
  s_cbranch_scc1 L_p2_4
  s_cmpk_gt_i32 s69, 0xffed
  s_cbranch_scc1 L_p2_1
  s_waitcnt vmcnt(6)
L_p2_1:
  s_waitcnt vmcnt(8)
L_p2_4:
  s_waitcnt vmcnt(9)
  buffer_load_dwordx4 v[92:95], v221, s[32:35], 0 offen nt
  v_dot2_f32_bf16 v22, v129, v60, 0
  v_add_f32_dpp v21, v18, v18 row_ror:8 row_mask:0xf bank_mask:0xc
  v_add_f32_dpp v21, v20, v20 row_ror:8 row_mask:0xf bank_mask:0x3
  v_add_f32_dpp v20, v35, v35 row_half_mirror row_mask:0xf bank_mask:0x5
  v_dot2_f32_bf16 v23, v134, v61, 0
  v_add_f32_dpp v20, v21, v21 row_half_mirror row_mask:0xf bank_mask:0xa
  v_dot2_f32_bf16 v24, v132, v62, 0
  v_dot2_f32_bf16 v25, v135, v63, 0
  v_add_f32_dpp v20, v20, v20 quad_perm:[2,3,0,1] row_mask:0xf bank_mask:0xf
  v_cvt_f32_i32 v108, v108
  v_cvt_f32_i32 v109, v109
  v_add_f32_dpp v20, v20, v20 quad_perm:[1,0,3,2] row_mask:0xf bank_mask:0xf
  v_cndmask_b32_e64 v33, v33, v20, s[50:51]
  v_cvt_f32_i32 v110, v110
  v_cvt_f32_i32 v111, v111
  v_pk_mul_f32 v[20:21], v[108:109], v[22:23]
  v_pk_add_f32 v[18:19], v[22:23], v[24:25]
  v_pk_fma_f32 v[20:21], v[110:111], v[24:25], v[20:21]
  v_add_f32 v18, v18, v19
  v_add_f32 v20, v20, v21
  s_add_u32 m0, s100, 11264
  v_lshrrev_b32 v10, 1, v223
  v_add_u32 v10, v10, v242
  v_mad_u64_u32 v[30:31], s[64:65], v10, 1, v[28:29]
  global_load_lds_dwordx4 v[30:31], off
  s_cmpk_gt_i32 s69, 0x31
  s_cbranch_scc1 L_p3_4
  s_cmpk_gt_i32 s69, 0xb
  s_cbranch_scc1 L_p3_2
  s_waitcnt vmcnt(8)
L_p3_2:
  s_waitcnt vmcnt(10)
L_p3_4:
  s_waitcnt vmcnt(11)
  buffer_load_dwordx4 v[96:99], v222, s[32:35], 0 offen nt
  s_waitcnt vmcnt(11)
  ds_read_b64 v[140:141], v12 offset:6144
  ds_read_b64 v[142:143], v12 offset:6272
  ds_read_b64 v[144:145], v12 offset:7168
  ds_read_b64 v[146:147], v12 offset:7296
  ds_read_b64 v[148:149], v12 offset:8192
  ds_read_b64 v[150:151], v12 offset:8320
  v_dot2_f32_bf16 v22, v133, v64, 0
  v_add_f32_dpp v35, v18, v18 row_ror:8 row_mask:0xf bank_mask:0xc
  v_add_f32_dpp v35, v20, v20 row_ror:8 row_mask:0xf bank_mask:0x3
  v_dot2_f32_bf16 v23, v138, v65, 0
  v_dot2_f32_bf16 v24, v136, v66, 0
  v_dot2_f32_bf16 v25, v139, v67, 0
  v_cvt_f32_i32 v112, v112
  v_cvt_f32_i32 v113, v113
  v_cvt_f32_i32 v114, v114
  v_cvt_f32_i32 v115, v115
  v_pk_mul_f32 v[20:21], v[112:113], v[22:23]
  v_pk_add_f32 v[18:19], v[22:23], v[24:25]
  v_pk_fma_f32 v[20:21], v[114:115], v[24:25], v[20:21]
  v_add_f32 v18, v18, v19
  v_add_f32 v20, v20, v21
  s_cmpk_gt_i32 s69, 0x31
  s_cbranch_scc1 L_p4_4
  s_cmpk_gt_i32 s69, 0x1d
  s_cbranch_scc1 L_p4_3
  s_cmpk_gt_i32 s69, 0xffcd
  s_cbranch_scc1 L_p4_0
  s_waitcnt vmcnt(8)
L_p4_0:
  s_waitcnt vmcnt(9)
L_p4_3:
  s_waitcnt vmcnt(11)
L_p4_4:
  s_waitcnt vmcnt(12)
  buffer_load_dwordx4 v[100:103], v223, s[32:35], 0 offen nt
L_it4:
  s_waitcnt lgkmcnt(0)
  s_add_u32 s44, s78, 0x03030303
  v_msad_u8 v9, s78, v36, 0
  v_msad_u8 v10, s44, v36, 0
  v_msad_u8 v9, s78, v37, v9
  v_msad_u8 v10, s44, v37, v10
  v_msad_u8 v9, s78, v38, v9
  v_msad_u8 v10, s44, v38, v10
  s_mov_b64 exec, 3
  global_store_byte v7, v8, s[30:31]
  global_load_dwordx3 v[36:38], v236, s[30:31] sc1
  v_sub_u32 v9, v9, v10
  v_add_u32 v8, 1, v8
  s_mov_b64 exec, -1
  v_readlane_b32 s66, v9, 0
  v_readlane_b32 s67, v9, 1
  s_add_u32 s78, s78, 0x01010101
  s_lshl1_add_u32 s69, s91, s95
  s_add_u32 s95, s66, s67
  s_mov_b32 s69, 0
  v_perm_b32 v137, v142, v140, s56
  v_perm_b32 v142, v142, v140, s57
  v_perm_b32 v140, v143, v141, s56
  v_perm_b32 v143, v143, v141, s57
  v_dot2_f32_bf16 v22, v137, v44, 0
  v_add_f32_dpp v21, v18, v18 row_ror:8 row_mask:0xf bank_mask:0xc
  v_add_f32_dpp v21, v20, v20 row_ror:8 row_mask:0xf bank_mask:0x3
  v_add_f32_dpp v20, v35, v35 row_half_mirror row_mask:0xf bank_mask:0x5
  v_dot2_f32_bf16 v23, v142, v45, 0
  v_add_f32_dpp v20, v21, v21 row_half_mirror row_mask:0xf bank_mask:0xa
  v_dot2_f32_bf16 v24, v140, v46, 0
  v_dot2_f32_bf16 v25, v143, v47, 0
  v_add_f32_dpp v20, v20, v20 quad_perm:[2,3,0,1] row_mask:0xf bank_mask:0xf
  v_cvt_f32_i32 v68, v68
  v_cvt_f32_i32 v69, v69
  v_add_f32_dpp v20, v20, v20 quad_perm:[1,0,3,2] row_mask:0xf bank_mask:0xf
  v_cndmask_b32_e64 v33, v33, v20, s[52:53]
  v_cvt_f32_i32 v70, v70
  v_cvt_f32_i32 v71, v71
  v_pk_mul_f32 v[20:21], v[68:69], v[22:23]
  v_pk_add_f32 v[18:19], v[22:23], v[24:25]
  v_pk_fma_f32 v[20:21], v[70:71], v[24:25], v[20:21]
  v_add_f32 v18, v18, v19
  v_add_f32 v20, v20, v21
  s_add_u32 m0, s100, 12288
  v_lshrrev_b32 v10, 1, v224
  v_add_u32 v10, v10, v240
  v_mad_u64_u32 v[30:31], s[64:65], v10, 1, v[28:29]
  global_load_lds_dwordx4 v[30:31], off
  s_cmpk_gt_i32 s69, 0x31
  s_cbranch_scc1 L_p5_4
  s_cmpk_gt_i32 s69, 0xffed
  s_cbranch_scc1 L_p5_1
  s_waitcnt vmcnt(7)
L_p5_1:
  s_waitcnt vmcnt(10)
L_p5_4:
  s_waitcnt vmcnt(12)
  buffer_load_dwordx4 v[104:107], v221, s[32:35], s80 offen nt
  v_perm_b32 v141, v146, v144, s56
  v_perm_b32 v146, v146, v144, s57
  v_perm_b32 v144, v147, v145, s56
  v_perm_b32 v147, v147, v145, s57
  v_dot2_f32_bf16 v22, v141, v48, 0
  v_add_f32_dpp v34, v18, v18 row_ror:8 row_mask:0xf bank_mask:0xc
  v_add_f32_dpp v34, v20, v20 row_ror:8 row_mask:0xf bank_mask:0x3
  v_dot2_f32_bf16 v23, v146, v49, 0
  v_dot2_f32_bf16 v24, v144, v50, 0
  v_dot2_f32_bf16 v25, v147, v51, 0
  v_cvt_f32_i32 v72, v72
  v_cvt_f32_i32 v73, v73
  v_cvt_f32_i32 v74, v74
  v_cvt_f32_i32 v75, v75
  v_pk_mul_f32 v[20:21], v[72:73], v[22:23]
  v_pk_add_f32 v[18:19], v[22:23], v[24:25]
  v_pk_fma_f32 v[20:21], v[74:75], v[24:25], v[20:21]
  v_add_f32 v18, v18, v19
  v_add_f32 v20, v20, v21
  s_cmpk_gt_i32 s69, 0x31
  s_cbranch_scc1 L_p6_4
  s_cmpk_gt_i32 s69, 0xb
  s_cbranch_scc1 L_p6_2
  s_waitcnt vmcnt(8)
L_p6_2:
  s_waitcnt vmcnt(11)
L_p6_4:
  s_waitcnt vmcnt(13)
  buffer_load_dwordx4 v[108:111], v222, s[32:35], s80 offen nt
  v_perm_b32 v145, v150, v148, s56
  v_perm_b32 v150, v150, v148, s57
  v_perm_b32 v148, v151, v149, s56
  v_perm_b32 v151, v151, v149, s57
  v_dot2_f32_bf16 v22, v145, v52, 0
  v_add_f32_dpp v21, v18, v18 row_ror:8 row_mask:0xf bank_mask:0xc
  v_add_f32_dpp v21, v20, v20 row_ror:8 row_mask:0xf bank_mask:0x3
  v_add_f32_dpp v20, v34, v34 row_half_mirror row_mask:0xf bank_mask:0x5
  v_dot2_f32_bf16 v23, v150, v53, 0
  v_add_f32_dpp v20, v21, v21 row_half_mirror row_mask:0xf bank_mask:0xa
  v_dot2_f32_bf16 v24, v148, v54, 0
  v_dot2_f32_bf16 v25, v151, v55, 0
  v_add_f32_dpp v20, v20, v20 quad_perm:[2,3,0,1] row_mask:0xf bank_mask:0xf
  v_cvt_f32_i32 v76, v76
  v_cvt_f32_i32 v77, v77
  v_add_f32_dpp v20, v20, v20 quad_perm:[1,0,3,2] row_mask:0xf bank_mask:0xf
  v_cndmask_b32_e64 v32, v32, v20, s[54:55]
  ds_write_b32 v1, v32 offset:0
  v_cvt_f32_i32 v78, v78
  v_cvt_f32_i32 v79, v79
  v_pk_mul_f32 v[20:21], v[76:77], v[22:23]
  v_pk_add_f32 v[18:19], v[22:23], v[24:25]
  v_pk_fma_f32 v[20:21], v[78:79], v[24:25], v[20:21]
  v_add_f32 v18, v18, v19
  v_add_f32 v20, v20, v21
  s_add_u32 m0, s100, 13312
  v_lshrrev_b32 v10, 1, v225
  v_add_u32 v10, v10, v241
  v_mad_u64_u32 v[30:31], s[64:65], v10, 1, v[28:29]
  global_load_lds_dwordx4 v[30:31], off
  s_cmpk_gt_i32 s69, 0x31
  s_cbranch_scc1 L_p7_4
  s_cmpk_gt_i32 s69, 0x1d
  s_cbranch_scc1 L_p7_3
  s_cmpk_gt_i32 s69, 0xffcd
  s_cbranch_scc1 L_p7_0
  s_waitcnt vmcnt(8)
L_p7_0:
  s_waitcnt vmcnt(10)
L_p7_3:
  s_waitcnt vmcnt(13)
L_p7_4:
  s_waitcnt vmcnt(15)
  buffer_load_dwordx4 v[112:115], v223, s[32:35], s80 offen nt
L_it5:
  s_waitcnt lgkmcnt(0)
  s_waitcnt vmcnt(10)
  s_add_u32 s44, s78, 0x03030303
  v_msad_u8 v9, s78, v40, 0
  v_msad_u8 v10, s44, v40, 0
  v_msad_u8 v9, s78, v41, v9
  v_msad_u8 v10, s44, v41, v10
  v_msad_u8 v9, s78, v42, v9
  v_msad_u8 v10, s44, v42, v10
  s_mov_b64 exec, 3
  global_load_dwordx2 v[26:27], v11, s[30:31] sc1
  global_store_byte v7, v8, s[30:31]
  global_load_dwordx3 v[40:42], v237, s[30:31] sc1
  v_sub_u32 v9, v9, v10
  v_add_u32 v8, 1, v8
  s_mov_b64 exec, -1
  v_readlane_b32 s66, v9, 0
  v_readlane_b32 s67, v9, 1
  s_add_u32 s78, s78, 0x01010101
  s_lshl1_add_u32 s69, s91, s95
  s_add_u32 s95, s66, s67
  s_add_u32 s69, s69, s95
  v_dot2_f32_bf16 v22, v137, v56, 0
  v_add_f32_dpp v34, v18, v18 row_ror:8 row_mask:0xf bank_mask:0xc
  v_add_f32_dpp v34, v20, v20 row_ror:8 row_mask:0xf bank_mask:0x3
  v_dot2_f32_bf16 v23, v142, v57, 0
  v_dot2_f32_bf16 v24, v140, v58, 0
  v_dot2_f32_bf16 v25, v143, v59, 0
  v_cvt_f32_i32 v80, v80
  v_cvt_f32_i32 v81, v81
  v_cvt_f32_i32 v82, v82
  v_cvt_f32_i32 v83, v83
  v_pk_mul_f32 v[20:21], v[80:81], v[22:23]
  v_pk_add_f32 v[18:19], v[22:23], v[24:25]
  v_pk_fma_f32 v[20:21], v[82:83], v[24:25], v[20:21]
  v_add_f32 v18, v18, v19
  v_add_f32 v20, v20, v21
  s_cmpk_gt_i32 s69, 0x31
  s_cbranch_scc1 L_p8_4
  s_cmpk_gt_i32 s69, 0xffed
  s_cbranch_scc1 L_p8_1
  s_waitcnt vmcnt(7)
L_p8_1:
  s_waitcnt vmcnt(11)
L_p8_4:
  s_waitcnt vmcnt(12)
  buffer_load_dwordx4 v[68:71], v224, s[32:35], 0 offen nt
  v_dot2_f32_bf16 v22, v141, v60, 0
  v_add_f32_dpp v35, v18, v18 row_ror:8 row_mask:0xf bank_mask:0xc
  v_add_f32_dpp v35, v20, v20 row_ror:8 row_mask:0xf bank_mask:0x3
  v_dot2_f32_bf16 v23, v146, v61, 0
  v_dot2_f32_bf16 v24, v144, v62, 0
  v_dot2_f32_bf16 v25, v147, v63, 0
  v_cvt_f32_i32 v84, v84
  v_cvt_f32_i32 v85, v85
  v_cvt_f32_i32 v86, v86
  v_cvt_f32_i32 v87, v87
  v_pk_mul_f32 v[20:21], v[84:85], v[22:23]
  v_pk_add_f32 v[18:19], v[22:23], v[24:25]
  v_pk_fma_f32 v[20:21], v[86:87], v[24:25], v[20:21]
  v_add_f32 v18, v18, v19
  v_add_f32 v20, v20, v21
  s_add_u32 m0, s100, 14336
  v_lshrrev_b32 v10, 1, v226
  v_add_u32 v10, v10, v242
  v_mad_u64_u32 v[30:31], s[64:65], v10, 1, v[28:29]
  global_load_lds_dwordx4 v[30:31], off
  s_cmpk_gt_i32 s69, 0x31
  s_cbranch_scc1 L_p9_4
  s_cmpk_gt_i32 s69, 0xb
  s_cbranch_scc1 L_p9_2
  s_waitcnt vmcnt(9)
L_p9_2:
  s_waitcnt vmcnt(13)
L_p9_4:
  s_waitcnt vmcnt(14)
  buffer_load_dwordx4 v[72:75], v225, s[32:35], 0 offen nt
  s_waitcnt vmcnt(13)
  ds_read_b64 v[152:153], v12 offset:9216
  ds_read_b64 v[154:155], v12 offset:9344
  ds_read_b64 v[156:157], v12 offset:10240
  ds_read_b64 v[158:159], v12 offset:10368
  ds_read_b64 v[160:161], v12 offset:11264
  ds_read_b64 v[162:163], v12 offset:11392
  v_dot2_f32_bf16 v22, v145, v64, 0
  v_add_f32_dpp v21, v18, v18 row_ror:8 row_mask:0xf bank_mask:0xc
  v_add_f32_dpp v21, v20, v20 row_ror:8 row_mask:0xf bank_mask:0x3
  v_add_f32_dpp v20, v35, v35 row_half_mirror row_mask:0xf bank_mask:0x5
  v_dot2_f32_bf16 v23, v150, v65, 0
  v_add_f32_dpp v20, v21, v21 row_half_mirror row_mask:0xf bank_mask:0xa
  v_dot2_f32_bf16 v24, v148, v66, 0
  v_dot2_f32_bf16 v25, v151, v67, 0
  v_add_f32_dpp v20, v20, v20 quad_perm:[2,3,0,1] row_mask:0xf bank_mask:0xf
  v_cvt_f32_i32 v88, v88
  v_cvt_f32_i32 v89, v89
  v_add_f32_dpp v20, v20, v20 quad_perm:[1,0,3,2] row_mask:0xf bank_mask:0xf
  v_cndmask_b32_e64 v33, v33, v20, s[54:55]
  ds_write_b32 v1, v33 offset:3072
  v_cvt_f32_i32 v90, v90
  v_cvt_f32_i32 v91, v91
  v_pk_mul_f32 v[20:21], v[88:89], v[22:23]
  v_pk_add_f32 v[18:19], v[22:23], v[24:25]
  v_pk_fma_f32 v[20:21], v[90:91], v[24:25], v[20:21]
  v_add_f32 v18, v18, v19
  v_add_f32 v20, v20, v21
  s_cmpk_gt_i32 s69, 0x31
  s_cbranch_scc1 L_p10_4
  s_cmpk_gt_i32 s69, 0x1d
  s_cbranch_scc1 L_p10_3
  s_cmpk_gt_i32 s69, 0xffcd
  s_cbranch_scc1 L_p10_0
  s_waitcnt vmcnt(9)
L_p10_0:
  s_waitcnt vmcnt(10)
L_p10_3:
  s_waitcnt vmcnt(14)
L_p10_4:
  s_waitcnt vmcnt(15)
  buffer_load_dwordx4 v[76:79], v226, s[32:35], 0 offen nt
L_it6:
  s_waitcnt lgkmcnt(0)
  s_waitcnt vmcnt(11)
  s_add_u32 s44, s78, 0x03030303
  v_msad_u8 v9, s78, v36, 0
  v_msad_u8 v10, s44, v36, 0
  v_msad_u8 v9, s78, v37, v9
  v_msad_u8 v10, s44, v37, v10
  v_msad_u8 v9, s78, v38, v9
  v_msad_u8 v10, s44, v38, v10
  s_mov_b64 exec, 3
  global_store_byte v7, v8, s[30:31]
  global_load_dwordx3 v[36:38], v238, s[30:31] sc1
  v_sub_u32 v9, v9, v10
  v_add_u32 v8, 1, v8
  s_mov_b64 exec, -1
  v_readlane_b32 s66, v9, 0
  v_readlane_b32 s67, v9, 1
  s_add_u32 s78, s78, 0x01010101
  s_lshl1_add_u32 s69, s91, s95
  s_add_u32 s95, s66, s67
  s_add_u32 s69, s69, s95
  v_perm_b32 v149, v154, v152, s56
  v_perm_b32 v154, v154, v152, s57
  v_perm_b32 v152, v155, v153, s56
  v_perm_b32 v155, v155, v153, s57
  v_dot2_f32_bf16 v22, v149, v44, 0
  v_add_f32_dpp v35, v18, v18 row_ror:8 row_mask:0xf bank_mask:0xc
  v_add_f32_dpp v35, v20, v20 row_ror:8 row_mask:0xf bank_mask:0x3
  v_dot2_f32_bf16 v23, v154, v45, 0
  v_dot2_f32_bf16 v24, v152, v46, 0
  v_dot2_f32_bf16 v25, v155, v47, 0
  v_cvt_f32_i32 v92, v92
  v_cvt_f32_i32 v93, v93
  v_cvt_f32_i32 v94, v94
  v_cvt_f32_i32 v95, v95
  v_pk_mul_f32 v[20:21], v[92:93], v[22:23]
  v_pk_add_f32 v[18:19], v[22:23], v[24:25]
  v_pk_fma_f32 v[20:21], v[94:95], v[24:25], v[20:21]
  v_add_f32 v18, v18, v19
  v_add_f32 v20, v20, v21
  s_add_u32 m0, s100, 15360
  v_lshrrev_b32 v10, 1, v227
  v_add_u32 v10, v10, v240
  v_mad_u64_u32 v[30:31], s[64:65], v10, 1, v[28:29]
  global_load_lds_dwordx4 v[30:31], off
  s_cmpk_gt_i32 s69, 0x31
  s_cbranch_scc1 L_p11_4
  s_cmpk_gt_i32 s69, 0xffed
  s_cbranch_scc1 L_p11_1
  s_waitcnt vmcnt(7)
L_p11_1:
  s_waitcnt vmcnt(11)
L_p11_4:
  s_waitcnt vmcnt(13)
  buffer_load_dwordx4 v[80:83], v224, s[32:35], s80 offen nt
  v_perm_b32 v153, v158, v156, s56
  v_perm_b32 v158, v158, v156, s57
  v_perm_b32 v156, v159, v157, s56
  v_perm_b32 v159, v159, v157, s57
  v_dot2_f32_bf16 v22, v153, v48, 0
  v_add_f32_dpp v21, v18, v18 row_ror:8 row_mask:0xf bank_mask:0xc
  v_add_f32_dpp v21, v20, v20 row_ror:8 row_mask:0xf bank_mask:0x3
  v_add_f32_dpp v20, v34, v34 row_half_mirror row_mask:0xf bank_mask:0x5
  v_dot2_f32_bf16 v23, v158, v49, 0
  v_add_f32_dpp v20, v21, v21 row_half_mirror row_mask:0xf bank_mask:0xa
  v_dot2_f32_bf16 v24, v156, v50, 0
  v_dot2_f32_bf16 v25, v159, v51, 0
  v_add_f32_dpp v20, v20, v20 quad_perm:[2,3,0,1] row_mask:0xf bank_mask:0xf
  v_cvt_f32_i32 v96, v96
  v_cvt_f32_i32 v97, v97
  v_add_f32_dpp v20, v20, v20 quad_perm:[1,0,3,2] row_mask:0xf bank_mask:0xf
  v_cndmask_b32_e64 v32, v32, v20, s[48:49]
  v_cvt_f32_i32 v98, v98
  v_cvt_f32_i32 v99, v99
  v_pk_mul_f32 v[20:21], v[96:97], v[22:23]
  v_pk_add_f32 v[18:19], v[22:23], v[24:25]
  v_pk_fma_f32 v[20:21], v[98:99], v[24:25], v[20:21]
  v_add_f32 v18, v18, v19
  v_add_f32 v20, v20, v21
  s_cmpk_gt_i32 s69, 0x31
  s_cbranch_scc1 L_p12_4
  s_cmpk_gt_i32 s69, 0xb
  s_cbranch_scc1 L_p12_2
  s_waitcnt vmcnt(8)
L_p12_2:
  s_waitcnt vmcnt(12)
L_p12_4:
  s_waitcnt vmcnt(14)
  buffer_load_dwordx4 v[84:87], v225, s[32:35], s80 offen nt
  v_perm_b32 v157, v162, v160, s56
  v_perm_b32 v162, v162, v160, s57
  v_perm_b32 v160, v163, v161, s56
  v_perm_b32 v163, v163, v161, s57
  v_dot2_f32_bf16 v22, v157, v52, 0
  v_add_f32_dpp v34, v18, v18 row_ror:8 row_mask:0xf bank_mask:0xc
  v_add_f32_dpp v34, v20, v20 row_ror:8 row_mask:0xf bank_mask:0x3
  v_dot2_f32_bf16 v23, v162, v53, 0
  v_dot2_f32_bf16 v24, v160, v54, 0
  v_dot2_f32_bf16 v25, v163, v55, 0
  v_cvt_f32_i32 v100, v100
  v_cvt_f32_i32 v101, v101
  v_cvt_f32_i32 v102, v102
  v_cvt_f32_i32 v103, v103
  v_pk_mul_f32 v[20:21], v[100:101], v[22:23]
  v_pk_add_f32 v[18:19], v[22:23], v[24:25]
  v_pk_fma_f32 v[20:21], v[102:103], v[24:25], v[20:21]
  v_add_f32 v18, v18, v19
  v_add_f32 v20, v20, v21
  s_add_u32 m0, s100, 16384
  v_lshrrev_b32 v10, 1, v228
  v_add_u32 v10, v10, v241
  v_mad_u64_u32 v[30:31], s[64:65], v10, 1, v[28:29]
  global_load_lds_dwordx4 v[30:31], off
  s_cmpk_gt_i32 s69, 0x31
  s_cbranch_scc1 L_p13_4
  s_cmpk_gt_i32 s69, 0x1d
  s_cbranch_scc1 L_p13_3
  s_cmpk_gt_i32 s69, 0xffcd
  s_cbranch_scc1 L_p13_0
  s_waitcnt vmcnt(8)
L_p13_0:
  s_waitcnt vmcnt(10)
L_p13_3:
  s_waitcnt vmcnt(14)
L_p13_4:
  s_waitcnt vmcnt(16)
  buffer_load_dwordx4 v[88:91], v226, s[32:35], s80 offen nt
L_it7:
  s_waitcnt lgkmcnt(0)
  s_waitcnt vmcnt(10)
  s_add_u32 s44, s78, 0x03030303
  v_msad_u8 v9, s78, v40, 0
  v_msad_u8 v10, s44, v40, 0
  v_msad_u8 v9, s78, v41, v9
  v_msad_u8 v10, s44, v41, v10
  v_msad_u8 v9, s78, v42, v9
  v_msad_u8 v10, s44, v42, v10
  s_mov_b64 exec, 3
  global_store_byte v7, v8, s[30:31]
  global_load_dwordx3 v[40:42], v239, s[30:31] sc1
  v_sub_u32 v9, v9, v10
  v_add3_u32 v10, v26, v27, s58
  v_add_u32 v8, 1, v8
  s_mov_b64 exec, -1
  v_readlane_b32 s66, v9, 0
  v_readlane_b32 s67, v9, 1
  v_readlane_b32 s91, v10, 0
  s_add_u32 s78, s78, 0x01010101
  s_lshl1_add_u32 s69, s91, s95
  s_add_u32 s95, s66, s67
  s_add_u32 s69, s69, s95
  v_dot2_f32_bf16 v22, v149, v56, 0
  v_add_f32_dpp v21, v18, v18 row_ror:8 row_mask:0xf bank_mask:0xc
  v_add_f32_dpp v21, v20, v20 row_ror:8 row_mask:0xf bank_mask:0x3
  v_add_f32_dpp v20, v34, v34 row_half_mirror row_mask:0xf bank_mask:0x5
  v_dot2_f32_bf16 v23, v154, v57, 0
  v_add_f32_dpp v20, v21, v21 row_half_mirror row_mask:0xf bank_mask:0xa
  v_dot2_f32_bf16 v24, v152, v58, 0
  v_dot2_f32_bf16 v25, v155, v59, 0
  v_add_f32_dpp v20, v20, v20 quad_perm:[2,3,0,1] row_mask:0xf bank_mask:0xf
  v_cvt_f32_i32 v104, v104
  v_cvt_f32_i32 v105, v105
  v_add_f32_dpp v20, v20, v20 quad_perm:[1,0,3,2] row_mask:0xf bank_mask:0xf
  v_cndmask_b32_e64 v32, v32, v20, s[50:51]
  v_cvt_f32_i32 v106, v106
  v_cvt_f32_i32 v107, v107
  v_pk_mul_f32 v[20:21], v[104:105], v[22:23]
  v_pk_add_f32 v[18:19], v[22:23], v[24:25]
  v_pk_fma_f32 v[20:21], v[106:107], v[24:25], v[20:21]
  v_add_f32 v18, v18, v19
  v_add_f32 v20, v20, v21
  s_cmpk_gt_i32 s69, 0x31
  s_cbranch_scc1 L_p14_4
  s_cmpk_gt_i32 s69, 0xffed
  s_cbranch_scc1 L_p14_1
  s_waitcnt vmcnt(6)
L_p14_1:
  s_waitcnt vmcnt(10)
L_p14_4:
  s_waitcnt vmcnt(11)
  buffer_load_dwordx4 v[92:95], v227, s[32:35], 0 offen nt
  v_dot2_f32_bf16 v22, v153, v60, 0
  v_add_f32_dpp v21, v18, v18 row_ror:8 row_mask:0xf bank_mask:0xc
  v_add_f32_dpp v21, v20, v20 row_ror:8 row_mask:0xf bank_mask:0x3
  v_add_f32_dpp v20, v35, v35 row_half_mirror row_mask:0xf bank_mask:0x5
  v_dot2_f32_bf16 v23, v158, v61, 0
  v_add_f32_dpp v20, v21, v21 row_half_mirror row_mask:0xf bank_mask:0xa
  v_dot2_f32_bf16 v24, v156, v62, 0
  v_dot2_f32_bf16 v25, v159, v63, 0
  v_add_f32_dpp v20, v20, v20 quad_perm:[2,3,0,1] row_mask:0xf bank_mask:0xf
  v_cvt_f32_i32 v108, v108
  v_cvt_f32_i32 v109, v109
  v_add_f32_dpp v20, v20, v20 quad_perm:[1,0,3,2] row_mask:0xf bank_mask:0xf
  v_cndmask_b32_e64 v33, v33, v20, s[48:49]
  v_cvt_f32_i32 v110, v110
  v_cvt_f32_i32 v111, v111
  v_pk_mul_f32 v[20:21], v[108:109], v[22:23]
  v_pk_add_f32 v[18:19], v[22:23], v[24:25]
  v_pk_fma_f32 v[20:21], v[110:111], v[24:25], v[20:21]
  v_add_f32 v18, v18, v19
  v_add_f32 v20, v20, v21
  s_add_u32 m0, s100, 17408
  v_lshrrev_b32 v10, 1, v229
  v_add_u32 v10, v10, v242
  v_mad_u64_u32 v[30:31], s[64:65], v10, 1, v[28:29]
  global_load_lds_dwordx4 v[30:31], off
  s_cmpk_gt_i32 s69, 0x31
  s_cbranch_scc1 L_p15_4
  s_cmpk_gt_i32 s69, 0xb
  s_cbranch_scc1 L_p15_2
  s_waitcnt vmcnt(8)
L_p15_2:
  s_waitcnt vmcnt(12)
L_p15_4:
  s_waitcnt vmcnt(13)
  buffer_load_dwordx4 v[96:99], v228, s[32:35], 0 offen nt
  s_waitcnt vmcnt(12)
  ds_read_b64 v[164:165], v12 offset:12288
  ds_read_b64 v[166:167], v12 offset:12416
  ds_read_b64 v[168:169], v12 offset:13312
  ds_read_b64 v[170:171], v12 offset:13440
  ds_read_b64 v[172:173], v12 offset:14336
  ds_read_b64 v[174:175], v12 offset:14464
  v_dot2_f32_bf16 v22, v157, v64, 0
  v_add_f32_dpp v35, v18, v18 row_ror:8 row_mask:0xf bank_mask:0xc
  v_add_f32_dpp v35, v20, v20 row_ror:8 row_mask:0xf bank_mask:0x3
  v_dot2_f32_bf16 v23, v162, v65, 0
  v_dot2_f32_bf16 v24, v160, v66, 0
  v_dot2_f32_bf16 v25, v163, v67, 0
  v_cvt_f32_i32 v112, v112
  v_cvt_f32_i32 v113, v113
  v_cvt_f32_i32 v114, v114
  v_cvt_f32_i32 v115, v115
  v_pk_mul_f32 v[20:21], v[112:113], v[22:23]
  v_pk_add_f32 v[18:19], v[22:23], v[24:25]
  v_pk_fma_f32 v[20:21], v[114:115], v[24:25], v[20:21]
  v_add_f32 v18, v18, v19
  v_add_f32 v20, v20, v21
  s_cmpk_gt_i32 s69, 0x31
  s_cbranch_scc1 L_p16_4
  s_cmpk_gt_i32 s69, 0x1d
  s_cbranch_scc1 L_p16_3
  s_cmpk_gt_i32 s69, 0xffcd
  s_cbranch_scc1 L_p16_0
  s_waitcnt vmcnt(8)
L_p16_0:
  s_waitcnt vmcnt(9)
L_p16_3:
  s_waitcnt vmcnt(13)
L_p16_4:
  s_waitcnt vmcnt(14)
  buffer_load_dwordx4 v[100:103], v229, s[32:35], 0 offen nt
  v_mov_b32 v9, 1
  ds_write_b32 v6, v9 offset:0
L_it8:
  s_waitcnt lgkmcnt(0)
  s_waitcnt vmcnt(10)
  s_add_u32 s44, s78, 0x03030303
  v_msad_u8 v9, s78, v36, 0
  v_msad_u8 v10, s44, v36, 0
  v_msad_u8 v9, s78, v37, v9
  v_msad_u8 v10, s44, v37, v10
  v_msad_u8 v9, s78, v38, v9
  v_msad_u8 v10, s44, v38, v10
  s_mov_b64 exec, 3
  global_store_byte v7, v8, s[30:31]
  global_load_dwordx3 v[36:38], v236, s[30:31] sc1
  v_sub_u32 v9, v9, v10
  v_add_u32 v8, 1, v8
  s_mov_b64 exec, -1
  v_readlane_b32 s66, v9, 0
  v_readlane_b32 s67, v9, 1
  s_add_u32 s78, s78, 0x01010101
  s_lshl1_add_u32 s69, s91, s95
  s_add_u32 s95, s66, s67
  s_add_u32 s69, s69, s95
  v_perm_b32 v161, v166, v164, s56
  v_perm_b32 v166, v166, v164, s57
  v_perm_b32 v164, v167, v165, s56
  v_perm_b32 v167, v167, v165, s57
  v_dot2_f32_bf16 v22, v161, v44, 0
  v_add_f32_dpp v21, v18, v18 row_ror:8 row_mask:0xf bank_mask:0xc
  v_add_f32_dpp v21, v20, v20 row_ror:8 row_mask:0xf bank_mask:0x3
  v_add_f32_dpp v20, v35, v35 row_half_mirror row_mask:0xf bank_mask:0x5
  v_dot2_f32_bf16 v23, v166, v45, 0
  v_add_f32_dpp v20, v21, v21 row_half_mirror row_mask:0xf bank_mask:0xa
  v_dot2_f32_bf16 v24, v164, v46, 0
  v_dot2_f32_bf16 v25, v167, v47, 0
  v_add_f32_dpp v20, v20, v20 quad_perm:[2,3,0,1] row_mask:0xf bank_mask:0xf
  v_cvt_f32_i32 v68, v68
  v_cvt_f32_i32 v69, v69
  v_add_f32_dpp v20, v20, v20 quad_perm:[1,0,3,2] row_mask:0xf bank_mask:0xf
  v_cndmask_b32_e64 v33, v33, v20, s[50:51]
  v_cvt_f32_i32 v70, v70
  v_cvt_f32_i32 v71, v71
  v_pk_mul_f32 v[20:21], v[68:69], v[22:23]
  v_pk_add_f32 v[18:19], v[22:23], v[24:25]
  v_pk_fma_f32 v[20:21], v[70:71], v[24:25], v[20:21]
  v_add_f32 v18, v18, v19
  v_add_f32 v20, v20, v21
  s_add_u32 m0, s100, 18432
  v_lshrrev_b32 v10, 1, v230
  v_add_u32 v10, v10, v240
  v_mad_u64_u32 v[30:31], s[64:65], v10, 1, v[28:29]
  global_load_lds_dwordx4 v[30:31], off
  s_cmpk_gt_i32 s69, 0x31
  s_cbranch_scc1 L_p17_4
  s_cmpk_gt_i32 s69, 0xffed
  s_cbranch_scc1 L_p17_1
  s_waitcnt vmcnt(7)
L_p17_1:
  s_waitcnt vmcnt(10)
L_p17_4:
  s_waitcnt vmcnt(12)
  buffer_load_dwordx4 v[104:107], v227, s[32:35], s80 offen nt
  v_perm_b32 v165, v170, v168, s56
  v_perm_b32 v170, v170, v168, s57
  v_perm_b32 v168, v171, v169, s56
  v_perm_b32 v171, v171, v169, s57
  v_dot2_f32_bf16 v22, v165, v48, 0
  v_add_f32_dpp v34, v18, v18 row_ror:8 row_mask:0xf bank_mask:0xc
  v_add_f32_dpp v34, v20, v20 row_ror:8 row_mask:0xf bank_mask:0x3
  v_dot2_f32_bf16 v23, v170, v49, 0
  v_dot2_f32_bf16 v24, v168, v50, 0
  v_dot2_f32_bf16 v25, v171, v51, 0
  v_cvt_f32_i32 v72, v72
  v_cvt_f32_i32 v73, v73
  v_cvt_f32_i32 v74, v74
  v_cvt_f32_i32 v75, v75
  v_pk_mul_f32 v[20:21], v[72:73], v[22:23]
  v_pk_add_f32 v[18:19], v[22:23], v[24:25]
  v_pk_fma_f32 v[20:21], v[74:75], v[24:25], v[20:21]
  v_add_f32 v18, v18, v19
  v_add_f32 v20, v20, v21
  s_cmpk_gt_i32 s69, 0x31
  s_cbranch_scc1 L_p18_4
  s_cmpk_gt_i32 s69, 0xb
  s_cbranch_scc1 L_p18_2
  s_waitcnt vmcnt(8)
L_p18_2:
  s_waitcnt vmcnt(11)
L_p18_4:
  s_waitcnt vmcnt(13)
  buffer_load_dwordx4 v[108:111], v228, s[32:35], s80 offen nt
  v_perm_b32 v169, v174, v172, s56
  v_perm_b32 v174, v174, v172, s57
  v_perm_b32 v172, v175, v173, s56
  v_perm_b32 v175, v175, v173, s57
  v_dot2_f32_bf16 v22, v169, v52, 0
  v_add_f32_dpp v21, v18, v18 row_ror:8 row_mask:0xf bank_mask:0xc
  v_add_f32_dpp v21, v20, v20 row_ror:8 row_mask:0xf bank_mask:0x3
  v_add_f32_dpp v20, v34, v34 row_half_mirror row_mask:0xf bank_mask:0x5
  v_dot2_f32_bf16 v23, v174, v53, 0
  v_add_f32_dpp v20, v21, v21 row_half_mirror row_mask:0xf bank_mask:0xa
  v_dot2_f32_bf16 v24, v172, v54, 0
  v_dot2_f32_bf16 v25, v175, v55, 0
  v_add_f32_dpp v20, v20, v20 quad_perm:[2,3,0,1] row_mask:0xf bank_mask:0xf
  v_cvt_f32_i32 v76, v76
  v_cvt_f32_i32 v77, v77
  v_add_f32_dpp v20, v20, v20 quad_perm:[1,0,3,2] row_mask:0xf bank_mask:0xf
  v_cndmask_b32_e64 v32, v32, v20, s[52:53]
  v_cvt_f32_i32 v78, v78
  v_cvt_f32_i32 v79, v79
  v_pk_mul_f32 v[20:21], v[76:77], v[22:23]
  v_pk_add_f32 v[18:19], v[22:23], v[24:25]
  v_pk_fma_f32 v[20:21], v[78:79], v[24:25], v[20:21]
  v_add_f32 v18, v18, v19
  v_add_f32 v20, v20, v21
  s_add_u32 m0, s100, 19456
  v_lshrrev_b32 v10, 1, v231
  v_add_u32 v10, v10, v241
  v_mad_u64_u32 v[30:31], s[64:65], v10, 1, v[28:29]
  global_load_lds_dwordx4 v[30:31], off
  s_cmpk_gt_i32 s69, 0x31
  s_cbranch_scc1 L_p19_4
  s_cmpk_gt_i32 s69, 0x1d
  s_cbranch_scc1 L_p19_3
  s_cmpk_gt_i32 s69, 0xffcd
  s_cbranch_scc1 L_p19_0
  s_waitcnt vmcnt(8)
L_p19_0:
  s_waitcnt vmcnt(10)
L_p19_3:
  s_waitcnt vmcnt(13)
L_p19_4:
  s_waitcnt vmcnt(15)
  buffer_load_dwordx4 v[112:115], v229, s[32:35], s80 offen nt
L_it9:
  s_waitcnt lgkmcnt(0)
  s_waitcnt vmcnt(10)
  s_add_u32 s44, s78, 0x03030303
  v_msad_u8 v9, s78, v40, 0
  v_msad_u8 v10, s44, v40, 0
  v_msad_u8 v9, s78, v41, v9
  v_msad_u8 v10, s44, v41, v10
  v_msad_u8 v9, s78, v42, v9
  v_msad_u8 v10, s44, v42, v10
  s_mov_b64 exec, 3
  global_store_byte v7, v8, s[30:31]
  global_load_dwordx3 v[40:42], v237, s[30:31] sc1
  v_sub_u32 v9, v9, v10
  v_add_u32 v8, 1, v8
  s_mov_b64 exec, -1
  v_readlane_b32 s66, v9, 0
  v_readlane_b32 s67, v9, 1
  s_add_u32 s78, s78, 0x01010101
  s_lshl1_add_u32 s69, s91, s95
  s_add_u32 s95, s66, s67
  s_add_u32 s69, s69, s95
  v_dot2_f32_bf16 v22, v161, v56, 0
  v_add_f32_dpp v34, v18, v18 row_ror:8 row_mask:0xf bank_mask:0xc
  v_add_f32_dpp v34, v20, v20 row_ror:8 row_mask:0xf bank_mask:0x3
  v_dot2_f32_bf16 v23, v166, v57, 0
  v_dot2_f32_bf16 v24, v164, v58, 0
  v_dot2_f32_bf16 v25, v167, v59, 0
  v_cvt_f32_i32 v80, v80
  v_cvt_f32_i32 v81, v81
  v_cvt_f32_i32 v82, v82
  v_cvt_f32_i32 v83, v83
  v_pk_mul_f32 v[20:21], v[80:81], v[22:23]
  v_pk_add_f32 v[18:19], v[22:23], v[24:25]
  v_pk_fma_f32 v[20:21], v[82:83], v[24:25], v[20:21]
  v_add_f32 v18, v18, v19
  v_add_f32 v20, v20, v21
  s_cmpk_gt_i32 s69, 0x31
  s_cbranch_scc1 L_p20_4
  s_cmpk_gt_i32 s69, 0xffed
  s_cbranch_scc1 L_p20_1
  s_waitcnt vmcnt(6)
L_p20_1:
  s_waitcnt vmcnt(10)
L_p20_4:
  s_waitcnt vmcnt(11)
  buffer_load_dwordx4 v[68:71], v230, s[32:35], 0 offen nt
  v_dot2_f32_bf16 v22, v165, v60, 0
  v_add_f32_dpp v35, v18, v18 row_ror:8 row_mask:0xf bank_mask:0xc
  v_add_f32_dpp v35, v20, v20 row_ror:8 row_mask:0xf bank_mask:0x3
  v_dot2_f32_bf16 v23, v170, v61, 0
  v_dot2_f32_bf16 v24, v168, v62, 0
  v_dot2_f32_bf16 v25, v171, v63, 0
  v_cvt_f32_i32 v84, v84
  v_cvt_f32_i32 v85, v85
  v_cvt_f32_i32 v86, v86
  v_cvt_f32_i32 v87, v87
  v_pk_mul_f32 v[20:21], v[84:85], v[22:23]
  v_pk_add_f32 v[18:19], v[22:23], v[24:25]
  v_pk_fma_f32 v[20:21], v[86:87], v[24:25], v[20:21]
  v_add_f32 v18, v18, v19
  v_add_f32 v20, v20, v21
  s_add_u32 m0, s100, 20480
  v_lshrrev_b32 v10, 1, v232
  v_add_u32 v10, v10, v242
  v_mad_u64_u32 v[30:31], s[64:65], v10, 1, v[28:29]
  global_load_lds_dwordx4 v[30:31], off
  s_cmpk_gt_i32 s69, 0x31
  s_cbranch_scc1 L_p21_4
  s_cmpk_gt_i32 s69, 0xb
  s_cbranch_scc1 L_p21_2
  s_waitcnt vmcnt(8)
L_p21_2:
  s_waitcnt vmcnt(12)
L_p21_4:
  s_waitcnt vmcnt(13)
  buffer_load_dwordx4 v[72:75], v231, s[32:35], 0 offen nt
  s_waitcnt vmcnt(12)
  ds_read_b64 v[176:177], v12 offset:15360
  ds_read_b64 v[178:179], v12 offset:15488
  ds_read_b64 v[180:181], v12 offset:16384
  ds_read_b64 v[182:183], v12 offset:16512
  ds_read_b64 v[184:185], v12 offset:17408
  ds_read_b64 v[186:187], v12 offset:17536
  v_dot2_f32_bf16 v22, v169, v64, 0
  v_add_f32_dpp v21, v18, v18 row_ror:8 row_mask:0xf bank_mask:0xc
  v_add_f32_dpp v21, v20, v20 row_ror:8 row_mask:0xf bank_mask:0x3
  v_add_f32_dpp v20, v35, v35 row_half_mirror row_mask:0xf bank_mask:0x5
  v_dot2_f32_bf16 v23, v174, v65, 0
  v_add_f32_dpp v20, v21, v21 row_half_mirror row_mask:0xf bank_mask:0xa
  v_dot2_f32_bf16 v24, v172, v66, 0
  v_dot2_f32_bf16 v25, v175, v67, 0
  v_add_f32_dpp v20, v20, v20 quad_perm:[2,3,0,1] row_mask:0xf bank_mask:0xf
  v_cvt_f32_i32 v88, v88
  v_cvt_f32_i32 v89, v89
  v_add_f32_dpp v20, v20, v20 quad_perm:[1,0,3,2] row_mask:0xf bank_mask:0xf
  v_cndmask_b32_e64 v33, v33, v20, s[52:53]
  v_cvt_f32_i32 v90, v90
  v_cvt_f32_i32 v91, v91
  v_pk_mul_f32 v[20:21], v[88:89], v[22:23]
  v_pk_add_f32 v[18:19], v[22:23], v[24:25]
  v_pk_fma_f32 v[20:21], v[90:91], v[24:25], v[20:21]
  v_add_f32 v18, v18, v19
  v_add_f32 v20, v20, v21
  s_cmpk_gt_i32 s69, 0x31
  s_cbranch_scc1 L_p22_4
  s_cmpk_gt_i32 s69, 0x1d
  s_cbranch_scc1 L_p22_3
  s_cmpk_gt_i32 s69, 0xffcd
  s_cbranch_scc1 L_p22_0
  s_waitcnt vmcnt(8)
L_p22_0:
  s_waitcnt vmcnt(9)
L_p22_3:
  s_waitcnt vmcnt(13)
L_p22_4:
  s_waitcnt vmcnt(14)
  buffer_load_dwordx4 v[76:79], v232, s[32:35], 0 offen nt
L_it10:
  s_waitcnt lgkmcnt(0)
  s_waitcnt vmcnt(10)
  s_add_u32 s44, s78, 0x03030303
  v_msad_u8 v9, s78, v36, 0
  v_msad_u8 v10, s44, v36, 0
  v_msad_u8 v9, s78, v37, v9
  v_msad_u8 v10, s44, v37, v10
  v_msad_u8 v9, s78, v38, v9
  v_msad_u8 v10, s44, v38, v10
  s_mov_b64 exec, 3
  global_store_byte v7, v8, s[30:31]
  global_load_dwordx3 v[36:38], v238, s[30:31] sc1
  v_sub_u32 v9, v9, v10
  v_add_u32 v8, 1, v8
  s_mov_b64 exec, -1
  v_readlane_b32 s66, v9, 0
  v_readlane_b32 s67, v9, 1
  s_add_u32 s78, s78, 0x01010101
  s_lshl1_add_u32 s69, s91, s95
  s_add_u32 s95, s66, s67
  s_add_u32 s69, s69, s95
  v_perm_b32 v173, v178, v176, s56
  v_perm_b32 v178, v178, v176, s57
  v_perm_b32 v176, v179, v177, s56
  v_perm_b32 v179, v179, v177, s57
  v_dot2_f32_bf16 v22, v173, v44, 0
  v_add_f32_dpp v35, v18, v18 row_ror:8 row_mask:0xf bank_mask:0xc
  v_add_f32_dpp v35, v20, v20 row_ror:8 row_mask:0xf bank_mask:0x3
  v_dot2_f32_bf16 v23, v178, v45, 0
  v_dot2_f32_bf16 v24, v176, v46, 0
  v_dot2_f32_bf16 v25, v179, v47, 0
  v_cvt_f32_i32 v92, v92
  v_cvt_f32_i32 v93, v93
  v_cvt_f32_i32 v94, v94
  v_cvt_f32_i32 v95, v95
  v_pk_mul_f32 v[20:21], v[92:93], v[22:23]
  v_pk_add_f32 v[18:19], v[22:23], v[24:25]
  v_pk_fma_f32 v[20:21], v[94:95], v[24:25], v[20:21]
  v_add_f32 v18, v18, v19
  v_add_f32 v20, v20, v21
  s_add_u32 m0, s100, 21504
  v_lshrrev_b32 v10, 1, v233
  v_add_u32 v10, v10, v240
  v_mad_u64_u32 v[30:31], s[64:65], v10, 1, v[28:29]
  global_load_lds_dwordx4 v[30:31], off
  s_cmpk_gt_i32 s69, 0x31
  s_cbranch_scc1 L_p23_4
  s_cmpk_gt_i32 s69, 0xffed
  s_cbranch_scc1 L_p23_1
  s_waitcnt vmcnt(7)
L_p23_1:
  s_waitcnt vmcnt(10)
L_p23_4:
  s_waitcnt vmcnt(12)
  buffer_load_dwordx4 v[80:83], v230, s[32:35], s80 offen nt
  v_perm_b32 v177, v182, v180, s56
  v_perm_b32 v182, v182, v180, s57
  v_perm_b32 v180, v183, v181, s56
  v_perm_b32 v183, v183, v181, s57
  v_dot2_f32_bf16 v22, v177, v48, 0
  v_add_f32_dpp v21, v18, v18 row_ror:8 row_mask:0xf bank_mask:0xc
  v_add_f32_dpp v21, v20, v20 row_ror:8 row_mask:0xf bank_mask:0x3
  v_add_f32_dpp v20, v34, v34 row_half_mirror row_mask:0xf bank_mask:0x5
  v_dot2_f32_bf16 v23, v182, v49, 0
  v_add_f32_dpp v20, v21, v21 row_half_mirror row_mask:0xf bank_mask:0xa
  v_dot2_f32_bf16 v24, v180, v50, 0
  v_dot2_f32_bf16 v25, v183, v51, 0
  v_add_f32_dpp v20, v20, v20 quad_perm:[2,3,0,1] row_mask:0xf bank_mask:0xf
  v_cvt_f32_i32 v96, v96
  v_cvt_f32_i32 v97, v97
  v_add_f32_dpp v20, v20, v20 quad_perm:[1,0,3,2] row_mask:0xf bank_mask:0xf
  v_cndmask_b32_e64 v32, v32, v20, s[54:55]
  ds_write_b32 v1, v32 offset:512
  v_cvt_f32_i32 v98, v98
  v_cvt_f32_i32 v99, v99
  v_pk_mul_f32 v[20:21], v[96:97], v[22:23]
  v_pk_add_f32 v[18:19], v[22:23], v[24:25]
  v_pk_fma_f32 v[20:21], v[98:99], v[24:25], v[20:21]
  v_add_f32 v18, v18, v19
  v_add_f32 v20, v20, v21
  s_cmpk_gt_i32 s69, 0x31
  s_cbranch_scc1 L_p24_4
  s_cmpk_gt_i32 s69, 0xb
  s_cbranch_scc1 L_p24_2
  s_waitcnt vmcnt(8)
L_p24_2:
  s_waitcnt vmcnt(11)
L_p24_4:
  s_waitcnt vmcnt(13)
  buffer_load_dwordx4 v[84:87], v231, s[32:35], s80 offen nt
  v_perm_b32 v181, v186, v184, s56
  v_perm_b32 v186, v186, v184, s57
  v_perm_b32 v184, v187, v185, s56
  v_perm_b32 v187, v187, v185, s57
  v_dot2_f32_bf16 v22, v181, v52, 0
  v_add_f32_dpp v34, v18, v18 row_ror:8 row_mask:0xf bank_mask:0xc
  v_add_f32_dpp v34, v20, v20 row_ror:8 row_mask:0xf bank_mask:0x3
  v_dot2_f32_bf16 v23, v186, v53, 0
  v_dot2_f32_bf16 v24, v184, v54, 0
  v_dot2_f32_bf16 v25, v187, v55, 0
  v_cvt_f32_i32 v100, v100
  v_cvt_f32_i32 v101, v101
  v_cvt_f32_i32 v102, v102
  v_cvt_f32_i32 v103, v103
  v_pk_mul_f32 v[20:21], v[100:101], v[22:23]
  v_pk_add_f32 v[18:19], v[22:23], v[24:25]
  v_pk_fma_f32 v[20:21], v[102:103], v[24:25], v[20:21]
  v_add_f32 v18, v18, v19
  v_add_f32 v20, v20, v21
  s_add_u32 m0, s100, 22528
  v_lshrrev_b32 v10, 1, v234
  v_add_u32 v10, v10, v241
  v_mad_u64_u32 v[30:31], s[64:65], v10, 1, v[28:29]
  global_load_lds_dwordx4 v[30:31], off
  s_cmpk_gt_i32 s69, 0x31
  s_cbranch_scc1 L_p25_4
  s_cmpk_gt_i32 s69, 0x1d
  s_cbranch_scc1 L_p25_3
  s_cmpk_gt_i32 s69, 0xffcd
  s_cbranch_scc1 L_p25_0
  s_waitcnt vmcnt(8)
L_p25_0:
  s_waitcnt vmcnt(10)
L_p25_3:
  s_waitcnt vmcnt(13)
L_p25_4:
  s_waitcnt vmcnt(15)
  buffer_load_dwordx4 v[88:91], v232, s[32:35], s80 offen nt
L_it11:
  s_waitcnt lgkmcnt(0)
  s_waitcnt vmcnt(10)
  s_add_u32 s44, s78, 0x03030303
  v_msad_u8 v9, s78, v40, 0
  v_msad_u8 v10, s44, v40, 0
  v_msad_u8 v9, s78, v41, v9
  v_msad_u8 v10, s44, v41, v10
  v_msad_u8 v9, s78, v42, v9
  v_msad_u8 v10, s44, v42, v10
  s_mov_b64 exec, 3
  global_store_byte v7, v8, s[30:31]
  global_load_dwordx3 v[40:42], v239, s[30:31] sc1
  v_sub_u32 v9, v9, v10
  v_add_u32 v8, 1, v8
  s_mov_b64 exec, -1
  v_readlane_b32 s66, v9, 0
  v_readlane_b32 s67, v9, 1
  s_add_u32 s78, s78, 0x01010101
  s_lshl1_add_u32 s69, s91, s95
  s_add_u32 s95, s66, s67
  s_add_u32 s69, s69, s95
  v_dot2_f32_bf16 v22, v173, v56, 0
  v_add_f32_dpp v21, v18, v18 row_ror:8 row_mask:0xf bank_mask:0xc
  v_add_f32_dpp v21, v20, v20 row_ror:8 row_mask:0xf bank_mask:0x3
  v_add_f32_dpp v20, v34, v34 row_half_mirror row_mask:0xf bank_mask:0x5
  v_dot2_f32_bf16 v23, v178, v57, 0
  v_add_f32_dpp v20, v21, v21 row_half_mirror row_mask:0xf bank_mask:0xa
  v_dot2_f32_bf16 v24, v176, v58, 0
  v_dot2_f32_bf16 v25, v179, v59, 0
  v_add_f32_dpp v20, v20, v20 quad_perm:[2,3,0,1] row_mask:0xf bank_mask:0xf
  v_cvt_f32_i32 v104, v104
  v_cvt_f32_i32 v105, v105
  v_add_f32_dpp v20, v20, v20 quad_perm:[1,0,3,2] row_mask:0xf bank_mask:0xf
  v_cndmask_b32_e64 v32, v32, v20, s[48:49]
  v_cvt_f32_i32 v106, v106
  v_cvt_f32_i32 v107, v107
  v_pk_mul_f32 v[20:21], v[104:105], v[22:23]
  v_pk_add_f32 v[18:19], v[22:23], v[24:25]
  v_pk_fma_f32 v[20:21], v[106:107], v[24:25], v[20:21]
  v_add_f32 v18, v18, v19
  v_add_f32 v20, v20, v21
  s_cmpk_gt_i32 s69, 0x31
  s_cbranch_scc1 L_p26_4
  s_cmpk_gt_i32 s69, 0xffed
  s_cbranch_scc1 L_p26_1
  s_waitcnt vmcnt(6)
L_p26_1:
  s_waitcnt vmcnt(10)
L_p26_4:
  s_waitcnt vmcnt(11)
  buffer_load_dwordx4 v[92:95], v233, s[32:35], 0 offen nt
  v_dot2_f32_bf16 v22, v177, v60, 0
  v_add_f32_dpp v21, v18, v18 row_ror:8 row_mask:0xf bank_mask:0xc
  v_add_f32_dpp v21, v20, v20 row_ror:8 row_mask:0xf bank_mask:0x3
  v_add_f32_dpp v20, v35, v35 row_half_mirror row_mask:0xf bank_mask:0x5
  v_dot2_f32_bf16 v23, v182, v61, 0
  v_add_f32_dpp v20, v21, v21 row_half_mirror row_mask:0xf bank_mask:0xa
  v_dot2_f32_bf16 v24, v180, v62, 0
  v_dot2_f32_bf16 v25, v183, v63, 0
  v_add_f32_dpp v20, v20, v20 quad_perm:[2,3,0,1] row_mask:0xf bank_mask:0xf
  v_cvt_f32_i32 v108, v108
  v_cvt_f32_i32 v109, v109
  v_add_f32_dpp v20, v20, v20 quad_perm:[1,0,3,2] row_mask:0xf bank_mask:0xf
  v_cndmask_b32_e64 v33, v33, v20, s[54:55]
  ds_write_b32 v1, v33 offset:3584
  v_cvt_f32_i32 v110, v110
  v_cvt_f32_i32 v111, v111
  v_pk_mul_f32 v[20:21], v[108:109], v[22:23]
  v_pk_add_f32 v[18:19], v[22:23], v[24:25]
  v_pk_fma_f32 v[20:21], v[110:111], v[24:25], v[20:21]
  v_add_f32 v18, v18, v19
  v_add_f32 v20, v20, v21
  s_add_u32 m0, s100, 23552
  v_lshrrev_b32 v10, 1, v235
  v_add_u32 v10, v10, v242
  v_mad_u64_u32 v[30:31], s[64:65], v10, 1, v[28:29]
  global_load_lds_dwordx4 v[30:31], off
  s_cmpk_gt_i32 s69, 0x31
  s_cbranch_scc1 L_p27_4
  s_cmpk_gt_i32 s69, 0xb
  s_cbranch_scc1 L_p27_2
  s_waitcnt vmcnt(8)
L_p27_2:
  s_waitcnt vmcnt(12)
L_p27_4:
  s_waitcnt vmcnt(13)
  buffer_load_dwordx4 v[96:99], v234, s[32:35], 0 offen nt
  s_waitcnt vmcnt(12)
  ds_read_b64 v[188:189], v12 offset:18432
  ds_read_b64 v[190:191], v12 offset:18560
  ds_read_b64 v[192:193], v12 offset:19456
  ds_read_b64 v[194:195], v12 offset:19584
  ds_read_b64 v[196:197], v12 offset:20480
  ds_read_b64 v[198:199], v12 offset:20608
  v_dot2_f32_bf16 v22, v181, v64, 0
  v_add_f32_dpp v35, v18, v18 row_ror:8 row_mask:0xf bank_mask:0xc
  v_add_f32_dpp v35, v20, v20 row_ror:8 row_mask:0xf bank_mask:0x3
  v_dot2_f32_bf16 v23, v186, v65, 0
  v_dot2_f32_bf16 v24, v184, v66, 0
  v_dot2_f32_bf16 v25, v187, v67, 0
  v_cvt_f32_i32 v112, v112
  v_cvt_f32_i32 v113, v113
  v_cvt_f32_i32 v114, v114
  v_cvt_f32_i32 v115, v115
  v_pk_mul_f32 v[20:21], v[112:113], v[22:23]
  v_pk_add_f32 v[18:19], v[22:23], v[24:25]
  v_pk_fma_f32 v[20:21], v[114:115], v[24:25], v[20:21]
  v_add_f32 v18, v18, v19
  v_add_f32 v20, v20, v21
  s_cmpk_gt_i32 s69, 0x31
  s_cbranch_scc1 L_p28_4
  s_cmpk_gt_i32 s69, 0x1d
  s_cbranch_scc1 L_p28_3
  s_cmpk_gt_i32 s69, 0xffcd
  s_cbranch_scc1 L_p28_0
  s_waitcnt vmcnt(8)
L_p28_0:
  s_waitcnt vmcnt(9)
L_p28_3:
  s_waitcnt vmcnt(13)
L_p28_4:
  s_waitcnt vmcnt(14)
  buffer_load_dwordx4 v[100:103], v235, s[32:35], 0 offen nt
L_it12:
  s_waitcnt lgkmcnt(0)
  s_waitcnt vmcnt(10)
  s_add_u32 s44, s78, 0x03030303
  v_msad_u8 v9, s78, v36, 0
  v_msad_u8 v10, s44, v36, 0
  v_msad_u8 v9, s78, v37, v9
  v_msad_u8 v10, s44, v37, v10
  v_msad_u8 v9, s78, v38, v9
  v_msad_u8 v10, s44, v38, v10
  s_mov_b64 exec, 3
  global_store_byte v7, v8, s[30:31]
  global_load_dwordx3 v[36:38], v236, s[30:31] sc1
  v_sub_u32 v9, v9, v10
  v_add_u32 v8, 1, v8
  s_mov_b64 exec, -1
  v_readlane_b32 s66, v9, 0
  v_readlane_b32 s67, v9, 1
  s_add_u32 s78, s78, 0x01010101
  s_lshl1_add_u32 s69, s91, s95
  s_add_u32 s95, s66, s67
  s_add_u32 s69, s69, s95
  v_perm_b32 v185, v190, v188, s56
  v_perm_b32 v190, v190, v188, s57
  v_perm_b32 v188, v191, v189, s56
  v_perm_b32 v191, v191, v189, s57
  v_dot2_f32_bf16 v22, v185, v44, 0
  v_add_f32_dpp v21, v18, v18 row_ror:8 row_mask:0xf bank_mask:0xc
  v_add_f32_dpp v21, v20, v20 row_ror:8 row_mask:0xf bank_mask:0x3
  v_add_f32_dpp v20, v35, v35 row_half_mirror row_mask:0xf bank_mask:0x5
  v_dot2_f32_bf16 v23, v190, v45, 0
  v_add_f32_dpp v20, v21, v21 row_half_mirror row_mask:0xf bank_mask:0xa
  v_dot2_f32_bf16 v24, v188, v46, 0
  v_dot2_f32_bf16 v25, v191, v47, 0
  v_add_f32_dpp v20, v20, v20 quad_perm:[2,3,0,1] row_mask:0xf bank_mask:0xf
  v_cvt_f32_i32 v68, v68
  v_cvt_f32_i32 v69, v69
  v_add_f32_dpp v20, v20, v20 quad_perm:[1,0,3,2] row_mask:0xf bank_mask:0xf
  v_cndmask_b32_e64 v33, v33, v20, s[48:49]
  v_cvt_f32_i32 v70, v70
  v_cvt_f32_i32 v71, v71
  v_pk_mul_f32 v[20:21], v[68:69], v[22:23]
  v_pk_add_f32 v[18:19], v[22:23], v[24:25]
  v_pk_fma_f32 v[20:21], v[70:71], v[24:25], v[20:21]
  v_add_f32 v18, v18, v19
  v_add_f32 v20, v20, v21
  s_cmpk_gt_i32 s69, 0x31
  s_cbranch_scc1 L_p29_4
  s_cmpk_gt_i32 s69, 0xffed
  s_cbranch_scc1 L_p29_1
  s_waitcnt vmcnt(6)
L_p29_1:
  s_waitcnt vmcnt(9)
L_p29_4:
  s_waitcnt vmcnt(11)
  buffer_load_dwordx4 v[104:107], v233, s[32:35], s80 offen nt
  v_perm_b32 v189, v194, v192, s56
  v_perm_b32 v194, v194, v192, s57
  v_perm_b32 v192, v195, v193, s56
  v_perm_b32 v195, v195, v193, s57
  v_dot2_f32_bf16 v22, v189, v48, 0
  v_add_f32_dpp v34, v18, v18 row_ror:8 row_mask:0xf bank_mask:0xc
  v_add_f32_dpp v34, v20, v20 row_ror:8 row_mask:0xf bank_mask:0x3
  v_dot2_f32_bf16 v23, v194, v49, 0
  v_dot2_f32_bf16 v24, v192, v50, 0
  v_dot2_f32_bf16 v25, v195, v51, 0
  v_cvt_f32_i32 v72, v72
  v_cvt_f32_i32 v73, v73
  v_cvt_f32_i32 v74, v74
  v_cvt_f32_i32 v75, v75
  v_pk_mul_f32 v[20:21], v[72:73], v[22:23]
  v_pk_add_f32 v[18:19], v[22:23], v[24:25]
  v_pk_fma_f32 v[20:21], v[74:75], v[24:25], v[20:21]
  v_add_f32 v18, v18, v19
  v_add_f32 v20, v20, v21
  s_cmpk_gt_i32 s69, 0x31
  s_cbranch_scc1 L_p30_4
  s_cmpk_gt_i32 s69, 0xb
  s_cbranch_scc1 L_p30_2
  s_waitcnt vmcnt(7)
L_p30_2:
  s_waitcnt vmcnt(10)
L_p30_4:
  s_waitcnt vmcnt(12)
  buffer_load_dwordx4 v[108:111], v234, s[32:35], s80 offen nt
  v_perm_b32 v193, v198, v196, s56
  v_perm_b32 v198, v198, v196, s57
  v_perm_b32 v196, v199, v197, s56
  v_perm_b32 v199, v199, v197, s57
  v_dot2_f32_bf16 v22, v193, v52, 0
  v_add_f32_dpp v21, v18, v18 row_ror:8 row_mask:0xf bank_mask:0xc
  v_add_f32_dpp v21, v20, v20 row_ror:8 row_mask:0xf bank_mask:0x3
  v_add_f32_dpp v20, v34, v34 row_half_mirror row_mask:0xf bank_mask:0x5
  v_dot2_f32_bf16 v23, v198, v53, 0
  v_add_f32_dpp v20, v21, v21 row_half_mirror row_mask:0xf bank_mask:0xa
  v_dot2_f32_bf16 v24, v196, v54, 0
  v_dot2_f32_bf16 v25, v199, v55, 0
  v_add_f32_dpp v20, v20, v20 quad_perm:[2,3,0,1] row_mask:0xf bank_mask:0xf
  v_cvt_f32_i32 v76, v76
  v_cvt_f32_i32 v77, v77
  v_add_f32_dpp v20, v20, v20 quad_perm:[1,0,3,2] row_mask:0xf bank_mask:0xf
  v_cndmask_b32_e64 v32, v32, v20, s[50:51]
  v_cvt_f32_i32 v78, v78
  v_cvt_f32_i32 v79, v79
  v_pk_mul_f32 v[20:21], v[76:77], v[22:23]
  v_pk_add_f32 v[18:19], v[22:23], v[24:25]
  v_pk_fma_f32 v[20:21], v[78:79], v[24:25], v[20:21]
  v_add_f32 v18, v18, v19
  v_add_f32 v20, v20, v21
  s_cmpk_gt_i32 s69, 0x31
  s_cbranch_scc1 L_p31_4
  s_cmpk_gt_i32 s69, 0x1d
  s_cbranch_scc1 L_p31_3
  s_cmpk_gt_i32 s69, 0xffcd
  s_cbranch_scc1 L_p31_0
  s_waitcnt vmcnt(6)
L_p31_0:
  s_waitcnt vmcnt(8)
L_p31_3:
  s_waitcnt vmcnt(11)
L_p31_4:
  s_waitcnt vmcnt(13)
  buffer_load_dwordx4 v[112:115], v235, s[32:35], s80 offen nt
L_it13:
  s_waitcnt lgkmcnt(0)
  s_waitcnt vmcnt(8)
  s_add_u32 s44, s78, 0x03030303
  v_msad_u8 v9, s78, v40, 0
  v_msad_u8 v10, s44, v40, 0
  v_msad_u8 v9, s78, v41, v9
  v_msad_u8 v10, s44, v41, v10
  v_msad_u8 v9, s78, v42, v9
  v_msad_u8 v10, s44, v42, v10
  s_mov_b64 exec, 3
  global_load_dwordx2 v[26:27], v11, s[30:31] sc1
  global_store_byte v7, v8, s[30:31]
  global_load_dwordx3 v[40:42], v237, s[30:31] sc1
  v_sub_u32 v9, v9, v10
  v_add_u32 v8, 1, v8
  s_mov_b64 exec, -1
  v_readlane_b32 s66, v9, 0
  v_readlane_b32 s67, v9, 1
  s_add_u32 s78, s78, 0x01010101
  s_lshl1_add_u32 s69, s91, s95
  s_add_u32 s95, s66, s67
  s_add_u32 s69, s69, s95
  v_dot2_f32_bf16 v22, v185, v56, 0
  v_add_f32_dpp v34, v18, v18 row_ror:8 row_mask:0xf bank_mask:0xc
  v_add_f32_dpp v34, v20, v20 row_ror:8 row_mask:0xf bank_mask:0x3
  v_dot2_f32_bf16 v23, v190, v57, 0
  v_dot2_f32_bf16 v24, v188, v58, 0
  v_dot2_f32_bf16 v25, v191, v59, 0
  v_cvt_f32_i32 v80, v80
  v_cvt_f32_i32 v81, v81
  v_cvt_f32_i32 v82, v82
  v_cvt_f32_i32 v83, v83
  v_pk_mul_f32 v[20:21], v[80:81], v[22:23]
  v_pk_add_f32 v[18:19], v[22:23], v[24:25]
  v_pk_fma_f32 v[20:21], v[82:83], v[24:25], v[20:21]
  v_add_f32 v18, v18, v19
  v_add_f32 v20, v20, v21
  s_cmpk_gt_i32 s69, 0x31
  s_cbranch_scc1 L_p32_4
  s_cmpk_gt_i32 s69, 0xffed
  s_cbranch_scc1 L_p32_1
  s_waitcnt vmcnt(6)
L_p32_1:
  s_waitcnt vmcnt(9)
L_p32_4:
  s_waitcnt vmcnt(10)
  buffer_load_dwordx4 v[68:71], v212, s[32:35], s3 offen nt
  v_dot2_f32_bf16 v22, v189, v60, 0
  v_add_f32_dpp v35, v18, v18 row_ror:8 row_mask:0xf bank_mask:0xc
  v_add_f32_dpp v35, v20, v20 row_ror:8 row_mask:0xf bank_mask:0x3
  v_dot2_f32_bf16 v23, v194, v61, 0
  v_dot2_f32_bf16 v24, v192, v62, 0
  v_dot2_f32_bf16 v25, v195, v63, 0
  v_cvt_f32_i32 v84, v84
  v_cvt_f32_i32 v85, v85
  v_cvt_f32_i32 v86, v86
  v_cvt_f32_i32 v87, v87
  v_pk_mul_f32 v[20:21], v[84:85], v[22:23]
  v_pk_add_f32 v[18:19], v[22:23], v[24:25]
  v_pk_fma_f32 v[20:21], v[86:87], v[24:25], v[20:21]
  v_add_f32 v18, v18, v19
  v_add_f32 v20, v20, v21
  s_cmpk_gt_i32 s69, 0x31
  s_cbranch_scc1 L_p33_4
  s_cmpk_gt_i32 s69, 0xb
  s_cbranch_scc1 L_p33_2
  s_waitcnt vmcnt(7)
L_p33_2:
  s_waitcnt vmcnt(10)
L_p33_4:
  s_waitcnt vmcnt(11)
  buffer_load_dwordx4 v[72:75], v213, s[32:35], s3 offen nt
  s_waitcnt vmcnt(10)
  ds_read_b64 v[200:201], v12 offset:21504
  ds_read_b64 v[202:203], v12 offset:21632
  ds_read_b64 v[204:205], v12 offset:22528
  ds_read_b64 v[206:207], v12 offset:22656
  ds_read_b64 v[208:209], v12 offset:23552
  ds_read_b64 v[210:211], v12 offset:23680
  v_dot2_f32_bf16 v22, v193, v64, 0
  v_add_f32_dpp v21, v18, v18 row_ror:8 row_mask:0xf bank_mask:0xc
  v_add_f32_dpp v21, v20, v20 row_ror:8 row_mask:0xf bank_mask:0x3
  v_add_f32_dpp v20, v35, v35 row_half_mirror row_mask:0xf bank_mask:0x5
  v_dot2_f32_bf16 v23, v198, v65, 0
  v_add_f32_dpp v20, v21, v21 row_half_mirror row_mask:0xf bank_mask:0xa
  v_dot2_f32_bf16 v24, v196, v66, 0
  v_dot2_f32_bf16 v25, v199, v67, 0
  v_add_f32_dpp v20, v20, v20 quad_perm:[2,3,0,1] row_mask:0xf bank_mask:0xf
  v_cvt_f32_i32 v88, v88
  v_cvt_f32_i32 v89, v89
  v_add_f32_dpp v20, v20, v20 quad_perm:[1,0,3,2] row_mask:0xf bank_mask:0xf
  v_cndmask_b32_e64 v33, v33, v20, s[50:51]
  v_cvt_f32_i32 v90, v90
  v_cvt_f32_i32 v91, v91
  v_pk_mul_f32 v[20:21], v[88:89], v[22:23]
  v_pk_add_f32 v[18:19], v[22:23], v[24:25]
  v_pk_fma_f32 v[20:21], v[90:91], v[24:25], v[20:21]
  v_add_f32 v18, v18, v19
  v_add_f32 v20, v20, v21
  s_cmpk_gt_i32 s69, 0x31
  s_cbranch_scc1 L_p34_4
  s_cmpk_gt_i32 s69, 0x1d
  s_cbranch_scc1 L_p34_3
  s_cmpk_gt_i32 s69, 0xffcd
  s_cbranch_scc1 L_p34_0
  s_waitcnt vmcnt(7)
L_p34_0:
  s_waitcnt vmcnt(8)
L_p34_3:
  s_waitcnt vmcnt(11)
L_p34_4:
  s_waitcnt vmcnt(12)
  buffer_load_dwordx4 v[76:79], v214, s[32:35], s3 offen nt
L_it14:
  s_waitcnt lgkmcnt(0)
  ds_read_b32 v4, v14 offset:16
  s_waitcnt vmcnt(8)
  s_add_u32 s44, s78, 0x03030303
  v_msad_u8 v9, s78, v36, 0
  v_msad_u8 v10, s44, v36, 0
  v_msad_u8 v9, s78, v37, v9
  v_msad_u8 v10, s44, v37, v10
  v_msad_u8 v9, s78, v38, v9
  v_msad_u8 v10, s44, v38, v10
  s_mov_b64 exec, 3
  global_store_byte v7, v8, s[30:31]
  global_load_dwordx3 v[36:38], v238, s[30:31] sc1
  v_sub_u32 v9, v9, v10
  v_add_u32 v8, 1, v8
  s_mov_b64 exec, -1
  v_readlane_b32 s66, v9, 0
  v_readlane_b32 s67, v9, 1
  s_add_u32 s78, s78, 0x01010101
  s_lshl1_add_u32 s69, s91, s95
  s_add_u32 s95, s66, s67
  s_add_u32 s69, s69, s95
  v_perm_b32 v197, v202, v200, s56
  v_perm_b32 v202, v202, v200, s57
  v_perm_b32 v200, v203, v201, s56
  v_perm_b32 v203, v203, v201, s57
  v_dot2_f32_bf16 v22, v197, v44, 0
  v_add_f32_dpp v35, v18, v18 row_ror:8 row_mask:0xf bank_mask:0xc
  v_add_f32_dpp v35, v20, v20 row_ror:8 row_mask:0xf bank_mask:0x3
  v_dot2_f32_bf16 v23, v202, v45, 0
  v_dot2_f32_bf16 v24, v200, v46, 0
  v_dot2_f32_bf16 v25, v203, v47, 0
  v_cvt_f32_i32 v92, v92
  v_cvt_f32_i32 v93, v93
  v_cvt_f32_i32 v94, v94
  v_cvt_f32_i32 v95, v95
  v_pk_mul_f32 v[20:21], v[92:93], v[22:23]
  v_pk_add_f32 v[18:19], v[22:23], v[24:25]
  v_pk_fma_f32 v[20:21], v[94:95], v[24:25], v[20:21]
  v_add_f32 v18, v18, v19
  v_add_f32 v20, v20, v21
  s_cmpk_gt_i32 s69, 0x31
  s_cbranch_scc1 L_p35_4
  s_cmpk_gt_i32 s69, 0xffed
  s_cbranch_scc1 L_p35_1
  s_waitcnt vmcnt(5)
L_p35_1:
  s_waitcnt vmcnt(9)
L_p35_4:
  s_waitcnt vmcnt(10)
  buffer_load_dwordx4 v[80:83], v215, s[32:35], s3 offen nt
  v_perm_b32 v201, v206, v204, s56
  v_perm_b32 v206, v206, v204, s57
  v_perm_b32 v204, v207, v205, s56
  v_perm_b32 v207, v207, v205, s57
  v_dot2_f32_bf16 v22, v201, v48, 0
  v_add_f32_dpp v21, v18, v18 row_ror:8 row_mask:0xf bank_mask:0xc
  v_add_f32_dpp v21, v20, v20 row_ror:8 row_mask:0xf bank_mask:0x3
  v_add_f32_dpp v20, v34, v34 row_half_mirror row_mask:0xf bank_mask:0x5
  v_dot2_f32_bf16 v23, v206, v49, 0
  v_add_f32_dpp v20, v21, v21 row_half_mirror row_mask:0xf bank_mask:0xa
  v_dot2_f32_bf16 v24, v204, v50, 0
  v_dot2_f32_bf16 v25, v207, v51, 0
  v_add_f32_dpp v20, v20, v20 quad_perm:[2,3,0,1] row_mask:0xf bank_mask:0xf
  v_cvt_f32_i32 v96, v96
  v_cvt_f32_i32 v97, v97
  v_add_f32_dpp v20, v20, v20 quad_perm:[1,0,3,2] row_mask:0xf bank_mask:0xf
  v_cndmask_b32_e64 v32, v32, v20, s[52:53]
  v_cvt_f32_i32 v98, v98
  v_cvt_f32_i32 v99, v99
  v_pk_mul_f32 v[20:21], v[96:97], v[22:23]
  v_pk_add_f32 v[18:19], v[22:23], v[24:25]
  v_pk_fma_f32 v[20:21], v[98:99], v[24:25], v[20:21]
  v_add_f32 v18, v18, v19
  v_add_f32 v20, v20, v21
  s_cmpk_gt_i32 s69, 0x31
  s_cbranch_scc1 L_p36_4
  s_cmpk_gt_i32 s69, 0xb
  s_cbranch_scc1 L_p36_2
  s_waitcnt vmcnt(6)
L_p36_2:
  s_waitcnt vmcnt(10)
L_p36_4:
  s_waitcnt vmcnt(11)
  buffer_load_dwordx4 v[84:87], v216, s[32:35], s3 offen nt
  v_perm_b32 v205, v210, v208, s56
  v_perm_b32 v210, v210, v208, s57
  v_perm_b32 v208, v211, v209, s56
  v_perm_b32 v211, v211, v209, s57
  v_dot2_f32_bf16 v22, v205, v52, 0
  v_add_f32_dpp v34, v18, v18 row_ror:8 row_mask:0xf bank_mask:0xc
  v_add_f32_dpp v34, v20, v20 row_ror:8 row_mask:0xf bank_mask:0x3
  v_dot2_f32_bf16 v23, v210, v53, 0
  v_dot2_f32_bf16 v24, v208, v54, 0
  v_dot2_f32_bf16 v25, v211, v55, 0
  v_cvt_f32_i32 v100, v100
  v_cvt_f32_i32 v101, v101
  v_cvt_f32_i32 v102, v102
  v_cvt_f32_i32 v103, v103
  v_pk_mul_f32 v[20:21], v[100:101], v[22:23]
  v_pk_add_f32 v[18:19], v[22:23], v[24:25]
  v_pk_fma_f32 v[20:21], v[102:103], v[24:25], v[20:21]
  v_add_f32 v18, v18, v19
  v_add_f32 v20, v20, v21
  s_cmpk_gt_i32 s69, 0x31
  s_cbranch_scc1 L_p37_4
  s_cmpk_gt_i32 s69, 0x1d
  s_cbranch_scc1 L_p37_3
  s_cmpk_gt_i32 s69, 0xffcd
  s_cbranch_scc1 L_p37_0
  s_waitcnt vmcnt(6)
L_p37_0:
  s_waitcnt vmcnt(7)
L_p37_3:
  s_waitcnt vmcnt(11)
L_p37_4:
  s_waitcnt vmcnt(12)
  buffer_load_dwordx4 v[88:91], v217, s[32:35], s3 offen nt
L_it15:
  s_mov_b32 s47, 3
L_fq15:
  s_waitcnt lgkmcnt(0)
  v_readfirstlane_b32 s46, v4
  s_cmp_ge_u32 s46, s47
  s_cbranch_scc1 L_fq15_ok
  s_cmp_eq_u32 s94, 0
  s_cbranch_scc1 L_fq15_ok
  s_sub_u32 s94, s94, 1
  ds_read_b32 v4, v14 offset:16
  s_branch L_fq15
L_fq15_ok:
  s_waitcnt vmcnt(7)
  s_add_u32 s44, s78, 0x03030303
  v_msad_u8 v9, s78, v40, 0
  v_msad_u8 v10, s44, v40, 0
  v_msad_u8 v9, s78, v41, v9
  v_msad_u8 v10, s44, v41, v10
  v_msad_u8 v9, s78, v42, v9
  v_msad_u8 v10, s44, v42, v10
  s_mov_b64 exec, 3
  global_store_byte v7, v8, s[30:31]
  global_load_dwordx3 v[40:42], v239, s[30:31] sc1
  v_sub_u32 v9, v9, v10
  v_add3_u32 v10, v26, v27, s58
  v_add_u32 v8, 1, v8
  s_mov_b64 exec, -1
  v_readlane_b32 s66, v9, 0
  v_readlane_b32 s67, v9, 1
  v_readlane_b32 s91, v10, 0
  s_add_u32 s78, s78, 0x01010101
  s_lshl1_add_u32 s69, s91, s95
  s_add_u32 s95, s66, s67
  s_add_u32 s69, s69, s95
  v_dot2_f32_bf16 v22, v197, v56, 0
  v_add_f32_dpp v21, v18, v18 row_ror:8 row_mask:0xf bank_mask:0xc
  v_add_f32_dpp v21, v20, v20 row_ror:8 row_mask:0xf bank_mask:0x3
  v_add_f32_dpp v20, v34, v34 row_half_mirror row_mask:0xf bank_mask:0x5
  v_dot2_f32_bf16 v23, v202, v57, 0
  v_add_f32_dpp v20, v21, v21 row_half_mirror row_mask:0xf bank_mask:0xa
  v_dot2_f32_bf16 v24, v200, v58, 0
  v_dot2_f32_bf16 v25, v203, v59, 0
  v_add_f32_dpp v20, v20, v20 quad_perm:[2,3,0,1] row_mask:0xf bank_mask:0xf
  v_cvt_f32_i32 v104, v104
  v_cvt_f32_i32 v105, v105
  v_add_f32_dpp v20, v20, v20 quad_perm:[1,0,3,2] row_mask:0xf bank_mask:0xf
  v_cndmask_b32_e64 v32, v32, v20, s[54:55]
  ds_write_b32 v1, v32 offset:1024
  v_cvt_f32_i32 v106, v106
  v_cvt_f32_i32 v107, v107
  ds_read_b128 v[44:47], v15 offset:2560
  v_pk_mul_f32 v[20:21], v[104:105], v[22:23]
  v_pk_add_f32 v[18:19], v[22:23], v[24:25]
  v_pk_fma_f32 v[20:21], v[106:107], v[24:25], v[20:21]
  v_add_f32 v18, v18, v19
  v_add_f32 v20, v20, v21
  s_cmpk_gt_i32 s69, 0x31
  s_cbranch_scc1 L_p38_4
  s_cmpk_gt_i32 s69, 0xffed
  s_cbranch_scc1 L_p38_1
  s_waitcnt vmcnt(5)
L_p38_1:
  s_waitcnt vmcnt(8)
L_p38_4:
  s_waitcnt vmcnt(9)
  buffer_load_dwordx4 v[92:95], v218, s[32:35], s3 offen nt
  v_dot2_f32_bf16 v22, v201, v60, 0
  v_add_f32_dpp v21, v18, v18 row_ror:8 row_mask:0xf bank_mask:0xc
  v_add_f32_dpp v21, v20, v20 row_ror:8 row_mask:0xf bank_mask:0x3
  v_add_f32_dpp v20, v35, v35 row_half_mirror row_mask:0xf bank_mask:0x5
  v_dot2_f32_bf16 v23, v206, v61, 0
  v_add_f32_dpp v20, v21, v21 row_half_mirror row_mask:0xf bank_mask:0xa
  v_dot2_f32_bf16 v24, v204, v62, 0
  v_dot2_f32_bf16 v25, v207, v63, 0
  v_add_f32_dpp v20, v20, v20 quad_perm:[2,3,0,1] row_mask:0xf bank_mask:0xf
  v_cvt_f32_i32 v108, v108
  v_cvt_f32_i32 v109, v109
  v_add_f32_dpp v20, v20, v20 quad_perm:[1,0,3,2] row_mask:0xf bank_mask:0xf
  v_cndmask_b32_e64 v33, v33, v20, s[52:53]
  v_cvt_f32_i32 v110, v110
  v_cvt_f32_i32 v111, v111
  ds_read_b128 v[48:51], v16 offset:2560
  v_pk_mul_f32 v[20:21], v[108:109], v[22:23]
  v_pk_add_f32 v[18:19], v[22:23], v[24:25]
  v_pk_fma_f32 v[20:21], v[110:111], v[24:25], v[20:21]
  v_add_f32 v18, v18, v19
  v_add_f32 v20, v20, v21
  s_cmpk_gt_i32 s69, 0x31
  s_cbranch_scc1 L_p39_4
  s_cmpk_gt_i32 s69, 0xb
  s_cbranch_scc1 L_p39_2
  s_waitcnt vmcnt(6)
L_p39_2:
  s_waitcnt vmcnt(9)
L_p39_4:
  s_waitcnt vmcnt(10)
  buffer_load_dwordx4 v[96:99], v219, s[32:35], s3 offen nt
  v_dot2_f32_bf16 v22, v205, v64, 0
  v_add_f32_dpp v35, v18, v18 row_ror:8 row_mask:0xf bank_mask:0xc
  v_add_f32_dpp v35, v20, v20 row_ror:8 row_mask:0xf bank_mask:0x3
  v_dot2_f32_bf16 v23, v210, v65, 0
  v_dot2_f32_bf16 v24, v208, v66, 0
  v_dot2_f32_bf16 v25, v211, v67, 0
  v_cvt_f32_i32 v112, v112
  v_cvt_f32_i32 v113, v113
  v_cvt_f32_i32 v114, v114
  v_cvt_f32_i32 v115, v115
  ds_read_b128 v[52:55], v17 offset:2560
  v_pk_mul_f32 v[20:21], v[112:113], v[22:23]
  v_pk_add_f32 v[18:19], v[22:23], v[24:25]
  v_pk_fma_f32 v[20:21], v[114:115], v[24:25], v[20:21]
  v_add_f32 v18, v18, v19
  v_add_f32 v20, v20, v21
  s_cmpk_gt_i32 s69, 0x31
  s_cbranch_scc1 L_p40_4
  s_cmpk_gt_i32 s69, 0x1d
  s_cbranch_scc1 L_p40_3
  s_cmpk_gt_i32 s69, 0xffcd
  s_cbranch_scc1 L_p40_0
  s_waitcnt vmcnt(6)
L_p40_0:
  s_waitcnt vmcnt(7)
L_p40_3:
  s_waitcnt vmcnt(10)
L_p40_4:
  s_waitcnt vmcnt(11)
  buffer_load_dwordx4 v[100:103], v220, s[32:35], s3 offen nt
  s_nop 0
  v_add_f32_dpp v21, v18, v18 row_ror:8 row_mask:0xf bank_mask:0xc
  v_add_f32_dpp v21, v20, v20 row_ror:8 row_mask:0xf bank_mask:0x3
  v_add_f32_dpp v20, v35, v35 row_half_mirror row_mask:0xf bank_mask:0x5
  s_nop 0
  v_add_f32_dpp v20, v21, v21 row_half_mirror row_mask:0xf bank_mask:0xa
  s_nop 1
  v_add_f32_dpp v20, v20, v20 quad_perm:[2,3,0,1] row_mask:0xf bank_mask:0xf
  s_nop 1
  v_add_f32_dpp v20, v20, v20 quad_perm:[1,0,3,2] row_mask:0xf bank_mask:0xf
  v_cndmask_b32_e64 v33, v33, v20, s[54:55]
  ds_write_b32 v1, v33 offset:4096
  v_mov_b32 v9, 2
  ds_write_b32 v6, v9 offset:0
  v_add_u32 v15, 2048, v15
  v_add_u32 v16, 2048, v16
  v_add_u32 v17, 2048, v17
  s_mov_b32 s43, 2
  s_movk_i32 s101, 6144
  s_mov_b32 s34, 1572864
  s_add_u32 s32, s32, s3
  s_addc_u32 s33, s33, 0
  s_mov_b32 s68, 3
  s_lshl_b32 s44, s68, 2
  s_lshr_b64 s[64:65], s[96:97], s44
  s_and_b32 s64, s64, 15
  s_lshl4_add_u32 s68, s68, s64
  s_mul_i32 s44, s68, 1572864
  s_add_u32 s36, s6, s44
  s_addc_u32 s37, s7, 0
.p2align 6
L_k:
  s_add_u32 s44, s43, 2
  s_min_u32 s47, s44, 16
  v_add_u32 v15, 1024, v15
  v_and_b32 v15, 0xfff, v15
  v_add_u32 v16, 1024, v16
  v_and_b32 v16, 0xfff, v16
  v_add_u32 v17, 1024, v17
  v_and_b32 v17, 0xfff, v17
  v_add_u32 v2, s101, v1
  s_addk_i32 s101, 3072
  s_cmpk_eq_u32 s101, 18432
  s_cselect_b32 s101, 0, s101
  s_waitcnt lgkmcnt(0)
  s_waitcnt vmcnt(8)
  s_add_u32 s44, s78, 0x03030303
  v_msad_u8 v9, s78, v36, 0
  v_msad_u8 v10, s44, v36, 0
  v_msad_u8 v9, s78, v37, v9
  v_msad_u8 v10, s44, v37, v10
  v_msad_u8 v9, s78, v38, v9
  v_msad_u8 v10, s44, v38, v10
  s_mov_b64 exec, 3
  global_store_byte v7, v8, s[30:31]
  global_load_dwordx3 v[36:38], v236, s[30:31] sc1
  v_sub_u32 v9, v9, v10
  v_add_u32 v8, 1, v8
  s_mov_b64 exec, -1
  v_readlane_b32 s66, v9, 0
  v_readlane_b32 s67, v9, 1
  s_add_u32 s78, s78, 0x01010101
  s_lshl1_add_u32 s69, s91, s95
  s_add_u32 s95, s66, s67
  s_add_u32 s69, s69, s95
  v_dot2_f32_bf16 v22, v13, v44, 0
  v_dot2_f32_bf16 v23, v118, v45, 0
  v_dot2_f32_bf16 v24, v116, v46, 0
  v_dot2_f32_bf16 v25, v119, v47, 0
  v_cvt_f32_i32 v68, v68
  v_cvt_f32_i32 v69, v69
  v_cvt_f32_i32 v70, v70
  v_cvt_f32_i32 v71, v71
  v_pk_mul_f32 v[20:21], v[68:69], v[22:23]
  v_pk_add_f32 v[18:19], v[22:23], v[24:25]
  v_pk_fma_f32 v[20:21], v[70:71], v[24:25], v[20:21]
  v_add_f32 v18, v18, v19
  v_add_f32 v20, v20, v21
  s_cmpk_gt_i32 s69, 0x2d
  s_cbranch_scc1 L_p41_4
  s_cmpk_gt_i32 s69, 0xffe9
  s_cbranch_scc1 L_p41_1
  s_waitcnt vmcnt(5)
L_p41_1:
  s_waitcnt vmcnt(8)
L_p41_4:
  s_waitcnt vmcnt(9)
  buffer_load_dwordx4 v[104:107], v221, s[32:35], 0 offen nt
  v_dot2_f32_bf16 v22, v117, v48, 0
  v_add_f32_dpp v34, v18, v18 row_ror:8 row_mask:0xf bank_mask:0xc
  v_add_f32_dpp v34, v20, v20 row_ror:8 row_mask:0xf bank_mask:0x3
  v_dot2_f32_bf16 v23, v122, v49, 0
  v_dot2_f32_bf16 v24, v120, v50, 0
  v_dot2_f32_bf16 v25, v123, v51, 0
  v_cvt_f32_i32 v72, v72
  v_cvt_f32_i32 v73, v73
  v_cvt_f32_i32 v74, v74
  v_cvt_f32_i32 v75, v75
  v_pk_mul_f32 v[20:21], v[72:73], v[22:23]
  v_pk_add_f32 v[18:19], v[22:23], v[24:25]
  v_pk_fma_f32 v[20:21], v[74:75], v[24:25], v[20:21]
  v_add_f32 v18, v18, v19
  v_add_f32 v20, v20, v21
  s_cmpk_gt_i32 s69, 0x2d
  s_cbranch_scc1 L_p42_4
  s_cmpk_gt_i32 s69, 0x7
  s_cbranch_scc1 L_p42_2
  s_waitcnt vmcnt(6)
L_p42_2:
  s_waitcnt vmcnt(9)
L_p42_4:
  s_waitcnt vmcnt(10)
  buffer_load_dwordx4 v[108:111], v222, s[32:35], 0 offen nt
  v_dot2_f32_bf16 v22, v121, v52, 0
  v_add_f32_dpp v21, v18, v18 row_ror:8 row_mask:0xf bank_mask:0xc
  v_add_f32_dpp v21, v20, v20 row_ror:8 row_mask:0xf bank_mask:0x3
  v_add_f32_dpp v20, v34, v34 row_half_mirror row_mask:0xf bank_mask:0x5
  v_dot2_f32_bf16 v23, v126, v53, 0
  v_add_f32_dpp v20, v21, v21 row_half_mirror row_mask:0xf bank_mask:0xa
  v_dot2_f32_bf16 v24, v124, v54, 0
  v_dot2_f32_bf16 v25, v127, v55, 0
  v_add_f32_dpp v20, v20, v20 quad_perm:[2,3,0,1] row_mask:0xf bank_mask:0xf
  v_cvt_f32_i32 v76, v76
  v_cvt_f32_i32 v77, v77
  v_add_f32_dpp v20, v20, v20 quad_perm:[1,0,3,2] row_mask:0xf bank_mask:0xf
  v_cndmask_b32_e64 v32, v32, v20, s[48:49]
  v_cvt_f32_i32 v78, v78
  v_cvt_f32_i32 v79, v79
  v_pk_mul_f32 v[20:21], v[76:77], v[22:23]
  v_pk_add_f32 v[18:19], v[22:23], v[24:25]
  v_pk_fma_f32 v[20:21], v[78:79], v[24:25], v[20:21]
  v_add_f32 v18, v18, v19
  v_add_f32 v20, v20, v21
  s_cmpk_gt_i32 s69, 0x2d
  s_cbranch_scc1 L_p43_4
  s_cmpk_gt_i32 s69, 0x19
  s_cbranch_scc1 L_p43_3
  s_cmpk_gt_i32 s69, 0xffc9
  s_cbranch_scc1 L_p43_0
  s_waitcnt vmcnt(6)
L_p43_0:
  s_waitcnt vmcnt(7)
L_p43_3:
  s_waitcnt vmcnt(10)
L_p43_4:
  s_waitcnt vmcnt(11)
  buffer_load_dwordx4 v[112:115], v223, s[32:35], 0 offen nt
  s_waitcnt vmcnt(8)
  s_add_u32 s44, s78, 0x03030303
  v_msad_u8 v9, s78, v40, 0
  v_msad_u8 v10, s44, v40, 0
  v_msad_u8 v9, s78, v41, v9
  v_msad_u8 v10, s44, v41, v10
  v_msad_u8 v9, s78, v42, v9
  v_msad_u8 v10, s44, v42, v10
  s_mov_b64 exec, 3
  global_store_byte v7, v8, s[30:31]
  global_load_dwordx3 v[40:42], v237, s[30:31] sc1
  v_sub_u32 v9, v9, v10
  v_add_u32 v8, 1, v8
  s_mov_b64 exec, -1
  v_readlane_b32 s66, v9, 0
  v_readlane_b32 s67, v9, 1
  s_add_u32 s78, s78, 0x01010101
  s_lshl1_add_u32 s69, s91, s95
  s_add_u32 s95, s66, s67
  s_add_u32 s69, s69, s95
  v_dot2_f32_bf16 v22, v125, v44, 0
  v_add_f32_dpp v34, v18, v18 row_ror:8 row_mask:0xf bank_mask:0xc
  v_add_f32_dpp v34, v20, v20 row_ror:8 row_mask:0xf bank_mask:0x3
  v_dot2_f32_bf16 v23, v130, v45, 0
  v_dot2_f32_bf16 v24, v128, v46, 0
  v_dot2_f32_bf16 v25, v131, v47, 0
  v_cvt_f32_i32 v80, v80
  v_cvt_f32_i32 v81, v81
  v_cvt_f32_i32 v82, v82
  v_cvt_f32_i32 v83, v83
  v_pk_mul_f32 v[20:21], v[80:81], v[22:23]
  v_pk_add_f32 v[18:19], v[22:23], v[24:25]
  v_pk_fma_f32 v[20:21], v[82:83], v[24:25], v[20:21]
  v_add_f32 v18, v18, v19
  v_add_f32 v20, v20, v21
  s_cmpk_gt_i32 s69, 0x2d
  s_cbranch_scc1 L_p44_4
  s_cmpk_gt_i32 s69, 0xffe9
  s_cbranch_scc1 L_p44_1
  s_waitcnt vmcnt(5)
L_p44_1:
  s_waitcnt vmcnt(8)
L_p44_4:
  s_waitcnt vmcnt(9)
  buffer_load_dwordx4 v[68:71], v224, s[32:35], 0 offen nt
  v_dot2_f32_bf16 v22, v129, v48, 0
  v_add_f32_dpp v21, v18, v18 row_ror:8 row_mask:0xf bank_mask:0xc
  v_add_f32_dpp v21, v20, v20 row_ror:8 row_mask:0xf bank_mask:0x3
  v_add_f32_dpp v20, v34, v34 row_half_mirror row_mask:0xf bank_mask:0x5
  v_dot2_f32_bf16 v23, v134, v49, 0
  v_add_f32_dpp v20, v21, v21 row_half_mirror row_mask:0xf bank_mask:0xa
  v_dot2_f32_bf16 v24, v132, v50, 0
  v_dot2_f32_bf16 v25, v135, v51, 0
  v_add_f32_dpp v20, v20, v20 quad_perm:[2,3,0,1] row_mask:0xf bank_mask:0xf
  v_cvt_f32_i32 v84, v84
  v_cvt_f32_i32 v85, v85
  v_add_f32_dpp v20, v20, v20 quad_perm:[1,0,3,2] row_mask:0xf bank_mask:0xf
  v_cndmask_b32_e64 v32, v32, v20, s[50:51]
  v_cvt_f32_i32 v86, v86
  v_cvt_f32_i32 v87, v87
  v_pk_mul_f32 v[20:21], v[84:85], v[22:23]
  v_pk_add_f32 v[18:19], v[22:23], v[24:25]
  v_pk_fma_f32 v[20:21], v[86:87], v[24:25], v[20:21]
  v_add_f32 v18, v18, v19
  v_add_f32 v20, v20, v21
  s_cmpk_gt_i32 s69, 0x2d
  s_cbranch_scc1 L_p45_4
  s_cmpk_gt_i32 s69, 0x7
  s_cbranch_scc1 L_p45_2
  s_waitcnt vmcnt(6)
L_p45_2:
  s_waitcnt vmcnt(9)
L_p45_4:
  s_waitcnt vmcnt(10)
  buffer_load_dwordx4 v[72:75], v225, s[32:35], 0 offen nt
  v_dot2_f32_bf16 v22, v133, v52, 0
  v_add_f32_dpp v34, v18, v18 row_ror:8 row_mask:0xf bank_mask:0xc
  v_add_f32_dpp v34, v20, v20 row_ror:8 row_mask:0xf bank_mask:0x3
  v_dot2_f32_bf16 v23, v138, v53, 0
  v_dot2_f32_bf16 v24, v136, v54, 0
  v_dot2_f32_bf16 v25, v139, v55, 0
  v_cvt_f32_i32 v88, v88
  v_cvt_f32_i32 v89, v89
  v_cvt_f32_i32 v90, v90
  v_cvt_f32_i32 v91, v91
  v_pk_mul_f32 v[20:21], v[88:89], v[22:23]
  v_pk_add_f32 v[18:19], v[22:23], v[24:25]
  v_pk_fma_f32 v[20:21], v[90:91], v[24:25], v[20:21]
  v_add_f32 v18, v18, v19
  v_add_f32 v20, v20, v21
  s_cmpk_gt_i32 s69, 0x2d
  s_cbranch_scc1 L_p46_4
  s_cmpk_gt_i32 s69, 0x19
  s_cbranch_scc1 L_p46_3
  s_cmpk_gt_i32 s69, 0xffc9
  s_cbranch_scc1 L_p46_0
  s_waitcnt vmcnt(6)
L_p46_0:
  s_waitcnt vmcnt(7)
L_p46_3:
  s_waitcnt vmcnt(10)
L_p46_4:
  s_waitcnt vmcnt(11)
  buffer_load_dwordx4 v[76:79], v226, s[32:35], 0 offen nt
  v_mov_b32 v9, s43
  ds_write_b32 v14, v9 offset:28
  s_waitcnt vmcnt(8)
  s_add_u32 s44, s78, 0x03030303
  v_msad_u8 v9, s78, v36, 0
  v_msad_u8 v10, s44, v36, 0
  v_msad_u8 v9, s78, v37, v9
  v_msad_u8 v10, s44, v37, v10
  v_msad_u8 v9, s78, v38, v9
  v_msad_u8 v10, s44, v38, v10
  s_mov_b64 exec, 3
  global_store_byte v7, v8, s[30:31]
  global_load_dwordx3 v[36:38], v238, s[30:31] sc1
  v_sub_u32 v9, v9, v10
  v_add_u32 v8, 1, v8
  s_mov_b64 exec, -1
  v_readlane_b32 s66, v9, 0
  v_readlane_b32 s67, v9, 1
  s_add_u32 s78, s78, 0x01010101
  s_lshl1_add_u32 s69, s91, s95
  s_add_u32 s95, s66, s67
  s_add_u32 s69, s69, s95
  v_dot2_f32_bf16 v22, v137, v44, 0
  v_add_f32_dpp v21, v18, v18 row_ror:8 row_mask:0xf bank_mask:0xc
  v_add_f32_dpp v21, v20, v20 row_ror:8 row_mask:0xf bank_mask:0x3
  v_add_f32_dpp v20, v34, v34 row_half_mirror row_mask:0xf bank_mask:0x5
  v_dot2_f32_bf16 v23, v142, v45, 0
  v_add_f32_dpp v20, v21, v21 row_half_mirror row_mask:0xf bank_mask:0xa
  v_dot2_f32_bf16 v24, v140, v46, 0
  v_dot2_f32_bf16 v25, v143, v47, 0
  v_add_f32_dpp v20, v20, v20 quad_perm:[2,3,0,1] row_mask:0xf bank_mask:0xf
  v_cvt_f32_i32 v92, v92
  v_cvt_f32_i32 v93, v93
  v_add_f32_dpp v20, v20, v20 quad_perm:[1,0,3,2] row_mask:0xf bank_mask:0xf
  v_cndmask_b32_e64 v32, v32, v20, s[52:53]
  v_cvt_f32_i32 v94, v94
  v_cvt_f32_i32 v95, v95
  v_pk_mul_f32 v[20:21], v[92:93], v[22:23]
  v_pk_add_f32 v[18:19], v[22:23], v[24:25]
  v_pk_fma_f32 v[20:21], v[94:95], v[24:25], v[20:21]
  v_add_f32 v18, v18, v19
  v_add_f32 v20, v20, v21
  s_cmpk_gt_i32 s69, 0x2d
  s_cbranch_scc1 L_p47_4
  s_cmpk_gt_i32 s69, 0xffe9
  s_cbranch_scc1 L_p47_1
  s_waitcnt vmcnt(5)
L_p47_1:
  s_waitcnt vmcnt(8)
L_p47_4:
  s_waitcnt vmcnt(9)
  buffer_load_dwordx4 v[80:83], v227, s[32:35], 0 offen nt
  v_dot2_f32_bf16 v22, v141, v48, 0
  v_add_f32_dpp v34, v18, v18 row_ror:8 row_mask:0xf bank_mask:0xc
  v_add_f32_dpp v34, v20, v20 row_ror:8 row_mask:0xf bank_mask:0x3
  v_dot2_f32_bf16 v23, v146, v49, 0
  v_dot2_f32_bf16 v24, v144, v50, 0
  v_dot2_f32_bf16 v25, v147, v51, 0
  v_cvt_f32_i32 v96, v96
  v_cvt_f32_i32 v97, v97
  v_cvt_f32_i32 v98, v98
  v_cvt_f32_i32 v99, v99
  v_pk_mul_f32 v[20:21], v[96:97], v[22:23]
  v_pk_add_f32 v[18:19], v[22:23], v[24:25]
  v_pk_fma_f32 v[20:21], v[98:99], v[24:25], v[20:21]
  v_add_f32 v18, v18, v19
  v_add_f32 v20, v20, v21
  s_cmpk_gt_i32 s69, 0x2d
  s_cbranch_scc1 L_p48_4
  s_cmpk_gt_i32 s69, 0x7
  s_cbranch_scc1 L_p48_2
  s_waitcnt vmcnt(6)
L_p48_2:
  s_waitcnt vmcnt(9)
L_p48_4:
  s_waitcnt vmcnt(10)
  buffer_load_dwordx4 v[84:87], v228, s[32:35], 0 offen nt
  v_dot2_f32_bf16 v22, v145, v52, 0
  v_add_f32_dpp v21, v18, v18 row_ror:8 row_mask:0xf bank_mask:0xc
  v_add_f32_dpp v21, v20, v20 row_ror:8 row_mask:0xf bank_mask:0x3
  v_add_f32_dpp v20, v34, v34 row_half_mirror row_mask:0xf bank_mask:0x5
  v_dot2_f32_bf16 v23, v150, v53, 0
  v_add_f32_dpp v20, v21, v21 row_half_mirror row_mask:0xf bank_mask:0xa
  v_dot2_f32_bf16 v24, v148, v54, 0
  v_dot2_f32_bf16 v25, v151, v55, 0
  v_add_f32_dpp v20, v20, v20 quad_perm:[2,3,0,1] row_mask:0xf bank_mask:0xf
  v_cvt_f32_i32 v100, v100
  v_cvt_f32_i32 v101, v101
  v_add_f32_dpp v20, v20, v20 quad_perm:[1,0,3,2] row_mask:0xf bank_mask:0xf
  v_cndmask_b32_e64 v32, v32, v20, s[54:55]
  ds_write_b32 v2, v32 offset:0
  v_cvt_f32_i32 v102, v102
  v_cvt_f32_i32 v103, v103
  v_pk_mul_f32 v[20:21], v[100:101], v[22:23]
  v_pk_add_f32 v[18:19], v[22:23], v[24:25]
  v_pk_fma_f32 v[20:21], v[102:103], v[24:25], v[20:21]
  v_add_f32 v18, v18, v19
  v_add_f32 v20, v20, v21
  s_cmpk_gt_i32 s69, 0x2d
  s_cbranch_scc1 L_p49_4
  s_cmpk_gt_i32 s69, 0x19
  s_cbranch_scc1 L_p49_3
  s_cmpk_gt_i32 s69, 0xffc9
  s_cbranch_scc1 L_p49_0
  s_waitcnt vmcnt(6)
L_p49_0:
  s_waitcnt vmcnt(7)
L_p49_3:
  s_waitcnt vmcnt(10)
L_p49_4:
  s_waitcnt vmcnt(11)
  buffer_load_dwordx4 v[88:91], v229, s[32:35], 0 offen nt
  s_waitcnt vmcnt(8)
  s_add_u32 s44, s78, 0x03030303
  v_msad_u8 v9, s78, v40, 0
  v_msad_u8 v10, s44, v40, 0
  v_msad_u8 v9, s78, v41, v9
  v_msad_u8 v10, s44, v41, v10
  v_msad_u8 v9, s78, v42, v9
  v_msad_u8 v10, s44, v42, v10
  s_mov_b64 exec, 3
  global_store_byte v7, v8, s[30:31]
  global_load_dwordx3 v[40:42], v239, s[30:31] sc1
  v_sub_u32 v9, v9, v10
  v_add_u32 v8, 1, v8
  s_mov_b64 exec, -1
  v_readlane_b32 s66, v9, 0
  v_readlane_b32 s67, v9, 1
  s_add_u32 s78, s78, 0x01010101
  s_lshl1_add_u32 s69, s91, s95
  s_add_u32 s95, s66, s67
  s_add_u32 s69, s69, s95
  v_dot2_f32_bf16 v22, v149, v44, 0
  v_add_f32_dpp v34, v18, v18 row_ror:8 row_mask:0xf bank_mask:0xc
  v_add_f32_dpp v34, v20, v20 row_ror:8 row_mask:0xf bank_mask:0x3
  v_dot2_f32_bf16 v23, v154, v45, 0
  v_dot2_f32_bf16 v24, v152, v46, 0
  v_dot2_f32_bf16 v25, v155, v47, 0
  v_cvt_f32_i32 v104, v104
  v_cvt_f32_i32 v105, v105
  v_cvt_f32_i32 v106, v106
  v_cvt_f32_i32 v107, v107
  v_pk_mul_f32 v[20:21], v[104:105], v[22:23]
  v_pk_add_f32 v[18:19], v[22:23], v[24:25]
  v_pk_fma_f32 v[20:21], v[106:107], v[24:25], v[20:21]
  v_add_f32 v18, v18, v19
  v_add_f32 v20, v20, v21
  s_cmpk_gt_i32 s69, 0x2d
  s_cbranch_scc1 L_p50_4
  s_cmpk_gt_i32 s69, 0xffe9
  s_cbranch_scc1 L_p50_1
  s_waitcnt vmcnt(5)
L_p50_1:
  s_waitcnt vmcnt(8)
L_p50_4:
  s_waitcnt vmcnt(9)
  buffer_load_dwordx4 v[92:95], v230, s[32:35], 0 offen nt
  v_dot2_f32_bf16 v22, v153, v48, 0
  v_add_f32_dpp v21, v18, v18 row_ror:8 row_mask:0xf bank_mask:0xc
  v_add_f32_dpp v21, v20, v20 row_ror:8 row_mask:0xf bank_mask:0x3
  v_add_f32_dpp v20, v34, v34 row_half_mirror row_mask:0xf bank_mask:0x5
  v_dot2_f32_bf16 v23, v158, v49, 0
  v_add_f32_dpp v20, v21, v21 row_half_mirror row_mask:0xf bank_mask:0xa
  v_dot2_f32_bf16 v24, v156, v50, 0
  v_dot2_f32_bf16 v25, v159, v51, 0
  v_add_f32_dpp v20, v20, v20 quad_perm:[2,3,0,1] row_mask:0xf bank_mask:0xf
  v_cvt_f32_i32 v108, v108
  v_cvt_f32_i32 v109, v109
  v_add_f32_dpp v20, v20, v20 quad_perm:[1,0,3,2] row_mask:0xf bank_mask:0xf
  v_cndmask_b32_e64 v32, v32, v20, s[48:49]
  v_cvt_f32_i32 v110, v110
  v_cvt_f32_i32 v111, v111
  v_pk_mul_f32 v[20:21], v[108:109], v[22:23]
  v_pk_add_f32 v[18:19], v[22:23], v[24:25]
  v_pk_fma_f32 v[20:21], v[110:111], v[24:25], v[20:21]
  v_add_f32 v18, v18, v19
  v_add_f32 v20, v20, v21
  s_cmpk_gt_i32 s69, 0x2d
  s_cbranch_scc1 L_p51_4
  s_cmpk_gt_i32 s69, 0x7
  s_cbranch_scc1 L_p51_2
  s_waitcnt vmcnt(6)
L_p51_2:
  s_waitcnt vmcnt(9)
L_p51_4:
  s_waitcnt vmcnt(10)
  buffer_load_dwordx4 v[96:99], v231, s[32:35], 0 offen nt
  v_dot2_f32_bf16 v22, v157, v52, 0
  v_add_f32_dpp v34, v18, v18 row_ror:8 row_mask:0xf bank_mask:0xc
  v_add_f32_dpp v34, v20, v20 row_ror:8 row_mask:0xf bank_mask:0x3
  v_dot2_f32_bf16 v23, v162, v53, 0
  v_dot2_f32_bf16 v24, v160, v54, 0
  v_dot2_f32_bf16 v25, v163, v55, 0
  v_cvt_f32_i32 v112, v112
  v_cvt_f32_i32 v113, v113
  v_cvt_f32_i32 v114, v114
  v_cvt_f32_i32 v115, v115
  v_pk_mul_f32 v[20:21], v[112:113], v[22:23]
  v_pk_add_f32 v[18:19], v[22:23], v[24:25]
  v_pk_fma_f32 v[20:21], v[114:115], v[24:25], v[20:21]
  v_add_f32 v18, v18, v19
  v_add_f32 v20, v20, v21
  s_cmpk_gt_i32 s69, 0x2d
  s_cbranch_scc1 L_p52_4
  s_cmpk_gt_i32 s69, 0x19
  s_cbranch_scc1 L_p52_3
  s_cmpk_gt_i32 s69, 0xffc9
  s_cbranch_scc1 L_p52_0
  s_waitcnt vmcnt(6)
L_p52_0:
  s_waitcnt vmcnt(7)
L_p52_3:
  s_waitcnt vmcnt(10)
L_p52_4:
  s_waitcnt vmcnt(11)
  buffer_load_dwordx4 v[100:103], v232, s[32:35], 0 offen nt
  s_waitcnt vmcnt(8)
  s_add_u32 s44, s78, 0x03030303
  v_msad_u8 v9, s78, v36, 0
  v_msad_u8 v10, s44, v36, 0
  v_msad_u8 v9, s78, v37, v9
  v_msad_u8 v10, s44, v37, v10
  v_msad_u8 v9, s78, v38, v9
  v_msad_u8 v10, s44, v38, v10
  s_mov_b64 exec, 3
  global_store_byte v7, v8, s[30:31]
  global_load_dwordx3 v[36:38], v236, s[30:31] sc1
  v_sub_u32 v9, v9, v10
  v_add_u32 v8, 1, v8
  s_mov_b64 exec, -1
  v_readlane_b32 s66, v9, 0
  v_readlane_b32 s67, v9, 1
  s_add_u32 s78, s78, 0x01010101
  s_lshl1_add_u32 s69, s91, s95
  s_add_u32 s95, s66, s67
  s_add_u32 s69, s69, s95
  v_dot2_f32_bf16 v22, v161, v44, 0
  v_add_f32_dpp v21, v18, v18 row_ror:8 row_mask:0xf bank_mask:0xc
  v_add_f32_dpp v21, v20, v20 row_ror:8 row_mask:0xf bank_mask:0x3
  v_add_f32_dpp v20, v34, v34 row_half_mirror row_mask:0xf bank_mask:0x5
  v_dot2_f32_bf16 v23, v166, v45, 0
  v_add_f32_dpp v20, v21, v21 row_half_mirror row_mask:0xf bank_mask:0xa
  v_dot2_f32_bf16 v24, v164, v46, 0
  v_dot2_f32_bf16 v25, v167, v47, 0
  v_add_f32_dpp v20, v20, v20 quad_perm:[2,3,0,1] row_mask:0xf bank_mask:0xf
  v_cvt_f32_i32 v68, v68
  v_cvt_f32_i32 v69, v69
  v_add_f32_dpp v20, v20, v20 quad_perm:[1,0,3,2] row_mask:0xf bank_mask:0xf
  v_cndmask_b32_e64 v32, v32, v20, s[50:51]
  v_cvt_f32_i32 v70, v70
  v_cvt_f32_i32 v71, v71
  v_pk_mul_f32 v[20:21], v[68:69], v[22:23]
  v_pk_add_f32 v[18:19], v[22:23], v[24:25]
  v_pk_fma_f32 v[20:21], v[70:71], v[24:25], v[20:21]
  v_add_f32 v18, v18, v19
  v_add_f32 v20, v20, v21
  s_cmpk_gt_i32 s69, 0x2d
  s_cbranch_scc1 L_p53_4
  s_cmpk_gt_i32 s69, 0xffe9
  s_cbranch_scc1 L_p53_1
  s_waitcnt vmcnt(5)
L_p53_1:
  s_waitcnt vmcnt(8)
L_p53_4:
  s_waitcnt vmcnt(9)
  buffer_load_dwordx4 v[104:107], v233, s[32:35], 0 offen nt
  v_dot2_f32_bf16 v22, v165, v48, 0
  v_add_f32_dpp v34, v18, v18 row_ror:8 row_mask:0xf bank_mask:0xc
  v_add_f32_dpp v34, v20, v20 row_ror:8 row_mask:0xf bank_mask:0x3
  v_dot2_f32_bf16 v23, v170, v49, 0
  v_dot2_f32_bf16 v24, v168, v50, 0
  v_dot2_f32_bf16 v25, v171, v51, 0
  v_cvt_f32_i32 v72, v72
  v_cvt_f32_i32 v73, v73
  v_cvt_f32_i32 v74, v74
  v_cvt_f32_i32 v75, v75
  v_pk_mul_f32 v[20:21], v[72:73], v[22:23]
  v_pk_add_f32 v[18:19], v[22:23], v[24:25]
  v_pk_fma_f32 v[20:21], v[74:75], v[24:25], v[20:21]
  v_add_f32 v18, v18, v19
  v_add_f32 v20, v20, v21
  s_cmpk_gt_i32 s69, 0x2d
  s_cbranch_scc1 L_p54_4
  s_cmpk_gt_i32 s69, 0x7
  s_cbranch_scc1 L_p54_2
  s_waitcnt vmcnt(6)
L_p54_2:
  s_waitcnt vmcnt(9)
L_p54_4:
  s_waitcnt vmcnt(10)
  buffer_load_dwordx4 v[108:111], v234, s[32:35], 0 offen nt
  v_dot2_f32_bf16 v22, v169, v52, 0
  v_add_f32_dpp v21, v18, v18 row_ror:8 row_mask:0xf bank_mask:0xc
  v_add_f32_dpp v21, v20, v20 row_ror:8 row_mask:0xf bank_mask:0x3
  v_add_f32_dpp v20, v34, v34 row_half_mirror row_mask:0xf bank_mask:0x5
  v_dot2_f32_bf16 v23, v174, v53, 0
  v_add_f32_dpp v20, v21, v21 row_half_mirror row_mask:0xf bank_mask:0xa
  v_dot2_f32_bf16 v24, v172, v54, 0
  v_dot2_f32_bf16 v25, v175, v55, 0
  v_add_f32_dpp v20, v20, v20 quad_perm:[2,3,0,1] row_mask:0xf bank_mask:0xf
  v_cvt_f32_i32 v76, v76
  v_cvt_f32_i32 v77, v77
  v_add_f32_dpp v20, v20, v20 quad_perm:[1,0,3,2] row_mask:0xf bank_mask:0xf
  v_cndmask_b32_e64 v32, v32, v20, s[52:53]
  v_cvt_f32_i32 v78, v78
  v_cvt_f32_i32 v79, v79
  v_pk_mul_f32 v[20:21], v[76:77], v[22:23]
  v_pk_add_f32 v[18:19], v[22:23], v[24:25]
  v_pk_fma_f32 v[20:21], v[78:79], v[24:25], v[20:21]
  v_add_f32 v18, v18, v19
  v_add_f32 v20, v20, v21
  s_cmpk_gt_i32 s69, 0x2d
  s_cbranch_scc1 L_p55_4
  s_cmpk_gt_i32 s69, 0x19
  s_cbranch_scc1 L_p55_3
  s_cmpk_gt_i32 s69, 0xffc9
  s_cbranch_scc1 L_p55_0
  s_waitcnt vmcnt(6)
L_p55_0:
  s_waitcnt vmcnt(7)
L_p55_3:
  s_waitcnt vmcnt(10)
L_p55_4:
  s_waitcnt vmcnt(11)
  buffer_load_dwordx4 v[112:115], v235, s[32:35], 0 offen nt
  s_waitcnt vmcnt(8)
  s_add_u32 s44, s78, 0x03030303
  v_msad_u8 v9, s78, v40, 0
  v_msad_u8 v10, s44, v40, 0
  v_msad_u8 v9, s78, v41, v9
  v_msad_u8 v10, s44, v41, v10
  v_msad_u8 v9, s78, v42, v9
  v_msad_u8 v10, s44, v42, v10
  s_mov_b64 exec, 3
  global_load_dwordx2 v[26:27], v11, s[30:31] sc1
  global_store_byte v7, v8, s[30:31]
  global_load_dwordx3 v[40:42], v237, s[30:31] sc1
  v_sub_u32 v9, v9, v10
  v_add_u32 v8, 1, v8
  s_mov_b64 exec, -1
  v_readlane_b32 s66, v9, 0
  v_readlane_b32 s67, v9, 1
  s_add_u32 s78, s78, 0x01010101
  s_lshl1_add_u32 s69, s91, s95
  s_add_u32 s95, s66, s67
  s_add_u32 s69, s69, s95
  v_dot2_f32_bf16 v22, v173, v44, 0
  v_add_f32_dpp v34, v18, v18 row_ror:8 row_mask:0xf bank_mask:0xc
  v_add_f32_dpp v34, v20, v20 row_ror:8 row_mask:0xf bank_mask:0x3
  v_dot2_f32_bf16 v23, v178, v45, 0
  v_dot2_f32_bf16 v24, v176, v46, 0
  v_dot2_f32_bf16 v25, v179, v47, 0
  v_cvt_f32_i32 v80, v80
  v_cvt_f32_i32 v81, v81
  v_cvt_f32_i32 v82, v82
  v_cvt_f32_i32 v83, v83
  v_pk_mul_f32 v[20:21], v[80:81], v[22:23]
  v_pk_add_f32 v[18:19], v[22:23], v[24:25]
  v_pk_fma_f32 v[20:21], v[82:83], v[24:25], v[20:21]
  v_add_f32 v18, v18, v19
  v_add_f32 v20, v20, v21
  s_cmpk_gt_i32 s69, 0x2d
  s_cbranch_scc1 L_p56_4
  s_cmpk_gt_i32 s69, 0xffe9
  s_cbranch_scc1 L_p56_1
  s_waitcnt vmcnt(6)
L_p56_1:
  s_waitcnt vmcnt(9)
L_p56_4:
  s_waitcnt vmcnt(10)
  buffer_load_dwordx4 v[68:71], v212, s[36:39], 0 offen nt
  v_dot2_f32_bf16 v22, v177, v48, 0
  v_add_f32_dpp v21, v18, v18 row_ror:8 row_mask:0xf bank_mask:0xc
  v_add_f32_dpp v21, v20, v20 row_ror:8 row_mask:0xf bank_mask:0x3
  v_add_f32_dpp v20, v34, v34 row_half_mirror row_mask:0xf bank_mask:0x5
  v_dot2_f32_bf16 v23, v182, v49, 0
  v_add_f32_dpp v20, v21, v21 row_half_mirror row_mask:0xf bank_mask:0xa
  v_dot2_f32_bf16 v24, v180, v50, 0
  v_dot2_f32_bf16 v25, v183, v51, 0
  v_add_f32_dpp v20, v20, v20 quad_perm:[2,3,0,1] row_mask:0xf bank_mask:0xf
  v_cvt_f32_i32 v84, v84
  v_cvt_f32_i32 v85, v85
  v_add_f32_dpp v20, v20, v20 quad_perm:[1,0,3,2] row_mask:0xf bank_mask:0xf
  v_cndmask_b32_e64 v32, v32, v20, s[54:55]
  ds_write_b32 v2, v32 offset:512
  v_cvt_f32_i32 v86, v86
  v_cvt_f32_i32 v87, v87
  v_pk_mul_f32 v[20:21], v[84:85], v[22:23]
  v_pk_add_f32 v[18:19], v[22:23], v[24:25]
  v_pk_fma_f32 v[20:21], v[86:87], v[24:25], v[20:21]
  v_add_f32 v18, v18, v19
  v_add_f32 v20, v20, v21
  s_cmpk_gt_i32 s69, 0x2d
  s_cbranch_scc1 L_p57_4
  s_cmpk_gt_i32 s69, 0x7
  s_cbranch_scc1 L_p57_2
  s_waitcnt vmcnt(7)
L_p57_2:
  s_waitcnt vmcnt(10)
L_p57_4:
  s_waitcnt vmcnt(11)
  buffer_load_dwordx4 v[72:75], v213, s[36:39], 0 offen nt
  v_dot2_f32_bf16 v22, v181, v52, 0
  v_add_f32_dpp v34, v18, v18 row_ror:8 row_mask:0xf bank_mask:0xc
  v_add_f32_dpp v34, v20, v20 row_ror:8 row_mask:0xf bank_mask:0x3
  v_dot2_f32_bf16 v23, v186, v53, 0
  v_dot2_f32_bf16 v24, v184, v54, 0
  v_dot2_f32_bf16 v25, v187, v55, 0
  v_cvt_f32_i32 v88, v88
  v_cvt_f32_i32 v89, v89
  v_cvt_f32_i32 v90, v90
  v_cvt_f32_i32 v91, v91
  v_pk_mul_f32 v[20:21], v[88:89], v[22:23]
  v_pk_add_f32 v[18:19], v[22:23], v[24:25]
  v_pk_fma_f32 v[20:21], v[90:91], v[24:25], v[20:21]
  v_add_f32 v18, v18, v19
  v_add_f32 v20, v20, v21
  s_cmpk_gt_i32 s69, 0x2d
  s_cbranch_scc1 L_p58_4
  s_cmpk_gt_i32 s69, 0x19
  s_cbranch_scc1 L_p58_3
  s_cmpk_gt_i32 s69, 0xffc9
  s_cbranch_scc1 L_p58_0
  s_waitcnt vmcnt(7)
L_p58_0:
  s_waitcnt vmcnt(8)
L_p58_3:
  s_waitcnt vmcnt(11)
L_p58_4:
  s_waitcnt vmcnt(12)
  buffer_load_dwordx4 v[76:79], v214, s[36:39], 0 offen nt
  ds_read_b32 v4, v14 offset:16
  s_waitcnt vmcnt(9)
  s_add_u32 s44, s78, 0x03030303
  v_msad_u8 v9, s78, v36, 0
  v_msad_u8 v10, s44, v36, 0
  v_msad_u8 v9, s78, v37, v9
  v_msad_u8 v10, s44, v37, v10
  v_msad_u8 v9, s78, v38, v9
  v_msad_u8 v10, s44, v38, v10
  s_mov_b64 exec, 3
  global_store_byte v7, v8, s[30:31]
  global_load_dwordx3 v[36:38], v238, s[30:31] sc1
  v_sub_u32 v9, v9, v10
  v_add_u32 v8, 1, v8
  s_mov_b64 exec, -1
  v_readlane_b32 s66, v9, 0
  v_readlane_b32 s67, v9, 1
  s_add_u32 s78, s78, 0x01010101
  s_lshl1_add_u32 s69, s91, s95
  s_add_u32 s95, s66, s67
  s_add_u32 s69, s69, s95
  v_dot2_f32_bf16 v22, v185, v44, 0
  v_add_f32_dpp v21, v18, v18 row_ror:8 row_mask:0xf bank_mask:0xc
  v_add_f32_dpp v21, v20, v20 row_ror:8 row_mask:0xf bank_mask:0x3
  v_add_f32_dpp v20, v34, v34 row_half_mirror row_mask:0xf bank_mask:0x5
  v_dot2_f32_bf16 v23, v190, v45, 0
  v_add_f32_dpp v20, v21, v21 row_half_mirror row_mask:0xf bank_mask:0xa
  v_dot2_f32_bf16 v24, v188, v46, 0
  v_dot2_f32_bf16 v25, v191, v47, 0
  v_add_f32_dpp v20, v20, v20 quad_perm:[2,3,0,1] row_mask:0xf bank_mask:0xf
  v_cvt_f32_i32 v92, v92
  v_cvt_f32_i32 v93, v93
  v_add_f32_dpp v20, v20, v20 quad_perm:[1,0,3,2] row_mask:0xf bank_mask:0xf
  v_cndmask_b32_e64 v32, v32, v20, s[48:49]
  v_cvt_f32_i32 v94, v94
  v_cvt_f32_i32 v95, v95
  v_pk_mul_f32 v[20:21], v[92:93], v[22:23]
  v_pk_add_f32 v[18:19], v[22:23], v[24:25]
  v_pk_fma_f32 v[20:21], v[94:95], v[24:25], v[20:21]
  v_add_f32 v18, v18, v19
  v_add_f32 v20, v20, v21
  s_cmpk_gt_i32 s69, 0x2d
  s_cbranch_scc1 L_p59_4
  s_cmpk_gt_i32 s69, 0xffe9
  s_cbranch_scc1 L_p59_1
  s_waitcnt vmcnt(5)
L_p59_1:
  s_waitcnt vmcnt(9)
L_p59_4:
  s_waitcnt vmcnt(10)
  buffer_load_dwordx4 v[80:83], v215, s[36:39], 0 offen nt
  v_dot2_f32_bf16 v22, v189, v48, 0
  v_add_f32_dpp v34, v18, v18 row_ror:8 row_mask:0xf bank_mask:0xc
  v_add_f32_dpp v34, v20, v20 row_ror:8 row_mask:0xf bank_mask:0x3
  v_dot2_f32_bf16 v23, v194, v49, 0
  v_dot2_f32_bf16 v24, v192, v50, 0
  v_dot2_f32_bf16 v25, v195, v51, 0
  v_cvt_f32_i32 v96, v96
  v_cvt_f32_i32 v97, v97
  v_cvt_f32_i32 v98, v98
  v_cvt_f32_i32 v99, v99
  v_pk_mul_f32 v[20:21], v[96:97], v[22:23]
  v_pk_add_f32 v[18:19], v[22:23], v[24:25]
  v_pk_fma_f32 v[20:21], v[98:99], v[24:25], v[20:21]
  v_add_f32 v18, v18, v19
  v_add_f32 v20, v20, v21
  s_cmpk_gt_i32 s69, 0x2d
  s_cbranch_scc1 L_p60_4
  s_cmpk_gt_i32 s69, 0x7
  s_cbranch_scc1 L_p60_2
  s_waitcnt vmcnt(6)
L_p60_2:
  s_waitcnt vmcnt(10)
L_p60_4:
  s_waitcnt vmcnt(11)
  buffer_load_dwordx4 v[84:87], v216, s[36:39], 0 offen nt
  v_dot2_f32_bf16 v22, v193, v52, 0
  v_add_f32_dpp v21, v18, v18 row_ror:8 row_mask:0xf bank_mask:0xc
  v_add_f32_dpp v21, v20, v20 row_ror:8 row_mask:0xf bank_mask:0x3
  v_add_f32_dpp v20, v34, v34 row_half_mirror row_mask:0xf bank_mask:0x5
  v_dot2_f32_bf16 v23, v198, v53, 0
  v_add_f32_dpp v20, v21, v21 row_half_mirror row_mask:0xf bank_mask:0xa
  v_dot2_f32_bf16 v24, v196, v54, 0
  v_dot2_f32_bf16 v25, v199, v55, 0
  v_add_f32_dpp v20, v20, v20 quad_perm:[2,3,0,1] row_mask:0xf bank_mask:0xf
  v_cvt_f32_i32 v100, v100
  v_cvt_f32_i32 v101, v101
  v_add_f32_dpp v20, v20, v20 quad_perm:[1,0,3,2] row_mask:0xf bank_mask:0xf
  v_cndmask_b32_e64 v32, v32, v20, s[50:51]
  v_cvt_f32_i32 v102, v102
  v_cvt_f32_i32 v103, v103
  v_pk_mul_f32 v[20:21], v[100:101], v[22:23]
  v_pk_add_f32 v[18:19], v[22:23], v[24:25]
  v_pk_fma_f32 v[20:21], v[102:103], v[24:25], v[20:21]
  v_add_f32 v18, v18, v19
  v_add_f32 v20, v20, v21
  s_cmpk_gt_i32 s69, 0x2d
  s_cbranch_scc1 L_p61_4
  s_cmpk_gt_i32 s69, 0x19
  s_cbranch_scc1 L_p61_3
  s_cmpk_gt_i32 s69, 0xffc9
  s_cbranch_scc1 L_p61_0
  s_waitcnt vmcnt(6)
L_p61_0:
  s_waitcnt vmcnt(7)
L_p61_3:
  s_waitcnt vmcnt(11)
L_p61_4:
  s_waitcnt vmcnt(12)
  buffer_load_dwordx4 v[88:91], v217, s[36:39], 0 offen nt
L_qn:
  s_waitcnt lgkmcnt(0)
  v_readfirstlane_b32 s46, v4
  s_cmp_ge_u32 s46, s47
  s_cbranch_scc1 L_qn_ok
  s_cmp_eq_u32 s94, 0
  s_cbranch_scc1 L_qn_ok
  s_sub_u32 s94, s94, 1
  ds_read_b32 v4, v14 offset:16
  s_branch L_qn
L_qn_ok:
  s_waitcnt vmcnt(8)
  s_add_u32 s44, s78, 0x03030303
  v_msad_u8 v9, s78, v40, 0
  v_msad_u8 v10, s44, v40, 0
  v_msad_u8 v9, s78, v41, v9
  v_msad_u8 v10, s44, v41, v10
  v_msad_u8 v9, s78, v42, v9
  v_msad_u8 v10, s44, v42, v10
  s_mov_b64 exec, 3
  global_store_byte v7, v8, s[30:31]
  global_load_dwordx3 v[40:42], v239, s[30:31] sc1
  v_sub_u32 v9, v9, v10
  v_add3_u32 v10, v26, v27, s58
  v_add_u32 v8, 1, v8
  s_mov_b64 exec, -1
  v_readlane_b32 s66, v9, 0
  v_readlane_b32 s67, v9, 1
  v_readlane_b32 s91, v10, 0
  s_add_u32 s78, s78, 0x01010101
  s_lshl1_add_u32 s69, s91, s95
  s_add_u32 s95, s66, s67
  s_add_u32 s69, s69, s95
  v_dot2_f32_bf16 v22, v197, v44, 0
  v_add_f32_dpp v34, v18, v18 row_ror:8 row_mask:0xf bank_mask:0xc
  v_add_f32_dpp v34, v20, v20 row_ror:8 row_mask:0xf bank_mask:0x3
  v_dot2_f32_bf16 v23, v202, v45, 0
  v_dot2_f32_bf16 v24, v200, v46, 0
  v_dot2_f32_bf16 v25, v203, v47, 0
  v_cvt_f32_i32 v104, v104
  v_cvt_f32_i32 v105, v105
  v_cvt_f32_i32 v106, v106
  v_cvt_f32_i32 v107, v107
  ds_read_b128 v[44:47], v15 offset:512
  v_pk_mul_f32 v[20:21], v[104:105], v[22:23]
  v_pk_add_f32 v[18:19], v[22:23], v[24:25]
  v_pk_fma_f32 v[20:21], v[106:107], v[24:25], v[20:21]
  v_add_f32 v18, v18, v19
  v_add_f32 v20, v20, v21
  s_cmpk_gt_i32 s69, 0x2d
  s_cbranch_scc1 L_p62_4
  s_cmpk_gt_i32 s69, 0xffe9
  s_cbranch_scc1 L_p62_1
  s_waitcnt vmcnt(5)
L_p62_1:
  s_waitcnt vmcnt(8)
L_p62_4:
  s_waitcnt vmcnt(9)
  buffer_load_dwordx4 v[92:95], v218, s[36:39], 0 offen nt
  v_dot2_f32_bf16 v22, v201, v48, 0
  v_add_f32_dpp v21, v18, v18 row_ror:8 row_mask:0xf bank_mask:0xc
  v_add_f32_dpp v21, v20, v20 row_ror:8 row_mask:0xf bank_mask:0x3
  v_add_f32_dpp v20, v34, v34 row_half_mirror row_mask:0xf bank_mask:0x5
  v_dot2_f32_bf16 v23, v206, v49, 0
  v_add_f32_dpp v20, v21, v21 row_half_mirror row_mask:0xf bank_mask:0xa
  v_dot2_f32_bf16 v24, v204, v50, 0
  v_dot2_f32_bf16 v25, v207, v51, 0
  v_add_f32_dpp v20, v20, v20 quad_perm:[2,3,0,1] row_mask:0xf bank_mask:0xf
  v_cvt_f32_i32 v108, v108
  v_cvt_f32_i32 v109, v109
  v_add_f32_dpp v20, v20, v20 quad_perm:[1,0,3,2] row_mask:0xf bank_mask:0xf
  v_cndmask_b32_e64 v32, v32, v20, s[52:53]
  v_cvt_f32_i32 v110, v110
  v_cvt_f32_i32 v111, v111
  ds_read_b128 v[48:51], v16 offset:512
  v_pk_mul_f32 v[20:21], v[108:109], v[22:23]
  v_pk_add_f32 v[18:19], v[22:23], v[24:25]
  v_pk_fma_f32 v[20:21], v[110:111], v[24:25], v[20:21]
  v_add_f32 v18, v18, v19
  v_add_f32 v20, v20, v21
  s_cmpk_gt_i32 s69, 0x2d
  s_cbranch_scc1 L_p63_4
  s_cmpk_gt_i32 s69, 0x7
  s_cbranch_scc1 L_p63_2
  s_waitcnt vmcnt(6)
L_p63_2:
  s_waitcnt vmcnt(9)
L_p63_4:
  s_waitcnt vmcnt(10)
  buffer_load_dwordx4 v[96:99], v219, s[36:39], 0 offen nt
  v_dot2_f32_bf16 v22, v205, v52, 0
  v_add_f32_dpp v34, v18, v18 row_ror:8 row_mask:0xf bank_mask:0xc
  v_add_f32_dpp v34, v20, v20 row_ror:8 row_mask:0xf bank_mask:0x3
  v_dot2_f32_bf16 v23, v210, v53, 0
  v_dot2_f32_bf16 v24, v208, v54, 0
  v_dot2_f32_bf16 v25, v211, v55, 0
  v_cvt_f32_i32 v112, v112
  v_cvt_f32_i32 v113, v113
  v_cvt_f32_i32 v114, v114
  v_cvt_f32_i32 v115, v115
  ds_read_b128 v[52:55], v17 offset:512
  v_pk_mul_f32 v[20:21], v[112:113], v[22:23]
  v_pk_add_f32 v[18:19], v[22:23], v[24:25]
  v_pk_fma_f32 v[20:21], v[114:115], v[24:25], v[20:21]
  v_add_f32 v18, v18, v19
  v_add_f32 v20, v20, v21
  s_cmpk_gt_i32 s69, 0x2d
  s_cbranch_scc1 L_p64_4
  s_cmpk_gt_i32 s69, 0x19
  s_cbranch_scc1 L_p64_3
  s_cmpk_gt_i32 s69, 0xffc9
  s_cbranch_scc1 L_p64_0
  s_waitcnt vmcnt(6)
L_p64_0:
  s_waitcnt vmcnt(7)
L_p64_3:
  s_waitcnt vmcnt(10)
L_p64_4:
  s_waitcnt vmcnt(11)
  buffer_load_dwordx4 v[100:103], v220, s[36:39], 0 offen nt
  s_nop 0
  v_add_f32_dpp v21, v18, v18 row_ror:8 row_mask:0xf bank_mask:0xc
  v_add_f32_dpp v21, v20, v20 row_ror:8 row_mask:0xf bank_mask:0x3
  v_add_f32_dpp v20, v34, v34 row_half_mirror row_mask:0xf bank_mask:0x5
  s_nop 0
  v_add_f32_dpp v20, v21, v21 row_half_mirror row_mask:0xf bank_mask:0xa
  s_nop 1
  v_add_f32_dpp v20, v20, v20 quad_perm:[2,3,0,1] row_mask:0xf bank_mask:0xf
  s_nop 1
  v_add_f32_dpp v20, v20, v20 quad_perm:[1,0,3,2] row_mask:0xf bank_mask:0xf
  v_cndmask_b32_e64 v32, v32, v20, s[54:55]
  ds_write_b32 v2, v32 offset:1024
  s_add_u32 s43, s43, 1
  v_mov_b32 v4, s43
  ds_write_b32 v6, v4 offset:0
  s_mov_b64 s[32:33], s[36:37]
  s_add_u32 s68, s43, 1
  s_sub_u32 s45, s68, 16
  s_lshl_b32 s46, s45, 2
  s_lshr_b64 s[64:65], s[92:93], s46
  s_and_b32 s46, s64, 15
  s_cmp_lt_u32 s68, 16
  s_cselect_b32 s68, s68, s46
  s_cselect_b32 s70, s6, s12
  s_cselect_b32 s71, s7, s13
  s_lshl_b32 s44, s68, 2
  s_lshr_b64 s[64:65], s[96:97], s44
  s_and_b32 s64, s64, 15
  s_lshl4_add_u32 s68, s68, s64
  s_mul_i32 s44, s68, 1572864
  s_add_u32 s36, s70, s44
  s_addc_u32 s37, s71, 0
  s_cmp_lt_u32 s43, 16
  s_cbranch_scc1 L_k
L_vpre:
  s_cmp_eq_u32 s41, 0
  s_cselect_b32 s44, 1, -1
  s_cselect_b32 s45, 0, -1
  s_mulk_i32 s44, 512
  s_add_u32 s82, s82, s44
  s_addc_u32 s83, s83, s45
  s_load_dword s98, s[82:83], 16
  v_lshrrev_b32 v116, 4, v0
  v_and_b32 v119, 15, v0
  v_and_or_b32 v120, v0, 7, 16
  v_lshl_add_u32 v119, v119, 4, v116
  v_mul_u32_u24 v119, 683, v119
  v_lshrrev_b32 v119, 11, v119
  v_lshlrev_b32 v119, 2, v119
  v_lshl_add_u32 v120, v120, 4, v116
  v_mul_u32_u24 v120, 683, v120
  v_lshrrev_b32 v120, 11, v120
  v_lshlrev_b32 v120, 2, v120
  s_mov_b64 vcc, 0
  s_mov_b32 s43, 0
  s_lshl_b32 s68, s43, 2
  s_lshr_b64 s[64:65], s[92:93], s68
  s_and_b32 s68, s64, 15
  s_add_u32 s47, s68, 1
  ds_read_b32 v4, v14 offset:20
L_a0:
  s_waitcnt lgkmcnt(0)
  v_readfirstlane_b32 s46, v4
  s_cmp_ge_u32 s46, s47
  s_cbranch_scc1 L_a0_ok
  s_cmp_eq_u32 s94, 0
  s_cbranch_scc1 L_a0_ok
  s_sub_u32 s94, s94, 1
  ds_read_b32 v4, v14 offset:20
  s_branch L_a0
L_a0_ok:
  v_lshl_add_u32 v121, s68, 9, v119
  v_lshl_add_u32 v122, s68, 9, v120
  ds_read_b32 v116, v121 offset:37376
  ds_read_b32 v117, v122 offset:37376
.p2align 6
L_v:
  s_add_u32 s45, s43, 1
  s_min_u32 s45, s45, 15
  s_lshl_b32 s68, s45, 2
  s_lshr_b64 s[64:65], s[92:93], s68
  s_and_b32 s68, s64, 15
  s_add_u32 s47, s68, 1
  v_lshl_add_u32 v121, s68, 9, v119
  v_lshl_add_u32 v122, s68, 9, v120
  s_waitcnt lgkmcnt(0)
  s_waitcnt vmcnt(8)
  s_add_u32 s44, s78, 0x03030303
  v_msad_u8 v9, s78, v36, 0
  v_msad_u8 v10, s44, v36, 0
  v_msad_u8 v9, s78, v37, v9
  v_msad_u8 v10, s44, v37, v10
  v_msad_u8 v9, s78, v38, v9
  v_msad_u8 v10, s44, v38, v10
  s_mov_b64 exec, 3
  global_store_byte v7, v8, s[30:31]
  global_load_dwordx3 v[36:38], v236, s[30:31] sc1
  v_sub_u32 v9, v9, v10
  v_add_u32 v8, 1, v8
  s_mov_b64 exec, -1
  v_readlane_b32 s66, v9, 0
  v_readlane_b32 s67, v9, 1
  s_add_u32 s78, s78, 0x01010101
  s_lshl1_add_u32 s69, s91, s95
  s_add_u32 s95, s66, s67
  s_add_u32 s69, s69, s95
  v_mov_b32_dpp v18, v116 row_newbcast:0 row_mask:0xf bank_mask:0xf
  v_cvt_f32_i32 v68, v68
  v_cvt_f32_i32 v69, v69
  v_cvt_f32_i32 v70, v70
  v_cvt_f32_i32 v71, v71
  v_pk_mul_f32 v[44:45], v[68:69], v[18:19] op_sel_hi:[1,0]
  v_pk_mul_f32 v[46:47], v[70:71], v[18:19] op_sel_hi:[1,0]
  s_cmpk_gt_i32 s69, 0x35
  s_cbranch_scc1 L_p65_4
  s_cmpk_gt_i32 s69, 0xfff1
  s_cbranch_scc1 L_p65_1
  s_waitcnt vmcnt(5)
L_p65_1:
  s_waitcnt vmcnt(8)
L_p65_4:
  s_waitcnt vmcnt(9)
  buffer_load_dwordx4 v[104:107], v221, s[32:35], 0 offen nt
  v_mov_b32_dpp v18, v116 row_newbcast:1 row_mask:0xf bank_mask:0xf
  v_cvt_f32_i32 v72, v72
  v_cvt_f32_i32 v73, v73
  v_cvt_f32_i32 v74, v74
  v_cvt_f32_i32 v75, v75
  v_pk_mul_f32 v[48:49], v[72:73], v[18:19] op_sel_hi:[1,0]
  v_pk_mul_f32 v[50:51], v[74:75], v[18:19] op_sel_hi:[1,0]
  s_cmpk_gt_i32 s69, 0x35
  s_cbranch_scc1 L_p66_4
  s_cmpk_gt_i32 s69, 0xf
  s_cbranch_scc1 L_p66_2
  s_waitcnt vmcnt(6)
L_p66_2:
  s_waitcnt vmcnt(9)
L_p66_4:
  s_waitcnt vmcnt(10)
  buffer_load_dwordx4 v[108:111], v222, s[32:35], 0 offen nt
  v_mov_b32_dpp v18, v116 row_newbcast:2 row_mask:0xf bank_mask:0xf
  v_cvt_f32_i32 v76, v76
  v_cvt_f32_i32 v77, v77
  v_cvt_f32_i32 v78, v78
  v_cvt_f32_i32 v79, v79
  v_pk_mul_f32 v[52:53], v[76:77], v[18:19] op_sel_hi:[1,0]
  v_pk_mul_f32 v[54:55], v[78:79], v[18:19] op_sel_hi:[1,0]
  s_cmpk_gt_i32 s69, 0x35
  s_cbranch_scc1 L_p67_4
  s_cmpk_gt_i32 s69, 0x21
  s_cbranch_scc1 L_p67_3
  s_cmpk_gt_i32 s69, 0xffd1
  s_cbranch_scc1 L_p67_0
  s_waitcnt vmcnt(6)
L_p67_0:
  s_waitcnt vmcnt(7)
L_p67_3:
  s_waitcnt vmcnt(10)
L_p67_4:
  s_waitcnt vmcnt(11)
  buffer_load_dwordx4 v[112:115], v223, s[32:35], 0 offen nt
  s_waitcnt vmcnt(8)
  s_add_u32 s44, s78, 0x03030303
  v_msad_u8 v9, s78, v40, 0
  v_msad_u8 v10, s44, v40, 0
  v_msad_u8 v9, s78, v41, v9
  v_msad_u8 v10, s44, v41, v10
  v_msad_u8 v9, s78, v42, v9
  v_msad_u8 v10, s44, v42, v10
  s_mov_b64 exec, 3
  global_store_byte v7, v8, s[30:31]
  global_load_dwordx3 v[40:42], v237, s[30:31] sc1
  v_sub_u32 v9, v9, v10
  v_add_u32 v8, 1, v8
  s_mov_b64 exec, -1
  v_readlane_b32 s66, v9, 0
  v_readlane_b32 s67, v9, 1
  s_add_u32 s78, s78, 0x01010101
  s_lshl1_add_u32 s69, s91, s95
  s_add_u32 s95, s66, s67
  s_add_u32 s69, s69, s95
  v_mov_b32_dpp v18, v116 row_newbcast:3 row_mask:0xf bank_mask:0xf
  v_cvt_f32_i32 v80, v80
  v_cvt_f32_i32 v81, v81
  v_cvt_f32_i32 v82, v82
  v_cvt_f32_i32 v83, v83
  v_pk_fma_f32 v[44:45], v[80:81], v[18:19], v[44:45] op_sel_hi:[1,0,1]
  v_pk_fma_f32 v[46:47], v[82:83], v[18:19], v[46:47] op_sel_hi:[1,0,1]
  s_cmpk_gt_i32 s69, 0x35
  s_cbranch_scc1 L_p68_4
  s_cmpk_gt_i32 s69, 0xfff1
  s_cbranch_scc1 L_p68_1
  s_waitcnt vmcnt(5)
L_p68_1:
  s_waitcnt vmcnt(8)
L_p68_4:
  s_waitcnt vmcnt(9)
  buffer_load_dwordx4 v[68:71], v224, s[32:35], 0 offen nt
  v_mov_b32_dpp v18, v116 row_newbcast:4 row_mask:0xf bank_mask:0xf
  v_cvt_f32_i32 v84, v84
  v_cvt_f32_i32 v85, v85
  v_cvt_f32_i32 v86, v86
  v_cvt_f32_i32 v87, v87
  v_pk_fma_f32 v[48:49], v[84:85], v[18:19], v[48:49] op_sel_hi:[1,0,1]
  v_pk_fma_f32 v[50:51], v[86:87], v[18:19], v[50:51] op_sel_hi:[1,0,1]
  s_cmpk_gt_i32 s69, 0x35
  s_cbranch_scc1 L_p69_4
  s_cmpk_gt_i32 s69, 0xf
  s_cbranch_scc1 L_p69_2
  s_waitcnt vmcnt(6)
L_p69_2:
  s_waitcnt vmcnt(9)
L_p69_4:
  s_waitcnt vmcnt(10)
  buffer_load_dwordx4 v[72:75], v225, s[32:35], 0 offen nt
  v_mov_b32_dpp v18, v116 row_newbcast:5 row_mask:0xf bank_mask:0xf
  v_cvt_f32_i32 v88, v88
  v_cvt_f32_i32 v89, v89
  v_cvt_f32_i32 v90, v90
  v_cvt_f32_i32 v91, v91
  v_pk_fma_f32 v[52:53], v[88:89], v[18:19], v[52:53] op_sel_hi:[1,0,1]
  v_pk_fma_f32 v[54:55], v[90:91], v[18:19], v[54:55] op_sel_hi:[1,0,1]
  s_cmpk_gt_i32 s69, 0x35
  s_cbranch_scc1 L_p70_4
  s_cmpk_gt_i32 s69, 0x21
  s_cbranch_scc1 L_p70_3
  s_cmpk_gt_i32 s69, 0xffd1
  s_cbranch_scc1 L_p70_0
  s_waitcnt vmcnt(6)
L_p70_0:
  s_waitcnt vmcnt(7)
L_p70_3:
  s_waitcnt vmcnt(10)
L_p70_4:
  s_waitcnt vmcnt(11)
  buffer_load_dwordx4 v[76:79], v226, s[32:35], 0 offen nt
  v_add_u32_e64 v9, s43, 16
  ds_write_b32 v14, v9 offset:28
  s_waitcnt vmcnt(8)
  s_add_u32 s44, s78, 0x03030303
  v_msad_u8 v9, s78, v36, 0
  v_msad_u8 v10, s44, v36, 0
  v_msad_u8 v9, s78, v37, v9
  v_msad_u8 v10, s44, v37, v10
  v_msad_u8 v9, s78, v38, v9
  v_msad_u8 v10, s44, v38, v10
  s_mov_b64 exec, 3
  global_store_byte v7, v8, s[30:31]
  global_load_dwordx3 v[36:38], v238, s[30:31] sc1
  v_sub_u32 v9, v9, v10
  v_add_u32 v8, 1, v8
  s_mov_b64 exec, -1
  v_readlane_b32 s66, v9, 0
  v_readlane_b32 s67, v9, 1
  s_add_u32 s78, s78, 0x01010101
  s_lshl1_add_u32 s69, s91, s95
  s_add_u32 s95, s66, s67
  s_add_u32 s69, s69, s95
  v_mov_b32_dpp v18, v116 row_newbcast:6 row_mask:0xf bank_mask:0xf
  v_cvt_f32_i32 v92, v92
  v_cvt_f32_i32 v93, v93
  v_cvt_f32_i32 v94, v94
  v_cvt_f32_i32 v95, v95
  v_pk_fma_f32 v[44:45], v[92:93], v[18:19], v[44:45] op_sel_hi:[1,0,1]
  v_pk_fma_f32 v[46:47], v[94:95], v[18:19], v[46:47] op_sel_hi:[1,0,1]
  s_cmpk_gt_i32 s69, 0x35
  s_cbranch_scc1 L_p71_4
  s_cmpk_gt_i32 s69, 0xfff1
  s_cbranch_scc1 L_p71_1
  s_waitcnt vmcnt(5)
L_p71_1:
  s_waitcnt vmcnt(8)
L_p71_4:
  s_waitcnt vmcnt(9)
  buffer_load_dwordx4 v[80:83], v227, s[32:35], 0 offen nt
  v_mov_b32_dpp v18, v116 row_newbcast:7 row_mask:0xf bank_mask:0xf
  v_cvt_f32_i32 v96, v96
  v_cvt_f32_i32 v97, v97
  v_cvt_f32_i32 v98, v98
  v_cvt_f32_i32 v99, v99
  v_pk_fma_f32 v[48:49], v[96:97], v[18:19], v[48:49] op_sel_hi:[1,0,1]
  v_pk_fma_f32 v[50:51], v[98:99], v[18:19], v[50:51] op_sel_hi:[1,0,1]
  s_cmpk_gt_i32 s69, 0x35
  s_cbranch_scc1 L_p72_4
  s_cmpk_gt_i32 s69, 0xf
  s_cbranch_scc1 L_p72_2
  s_waitcnt vmcnt(6)
L_p72_2:
  s_waitcnt vmcnt(9)
L_p72_4:
  s_waitcnt vmcnt(10)
  buffer_load_dwordx4 v[84:87], v228, s[32:35], 0 offen nt
  v_mov_b32_dpp v18, v116 row_newbcast:8 row_mask:0xf bank_mask:0xf
  v_cvt_f32_i32 v100, v100
  v_cvt_f32_i32 v101, v101
  v_cvt_f32_i32 v102, v102
  v_cvt_f32_i32 v103, v103
  v_pk_fma_f32 v[52:53], v[100:101], v[18:19], v[52:53] op_sel_hi:[1,0,1]
  v_pk_fma_f32 v[54:55], v[102:103], v[18:19], v[54:55] op_sel_hi:[1,0,1]
  s_cmpk_gt_i32 s69, 0x35
  s_cbranch_scc1 L_p73_4
  s_cmpk_gt_i32 s69, 0x21
  s_cbranch_scc1 L_p73_3
  s_cmpk_gt_i32 s69, 0xffd1
  s_cbranch_scc1 L_p73_0
  s_waitcnt vmcnt(6)
L_p73_0:
  s_waitcnt vmcnt(7)
L_p73_3:
  s_waitcnt vmcnt(10)
L_p73_4:
  s_waitcnt vmcnt(11)
  buffer_load_dwordx4 v[88:91], v229, s[32:35], 0 offen nt
  s_waitcnt vmcnt(8)
  s_add_u32 s44, s78, 0x03030303
  v_msad_u8 v9, s78, v40, 0
  v_msad_u8 v10, s44, v40, 0
  v_msad_u8 v9, s78, v41, v9
  v_msad_u8 v10, s44, v41, v10
  v_msad_u8 v9, s78, v42, v9
  v_msad_u8 v10, s44, v42, v10
  s_mov_b64 exec, 3
  global_store_byte v7, v8, s[30:31]
  global_load_dwordx3 v[40:42], v239, s[30:31] sc1
  v_sub_u32 v9, v9, v10
  v_add_u32 v8, 1, v8
  s_mov_b64 exec, -1
  v_readlane_b32 s66, v9, 0
  v_readlane_b32 s67, v9, 1
  s_add_u32 s78, s78, 0x01010101
  s_lshl1_add_u32 s69, s91, s95
  s_add_u32 s95, s66, s67
  s_add_u32 s69, s69, s95
  v_mov_b32_dpp v18, v116 row_newbcast:9 row_mask:0xf bank_mask:0xf
  v_cvt_f32_i32 v104, v104
  v_cvt_f32_i32 v105, v105
  v_cvt_f32_i32 v106, v106
  v_cvt_f32_i32 v107, v107
  v_pk_fma_f32 v[44:45], v[104:105], v[18:19], v[44:45] op_sel_hi:[1,0,1]
  v_pk_fma_f32 v[46:47], v[106:107], v[18:19], v[46:47] op_sel_hi:[1,0,1]
  s_cmpk_gt_i32 s69, 0x35
  s_cbranch_scc1 L_p74_4
  s_cmpk_gt_i32 s69, 0xfff1
  s_cbranch_scc1 L_p74_1
  s_waitcnt vmcnt(5)
L_p74_1:
  s_waitcnt vmcnt(8)
L_p74_4:
  s_waitcnt vmcnt(9)
  buffer_load_dwordx4 v[92:95], v230, s[32:35], 0 offen nt
  v_mov_b32_dpp v18, v116 row_newbcast:10 row_mask:0xf bank_mask:0xf
  v_cvt_f32_i32 v108, v108
  v_cvt_f32_i32 v109, v109
  v_cvt_f32_i32 v110, v110
  v_cvt_f32_i32 v111, v111
  v_pk_fma_f32 v[48:49], v[108:109], v[18:19], v[48:49] op_sel_hi:[1,0,1]
  v_pk_fma_f32 v[50:51], v[110:111], v[18:19], v[50:51] op_sel_hi:[1,0,1]
  s_cmpk_gt_i32 s69, 0x35
  s_cbranch_scc1 L_p75_4
  s_cmpk_gt_i32 s69, 0xf
  s_cbranch_scc1 L_p75_2
  s_waitcnt vmcnt(6)
L_p75_2:
  s_waitcnt vmcnt(9)
L_p75_4:
  s_waitcnt vmcnt(10)
  buffer_load_dwordx4 v[96:99], v231, s[32:35], 0 offen nt
  v_mov_b32_dpp v18, v116 row_newbcast:11 row_mask:0xf bank_mask:0xf
  v_cvt_f32_i32 v112, v112
  v_cvt_f32_i32 v113, v113
  v_cvt_f32_i32 v114, v114
  v_cvt_f32_i32 v115, v115
  v_pk_fma_f32 v[52:53], v[112:113], v[18:19], v[52:53] op_sel_hi:[1,0,1]
  v_pk_fma_f32 v[54:55], v[114:115], v[18:19], v[54:55] op_sel_hi:[1,0,1]
  s_cmpk_gt_i32 s69, 0x35
  s_cbranch_scc1 L_p76_4
  s_cmpk_gt_i32 s69, 0x21
  s_cbranch_scc1 L_p76_3
  s_cmpk_gt_i32 s69, 0xffd1
  s_cbranch_scc1 L_p76_0
  s_waitcnt vmcnt(6)
L_p76_0:
  s_waitcnt vmcnt(7)
L_p76_3:
  s_waitcnt vmcnt(10)
L_p76_4:
  s_waitcnt vmcnt(11)
  buffer_load_dwordx4 v[100:103], v232, s[32:35], 0 offen nt
  s_waitcnt vmcnt(8)
  s_add_u32 s44, s78, 0x03030303
  v_msad_u8 v9, s78, v36, 0
  v_msad_u8 v10, s44, v36, 0
  v_msad_u8 v9, s78, v37, v9
  v_msad_u8 v10, s44, v37, v10
  v_msad_u8 v9, s78, v38, v9
  v_msad_u8 v10, s44, v38, v10
  s_mov_b64 exec, 3
  global_store_byte v7, v8, s[30:31]
  global_load_dwordx3 v[36:38], v236, s[30:31] sc1
  v_sub_u32 v9, v9, v10
  v_add_u32 v8, 1, v8
  s_mov_b64 exec, -1
  v_readlane_b32 s66, v9, 0
  v_readlane_b32 s67, v9, 1
  s_add_u32 s78, s78, 0x01010101
  s_lshl1_add_u32 s69, s91, s95
  s_add_u32 s95, s66, s67
  s_add_u32 s69, s69, s95
  v_mov_b32_dpp v18, v116 row_newbcast:12 row_mask:0xf bank_mask:0xf
  v_cvt_f32_i32 v68, v68
  v_cvt_f32_i32 v69, v69
  v_cvt_f32_i32 v70, v70
  v_cvt_f32_i32 v71, v71
  v_pk_fma_f32 v[44:45], v[68:69], v[18:19], v[44:45] op_sel_hi:[1,0,1]
  v_pk_fma_f32 v[46:47], v[70:71], v[18:19], v[46:47] op_sel_hi:[1,0,1]
  s_cmpk_gt_i32 s69, 0x35
  s_cbranch_scc1 L_p77_4
  s_cmpk_gt_i32 s69, 0xfff1
  s_cbranch_scc1 L_p77_1
  s_waitcnt vmcnt(5)
L_p77_1:
  s_waitcnt vmcnt(8)
L_p77_4:
  s_waitcnt vmcnt(9)
  buffer_load_dwordx4 v[104:107], v233, s[32:35], 0 offen nt
  v_mov_b32_dpp v18, v116 row_newbcast:13 row_mask:0xf bank_mask:0xf
  v_cvt_f32_i32 v72, v72
  v_cvt_f32_i32 v73, v73
  v_cvt_f32_i32 v74, v74
  v_cvt_f32_i32 v75, v75
  v_pk_fma_f32 v[48:49], v[72:73], v[18:19], v[48:49] op_sel_hi:[1,0,1]
  v_pk_fma_f32 v[50:51], v[74:75], v[18:19], v[50:51] op_sel_hi:[1,0,1]
  s_cmpk_gt_i32 s69, 0x35
  s_cbranch_scc1 L_p78_4
  s_cmpk_gt_i32 s69, 0xf
  s_cbranch_scc1 L_p78_2
  s_waitcnt vmcnt(6)
L_p78_2:
  s_waitcnt vmcnt(9)
L_p78_4:
  s_waitcnt vmcnt(10)
  buffer_load_dwordx4 v[108:111], v234, s[32:35], 0 offen nt
  v_mov_b32_dpp v18, v116 row_newbcast:14 row_mask:0xf bank_mask:0xf
  v_cvt_f32_i32 v76, v76
  v_cvt_f32_i32 v77, v77
  v_cvt_f32_i32 v78, v78
  v_cvt_f32_i32 v79, v79
  v_pk_fma_f32 v[52:53], v[76:77], v[18:19], v[52:53] op_sel_hi:[1,0,1]
  v_pk_fma_f32 v[54:55], v[78:79], v[18:19], v[54:55] op_sel_hi:[1,0,1]
  s_cmpk_gt_i32 s69, 0x35
  s_cbranch_scc1 L_p79_4
  s_cmpk_gt_i32 s69, 0x21
  s_cbranch_scc1 L_p79_3
  s_cmpk_gt_i32 s69, 0xffd1
  s_cbranch_scc1 L_p79_0
  s_waitcnt vmcnt(6)
L_p79_0:
  s_waitcnt vmcnt(7)
L_p79_3:
  s_waitcnt vmcnt(10)
L_p79_4:
  s_waitcnt vmcnt(11)
  buffer_load_dwordx4 v[112:115], v235, s[32:35], 0 offen nt
  s_cbranch_vccnz L_vtail
  ds_read_b32 v4, v14 offset:20
  s_waitcnt vmcnt(8)
  s_add_u32 s44, s78, 0x03030303
  v_msad_u8 v9, s78, v40, 0
  v_msad_u8 v10, s44, v40, 0
  v_msad_u8 v9, s78, v41, v9
  v_msad_u8 v10, s44, v41, v10
  v_msad_u8 v9, s78, v42, v9
  v_msad_u8 v10, s44, v42, v10
  s_mov_b64 exec, 3
  global_load_dwordx2 v[26:27], v11, s[30:31] sc1
  global_store_byte v7, v8, s[30:31]
  global_load_dwordx3 v[40:42], v237, s[30:31] sc1
  v_sub_u32 v9, v9, v10
  v_add_u32 v8, 1, v8
  s_mov_b64 exec, -1
  v_readlane_b32 s66, v9, 0
  v_readlane_b32 s67, v9, 1
  s_add_u32 s78, s78, 0x01010101
  s_lshl1_add_u32 s69, s91, s95
  s_add_u32 s95, s66, s67
  s_add_u32 s69, s69, s95
  v_mov_b32_dpp v18, v116 row_newbcast:15 row_mask:0xf bank_mask:0xf
  v_cvt_f32_i32 v80, v80
  v_cvt_f32_i32 v81, v81
  v_cvt_f32_i32 v82, v82
  v_cvt_f32_i32 v83, v83
  v_pk_fma_f32 v[44:45], v[80:81], v[18:19], v[44:45] op_sel_hi:[1,0,1]
  v_pk_fma_f32 v[46:47], v[82:83], v[18:19], v[46:47] op_sel_hi:[1,0,1]
  s_cmpk_gt_i32 s69, 0x35
  s_cbranch_scc1 L_p80_4
  s_cmpk_gt_i32 s69, 0xfff1
  s_cbranch_scc1 L_p80_1
  s_waitcnt vmcnt(6)
L_p80_1:
  s_waitcnt vmcnt(9)
L_p80_4:
  s_waitcnt vmcnt(10)
  buffer_load_dwordx4 v[68:71], v212, s[36:39], 0 offen nt
  v_mov_b32_dpp v18, v117 row_newbcast:0 row_mask:0xf bank_mask:0xf
  v_cvt_f32_i32 v84, v84
  v_cvt_f32_i32 v85, v85
  v_cvt_f32_i32 v86, v86
  v_cvt_f32_i32 v87, v87
  v_pk_fma_f32 v[48:49], v[84:85], v[18:19], v[48:49] op_sel_hi:[1,0,1]
  v_pk_fma_f32 v[50:51], v[86:87], v[18:19], v[50:51] op_sel_hi:[1,0,1]
  s_cmpk_gt_i32 s69, 0x35
  s_cbranch_scc1 L_p81_4
  s_cmpk_gt_i32 s69, 0xf
  s_cbranch_scc1 L_p81_2
  s_waitcnt vmcnt(7)
L_p81_2:
  s_waitcnt vmcnt(10)
L_p81_4:
  s_waitcnt vmcnt(11)
  buffer_load_dwordx4 v[72:75], v213, s[36:39], 0 offen nt
  v_mov_b32_dpp v18, v117 row_newbcast:1 row_mask:0xf bank_mask:0xf
  v_cvt_f32_i32 v88, v88
  v_cvt_f32_i32 v89, v89
  v_cvt_f32_i32 v90, v90
  v_cvt_f32_i32 v91, v91
  v_pk_fma_f32 v[52:53], v[88:89], v[18:19], v[52:53] op_sel_hi:[1,0,1]
  v_pk_fma_f32 v[54:55], v[90:91], v[18:19], v[54:55] op_sel_hi:[1,0,1]
  s_cmpk_gt_i32 s69, 0x35
  s_cbranch_scc1 L_p82_4
  s_cmpk_gt_i32 s69, 0x21
  s_cbranch_scc1 L_p82_3
  s_cmpk_gt_i32 s69, 0xffd1
  s_cbranch_scc1 L_p82_0
  s_waitcnt vmcnt(7)
L_p82_0:
  s_waitcnt vmcnt(8)
L_p82_3:
  s_waitcnt vmcnt(11)
L_p82_4:
  s_waitcnt vmcnt(12)
  buffer_load_dwordx4 v[76:79], v214, s[36:39], 0 offen nt
L_an:
  s_waitcnt lgkmcnt(0)
  v_readfirstlane_b32 s46, v4
  s_cmp_ge_u32 s46, s47
  s_cbranch_scc1 L_an_ok
  s_cmp_eq_u32 s94, 0
  s_cbranch_scc1 L_an_ok
  s_sub_u32 s94, s94, 1
  ds_read_b32 v4, v14 offset:20
  s_branch L_an
L_an_ok:
  ds_read_b32 v116, v121 offset:37376
  ds_read_b32 v118, v122 offset:37376
  v_add_u32_e64 v9, s43, 16
  ds_write_b32 v14, v9 offset:24
  s_waitcnt vmcnt(9)
  s_add_u32 s44, s78, 0x03030303
  v_msad_u8 v9, s78, v36, 0
  v_msad_u8 v10, s44, v36, 0
  v_msad_u8 v9, s78, v37, v9
  v_msad_u8 v10, s44, v37, v10
  v_msad_u8 v9, s78, v38, v9
  v_msad_u8 v10, s44, v38, v10
  s_mov_b64 exec, 3
  global_store_byte v7, v8, s[30:31]
  global_load_dwordx3 v[36:38], v238, s[30:31] sc1
  v_sub_u32 v9, v9, v10
  v_add_u32 v8, 1, v8
  s_mov_b64 exec, -1
  v_readlane_b32 s66, v9, 0
  v_readlane_b32 s67, v9, 1
  s_add_u32 s78, s78, 0x01010101
  s_lshl1_add_u32 s69, s91, s95
  s_add_u32 s95, s66, s67
  s_add_u32 s69, s69, s95
  v_mov_b32_dpp v18, v117 row_newbcast:2 row_mask:0xf bank_mask:0xf
  v_cvt_f32_i32 v92, v92
  v_cvt_f32_i32 v93, v93
  v_cvt_f32_i32 v94, v94
  v_cvt_f32_i32 v95, v95
  v_pk_fma_f32 v[44:45], v[92:93], v[18:19], v[44:45] op_sel_hi:[1,0,1]
  v_pk_fma_f32 v[46:47], v[94:95], v[18:19], v[46:47] op_sel_hi:[1,0,1]
  s_cmpk_gt_i32 s69, 0x35
  s_cbranch_scc1 L_p83_4
  s_cmpk_gt_i32 s69, 0xfff1
  s_cbranch_scc1 L_p83_1
  s_waitcnt vmcnt(5)
L_p83_1:
  s_waitcnt vmcnt(9)
L_p83_4:
  s_waitcnt vmcnt(10)
  buffer_load_dwordx4 v[80:83], v215, s[36:39], 0 offen nt
  v_mov_b32_dpp v18, v117 row_newbcast:3 row_mask:0xf bank_mask:0xf
  v_cvt_f32_i32 v96, v96
  v_cvt_f32_i32 v97, v97
  v_cvt_f32_i32 v98, v98
  v_cvt_f32_i32 v99, v99
  v_pk_fma_f32 v[48:49], v[96:97], v[18:19], v[48:49] op_sel_hi:[1,0,1]
  v_pk_fma_f32 v[50:51], v[98:99], v[18:19], v[50:51] op_sel_hi:[1,0,1]
  s_cmpk_gt_i32 s69, 0x35
  s_cbranch_scc1 L_p84_4
  s_cmpk_gt_i32 s69, 0xf
  s_cbranch_scc1 L_p84_2
  s_waitcnt vmcnt(6)
L_p84_2:
  s_waitcnt vmcnt(10)
L_p84_4:
  s_waitcnt vmcnt(11)
  buffer_load_dwordx4 v[84:87], v216, s[36:39], 0 offen nt
  v_mov_b32_dpp v18, v117 row_newbcast:4 row_mask:0xf bank_mask:0xf
  v_cvt_f32_i32 v100, v100
  v_cvt_f32_i32 v101, v101
  v_cvt_f32_i32 v102, v102
  v_cvt_f32_i32 v103, v103
  v_pk_fma_f32 v[52:53], v[100:101], v[18:19], v[52:53] op_sel_hi:[1,0,1]
  v_pk_fma_f32 v[54:55], v[102:103], v[18:19], v[54:55] op_sel_hi:[1,0,1]
  s_cmpk_gt_i32 s69, 0x35
  s_cbranch_scc1 L_p85_4
  s_cmpk_gt_i32 s69, 0x21
  s_cbranch_scc1 L_p85_3
  s_cmpk_gt_i32 s69, 0xffd1
  s_cbranch_scc1 L_p85_0
  s_waitcnt vmcnt(6)
L_p85_0:
  s_waitcnt vmcnt(7)
L_p85_3:
  s_waitcnt vmcnt(11)
L_p85_4:
  s_waitcnt vmcnt(12)
  buffer_load_dwordx4 v[88:91], v217, s[36:39], 0 offen nt
  s_waitcnt vmcnt(8)
  s_add_u32 s44, s78, 0x03030303
  v_msad_u8 v9, s78, v40, 0
  v_msad_u8 v10, s44, v40, 0
  v_msad_u8 v9, s78, v41, v9
  v_msad_u8 v10, s44, v41, v10
  v_msad_u8 v9, s78, v42, v9
  v_msad_u8 v10, s44, v42, v10
  s_mov_b64 exec, 3
  global_store_byte v7, v8, s[30:31]
  global_load_dwordx3 v[40:42], v239, s[30:31] sc1
  v_sub_u32 v9, v9, v10
  v_add3_u32 v10, v26, v27, s58
  v_add_u32 v8, 1, v8
  s_mov_b64 exec, -1
  v_readlane_b32 s66, v9, 0
  v_readlane_b32 s67, v9, 1
  v_readlane_b32 s91, v10, 0
  s_add_u32 s78, s78, 0x01010101
  s_lshl1_add_u32 s69, s91, s95
  s_add_u32 s95, s66, s67
  s_add_u32 s69, s69, s95
  v_mov_b32_dpp v18, v117 row_newbcast:5 row_mask:0xf bank_mask:0xf
  v_cvt_f32_i32 v104, v104
  v_cvt_f32_i32 v105, v105
  v_cvt_f32_i32 v106, v106
  v_cvt_f32_i32 v107, v107
  v_pk_fma_f32 v[44:45], v[104:105], v[18:19], v[44:45] op_sel_hi:[1,0,1]
  v_pk_fma_f32 v[46:47], v[106:107], v[18:19], v[46:47] op_sel_hi:[1,0,1]
  s_cmpk_gt_i32 s69, 0x35
  s_cbranch_scc1 L_p86_4
  s_cmpk_gt_i32 s69, 0xfff1
  s_cbranch_scc1 L_p86_1
  s_waitcnt vmcnt(5)
L_p86_1:
  s_waitcnt vmcnt(8)
L_p86_4:
  s_waitcnt vmcnt(9)
  buffer_load_dwordx4 v[92:95], v218, s[36:39], 0 offen nt
  v_mov_b32_dpp v18, v117 row_newbcast:6 row_mask:0xf bank_mask:0xf
  v_cvt_f32_i32 v108, v108
  v_cvt_f32_i32 v109, v109
  v_cvt_f32_i32 v110, v110
  v_cvt_f32_i32 v111, v111
  v_pk_fma_f32 v[48:49], v[108:109], v[18:19], v[48:49] op_sel_hi:[1,0,1]
  v_pk_fma_f32 v[50:51], v[110:111], v[18:19], v[50:51] op_sel_hi:[1,0,1]
  s_cmpk_gt_i32 s69, 0x35
  s_cbranch_scc1 L_p87_4
  s_cmpk_gt_i32 s69, 0xf
  s_cbranch_scc1 L_p87_2
  s_waitcnt vmcnt(6)
L_p87_2:
  s_waitcnt vmcnt(9)
L_p87_4:
  s_waitcnt vmcnt(10)
  buffer_load_dwordx4 v[96:99], v219, s[36:39], 0 offen nt
  v_mov_b32_dpp v18, v117 row_newbcast:7 row_mask:0xf bank_mask:0xf
  v_cvt_f32_i32 v112, v112
  v_cvt_f32_i32 v113, v113
  v_cvt_f32_i32 v114, v114
  v_cvt_f32_i32 v115, v115
  v_pk_fma_f32 v[52:53], v[112:113], v[18:19], v[52:53] op_sel_hi:[1,0,1]
  v_pk_fma_f32 v[54:55], v[114:115], v[18:19], v[54:55] op_sel_hi:[1,0,1]
  s_cmpk_gt_i32 s69, 0x35
  s_cbranch_scc1 L_p88_4
  s_cmpk_gt_i32 s69, 0x21
  s_cbranch_scc1 L_p88_3
  s_cmpk_gt_i32 s69, 0xffd1
  s_cbranch_scc1 L_p88_0
  s_waitcnt vmcnt(6)
L_p88_0:
  s_waitcnt vmcnt(7)
L_p88_3:
  s_waitcnt vmcnt(10)
L_p88_4:
  s_waitcnt vmcnt(11)
  buffer_load_dwordx4 v[100:103], v220, s[36:39], 0 offen nt
  s_add_u32 s43, s43, 1
  v_permlane32_swap_b32 v44, v46
  v_permlane32_swap_b32 v45, v47
  v_permlane32_swap_b32 v48, v50
  v_permlane32_swap_b32 v49, v51
  v_permlane32_swap_b32 v52, v54
  v_permlane32_swap_b32 v53, v55
  v_add_f32 v44, v44, v50
  v_add_f32 v45, v45, v51
  v_add_f32 v48, v48, v54
  v_add_f32 v49, v49, v55
  v_add_f32 v52, v52, v46
  v_add_f32 v53, v53, v47
  s_add_u32 s44, s43, 16
  s_cmp_eq_u32 s43, 15
  s_cselect_b64 vcc, -1, 0
  v_mov_b32 v4, s44
  v_permlane16_swap_b32 v44, v45
  v_permlane16_swap_b32 v48, v49
  v_permlane16_swap_b32 v52, v53
  v_add_f32 v44, v44, v53
  v_add_f32 v48, v48, v45
  v_add_f32 v52, v52, v49
  s_waitcnt lgkmcnt(0)
  ds_write_b32 v3, v44 offset:0
  ds_write_b32 v3, v48 offset:256
  ds_write_b32 v3, v52 offset:512
  ds_write_b32 v6, v4 offset:0
  v_mov_b32 v117, v118
  v_add_u32 v3, 3072, v3
  s_mov_b64 s[32:33], s[36:37]
  s_add_u32 s45, s43, 1
  s_min_u32 s45, s45, 15
  s_lshl_b32 s68, s45, 2
  s_lshr_b64 s[64:65], s[92:93], s68
  s_and_b32 s68, s64, 15
  s_lshl_b32 s44, s68, 2
  s_lshr_b64 s[64:65], s[96:97], s44
  s_and_b32 s64, s64, 15
  s_lshl4_add_u32 s68, s68, s64
  s_mul_i32 s44, s68, 1572864
  s_add_u32 s36, s12, s44
  s_addc_u32 s37, s13, 0
  s_branch L_v
L_vtail:
  s_mul_i32 s44, s98, 1572864
  s_add_u32 s36, s12, s44
  s_addc_u32 s37, s13, 0
  s_cmp_eq_u32 s41, 0
  s_cselect_b32 s44, 43, -16
  s_cselect_b32 s44, s44, -43
  s_cselect_b32 s45, 0, -1
  s_mulk_i32 s44, 768
  s_add_u32 s36, s36, s44
  s_addc_u32 s37, s37, s45
  s_cmpk_gt_i32 s69, 0x11
  s_cselect_b32 s38, 0, s38
  s_mov_b32 exec_lo, 0x11111111
  s_mov_b32 exec_hi, 0x11111111
  buffer_load_dword v145, v233, s[36:39], 0 offen
  buffer_load_dword v146, v234, s[36:39], 0 offen
  buffer_load_dword v147, v235, s[36:39], 0 offen
  s_mov_b64 exec, -1
  s_waitcnt vmcnt(13)
  v_mov_b32_dpp v18, v116 row_newbcast:15 row_mask:0xf bank_mask:0xf
  v_cvt_f32_i32 v80, v80
  v_cvt_f32_i32 v81, v81
  v_cvt_f32_i32 v82, v82
  v_cvt_f32_i32 v83, v83
  v_pk_fma_f32 v[44:45], v[80:81], v[18:19], v[44:45] op_sel_hi:[1,0,1]
  v_pk_fma_f32 v[46:47], v[82:83], v[18:19], v[46:47] op_sel_hi:[1,0,1]
  s_waitcnt vmcnt(12)
  v_mov_b32_dpp v18, v117 row_newbcast:0 row_mask:0xf bank_mask:0xf
  v_cvt_f32_i32 v84, v84
  v_cvt_f32_i32 v85, v85
  v_cvt_f32_i32 v86, v86
  v_cvt_f32_i32 v87, v87
  v_pk_fma_f32 v[48:49], v[84:85], v[18:19], v[48:49] op_sel_hi:[1,0,1]
  v_pk_fma_f32 v[50:51], v[86:87], v[18:19], v[50:51] op_sel_hi:[1,0,1]
  s_waitcnt vmcnt(11)
  v_mov_b32_dpp v18, v117 row_newbcast:1 row_mask:0xf bank_mask:0xf
  v_cvt_f32_i32 v88, v88
  v_cvt_f32_i32 v89, v89
  v_cvt_f32_i32 v90, v90
  v_cvt_f32_i32 v91, v91
  v_pk_fma_f32 v[52:53], v[88:89], v[18:19], v[52:53] op_sel_hi:[1,0,1]
  v_pk_fma_f32 v[54:55], v[90:91], v[18:19], v[54:55] op_sel_hi:[1,0,1]
  s_waitcnt vmcnt(9)
  v_mov_b32_dpp v18, v117 row_newbcast:2 row_mask:0xf bank_mask:0xf
  v_cvt_f32_i32 v92, v92
  v_cvt_f32_i32 v93, v93
  v_cvt_f32_i32 v94, v94
  v_cvt_f32_i32 v95, v95
  v_pk_fma_f32 v[44:45], v[92:93], v[18:19], v[44:45] op_sel_hi:[1,0,1]
  v_pk_fma_f32 v[46:47], v[94:95], v[18:19], v[46:47] op_sel_hi:[1,0,1]
  s_waitcnt vmcnt(8)
  v_mov_b32_dpp v18, v117 row_newbcast:3 row_mask:0xf bank_mask:0xf
  v_cvt_f32_i32 v96, v96
  v_cvt_f32_i32 v97, v97
  v_cvt_f32_i32 v98, v98
  v_cvt_f32_i32 v99, v99
  v_pk_fma_f32 v[48:49], v[96:97], v[18:19], v[48:49] op_sel_hi:[1,0,1]
  v_pk_fma_f32 v[50:51], v[98:99], v[18:19], v[50:51] op_sel_hi:[1,0,1]
  s_waitcnt vmcnt(7)
  v_mov_b32_dpp v18, v117 row_newbcast:4 row_mask:0xf bank_mask:0xf
  v_cvt_f32_i32 v100, v100
  v_cvt_f32_i32 v101, v101
  v_cvt_f32_i32 v102, v102
  v_cvt_f32_i32 v103, v103
  v_pk_fma_f32 v[52:53], v[100:101], v[18:19], v[52:53] op_sel_hi:[1,0,1]
  v_pk_fma_f32 v[54:55], v[102:103], v[18:19], v[54:55] op_sel_hi:[1,0,1]
  s_waitcnt vmcnt(5)
  v_mov_b32_dpp v18, v117 row_newbcast:5 row_mask:0xf bank_mask:0xf
  v_cvt_f32_i32 v104, v104
  v_cvt_f32_i32 v105, v105
  v_cvt_f32_i32 v106, v106
  v_cvt_f32_i32 v107, v107
  v_pk_fma_f32 v[44:45], v[104:105], v[18:19], v[44:45] op_sel_hi:[1,0,1]
  v_pk_fma_f32 v[46:47], v[106:107], v[18:19], v[46:47] op_sel_hi:[1,0,1]
  s_waitcnt vmcnt(4)
  v_mov_b32_dpp v18, v117 row_newbcast:6 row_mask:0xf bank_mask:0xf
  v_cvt_f32_i32 v108, v108
  v_cvt_f32_i32 v109, v109
  v_cvt_f32_i32 v110, v110
  v_cvt_f32_i32 v111, v111
  v_pk_fma_f32 v[48:49], v[108:109], v[18:19], v[48:49] op_sel_hi:[1,0,1]
  v_pk_fma_f32 v[50:51], v[110:111], v[18:19], v[50:51] op_sel_hi:[1,0,1]
  v_permlane32_swap_b32 v44, v46
  v_permlane32_swap_b32 v45, v47
  v_permlane32_swap_b32 v48, v50
  v_permlane32_swap_b32 v49, v51
  v_add_f32 v44, v44, v50
  v_add_f32 v45, v45, v51
  s_waitcnt vmcnt(3)
  v_mov_b32_dpp v18, v117 row_newbcast:7 row_mask:0xf bank_mask:0xf
  v_cvt_f32_i32 v112, v112
  v_cvt_f32_i32 v113, v113
  v_cvt_f32_i32 v114, v114
  v_cvt_f32_i32 v115, v115
  v_pk_fma_f32 v[52:53], v[112:113], v[18:19], v[52:53] op_sel_hi:[1,0,1]
  v_pk_fma_f32 v[54:55], v[114:115], v[18:19], v[54:55] op_sel_hi:[1,0,1]
  v_permlane16_swap_b32 v44, v45
  s_nop 0
  v_permlane32_swap_b32 v52, v54
  v_permlane32_swap_b32 v53, v55
  v_add_f32 v48, v48, v54
  v_add_f32 v49, v49, v55
  v_add_f32 v52, v52, v46
  v_add_f32 v53, v53, v47
  v_permlane16_swap_b32 v48, v49
  v_add_f32 v48, v48, v45
  v_permlane16_swap_b32 v52, v53
  ds_write_b32 v3, v48 offset:256
  v_add_f32 v44, v44, v53
  v_add_f32 v52, v52, v49
  ds_write_b32 v3, v44 offset:0
  ds_write_b32 v3, v52 offset:512
  s_waitcnt lgkmcnt(0)
  s_barrier
  s_endpgm
L_helper:
  s_getreg_b32 s81, hwreg(HW_REG_HW_ID, 13, 2)
  s_getreg_b32 s79, hwreg(HW_REG_HW_ID, 8, 4)
  s_getreg_b32 s46, hwreg(HW_REG_XCC_ID, 0, 3)
  s_mul_i32 s46, s46, 4352
  s_add_u32 s46, s46, 8126464
  v_lshrrev_b32 v24, 1, v20
  v_lshl_add_u32 v42, v24, 8, s46
  v_and_b32 v24, 1, v20
  v_lshl_add_u32 v42, v24, 4, v42
  s_mov_b64 exec, 0x3ffff
  global_store_dwordx4 v42, v[48:51], s[30:31]
  s_mov_b64 exec, -1
  s_add_u32 s68, s42, 32
  s_mul_i32 s44, s68, 384
  s_add_u32 s32, s4, s44
  s_addc_u32 s33, s5, 0
  global_load_dwordx2 v[68:69], v26, s[32:33]
  global_load_dwordx2 v[70:71], v27, s[32:33]
  s_setprio 0
  s_getpc_b64 s[82:83]
L_pc89:
  s_lshl_b32 s44, s2, 6
  s_add_u32 s44, s44, L_order-L_pc89
  s_add_u32 s82, s82, s44
  s_addc_u32 s83, s83, 0
  s_load_dwordx2 s[92:93], s[82:83], 0
  s_load_dwordx2 s[96:97], s[82:83], 8
  s_mov_b32 s94, 4000000
  s_and_b32 s41, s2, 7
  s_lshl_b32 s41, s41, 1
  s_bitcmp1_b32 s2, 3
  s_addc_u32 s41, s41, 0
  s_load_dword s3, s[82:83], 24
  s_load_dwordx2 s[98:99], s[82:83], 16
  s_waitcnt vmcnt(0)
  ds_write_b32 v14, v38 offset:24
  s_waitcnt lgkmcnt(0)
  v_min_u32 v22, 2, v20
  v_lshlrev_b32 v23, 3, v22
  v_bfe_u32 v23, s99, v23, 8
  v_mul_u32_u24 v36, 4352, v23
  v_add_u32 v36, 7340032, v36
  v_and_b32 v23, 15, v23
  v_lshlrev_b32 v37, 4, v23
  v_lshl_add_u32 v22, v22, 4, s42
  v_mul_u32_u24 v45, 4352, v22
  v_add_u32 v45, 7340032, v45
  s_and_b32 s45, s81, 2
  s_lshl_b32 s44, s45, 9
  s_add_u32 s44, s44, s46
  v_add_u32 v44, s44, v20
  s_lshl_b32 s45, s45, 1
  s_add_u32 s46, s46, s45
  s_add_u32 s46, s46, 2048
  v_mov_b32 v43, s46
  v_mul_u32_u24 v39, 384, v20
  v_add_u32 v39, 7864320, v39
  v_mov_b32 v40, 0
  s_mov_b32 s47, 0
  s_mov_b32 s90, 0
  s_mov_b32 s80, 0
  v_add_u32 v33, 0, v20
  s_and_b32 s44, s41, 1
  v_add_u32 v23, s44, v33
  v_cmp_le_u32 vcc, 43, v23
  s_add_u32 s45, s44, 42
  v_mov_b32 v24, s45
  v_cndmask_b32 v24, 0, v24, vcc
  v_cmp_le_u32 vcc, 86, v23
  v_add_u32 v22, v33, v24
  s_sub_u32 s45, 43, s44
  v_mov_b32 v24, s45
  v_cndmask_b32 v24, 0, v24, vcc
  s_mul_i32 s44, s44, 43
  s_lshr_b32 s45, s41, 1
  s_lshl_b32 s45, s45, 8
  s_add_u32 s44, s44, s45
  v_add3_u32 v22, v22, v24, s44
  v_and_b32 v33, 255, v22
  v_lshlrev_b32 v33, 1, v33
  v_add_u32 v34, 64, v20
  s_and_b32 s44, s41, 1
  v_add_u32 v23, s44, v34
  v_cmp_le_u32 vcc, 43, v23
  s_add_u32 s45, s44, 42
  v_mov_b32 v24, s45
  v_cndmask_b32 v24, 0, v24, vcc
  v_cmp_le_u32 vcc, 86, v23
  v_add_u32 v22, v34, v24
  s_sub_u32 s45, 43, s44
  v_mov_b32 v24, s45
  v_cndmask_b32 v24, 0, v24, vcc
  s_mul_i32 s44, s44, 43
  s_lshr_b32 s45, s41, 1
  s_lshl_b32 s45, s45, 8
  s_add_u32 s44, s44, s45
  v_add3_u32 v22, v22, v24, s44
  v_and_b32 v34, 255, v22
  v_lshlrev_b32 v34, 1, v34
  v_lshlrev_b32 v46, 2, v20
  v_mul_u32_u24 v199, 12, v20
  v_add_u32 v199, 45568, v199
  s_mov_b32 s101, 0
  v_mov_b32 v47, 118912
  v_mov_b32 v51, -1
  v_mov_b32 v60, 0
  v_mov_b32 v61, 0
  v_mov_b32 v62, 0
  v_mov_b32 v63, 0
  v_mov_b32 v64, 0
  v_mov_b32 v65, 0
  v_mov_b32 v66, 0
  v_mov_b32 v67, 0
  s_and_b32 s45, s2, 7
  s_lshl_b32 s45, s45, 9
  v_and_b32 v22, 31, v20
  v_lshl_add_u32 v22, v22, 4, s45
  v_lshrrev_b32 v23, 5, v20
  v_lshl_add_u32 v22, v23, 16, v22
  v_lshlrev_b32 v23, 2, v23
  s_lshr_b32 s44, s96, 0
  v_bfe_u32 v24, s44, v23, 4
  v_lshl_add_u32 v188, v24, 12, v22
  v_add_u32 v22, 0x20000, v22
  s_lshr_b32 s44, s96, 8
  v_bfe_u32 v24, s44, v23, 4
  v_lshl_add_u32 v189, v24, 12, v22
  v_add_u32 v22, 0x20000, v22
  s_lshr_b32 s44, s96, 16
  v_bfe_u32 v24, s44, v23, 4
  v_lshl_add_u32 v190, v24, 12, v22
  v_add_u32 v22, 0x20000, v22
  s_lshr_b32 s44, s96, 24
  v_bfe_u32 v24, s44, v23, 4
  v_lshl_add_u32 v191, v24, 12, v22
  v_add_u32 v22, 0x20000, v22
  s_lshr_b32 s44, s97, 0
  v_bfe_u32 v24, s44, v23, 4
  v_lshl_add_u32 v192, v24, 12, v22
  v_add_u32 v22, 0x20000, v22
  s_lshr_b32 s44, s97, 8
  v_bfe_u32 v24, s44, v23, 4
  v_lshl_add_u32 v193, v24, 12, v22
  v_add_u32 v22, 0x20000, v22
  s_lshr_b32 s44, s97, 16
  v_bfe_u32 v24, s44, v23, 4
  v_lshl_add_u32 v194, v24, 12, v22
  v_add_u32 v22, 0x20000, v22
  s_lshr_b32 s44, s97, 24
  v_bfe_u32 v24, s44, v23, 4
  v_lshl_add_u32 v195, v24, 12, v22
  s_mov_b32 s69, 0
  s_movk_i32 m0, 4608
  s_branch L_hq_nl
L_hk:
  s_sub_u32 s47, s43, 1
L_hsw:
  ds_read_b128 v[104:107], v14 offset:0
  s_waitcnt lgkmcnt(0)
  v_min_u32 v104, v104, v105
  v_min3_u32 v104, v104, v106, v107
  s_nop 0
  v_readfirstlane_b32 s46, v104
  s_cmp_ge_u32 s46, s47
  s_cbranch_scc1 L_hsw_ok
  s_cmp_eq_u32 s94, 0
  s_cbranch_scc1 L_hsw_ok
  s_sub_u32 s94, s94, 1
  s_sleep 1
  s_branch L_hsw
L_hsw_ok:
  s_bitcmp1_b32 s80, s47
  s_cbranch_scc0 L_fas
  s_mul_i32 s44, s47, 384
  s_add_u32 s44, s44, 7864320
  s_movk_i32 s78, 1
  s_atomic_add s78, s[30:31], s44 glc
  s_mov_b64 exec, 1
  global_load_dword v41, v43, s[30:31] offset:8 sc1
  s_mov_b64 exec, -1
L_fas:
  s_cmp_lt_u32 s43, 5
  s_cbranch_scc1 L_hs_done
  s_add_u32 s68, s69, 2
  s_min_u32 s68, s68, s47
L_hs:
  ds_read_u16_d16_hi v60, v33 offset:4608
  ds_read_u16_d16_hi v61, v34 offset:4608
  ds_read_u16_d16_hi v62, v33 offset:12800
  ds_read_u16_d16_hi v63, v34 offset:12800
  ds_read_u16_d16_hi v64, v33 offset:20992
  ds_read_u16_d16_hi v65, v34 offset:20992
  ds_read_u16_d16_hi v66, v33 offset:29184
  ds_read_u16_d16_hi v67, v34 offset:29184
  v_add_u32 v200, s101, v199
  v_add_u32 v201, 1536, v200
  s_addk_i32 s101, 3072
  s_cmpk_eq_u32 s101, 18432
  s_cselect_b32 s101, 0, s101
  s_add_u32 s69, s69, 1
  s_waitcnt lgkmcnt(4)
  ds_read2_b32 v[76:77], v200 offset0:0 offset1:1
  ds_read_b32 v72, v200 offset:8
  ds_read2_b32 v[78:79], v200 offset0:192 offset1:193
  ds_read_b32 v73, v200 offset:776
  ds_read2_b32 v[80:81], v201 offset0:0 offset1:1
  ds_read_b32 v74, v201 offset:8
  ds_read2_b32 v[82:83], v201 offset0:192 offset1:193
  ds_read_b32 v75, v201 offset:776
  s_waitcnt lgkmcnt(0)
  v_add_f32 v76, v76, v77
  v_add_f32 v78, v78, v79
  v_add_f32 v80, v80, v81
  v_add_f32 v82, v82, v83
  v_add_f32 v72, v72, v76
  v_add_f32 v73, v73, v78
  v_add_f32 v74, v74, v80
  v_add_f32 v75, v75, v82
  v_fma_f32 v72, -v62, v74, v72
  v_fma_f32 v73, -v63, v75, v73
  v_mul_f32 v74, s67, v60
  v_mul_f32 v75, s67, v61
  v_mul_f32 v72, v72, v74
  v_mul_f32 v73, v73, v75
  v_max_f32 v48, v72, v73
  s_nop 1
  v_max_f32_dpp v48, v48, v48 row_ror:8 row_mask:0xf bank_mask:0xf
  s_nop 1
  v_max_f32_dpp v48, v48, v48 row_ror:4 row_mask:0xf bank_mask:0xf
  s_nop 1
  v_max_f32_dpp v48, v48, v48 row_ror:2 row_mask:0xf bank_mask:0xf
  s_nop 1
  v_max_f32_dpp v48, v48, v48 row_ror:1 row_mask:0xf bank_mask:0xf
  v_mov_b32 v22, v48
  s_nop 1
  v_permlane16_swap_b32 v48, v22
  v_max_f32 v48, v48, v22
  v_mov_b32 v22, v48
  s_nop 1
  v_permlane32_swap_b32 v48, v22
  v_max_f32 v48, v48, v22
  v_sub_f32 v72, v72, v48
  v_sub_f32 v73, v73, v48
  v_exp_f32 v72, v72
  v_exp_f32 v73, v73
  s_nop 0
  v_add_f32 v49, v72, v73
  v_mul_f32 v72, v72, v64
  v_mul_f32 v73, v73, v65
  v_mul_f32 v50, v72, v66
  v_fmac_f32 v50, v73, v67
  ds_write_b32 v46, v72 offset:37376
  ds_write_b32 v46, v73 offset:37632
  s_nop 1
  v_add_f32_dpp v49, v49, v49 row_ror:8 row_mask:0xf bank_mask:0xf
  s_nop 1
  v_add_f32_dpp v49, v49, v49 row_ror:4 row_mask:0xf bank_mask:0xf
  s_nop 1
  v_add_f32_dpp v49, v49, v49 row_ror:2 row_mask:0xf bank_mask:0xf
  s_nop 1
  v_add_f32_dpp v49, v49, v49 row_ror:1 row_mask:0xf bank_mask:0xf
  v_mov_b32 v22, v49
  s_nop 1
  v_permlane16_swap_b32 v49, v22
  v_add_f32 v49, v49, v22
  v_mov_b32 v22, v49
  s_nop 1
  v_permlane32_swap_b32 v49, v22
  v_add_f32 v49, v49, v22
  s_nop 1
  v_add_f32_dpp v50, v50, v50 row_ror:8 row_mask:0xf bank_mask:0xf
  s_nop 1
  v_add_f32_dpp v50, v50, v50 row_ror:4 row_mask:0xf bank_mask:0xf
  s_nop 1
  v_add_f32_dpp v50, v50, v50 row_ror:2 row_mask:0xf bank_mask:0xf
  s_nop 1
  v_add_f32_dpp v50, v50, v50 row_ror:1 row_mask:0xf bank_mask:0xf
  v_mov_b32 v22, v50
  s_nop 1
  v_permlane16_swap_b32 v50, v22
  v_add_f32 v50, v50, v22
  v_mov_b32 v22, v50
  s_nop 1
  v_permlane32_swap_b32 v50, v22
  v_add_f32 v50, v50, v22
  v_mov_b32 v22, s69
  ds_write_b128 v47, v[48:51]
  ds_write_b32 v14, v22 offset:20
  v_add_u32 v46, 512, v46
  v_add_u32 v47, 16, v47
  v_add_u32 v33, 512, v33
  v_add_u32 v34, 512, v34
  s_cmp_lt_u32 s69, s68
  s_cbranch_scc1 L_hs
L_hs_done:
  s_bitcmp1_b32 s80, s47
  s_cbranch_scc0 L_fbs
  s_waitcnt vmcnt(0) lgkmcnt(0)
  v_readlane_b32 s46, v40, s47
  s_sub_u32 s78, s78, s46
  s_bfe_u32 s46, s78, 0x80000
  s_min_u32 s46, s46, 15
  s_lshl_b32 s46, s46, 1
  s_sub_u32 s46, s46, 15
  v_readfirstlane_b32 s95, v41
  s_mul_i32 s45, s46, 6
  s_ashr_i32 s44, s95, 3
  s_sub_u32 s95, s95, s44
  s_cmp_lt_i32 s46, 0
  s_cselect_b32 s95, s95, 0
  s_cselect_b32 s45, -48, 0
  s_add_u32 s45, s45, s95
  v_mov_b32 v41, s45
  s_lshl4_add_u32 s46, s46, s95
  s_cmp_gt_i32 s46, 0
  s_cselect_b32 s44, 3, 6
  s_mul_i32 s46, s46, s44
  s_add_u32 s46, s46, 128
  s_ashr_i32 s46, s46, 8
  v_mov_b32 v42, s46
  s_mov_b64 exec, 1
  global_store_dword v43, v42, s[30:31]
  global_store_dword v43, v41, s[30:31] offset:8
  s_mov_b64 exec, -1
L_fbs:
  s_cmp_eq_u32 s47, 1
  s_cbranch_scc0 L_el
  s_bitcmp0_b32 s81, 0
  s_cbranch_scc0 L_el
  s_mov_b64 exec, 0xffff
  global_load_ubyte v42, v44, s[30:31] sc1
  s_waitcnt vmcnt(0)
  v_cmp_ne_u32 s[64:65], 0, v42
  s_lshr_b32 s44, s64, s79
  s_bcnt1_i32_b32 s44, s44
  s_sub_u32 s45, s44, 1
  s_cmp_lt_u32 s45, 7
  s_cbranch_scc0 L_el
  s_lshl_b32 s80, 0x10204081, s45
  s_and_b32 s80, s80, 0x7ffffffc
  s_mov_b32 exec_lo, s80
  global_load_dword v40, v39, s[30:31] sc1
L_el:
  s_mov_b64 exec, -1
L_hq:
  s_add_u32 s43, s43, 1
  s_cmp_gt_u32 s43, 16
  s_cbranch_scc1 L_hq_nl
  s_waitcnt vmcnt(0)
  v_lshlrev_b32 v76, 16, v68
  v_and_b32 v77, s66, v68
  v_lshlrev_b32 v78, 16, v69
  v_and_b32 v79, s66, v69
  v_lshlrev_b32 v80, 16, v70
  v_and_b32 v81, s66, v70
  v_lshlrev_b32 v82, 16, v71
  v_and_b32 v83, s66, v71
  v_mul_f32 v76, v76, v52
  v_mul_f32 v77, v77, v53
  v_mul_f32 v78, v78, v54
  v_mul_f32 v79, v79, v55
  v_mul_f32 v80, v80, v56
  v_mul_f32 v81, v81, v57
  v_mul_f32 v82, v82, v58
  v_mul_f32 v83, v83, v59
  v_cvt_pk_bf16_f32 v84, v76, v80
  v_cvt_pk_bf16_f32 v85, v77, v81
  v_cvt_pk_bf16_f32 v86, v78, v82
  v_cvt_pk_bf16_f32 v87, v79, v83
  v_lshlrev_b32 v76, 16, v84
  v_and_b32 v80, s66, v84
  v_lshlrev_b32 v77, 16, v85
  v_and_b32 v81, s66, v85
  v_lshlrev_b32 v78, 16, v86
  v_and_b32 v82, s66, v86
  v_lshlrev_b32 v79, 16, v87
  v_and_b32 v83, s66, v87
  v_fma_f32 v76, v80, v30, v76
  v_fma_f32 v77, v81, v30, v77
  v_fma_f32 v78, v82, v30, v78
  v_fma_f32 v79, v83, v30, v79
  v_cvt_pk_bf16_f32 v84, v76, v77
  v_cvt_pk_bf16_f32 v85, v78, v79
  v_xor_b32 v86, v31, v84
  v_xor_b32 v87, v31, v85
  v_mov_b32 v22, s43
  ds_write_b16 v28, v84 offset:512
  ds_write_b16_d16_hi v28, v84 offset:516
  ds_write_b16 v28, v85 offset:520
  ds_write_b16_d16_hi v28, v85 offset:524
  ds_write_b16 v29, v86 offset:514
  ds_write_b16_d16_hi v29, v86 offset:518
  ds_write_b16 v29, v87 offset:522
  ds_write_b16_d16_hi v29, v87 offset:526
  ds_write_b32 v14, v22 offset:16
  v_add_u32 v28, 1024, v28
  v_add_u32 v29, 1024, v29
  v_and_b32 v28, 0xfff, v28
  v_and_b32 v29, 0xfff, v29
  s_cmp_eq_u32 s43, 16
  s_cbranch_scc1 L_hq_nl
  s_lshl_b32 s44, s43, 2
  s_lshr_b64 s[64:65], s[96:97], s44
  s_and_b32 s64, s64, 15
  s_lshl4_add_u32 s68, s43, s64
  s_mul_i32 s44, s68, 384
  s_add_u32 s32, s4, s44
  s_addc_u32 s33, s5, 0
  global_load_dwordx2 v[68:69], v26, s[32:33]
  global_load_dwordx2 v[70:71], v27, s[32:33]
L_hq_nl:
  s_sub_u32 s44, s43, 4
  s_cmp_lt_u32 s44, 2
  s_cbranch_scc0 L_sc_done
  global_load_lds_dwordx4 v188, s[8:9]
  s_addk_i32 m0, 1024
  s_waitcnt vmcnt(3)
  global_load_lds_dwordx4 v189, s[8:9]
  s_addk_i32 m0, 1024
  s_waitcnt vmcnt(3)
  global_load_lds_dwordx4 v190, s[8:9]
  s_addk_i32 m0, 1024
  s_waitcnt vmcnt(3)
  global_load_lds_dwordx4 v191, s[8:9]
  s_addk_i32 m0, 1024
  s_waitcnt vmcnt(3)
  global_load_lds_dwordx4 v192, s[8:9]
  s_addk_i32 m0, 1024
  s_waitcnt vmcnt(3)
  global_load_lds_dwordx4 v193, s[8:9]
  s_addk_i32 m0, 1024
  s_waitcnt vmcnt(3)
  global_load_lds_dwordx4 v194, s[8:9]
  s_addk_i32 m0, 1024
  s_waitcnt vmcnt(3)
  global_load_lds_dwordx4 v195, s[8:9]
  s_addk_i32 m0, 1024
  s_mov_b64 s[8:9], s[10:11]
  s_mov_b64 s[10:11], s[14:15]
  s_mov_b64 s[14:15], s[16:17]
  s_waitcnt vmcnt(3)
  global_load_lds_dwordx4 v188, s[8:9]
  s_addk_i32 m0, 1024
  s_waitcnt vmcnt(3)
  global_load_lds_dwordx4 v189, s[8:9]
  s_addk_i32 m0, 1024
  s_waitcnt vmcnt(3)
  global_load_lds_dwordx4 v190, s[8:9]
  s_addk_i32 m0, 1024
  s_waitcnt vmcnt(3)
  global_load_lds_dwordx4 v191, s[8:9]
  s_addk_i32 m0, 1024
  s_waitcnt vmcnt(3)
  global_load_lds_dwordx4 v192, s[8:9]
  s_addk_i32 m0, 1024
  s_waitcnt vmcnt(3)
  global_load_lds_dwordx4 v193, s[8:9]
  s_addk_i32 m0, 1024
  s_waitcnt vmcnt(3)
  global_load_lds_dwordx4 v194, s[8:9]
  s_addk_i32 m0, 1024
  s_waitcnt vmcnt(3)
  global_load_lds_dwordx4 v195, s[8:9]
  s_addk_i32 m0, 1024
  s_mov_b64 s[8:9], s[10:11]
  s_mov_b64 s[10:11], s[14:15]
  s_mov_b64 s[14:15], s[16:17]
  s_cmp_eq_u32 s43, 5
  s_cbranch_scc0 L_sc_done
  s_waitcnt vmcnt(0)
L_sc_done:
  s_cmp_eq_u32 s43, 16
  s_cbranch_scc0 L_hq_skip
  s_cmp_eq_u32 s3, 0
  s_cbranch_scc0 L_hq_skip
  s_mov_b64 exec, 7
  global_store_dword v45, v14, s[30:31] sc1
  s_waitcnt vmcnt(0)
  s_mov_b64 exec, 1
  global_store_dword v37, v38, s[28:29] sc1
  s_mov_b64 exec, -1
L_hq_skip:
  s_waitcnt lgkmcnt(0)
  s_cmp_lt_u32 s43, 18
  s_cbranch_scc1 L_hk
  v_and_b32 v24, 15, v20
  v_lshlrev_b32 v24, 1, v24
  global_load_ushort v25, v24, s[82:83] offset:32
  s_mov_b32 s43, 0
  v_min_u32 v28, 23, v20
  v_lshlrev_b32 v28, 4, v28
  v_lshlrev_b32 v22, 1, v28
  v_subrev_u32 v196, 256, v22
  v_add_u32 v197, 512, v22
  v_min_u32 v197, v196, v197
  v_add_u32 v197, 64000, v197
  v_subrev_u32 v196, 512, v22
  v_add_u32 v198, 256, v22
  v_min_u32 v198, v196, v198
  v_add_u32 v198, 64000, v198
  v_add_u32 v196, 64000, v22
  v_add_u32 v28, 113152, v28
  v_lshlrev_b32 v32, 4, v20
  v_add_u32 v30, 113152, v32
  v_cmp_gt_u32 vcc, 24, v20
  v_lshrrev_b32 v21, 1, v35
  s_mul_i32 s44, s98, 384
  s_add_u32 s26, s26, s44
  s_addc_u32 s27, s27, 0
  v_mov_b32 v31, s2
  v_mul_u32_u24 v31, 6144, v31
  v_add_u32 v31, 8388608, v31
  v_add_u32 v23, 0, v32
  v_add_u32 v188, v23, v31
  v_add_u32 v23, 1024, v32
  v_add_u32 v189, v23, v31
  v_add_u32 v23, 2048, v32
  v_add_u32 v190, v23, v31
  v_add_u32 v23, 3072, v32
  v_add_u32 v191, v23, v31
  v_add_u32 v23, 4096, v32
  v_add_u32 v192, v23, v31
  v_add_u32 v23, 5120, v32
  v_add_u32 v193, v23, v31
  s_mov_b32 s45, 14
  s_lshl_b32 s68, s45, 2
  s_lshr_b64 s[64:65], s[92:93], s68
  s_and_b32 s68, s64, 15
  v_lshl_add_u32 v23, s68, 4, v32
  v_cndmask_b32 v23, v23, v32, vcc
  v_add_u32 v23, 5376, v23
  v_add_u32 v168, v23, v31
  s_waitcnt vmcnt(0)
  v_lshrrev_b32 v31, 4, v25
  v_mul_u32_u24 v31, 6144, v31
  v_add_u32 v31, 8388608, v31
  v_and_b32 v25, 15, v25
  v_mul_u32_u24 v25, 384, v25
  s_lshl4_add_u32 s44, s3, 5760
  v_mov_b32 v23, s44
  v_add_u32 v187, v23, v31
  v_add_u32_dpp v23, v25, v21 row_newbcast:0 row_mask:0xf bank_mask:0xf
  v_mov_b32_dpp v29, v31 row_newbcast:0 row_mask:0xf bank_mask:0xf
  v_add_u32 v172, v23, v29
  v_add_u32_dpp v23, v25, v21 row_newbcast:1 row_mask:0xf bank_mask:0xf
  v_mov_b32_dpp v29, v31 row_newbcast:1 row_mask:0xf bank_mask:0xf
  v_add_u32 v173, v23, v29
  v_add_u32_dpp v23, v25, v21 row_newbcast:2 row_mask:0xf bank_mask:0xf
  v_mov_b32_dpp v29, v31 row_newbcast:2 row_mask:0xf bank_mask:0xf
  v_add_u32 v174, v23, v29
  v_add_u32_dpp v23, v25, v21 row_newbcast:3 row_mask:0xf bank_mask:0xf
  v_mov_b32_dpp v29, v31 row_newbcast:3 row_mask:0xf bank_mask:0xf
  v_add_u32 v175, v23, v29
  v_add_u32_dpp v23, v25, v21 row_newbcast:4 row_mask:0xf bank_mask:0xf
  v_mov_b32_dpp v29, v31 row_newbcast:4 row_mask:0xf bank_mask:0xf
  v_add_u32 v176, v23, v29
  v_add_u32_dpp v23, v25, v21 row_newbcast:5 row_mask:0xf bank_mask:0xf
  v_mov_b32_dpp v29, v31 row_newbcast:5 row_mask:0xf bank_mask:0xf
  v_add_u32 v177, v23, v29
  v_add_u32_dpp v23, v25, v21 row_newbcast:6 row_mask:0xf bank_mask:0xf
  v_mov_b32_dpp v29, v31 row_newbcast:6 row_mask:0xf bank_mask:0xf
  v_add_u32 v178, v23, v29
  v_add_u32_dpp v23, v25, v21 row_newbcast:7 row_mask:0xf bank_mask:0xf
  v_mov_b32_dpp v29, v31 row_newbcast:7 row_mask:0xf bank_mask:0xf
  v_add_u32 v179, v23, v29
  v_add_u32_dpp v23, v25, v21 row_newbcast:8 row_mask:0xf bank_mask:0xf
  v_mov_b32_dpp v29, v31 row_newbcast:8 row_mask:0xf bank_mask:0xf
  v_add_u32 v180, v23, v29
  v_add_u32_dpp v23, v25, v21 row_newbcast:9 row_mask:0xf bank_mask:0xf
  v_mov_b32_dpp v29, v31 row_newbcast:9 row_mask:0xf bank_mask:0xf
  v_add_u32 v181, v23, v29
  v_add_u32_dpp v23, v25, v21 row_newbcast:10 row_mask:0xf bank_mask:0xf
  v_mov_b32_dpp v29, v31 row_newbcast:10 row_mask:0xf bank_mask:0xf
  v_add_u32 v182, v23, v29
  v_add_u32_dpp v23, v25, v21 row_newbcast:11 row_mask:0xf bank_mask:0xf
  v_mov_b32_dpp v29, v31 row_newbcast:11 row_mask:0xf bank_mask:0xf
  v_add_u32 v183, v23, v29
  v_add_u32_dpp v23, v25, v21 row_newbcast:12 row_mask:0xf bank_mask:0xf
  v_mov_b32_dpp v29, v31 row_newbcast:12 row_mask:0xf bank_mask:0xf
  v_add_u32 v184, v23, v29
  v_add_u32_dpp v23, v25, v21 row_newbcast:13 row_mask:0xf bank_mask:0xf
  v_mov_b32_dpp v29, v31 row_newbcast:13 row_mask:0xf bank_mask:0xf
  v_add_u32 v185, v23, v29
  v_add_u32_dpp v23, v25, v21 row_newbcast:14 row_mask:0xf bank_mask:0xf
  v_mov_b32_dpp v29, v31 row_newbcast:14 row_mask:0xf bank_mask:0xf
  v_add_u32 v186, v23, v29
  v_mov_b32 v108, -1
  v_mov_b32 v109, -1
  v_mov_b32 v110, -1
  v_mov_b32 v111, -1
  s_lshl4_add_u32 s44, s3, 118912
  v_mov_b32 v23, s44
  ds_write_b128 v28, v[108:111] offset:5376
  ds_write_b32 v23, v38 offset:12
L_hp:
  s_min_u32 s44, s3, 13
  s_cmp_eq_u32 s44, s43
  s_cbranch_scc0 L_hc_ok
L_hc:
  global_load_dword v104, v37, s[28:29] sc1
  s_waitcnt vmcnt(0)
  v_cmp_ne_u32 s[64:65], 1, v104
  s_cmp_eq_u64 s[64:65], 0
  s_cbranch_scc1 L_hc_ok
  s_cmp_eq_u32 s94, 0
  s_cbranch_scc1 L_hc_ok
  s_sub_u32 s94, s94, 1
  s_sleep 64
  s_branch L_hc
L_hc_ok:
  s_lshl_b32 s68, s43, 2
  s_lshr_b64 s[64:65], s[92:93], s68
  s_and_b32 s68, s64, 15
  s_lshl4_add_u32 s44, s68, 118912
  v_mov_b32 v23, s44
  s_cmp_eq_u32 s43, 14
  s_cbranch_scc0 L_hp_mid
  ds_read_b128 v[144:147], v30 offset:0
  ds_read_b128 v[148:151], v30 offset:1024
  ds_read_b128 v[152:155], v30 offset:2048
  ds_read_b128 v[156:159], v30 offset:3072
  ds_read_b128 v[160:163], v30 offset:4096
  ds_read_b128 v[164:167], v30 offset:5120
L_hm:
  ds_read_b32 v104, v14 offset:24
  s_waitcnt lgkmcnt(0)
  v_readfirstlane_b32 s46, v104
  s_cmp_ge_u32 s46, 30
  s_cbranch_scc1 L_hm_ok
  s_cmp_eq_u32 s94, 0
  s_cbranch_scc1 L_hm_ok
  s_sub_u32 s94, s94, 1
  s_sleep 1
  s_branch L_hm
L_hm_ok:
  global_store_dwordx4 v188, v[144:147], s[30:31] sc1
  global_store_dwordx4 v189, v[148:151], s[30:31] sc1
  global_store_dwordx4 v190, v[152:155], s[30:31] sc1
  global_store_dwordx4 v191, v[156:159], s[30:31] sc1
  global_store_dwordx4 v192, v[160:163], s[30:31] sc1
  s_mov_b32 exec_hi, 0xffffff
  global_store_dwordx4 v193, v[164:167], s[30:31] sc1
  s_mov_b64 exec, 7
  s_waitcnt vmcnt(0)
  global_atomic_add v36, v38, s[30:31] sc1
  s_mov_b64 exec, -1
L_hp_mid:
  s_add_u32 s43, s43, 1
  s_add_u32 s47, s43, 16
L_hpw:
  ds_read_b128 v[104:107], v14 offset:0
  s_waitcnt lgkmcnt(0)
  v_min_u32 v104, v104, v105
  v_min3_u32 v104, v104, v106, v107
  s_nop 0
  v_readfirstlane_b32 s46, v104
  s_cmp_ge_u32 s46, s47
  s_cbranch_scc1 L_hpw_ok
  s_cmp_eq_u32 s94, 0
  s_cbranch_scc1 L_hpw_ok
  s_sub_u32 s94, s94, 1
  s_sleep 1
  s_branch L_hpw
L_hpw_ok:
  s_bitcmp1_b32 s80, s47
  s_cbranch_scc0 L_fap
  s_mul_i32 s44, s47, 384
  s_add_u32 s44, s44, 7864320
  s_movk_i32 s78, 1
  s_atomic_add s78, s[30:31], s44 glc
  s_mov_b64 exec, 1
  global_load_dword v41, v43, s[30:31] offset:8 sc1
  s_mov_b64 exec, -1
L_fap:
  ds_read_b128 v[72:75], v196 offset:0
  ds_read_b128 v[76:79], v196 offset:16
  ds_read_b128 v[80:83], v197 offset:768
  ds_read_b128 v[84:87], v197 offset:784
  ds_read_b128 v[88:91], v198 offset:1536
  ds_read_b128 v[92:95], v198 offset:1552
  ds_read_b128 v[96:99], v196 offset:2304
  ds_read_b128 v[100:103], v196 offset:2320
  ds_read_b128 v[48:51], v23
  s_waitcnt lgkmcnt(0)
  v_pk_add_f32 v[72:73], v[72:73], v[80:81]
  v_pk_add_f32 v[88:89], v[88:89], v[96:97]
  v_pk_add_f32 v[74:75], v[74:75], v[82:83]
  v_pk_add_f32 v[90:91], v[90:91], v[98:99]
  v_pk_add_f32 v[76:77], v[76:77], v[84:85]
  v_pk_add_f32 v[92:93], v[92:93], v[100:101]
  v_pk_add_f32 v[78:79], v[78:79], v[86:87]
  v_pk_add_f32 v[94:95], v[94:95], v[102:103]
  v_pk_add_f32 v[72:73], v[72:73], v[88:89]
  v_pk_add_f32 v[74:75], v[74:75], v[90:91]
  v_pk_add_f32 v[76:77], v[76:77], v[92:93]
  v_pk_add_f32 v[78:79], v[78:79], v[94:95]
  v_pk_add_f32 v[72:73], v[72:73], v[50:51] op_sel_hi:[1,0] neg_lo:[0,1] neg_hi:[0,1]
  v_pk_add_f32 v[74:75], v[74:75], v[50:51] op_sel_hi:[1,0] neg_lo:[0,1] neg_hi:[0,1]
  v_pk_add_f32 v[76:77], v[76:77], v[50:51] op_sel_hi:[1,0] neg_lo:[0,1] neg_hi:[0,1]
  v_pk_add_f32 v[78:79], v[78:79], v[50:51] op_sel_hi:[1,0] neg_lo:[0,1] neg_hi:[0,1]
  v_max3_f32 v25, |v72|, |v73|, |v74|
  v_max3_f32 v25, v25, |v75|, |v76|
  v_max3_f32 v25, v25, |v77|, |v78|
  v_max_f32_e64 v25, v25, |v79|
  s_nop 1
  v_max_f32_dpp v25, v25, v25 row_ror:8 row_mask:0xf bank_mask:0xf
  s_nop 1
  v_max_f32_dpp v25, v25, v25 row_ror:4 row_mask:0xf bank_mask:0xf
  s_nop 1
  v_max_f32_dpp v25, v25, v25 row_ror:2 row_mask:0xf bank_mask:0xf
  s_nop 1
  v_max_f32_dpp v25, v25, v25 row_ror:1 row_mask:0xf bank_mask:0xf
  v_mov_b32 v29, v25
  s_nop 1
  v_permlane16_swap_b32 v25, v29
  v_max_f32 v25, v25, v29
  v_mov_b32 v29, v25
  s_nop 1
  v_permlane32_swap_b32 v25, v29
  v_max_f32 v25, v25, v29
  v_frexp_exp_i32_f32 v25, v25
  v_sub_u32 v29, 14, v25
  v_add_u32 v51, 242, v25
  v_ldexp_f32 v72, v72, v29
  v_ldexp_f32 v73, v73, v29
  v_ldexp_f32 v74, v74, v29
  v_ldexp_f32 v75, v75, v29
  v_ldexp_f32 v76, v76, v29
  v_ldexp_f32 v77, v77, v29
  v_ldexp_f32 v78, v78, v29
  v_ldexp_f32 v79, v79, v29
  v_cvt_pk_f16_f32 v108, v72, v73
  v_cvt_pk_f16_f32 v109, v74, v75
  v_cvt_pk_f16_f32 v110, v76, v77
  v_cvt_pk_f16_f32 v111, v78, v79
  v_min_u32 v108, -2, v108
  v_min_u32 v109, -2, v109
  v_min_u32 v110, -2, v110
  v_min_u32 v111, -2, v111
  s_cmp_eq_u32 s43, 15
  s_cbranch_scc1 L_hp_last
  ds_write_b32 v23, v51 offset:12
  v_add_u32 v196, 3072, v196
  v_add_u32 v197, 3072, v197
  v_add_u32 v198, 3072, v198
  ds_write_b128 v28, v[108:111]
  v_add_u32 v28, 384, v28
  s_bitcmp1_b32 s80, s47
  s_cbranch_scc0 L_fbp
  s_waitcnt vmcnt(0) lgkmcnt(0)
  v_readlane_b32 s46, v40, s47
  s_sub_u32 s78, s78, s46
  s_bfe_u32 s46, s78, 0x80000
  s_min_u32 s46, s46, 15
  s_lshl_b32 s46, s46, 1
  s_sub_u32 s46, s46, 15
  v_readfirstlane_b32 s95, v41
  s_mul_i32 s45, s46, 6
  s_ashr_i32 s44, s95, 3
  s_sub_u32 s95, s95, s44
  s_cmp_lt_i32 s46, 0
  s_cselect_b32 s95, s95, 0
  s_cselect_b32 s45, -48, 0
  s_add_u32 s45, s45, s95
  v_mov_b32 v41, s45
  s_lshl4_add_u32 s46, s46, s95
  s_cmp_gt_i32 s46, 0
  s_cselect_b32 s44, 3, 6
  s_mul_i32 s46, s46, s44
  s_add_u32 s46, s46, 128
  s_ashr_i32 s46, s46, 8
  v_mov_b32 v42, s46
  s_mov_b64 exec, 1
  global_store_dword v43, v42, s[30:31]
  global_store_dword v43, v41, s[30:31] offset:8
  s_mov_b64 exec, -1
L_fbp:
  s_branch L_hp
L_hp_last:
  v_cndmask_b32 v108, v48, v108, vcc
  v_cndmask_b32 v109, v49, v109, vcc
  v_cndmask_b32 v110, v50, v110, vcc
  v_cndmask_b32 v111, v51, v111, vcc
  s_mov_b64 exec, 0x1ffffff
  global_store_dwordx4 v168, v[108:111], s[30:31] sc1
  s_mov_b64 exec, -1
  v_subrev_u32 v196, 256, v35
  v_add_u32 v197, 512, v35
  v_min_u32 v197, v196, v197
  v_add_u32 v197, 110080, v197
  v_subrev_u32 v196, 512, v35
  v_add_u32 v198, 256, v35
  v_min_u32 v198, v196, v198
  v_add_u32 v198, 110080, v198
  v_add_u32 v196, 110080, v35
L_hn:
  ds_read_b32 v104, v14 offset:28
  s_waitcnt lgkmcnt(0)
  v_readfirstlane_b32 s46, v104
  s_cmp_ge_u32 s46, 31
  s_cbranch_scc1 L_hn_ok
  s_cmp_eq_u32 s94, 0
  s_cbranch_scc1 L_hn_ok
  s_sub_u32 s94, s94, 1
  s_sleep 1
  s_branch L_hn
L_hn_ok:
  s_mov_b64 exec, 1
L_hw:
  global_atomic_add v68, v36, v14, s[30:31] sc0 sc1
  s_waitcnt vmcnt(0)
  v_readfirstlane_b32 s46, v68
  s_cmp_ge_u32 s46, 16
  s_cbranch_scc1 L_hw_ok
  s_cmp_eq_u32 s94, 0
  s_cbranch_scc1 L_hw_ok
  s_sub_u32 s94, s94, 1
  s_branch L_hw
L_hw_ok:
  s_mov_b64 exec, -1
L_hg:
  global_load_dwordx4 v[52:55], v187, s[30:31] sc1
  global_load_dwordx2 v[112:113], v172, s[30:31] sc1
  global_load_dwordx2 v[114:115], v173, s[30:31] sc1
  global_load_dwordx2 v[116:117], v174, s[30:31] sc1
  global_load_dwordx2 v[118:119], v175, s[30:31] sc1
  global_load_dwordx2 v[120:121], v176, s[30:31] sc1
  global_load_dwordx2 v[122:123], v177, s[30:31] sc1
  global_load_dwordx2 v[124:125], v178, s[30:31] sc1
  global_load_dwordx2 v[126:127], v179, s[30:31] sc1
  global_load_dwordx2 v[128:129], v180, s[30:31] sc1
  global_load_dwordx2 v[130:131], v181, s[30:31] sc1
  global_load_dwordx2 v[132:133], v182, s[30:31] sc1
  global_load_dwordx2 v[134:135], v183, s[30:31] sc1
  global_load_dwordx2 v[136:137], v184, s[30:31] sc1
  global_load_dwordx2 v[138:139], v185, s[30:31] sc1
  global_load_dwordx2 v[140:141], v186, s[30:31] sc1
  s_waitcnt vmcnt(15)
  v_mov_b32 v23, v55
  v_mov_b32 v24, v52
  s_nop 1
  v_max_f32_dpp v24, v24, v24 row_ror:8 row_mask:0xf bank_mask:0xf
  s_nop 1
  v_max_f32_dpp v24, v24, v24 row_ror:4 row_mask:0xf bank_mask:0xf
  s_nop 1
  v_max_f32_dpp v24, v24, v24 row_ror:2 row_mask:0xf bank_mask:0xf
  s_nop 1
  v_max_f32_dpp v24, v24, v24 row_ror:1 row_mask:0xf bank_mask:0xf
  v_sub_f32 v24, v52, v24
  v_exp_f32 v24, v24
  v_subrev_u32 v55, 256, v55
  v_mul_f32 v25, v24, v53
  s_nop 1
  v_add_f32_dpp v25, v25, v25 row_ror:8 row_mask:0xf bank_mask:0xf
  s_nop 1
  v_add_f32_dpp v25, v25, v25 row_ror:4 row_mask:0xf bank_mask:0xf
  s_nop 1
  v_add_f32_dpp v25, v25, v25 row_ror:2 row_mask:0xf bank_mask:0xf
  s_nop 1
  v_add_f32_dpp v25, v25, v25 row_ror:1 row_mask:0xf bank_mask:0xf
  v_rcp_f32 v25, v25
  s_nop 0
  v_mul_f32 v24, v24, v25
  v_ldexp_f32 v25, v24, v55
  v_mul_f32_e64 v54, v24, -v54
  v_readlane_b32 s63, v24, 15
  v_readlane_b32 s44, v54, 15
  v_readlane_b32 s48, v25, 0
  v_readlane_b32 s49, v25, 1
  v_readlane_b32 s50, v25, 2
  v_readlane_b32 s51, v25, 3
  v_readlane_b32 s52, v25, 4
  v_readlane_b32 s53, v25, 5
  v_readlane_b32 s54, v25, 6
  v_readlane_b32 s55, v25, 7
  v_readlane_b32 s56, v25, 8
  v_readlane_b32 s57, v25, 9
  v_readlane_b32 s58, v25, 10
  v_readlane_b32 s59, v25, 11
  v_readlane_b32 s60, v25, 12
  v_readlane_b32 s61, v25, 13
  v_readlane_b32 s62, v25, 14
  v_mov_b32 v108, s44
  v_mov_b32 v109, s44
  v_mov_b32 v110, s44
  v_mov_b32 v111, s44
  s_waitcnt vmcnt(14)
  v_max3_u32 v23, v23, v112, v113
  v_fma_mix_f32 v108, v112, s48, v108 op_sel:[0,0,0] op_sel_hi:[1,0,0]
  v_fma_mix_f32 v109, v112, s48, v109 op_sel:[1,0,0] op_sel_hi:[1,0,0]
  v_fma_mix_f32 v110, v113, s48, v110 op_sel:[0,0,0] op_sel_hi:[1,0,0]
  v_fma_mix_f32 v111, v113, s48, v111 op_sel:[1,0,0] op_sel_hi:[1,0,0]
  s_waitcnt vmcnt(13)
  v_max3_u32 v23, v23, v114, v115
  v_fma_mix_f32 v108, v114, s49, v108 op_sel:[0,0,0] op_sel_hi:[1,0,0]
  v_fma_mix_f32 v109, v114, s49, v109 op_sel:[1,0,0] op_sel_hi:[1,0,0]
  v_fma_mix_f32 v110, v115, s49, v110 op_sel:[0,0,0] op_sel_hi:[1,0,0]
  v_fma_mix_f32 v111, v115, s49, v111 op_sel:[1,0,0] op_sel_hi:[1,0,0]
  s_waitcnt vmcnt(12)
  v_max3_u32 v23, v23, v116, v117
  v_fma_mix_f32 v108, v116, s50, v108 op_sel:[0,0,0] op_sel_hi:[1,0,0]
  v_fma_mix_f32 v109, v116, s50, v109 op_sel:[1,0,0] op_sel_hi:[1,0,0]
  v_fma_mix_f32 v110, v117, s50, v110 op_sel:[0,0,0] op_sel_hi:[1,0,0]
  v_fma_mix_f32 v111, v117, s50, v111 op_sel:[1,0,0] op_sel_hi:[1,0,0]
  s_waitcnt vmcnt(11)
  v_max3_u32 v23, v23, v118, v119
  v_fma_mix_f32 v108, v118, s51, v108 op_sel:[0,0,0] op_sel_hi:[1,0,0]
  v_fma_mix_f32 v109, v118, s51, v109 op_sel:[1,0,0] op_sel_hi:[1,0,0]
  v_fma_mix_f32 v110, v119, s51, v110 op_sel:[0,0,0] op_sel_hi:[1,0,0]
  v_fma_mix_f32 v111, v119, s51, v111 op_sel:[1,0,0] op_sel_hi:[1,0,0]
  s_waitcnt vmcnt(10)
  v_max3_u32 v23, v23, v120, v121
  v_fma_mix_f32 v108, v120, s52, v108 op_sel:[0,0,0] op_sel_hi:[1,0,0]
  v_fma_mix_f32 v109, v120, s52, v109 op_sel:[1,0,0] op_sel_hi:[1,0,0]
  v_fma_mix_f32 v110, v121, s52, v110 op_sel:[0,0,0] op_sel_hi:[1,0,0]
  v_fma_mix_f32 v111, v121, s52, v111 op_sel:[1,0,0] op_sel_hi:[1,0,0]
  s_waitcnt vmcnt(9)
  v_max3_u32 v23, v23, v122, v123
  v_fma_mix_f32 v108, v122, s53, v108 op_sel:[0,0,0] op_sel_hi:[1,0,0]
  v_fma_mix_f32 v109, v122, s53, v109 op_sel:[1,0,0] op_sel_hi:[1,0,0]
  v_fma_mix_f32 v110, v123, s53, v110 op_sel:[0,0,0] op_sel_hi:[1,0,0]
  v_fma_mix_f32 v111, v123, s53, v111 op_sel:[1,0,0] op_sel_hi:[1,0,0]
  s_waitcnt vmcnt(8)
  v_max3_u32 v23, v23, v124, v125
  v_fma_mix_f32 v108, v124, s54, v108 op_sel:[0,0,0] op_sel_hi:[1,0,0]
  v_fma_mix_f32 v109, v124, s54, v109 op_sel:[1,0,0] op_sel_hi:[1,0,0]
  v_fma_mix_f32 v110, v125, s54, v110 op_sel:[0,0,0] op_sel_hi:[1,0,0]
  v_fma_mix_f32 v111, v125, s54, v111 op_sel:[1,0,0] op_sel_hi:[1,0,0]
  s_waitcnt vmcnt(7)
  v_max3_u32 v23, v23, v126, v127
  v_fma_mix_f32 v108, v126, s55, v108 op_sel:[0,0,0] op_sel_hi:[1,0,0]
  v_fma_mix_f32 v109, v126, s55, v109 op_sel:[1,0,0] op_sel_hi:[1,0,0]
  v_fma_mix_f32 v110, v127, s55, v110 op_sel:[0,0,0] op_sel_hi:[1,0,0]
  v_fma_mix_f32 v111, v127, s55, v111 op_sel:[1,0,0] op_sel_hi:[1,0,0]
  s_waitcnt vmcnt(6)
  v_max3_u32 v23, v23, v128, v129
  v_fma_mix_f32 v108, v128, s56, v108 op_sel:[0,0,0] op_sel_hi:[1,0,0]
  v_fma_mix_f32 v109, v128, s56, v109 op_sel:[1,0,0] op_sel_hi:[1,0,0]
  v_fma_mix_f32 v110, v129, s56, v110 op_sel:[0,0,0] op_sel_hi:[1,0,0]
  v_fma_mix_f32 v111, v129, s56, v111 op_sel:[1,0,0] op_sel_hi:[1,0,0]
  s_waitcnt vmcnt(5)
  v_max3_u32 v23, v23, v130, v131
  v_fma_mix_f32 v108, v130, s57, v108 op_sel:[0,0,0] op_sel_hi:[1,0,0]
  v_fma_mix_f32 v109, v130, s57, v109 op_sel:[1,0,0] op_sel_hi:[1,0,0]
  v_fma_mix_f32 v110, v131, s57, v110 op_sel:[0,0,0] op_sel_hi:[1,0,0]
  v_fma_mix_f32 v111, v131, s57, v111 op_sel:[1,0,0] op_sel_hi:[1,0,0]
  s_waitcnt vmcnt(4)
  v_max3_u32 v23, v23, v132, v133
  v_fma_mix_f32 v108, v132, s58, v108 op_sel:[0,0,0] op_sel_hi:[1,0,0]
  v_fma_mix_f32 v109, v132, s58, v109 op_sel:[1,0,0] op_sel_hi:[1,0,0]
  v_fma_mix_f32 v110, v133, s58, v110 op_sel:[0,0,0] op_sel_hi:[1,0,0]
  v_fma_mix_f32 v111, v133, s58, v111 op_sel:[1,0,0] op_sel_hi:[1,0,0]
  s_waitcnt vmcnt(3)
  v_max3_u32 v23, v23, v134, v135
  v_fma_mix_f32 v108, v134, s59, v108 op_sel:[0,0,0] op_sel_hi:[1,0,0]
  v_fma_mix_f32 v109, v134, s59, v109 op_sel:[1,0,0] op_sel_hi:[1,0,0]
  v_fma_mix_f32 v110, v135, s59, v110 op_sel:[0,0,0] op_sel_hi:[1,0,0]
  v_fma_mix_f32 v111, v135, s59, v111 op_sel:[1,0,0] op_sel_hi:[1,0,0]
  s_waitcnt vmcnt(2)
  v_max3_u32 v23, v23, v136, v137
  v_fma_mix_f32 v108, v136, s60, v108 op_sel:[0,0,0] op_sel_hi:[1,0,0]
  v_fma_mix_f32 v109, v136, s60, v109 op_sel:[1,0,0] op_sel_hi:[1,0,0]
  v_fma_mix_f32 v110, v137, s60, v110 op_sel:[0,0,0] op_sel_hi:[1,0,0]
  v_fma_mix_f32 v111, v137, s60, v111 op_sel:[1,0,0] op_sel_hi:[1,0,0]
  s_waitcnt vmcnt(1)
  v_max3_u32 v23, v23, v138, v139
  v_fma_mix_f32 v108, v138, s61, v108 op_sel:[0,0,0] op_sel_hi:[1,0,0]
  v_fma_mix_f32 v109, v138, s61, v109 op_sel:[1,0,0] op_sel_hi:[1,0,0]
  v_fma_mix_f32 v110, v139, s61, v110 op_sel:[0,0,0] op_sel_hi:[1,0,0]
  v_fma_mix_f32 v111, v139, s61, v111 op_sel:[1,0,0] op_sel_hi:[1,0,0]
  s_waitcnt vmcnt(0)
  v_max3_u32 v23, v23, v140, v141
  v_cmp_eq_u32 s[64:65], -1, v23
  v_fma_mix_f32 v108, v140, s62, v108 op_sel:[0,0,0] op_sel_hi:[1,0,0]
  v_fma_mix_f32 v109, v140, s62, v109 op_sel:[1,0,0] op_sel_hi:[1,0,0]
  v_fma_mix_f32 v110, v141, s62, v110 op_sel:[0,0,0] op_sel_hi:[1,0,0]
  v_fma_mix_f32 v111, v141, s62, v111 op_sel:[1,0,0] op_sel_hi:[1,0,0]
  s_cmp_eq_u64 s[64:65], 0
  s_cbranch_scc1 L_hg_ok
  s_cmp_eq_u32 s94, 0
  s_cbranch_scc1 L_hg_ok
  s_sub_u32 s94, s94, 1
  s_branch L_hg
L_hg_ok:
  v_mov_b32 v168, s63
  s_mov_b32 exec_hi, 0xffff
  s_barrier
  ds_read_b128 v[72:75], v196 offset:0
  ds_read_b128 v[76:79], v197 offset:768
  ds_read_b128 v[80:83], v198 offset:1536
  ds_read_b128 v[84:87], v196 offset:2304
  s_waitcnt lgkmcnt(3)
  v_pk_fma_f32 v[108:109], v[72:73], v[168:169], v[108:109] op_sel_hi:[1,0,1]
  v_pk_fma_f32 v[110:111], v[74:75], v[168:169], v[110:111] op_sel_hi:[1,0,1]
  s_waitcnt lgkmcnt(2)
  v_pk_fma_f32 v[108:109], v[76:77], v[168:169], v[108:109] op_sel_hi:[1,0,1]
  v_pk_fma_f32 v[110:111], v[78:79], v[168:169], v[110:111] op_sel_hi:[1,0,1]
  s_waitcnt lgkmcnt(1)
  v_pk_fma_f32 v[108:109], v[80:81], v[168:169], v[108:109] op_sel_hi:[1,0,1]
  v_pk_fma_f32 v[110:111], v[82:83], v[168:169], v[110:111] op_sel_hi:[1,0,1]
  s_waitcnt lgkmcnt(0)
  v_pk_fma_f32 v[108:109], v[84:85], v[168:169], v[108:109] op_sel_hi:[1,0,1]
  v_pk_fma_f32 v[110:111], v[86:87], v[168:169], v[110:111] op_sel_hi:[1,0,1]
  v_cvt_pk_bf16_f32 v108, v108, v109
  v_cvt_pk_bf16_f32 v109, v110, v111
  global_store_dwordx2 v21, v[108:109], s[26:27]
L_end:
  s_endpgm
.p2align 6
.type L_order,@object
L_order:
  .long 0x76afedcb, 0x45321098, 0x500000, 0x300, 0x40, 0x251300, 0x4, 0x0
  .long 0x2e001e, 0x4e003e, 0x6e005e, 0x8d007e, 0xae009e, 0xce00be, 0xee00de, 0xf00fe
  .long 0x96afedcb, 0x74321058, 0x700000, 0x700, 0x70, 0x271700, 0x7, 0x0
  .long 0x270007, 0x470037, 0x670057, 0x870077, 0xa70097, 0xc700b7, 0xe700d7, 0x1f00f7
  .long 0x765aedfb, 0xc4321098, 0xd00000, 0xf00, 0xc0, 0x2d1f00, 0xc, 0x0
  .long 0x110001, 0x410031, 0x610051, 0x810071, 0xa10091, 0xc100b1, 0xe100d1, 0x2f00f1
  .long 0x785fedcb, 0x6432109a, 0x900000, 0x200, 0x60, 0x291200, 0x6, 0x0
  .long 0x160006, 0x460026, 0x660056, 0x860076, 0xa60096, 0xc600b6, 0xe600d6, 0x3f00f6
  .long 0x765faecb, 0xd4321098, 0xf00000, 0xd00, 0xd0, 0x2f1d00, 0xd, 0x0
  .long 0x120002, 0x320022, 0x620052, 0x820072, 0xa20092, 0xc200b2, 0xe200d2, 0x4f00f2
  .long 0x765fedca, 0xb4321098, 0x800000, 0xf00, 0xb0, 0x281f00, 0xb, 0x0
  .long 0x100000, 0x300020, 0x600040, 0x800070, 0xa00090, 0xc000b0, 0xe000d0, 0x5f00f0
  .long 0x76afedcb, 0x24351098, 0x400000, 0x0, 0x20, 0x241000, 0x2, 0x0
  .long 0x1c000c, 0x3c002c, 0x5c004c, 0x8c007c, 0xac009c, 0xcc00bc, 0xea00dc, 0x6f00fc
  .long 0x76afedcb, 0x14325098, 0x400000, 0x400, 0x10, 0x241400, 0x1, 0x0
  .long 0x1b000b, 0x3b002b, 0x5b004b, 0x8b006b, 0xab009b, 0xcb00bb, 0xeb00db, 0x7f00fb
  .long 0x76afedcb, 0x35421098, 0x500000, 0x300, 0x30, 0x251300, 0x3, 0x0
  .long 0x1d000d, 0x3d002d, 0x5d004d, 0x7d006d, 0xad009d, 0xcd00bd, 0xed00dd, 0x8f00fd
  .long 0x76afedcb, 0x94321058, 0x700000, 0x700, 0x90, 0x271700, 0x9, 0x0
  .long 0x170009, 0x390029, 0x590049, 0x790069, 0xa90089, 0xc900b9, 0xe900d9, 0x9f00f9
  .long 0x765aedcb, 0xf4321098, 0xd00000, 0xf00, 0xf0, 0x2d1f00, 0xf, 0x0
  .long 0x140004, 0x340021, 0x540044, 0x740064, 0x940084, 0xc400b4, 0xe400d4, 0xaf00f4
  .long 0x765fedcb, 0x8432109a, 0x900000, 0x200, 0x80, 0x291200, 0x8, 0x0
  .long 0x180008, 0x360028, 0x580048, 0x780068, 0x980088, 0xc800a8, 0xe800d8, 0xbf00f8
  .long 0x765fadcb, 0xe4321098, 0xf00000, 0xd00, 0xe0, 0x2f1d00, 0xe, 0x0
  .long 0x130003, 0x330023, 0x530042, 0x730063, 0x930083, 0xb300a3, 0xe300d3, 0xcf00f3
  .long 0x765fedcb, 0xa4321098, 0x800000, 0xf00, 0xaf, 0x28001f, 0xa, 0x0
  .long 0x500024, 0x14400a4, 0x2b40234, 0x6f40674, 0x7830703, 0xc1408c2, 0xd630c94, 0xdf0de3
  .long 0x76afedcb, 0x4351298, 0x400000, 0x0, 0x0, 0x241000, 0x0, 0x0
  .long 0x1a000a, 0x3a002a, 0x5a004a, 0x7a006a, 0x9a008a, 0xba00aa, 0xda00ca, 0xef00fa
  .long 0x76afedcb, 0x54321098, 0x400000, 0x400, 0x54, 0x140024, 0x5, 0x0
  .long 0x7b006c, 0x1cc00ec, 0x4be043e, 0x58d050d, 0x7de075e, 0xe1c084d, 0xe9c0e2e, 0xff0eae
  .long 0x765fadce, 0xb4321098, 0x11911111, 0x11111e11, 0xb1, 0x291e01, 0xb, 0x0
  .long 0x1200110, 0x1400130, 0x1600150, 0x1800170, 0x1a00190, 0x1c001b0, 0x1e001d0, 0x10f01f0
  .long 0x76afedcb, 0x94321058, 0x11b11111, 0x11111011, 0x91, 0x2b1001, 0x9, 0x0
  .long 0x1290109, 0x1490139, 0x1690159, 0x1890179, 0x1a90199, 0x1c901b9, 0x1e901d9, 0x11f01f9
  .long 0x765fedcb, 0x8432109a, 0x11a11111, 0x11111111, 0x81, 0x2a1101, 0x8, 0x0
  .long 0x1180108, 0x1480138, 0x1680158, 0x1880178, 0x1a70198, 0x1c801b8, 0x1e801d8, 0x12f01f8
  .long 0x765feadb, 0xc4321098, 0x11811111, 0x11111e11, 0xc1, 0x281e01, 0xc, 0x0
  .long 0x1110101, 0x1410121, 0x1610151, 0x1810171, 0x1a10191, 0x1c101b1, 0x1e101d1, 0x13f01f1
  .long 0x765aedcb, 0xf4321098, 0x11e11111, 0x11111f11, 0xf1, 0x2e1f01, 0xf, 0x0
  .long 0x1140104, 0x1340124, 0x1640154, 0x1840174, 0x1a40194, 0x1c401b4, 0x1e401d4, 0x14f01f4
  .long 0x76afedcb, 0x45321098, 0x11311111, 0x11111811, 0x41, 0x231801, 0x4, 0x0
  .long 0x11e010e, 0x13e012e, 0x16e014e, 0x18e017e, 0x1ae019e, 0x1ce01be, 0x1ee01dd, 0x15f01fe
  .long 0x7a5fedcb, 0x64321098, 0x11811111, 0x11111311, 0x61, 0x281301, 0x6, 0x0
  .long 0x1160106, 0x1360126, 0x1560146, 0x1860176, 0x1a60196, 0x1c601b6, 0x1e601d6, 0x16f01f6
  .long 0x76afedcb, 0x14325098, 0x11011111, 0x11111311, 0x11, 0x201301, 0x1, 0x0
  .long 0x11b010b, 0x13b012b, 0x15b014b, 0x18b016b, 0x1ab019b, 0x1cb01bb, 0x1eb01db, 0x17f01fa
  .long 0x765fadcb, 0xe4321098, 0x11911111, 0x11111e11, 0xe1, 0x291e01, 0xe, 0x0
  .long 0x1130100, 0x1330123, 0x1530143, 0x1730163, 0x1a30193, 0x1c301b3, 0x1e301d3, 0x18f01f3
  .long 0x76afedcb, 0x54321098, 0x11b11111, 0x11111011, 0x5b, 0x10012b, 0x5, 0x0
  .long 0x3090119, 0x5450389, 0xc2505c5, 0xd650ca5, 0xe750de5, 0xf380ef5, 0xfb80f55, 0x19f0fd5
  .long 0x865fedcb, 0x7432109a, 0x11a11111, 0x11111111, 0x71, 0x2a1101, 0x7, 0x0
  .long 0x1170107, 0x1370127, 0x1570147, 0x1770167, 0x1970187, 0x1c701b7, 0x1e701d7, 0x1af01f7
  .long 0x765feacb, 0xd4321098, 0x11811111, 0x11111e11, 0xd1, 0x281e01, 0xd, 0x0
  .long 0x1120102, 0x1310122, 0x1520142, 0x1720162, 0x1920182, 0x1c201a2, 0x1e201d2, 0x1bf01f2
  .long 0x76afedcb, 0x24351098, 0x11411111, 0x11111711, 0x21, 0x241701, 0x2, 0x0
  .long 0x11c010c, 0x13c012c, 0x15c014c, 0x17c016c, 0x19c018c, 0x1bc01ac, 0x1ec01dc, 0x1cf01fc
  .long 0x76afedcb, 0x35421098, 0x11311111, 0x11111811, 0x31, 0x231801, 0x3, 0x0
  .long 0x11d010d, 0x13d012d, 0x15d014d, 0x17d016d, 0x19d018d, 0x1bd01ad, 0x1ed01cd, 0x1df01fd
  .long 0x765fedcb, 0xa4321098, 0x11811111, 0x11111311, 0xa3, 0x280113, 0xa, 0x0
  .long 0x850005, 0x1750166, 0x62501f5, 0x74506a5, 0xbd507c5, 0xd350d15, 0xdb50d95, 0x1ef0e55
  .long 0x76afedcb, 0x4325198, 0x11011111, 0x11111311, 0x1, 0x201301, 0x0, 0x0
  .long 0x11a010a, 0x13a012a, 0x15a014a, 0x17a016a, 0x19a018a, 0x1ba01aa, 0x1da01ca, 0x1ff01ea
  .long 0x76afedcb, 0x45321098, 0x22222222, 0x22222a22, 0x42, 0x221a02, 0x4, 0x0
  .long 0x22e021e, 0x24e023e, 0x26e025e, 0x28b027e, 0x2ae029e, 0x2ce02be, 0x2ee02de, 0x20f02fe
  .long 0x7a5fedcb, 0x64321098, 0x22c22222, 0x22222622, 0x62, 0x2c1602, 0x6, 0x0
  .long 0x2260206, 0x2460236, 0x2660256, 0x2860276, 0x2a60296, 0x2c602b6, 0x2e602d6, 0x21f02f6
  .long 0x76afedcb, 0x54321098, 0x22922222, 0x22222522, 0x59, 0x150229, 0x5, 0x0
  .long 0xb50035, 0x1850105, 0x2f502a8, 0x3550315, 0x3d50395, 0x6650575, 0x94506e5, 0x22f09c5
  .long 0x765aedcb, 0xf4321098, 0x22f22222, 0x22222f22, 0xf2, 0x2f1f02, 0xf, 0x0
  .long 0x2140204, 0x2440224, 0x2640254, 0x2840274, 0x2a40294, 0x2c402b2, 0x2e402d4, 0x23f02f4
  .long 0x76afedcb, 0x24351098, 0x22222222, 0x22222522, 0x22, 0x221502, 0x2, 0x0
  .long 0x21c020c, 0x23c022c, 0x26c025c, 0x28c027c, 0x2ac029c, 0x2ca02bc, 0x2ec02dc, 0x24f02fc
  .long 0x965fedcb, 0x743210a8, 0x22722222, 0x22222022, 0x72, 0x271002, 0x7, 0x0
  .long 0x2170207, 0x2370227, 0x2670247, 0x2870277, 0x2a70297, 0x2c702b7, 0x2e702d7, 0x25f02f7
  .long 0x765fadce, 0xb4321098, 0x22a22222, 0x22222e22, 0xb2, 0x2a1e02, 0xb, 0x0
  .long 0x2100200, 0x2300220, 0x2500240, 0x2800270, 0x2a00290, 0x2c002b0, 0x2e002d0, 0x26f02f0
  .long 0x76afedcb, 0x34521098, 0x22222222, 0x22222822, 0x32, 0x221802, 0x3, 0x0
  .long 0x21d020d, 0x23d022d, 0x25d024d, 0x28d026d, 0x2ad029d, 0x2cd02bd, 0x2ed02dd, 0x27f02fd
  .long 0x76afedcb, 0x15324098, 0x22222222, 0x22222a22, 0x12, 0x221a02, 0x1, 0x0
  .long 0x21b020b, 0x23b022b, 0x25b024b, 0x27b026b, 0x2ab029b, 0x2cb02bb, 0x2eb02db, 0x28f02fb
  .long 0x765fedcb, 0xa4321098, 0x22c22222, 0x22222622, 0xa6, 0x2c0216, 0xa, 0x0
  .long 0x3650216, 0x42503e5, 0x73504a5, 0x7750755, 0x7d507b5, 0xb4507f5, 0xd050bc5, 0x29f0d85
  .long 0x76afedcb, 0x84321095, 0x22922222, 0x22222522, 0x82, 0x291502, 0x8, 0x0
  .long 0x2180208, 0x2380228, 0x2580248, 0x2780268, 0x2980288, 0x2c802b8, 0x2e802d8, 0x2af02f8
  .long 0x765aefcb, 0xd4321098, 0x22f22222, 0x22222f22, 0xd2, 0x2f1f02, 0xd, 0x0
  .long 0x2120202, 0x2320222, 0x2520242, 0x2720262, 0x2920282, 0x2c202a2, 0x2e202d2, 0x2bf02f2
  .long 0x76afedcb, 0x4351298, 0x22222222, 0x22222522, 0x2, 0x221502, 0x0, 0x0
  .long 0x21a020a, 0x23a022a, 0x25a024a, 0x27a026a, 0x29a028a, 0x2ba02aa, 0x2ea02da, 0x2cf02fa
  .long 0x765fedcb, 0x943210a8, 0x22722222, 0x22222022, 0x92, 0x271002, 0x9, 0x0
  .long 0x2190209, 0x2390229, 0x2570249, 0x2790269, 0x2990289, 0x2b902a9, 0x2e902c9, 0x2df02f9
  .long 0x765fadcb, 0xe4321098, 0x22a22222, 0x22222e22, 0xe2, 0x2a1e02, 0xe, 0x0
  .long 0x2130203, 0x2330223, 0x2530243, 0x2730260, 0x2930283, 0x2b302a3, 0x2d302c3, 0x2ef02f3
  .long 0x765fedab, 0xc4321098, 0x22922222, 0x22222d22, 0xc2, 0x291d02, 0xc, 0x0
  .long 0x2110201, 0x2310221, 0x2510241, 0x2710261, 0x2910281, 0x2b102a1, 0x2d102c1, 0x2ff02e1
  .long 0x76afedcb, 0x84321059, 0x33b33333, 0x33333133, 0x83, 0x2b1103, 0x8, 0x0
  .long 0x3280318, 0x3480338, 0x3680358, 0x3880378, 0x3a80398, 0x3c803b8, 0x3e803d8, 0x30f03f8
  .long 0x765aedcb, 0xf4321098, 0x33933333, 0x33333e33, 0xf3, 0x291e03, 0xf, 0x0
  .long 0x3240304, 0x3440334, 0x3640354, 0x3840374, 0x3a40394, 0x3c403b4, 0x3e403d4, 0x31f03f4
  .long 0x76afedcb, 0x4321598, 0x33033333, 0x33333233, 0x3, 0x201203, 0x0, 0x0
  .long 0x31a030a, 0x34a033a, 0x36a035a, 0x38a037a, 0x3aa039a, 0x3ca03ba, 0x3ea03da, 0x32f03fa
  .long 0x765fedac, 0xb4321098, 0x33a33333, 0x33333b33, 0xb3, 0x2a1b03, 0xb, 0x0
  .long 0x3100300, 0x3400320, 0x3600350, 0x3800370, 0x3a00390, 0x3c003b0, 0x3e003d0, 0x33f03f0
  .long 0x76afedcb, 0x24531098, 0x33133333, 0x33333a33, 0x23, 0x211a03, 0x2, 0x0
  .long 0x31c030c, 0x33c032c, 0x36c035c, 0x38c037c, 0x3ac039c, 0x3cc03bc, 0x3ec03dc, 0x34f03fc
  .long 0xa65fedcb, 0x74321098, 0x33933333, 0x33333133, 0x73, 0x291103, 0x7, 0x0
  .long 0x3170307, 0x3370327, 0x3670347, 0x3870377, 0x3a70397, 0x3c703b7, 0x3e703d6, 0x35f03f7
  .long 0x76afedcb, 0x15324098, 0x33333333, 0x33333633, 0x13, 0x231603, 0x1, 0x0
  .long 0x31b030b, 0x33b032b, 0x35b034b, 0x38b037b, 0x3ab039b, 0x3cb03bb, 0x3eb03db, 0x36f03fb
  .long 0x765fadcb, 0xe4321098, 0x33e33333, 0x33333a33, 0xe3, 0x2e1a03, 0xe, 0x0
  .long 0x3130303, 0x3330323, 0x3530343, 0x3830363, 0x3a30393, 0x3c303b3, 0x3e303d3, 0x37f03f2
  .long 0x76afedcb, 0x94321058, 0x33b33333, 0x33333133, 0x93, 0x2b1103, 0x9, 0x0
  .long 0x3190308, 0x3390329, 0x3590349, 0x3790369, 0x3a90399, 0x3c903b9, 0x3e903d9, 0x38f03f9
  .long 0x765fedcb, 0xa4321098, 0x33933333, 0x33333e33, 0xae, 0x29031e, 0xa, 0x0
  .long 0x1320103, 0x1b20183, 0x2e30263, 0x4740314, 0x82304f4, 0xd5208a3, 0xe420dd2, 0x39f0ec2
  .long 0x76afedcb, 0x54321098, 0x33033333, 0x33333233, 0x50, 0x120320, 0x5, 0x0
  .long 0x1fb017b, 0x65e032a, 0x73c06de, 0xaeb07bc, 0xc6a0c4d, 0xd0c0ccd, 0xf1e0d8c, 0x3af0f9e
  .long 0x765fedab, 0xc4321098, 0x33a33333, 0x33333b33, 0xc3, 0x2a1b03, 0xc, 0x0
  .long 0x3110301, 0x3300321, 0x3510341, 0x3710361, 0x3910381, 0x3c103a1, 0x3e103d1, 0x3bf03f1
  .long 0x76afedcb, 0x34521098, 0x33133333, 0x33333a33, 0x33, 0x211a03, 0x3, 0x0
  .long 0x31d030d, 0x33d032d, 0x35d034c, 0x37d036d, 0x39d038d, 0x3bd03ad, 0x3ed03dd, 0x3cf03fd
  .long 0xa75fedcb, 0x64321098, 0x33933333, 0x33333133, 0x63, 0x291103, 0x6, 0x0
  .long 0x3160306, 0x3360326, 0x3560346, 0x3760366, 0x3960386, 0x3b603a6, 0x3e603c6, 0x3df03f6
  .long 0x76afedcb, 0x45321098, 0x33333333, 0x33333633, 0x43, 0x231603, 0x4, 0x0
  .long 0x31e030e, 0x33e032e, 0x35e034e, 0x37e036b, 0x39e038e, 0x3be03ae, 0x3de03ce, 0x3ef03fe
  .long 0x765faecb, 0xd4321098, 0x33e33333, 0x33333a33, 0xd3, 0x2e1a03, 0xd, 0x0
  .long 0x3120302, 0x3320322, 0x3520342, 0x3720362, 0x3920382, 0x3b203a2, 0x3d203c2, 0x3ff03e2
  .long 0x765fedcb, 0x8432109a, 0x44a44444, 0x44444944, 0x84, 0x2a1904, 0x8, 0x0
  .long 0x4280418, 0x4480438, 0x4680458, 0x4870478, 0x4a80498, 0x4c804b8, 0x4e804d8, 0x40f04f8
  .long 0x76afedcb, 0x4521398, 0x44544444, 0x44444544, 0x4, 0x251504, 0x0, 0x0
  .long 0x42a040a, 0x44a043a, 0x46a045a, 0x48a047a, 0x4aa049a, 0x4ca04ba, 0x4ea04da, 0x41f04fa
  .long 0x76afedcb, 0x24351098, 0x44344444, 0x44444644, 0x24, 0x231604, 0x2, 0x0
  .long 0x41c040c, 0x44c043c, 0x46c045c, 0x48c047c, 0x4ac049c, 0x4cc04bc, 0x4ec04dc, 0x42f04fc
  .long 0x76afedcb, 0x45321098, 0x44444444, 0x44444a44, 0x44, 0x241a04, 0x4, 0x0
  .long 0x41e040e, 0x44e042e, 0x46e045e, 0x48e047e, 0x4ae049e, 0x4ce04bb, 0x4ee04de, 0x43f04fe
  .long 0x765fadce, 0xb4321098, 0x44744444, 0x44444b44, 0xb4, 0x271b04, 0xb, 0x0
  .long 0x4100400, 0x4300420, 0x4600450, 0x4800470, 0x4a00490, 0x4c004b0, 0x4e004d0, 0x44f04f0
  .long 0x765feacb, 0xd4321098, 0x44644444, 0x44444c44, 0xd4, 0x261c04, 0xd, 0x0
  .long 0x4120402, 0x4320422, 0x4620442, 0x4820472, 0x4a20492, 0x4c204b2, 0x4e204d2, 0x45f04f2
  .long 0x79afedcb, 0x64321058, 0x44744444, 0x44444744, 0x64, 0x271704, 0x6, 0x0
  .long 0x4160406, 0x4360426, 0x4560446, 0x4860476, 0x4a60496, 0x4c604b6, 0x4e604d6, 0x46f04f6
  .long 0x765aedcb, 0xf4321098, 0x44644444, 0x44444e44, 0xf4, 0x261e04, 0xf, 0x0
  .long 0x4140404, 0x4340424, 0x4540444, 0x4840464, 0x4a40494, 0x4c404b4, 0x4e404d4, 0x47f04f1
  .long 0x865fedcb, 0x7432109a, 0x44a44444, 0x44444944, 0x74, 0x2a1904, 0x7, 0x0
  .long 0x4170407, 0x4370427, 0x4570447, 0x4770467, 0x4a70497, 0x4c704b7, 0x4e704d7, 0x48f04f7
  .long 0x76afedcb, 0x34521098, 0x44544444, 0x44444544, 0x34, 0x251504, 0x3, 0x0
  .long 0x41a040d, 0x43d042d, 0x45d044d, 0x47d046d, 0x4ad048d, 0x4cd04bd, 0x4ed04dd, 0x49f04fd
  .long 0x76afedcb, 0x54321098, 0x44344444, 0x44444644, 0x53, 0x160423, 0x5, 0x0
  .long 0x1de015e, 0x3ee036e, 0x81b042c, 0x89b087e, 0x93d08fe, 0xd4e09bd, 0xf0d0dce, 0x4af0f8d
  .long 0x76afedcb, 0x15324098, 0x44444444, 0x44444a44, 0x14, 0x241a04, 0x1, 0x0
  .long 0x41b040b, 0x43b042b, 0x45b044b, 0x47b046b, 0x49b048b, 0x4cb04ab, 0x4eb04db, 0x4bf04fb
  .long 0x765fadcb, 0xe4321098, 0x44744444, 0x44444b44, 0xe4, 0x271b04, 0xe, 0x0
  .long 0x4130403, 0x4330423, 0x4530440, 0x4730463, 0x4930483, 0x4b304a3, 0x4e304d3, 0x4cf04f3
  .long 0x765fedcb, 0xa4321098, 0x44644444, 0x44444c44, 0xac, 0x26041c, 0xa, 0x0
  .long 0x5230452, 0x76405a3, 0x94207e4, 0xb1109c2, 0xb910b34, 0xc030bb4, 0xf740c83, 0x4df0ff4
  .long 0x76afedcb, 0x94321058, 0x44744444, 0x44444744, 0x94, 0x271704, 0x9, 0x0
  .long 0x4190409, 0x4390429, 0x4590449, 0x4790466, 0x4990489, 0x4b904a9, 0x4d904c9, 0x4ef04f9
  .long 0x765aedfb, 0xc4321098, 0x44644444, 0x44444e44, 0xc4, 0x261e04, 0xc, 0x0
  .long 0x4110401, 0x4310421, 0x4510441, 0x4710461, 0x4910481, 0x4b104a1, 0x4d104c1, 0x4ff04e1
  .long 0x76afedcb, 0x34521098, 0x55455555, 0x55555855, 0x35, 0x241805, 0x3, 0x0
  .long 0x52d051d, 0x54d053d, 0x56d055d, 0x58c057d, 0x5ad059d, 0x5cd05bd, 0x5ed05dd, 0x50f05fd
  .long 0x765fedcb, 0x943210a8, 0x55f55555, 0x55555a55, 0x95, 0x2f1a05, 0x9, 0x0
  .long 0x5290509, 0x5490539, 0x5690559, 0x5890579, 0x5a90596, 0x5c905b9, 0x5e905d9, 0x51f05f9
  .long 0x765fadeb, 0xc4321098, 0x55755555, 0x55555c55, 0xc5, 0x271c05, 0xc, 0x0
  .long 0x5110501, 0x5410531, 0x5610551, 0x5810571, 0x5a10591, 0x5c105b1, 0x5e105d1, 0x52f05f1
  .long 0x765feacd, 0xb4321098, 0x55c55555, 0x55555d55, 0xb5, 0x2c1d05, 0xb, 0x0
  .long 0x5100500, 0x5400520, 0x5600550, 0x5800570, 0x5a00590, 0x5c005b0, 0x5e005d0, 0x53f05f0
  .long 0xa65fedcb, 0x74321098, 0x55b55555, 0x55555455, 0x75, 0x2b1405, 0x7, 0x0
  .long 0x5170507, 0x5370527, 0x5670557, 0x5870577, 0x5a70597, 0x5c705b7, 0x5e705d7, 0x54f05f7
  .long 0x76afedcb, 0x84321095, 0x55f55555, 0x55555755, 0x85, 0x2f1705, 0x8, 0x0
  .long 0x5180508, 0x5380528, 0x5680548, 0x5880578, 0x5a80598, 0x5c805b8, 0x5e805d8, 0x55f05f8
  .long 0x76afedcb, 0x4325198, 0x55255555, 0x55555255, 0x5, 0x221205, 0x0, 0x0
  .long 0x51a050a, 0x53a052a, 0x55a054a, 0x58a057a, 0x5aa059a, 0x5ca05ba, 0x5ea05da, 0x56f05fa
  .long 0x765aedcb, 0xf4321098, 0x55955555, 0x55555d55, 0xf5, 0x291d05, 0xf, 0x0
  .long 0x5140504, 0x5340524, 0x5540544, 0x5840564, 0x5a40594, 0x5c405b4, 0x5e405d4, 0x57f05f4
  .long 0x76afedcb, 0x24531098, 0x55455555, 0x55555855, 0x25, 0x241805, 0x2, 0x0
  .long 0x51c050c, 0x53c052c, 0x55c054c, 0x57c056c, 0x5ac059c, 0x5cc05bc, 0x5ec05dc, 0x58f05fc
  .long 0x795fedcb, 0x643210a8, 0x55f55555, 0x55555a55, 0x65, 0x2f1a05, 0x6, 0x0
  .long 0x5160506, 0x5360526, 0x5560546, 0x5760566, 0x5a60586, 0x5c605b6, 0x5e605d6, 0x59f05f6
  .long 0x765fadcb, 0xe4321098, 0x55755555, 0x55555c55, 0xe5, 0x271c05, 0xe, 0x0
  .long 0x5130503, 0x5330521, 0x5530543, 0x5730563, 0x5930583, 0x5c305b3, 0x5e305d3, 0x5af05f3
  .long 0x765feacb, 0xd4321098, 0x55c55555, 0x55555d55, 0xd5, 0x2c1d05, 0xd, 0x0
  .long 0x5120502, 0x5300522, 0x5520542, 0x5720562, 0x5920582, 0x5c205a2, 0x5e205d2, 0x5bf05f2
  .long 0x765fedcb, 0xa4321098, 0x55b55555, 0x55555455, 0xa4, 0x2b0514, 0xa, 0x0
  .long 0xf50075, 0x6350547, 0x81506b5, 0x8950855, 0xb6508d5, 0xc290be5, 0xf050ca9, 0x5cf0f85
  .long 0x76afedcb, 0x54321098, 0x55f55555, 0x55555755, 0x5f, 0x17052f, 0x5, 0x0
  .long 0xc50045, 0x2b50235, 0x5580515, 0x8650595, 0xd2508e5, 0xdf50d75, 0xe850e05, 0x5df0fa5
  .long 0x76afedcb, 0x14325098, 0x55255555, 0x55555255, 0x15, 0x221205, 0x1, 0x0
  .long 0x51b050b, 0x53b052b, 0x55b054b, 0x57b056a, 0x59b058b, 0x5bb05ab, 0x5db05cb, 0x5ef05fb
  .long 0x76afedcb, 0x45321098, 0x55255555, 0x55555855, 0x45, 0x221805, 0x4, 0x0
  .long 0x51e050e, 0x53e052e, 0x55e054e, 0x57e056e, 0x59e058e, 0x5be05ae, 0x5de05ce, 0x5ff05ee
  .long 0x76afedcb, 0x24351098, 0x66166666, 0x66666566, 0x26, 0x211506, 0x2, 0x0
  .long 0x62c061c, 0x64c063c, 0x66c065c, 0x68c067c, 0x6ac069c, 0x6cc06bc, 0x6ec06dc, 0x60f06fc
  .long 0x765feacd, 0xb4321098, 0x66a66666, 0x66666b66, 0xb6, 0x2a1b06, 0xb, 0x0
  .long 0x6200600, 0x6400630, 0x6600650, 0x6800670, 0x6a00690, 0x6c006b0, 0x6e006d0, 0x61f06f0
  .long 0x76afedcb, 0x94321058, 0x66e66666, 0x66666366, 0x96, 0x2e1306, 0x9, 0x0
  .long 0x6190609, 0x6490639, 0x6690659, 0x6890679, 0x6a70699, 0x6c906b9, 0x6e906d9, 0x62f06f9
  .long 0x76afedcb, 0x4325198, 0x66166666, 0x66666466, 0x6, 0x211406, 0x0, 0x0
  .long 0x61a060a, 0x64a062a, 0x66a065a, 0x68a067a, 0x6aa069a, 0x6ca06ba, 0x6ea06da, 0x63f06fa
  .long 0x76afedcb, 0x84321095, 0x66566666, 0x66666966, 0x86, 0x251906, 0x8, 0x0
  .long 0x6180608, 0x6380628, 0x6680658, 0x6880678, 0x6a80698, 0x6c606b8, 0x6e806d8, 0x64f06f8
  .long 0x76afedcb, 0x45321098, 0x66066666, 0x66666566, 0x46, 0x201506, 0x4, 0x0
  .long 0x61e060e, 0x63e062e, 0x66e064e, 0x68e067e, 0x6ae069e, 0x6ce06be, 0x6ee06dd, 0x65f06fe
  .long 0x765fedcb, 0xa4321098, 0x66966666, 0x66666a66, 0xaa, 0x29061a, 0xa, 0x0
  .long 0x2850205, 0x3730345, 0x3f303c5, 0x4b50435, 0x5990519, 0x92506e3, 0xb5209a5, 0x66f0ed4
  .long 0x765aedfb, 0xc4321098, 0x66866666, 0x66666f66, 0xc6, 0x281f06, 0xc, 0x0
  .long 0x6110601, 0x6310621, 0x6510641, 0x6810661, 0x6a10691, 0x6c106b1, 0x6e106d1, 0x67f06f1
  .long 0x76afedcb, 0x54321098, 0x66166666, 0x66666566, 0x51, 0x150621, 0x5, 0x0
  .long 0x3cd034d, 0x63b060c, 0x91e06bb, 0xa2d099e, 0xb6d0aad, 0xbdc0b7e, 0xbfe0bed, 0x68f0e5d
  .long 0x765feacb, 0xd4321098, 0x66a66666, 0x66666b66, 0xd6, 0x2a1b06, 0xd, 0x0
  .long 0x6100602, 0x6320622, 0x6520642, 0x6720662, 0x6a20682, 0x6c206b2, 0x6e206d2, 0x69f06f2
  .long 0x96afedcb, 0x74321058, 0x66e66666, 0x66666366, 0x76, 0x2e1306, 0x7, 0x0
  .long 0x6170607, 0x6370627, 0x6570647, 0x6770667, 0x6970687, 0x6c706b7, 0x6e706d7, 0x6af06f7
  .long 0x76afedcb, 0x14325098, 0x66166666, 0x66666466, 0x16, 0x211406, 0x1, 0x0
  .long 0x61b060b, 0x63a062b, 0x65b064b, 0x67b066b, 0x69b068b, 0x6cb06ab, 0x6eb06db, 0x6bf06fb
  .long 0x78afedcb, 0x64321095, 0x66566666, 0x66666966, 0x66, 0x251906, 0x6, 0x0
  .long 0x6160606, 0x6360626, 0x6560646, 0x6760666, 0x6960686, 0x6b606a6, 0x6e606d6, 0x6cf06f6
  .long 0x76afedcb, 0x35421098, 0x66066666, 0x66666566, 0x36, 0x201506, 0x3, 0x0
  .long 0x61d060d, 0x63d062d, 0x65d064d, 0x67d066d, 0x69d068d, 0x6bd06ad, 0x6ed06cd, 0x6df06fd
  .long 0x765fadcb, 0xe4321098, 0x66966666, 0x66666a66, 0xe6, 0x291a06, 0xe, 0x0
  .long 0x6130603, 0x6330623, 0x6530643, 0x6730663, 0x6930683, 0x6b306a3, 0x6d306c3, 0x6ef06f3
  .long 0x765aedcb, 0xf4321098, 0x66866666, 0x66666f66, 0xf6, 0x281f06, 0xf, 0x0
  .long 0x6140604, 0x6340624, 0x6540644, 0x6710664, 0x6940684, 0x6b406a4, 0x6d406c4, 0x6ff06e4
  .long 0x765fadcb, 0xe4321098, 0x77d77777, 0x77777f77, 0xe7, 0x2d1f07, 0xe, 0x0
  .long 0x7230713, 0x7430733, 0x7630753, 0x7800773, 0x7a30793, 0x7c307b3, 0x7e307d3, 0x70f07f3
  .long 0x76afedcb, 0x4321598, 0x77277777, 0x77777177, 0x7, 0x221107, 0x0, 0x0
  .long 0x72a070a, 0x74a073a, 0x76a075a, 0x78a077a, 0x7aa079a, 0x7ca07ba, 0x7ea07da, 0x71f07fa
  .long 0x765fedcb, 0xa4321098, 0x77877777, 0x77777d77, 0xad, 0x28071d, 0xa, 0x0
  .long 0xc30043, 0x53202f1, 0x5b20574, 0x96307a1, 0xa0409e3, 0xa840a13, 0xf520a93, 0x72f0fd2
  .long 0x76afedcb, 0x24351098, 0x77077777, 0x77777677, 0x27, 0x201607, 0x2, 0x0
  .long 0x71c070c, 0x74c072c, 0x76c075c, 0x78c077c, 0x7ac079c, 0x7cc07bb, 0x7ec07dc, 0x73f07fc
  .long 0x56afedcb, 0x74321098, 0x77677777, 0x77777377, 0x77, 0x261307, 0x7, 0x0
  .long 0x7170707, 0x7370727, 0x7670757, 0x7870777, 0x7a70797, 0x7c607b7, 0x7e707d7, 0x74f07f7
  .long 0x76afedcb, 0x45321098, 0x77477777, 0x77777677, 0x47, 0x241607, 0x4, 0x0
  .long 0x71e070e, 0x73e072e, 0x76e074e, 0x78e077e, 0x7ae079e, 0x7ce07be, 0x7ee07dd, 0x75f07fe
  .long 0x765aefcb, 0xd4321098, 0x77e77777, 0x77777c77, 0xd7, 0x2e1c07, 0xd, 0x0
  .long 0x7120702, 0x7320722, 0x7520742, 0x7820772, 0x7a20792, 0x7c207b2, 0x7e207d2, 0x76f07f2
  .long 0x76afedcb, 0x94321058, 0x77c77777, 0x77777677, 0x97, 0x2c1607, 0x9, 0x0
  .long 0x7190709, 0x7390729, 0x7590749, 0x7890769, 0x7a90799, 0x7c907b9, 0x7e907d9, 0x77f07f8
  .long 0x765fadce, 0xb4321098, 0x77d77777, 0x77777f77, 0xb7, 0x2d1f07, 0xb, 0x0
  .long 0x7100700, 0x7300720, 0x7500740, 0x7700760, 0x7a00790, 0x7c007b0, 0x7e007d0, 0x78f07f0
  .long 0x76afedcb, 0x54321098, 0x77277777, 0x77777177, 0x52, 0x110722, 0x5, 0x0
  .long 0x24c020e, 0x28e027d, 0x56b02cc, 0x5fe05eb, 0xa3e071a, 0xc5e0abe, 0xdad0cde, 0x79f0f2a
  .long 0x765fedab, 0xc4321098, 0x77877777, 0x77777d77, 0xc7, 0x281d07, 0xc, 0x0
  .long 0x7110701, 0x7310721, 0x7510741, 0x7710761, 0x7910781, 0x7c107b1, 0x7e107d1, 0x7af07f1
  .long 0x76afedcb, 0x14352098, 0x77077777, 0x77777677, 0x17, 0x201607, 0x1, 0x0
  .long 0x71b070b, 0x73b072b, 0x75b074b, 0x77b076b, 0x79b078b, 0x7cb07ab, 0x7eb07db, 0x7bf07fb
  .long 0x57afedcb, 0x64321098, 0x77677777, 0x77777377, 0x67, 0x261307, 0x6, 0x0
  .long 0x7160706, 0x7360726, 0x7560746, 0x7760766, 0x7960786, 0x7b607a6, 0x7e607d6, 0x7cf07f6
  .long 0x76afedcb, 0x35421098, 0x77477777, 0x77777677, 0x37, 0x241607, 0x3, 0x0
  .long 0x71d070d, 0x73d072d, 0x75d074d, 0x77d076d, 0x79d078d, 0x7bd07ad, 0x7ed07cd, 0x7df07fd
  .long 0x765aedcb, 0xf4321098, 0x77e77777, 0x77777c77, 0xf7, 0x2e1c07, 0xf, 0x0
  .long 0x7140704, 0x7340724, 0x7540744, 0x7740762, 0x7940784, 0x7b407a4, 0x7d407c4, 0x7ef07f4
  .long 0x76afedcb, 0x84321059, 0x77c77777, 0x77777677, 0x87, 0x2c1607, 0x8, 0x0
  .long 0x7180708, 0x7380728, 0x7580748, 0x7780768, 0x7980788, 0x7b807a8, 0x7d807c8, 0x7ff07e8
  .long 0x765aedcb, 0xf4321098, 0x88e88888, 0x88888b88, 0xf8, 0x2e1b08, 0xf, 0x0
  .long 0x8240814, 0x8440834, 0x8640854, 0x8810874, 0x8a40894, 0x8c408b4, 0x8e408d4, 0x80f08f4
  .long 0x76afedcb, 0x14325098, 0x88388888, 0x88888488, 0x18, 0x231408, 0x1, 0x0
  .long 0x82b080b, 0x84b083b, 0x86b085b, 0x88b087b, 0x8ab089a, 0x8cb08bb, 0x8eb08db, 0x81f08fb
  .long 0x765fadcb, 0xe4321098, 0x88688888, 0x88888e88, 0xe8, 0x261e08, 0xe, 0x0
  .long 0x8130803, 0x8430833, 0x8630853, 0x8830873, 0x8a00893, 0x8c308b3, 0x8e308d3, 0x82f08f3
  .long 0x96afedcb, 0x74321058, 0x88788888, 0x88888888, 0x78, 0x271808, 0x7, 0x0
  .long 0x8170807, 0x8470827, 0x8670857, 0x8870877, 0x8a70897, 0x8c708b7, 0x8e708d7, 0x83f08f7
  .long 0x76afedcb, 0x34521098, 0x88488888, 0x88888788, 0x38, 0x241708, 0x3, 0x0
  .long 0x81d080d, 0x83d082d, 0x86d085d, 0x88d087d, 0x8ad089d, 0x8cd08bd, 0x8ed08dd, 0x84f08fd
  .long 0x76afedcb, 0x54321098, 0x88e88888, 0x88888488, 0x5e, 0x14082e, 0x5, 0x0
  .long 0x3750145, 0x62903f5, 0x76506a9, 0x80507e5, 0x8c50885, 0xa1508d6, 0xc350a95, 0x85f0cb5
  .long 0x765fedcb, 0x8432109a, 0x88f88888, 0x88888988, 0x88, 0x2f1908, 0x8, 0x0
  .long 0x8180808, 0x8380828, 0x8580848, 0x8880878, 0x8a80898, 0x8c808b8, 0x8e808d8, 0x86f08f8
  .long 0x76afedcb, 0x45321098, 0x88388888, 0x88888788, 0x48, 0x231708, 0x4, 0x0
  .long 0x81e080e, 0x83e082e, 0x85e084e, 0x88e086e, 0x8ae089e, 0x8ce08be, 0x8ee08de, 0x87f08fc
  .long 0x765aedfb, 0xc4321098, 0x88e88888, 0x88888b88, 0xc8, 0x2e1b08, 0xc, 0x0
  .long 0x8110801, 0x8310821, 0x8510841, 0x8710861, 0x8a10891, 0x8c108b1, 0x8e108d1, 0x88f08f1
  .long 0x76afedcb, 0x4325198, 0x88388888, 0x88888488, 0x8, 0x231408, 0x0, 0x0
  .long 0x81a080a, 0x83a082a, 0x85a084a, 0x87a086a, 0x8aa088a, 0x8ca08ba, 0x8ea08da, 0x89f08fa
  .long 0x765fadce, 0xb4321098, 0x88688888, 0x88888e88, 0xb8, 0x261e08, 0xb, 0x0
  .long 0x8100800, 0x8300820, 0x8500840, 0x8700860, 0x8900880, 0x8c008b0, 0x8e008d0, 0x8af08f0
  .long 0x76afedcb, 0x94321058, 0x88788888, 0x88888888, 0x98, 0x271808, 0x9, 0x0
  .long 0x8190809, 0x8370829, 0x8590849, 0x8790869, 0x8990889, 0x8c908a9, 0x8e908d9, 0x8bf08f9
  .long 0x765feacb, 0xd4321098, 0x88e88888, 0x88888f88, 0xd8, 0x2e1f08, 0xd, 0x0
  .long 0x8120802, 0x8320822, 0x8520842, 0x8720862, 0x8920882, 0x8b208a2, 0x8e208d2, 0x8cf08f2
  .long 0x75afedcb, 0x64321098, 0x88e88888, 0x88888488, 0x68, 0x2e1408, 0x6, 0x0
  .long 0x8160806, 0x8360826, 0x8560846, 0x8760866, 0x8960886, 0x8b608a6, 0x8e608c6, 0x8df08f6
  .long 0x765fedcb, 0xa4321098, 0x88f88888, 0x88888988, 0xa9, 0x2f0819, 0xa, 0x0
  .long 0x4880408, 0x6c50645, 0xa350868, 0xc550ab5, 0xcd50c75, 0xe250cf5, 0xf150ea5, 0x8ef0f95
  .long 0x76afedcb, 0x25341098, 0x88388888, 0x88888788, 0x28, 0x231708, 0x2, 0x0
  .long 0x81c080c, 0x83c082c, 0x85c084c, 0x87c086c, 0x89c088c, 0x8bc08ac, 0x8dc08cc, 0x8ff08ec
  .long 0x78afedcb, 0x64321095, 0x99799999, 0x99999099, 0x69, 0x271009, 0x6, 0x0
  .long 0x9260916, 0x9460936, 0x9660956, 0x9860976, 0x9a60996, 0x9c609b6, 0x9e609d6, 0x90f09f6
  .long 0x76afedcb, 0x45321098, 0x99199999, 0x99999899, 0x49, 0x211809, 0x4, 0x0
  .long 0x92e090e, 0x94e093e, 0x96e095e, 0x98e097e, 0x9ae099c, 0x9ce09be, 0x9ee09de, 0x91f09fe
  .long 0x76afedcb, 0x14325098, 0x99599999, 0x99999a99, 0x19, 0x251a09, 0x1, 0x0
  .long 0x91b090b, 0x94b093b, 0x96b095b, 0x98b097b, 0x9ab099b, 0x9cb09bb, 0x9eb09db, 0x92f09fb
  .long 0x76afedcb, 0x4521398, 0x99399999, 0x99999599, 0x9, 0x231509, 0x0, 0x0
  .long 0x91a090a, 0x94a092a, 0x96a095a, 0x98a097a, 0x9aa099a, 0x9ca09ba, 0x9ea09da, 0x93f09fa
  .long 0x765feacb, 0xd4321098, 0x99999999, 0x99999c99, 0xd9, 0x291c09, 0xd, 0x0
  .long 0x9120902, 0x9320922, 0x9620952, 0x9820972, 0x9a20992, 0x9c009b2, 0x9e209d2, 0x94f09f2
  .long 0x765aedcb, 0xf4321098, 0x99c99999, 0x99999b99, 0xf9, 0x2c1b09, 0xf, 0x0
  .long 0x9140904, 0x9340924, 0x9640944, 0x9840974, 0x9a40994, 0x9c409b4, 0x9e409d4, 0x95f09f4
  .long 0x765fadcb, 0xe4321098, 0x99599999, 0x99999d99, 0xe9, 0x251d09, 0xe, 0x0
  .long 0x9130903, 0x9330923, 0x9530943, 0x9830973, 0x9a30993, 0x9c309b3, 0x9e109d3, 0x96f09f3
  .long 0x76afedcb, 0x94321058, 0x99d99999, 0x99999599, 0x99, 0x2d1509, 0x9, 0x0
  .long 0x9190909, 0x9390929, 0x9590949, 0x9890969, 0x9a90999, 0x9c909b9, 0x9e909d9, 0x97f09f7
  .long 0x76afedcb, 0x84321095, 0x99799999, 0x99999099, 0x89, 0x271009, 0x8, 0x0
  .long 0x9180906, 0x9380928, 0x9580948, 0x9780968, 0x9a80998, 0x9c809b8, 0x9e809d8, 0x98f09f8
  .long 0x76afedcb, 0x25341098, 0x99199999, 0x99999899, 0x29, 0x211809, 0x2, 0x0
  .long 0x91c090c, 0x93c092c, 0x95c094c, 0x97c096c, 0x9ac098c, 0x9cc09bc, 0x9ec09dc, 0x99f09fc
  .long 0x76afedcb, 0x54321098, 0x99599999, 0x99999a99, 0x55, 0x1a0925, 0x5, 0x0
  .long 0x8e000e, 0x49d041d, 0x6c80648, 0x965092b, 0xb5509e5, 0xeb80e38, 0xf750ed5, 0x9af0ff5
  .long 0x76afedcb, 0x34521098, 0x99399999, 0x99999599, 0x39, 0x231509, 0x3, 0x0
  .long 0x91d090d, 0x93a092d, 0x95d094d, 0x97d096d, 0x99d098d, 0x9cd09ad, 0x9ed09dd, 0x9bf09fd
  .long 0x765feacd, 0xb4321098, 0x99999999, 0x99999c99, 0xb9, 0x291c09, 0xb, 0x0
  .long 0x9100900, 0x9300920, 0x9500940, 0x9700960, 0x9900980, 0x9b009a0, 0x9e009d0, 0x9cf09f0
  .long 0x765fedcb, 0xa4321098, 0x99c99999, 0x99999b99, 0xab, 0x2c091b, 0xa, 0x0
  .long 0x3b10331, 0x4c30443, 0x6920612, 0x8840804, 0xa610954, 0xd240ce2, 0xef30e73, 0x9df0fa3
  .long 0x765fadeb, 0xc4321098, 0x99599999, 0x99999d99, 0xc9, 0x251d09, 0xc, 0x0
  .long 0x9110901, 0x9310921, 0x9510941, 0x9710961, 0x9910981, 0x9b109a1, 0x9d109c1, 0x9ef09f1
  .long 0x96afedcb, 0x74321058, 0x99d99999, 0x99999599, 0x79, 0x2d1509, 0x7, 0x0
  .long 0x9170907, 0x9370927, 0x9570947, 0x9770967, 0x9970987, 0x9b709a7, 0x9d709c7, 0x9ff09e7
  .long 0x765aedcb, 0xf4321098, 0xaa6aaaaa, 0xaaaaadaa, 0xfa, 0x261d0a, 0xf, 0x0
  .long 0xa240a14, 0xa440a34, 0xa640a54, 0xa820a74, 0xaa40a94, 0xac40ab4, 0xae40ad4, 0xa0f0af4
  .long 0x765fadce, 0xb4321098, 0xaaeaaaaa, 0xaaaaadaa, 0xba, 0x2e1d0a, 0xb, 0x0
  .long 0xa200a00, 0xa400a30, 0xa600a50, 0xa800a70, 0xaa00a90, 0xac00ab0, 0xae00ad0, 0xa1f0af0
  .long 0x76afedcb, 0x34521098, 0xaa1aaaaa, 0xaaaaa7aa, 0x3a, 0x21170a, 0x3, 0x0
  .long 0xa1d0a0d, 0xa4d0a3d, 0xa6d0a5d, 0xa8d0a7d, 0xaac0a9d, 0xacd0abd, 0xaed0add, 0xa2f0afd
  .long 0x76afedcb, 0x45321098, 0xaa2aaaaa, 0xaaaaa9aa, 0x4a, 0x22190a, 0x4, 0x0
  .long 0xa1e0a0e, 0xa4e0a2e, 0xa6e0a5e, 0xa8e0a7e, 0xaae0a9e, 0xace0aba, 0xaee0ade, 0xa3f0afe
  .long 0x765fedcb, 0xa4321098, 0xaaaaaaaa, 0xaaaaa8aa, 0xa8, 0x2a0a18, 0xa, 0x0
  .long 0x1d50155, 0x5050275, 0x5f50585, 0x8b50835, 0x9950915, 0xda50ac5, 0xee50e65, 0xa4f0f25
  .long 0x86afedcb, 0x74321095, 0xaadaaaaa, 0xaaaaa2aa, 0x7a, 0x2d120a, 0x7, 0x0
  .long 0xa170a07, 0xa370a27, 0xa670a47, 0xa870a77, 0xaa70a97, 0xac70ab7, 0xae70ad7, 0xa5f0af7
  .long 0x765fedab, 0xc4321098, 0xaa6aaaaa, 0xaaaaabaa, 0xca, 0x261b0a, 0xc, 0x0
  .long 0xa110a01, 0xa310a21, 0xa510a41, 0xa810a71, 0xaa10a91, 0xac10ab1, 0xae10ad1, 0xa6f0af1
  .long 0x765fedcb, 0x943210a8, 0xaaaaaaaa, 0xaaaaa1aa, 0x9a, 0x2a110a, 0x9, 0x0
  .long 0xa190a09, 0xa390a29, 0xa590a49, 0xa890a69, 0xaa90a99, 0xac90ab9, 0xae90ad9, 0xa7f0af6
  .long 0x765aefcb, 0xd4321098, 0xaa6aaaaa, 0xaaaaadaa, 0xda, 0x261d0a, 0xd, 0x0
  .long 0xa120a02, 0xa320a22, 0xa520a42, 0xa720a62, 0xaa20a92, 0xac20ab2, 0xae20ad2, 0xa8f0af2
  .long 0x765fadcb, 0xe4321098, 0xaaeaaaaa, 0xaaaaadaa, 0xea, 0x2e1d0a, 0xe, 0x0
  .long 0xa100a03, 0xa330a23, 0xa530a43, 0xa730a63, 0xaa30a83, 0xac30ab3, 0xae30ad3, 0xa9f0af3
  .long 0x76afedcb, 0x24531098, 0xaa1aaaaa, 0xaaaaa7aa, 0x2a, 0x21170a, 0x2, 0x0
  .long 0xa1c0a0c, 0xa3c0a2c, 0xa5c0a4c, 0xa7c0a6c, 0xa9c0a8c, 0xacc0abc, 0xaec0adc, 0xaaf0afc
  .long 0x76afedcb, 0x5321498, 0xaa2aaaaa, 0xaaaaa9aa, 0xa, 0x22190a, 0x0, 0x0
  .long 0xa1a0a0a, 0xa3a0a2a, 0xa5a0a4a, 0xa7a0a6a, 0xa9a0a8a, 0xaca0aaa, 0xaea0ada, 0xabf0afa
  .long 0x76afedcb, 0x54321098, 0xaaaaaaaa, 0xaaaaa8aa, 0x5a, 0x180a2a, 0x5, 0x0
  .long 0x1a50125, 0x2e50265, 0x3b50335, 0x4850405, 0x6950615, 0xa750a45, 0xd550af5, 0xacf0dd5
  .long 0x76afedcb, 0x84321095, 0xaadaaaaa, 0xaaaaa2aa, 0x8a, 0x2d120a, 0x8, 0x0
  .long 0xa180a08, 0xa380a28, 0xa570a48, 0xa780a68, 0xa980a88, 0xab80aa8, 0xae80ac8, 0xadf0af8
  .long 0x76afedcb, 0x14325098, 0xaa0aaaaa, 0xaaaaa1aa, 0x1a, 0x20110a, 0x1, 0x0
  .long 0xa1b0a0b, 0xa3b0a2b, 0xa5b0a4b, 0xa7b0a6b, 0xa9b0a8b, 0xabb0aab, 0xadb0acb, 0xaef0afb
  .long 0x795fedcb, 0x643210a8, 0xaaaaaaaa, 0xaaaaa1aa, 0x6a, 0x2a110a, 0x6, 0x0
  .long 0xa160a06, 0xa360a26, 0xa560a46, 0xa760a66, 0xa960a86, 0xab60aa6, 0xad60ac6, 0xaff0ae6
  .long 0x765fedcb, 0xa4321098, 0xbb8bbbbb, 0xbbbbb7bb, 0xa7, 0x280b17, 0xa, 0x0
  .long 0x950015, 0x46501c5, 0x55504e5, 0x84505d5, 0x8f50875, 0xaa50a25, 0xf350b86, 0xb0f0fb5
  .long 0x765fedac, 0xb4321098, 0xbbdbbbbb, 0xbbbbbcbb, 0xbb, 0x2d1c0b, 0xb, 0x0
  .long 0xb200b00, 0xb400b30, 0xb600b50, 0xb800b70, 0xba00b90, 0xbc00bb0, 0xbe00bd0, 0xb1f0bf0
  .long 0x765fedcb, 0x943210a8, 0xbbcbbbbb, 0xbbbbb0bb, 0x9b, 0x2c100b, 0x9, 0x0
  .long 0xb190b09, 0xb490b39, 0xb690b59, 0xb890b79, 0xba70b99, 0xbc90bb9, 0xbe90bd9, 0xb2f0bf9
  .long 0x765afdcb, 0xe4321098, 0xbb6bbbbb, 0xbbbbbcbb, 0xeb, 0x261c0b, 0xe, 0x0
  .long 0xb130b03, 0xb430b23, 0xb630b53, 0xb830b73, 0xba30b93, 0xbc30bb3, 0xbe30bd3, 0xb3f0bf3
  .long 0x76afedcb, 0x84321095, 0xbb8bbbbb, 0xbbbbb6bb, 0x8b, 0x28160b, 0x8, 0x0
  .long 0xb180b08, 0xb380b28, 0xb680b58, 0xb880b78, 0xba80b98, 0xbc80bb8, 0xbe80bd8, 0xb4f0bf8
  .long 0x765feacb, 0xd4321098, 0xbb5bbbbb, 0xbbbbbabb, 0xdb, 0x251a0b, 0xd, 0x0
  .long 0xb120b02, 0xb320b22, 0xb620b42, 0xb820b72, 0xba20b92, 0xbc20bb2, 0xbe20bd2, 0xb5f0bf2
  .long 0x76afedcb, 0x34521098, 0xbb1bbbbb, 0xbbbbb4bb, 0x3b, 0x21140b, 0x3, 0x0
  .long 0xb1d0b0d, 0xb3d0b2d, 0xb5d0b4d, 0xb8d0b7d, 0xbad0b9d, 0xbcd0bbd, 0xbeb0bdd, 0xb6f0bfd
  .long 0x76afedcb, 0x5321498, 0xbb1bbbbb, 0xbbbbb2bb, 0xb, 0x21120b, 0x0, 0x0
  .long 0xb1a0b0a, 0xb3a0b2a, 0xb5a0b4a, 0xb8a0b6a, 0xbaa0b9a, 0xbca0bba, 0xbea0bda, 0xb7f0bfa
  .long 0x7a5fedcb, 0x64321098, 0xbb8bbbbb, 0xbbbbb7bb, 0x6b, 0x28170b, 0x6, 0x0
  .long 0xb160b06, 0xb360b26, 0xb560b46, 0xb760b66, 0xba60b96, 0xbc60bb6, 0xbe60bd6, 0xb8f0bf6
  .long 0x765fedab, 0xc4321098, 0xbbdbbbbb, 0xbbbbbcbb, 0xcb, 0x2d1c0b, 0xc, 0x0
  .long 0xb100b01, 0xb310b21, 0xb510b41, 0xb710b61, 0xba10b81, 0xbc10bb1, 0xbe10bd1, 0xb9f0bf1
  .long 0x965fedcb, 0x743210a8, 0xbbcbbbbb, 0xbbbbb0bb, 0x7b, 0x2c100b, 0x7, 0x0
  .long 0xb170b07, 0xb370b27, 0xb570b47, 0xb770b67, 0xb970b87, 0xbc70bb7, 0xbe70bd7, 0xbaf0bf7
  .long 0x765aedcb, 0xf4321098, 0xbb6bbbbb, 0xbbbbbcbb, 0xfb, 0x261c0b, 0xf, 0x0
  .long 0xb140b04, 0xb330b24, 0xb540b44, 0xb740b64, 0xb940b84, 0xbc40ba4, 0xbe40bd4, 0xbbf0bf4
  .long 0x76afedcb, 0x54321098, 0xbb8bbbbb, 0xbbbbb6bb, 0x58, 0x160b28, 0x5, 0x0
  .long 0xd50055, 0x1650135, 0x1e501b5, 0x6f50675, 0x7a50725, 0xb480b05, 0xc150b85, 0xbcf0c95
  .long 0x76afedcb, 0x24351098, 0xbb1bbbbb, 0xbbbbb3bb, 0x2b, 0x21130b, 0x2, 0x0
  .long 0xb1c0b0c, 0xb3c0b2c, 0xb5c0b4c, 0xb7c0b6c, 0xb9c0b8c, 0xbbc0bac, 0xbec0bcc, 0xbdf0bfc
  .long 0x76afedcb, 0x14523098, 0xbb1bbbbb, 0xbbbbb4bb, 0x1b, 0x21140b, 0x1, 0x0
  .long 0xb1b0b0b, 0xb3b0b2b, 0xb5b0b4b, 0xb7b0b6b, 0xb9b0b8b, 0xbbb0bab, 0xbdb0bcb, 0xbef0bfb
  .long 0x76afedcb, 0x45321098, 0xbb1bbbbb, 0xbbbbb2bb, 0x4b, 0x21120b, 0x4, 0x0
  .long 0xb1e0b0e, 0xb3e0b2e, 0xb5e0b4e, 0xb7a0b6e, 0xb9e0b8e, 0xbbe0bae, 0xbde0bce, 0xbff0bee
  .long 0x765fadce, 0xb4321098, 0xcccccccc, 0xcccccccc, 0xbc, 0x2c1c0c, 0xb, 0x0
  .long 0xc200c10, 0xc400c30, 0xc600c50, 0xc800c70, 0xca00c90, 0xcc00cb0, 0xce00cd0, 0xc0f0cf0
  .long 0x765aedfb, 0xc4321098, 0xcc8ccccc, 0xcccccfcc, 0xcc, 0x281f0c, 0xc, 0x0
  .long 0xc210c01, 0xc410c31, 0xc610c51, 0xc810c71, 0xca10c91, 0xcc10cb1, 0xce10cd1, 0xc1f0cf1
  .long 0x765fedcb, 0x843210a9, 0xccbccccc, 0xccccc4cc, 0x8c, 0x2b140c, 0x8, 0x0
  .long 0xc180c08, 0xc480c38, 0xc680c58, 0xc880c78, 0xca80c98, 0xcc80cb8, 0xce80cd8, 0xc2f0cf8
  .long 0x765fedcb, 0xa4321098, 0xcceccccc, 0xccccc1cc, 0xa1, 0x2e0c11, 0xa, 0x0
  .long 0x1a80128, 0x3570305, 0x3d70385, 0x7950715, 0xae50a79, 0xc450af9, 0xcb70c65, 0xc3f0cc5
  .long 0x76afedcb, 0x34521098, 0xcc0ccccc, 0xccccc1cc, 0x3c, 0x20110c, 0x3, 0x0
  .long 0xc1d0c0d, 0xc3d0c2d, 0xc6d0c5d, 0xc8d0c7d, 0xcad0c9d, 0xccb0cbd, 0xced0cdd, 0xc4f0cfd
  .long 0x76afedcb, 0x25341098, 0xcc2ccccc, 0xccccc9cc, 0x2c, 0x22190c, 0x2, 0x0
  .long 0xc1c0c0c, 0xc3c0c2c, 0xc6c0c4c, 0xc8c0c7c, 0xcac0c9c, 0xccc0cbc, 0xcec0cdc, 0xc5f0cfc
  .long 0x76afedcb, 0x4321598, 0xcc0ccccc, 0xccccc1cc, 0xc, 0x20110c, 0x0, 0x0
  .long 0xc1a0c0a, 0xc3a0c2a, 0xc5a0c4a, 0xc8a0c7a, 0xcaa0c9a, 0xcca0cba, 0xcea0cda, 0xc6f0cfa
  .long 0x76afedcb, 0x54321098, 0xcc7ccccc, 0xccccc9cc, 0x57, 0x190c27, 0x5, 0x0
  .long 0x990019, 0x2d50255, 0x4690445, 0x4e904c5, 0x5a50525, 0x8b90839, 0x9880908, 0xc7f0cf6
  .long 0x765fadcb, 0xe4321098, 0xcccccccc, 0xcccccccc, 0xec, 0x2c1c0c, 0xe, 0x0
  .long 0xc130c00, 0xc330c23, 0xc530c43, 0xc730c63, 0xca30c93, 0xcc30cb3, 0xce30cd3, 0xc8f0cf3
  .long 0x765aedcb, 0xf4321098, 0xcc8ccccc, 0xcccccfcc, 0xfc, 0x281f0c, 0xf, 0x0
  .long 0xc110c04, 0xc340c24, 0xc540c44, 0xc740c64, 0xca40c84, 0xcc40cb4, 0xce40cd4, 0xc9f0cf4
  .long 0x765fedcb, 0x943210a8, 0xccbccccc, 0xccccc4cc, 0x9c, 0x2b140c, 0x9, 0x0
  .long 0xc190c09, 0xc390c28, 0xc590c49, 0xc790c69, 0xc990c89, 0xcc90cb9, 0xce90cd9, 0xcaf0cf9
  .long 0xa65fedcb, 0x74321098, 0xcceccccc, 0xccccc1cc, 0x7c, 0x2e110c, 0x7, 0x0
  .long 0xc170c07, 0xc370c27, 0xc570c47, 0xc770c67, 0xc970c87, 0xcc70ca7, 0xce70cd7, 0xcbf0cf7
  .long 0x76afedcb, 0x14523098, 0xcc0ccccc, 0xccccc1cc, 0x1c, 0x20110c, 0x1, 0x0
  .long 0xc1b0c0b, 0xc3b0c2b, 0xc5b0c4b, 0xc7b0c6b, 0xc9b0c8b, 0xcbb0cab, 0xceb0cdb, 0xccf0cfb
  .long 0x76afedcb, 0x45321098, 0xcc2ccccc, 0xccccc9cc, 0x4c, 0x22190c, 0x4, 0x0
  .long 0xc1e0c0e, 0xc3e0c2e, 0xc5c0c4e, 0xc7e0c6e, 0xc9e0c8e, 0xcbe0cae, 0xcee0cce, 0xcdf0cfe
  .long 0x765feacb, 0xd4321098, 0xcc6ccccc, 0xcccccbcc, 0xdc, 0x261b0c, 0xd, 0x0
  .long 0xc120c02, 0xc320c22, 0xc520c42, 0xc720c62, 0xc920c82, 0xcb20ca2, 0xcd20cc2, 0xcef0cf2
  .long 0x75afedcb, 0x64321098, 0xcc7ccccc, 0xccccc9cc, 0x6c, 0x27190c, 0x6, 0x0
  .long 0xc160c06, 0xc360c26, 0xc560c46, 0xc760c66, 0xc960c86, 0xcb60ca6, 0xcd60cc6, 0xcff0ce6
  .long 0x76afedcb, 0x24351098, 0xdd0ddddd, 0xddddd6dd, 0x2d, 0x20160d, 0x2, 0x0
  .long 0xd2c0d1c, 0xd4c0d3c, 0xd6c0d5c, 0xd8b0d7c, 0xdac0d9c, 0xdcc0dbc, 0xdec0ddc, 0xd0f0dfc
  .long 0x56afedcb, 0x74321098, 0xdd6ddddd, 0xddddd3dd, 0x7d, 0x26130d, 0x7, 0x0
  .long 0xd270d07, 0xd470d37, 0xd670d57, 0xd870d77, 0xda70d97, 0xdc70db7, 0xde70dd7, 0xd1f0df7
  .long 0x765aedcb, 0xf4321098, 0xddfddddd, 0xdddddbdd, 0xfd, 0x2f1b0d, 0xf, 0x0
  .long 0xd140d04, 0xd440d34, 0xd640d54, 0xd840d74, 0xda40d94, 0xdc40db4, 0xde40dd4, 0xd2f0df4
  .long 0x76afedcb, 0x94321058, 0xdddddddd, 0xddddd3dd, 0x9d, 0x2d130d, 0x9, 0x0
  .long 0xd190d09, 0xd490d29, 0xd690d59, 0xd890d79, 0xda90d99, 0xdc90db6, 0xde90dd9, 0xd3f0df9
  .long 0x76afedcb, 0x45321098, 0xdd3ddddd, 0xddddd0dd, 0x4d, 0x23100d, 0x4, 0x0
  .long 0xd1e0d0e, 0xd3e0d2e, 0xd6e0d5e, 0xd8e0d7e, 0xdae0d9e, 0xdca0dbe, 0xdee0dde, 0xd4f0dfe
  .long 0x765feadb, 0xc4321098, 0xddaddddd, 0xdddddedd, 0xcd, 0x2a1e0d, 0xc, 0x0
  .long 0xd110d01, 0xd310d21, 0xd610d41, 0xd810d71, 0xda10d91, 0xdc10db1, 0xde10dd1, 0xd5f0df1
  .long 0x765fadce, 0xb4321098, 0xddbddddd, 0xdddddfdd, 0xbd, 0x2b1f0d, 0xb, 0x0
  .long 0xd100d00, 0xd300d20, 0xd500d40, 0xd800d70, 0xda00d90, 0xdc00db0, 0xde00dd0, 0xd6f0df0
  .long 0x765fedcb, 0xa4321098, 0xddfddddd, 0xddddd0dd, 0xa0, 0x2f0d10, 0xa, 0x0
  .long 0xe50065, 0x1950115, 0x2d90259, 0x9850905, 0xba90b29, 0xdc50d45, 0xe350df8, 0xd7f0eb5
  .long 0x76afedcb, 0x14352098, 0xdd0ddddd, 0xddddd6dd, 0x1d, 0x20160d, 0x1, 0x0
  .long 0xd1b0d0b, 0xd3b0d2b, 0xd5b0d4b, 0xd7b0d6b, 0xdab0d9b, 0xdcb0dbb, 0xdeb0ddb, 0xd8f0dfb
  .long 0x76afedcb, 0x54321098, 0xdd6ddddd, 0xddddd3dd, 0x56, 0x130d26, 0x5, 0x0
  .long 0x4750455, 0x4f504d5, 0x7c70747, 0x8a50825, 0xa650a05, 0xb350a85, 0xce50bb5, 0xd9f0d17
  .long 0x76afedcb, 0x34521098, 0xdd2ddddd, 0xddddd8dd, 0x3d, 0x22180d, 0x3, 0x0
  .long 0xd1d0d0d, 0xd3d0d2d, 0xd5d0d4d, 0xd7d0d6d, 0xd9d0d8d, 0xdcd0dbd, 0xded0ddd, 0xdaf0dfd
  .long 0x79afedcb, 0x64321058, 0xdddddddd, 0xddddd3dd, 0x6d, 0x2d130d, 0x6, 0x0
  .long 0xd160d06, 0xd360d26, 0xd560d46, 0xd760d66, 0xd960d86, 0xdc60da6, 0xde60dd6, 0xdbf0df6
  .long 0x76afedcb, 0x5321498, 0xdd3ddddd, 0xddddd0dd, 0xd, 0x23100d, 0x0, 0x0
  .long 0xd1a0d0a, 0xd3a0d2a, 0xd5a0d4a, 0xd7a0d6a, 0xd9a0d8a, 0xdba0daa, 0xdea0dda, 0xdcf0dfa
  .long 0x765feacb, 0xd4321098, 0xddaddddd, 0xdddddedd, 0xdd, 0x2a1e0d, 0xd, 0x0
  .long 0xd120d02, 0xd320d22, 0xd510d42, 0xd720d62, 0xd920d82, 0xdb20da2, 0xde20dc2, 0xddf0df2
  .long 0x765fadcb, 0xe4321098, 0xddbddddd, 0xdddddfdd, 0xed, 0x2b1f0d, 0xe, 0x0
  .long 0xd130d03, 0xd330d23, 0xd530d43, 0xd730d60, 0xd930d83, 0xdb30da3, 0xdd30dc3, 0xdef0df3
  .long 0x765fedcb, 0x8432109a, 0xddfddddd, 0xddddd0dd, 0x8d, 0x2f100d, 0x8, 0x0
  .long 0xd180d08, 0xd380d28, 0xd580d48, 0xd780d68, 0xd980d88, 0xdb80da8, 0xdd80dc8, 0xdff0de8
  .long 0x7a5fedcb, 0x64321098, 0xeefeeeee, 0xeeeee2ee, 0x6e, 0x2f120e, 0x6, 0x0
  .long 0xe260e16, 0xe460e36, 0xe660e56, 0xe860e76, 0xea60e96, 0xec60eb6, 0xee60ed6, 0xe0f0ef6
  .long 0x76afedcb, 0x4351298, 0xee4eeeee, 0xeeeee2ee, 0xe, 0x24120e, 0x0, 0x0
  .long 0xe2a0e0a, 0xe4a0e3a, 0xe6a0e5a, 0xe8a0e7a, 0xeaa0e9a, 0xeca0eba, 0xeea0eda, 0xe1f0efa
  .long 0x76afedcb, 0x45321098, 0xee4eeeee, 0xeeeee9ee, 0x4e, 0x24190e, 0x4, 0x0
  .long 0xe1e0e0e, 0xe4e0e3e, 0xe6e0e5e, 0xe8e0e7e, 0xeab0e9e, 0xece0ebe, 0xeee0ede, 0xe2f0efe
  .long 0x76afedcb, 0x84321095, 0xee5eeeee, 0xeeeee0ee, 0x8e, 0x25100e, 0x8, 0x0
  .long 0xe180e08, 0xe480e28, 0xe680e58, 0xe880e78, 0xea80e98, 0xec80eb7, 0xee80ed8, 0xe3f0ef8
  .long 0x765feadb, 0xc4321098, 0xeeceeeee, 0xeeeeeeee, 0xce, 0x2c1e0e, 0xc, 0x0
  .long 0xe110e01, 0xe310e21, 0xe610e51, 0xe810e71, 0xea10e91, 0xec10eb1, 0xee10ed1, 0xe4f0ef1
  .long 0x76afedcb, 0x34521098, 0xee1eeeee, 0xeeeee3ee, 0x3e, 0x21130e, 0x3, 0x0
  .long 0xe1d0e0d, 0xe3d0e2d, 0xe6d0e4d, 0xe8d0e7d, 0xead0e9d, 0xecd0ebd, 0xeed0edd, 0xe5f0efd
  .long 0x76afedcb, 0x54321098, 0xeedeeeee, 0xeeeee8ee, 0x5d, 0x180e2d, 0x5, 0x0
  .long 0xa50025, 0x7850705, 0x9f90979, 0xad80a58, 0xb950b15, 0xdb90d39, 0xf450ee9, 0xe6f0fc5
  .long 0x765fadce, 0xb4321098, 0xeebeeeee, 0xeeeeebee, 0xbe, 0x2b1b0e, 0xb, 0x0
  .long 0xe100e00, 0xe300e20, 0xe500e40, 0xe800e60, 0xea00e90, 0xec00eb0, 0xee00ed0, 0xe7f0ef0
  .long 0x765fedcb, 0xa4321098, 0xeefeeeee, 0xeeeee2ee, 0xa2, 0x2f0e12, 0xa, 0x0
  .long 0xb80038, 0x3a50325, 0x5e50565, 0xad50a55, 0xbf50b75, 0xe150e06, 0xf490e95, 0xe8f0fc9
  .long 0x76afedcb, 0x24351098, 0xee4eeeee, 0xeeeee2ee, 0x2e, 0x24120e, 0x2, 0x0
  .long 0xe1a0e0c, 0xe3c0e2c, 0xe5c0e4c, 0xe7c0e6c, 0xeac0e8c, 0xecc0ebc, 0xeec0edc, 0xe9f0efc
  .long 0x76afedcb, 0x15324098, 0xee4eeeee, 0xeeeee9ee, 0x1e, 0x24190e, 0x1, 0x0
  .long 0xe1b0e0b, 0xe3b0e2b, 0xe5b0e4b, 0xe7b0e6b, 0xe9b0e8b, 0xecb0ebb, 0xeeb0edb, 0xeaf0efb
  .long 0x86afedcb, 0x74321095, 0xee5eeeee, 0xeeeee0ee, 0x7e, 0x25100e, 0x7, 0x0
  .long 0xe170e07, 0xe370e27, 0xe570e47, 0xe770e67, 0xe970e87, 0xec70ea7, 0xee70ed7, 0xebf0ef7
  .long 0x765feacb, 0xd4321098, 0xeeceeeee, 0xeeeeeeee, 0xde, 0x2c1e0e, 0xd, 0x0
  .long 0xe120e02, 0xe320e22, 0xe520e41, 0xe720e62, 0xe920e82, 0xeb20ea2, 0xee20ed2, 0xecf0ef2
  .long 0x765aedcb, 0xf4321098, 0xee5eeeee, 0xeeeeeaee, 0xfe, 0x251a0e, 0xf, 0x0
  .long 0xe140e04, 0xe340e24, 0xe540e44, 0xe740e64, 0xe940e84, 0xeb40ea4, 0xee40ec4, 0xedf0ef4
  .long 0x76afedcb, 0x94321058, 0xeedeeeee, 0xeeeee8ee, 0x9e, 0x2d180e, 0x9, 0x0
  .long 0xe190e09, 0xe390e29, 0xe590e49, 0xe790e69, 0xe990e89, 0xeb90ea9, 0xed90ec9, 0xeef0ef9
  .long 0x765fadcb, 0xe4321098, 0xeebeeeee, 0xeeeeebee, 0xee, 0x2b1b0e, 0xe, 0x0
  .long 0xe130e03, 0xe330e23, 0xe530e43, 0xe700e63, 0xe930e83, 0xeb30ea3, 0xed30ec3, 0xeff0ee3
  .long 0x76afedcb, 0x34521098, 0xff3fffff, 0xfffff4ff, 0x3f, 0x23140f, 0x3, 0x0
  .long 0xf2d0f1d, 0xf4d0f3d, 0xf6d0f5d, 0xf8b0f7d, 0xfad0f9d, 0xfcd0fbd, 0xfed0fdd, 0xf0f0ffd
  .long 0x76afedcb, 0x25341098, 0xff0fffff, 0xfffff9ff, 0x2f, 0x20190f, 0x2, 0x0
  .long 0xf2c0f0c, 0xf4c0f3c, 0xf6c0f5c, 0xf8c0f7c, 0xfac0f9c, 0xfcc0fbc, 0xfec0fdc, 0xf1f0ffc
  .long 0x76afedcb, 0x4321598, 0xff2fffff, 0xfffff8ff, 0xf, 0x22180f, 0x0, 0x0
  .long 0xf1a0f0a, 0xf4a0f3a, 0xf6a0f5a, 0xf8a0f7a, 0xfaa0f9a, 0xfca0fba, 0xfea0fda, 0xf2f0ffa
  .long 0x86afedcb, 0x74321095, 0xffbfffff, 0xfffff7ff, 0x7f, 0x2b170f, 0x7, 0x0
  .long 0xf170f07, 0xf470f27, 0xf670f57, 0xf870f77, 0xfa70f97, 0xfc70fb7, 0xfe70fd7, 0xf3f0ff7
  .long 0x795fedcb, 0x643210a8, 0xffdfffff, 0xfffff2ff, 0x6f, 0x2d120f, 0x6, 0x0
  .long 0xf160f06, 0xf360f26, 0xf660f56, 0xf860f76, 0xfa60f96, 0xfc60fb6, 0xfe60fd6, 0xf4f0ff6
  .long 0x765feacb, 0xd4321098, 0xffbfffff, 0xfffffdff, 0xdf, 0x2b1d0f, 0xd, 0x0
  .long 0xf120f02, 0xf320f22, 0xf620f42, 0xf820f72, 0xfa20f92, 0xfc20fb2, 0xfe20fd1, 0xf5f0ff2
  .long 0x76afedcb, 0x54321098, 0xffcfffff, 0xfffff5ff, 0x5c, 0x150f2c, 0x5, 0x0
  .long 0x2950215, 0x5b50535, 0x7f90779, 0x9d50955, 0xba50b25, 0xc850c05, 0xec50e45, 0xf6f0fe5
  .long 0x765aedcf, 0xb4321098, 0xff5fffff, 0xfffffcff, 0xbf, 0x251c0f, 0xb, 0x0
  .long 0xf100f00, 0xf300f20, 0xf500f40, 0xf800f60, 0xfa00f90, 0xfc00fb0, 0xfe00fd0, 0xf7f0ff0
  .long 0x76afedcb, 0x14523098, 0xff3fffff, 0xfffff4ff, 0x1f, 0x23140f, 0x1, 0x0
  .long 0xf1b0f0b, 0xf3b0f2b, 0xf5b0f4b, 0xf7b0f6b, 0xfab0f9b, 0xfcb0fbb, 0xfeb0fdb, 0xf8f0ffb
  .long 0x76afedcb, 0x45321098, 0xff0fffff, 0xfffff9ff, 0x4f, 0x20190f, 0x4, 0x0
  .long 0xf1c0f0e, 0xf3e0f2e, 0xf5e0f4e, 0xf7e0f6e, 0xfae0f8e, 0xfce0fbe, 0xfee0fde, 0xf9f0ffe
  .long 0x765fadcb, 0xe4321098, 0xffffffff, 0xfffffbff, 0xef, 0x2f1b0f, 0xe, 0x0
  .long 0xf130f03, 0xf330f23, 0xf530f43, 0xf730f63, 0xf930f83, 0xfc30fb3, 0xfe30fd3, 0xfaf0ff3
  .long 0x76afedcb, 0x84321095, 0xffbfffff, 0xfffff7ff, 0x8f, 0x2b170f, 0x8, 0x0
  .long 0xf180f08, 0xf370f28, 0xf580f48, 0xf780f68, 0xf980f88, 0xfc80fa8, 0xfe80fd8, 0xfbf0ff8
  .long 0x765fedcb, 0x943210a8, 0xffdfffff, 0xfffff2ff, 0x9f, 0x2d120f, 0x9, 0x0
  .long 0xf190f09, 0xf390f29, 0xf590f46, 0xf790f69, 0xf990f89, 0xfb90fa9, 0xfe90fd9, 0xfcf0ff9
  .long 0x765feadb, 0xc4321098, 0xffbfffff, 0xfffffdff, 0xcf, 0x2b1d0f, 0xc, 0x0
  .long 0xf110f01, 0xf310f21, 0xf510f41, 0xf710f61, 0xf910f81, 0xfb10fa1, 0xfe10fc1, 0xfdf0ff1
  .long 0x765fedcb, 0xa4321098, 0xffcfffff, 0xfffff5ff, 0xa5, 0x2c0f15, 0xa, 0x0
  .long 0x2450225, 0x2c502a5, 0x4950415, 0x6550605, 0x6d50685, 0x9750935, 0x9f509b5, 0xfef0f65
  .long 0x765aedcb, 0xf4321098, 0xff5fffff, 0xfffffcff, 0xff, 0x251c0f, 0xf, 0x0
  .long 0xf140f04, 0xf340f24, 0xf540f44, 0xf700f64, 0xf940f84, 0xfb40fa4, 0xfd40fc4, 0xfff0fe4
L_order_end:
.section .rodata,"a"
.p2align 6
.amdhsa_kernel standalone__kv_cache_quant_pre_rope_vs_post_rope__sampling_kernel
  .amdhsa_next_free_vgpr 243
  .amdhsa_next_free_sgpr 102
  .amdhsa_accum_offset 244
  .amdhsa_group_segment_fixed_size 0
  .amdhsa_kernarg_size 112
  .amdhsa_user_sgpr_count 2
  .amdhsa_user_sgpr_kernarg_segment_ptr 1
  .amdhsa_system_sgpr_workgroup_id_x 1
.end_amdhsa_kernel
```

```asm
; @launch grid=(256,1,1) block=(320,1,1) lds=162304
.amdgcn_target "amdgcn-amd-amdhsa--gfx950"
.text
.globl standalone__kv_cache_quant_pre_rope_vs_post_rope__sampling_kernel
.p2align 12
.type L_pad,@object
L_pad:
.fill 832, 4, 0xbf810000
.p2align 8
.type standalone__kv_cache_quant_pre_rope_vs_post_rope__sampling_kernel,@function
standalone__kv_cache_quant_pre_rope_vs_post_rope__sampling_kernel:
  s_cmpk_ge_u32 s2, 0x100
  s_cbranch_scc1 L_end
  s_load_dwordx16 s[4:19], s[0:1], 0
  s_load_dwordx8 s[20:27], s[0:1], 64
  s_load_dwordx4 s[28:31], s[0:1], 96
  v_readfirstlane_b32 s40, v0
  s_lshr_b32 s42, s2, 4
  s_cmp_lg_u32 s40, 0
  s_cbranch_scc1 L_s0
  s_setprio 3
  s_getpc_b64 s[64:65]
L_pc0:
  s_and_b32 s44, s2, 56
  v_and_b32 v20, 63, v0
  v_lshl_add_u32 v1, v20, 6, s44
  v_lshlrev_b32 v1, 4, v1
  v_min_u32 v1, L_order_end-L_pc0-1028, v1
  s_bfm_b64 exec, 43, 0
  global_load_dword v2, v1, s[64:65] offset:1024
  s_mov_b64 exec, -1
  v_min_u32 v21, 47, v20
  v_add_u32 v22, 24, v21
  v_subrev_u32 v23, 24, v21
  v_min_u32 v27, v22, v23
  s_mul_i32 s44, s42, 48
  v_add_lshl_u32 v22, v21, s44, 3
  v_add_lshl_u32 v23, v27, s44, 3
  v_lshlrev_b32 v26, 3, v21
  s_and_b32 s44, s2, 7
  s_lshr_b32 s45, s2, 3
  s_mul_i32 s68, s44, 96
  s_add_u32 s68, s68, s45
  v_and_b32 v3, 15, v21
  v_lshl_add_u32 v3, s68, 4, v3
  v_and_b32 v4, 48, v21
  v_lshl_add_u32 v3, v4, 5, v3
  v_lshlrev_b32 v3, 6, v3
  s_mul_i32 s68, s44, 98304
  v_subrev_u32 v12, s68, v3
  s_and_b32 s68, s45, 3
  s_lshl4_add_u32 s44, s68, s44
  s_lshr_b32 s45, s45, 2
  s_lshl_b32 s45, s45, 8
  s_add_u32 s44, s44, s45
  v_and_b32 v4, 7, v20
  v_lshl_add_u32 v4, s44, 3, v4
  v_and_b32 v5, 24, v20
  v_lshl_add_u32 v4, v5, 6, v4
  v_and_b32 v5, 32, v20
  v_lshl_add_u32 v4, v5, 1, v4
  v_lshlrev_b32 v4, 6, v4
  s_waitcnt lgkmcnt(0)
  global_load_dwordx2 v[108:109], v22, s[4:5]
  global_load_dwordx2 v[110:111], v23, s[4:5]
  global_load_dwordx2 v[104:105], v26, s[18:19]
  global_load_dwordx2 v[106:107], v26, s[20:21]
  v_lshlrev_b32 v27, 3, v27
  s_add_u32 s68, s42, 16
  s_mul_i32 s44, s68, 384
  s_add_u32 s32, s4, s44
  s_addc_u32 s33, s5, 0
  global_load_dwordx2 v[68:69], v26, s[32:33]
  global_load_dwordx2 v[70:71], v27, s[32:33]
  global_load_dword v5, v3, s[22:23]
  global_load_dword v6, v3, s[24:25]
  global_load_dword v7, v4, s[8:9]
  global_load_dword v8, v4, s[10:11]
  global_load_dword v9, v4, s[14:15]
  global_load_dword v10, v4, s[16:17]
  global_load_dword v11, v12, s[4:5]
  v_mov_b32 v14, 0
  v_cmp_gt_u32 vcc, 24, v21
  v_mov_b32 v48, 0
  v_mov_b32 v49, 0
  v_mov_b32 v50, 0
  v_mov_b32 v51, 0
  ds_write_b128 v14, v[48:51] offset:0
  ds_write_b128 v14, v[48:51] offset:16
  s_waitcnt lgkmcnt(0)
  s_barrier
  s_mov_b32 s66, 0xffff0000
  s_mov_b32 s67, 0x3dd53b95
  v_cndmask_b32_e64 v30, 1.0, -1.0, vcc
  v_lshlrev_b32 v35, 4, v21
  v_mov_b32 v28, v35
  v_lshlrev_b32 v29, 1, v27
  v_mov_b32 v22, 0x80008000
  v_cndmask_b32 v31, v14, v22, vcc
  v_mov_b32 v38, 1
  s_mov_b32 s43, 1
  s_waitcnt vmcnt(9)
  v_lshlrev_b32 v52, 16, v104
  v_and_b32 v53, s66, v104
  v_lshlrev_b32 v54, 16, v105
  v_and_b32 v55, s66, v105
  v_lshlrev_b32 v56, 16, v106
  v_and_b32 v57, s66, v106
  v_lshlrev_b32 v58, 16, v107
  v_and_b32 v59, s66, v107
L_hr:
  v_lshlrev_b32 v76, 16, v108
  v_and_b32 v77, s66, v108
  v_lshlrev_b32 v78, 16, v109
  v_and_b32 v79, s66, v109
  v_lshlrev_b32 v80, 16, v110
  v_and_b32 v81, s66, v110
  v_lshlrev_b32 v82, 16, v111
  v_and_b32 v83, s66, v111
  v_mul_f32 v76, v76, v52
  v_mul_f32 v77, v77, v53
  v_mul_f32 v78, v78, v54
  v_mul_f32 v79, v79, v55
  v_mul_f32 v80, v80, v56
  v_mul_f32 v81, v81, v57
  v_mul_f32 v82, v82, v58
  v_mul_f32 v83, v83, v59
  v_cvt_pk_bf16_f32 v84, v76, v80
  v_cvt_pk_bf16_f32 v85, v77, v81
  v_cvt_pk_bf16_f32 v86, v78, v82
  v_cvt_pk_bf16_f32 v87, v79, v83
  v_lshlrev_b32 v76, 16, v84
  v_and_b32 v80, s66, v84
  v_lshlrev_b32 v77, 16, v85
  v_and_b32 v81, s66, v85
  v_lshlrev_b32 v78, 16, v86
  v_and_b32 v82, s66, v86
  v_lshlrev_b32 v79, 16, v87
  v_and_b32 v83, s66, v87
  v_fma_f32 v76, v80, v30, v76
  v_fma_f32 v77, v81, v30, v77
  v_fma_f32 v78, v82, v30, v78
  v_fma_f32 v79, v83, v30, v79
  v_cvt_pk_bf16_f32 v84, v76, v77
  v_cvt_pk_bf16_f32 v85, v78, v79
  v_xor_b32 v86, v31, v84
  v_xor_b32 v87, v31, v85
  v_mov_b32 v22, s43
  ds_write_b16 v28, v84 offset:512
  ds_write_b16_d16_hi v28, v84 offset:516
  ds_write_b16 v28, v85 offset:520
  ds_write_b16_d16_hi v28, v85 offset:524
  ds_write_b16 v29, v86 offset:514
  ds_write_b16_d16_hi v29, v86 offset:518
  ds_write_b16 v29, v87 offset:522
  ds_write_b16_d16_hi v29, v87 offset:526
  ds_write_b32 v14, v22 offset:16
  v_add_u32 v28, 1024, v28
  v_add_u32 v29, 1024, v29
  v_and_b32 v28, 0xfff, v28
  v_and_b32 v29, 0xfff, v29
  s_cmp_eq_u32 s43, 2
  s_cbranch_scc1 L_helper
  s_mov_b32 s43, 2
  s_waitcnt vmcnt(7) lgkmcnt(0)
  v_mov_b32 v108, v68
  v_mov_b32 v109, v69
  v_mov_b32 v110, v70
  v_mov_b32 v111, v71
  s_branch L_hr
L_s0:
  v_subrev_u32 v0, 64, v0
  s_sub_u32 s40, s40, 64
  s_and_b32 s44, s2, 7
  s_mul_i32 s44, s44, 6
  s_bfe_u32 s41, s2, 0x10003
  s_add_u32 s44, s44, s41
  s_lshl_b32 s44, s44, 15
  s_lshr_b32 s40, s40, 6
  s_cmp_ge_u32 s40, 2
  s_cselect_b64 s[62:63], -1, 0
  s_and_b32 s45, s62, 16384
  s_sub_u32 s68, s44, s45
  s_add_u32 s44, s44, s45
  v_lshl_add_u32 v16, v0, 4, s68
  v_lshl_add_u32 v15, v0, 4, s44
  v_lshrrev_b32 v25, 4, v0
  v_and_b32 v24, 15, v0
  v_add_u32 v212, 0, v15
  v_add_u32 v213, 8192, v15
  v_add_u32 v214, 4096, v15
  s_sub_u32 s45, s41, 0
  s_mul_i32 s45, s45, 98304
  v_cmp_eq_u32 s[64:65], v25, 0
  v_add_u32 v20, s45, v212
  s_nop 0
  v_cndmask_b32_e64 v212, v212, v20, s[64:65]
  v_lshl_add_u32 v22, s41, 1, v25
  v_subrev_u32 v22, s62, v22
  v_mul_u32_u24 v20, 11, v22
  v_lshrrev_b32 v20, 5, v20
  v_mad_i32_i24 v20, v20, -3, v22
  v_lshlrev_b32 v21, 4, v24
  v_lshl_add_u32 v246, v20, 8, v21
  v_add_u32 v20, 256, v246
  v_subrev_u32 v21, 512, v246
  v_min_u32 v247, v20, v21
  v_add_u32 v20, 512, v246
  v_subrev_u32 v21, 256, v246
  v_min_u32 v248, v20, v21
  v_cmp_gt_u32 vcc, 8, v24
  v_lshlrev_b32 v23, 3, v24
  v_lshrrev_b32 v22, 1, v246
  v_add3_u32 v20, v22, v23, 64
  v_subrev_u32 v21, 384, v20
  v_min_u32 v20, v20, v21
  v_sub_u32 v20, v20, v22
  v_cndmask_b32 v240, v20, v23, vcc
  v_lshrrev_b32 v22, 1, v247
  v_add3_u32 v20, v22, v23, 64
  v_subrev_u32 v21, 384, v20
  v_min_u32 v20, v20, v21
  v_sub_u32 v20, v20, v22
  v_cndmask_b32 v241, v20, v23, vcc
  v_lshrrev_b32 v22, 1, v248
  v_add3_u32 v20, v22, v23, 64
  v_subrev_u32 v21, 384, v20
  v_min_u32 v20, v20, v21
  v_sub_u32 v20, v20, v22
  v_cndmask_b32 v242, v20, v23, vcc
  s_mul_i32 s100, s40, 24576
  s_add_u32 s100, s100, 64000
  s_mul_i32 s44, s42, 1572864
  s_mov_b32 s34, 51904512
  s_mov_b32 s35, 0x20000
  s_mov_b32 s80, 25165824
  s_mov_b32 s3, 50331648
  s_waitcnt lgkmcnt(0)
  s_add_u32 s32, s6, s44
  s_addc_u32 s33, s7, 0
  v_mov_b32 v21, s22
  v_mov_b32 v28, s24
  v_cndmask_b32 v28, v28, v21, vcc
  v_mov_b32 v21, s23
  v_mov_b32 v29, s25
  v_cndmask_b32 v29, v29, v21, vcc
  s_add_u32 m0, s100, 0
  v_lshrrev_b32 v10, 1, v212
  v_add_u32 v10, v10, v240
  v_mad_u64_u32 v[30:31], s[64:65], v10, 1, v[28:29]
  global_load_lds_dwordx4 v[30:31], off
  buffer_load_dwordx4 v[68:71], v212, s[32:35], 0 offen nt
  buffer_load_dwordx4 v[72:75], v213, s[32:35], 0 offen nt
  s_add_u32 m0, s100, 1024
  v_lshrrev_b32 v10, 1, v213
  v_add_u32 v10, v10, v242
  v_mad_u64_u32 v[30:31], s[64:65], v10, 1, v[28:29]
  global_load_lds_dwordx4 v[30:31], off
  buffer_load_dwordx4 v[76:79], v214, s[32:35], 0 offen nt
  buffer_load_dwordx4 v[80:83], v212, s[32:35], s80 offen nt
  s_add_u32 m0, s100, 2048
  v_lshrrev_b32 v10, 1, v214
  v_add_u32 v10, v10, v241
  v_mad_u64_u32 v[30:31], s[64:65], v10, 1, v[28:29]
  global_load_lds_dwordx4 v[30:31], off
  buffer_load_dwordx4 v[84:87], v213, s[32:35], s80 offen nt
  s_barrier
  s_getpc_b64 s[82:83]
L_pc1:
  s_lshl_b32 s44, s2, 6
  s_add_u32 s44, s44, L_order-L_pc1
  s_add_u32 s82, s82, s44
  s_addc_u32 s83, s83, 0
  s_load_dwordx2 s[92:93], s[82:83], 0
  s_load_dwordx2 s[96:97], s[82:83], 8
  s_mov_b32 s94, 4000000
  v_add_u32 v215, 12288, v15
  v_add_u32 v216, 16384, v16
  v_add_u32 v217, 24576, v16
  v_add_u32 v218, 20480, v16
  v_add_u32 v219, 28672, v16
  v_add_u32 v220, 65536, v15
  v_add_u32 v221, 73728, v15
  v_add_u32 v222, 69632, v15
  v_add_u32 v223, 77824, v15
  v_add_u32 v224, 81920, v16
  v_add_u32 v225, 90112, v16
  v_add_u32 v226, 86016, v16
  v_add_u32 v227, 94208, v16
  v_add_u32 v228, 131072, v15
  v_add_u32 v229, 139264, v15
  v_add_u32 v230, 135168, v15
  v_add_u32 v231, 143360, v15
  v_add_u32 v232, 147456, v16
  v_add_u32 v233, 155648, v16
  v_add_u32 v234, 151552, v16
  v_add_u32 v235, 159744, v16
  s_sub_u32 s45, s41, 0
  s_mul_i32 s45, s45, 98304
  v_cmp_eq_u32 s[64:65], v25, 15
  v_add_u32 v20, s45, v215
  s_nop 0
  v_cndmask_b32_e64 v215, v215, v20, s[64:65]
  s_sub_u32 s45, s41, 1
  s_mul_i32 s45, s45, 98304
  v_cmp_eq_u32 s[64:65], v25, 0
  v_add_u32 v20, s45, v228
  s_nop 0
  v_cndmask_b32_e64 v228, v228, v20, s[64:65]
  s_sub_u32 s45, s41, 1
  s_mul_i32 s45, s45, 98304
  v_cmp_eq_u32 s[64:65], v25, 15
  v_add_u32 v20, s45, v231
  s_nop 0
  v_cndmask_b32_e64 v231, v231, v20, s[64:65]
  v_cndmask_b32_e64 v249, v246, v247, s[62:63]
  v_cndmask_b32_e64 v250, v247, v248, s[62:63]
  v_cndmask_b32_e64 v251, v248, v246, s[62:63]
  v_cndmask_b32_e64 v243, v240, v241, s[62:63]
  v_cndmask_b32_e64 v244, v241, v242, s[62:63]
  v_cndmask_b32_e64 v245, v242, v240, s[62:63]
  v_lshrrev_b32 v22, 6, v0
  v_bfe_u32 v23, v0, 4, 2
  v_mov_b32 v14, 0
  v_and_b32 v20, 2, v0
  v_lshl_add_u32 v21, v20, 5, v25
  v_and_b32 v20, 1, v0
  v_lshl_add_u32 v21, v20, 4, v21
  v_and_b32 v20, 4, v0
  v_lshl_add_u32 v21, v20, 3, v21
  s_and_b32 s44, s62, 64
  v_xor_b32 v21, s44, v21
  v_cmp_eq_u32 s[48:49], 0, v21
  v_cmp_eq_u32 vcc, 127, v21
  s_cmp_eq_u32 s41, 0
  s_cselect_b32 s44, 0, -1
  v_add_u32 v15, s44, v21
  s_cselect_b32 s44, 2, -2
  v_add_u32 v16, s44, v21
  s_cselect_b32 s44, 1, 0
  v_add_u32 v17, s44, v21
  s_cselect_b64 s[50:51], 0, s[48:49]
  s_cselect_b64 s[52:53], 0, vcc
  s_cselect_b64 s[48:49], s[48:49], 0
  s_cselect_b64 vcc, vcc, 0
  v_mov_b32 v20, 254
  v_cndmask_b32_e64 v15, v15, v20, s[50:51]
  v_mov_b32 v20, 255
  v_cndmask_b32_e64 v15, v15, v20, s[52:53]
  v_mov_b32 v20, -128
  v_cndmask_b32_e64 v17, v17, v20, s[48:49]
  v_mov_b32 v20, -127
  v_cndmask_b32_e64 v17, v17, v20, vcc
  v_and_b32 v20, 8, v0
  v_mul_u32_u24 v20, 48, v20
  v_add_lshl_u32 v15, v15, v20, 2
  v_add_u32 v15, 45568, v15
  v_add_lshl_u32 v16, v16, v20, 2
  v_add_u32 v16, 46080, v16
  v_add_lshl_u32 v17, v17, v20, 2
  v_add_u32 v17, 46592, v17
  v_lshl_add_u32 v21, v24, 2, v23
  v_mul_u32_u24 v20, 192, v22
  v_add_lshl_u32 v3, v20, v21, 2
  v_add_u32 v3, 64000, v3
  v_lshlrev_b32 v6, 2, v22
  v_mov_b32 v32, 0
  v_mov_b32 v34, 0
  v_mov_b32 v33, 0
  v_mov_b32 v35, 0
  s_mov_b32 s48, 0x11111111
  s_mov_b32 s49, s48
  s_mov_b32 s50, 0x22222222
  s_mov_b32 s51, s50
  s_mov_b32 s52, 0x44444444
  s_mov_b32 s53, s52
  s_mov_b32 s54, 0x88888888
  s_mov_b32 s55, s54
  s_mov_b32 s56, 0x05040100
  s_mov_b32 s57, 0x07060302
  s_mov_b32 s38, 1572864
  s_mov_b32 s39, 0x20000
  v_lshlrev_b32 v21, 8, v23
  v_add_u32 v21, s100, v21
  v_lshl_add_u32 v12, v24, 3, v21
  s_getreg_b32 s81, hwreg(HW_REG_HW_ID, 13, 2)
  s_getreg_b32 s79, hwreg(HW_REG_HW_ID, 8, 4)
  s_getreg_b32 s46, hwreg(HW_REG_XCC_ID, 0, 3)
  s_mul_i32 s46, s46, 4352
  s_add_u32 s46, s46, 8126464
  s_add_u32 s44, s46, 2048
  v_mov_b32 v11, s44
  s_and_b32 s45, s81, 2
  s_lshl_b32 s45, s45, 9
  s_lshl_b32 s44, s40, 8
  s_add_u32 s44, s44, s45
  s_add_u32 s44, s44, s46
  s_add_u32 s44, s44, s79
  s_and_b32 s81, s81, 1
  s_lshl_b32 s81, s81, 4
  s_add_u32 s44, s44, s81
  v_mov_b32 v7, s44
  s_xor_b32 s45, s45, 1024
  s_add_u32 s46, s46, s45
  v_and_b32 v8, 1, v0
  v_lshl_add_u32 v8, v8, 4, s46
  v_bfe_u32 v21, v0, 1, 2
  v_mad_u32_u24 v21, v21, 4, v22
  v_add_u32 v9, 0, v21
  v_and_b32 v9, 3, v9
  v_lshl_add_u32 v236, v9, 8, v8
  v_add_u32 v9, 1, v21
  v_and_b32 v9, 3, v9
  v_lshl_add_u32 v237, v9, 8, v8
  v_add_u32 v9, 2, v21
  v_and_b32 v9, 3, v9
  v_lshl_add_u32 v238, v9, 8, v8
  v_add_u32 v9, 3, v21
  v_and_b32 v9, 3, v9
  v_lshl_add_u32 v239, v9, 8, v8
  s_mov_b32 s78, 0xfefefeff
  v_mov_b32 v36, 0
  v_mov_b32 v37, 0
  v_mov_b32 v38, 0
  v_mov_b32 v39, 0
  v_mov_b32 v40, 0
  v_mov_b32 v41, 0
  v_mov_b32 v42, 0
  v_mov_b32 v43, 0
  v_mov_b32 v26, 0
  v_mov_b32 v27, 0
  v_mov_b32 v8, 3
  s_cmp_lt_u32 s40, 4
  s_cselect_b64 s[60:61], 1, 0
  s_getreg_b32 s58, hwreg(HW_REG_XCC_ID, 0, 1)
  s_mul_i32 s58, s58, -5
  s_add_u32 s58, s58, 3
  s_mov_b32 s91, s58
  s_mov_b32 s69, 0
  s_mov_b32 s95, 0
  buffer_load_dwordx4 v[88:91], v214, s[32:35], s80 offen nt
  s_add_u32 m0, s100, 3072
  v_lshrrev_b32 v10, 1, v215
  v_add_u32 v10, v10, v240
  v_mad_u64_u32 v[30:31], s[64:65], v10, 1, v[28:29]
  s_waitcnt vmcnt(8)
  global_load_lds_dwordx4 v[30:31], off
  s_waitcnt vmcnt(8)
  buffer_load_dwordx4 v[92:95], v215, s[32:35], 0 offen nt
  s_add_u32 m0, s100, 4096
  v_lshrrev_b32 v10, 1, v216
  v_add_u32 v10, v10, v244
  v_mad_u64_u32 v[30:31], s[64:65], v10, 1, v[28:29]
  s_waitcnt vmcnt(8)
  global_load_lds_dwordx4 v[30:31], off
  s_waitcnt vmcnt(8)
  buffer_load_dwordx4 v[96:99], v216, s[32:35], 0 offen nt
  s_mov_b32 s47, 1
  ds_read_b32 v4, v14 offset:16
L_fqz:
  s_waitcnt lgkmcnt(0)
  v_readfirstlane_b32 s46, v4
  s_cmp_ge_u32 s46, s47
  s_cbranch_scc1 L_fqz_ok
  s_cmp_eq_u32 s94, 0
  s_cbranch_scc1 L_fqz_ok
  s_sub_u32 s94, s94, 1
  ds_read_b32 v4, v14 offset:16
  s_branch L_fqz
L_fqz_ok:
  ds_read_b128 v[44:47], v246 offset:512
  ds_read_b128 v[48:51], v248 offset:512
  ds_read_b128 v[52:55], v247 offset:512
  s_add_u32 m0, s100, 5120
  v_lshrrev_b32 v10, 1, v217
  v_add_u32 v10, v10, v243
  v_mad_u64_u32 v[30:31], s[64:65], v10, 1, v[28:29]
  s_waitcnt vmcnt(8)
  global_load_lds_dwordx4 v[30:31], off
  s_waitcnt vmcnt(7)
  ds_read_b64 v[116:117], v12 offset:0
  ds_read_b64 v[118:119], v12 offset:128
  ds_read_b64 v[120:121], v12 offset:1024
  ds_read_b64 v[122:123], v12 offset:1152
  ds_read_b64 v[124:125], v12 offset:2048
  ds_read_b64 v[126:127], v12 offset:2176
  buffer_load_dwordx4 v[100:103], v217, s[32:35], 0 offen nt
L_it0:
  s_mov_b32 s47, 2
  ds_read_b32 v4, v14 offset:16
L_fq0:
  s_waitcnt lgkmcnt(0)
  v_readfirstlane_b32 s46, v4
  s_cmp_ge_u32 s46, s47
  s_cbranch_scc1 L_fq0_ok
  s_cmp_eq_u32 s94, 0
  s_cbranch_scc1 L_fq0_ok
  s_sub_u32 s94, s94, 1
  ds_read_b32 v4, v14 offset:16
  s_branch L_fq0
L_fq0_ok:
  ds_read_b128 v[56:59], v246 offset:1536
  ds_read_b128 v[60:63], v248 offset:1536
  ds_read_b128 v[64:67], v247 offset:1536
  v_perm_b32 v13, v118, v116, s56
  v_perm_b32 v118, v118, v116, s57
  v_perm_b32 v116, v119, v117, s56
  v_perm_b32 v119, v119, v117, s57
  v_dot2_f32_bf16 v22, v13, v44, 0
  v_dot2_f32_bf16 v23, v118, v45, 0
  v_dot2_f32_bf16 v24, v116, v46, 0
  v_dot2_f32_bf16 v25, v119, v47, 0
  v_cvt_f32_i32 v68, v68
  v_cvt_f32_i32 v69, v69
  v_cvt_f32_i32 v70, v70
  v_cvt_f32_i32 v71, v71
  v_pk_mul_f32 v[20:21], v[68:69], v[22:23]
  v_pk_add_f32 v[18:19], v[22:23], v[24:25]
  v_pk_fma_f32 v[20:21], v[70:71], v[24:25], v[20:21]
  v_add_f32 v18, v18, v19
  v_add_f32 v20, v20, v21
  s_add_u32 m0, s100, 6144
  v_lshrrev_b32 v10, 1, v218
  v_add_u32 v10, v10, v245
  v_mad_u64_u32 v[30:31], s[64:65], v10, 1, v[28:29]
  global_load_lds_dwordx4 v[30:31], off
  s_waitcnt vmcnt(8)
  buffer_load_dwordx4 v[104:107], v215, s[32:35], s80 offen nt
  v_perm_b32 v117, v122, v120, s56
  v_perm_b32 v122, v122, v120, s57
  v_perm_b32 v120, v123, v121, s56
  v_perm_b32 v123, v123, v121, s57
  v_dot2_f32_bf16 v22, v117, v48, 0
  v_add_f32_dpp v34, v18, v18 row_ror:8 row_mask:0xf bank_mask:0xc
  v_add_f32_dpp v34, v20, v20 row_ror:8 row_mask:0xf bank_mask:0x3
  v_dot2_f32_bf16 v23, v122, v49, 0
  v_dot2_f32_bf16 v24, v120, v50, 0
  v_dot2_f32_bf16 v25, v123, v51, 0
  v_cvt_f32_i32 v72, v72
  v_cvt_f32_i32 v73, v73
  v_cvt_f32_i32 v74, v74
  v_cvt_f32_i32 v75, v75
  v_pk_mul_f32 v[20:21], v[72:73], v[22:23]
  v_pk_add_f32 v[18:19], v[22:23], v[24:25]
  v_pk_fma_f32 v[20:21], v[74:75], v[24:25], v[20:21]
  v_add_f32 v18, v18, v19
  v_add_f32 v20, v20, v21
  s_waitcnt vmcnt(8)
  buffer_load_dwordx4 v[108:111], v216, s[32:35], s80 offen nt
  v_perm_b32 v121, v126, v124, s56
  v_perm_b32 v126, v126, v124, s57
  v_perm_b32 v124, v127, v125, s56
  v_perm_b32 v127, v127, v125, s57
  v_dot2_f32_bf16 v22, v121, v52, 0
  v_add_f32_dpp v21, v18, v18 row_ror:8 row_mask:0xf bank_mask:0xc
  v_add_f32_dpp v21, v20, v20 row_ror:8 row_mask:0xf bank_mask:0x3
  v_add_f32_dpp v20, v34, v34 row_half_mirror row_mask:0xf bank_mask:0x5
  v_dot2_f32_bf16 v23, v126, v53, 0
  v_add_f32_dpp v20, v21, v21 row_half_mirror row_mask:0xf bank_mask:0xa
  v_dot2_f32_bf16 v24, v124, v54, 0
  v_dot2_f32_bf16 v25, v127, v55, 0
  v_add_f32_dpp v20, v20, v20 quad_perm:[2,3,0,1] row_mask:0xf bank_mask:0xf
  v_cvt_f32_i32 v76, v76
  v_cvt_f32_i32 v77, v77
  v_add_f32_dpp v20, v20, v20 quad_perm:[1,0,3,2] row_mask:0xf bank_mask:0xf
  v_cndmask_b32_e64 v32, v32, v20, s[48:49]
  v_cvt_f32_i32 v78, v78
  v_cvt_f32_i32 v79, v79
  v_pk_mul_f32 v[20:21], v[76:77], v[22:23]
  v_pk_add_f32 v[18:19], v[22:23], v[24:25]
  v_pk_fma_f32 v[20:21], v[78:79], v[24:25], v[20:21]
  v_add_f32 v18, v18, v19
  v_add_f32 v20, v20, v21
  s_add_u32 m0, s100, 7168
  v_lshrrev_b32 v10, 1, v219
  v_add_u32 v10, v10, v244
  v_mad_u64_u32 v[30:31], s[64:65], v10, 1, v[28:29]
  s_waitcnt vmcnt(8)
  global_load_lds_dwordx4 v[30:31], off
  s_waitcnt vmcnt(8)
  buffer_load_dwordx4 v[112:115], v217, s[32:35], s80 offen nt
L_it1:
  s_waitcnt lgkmcnt(0)
  ds_read_b128 v[44:47], v246 offset:512
  ds_read_b128 v[48:51], v250 offset:512
  ds_read_b128 v[52:55], v249 offset:512
  v_dot2_f32_bf16 v22, v13, v56, 0
  v_add_f32_dpp v34, v18, v18 row_ror:8 row_mask:0xf bank_mask:0xc
  v_add_f32_dpp v34, v20, v20 row_ror:8 row_mask:0xf bank_mask:0x3
  v_dot2_f32_bf16 v23, v118, v57, 0
  v_dot2_f32_bf16 v24, v116, v58, 0
  v_dot2_f32_bf16 v25, v119, v59, 0
  v_cvt_f32_i32 v80, v80
  v_cvt_f32_i32 v81, v81
  v_cvt_f32_i32 v82, v82
  v_cvt_f32_i32 v83, v83
  v_pk_mul_f32 v[20:21], v[80:81], v[22:23]
  v_pk_add_f32 v[18:19], v[22:23], v[24:25]
  v_pk_fma_f32 v[20:21], v[82:83], v[24:25], v[20:21]
  v_add_f32 v18, v18, v19
  v_add_f32 v20, v20, v21
  s_waitcnt vmcnt(8)
  buffer_load_dwordx4 v[68:71], v218, s[32:35], 0 offen nt
  v_dot2_f32_bf16 v22, v117, v60, 0
  v_add_f32_dpp v35, v18, v18 row_ror:8 row_mask:0xf bank_mask:0xc
  v_add_f32_dpp v35, v20, v20 row_ror:8 row_mask:0xf bank_mask:0x3
  v_dot2_f32_bf16 v23, v122, v61, 0
  v_dot2_f32_bf16 v24, v120, v62, 0
  v_dot2_f32_bf16 v25, v123, v63, 0
  v_cvt_f32_i32 v84, v84
  v_cvt_f32_i32 v85, v85
  v_cvt_f32_i32 v86, v86
  v_cvt_f32_i32 v87, v87
  v_pk_mul_f32 v[20:21], v[84:85], v[22:23]
  v_pk_add_f32 v[18:19], v[22:23], v[24:25]
  v_pk_fma_f32 v[20:21], v[86:87], v[24:25], v[20:21]
  v_add_f32 v18, v18, v19
  v_add_f32 v20, v20, v21
  s_add_u32 m0, s100, 8192
  v_lshrrev_b32 v10, 1, v220
  v_add_u32 v10, v10, v241
  v_mad_u64_u32 v[30:31], s[64:65], v10, 1, v[28:29]
  s_waitcnt vmcnt(8)
  global_load_lds_dwordx4 v[30:31], off
  s_waitcnt vmcnt(8)
  buffer_load_dwordx4 v[72:75], v219, s[32:35], 0 offen nt
  ds_read_b64 v[128:129], v12 offset:3072
  ds_read_b64 v[130:131], v12 offset:3200
  ds_read_b64 v[132:133], v12 offset:4096
  ds_read_b64 v[134:135], v12 offset:4224
  ds_read_b64 v[136:137], v12 offset:5120
  ds_read_b64 v[138:139], v12 offset:5248
  v_dot2_f32_bf16 v22, v121, v64, 0
  v_add_f32_dpp v21, v18, v18 row_ror:8 row_mask:0xf bank_mask:0xc
  v_add_f32_dpp v21, v20, v20 row_ror:8 row_mask:0xf bank_mask:0x3
  v_add_f32_dpp v20, v35, v35 row_half_mirror row_mask:0xf bank_mask:0x5
  v_dot2_f32_bf16 v23, v126, v65, 0
  v_add_f32_dpp v20, v21, v21 row_half_mirror row_mask:0xf bank_mask:0xa
  v_dot2_f32_bf16 v24, v124, v66, 0
  v_dot2_f32_bf16 v25, v127, v67, 0
  v_add_f32_dpp v20, v20, v20 quad_perm:[2,3,0,1] row_mask:0xf bank_mask:0xf
  v_cvt_f32_i32 v88, v88
  v_cvt_f32_i32 v89, v89
  v_add_f32_dpp v20, v20, v20 quad_perm:[1,0,3,2] row_mask:0xf bank_mask:0xf
  v_cndmask_b32_e64 v33, v33, v20, s[48:49]
  v_cvt_f32_i32 v90, v90
  v_cvt_f32_i32 v91, v91
  v_pk_mul_f32 v[20:21], v[88:89], v[22:23]
  v_pk_add_f32 v[18:19], v[22:23], v[24:25]
  v_pk_fma_f32 v[20:21], v[90:91], v[24:25], v[20:21]
  v_add_f32 v18, v18, v19
  v_add_f32 v20, v20, v21
  s_waitcnt vmcnt(8)
  buffer_load_dwordx4 v[76:79], v220, s[32:35], 0 offen nt
L_it2:
  s_waitcnt lgkmcnt(0)
  ds_read_b128 v[56:59], v246 offset:1536
  ds_read_b128 v[60:63], v250 offset:1536
  ds_read_b128 v[64:67], v249 offset:1536
  ds_read_b32 v4, v14 offset:24
  v_perm_b32 v125, v130, v128, s56
  v_perm_b32 v130, v130, v128, s57
  v_perm_b32 v128, v131, v129, s56
  v_perm_b32 v131, v131, v129, s57
  v_dot2_f32_bf16 v22, v125, v44, 0
  v_add_f32_dpp v35, v18, v18 row_ror:8 row_mask:0xf bank_mask:0xc
  v_add_f32_dpp v35, v20, v20 row_ror:8 row_mask:0xf bank_mask:0x3
  v_dot2_f32_bf16 v23, v130, v45, 0
  v_dot2_f32_bf16 v24, v128, v46, 0
  v_dot2_f32_bf16 v25, v131, v47, 0
  v_cvt_f32_i32 v92, v92
  v_cvt_f32_i32 v93, v93
  v_cvt_f32_i32 v94, v94
  v_cvt_f32_i32 v95, v95
  v_pk_mul_f32 v[20:21], v[92:93], v[22:23]
  v_pk_add_f32 v[18:19], v[22:23], v[24:25]
  v_pk_fma_f32 v[20:21], v[94:95], v[24:25], v[20:21]
  v_add_f32 v18, v18, v19
  v_add_f32 v20, v20, v21
  s_add_u32 m0, s100, 9216
  v_lshrrev_b32 v10, 1, v221
  v_add_u32 v10, v10, v240
  v_mad_u64_u32 v[30:31], s[64:65], v10, 1, v[28:29]
  s_waitcnt vmcnt(8)
  global_load_lds_dwordx4 v[30:31], off
  s_waitcnt vmcnt(8)
  buffer_load_dwordx4 v[80:83], v218, s[32:35], s80 offen nt
  v_perm_b32 v129, v134, v132, s56
  v_perm_b32 v134, v134, v132, s57
  v_perm_b32 v132, v135, v133, s56
  v_perm_b32 v135, v135, v133, s57
  v_dot2_f32_bf16 v22, v129, v48, 0
  v_add_f32_dpp v21, v18, v18 row_ror:8 row_mask:0xf bank_mask:0xc
  v_add_f32_dpp v21, v20, v20 row_ror:8 row_mask:0xf bank_mask:0x3
  v_add_f32_dpp v20, v34, v34 row_half_mirror row_mask:0xf bank_mask:0x5
  v_dot2_f32_bf16 v23, v134, v49, 0
  v_add_f32_dpp v20, v21, v21 row_half_mirror row_mask:0xf bank_mask:0xa
  v_dot2_f32_bf16 v24, v132, v50, 0
  v_dot2_f32_bf16 v25, v135, v51, 0
  v_add_f32_dpp v20, v20, v20 quad_perm:[2,3,0,1] row_mask:0xf bank_mask:0xf
  v_cvt_f32_i32 v96, v96
  v_cvt_f32_i32 v97, v97
  v_add_f32_dpp v20, v20, v20 quad_perm:[1,0,3,2] row_mask:0xf bank_mask:0xf
  v_cndmask_b32_e64 v32, v32, v20, s[50:51]
  v_cvt_f32_i32 v98, v98
  v_cvt_f32_i32 v99, v99
  v_pk_mul_f32 v[20:21], v[96:97], v[22:23]
  v_pk_add_f32 v[18:19], v[22:23], v[24:25]
  v_pk_fma_f32 v[20:21], v[98:99], v[24:25], v[20:21]
  v_add_f32 v18, v18, v19
  v_add_f32 v20, v20, v21
  s_waitcnt vmcnt(8)
  buffer_load_dwordx4 v[84:87], v219, s[32:35], s80 offen nt
  v_perm_b32 v133, v138, v136, s56
  v_perm_b32 v138, v138, v136, s57
  v_perm_b32 v136, v139, v137, s56
  v_perm_b32 v139, v139, v137, s57
  v_dot2_f32_bf16 v22, v133, v52, 0
  v_add_f32_dpp v34, v18, v18 row_ror:8 row_mask:0xf bank_mask:0xc
  v_add_f32_dpp v34, v20, v20 row_ror:8 row_mask:0xf bank_mask:0x3
  v_dot2_f32_bf16 v23, v138, v53, 0
  v_dot2_f32_bf16 v24, v136, v54, 0
  v_dot2_f32_bf16 v25, v139, v55, 0
  v_cvt_f32_i32 v100, v100
  v_cvt_f32_i32 v101, v101
  v_cvt_f32_i32 v102, v102
  v_cvt_f32_i32 v103, v103
  v_pk_mul_f32 v[20:21], v[100:101], v[22:23]
  v_pk_add_f32 v[18:19], v[22:23], v[24:25]
  v_pk_fma_f32 v[20:21], v[102:103], v[24:25], v[20:21]
  v_add_f32 v18, v18, v19
  v_add_f32 v20, v20, v21
  s_add_u32 m0, s100, 10240
  v_lshrrev_b32 v10, 1, v222
  v_add_u32 v10, v10, v242
  v_mad_u64_u32 v[30:31], s[64:65], v10, 1, v[28:29]
  s_waitcnt vmcnt(8)
  global_load_lds_dwordx4 v[30:31], off
  s_waitcnt vmcnt(8)
  buffer_load_dwordx4 v[88:91], v220, s[32:35], s80 offen nt
L_it3:
  s_mov_b32 s47, 1
L_fc:
  s_waitcnt lgkmcnt(0)
  v_readfirstlane_b32 s46, v4
  s_cmp_ge_u32 s46, s47
  s_cbranch_scc1 L_fc_ok
  s_cmp_eq_u32 s94, 0
  s_cbranch_scc1 L_fc_ok
  s_sub_u32 s94, s94, 1
  ds_read_b32 v4, v14 offset:24
  s_branch L_fc
L_fc_ok:
  ds_read_b128 v[44:47], v251 offset:512
  ds_read_b128 v[48:51], v250 offset:512
  ds_read_b128 v[52:55], v247 offset:512
  s_add_u32 s44, s78, 0x03030303
  v_msad_u8 v9, s78, v40, 0
  v_msad_u8 v10, s44, v40, 0
  v_msad_u8 v9, s78, v41, v9
  v_msad_u8 v10, s44, v41, v10
  v_msad_u8 v9, s78, v42, v9
  v_msad_u8 v10, s44, v42, v10
  s_mov_b64 exec, 3
  global_store_byte v7, v8, s[30:31]
  global_load_dwordx3 v[40:42], v239, s[30:31] sc1
  v_sub_u32 v9, v9, v10
  v_add_u32 v8, 1, v8
  s_mov_b64 exec, -1
  v_readlane_b32 s66, v9, 0
  v_readlane_b32 s67, v9, 1
  s_add_u32 s78, s78, 0x01010101
  s_lshl1_add_u32 s69, s91, s95
  s_add_u32 s95, s66, s67
  s_mov_b32 s69, 0
  v_dot2_f32_bf16 v22, v125, v56, 0
  v_add_f32_dpp v21, v18, v18 row_ror:8 row_mask:0xf bank_mask:0xc
  v_add_f32_dpp v21, v20, v20 row_ror:8 row_mask:0xf bank_mask:0x3
  v_add_f32_dpp v20, v34, v34 row_half_mirror row_mask:0xf bank_mask:0x5
  v_dot2_f32_bf16 v23, v130, v57, 0
  v_add_f32_dpp v20, v21, v21 row_half_mirror row_mask:0xf bank_mask:0xa
  v_dot2_f32_bf16 v24, v128, v58, 0
  v_dot2_f32_bf16 v25, v131, v59, 0
  v_add_f32_dpp v20, v20, v20 quad_perm:[2,3,0,1] row_mask:0xf bank_mask:0xf
  v_cvt_f32_i32 v104, v104
  v_cvt_f32_i32 v105, v105
  v_add_f32_dpp v20, v20, v20 quad_perm:[1,0,3,2] row_mask:0xf bank_mask:0xf
  v_cndmask_b32_e64 v32, v32, v20, s[52:53]
  v_cvt_f32_i32 v106, v106
  v_cvt_f32_i32 v107, v107
  v_pk_mul_f32 v[20:21], v[104:105], v[22:23]
  v_pk_add_f32 v[18:19], v[22:23], v[24:25]
  v_pk_fma_f32 v[20:21], v[106:107], v[24:25], v[20:21]
  v_add_f32 v18, v18, v19
  v_add_f32 v20, v20, v21
  s_cmpk_gt_i32 s69, 0x31
  s_cbranch_scc1 L_p2_4
  s_cmpk_gt_i32 s69, 0xffed
  s_cbranch_scc1 L_p2_1
  s_waitcnt vmcnt(6)
L_p2_1:
  s_waitcnt vmcnt(8)
L_p2_4:
  s_waitcnt vmcnt(9)
  buffer_load_dwordx4 v[92:95], v221, s[32:35], 0 offen nt
  v_dot2_f32_bf16 v22, v129, v60, 0
  v_add_f32_dpp v21, v18, v18 row_ror:8 row_mask:0xf bank_mask:0xc
  v_add_f32_dpp v21, v20, v20 row_ror:8 row_mask:0xf bank_mask:0x3
  v_add_f32_dpp v20, v35, v35 row_half_mirror row_mask:0xf bank_mask:0x5
  v_dot2_f32_bf16 v23, v134, v61, 0
  v_add_f32_dpp v20, v21, v21 row_half_mirror row_mask:0xf bank_mask:0xa
  v_dot2_f32_bf16 v24, v132, v62, 0
  v_dot2_f32_bf16 v25, v135, v63, 0
  v_add_f32_dpp v20, v20, v20 quad_perm:[2,3,0,1] row_mask:0xf bank_mask:0xf
  v_cvt_f32_i32 v108, v108
  v_cvt_f32_i32 v109, v109
  v_add_f32_dpp v20, v20, v20 quad_perm:[1,0,3,2] row_mask:0xf bank_mask:0xf
  v_cndmask_b32_e64 v33, v33, v20, s[50:51]
  v_cvt_f32_i32 v110, v110
  v_cvt_f32_i32 v111, v111
  v_pk_mul_f32 v[20:21], v[108:109], v[22:23]
  v_pk_add_f32 v[18:19], v[22:23], v[24:25]
  v_pk_fma_f32 v[20:21], v[110:111], v[24:25], v[20:21]
  v_add_f32 v18, v18, v19
  v_add_f32 v20, v20, v21
  s_add_u32 m0, s100, 11264
  v_lshrrev_b32 v10, 1, v223
  v_add_u32 v10, v10, v241
  v_mad_u64_u32 v[30:31], s[64:65], v10, 1, v[28:29]
  global_load_lds_dwordx4 v[30:31], off
  s_cmpk_gt_i32 s69, 0x31
  s_cbranch_scc1 L_p3_4
  s_cmpk_gt_i32 s69, 0xb
  s_cbranch_scc1 L_p3_2
  s_waitcnt vmcnt(8)
L_p3_2:
  s_waitcnt vmcnt(10)
L_p3_4:
  s_waitcnt vmcnt(11)
  buffer_load_dwordx4 v[96:99], v222, s[32:35], 0 offen nt
  s_waitcnt vmcnt(11)
  ds_read_b64 v[140:141], v12 offset:6144
  ds_read_b64 v[142:143], v12 offset:6272
  ds_read_b64 v[144:145], v12 offset:7168
  ds_read_b64 v[146:147], v12 offset:7296
  ds_read_b64 v[148:149], v12 offset:8192
  ds_read_b64 v[150:151], v12 offset:8320
  v_dot2_f32_bf16 v22, v133, v64, 0
  v_add_f32_dpp v35, v18, v18 row_ror:8 row_mask:0xf bank_mask:0xc
  v_add_f32_dpp v35, v20, v20 row_ror:8 row_mask:0xf bank_mask:0x3
  v_dot2_f32_bf16 v23, v138, v65, 0
  v_dot2_f32_bf16 v24, v136, v66, 0
  v_dot2_f32_bf16 v25, v139, v67, 0
  v_cvt_f32_i32 v112, v112
  v_cvt_f32_i32 v113, v113
  v_cvt_f32_i32 v114, v114
  v_cvt_f32_i32 v115, v115
  v_pk_mul_f32 v[20:21], v[112:113], v[22:23]
  v_pk_add_f32 v[18:19], v[22:23], v[24:25]
  v_pk_fma_f32 v[20:21], v[114:115], v[24:25], v[20:21]
  v_add_f32 v18, v18, v19
  v_add_f32 v20, v20, v21
  s_cmpk_gt_i32 s69, 0x31
  s_cbranch_scc1 L_p4_4
  s_cmpk_gt_i32 s69, 0x1d
  s_cbranch_scc1 L_p4_3
  s_cmpk_gt_i32 s69, 0xffcd
  s_cbranch_scc1 L_p4_0
  s_waitcnt vmcnt(8)
L_p4_0:
  s_waitcnt vmcnt(9)
L_p4_3:
  s_waitcnt vmcnt(11)
L_p4_4:
  s_waitcnt vmcnt(12)
  buffer_load_dwordx4 v[100:103], v223, s[32:35], 0 offen nt
L_it4:
  s_waitcnt lgkmcnt(0)
  ds_read_b128 v[56:59], v251 offset:1536
  ds_read_b128 v[60:63], v250 offset:1536
  ds_read_b128 v[64:67], v247 offset:1536
  s_add_u32 s44, s78, 0x03030303
  v_msad_u8 v9, s78, v36, 0
  v_msad_u8 v10, s44, v36, 0
  v_msad_u8 v9, s78, v37, v9
  v_msad_u8 v10, s44, v37, v10
  v_msad_u8 v9, s78, v38, v9
  v_msad_u8 v10, s44, v38, v10
  s_mov_b64 exec, 3
  global_store_byte v7, v8, s[30:31]
  global_load_dwordx3 v[36:38], v236, s[30:31] sc1
  v_sub_u32 v9, v9, v10
  v_add_u32 v8, 1, v8
  s_mov_b64 exec, -1
  v_readlane_b32 s66, v9, 0
  v_readlane_b32 s67, v9, 1
  s_add_u32 s78, s78, 0x01010101
  s_lshl1_add_u32 s69, s91, s95
  s_add_u32 s95, s66, s67
  s_mov_b32 s69, 0
  v_perm_b32 v137, v142, v140, s56
  v_perm_b32 v142, v142, v140, s57
  v_perm_b32 v140, v143, v141, s56
  v_perm_b32 v143, v143, v141, s57
  v_dot2_f32_bf16 v22, v137, v44, 0
  v_add_f32_dpp v21, v18, v18 row_ror:8 row_mask:0xf bank_mask:0xc
  v_add_f32_dpp v21, v20, v20 row_ror:8 row_mask:0xf bank_mask:0x3
  v_add_f32_dpp v20, v35, v35 row_half_mirror row_mask:0xf bank_mask:0x5
  v_dot2_f32_bf16 v23, v142, v45, 0
  v_add_f32_dpp v20, v21, v21 row_half_mirror row_mask:0xf bank_mask:0xa
  v_dot2_f32_bf16 v24, v140, v46, 0
  v_dot2_f32_bf16 v25, v143, v47, 0
  v_add_f32_dpp v20, v20, v20 quad_perm:[2,3,0,1] row_mask:0xf bank_mask:0xf
  v_cvt_f32_i32 v68, v68
  v_cvt_f32_i32 v69, v69
  v_add_f32_dpp v20, v20, v20 quad_perm:[1,0,3,2] row_mask:0xf bank_mask:0xf
  v_cndmask_b32_e64 v33, v33, v20, s[52:53]
  v_cvt_f32_i32 v70, v70
  v_cvt_f32_i32 v71, v71
  v_pk_mul_f32 v[20:21], v[68:69], v[22:23]
  v_pk_add_f32 v[18:19], v[22:23], v[24:25]
  v_pk_fma_f32 v[20:21], v[70:71], v[24:25], v[20:21]
  v_add_f32 v18, v18, v19
  v_add_f32 v20, v20, v21
  s_add_u32 m0, s100, 12288
  v_lshrrev_b32 v10, 1, v224
  v_add_u32 v10, v10, v245
  v_mad_u64_u32 v[30:31], s[64:65], v10, 1, v[28:29]
  global_load_lds_dwordx4 v[30:31], off
  s_cmpk_gt_i32 s69, 0x31
  s_cbranch_scc1 L_p5_4
  s_cmpk_gt_i32 s69, 0xffed
  s_cbranch_scc1 L_p5_1
  s_waitcnt vmcnt(7)
L_p5_1:
  s_waitcnt vmcnt(10)
L_p5_4:
  s_waitcnt vmcnt(12)
  buffer_load_dwordx4 v[104:107], v221, s[32:35], s80 offen nt
  v_perm_b32 v141, v146, v144, s56
  v_perm_b32 v146, v146, v144, s57
  v_perm_b32 v144, v147, v145, s56
  v_perm_b32 v147, v147, v145, s57
  v_dot2_f32_bf16 v22, v141, v48, 0
  v_add_f32_dpp v34, v18, v18 row_ror:8 row_mask:0xf bank_mask:0xc
  v_add_f32_dpp v34, v20, v20 row_ror:8 row_mask:0xf bank_mask:0x3
  v_dot2_f32_bf16 v23, v146, v49, 0
  v_dot2_f32_bf16 v24, v144, v50, 0
  v_dot2_f32_bf16 v25, v147, v51, 0
  v_cvt_f32_i32 v72, v72
  v_cvt_f32_i32 v73, v73
  v_cvt_f32_i32 v74, v74
  v_cvt_f32_i32 v75, v75
  v_pk_mul_f32 v[20:21], v[72:73], v[22:23]
  v_pk_add_f32 v[18:19], v[22:23], v[24:25]
  v_pk_fma_f32 v[20:21], v[74:75], v[24:25], v[20:21]
  v_add_f32 v18, v18, v19
  v_add_f32 v20, v20, v21
  s_cmpk_gt_i32 s69, 0x31
  s_cbranch_scc1 L_p6_4
  s_cmpk_gt_i32 s69, 0xb
  s_cbranch_scc1 L_p6_2
  s_waitcnt vmcnt(8)
L_p6_2:
  s_waitcnt vmcnt(11)
L_p6_4:
  s_waitcnt vmcnt(13)
  buffer_load_dwordx4 v[108:111], v222, s[32:35], s80 offen nt
  v_perm_b32 v145, v150, v148, s56
  v_perm_b32 v150, v150, v148, s57
  v_perm_b32 v148, v151, v149, s56
  v_perm_b32 v151, v151, v149, s57
  v_dot2_f32_bf16 v22, v145, v52, 0
  v_add_f32_dpp v21, v18, v18 row_ror:8 row_mask:0xf bank_mask:0xc
  v_add_f32_dpp v21, v20, v20 row_ror:8 row_mask:0xf bank_mask:0x3
  v_add_f32_dpp v20, v34, v34 row_half_mirror row_mask:0xf bank_mask:0x5
  v_dot2_f32_bf16 v23, v150, v53, 0
  v_add_f32_dpp v20, v21, v21 row_half_mirror row_mask:0xf bank_mask:0xa
  v_dot2_f32_bf16 v24, v148, v54, 0
  v_dot2_f32_bf16 v25, v151, v55, 0
  v_add_f32_dpp v20, v20, v20 quad_perm:[2,3,0,1] row_mask:0xf bank_mask:0xf
  v_cvt_f32_i32 v76, v76
  v_cvt_f32_i32 v77, v77
  v_add_f32_dpp v20, v20, v20 quad_perm:[1,0,3,2] row_mask:0xf bank_mask:0xf
  v_cndmask_b32_e64 v32, v32, v20, s[54:55]
  ds_write_b32 v15, v32 offset:0
  v_cvt_f32_i32 v78, v78
  v_cvt_f32_i32 v79, v79
  v_pk_mul_f32 v[20:21], v[76:77], v[22:23]
  v_pk_add_f32 v[18:19], v[22:23], v[24:25]
  v_pk_fma_f32 v[20:21], v[78:79], v[24:25], v[20:21]
  v_add_f32 v18, v18, v19
  v_add_f32 v20, v20, v21
  s_add_u32 m0, s100, 13312
  v_lshrrev_b32 v10, 1, v225
  v_add_u32 v10, v10, v244
  v_mad_u64_u32 v[30:31], s[64:65], v10, 1, v[28:29]
  global_load_lds_dwordx4 v[30:31], off
  s_cmpk_gt_i32 s69, 0x31
  s_cbranch_scc1 L_p7_4
  s_cmpk_gt_i32 s69, 0x1d
  s_cbranch_scc1 L_p7_3
  s_cmpk_gt_i32 s69, 0xffcd
  s_cbranch_scc1 L_p7_0
  s_waitcnt vmcnt(8)
L_p7_0:
  s_waitcnt vmcnt(10)
L_p7_3:
  s_waitcnt vmcnt(13)
L_p7_4:
  s_waitcnt vmcnt(15)
  buffer_load_dwordx4 v[112:115], v223, s[32:35], s80 offen nt
L_it5:
  s_waitcnt lgkmcnt(0)
  ds_read_b128 v[44:47], v246 offset:512
  ds_read_b128 v[48:51], v248 offset:512
  ds_read_b128 v[52:55], v247 offset:512
  s_waitcnt vmcnt(10)
  s_add_u32 s44, s78, 0x03030303
  v_msad_u8 v9, s78, v40, 0
  v_msad_u8 v10, s44, v40, 0
  v_msad_u8 v9, s78, v41, v9
  v_msad_u8 v10, s44, v41, v10
  v_msad_u8 v9, s78, v42, v9
  v_msad_u8 v10, s44, v42, v10
  s_mov_b64 exec, 3
  global_load_dwordx2 v[26:27], v11, s[30:31] sc1
  global_store_byte v7, v8, s[30:31]
  global_load_dwordx3 v[40:42], v237, s[30:31] sc1
  v_sub_u32 v9, v9, v10
  v_add_u32 v8, 1, v8
  s_mov_b64 exec, -1
  v_readlane_b32 s66, v9, 0
  v_readlane_b32 s67, v9, 1
  s_add_u32 s78, s78, 0x01010101
  s_lshl1_add_u32 s69, s91, s95
  s_add_u32 s95, s66, s67
  s_add_u32 s69, s69, s95
  v_dot2_f32_bf16 v22, v137, v56, 0
  v_add_f32_dpp v34, v18, v18 row_ror:8 row_mask:0xf bank_mask:0xc
  v_add_f32_dpp v34, v20, v20 row_ror:8 row_mask:0xf bank_mask:0x3
  v_dot2_f32_bf16 v23, v142, v57, 0
  v_dot2_f32_bf16 v24, v140, v58, 0
  v_dot2_f32_bf16 v25, v143, v59, 0
  v_cvt_f32_i32 v80, v80
  v_cvt_f32_i32 v81, v81
  v_cvt_f32_i32 v82, v82
  v_cvt_f32_i32 v83, v83
  v_pk_mul_f32 v[20:21], v[80:81], v[22:23]
  v_pk_add_f32 v[18:19], v[22:23], v[24:25]
  v_pk_fma_f32 v[20:21], v[82:83], v[24:25], v[20:21]
  v_add_f32 v18, v18, v19
  v_add_f32 v20, v20, v21
  s_cmpk_gt_i32 s69, 0x31
  s_cbranch_scc1 L_p8_4
  s_cmpk_gt_i32 s69, 0xffed
  s_cbranch_scc1 L_p8_1
  s_waitcnt vmcnt(7)
L_p8_1:
  s_waitcnt vmcnt(11)
L_p8_4:
  s_waitcnt vmcnt(12)
  buffer_load_dwordx4 v[68:71], v224, s[32:35], 0 offen nt
  v_dot2_f32_bf16 v22, v141, v60, 0
  v_add_f32_dpp v35, v18, v18 row_ror:8 row_mask:0xf bank_mask:0xc
  v_add_f32_dpp v35, v20, v20 row_ror:8 row_mask:0xf bank_mask:0x3
  v_dot2_f32_bf16 v23, v146, v61, 0
  v_dot2_f32_bf16 v24, v144, v62, 0
  v_dot2_f32_bf16 v25, v147, v63, 0
  v_cvt_f32_i32 v84, v84
  v_cvt_f32_i32 v85, v85
  v_cvt_f32_i32 v86, v86
  v_cvt_f32_i32 v87, v87
  v_pk_mul_f32 v[20:21], v[84:85], v[22:23]
  v_pk_add_f32 v[18:19], v[22:23], v[24:25]
  v_pk_fma_f32 v[20:21], v[86:87], v[24:25], v[20:21]
  v_add_f32 v18, v18, v19
  v_add_f32 v20, v20, v21
  s_add_u32 m0, s100, 14336
  v_lshrrev_b32 v10, 1, v226
  v_add_u32 v10, v10, v243
  v_mad_u64_u32 v[30:31], s[64:65], v10, 1, v[28:29]
  global_load_lds_dwordx4 v[30:31], off
  s_cmpk_gt_i32 s69, 0x31
  s_cbranch_scc1 L_p9_4
  s_cmpk_gt_i32 s69, 0xb
  s_cbranch_scc1 L_p9_2
  s_waitcnt vmcnt(9)
L_p9_2:
  s_waitcnt vmcnt(13)
L_p9_4:
  s_waitcnt vmcnt(14)
  buffer_load_dwordx4 v[72:75], v225, s[32:35], 0 offen nt
  s_waitcnt vmcnt(13)
  ds_read_b64 v[152:153], v12 offset:9216
  ds_read_b64 v[154:155], v12 offset:9344
  ds_read_b64 v[156:157], v12 offset:10240
  ds_read_b64 v[158:159], v12 offset:10368
  ds_read_b64 v[160:161], v12 offset:11264
  ds_read_b64 v[162:163], v12 offset:11392
  v_dot2_f32_bf16 v22, v145, v64, 0
  v_add_f32_dpp v21, v18, v18 row_ror:8 row_mask:0xf bank_mask:0xc
  v_add_f32_dpp v21, v20, v20 row_ror:8 row_mask:0xf bank_mask:0x3
  v_add_f32_dpp v20, v35, v35 row_half_mirror row_mask:0xf bank_mask:0x5
  v_dot2_f32_bf16 v23, v150, v65, 0
  v_add_f32_dpp v20, v21, v21 row_half_mirror row_mask:0xf bank_mask:0xa
  v_dot2_f32_bf16 v24, v148, v66, 0
  v_dot2_f32_bf16 v25, v151, v67, 0
  v_add_f32_dpp v20, v20, v20 quad_perm:[2,3,0,1] row_mask:0xf bank_mask:0xf
  v_cvt_f32_i32 v88, v88
  v_cvt_f32_i32 v89, v89
  v_add_f32_dpp v20, v20, v20 quad_perm:[1,0,3,2] row_mask:0xf bank_mask:0xf
  v_cndmask_b32_e64 v33, v33, v20, s[54:55]
  ds_write_b32 v15, v33 offset:3072
  v_cvt_f32_i32 v90, v90
  v_cvt_f32_i32 v91, v91
  v_pk_mul_f32 v[20:21], v[88:89], v[22:23]
  v_pk_add_f32 v[18:19], v[22:23], v[24:25]
  v_pk_fma_f32 v[20:21], v[90:91], v[24:25], v[20:21]
  v_add_f32 v18, v18, v19
  v_add_f32 v20, v20, v21
  s_cmpk_gt_i32 s69, 0x31
  s_cbranch_scc1 L_p10_4
  s_cmpk_gt_i32 s69, 0x1d
  s_cbranch_scc1 L_p10_3
  s_cmpk_gt_i32 s69, 0xffcd
  s_cbranch_scc1 L_p10_0
  s_waitcnt vmcnt(9)
L_p10_0:
  s_waitcnt vmcnt(10)
L_p10_3:
  s_waitcnt vmcnt(14)
L_p10_4:
  s_waitcnt vmcnt(15)
  buffer_load_dwordx4 v[76:79], v226, s[32:35], 0 offen nt
L_it6:
  s_waitcnt lgkmcnt(0)
  ds_read_b128 v[56:59], v246 offset:1536
  ds_read_b128 v[60:63], v248 offset:1536
  ds_read_b128 v[64:67], v247 offset:1536
  s_waitcnt vmcnt(11)
  s_add_u32 s44, s78, 0x03030303
  v_msad_u8 v9, s78, v36, 0
  v_msad_u8 v10, s44, v36, 0
  v_msad_u8 v9, s78, v37, v9
  v_msad_u8 v10, s44, v37, v10
  v_msad_u8 v9, s78, v38, v9
  v_msad_u8 v10, s44, v38, v10
  s_mov_b64 exec, 3
  global_store_byte v7, v8, s[30:31]
  global_load_dwordx3 v[36:38], v238, s[30:31] sc1
  v_sub_u32 v9, v9, v10
  v_add_u32 v8, 1, v8
  s_mov_b64 exec, -1
  v_readlane_b32 s66, v9, 0
  v_readlane_b32 s67, v9, 1
  s_add_u32 s78, s78, 0x01010101
  s_lshl1_add_u32 s69, s91, s95
  s_add_u32 s95, s66, s67
  s_add_u32 s69, s69, s95
  v_perm_b32 v149, v154, v152, s56
  v_perm_b32 v154, v154, v152, s57
  v_perm_b32 v152, v155, v153, s56
  v_perm_b32 v155, v155, v153, s57
  v_dot2_f32_bf16 v22, v149, v44, 0
  v_add_f32_dpp v35, v18, v18 row_ror:8 row_mask:0xf bank_mask:0xc
  v_add_f32_dpp v35, v20, v20 row_ror:8 row_mask:0xf bank_mask:0x3
  v_dot2_f32_bf16 v23, v154, v45, 0
  v_dot2_f32_bf16 v24, v152, v46, 0
  v_dot2_f32_bf16 v25, v155, v47, 0
  v_cvt_f32_i32 v92, v92
  v_cvt_f32_i32 v93, v93
  v_cvt_f32_i32 v94, v94
  v_cvt_f32_i32 v95, v95
  v_pk_mul_f32 v[20:21], v[92:93], v[22:23]
  v_pk_add_f32 v[18:19], v[22:23], v[24:25]
  v_pk_fma_f32 v[20:21], v[94:95], v[24:25], v[20:21]
  v_add_f32 v18, v18, v19
  v_add_f32 v20, v20, v21
  s_add_u32 m0, s100, 15360
  v_lshrrev_b32 v10, 1, v227
  v_add_u32 v10, v10, v245
  v_mad_u64_u32 v[30:31], s[64:65], v10, 1, v[28:29]
  global_load_lds_dwordx4 v[30:31], off
  s_cmpk_gt_i32 s69, 0x31
  s_cbranch_scc1 L_p11_4
  s_cmpk_gt_i32 s69, 0xffed
  s_cbranch_scc1 L_p11_1
  s_waitcnt vmcnt(7)
L_p11_1:
  s_waitcnt vmcnt(11)
L_p11_4:
  s_waitcnt vmcnt(13)
  buffer_load_dwordx4 v[80:83], v224, s[32:35], s80 offen nt
  v_perm_b32 v153, v158, v156, s56
  v_perm_b32 v158, v158, v156, s57
  v_perm_b32 v156, v159, v157, s56
  v_perm_b32 v159, v159, v157, s57
  v_dot2_f32_bf16 v22, v153, v48, 0
  v_add_f32_dpp v21, v18, v18 row_ror:8 row_mask:0xf bank_mask:0xc
  v_add_f32_dpp v21, v20, v20 row_ror:8 row_mask:0xf bank_mask:0x3
  v_add_f32_dpp v20, v34, v34 row_half_mirror row_mask:0xf bank_mask:0x5
  v_dot2_f32_bf16 v23, v158, v49, 0
  v_add_f32_dpp v20, v21, v21 row_half_mirror row_mask:0xf bank_mask:0xa
  v_dot2_f32_bf16 v24, v156, v50, 0
  v_dot2_f32_bf16 v25, v159, v51, 0
  v_add_f32_dpp v20, v20, v20 quad_perm:[2,3,0,1] row_mask:0xf bank_mask:0xf
  v_cvt_f32_i32 v96, v96
  v_cvt_f32_i32 v97, v97
  v_add_f32_dpp v20, v20, v20 quad_perm:[1,0,3,2] row_mask:0xf bank_mask:0xf
  v_cndmask_b32_e64 v32, v32, v20, s[48:49]
  v_cvt_f32_i32 v98, v98
  v_cvt_f32_i32 v99, v99
  v_pk_mul_f32 v[20:21], v[96:97], v[22:23]
  v_pk_add_f32 v[18:19], v[22:23], v[24:25]
  v_pk_fma_f32 v[20:21], v[98:99], v[24:25], v[20:21]
  v_add_f32 v18, v18, v19
  v_add_f32 v20, v20, v21
  s_cmpk_gt_i32 s69, 0x31
  s_cbranch_scc1 L_p12_4
  s_cmpk_gt_i32 s69, 0xb
  s_cbranch_scc1 L_p12_2
  s_waitcnt vmcnt(8)
L_p12_2:
  s_waitcnt vmcnt(12)
L_p12_4:
  s_waitcnt vmcnt(14)
  buffer_load_dwordx4 v[84:87], v225, s[32:35], s80 offen nt
  v_perm_b32 v157, v162, v160, s56
  v_perm_b32 v162, v162, v160, s57
  v_perm_b32 v160, v163, v161, s56
  v_perm_b32 v163, v163, v161, s57
  v_dot2_f32_bf16 v22, v157, v52, 0
  v_add_f32_dpp v34, v18, v18 row_ror:8 row_mask:0xf bank_mask:0xc
  v_add_f32_dpp v34, v20, v20 row_ror:8 row_mask:0xf bank_mask:0x3
  v_dot2_f32_bf16 v23, v162, v53, 0
  v_dot2_f32_bf16 v24, v160, v54, 0
  v_dot2_f32_bf16 v25, v163, v55, 0
  v_cvt_f32_i32 v100, v100
  v_cvt_f32_i32 v101, v101
  v_cvt_f32_i32 v102, v102
  v_cvt_f32_i32 v103, v103
  v_pk_mul_f32 v[20:21], v[100:101], v[22:23]
  v_pk_add_f32 v[18:19], v[22:23], v[24:25]
  v_pk_fma_f32 v[20:21], v[102:103], v[24:25], v[20:21]
  v_add_f32 v18, v18, v19
  v_add_f32 v20, v20, v21
  s_add_u32 m0, s100, 16384
  v_lshrrev_b32 v10, 1, v228
  v_add_u32 v10, v10, v242
  v_mad_u64_u32 v[30:31], s[64:65], v10, 1, v[28:29]
  global_load_lds_dwordx4 v[30:31], off
  s_cmpk_gt_i32 s69, 0x31
  s_cbranch_scc1 L_p13_4
  s_cmpk_gt_i32 s69, 0x1d
  s_cbranch_scc1 L_p13_3
  s_cmpk_gt_i32 s69, 0xffcd
  s_cbranch_scc1 L_p13_0
  s_waitcnt vmcnt(8)
L_p13_0:
  s_waitcnt vmcnt(10)
L_p13_3:
  s_waitcnt vmcnt(14)
L_p13_4:
  s_waitcnt vmcnt(16)
  buffer_load_dwordx4 v[88:91], v226, s[32:35], s80 offen nt
L_it7:
  s_waitcnt lgkmcnt(0)
  ds_read_b128 v[44:47], v251 offset:512
  ds_read_b128 v[48:51], v250 offset:512
  ds_read_b128 v[52:55], v249 offset:512
  s_waitcnt vmcnt(10)
  s_add_u32 s44, s78, 0x03030303
  v_msad_u8 v9, s78, v40, 0
  v_msad_u8 v10, s44, v40, 0
  v_msad_u8 v9, s78, v41, v9
  v_msad_u8 v10, s44, v41, v10
  v_msad_u8 v9, s78, v42, v9
  v_msad_u8 v10, s44, v42, v10
  s_mov_b64 exec, 3
  global_store_byte v7, v8, s[30:31]
  global_load_dwordx3 v[40:42], v239, s[30:31] sc1
  v_sub_u32 v9, v9, v10
  v_add3_u32 v10, v26, v27, s58
  v_add_u32 v8, 1, v8
  s_mov_b64 exec, -1
  v_readlane_b32 s66, v9, 0
  v_readlane_b32 s67, v9, 1
  v_readlane_b32 s91, v10, 0
  s_add_u32 s78, s78, 0x01010101
  s_lshl1_add_u32 s69, s91, s95
  s_add_u32 s95, s66, s67
  s_add_u32 s69, s69, s95
  v_dot2_f32_bf16 v22, v149, v56, 0
  v_add_f32_dpp v21, v18, v18 row_ror:8 row_mask:0xf bank_mask:0xc
  v_add_f32_dpp v21, v20, v20 row_ror:8 row_mask:0xf bank_mask:0x3
  v_add_f32_dpp v20, v34, v34 row_half_mirror row_mask:0xf bank_mask:0x5
  v_dot2_f32_bf16 v23, v154, v57, 0
  v_add_f32_dpp v20, v21, v21 row_half_mirror row_mask:0xf bank_mask:0xa
  v_dot2_f32_bf16 v24, v152, v58, 0
  v_dot2_f32_bf16 v25, v155, v59, 0
  v_add_f32_dpp v20, v20, v20 quad_perm:[2,3,0,1] row_mask:0xf bank_mask:0xf
  v_cvt_f32_i32 v104, v104
  v_cvt_f32_i32 v105, v105
  v_add_f32_dpp v20, v20, v20 quad_perm:[1,0,3,2] row_mask:0xf bank_mask:0xf
  v_cndmask_b32_e64 v32, v32, v20, s[50:51]
  v_cvt_f32_i32 v106, v106
  v_cvt_f32_i32 v107, v107
  v_pk_mul_f32 v[20:21], v[104:105], v[22:23]
  v_pk_add_f32 v[18:19], v[22:23], v[24:25]
  v_pk_fma_f32 v[20:21], v[106:107], v[24:25], v[20:21]
  v_add_f32 v18, v18, v19
  v_add_f32 v20, v20, v21
  s_cmpk_gt_i32 s69, 0x31
  s_cbranch_scc1 L_p14_4
  s_cmpk_gt_i32 s69, 0xffed
  s_cbranch_scc1 L_p14_1
  s_waitcnt vmcnt(6)
L_p14_1:
  s_waitcnt vmcnt(10)
L_p14_4:
  s_waitcnt vmcnt(11)
  buffer_load_dwordx4 v[92:95], v227, s[32:35], 0 offen nt
  v_dot2_f32_bf16 v22, v153, v60, 0
  v_add_f32_dpp v21, v18, v18 row_ror:8 row_mask:0xf bank_mask:0xc
  v_add_f32_dpp v21, v20, v20 row_ror:8 row_mask:0xf bank_mask:0x3
  v_add_f32_dpp v20, v35, v35 row_half_mirror row_mask:0xf bank_mask:0x5
  v_dot2_f32_bf16 v23, v158, v61, 0
  v_add_f32_dpp v20, v21, v21 row_half_mirror row_mask:0xf bank_mask:0xa
  v_dot2_f32_bf16 v24, v156, v62, 0
  v_dot2_f32_bf16 v25, v159, v63, 0
  v_add_f32_dpp v20, v20, v20 quad_perm:[2,3,0,1] row_mask:0xf bank_mask:0xf
  v_cvt_f32_i32 v108, v108
  v_cvt_f32_i32 v109, v109
  v_add_f32_dpp v20, v20, v20 quad_perm:[1,0,3,2] row_mask:0xf bank_mask:0xf
  v_cndmask_b32_e64 v33, v33, v20, s[48:49]
  v_cvt_f32_i32 v110, v110
  v_cvt_f32_i32 v111, v111
  v_pk_mul_f32 v[20:21], v[108:109], v[22:23]
  v_pk_add_f32 v[18:19], v[22:23], v[24:25]
  v_pk_fma_f32 v[20:21], v[110:111], v[24:25], v[20:21]
  v_add_f32 v18, v18, v19
  v_add_f32 v20, v20, v21
  s_add_u32 m0, s100, 17408
  v_lshrrev_b32 v10, 1, v229
  v_add_u32 v10, v10, v241
  v_mad_u64_u32 v[30:31], s[64:65], v10, 1, v[28:29]
  global_load_lds_dwordx4 v[30:31], off
  s_cmpk_gt_i32 s69, 0x31
  s_cbranch_scc1 L_p15_4
  s_cmpk_gt_i32 s69, 0xb
  s_cbranch_scc1 L_p15_2
  s_waitcnt vmcnt(8)
L_p15_2:
  s_waitcnt vmcnt(12)
L_p15_4:
  s_waitcnt vmcnt(13)
  buffer_load_dwordx4 v[96:99], v228, s[32:35], 0 offen nt
  s_waitcnt vmcnt(12)
  ds_read_b64 v[164:165], v12 offset:12288
  ds_read_b64 v[166:167], v12 offset:12416
  ds_read_b64 v[168:169], v12 offset:13312
  ds_read_b64 v[170:171], v12 offset:13440
  ds_read_b64 v[172:173], v12 offset:14336
  ds_read_b64 v[174:175], v12 offset:14464
  v_dot2_f32_bf16 v22, v157, v64, 0
  v_add_f32_dpp v35, v18, v18 row_ror:8 row_mask:0xf bank_mask:0xc
  v_add_f32_dpp v35, v20, v20 row_ror:8 row_mask:0xf bank_mask:0x3
  v_dot2_f32_bf16 v23, v162, v65, 0
  v_dot2_f32_bf16 v24, v160, v66, 0
  v_dot2_f32_bf16 v25, v163, v67, 0
  v_cvt_f32_i32 v112, v112
  v_cvt_f32_i32 v113, v113
  v_cvt_f32_i32 v114, v114
  v_cvt_f32_i32 v115, v115
  v_pk_mul_f32 v[20:21], v[112:113], v[22:23]
  v_pk_add_f32 v[18:19], v[22:23], v[24:25]
  v_pk_fma_f32 v[20:21], v[114:115], v[24:25], v[20:21]
  v_add_f32 v18, v18, v19
  v_add_f32 v20, v20, v21
  s_cmpk_gt_i32 s69, 0x31
  s_cbranch_scc1 L_p16_4
  s_cmpk_gt_i32 s69, 0x1d
  s_cbranch_scc1 L_p16_3
  s_cmpk_gt_i32 s69, 0xffcd
  s_cbranch_scc1 L_p16_0
  s_waitcnt vmcnt(8)
L_p16_0:
  s_waitcnt vmcnt(9)
L_p16_3:
  s_waitcnt vmcnt(13)
L_p16_4:
  s_waitcnt vmcnt(14)
  buffer_load_dwordx4 v[100:103], v229, s[32:35], 0 offen nt
  v_mov_b32 v9, 1
  ds_write_b32 v6, v9 offset:0
L_it8:
  s_waitcnt lgkmcnt(0)
  ds_read_b128 v[56:59], v251 offset:1536
  ds_read_b128 v[60:63], v250 offset:1536
  ds_read_b128 v[64:67], v249 offset:1536
  s_waitcnt vmcnt(10)
  s_add_u32 s44, s78, 0x03030303
  v_msad_u8 v9, s78, v36, 0
  v_msad_u8 v10, s44, v36, 0
  v_msad_u8 v9, s78, v37, v9
  v_msad_u8 v10, s44, v37, v10
  v_msad_u8 v9, s78, v38, v9
  v_msad_u8 v10, s44, v38, v10
  s_mov_b64 exec, 3
  global_store_byte v7, v8, s[30:31]
  global_load_dwordx3 v[36:38], v236, s[30:31] sc1
  v_sub_u32 v9, v9, v10
  v_add_u32 v8, 1, v8
  s_mov_b64 exec, -1
  v_readlane_b32 s66, v9, 0
  v_readlane_b32 s67, v9, 1
  s_add_u32 s78, s78, 0x01010101
  s_lshl1_add_u32 s69, s91, s95
  s_add_u32 s95, s66, s67
  s_add_u32 s69, s69, s95
  v_perm_b32 v161, v166, v164, s56
  v_perm_b32 v166, v166, v164, s57
  v_perm_b32 v164, v167, v165, s56
  v_perm_b32 v167, v167, v165, s57
  v_dot2_f32_bf16 v22, v161, v44, 0
  v_add_f32_dpp v21, v18, v18 row_ror:8 row_mask:0xf bank_mask:0xc
  v_add_f32_dpp v21, v20, v20 row_ror:8 row_mask:0xf bank_mask:0x3
  v_add_f32_dpp v20, v35, v35 row_half_mirror row_mask:0xf bank_mask:0x5
  v_dot2_f32_bf16 v23, v166, v45, 0
  v_add_f32_dpp v20, v21, v21 row_half_mirror row_mask:0xf bank_mask:0xa
  v_dot2_f32_bf16 v24, v164, v46, 0
  v_dot2_f32_bf16 v25, v167, v47, 0
  v_add_f32_dpp v20, v20, v20 quad_perm:[2,3,0,1] row_mask:0xf bank_mask:0xf
  v_cvt_f32_i32 v68, v68
  v_cvt_f32_i32 v69, v69
  v_add_f32_dpp v20, v20, v20 quad_perm:[1,0,3,2] row_mask:0xf bank_mask:0xf
  v_cndmask_b32_e64 v33, v33, v20, s[50:51]
  v_cvt_f32_i32 v70, v70
  v_cvt_f32_i32 v71, v71
  v_pk_mul_f32 v[20:21], v[68:69], v[22:23]
  v_pk_add_f32 v[18:19], v[22:23], v[24:25]
  v_pk_fma_f32 v[20:21], v[70:71], v[24:25], v[20:21]
  v_add_f32 v18, v18, v19
  v_add_f32 v20, v20, v21
  s_add_u32 m0, s100, 18432
  v_lshrrev_b32 v10, 1, v230
  v_add_u32 v10, v10, v240
  v_mad_u64_u32 v[30:31], s[64:65], v10, 1, v[28:29]
  global_load_lds_dwordx4 v[30:31], off
  s_cmpk_gt_i32 s69, 0x31
  s_cbranch_scc1 L_p17_4
  s_cmpk_gt_i32 s69, 0xffed
  s_cbranch_scc1 L_p17_1
  s_waitcnt vmcnt(7)
L_p17_1:
  s_waitcnt vmcnt(10)
L_p17_4:
  s_waitcnt vmcnt(12)
  buffer_load_dwordx4 v[104:107], v227, s[32:35], s80 offen nt
  v_perm_b32 v165, v170, v168, s56
  v_perm_b32 v170, v170, v168, s57
  v_perm_b32 v168, v171, v169, s56
  v_perm_b32 v171, v171, v169, s57
  v_dot2_f32_bf16 v22, v165, v48, 0
  v_add_f32_dpp v34, v18, v18 row_ror:8 row_mask:0xf bank_mask:0xc
  v_add_f32_dpp v34, v20, v20 row_ror:8 row_mask:0xf bank_mask:0x3
  v_dot2_f32_bf16 v23, v170, v49, 0
  v_dot2_f32_bf16 v24, v168, v50, 0
  v_dot2_f32_bf16 v25, v171, v51, 0
  v_cvt_f32_i32 v72, v72
  v_cvt_f32_i32 v73, v73
  v_cvt_f32_i32 v74, v74
  v_cvt_f32_i32 v75, v75
  v_pk_mul_f32 v[20:21], v[72:73], v[22:23]
  v_pk_add_f32 v[18:19], v[22:23], v[24:25]
  v_pk_fma_f32 v[20:21], v[74:75], v[24:25], v[20:21]
  v_add_f32 v18, v18, v19
  v_add_f32 v20, v20, v21
  s_cmpk_gt_i32 s69, 0x31
  s_cbranch_scc1 L_p18_4
  s_cmpk_gt_i32 s69, 0xb
  s_cbranch_scc1 L_p18_2
  s_waitcnt vmcnt(8)
L_p18_2:
  s_waitcnt vmcnt(11)
L_p18_4:
  s_waitcnt vmcnt(13)
  buffer_load_dwordx4 v[108:111], v228, s[32:35], s80 offen nt
  v_perm_b32 v169, v174, v172, s56
  v_perm_b32 v174, v174, v172, s57
  v_perm_b32 v172, v175, v173, s56
  v_perm_b32 v175, v175, v173, s57
  v_dot2_f32_bf16 v22, v169, v52, 0
  v_add_f32_dpp v21, v18, v18 row_ror:8 row_mask:0xf bank_mask:0xc
  v_add_f32_dpp v21, v20, v20 row_ror:8 row_mask:0xf bank_mask:0x3
  v_add_f32_dpp v20, v34, v34 row_half_mirror row_mask:0xf bank_mask:0x5
  v_dot2_f32_bf16 v23, v174, v53, 0
  v_add_f32_dpp v20, v21, v21 row_half_mirror row_mask:0xf bank_mask:0xa
  v_dot2_f32_bf16 v24, v172, v54, 0
  v_dot2_f32_bf16 v25, v175, v55, 0
  v_add_f32_dpp v20, v20, v20 quad_perm:[2,3,0,1] row_mask:0xf bank_mask:0xf
  v_cvt_f32_i32 v76, v76
  v_cvt_f32_i32 v77, v77
  v_add_f32_dpp v20, v20, v20 quad_perm:[1,0,3,2] row_mask:0xf bank_mask:0xf
  v_cndmask_b32_e64 v32, v32, v20, s[52:53]
  v_cvt_f32_i32 v78, v78
  v_cvt_f32_i32 v79, v79
  v_pk_mul_f32 v[20:21], v[76:77], v[22:23]
  v_pk_add_f32 v[18:19], v[22:23], v[24:25]
  v_pk_fma_f32 v[20:21], v[78:79], v[24:25], v[20:21]
  v_add_f32 v18, v18, v19
  v_add_f32 v20, v20, v21
  s_add_u32 m0, s100, 19456
  v_lshrrev_b32 v10, 1, v231
  v_add_u32 v10, v10, v242
  v_mad_u64_u32 v[30:31], s[64:65], v10, 1, v[28:29]
  global_load_lds_dwordx4 v[30:31], off
  s_cmpk_gt_i32 s69, 0x31
  s_cbranch_scc1 L_p19_4
  s_cmpk_gt_i32 s69, 0x1d
  s_cbranch_scc1 L_p19_3
  s_cmpk_gt_i32 s69, 0xffcd
  s_cbranch_scc1 L_p19_0
  s_waitcnt vmcnt(8)
L_p19_0:
  s_waitcnt vmcnt(10)
L_p19_3:
  s_waitcnt vmcnt(13)
L_p19_4:
  s_waitcnt vmcnt(15)
  buffer_load_dwordx4 v[112:115], v229, s[32:35], s80 offen nt
L_it9:
  s_waitcnt lgkmcnt(0)
  ds_read_b128 v[44:47], v251 offset:512
  ds_read_b128 v[48:51], v248 offset:512
  ds_read_b128 v[52:55], v247 offset:512
  s_waitcnt vmcnt(10)
  s_add_u32 s44, s78, 0x03030303
  v_msad_u8 v9, s78, v40, 0
  v_msad_u8 v10, s44, v40, 0
  v_msad_u8 v9, s78, v41, v9
  v_msad_u8 v10, s44, v41, v10
  v_msad_u8 v9, s78, v42, v9
  v_msad_u8 v10, s44, v42, v10
  s_mov_b64 exec, 3
  global_store_byte v7, v8, s[30:31]
  global_load_dwordx3 v[40:42], v237, s[30:31] sc1
  v_sub_u32 v9, v9, v10
  v_add_u32 v8, 1, v8
  s_mov_b64 exec, -1
  v_readlane_b32 s66, v9, 0
  v_readlane_b32 s67, v9, 1
  s_add_u32 s78, s78, 0x01010101
  s_lshl1_add_u32 s69, s91, s95
  s_add_u32 s95, s66, s67
  s_add_u32 s69, s69, s95
  v_dot2_f32_bf16 v22, v161, v56, 0
  v_add_f32_dpp v34, v18, v18 row_ror:8 row_mask:0xf bank_mask:0xc
  v_add_f32_dpp v34, v20, v20 row_ror:8 row_mask:0xf bank_mask:0x3
  v_dot2_f32_bf16 v23, v166, v57, 0
  v_dot2_f32_bf16 v24, v164, v58, 0
  v_dot2_f32_bf16 v25, v167, v59, 0
  v_cvt_f32_i32 v80, v80
  v_cvt_f32_i32 v81, v81
  v_cvt_f32_i32 v82, v82
  v_cvt_f32_i32 v83, v83
  v_pk_mul_f32 v[20:21], v[80:81], v[22:23]
  v_pk_add_f32 v[18:19], v[22:23], v[24:25]
  v_pk_fma_f32 v[20:21], v[82:83], v[24:25], v[20:21]
  v_add_f32 v18, v18, v19
  v_add_f32 v20, v20, v21
  s_cmpk_gt_i32 s69, 0x31
  s_cbranch_scc1 L_p20_4
  s_cmpk_gt_i32 s69, 0xffed
  s_cbranch_scc1 L_p20_1
  s_waitcnt vmcnt(6)
L_p20_1:
  s_waitcnt vmcnt(10)
L_p20_4:
  s_waitcnt vmcnt(11)
  buffer_load_dwordx4 v[68:71], v230, s[32:35], 0 offen nt
  v_dot2_f32_bf16 v22, v165, v60, 0
  v_add_f32_dpp v35, v18, v18 row_ror:8 row_mask:0xf bank_mask:0xc
  v_add_f32_dpp v35, v20, v20 row_ror:8 row_mask:0xf bank_mask:0x3
  v_dot2_f32_bf16 v23, v170, v61, 0
  v_dot2_f32_bf16 v24, v168, v62, 0
  v_dot2_f32_bf16 v25, v171, v63, 0
  v_cvt_f32_i32 v84, v84
  v_cvt_f32_i32 v85, v85
  v_cvt_f32_i32 v86, v86
  v_cvt_f32_i32 v87, v87
  v_pk_mul_f32 v[20:21], v[84:85], v[22:23]
  v_pk_add_f32 v[18:19], v[22:23], v[24:25]
  v_pk_fma_f32 v[20:21], v[86:87], v[24:25], v[20:21]
  v_add_f32 v18, v18, v19
  v_add_f32 v20, v20, v21
  s_add_u32 m0, s100, 20480
  v_lshrrev_b32 v10, 1, v232
  v_add_u32 v10, v10, v243
  v_mad_u64_u32 v[30:31], s[64:65], v10, 1, v[28:29]
  global_load_lds_dwordx4 v[30:31], off
  s_cmpk_gt_i32 s69, 0x31
  s_cbranch_scc1 L_p21_4
  s_cmpk_gt_i32 s69, 0xb
  s_cbranch_scc1 L_p21_2
  s_waitcnt vmcnt(8)
L_p21_2:
  s_waitcnt vmcnt(12)
L_p21_4:
  s_waitcnt vmcnt(13)
  buffer_load_dwordx4 v[72:75], v231, s[32:35], 0 offen nt
  s_waitcnt vmcnt(12)
  ds_read_b64 v[176:177], v12 offset:15360
  ds_read_b64 v[178:179], v12 offset:15488
  ds_read_b64 v[180:181], v12 offset:16384
  ds_read_b64 v[182:183], v12 offset:16512
  ds_read_b64 v[184:185], v12 offset:17408
  ds_read_b64 v[186:187], v12 offset:17536
  v_dot2_f32_bf16 v22, v169, v64, 0
  v_add_f32_dpp v21, v18, v18 row_ror:8 row_mask:0xf bank_mask:0xc
  v_add_f32_dpp v21, v20, v20 row_ror:8 row_mask:0xf bank_mask:0x3
  v_add_f32_dpp v20, v35, v35 row_half_mirror row_mask:0xf bank_mask:0x5
  v_dot2_f32_bf16 v23, v174, v65, 0
  v_add_f32_dpp v20, v21, v21 row_half_mirror row_mask:0xf bank_mask:0xa
  v_dot2_f32_bf16 v24, v172, v66, 0
  v_dot2_f32_bf16 v25, v175, v67, 0
  v_add_f32_dpp v20, v20, v20 quad_perm:[2,3,0,1] row_mask:0xf bank_mask:0xf
  v_cvt_f32_i32 v88, v88
  v_cvt_f32_i32 v89, v89
  v_add_f32_dpp v20, v20, v20 quad_perm:[1,0,3,2] row_mask:0xf bank_mask:0xf
  v_cndmask_b32_e64 v33, v33, v20, s[52:53]
  v_cvt_f32_i32 v90, v90
  v_cvt_f32_i32 v91, v91
  v_pk_mul_f32 v[20:21], v[88:89], v[22:23]
  v_pk_add_f32 v[18:19], v[22:23], v[24:25]
  v_pk_fma_f32 v[20:21], v[90:91], v[24:25], v[20:21]
  v_add_f32 v18, v18, v19
  v_add_f32 v20, v20, v21
  s_cmpk_gt_i32 s69, 0x31
  s_cbranch_scc1 L_p22_4
  s_cmpk_gt_i32 s69, 0x1d
  s_cbranch_scc1 L_p22_3
  s_cmpk_gt_i32 s69, 0xffcd
  s_cbranch_scc1 L_p22_0
  s_waitcnt vmcnt(8)
L_p22_0:
  s_waitcnt vmcnt(9)
L_p22_3:
  s_waitcnt vmcnt(13)
L_p22_4:
  s_waitcnt vmcnt(14)
  buffer_load_dwordx4 v[76:79], v232, s[32:35], 0 offen nt
L_it10:
  s_waitcnt lgkmcnt(0)
  ds_read_b128 v[56:59], v251 offset:1536
  ds_read_b128 v[60:63], v248 offset:1536
  ds_read_b128 v[64:67], v247 offset:1536
  s_waitcnt vmcnt(10)
  s_add_u32 s44, s78, 0x03030303
  v_msad_u8 v9, s78, v36, 0
  v_msad_u8 v10, s44, v36, 0
  v_msad_u8 v9, s78, v37, v9
  v_msad_u8 v10, s44, v37, v10
  v_msad_u8 v9, s78, v38, v9
  v_msad_u8 v10, s44, v38, v10
  s_mov_b64 exec, 3
  global_store_byte v7, v8, s[30:31]
  global_load_dwordx3 v[36:38], v238, s[30:31] sc1
  v_sub_u32 v9, v9, v10
  v_add_u32 v8, 1, v8
  s_mov_b64 exec, -1
  v_readlane_b32 s66, v9, 0
  v_readlane_b32 s67, v9, 1
  s_add_u32 s78, s78, 0x01010101
  s_lshl1_add_u32 s69, s91, s95
  s_add_u32 s95, s66, s67
  s_add_u32 s69, s69, s95
  v_perm_b32 v173, v178, v176, s56
  v_perm_b32 v178, v178, v176, s57
  v_perm_b32 v176, v179, v177, s56
  v_perm_b32 v179, v179, v177, s57
  v_dot2_f32_bf16 v22, v173, v44, 0
  v_add_f32_dpp v35, v18, v18 row_ror:8 row_mask:0xf bank_mask:0xc
  v_add_f32_dpp v35, v20, v20 row_ror:8 row_mask:0xf bank_mask:0x3
  v_dot2_f32_bf16 v23, v178, v45, 0
  v_dot2_f32_bf16 v24, v176, v46, 0
  v_dot2_f32_bf16 v25, v179, v47, 0
  v_cvt_f32_i32 v92, v92
  v_cvt_f32_i32 v93, v93
  v_cvt_f32_i32 v94, v94
  v_cvt_f32_i32 v95, v95
  v_pk_mul_f32 v[20:21], v[92:93], v[22:23]
  v_pk_add_f32 v[18:19], v[22:23], v[24:25]
  v_pk_fma_f32 v[20:21], v[94:95], v[24:25], v[20:21]
  v_add_f32 v18, v18, v19
  v_add_f32 v20, v20, v21
  s_add_u32 m0, s100, 21504
  v_lshrrev_b32 v10, 1, v233
  v_add_u32 v10, v10, v245
  v_mad_u64_u32 v[30:31], s[64:65], v10, 1, v[28:29]
  global_load_lds_dwordx4 v[30:31], off
  s_cmpk_gt_i32 s69, 0x31
  s_cbranch_scc1 L_p23_4
  s_cmpk_gt_i32 s69, 0xffed
  s_cbranch_scc1 L_p23_1
  s_waitcnt vmcnt(7)
L_p23_1:
  s_waitcnt vmcnt(10)
L_p23_4:
  s_waitcnt vmcnt(12)
  buffer_load_dwordx4 v[80:83], v230, s[32:35], s80 offen nt
  v_perm_b32 v177, v182, v180, s56
  v_perm_b32 v182, v182, v180, s57
  v_perm_b32 v180, v183, v181, s56
  v_perm_b32 v183, v183, v181, s57
  v_dot2_f32_bf16 v22, v177, v48, 0
  v_add_f32_dpp v21, v18, v18 row_ror:8 row_mask:0xf bank_mask:0xc
  v_add_f32_dpp v21, v20, v20 row_ror:8 row_mask:0xf bank_mask:0x3
  v_add_f32_dpp v20, v34, v34 row_half_mirror row_mask:0xf bank_mask:0x5
  v_dot2_f32_bf16 v23, v182, v49, 0
  v_add_f32_dpp v20, v21, v21 row_half_mirror row_mask:0xf bank_mask:0xa
  v_dot2_f32_bf16 v24, v180, v50, 0
  v_dot2_f32_bf16 v25, v183, v51, 0
  v_add_f32_dpp v20, v20, v20 quad_perm:[2,3,0,1] row_mask:0xf bank_mask:0xf
  v_cvt_f32_i32 v96, v96
  v_cvt_f32_i32 v97, v97
  v_add_f32_dpp v20, v20, v20 quad_perm:[1,0,3,2] row_mask:0xf bank_mask:0xf
  v_cndmask_b32_e64 v32, v32, v20, s[54:55]
  ds_write_b32 v16, v32 offset:0
  v_cvt_f32_i32 v98, v98
  v_cvt_f32_i32 v99, v99
  v_pk_mul_f32 v[20:21], v[96:97], v[22:23]
  v_pk_add_f32 v[18:19], v[22:23], v[24:25]
  v_pk_fma_f32 v[20:21], v[98:99], v[24:25], v[20:21]
  v_add_f32 v18, v18, v19
  v_add_f32 v20, v20, v21
  s_cmpk_gt_i32 s69, 0x31
  s_cbranch_scc1 L_p24_4
  s_cmpk_gt_i32 s69, 0xb
  s_cbranch_scc1 L_p24_2
  s_waitcnt vmcnt(8)
L_p24_2:
  s_waitcnt vmcnt(11)
L_p24_4:
  s_waitcnt vmcnt(13)
  buffer_load_dwordx4 v[84:87], v231, s[32:35], s80 offen nt
  v_perm_b32 v181, v186, v184, s56
  v_perm_b32 v186, v186, v184, s57
  v_perm_b32 v184, v187, v185, s56
  v_perm_b32 v187, v187, v185, s57
  v_dot2_f32_bf16 v22, v181, v52, 0
  v_add_f32_dpp v34, v18, v18 row_ror:8 row_mask:0xf bank_mask:0xc
  v_add_f32_dpp v34, v20, v20 row_ror:8 row_mask:0xf bank_mask:0x3
  v_dot2_f32_bf16 v23, v186, v53, 0
  v_dot2_f32_bf16 v24, v184, v54, 0
  v_dot2_f32_bf16 v25, v187, v55, 0
  v_cvt_f32_i32 v100, v100
  v_cvt_f32_i32 v101, v101
  v_cvt_f32_i32 v102, v102
  v_cvt_f32_i32 v103, v103
  v_pk_mul_f32 v[20:21], v[100:101], v[22:23]
  v_pk_add_f32 v[18:19], v[22:23], v[24:25]
  v_pk_fma_f32 v[20:21], v[102:103], v[24:25], v[20:21]
  v_add_f32 v18, v18, v19
  v_add_f32 v20, v20, v21
  s_add_u32 m0, s100, 22528
  v_lshrrev_b32 v10, 1, v234
  v_add_u32 v10, v10, v244
  v_mad_u64_u32 v[30:31], s[64:65], v10, 1, v[28:29]
  global_load_lds_dwordx4 v[30:31], off
  s_cmpk_gt_i32 s69, 0x31
  s_cbranch_scc1 L_p25_4
  s_cmpk_gt_i32 s69, 0x1d
  s_cbranch_scc1 L_p25_3
  s_cmpk_gt_i32 s69, 0xffcd
  s_cbranch_scc1 L_p25_0
  s_waitcnt vmcnt(8)
L_p25_0:
  s_waitcnt vmcnt(10)
L_p25_3:
  s_waitcnt vmcnt(13)
L_p25_4:
  s_waitcnt vmcnt(15)
  buffer_load_dwordx4 v[88:91], v232, s[32:35], s80 offen nt
L_it11:
  s_waitcnt lgkmcnt(0)
  ds_read_b128 v[44:47], v246 offset:512
  ds_read_b128 v[48:51], v248 offset:512
  ds_read_b128 v[52:55], v249 offset:512
  s_waitcnt vmcnt(10)
  s_add_u32 s44, s78, 0x03030303
  v_msad_u8 v9, s78, v40, 0
  v_msad_u8 v10, s44, v40, 0
  v_msad_u8 v9, s78, v41, v9
  v_msad_u8 v10, s44, v41, v10
  v_msad_u8 v9, s78, v42, v9
  v_msad_u8 v10, s44, v42, v10
  s_mov_b64 exec, 3
  global_store_byte v7, v8, s[30:31]
  global_load_dwordx3 v[40:42], v239, s[30:31] sc1
  v_sub_u32 v9, v9, v10
  v_add_u32 v8, 1, v8
  s_mov_b64 exec, -1
  v_readlane_b32 s66, v9, 0
  v_readlane_b32 s67, v9, 1
  s_add_u32 s78, s78, 0x01010101
  s_lshl1_add_u32 s69, s91, s95
  s_add_u32 s95, s66, s67
  s_add_u32 s69, s69, s95
  v_dot2_f32_bf16 v22, v173, v56, 0
  v_add_f32_dpp v21, v18, v18 row_ror:8 row_mask:0xf bank_mask:0xc
  v_add_f32_dpp v21, v20, v20 row_ror:8 row_mask:0xf bank_mask:0x3
  v_add_f32_dpp v20, v34, v34 row_half_mirror row_mask:0xf bank_mask:0x5
  v_dot2_f32_bf16 v23, v178, v57, 0
  v_add_f32_dpp v20, v21, v21 row_half_mirror row_mask:0xf bank_mask:0xa
  v_dot2_f32_bf16 v24, v176, v58, 0
  v_dot2_f32_bf16 v25, v179, v59, 0
  v_add_f32_dpp v20, v20, v20 quad_perm:[2,3,0,1] row_mask:0xf bank_mask:0xf
  v_cvt_f32_i32 v104, v104
  v_cvt_f32_i32 v105, v105
  v_add_f32_dpp v20, v20, v20 quad_perm:[1,0,3,2] row_mask:0xf bank_mask:0xf
  v_cndmask_b32_e64 v32, v32, v20, s[48:49]
  v_cvt_f32_i32 v106, v106
  v_cvt_f32_i32 v107, v107
  v_pk_mul_f32 v[20:21], v[104:105], v[22:23]
  v_pk_add_f32 v[18:19], v[22:23], v[24:25]
  v_pk_fma_f32 v[20:21], v[106:107], v[24:25], v[20:21]
  v_add_f32 v18, v18, v19
  v_add_f32 v20, v20, v21
  s_cmpk_gt_i32 s69, 0x31
  s_cbranch_scc1 L_p26_4
  s_cmpk_gt_i32 s69, 0xffed
  s_cbranch_scc1 L_p26_1
  s_waitcnt vmcnt(6)
L_p26_1:
  s_waitcnt vmcnt(10)
L_p26_4:
  s_waitcnt vmcnt(11)
  buffer_load_dwordx4 v[92:95], v233, s[32:35], 0 offen nt
  v_dot2_f32_bf16 v22, v177, v60, 0
  v_add_f32_dpp v21, v18, v18 row_ror:8 row_mask:0xf bank_mask:0xc
  v_add_f32_dpp v21, v20, v20 row_ror:8 row_mask:0xf bank_mask:0x3
  v_add_f32_dpp v20, v35, v35 row_half_mirror row_mask:0xf bank_mask:0x5
  v_dot2_f32_bf16 v23, v182, v61, 0
  v_add_f32_dpp v20, v21, v21 row_half_mirror row_mask:0xf bank_mask:0xa
  v_dot2_f32_bf16 v24, v180, v62, 0
  v_dot2_f32_bf16 v25, v183, v63, 0
  v_add_f32_dpp v20, v20, v20 quad_perm:[2,3,0,1] row_mask:0xf bank_mask:0xf
  v_cvt_f32_i32 v108, v108
  v_cvt_f32_i32 v109, v109
  v_add_f32_dpp v20, v20, v20 quad_perm:[1,0,3,2] row_mask:0xf bank_mask:0xf
  v_cndmask_b32_e64 v33, v33, v20, s[54:55]
  ds_write_b32 v16, v33 offset:3072
  v_cvt_f32_i32 v110, v110
  v_cvt_f32_i32 v111, v111
  v_pk_mul_f32 v[20:21], v[108:109], v[22:23]
  v_pk_add_f32 v[18:19], v[22:23], v[24:25]
  v_pk_fma_f32 v[20:21], v[110:111], v[24:25], v[20:21]
  v_add_f32 v18, v18, v19
  v_add_f32 v20, v20, v21
  s_add_u32 m0, s100, 23552
  v_lshrrev_b32 v10, 1, v235
  v_add_u32 v10, v10, v243
  v_mad_u64_u32 v[30:31], s[64:65], v10, 1, v[28:29]
  global_load_lds_dwordx4 v[30:31], off
  s_cmpk_gt_i32 s69, 0x31
  s_cbranch_scc1 L_p27_4
  s_cmpk_gt_i32 s69, 0xb
  s_cbranch_scc1 L_p27_2
  s_waitcnt vmcnt(8)
L_p27_2:
  s_waitcnt vmcnt(12)
L_p27_4:
  s_waitcnt vmcnt(13)
  buffer_load_dwordx4 v[96:99], v234, s[32:35], 0 offen nt
  s_waitcnt vmcnt(12)
  ds_read_b64 v[188:189], v12 offset:18432
  ds_read_b64 v[190:191], v12 offset:18560
  ds_read_b64 v[192:193], v12 offset:19456
  ds_read_b64 v[194:195], v12 offset:19584
  ds_read_b64 v[196:197], v12 offset:20480
  ds_read_b64 v[198:199], v12 offset:20608
  v_dot2_f32_bf16 v22, v181, v64, 0
  v_add_f32_dpp v35, v18, v18 row_ror:8 row_mask:0xf bank_mask:0xc
  v_add_f32_dpp v35, v20, v20 row_ror:8 row_mask:0xf bank_mask:0x3
  v_dot2_f32_bf16 v23, v186, v65, 0
  v_dot2_f32_bf16 v24, v184, v66, 0
  v_dot2_f32_bf16 v25, v187, v67, 0
  v_cvt_f32_i32 v112, v112
  v_cvt_f32_i32 v113, v113
  v_cvt_f32_i32 v114, v114
  v_cvt_f32_i32 v115, v115
  v_pk_mul_f32 v[20:21], v[112:113], v[22:23]
  v_pk_add_f32 v[18:19], v[22:23], v[24:25]
  v_pk_fma_f32 v[20:21], v[114:115], v[24:25], v[20:21]
  v_add_f32 v18, v18, v19
  v_add_f32 v20, v20, v21
  s_cmpk_gt_i32 s69, 0x31
  s_cbranch_scc1 L_p28_4
  s_cmpk_gt_i32 s69, 0x1d
  s_cbranch_scc1 L_p28_3
  s_cmpk_gt_i32 s69, 0xffcd
  s_cbranch_scc1 L_p28_0
  s_waitcnt vmcnt(8)
L_p28_0:
  s_waitcnt vmcnt(9)
L_p28_3:
  s_waitcnt vmcnt(13)
L_p28_4:
  s_waitcnt vmcnt(14)
  buffer_load_dwordx4 v[100:103], v235, s[32:35], 0 offen nt
L_it12:
  s_waitcnt lgkmcnt(0)
  ds_read_b128 v[56:59], v246 offset:1536
  ds_read_b128 v[60:63], v248 offset:1536
  ds_read_b128 v[64:67], v249 offset:1536
  s_waitcnt vmcnt(10)
  s_add_u32 s44, s78, 0x03030303
  v_msad_u8 v9, s78, v36, 0
  v_msad_u8 v10, s44, v36, 0
  v_msad_u8 v9, s78, v37, v9
  v_msad_u8 v10, s44, v37, v10
  v_msad_u8 v9, s78, v38, v9
  v_msad_u8 v10, s44, v38, v10
  s_mov_b64 exec, 3
  global_store_byte v7, v8, s[30:31]
  global_load_dwordx3 v[36:38], v236, s[30:31] sc1
  v_sub_u32 v9, v9, v10
  v_add_u32 v8, 1, v8
  s_mov_b64 exec, -1
  v_readlane_b32 s66, v9, 0
  v_readlane_b32 s67, v9, 1
  s_add_u32 s78, s78, 0x01010101
  s_lshl1_add_u32 s69, s91, s95
  s_add_u32 s95, s66, s67
  s_add_u32 s69, s69, s95
  v_perm_b32 v185, v190, v188, s56
  v_perm_b32 v190, v190, v188, s57
  v_perm_b32 v188, v191, v189, s56
  v_perm_b32 v191, v191, v189, s57
  v_dot2_f32_bf16 v22, v185, v44, 0
  v_add_f32_dpp v21, v18, v18 row_ror:8 row_mask:0xf bank_mask:0xc
  v_add_f32_dpp v21, v20, v20 row_ror:8 row_mask:0xf bank_mask:0x3
  v_add_f32_dpp v20, v35, v35 row_half_mirror row_mask:0xf bank_mask:0x5
  v_dot2_f32_bf16 v23, v190, v45, 0
  v_add_f32_dpp v20, v21, v21 row_half_mirror row_mask:0xf bank_mask:0xa
  v_dot2_f32_bf16 v24, v188, v46, 0
  v_dot2_f32_bf16 v25, v191, v47, 0
  v_add_f32_dpp v20, v20, v20 quad_perm:[2,3,0,1] row_mask:0xf bank_mask:0xf
  v_cvt_f32_i32 v68, v68
  v_cvt_f32_i32 v69, v69
  v_add_f32_dpp v20, v20, v20 quad_perm:[1,0,3,2] row_mask:0xf bank_mask:0xf
  v_cndmask_b32_e64 v33, v33, v20, s[48:49]
  v_cvt_f32_i32 v70, v70
  v_cvt_f32_i32 v71, v71
  v_pk_mul_f32 v[20:21], v[68:69], v[22:23]
  v_pk_add_f32 v[18:19], v[22:23], v[24:25]
  v_pk_fma_f32 v[20:21], v[70:71], v[24:25], v[20:21]
  v_add_f32 v18, v18, v19
  v_add_f32 v20, v20, v21
  s_cmpk_gt_i32 s69, 0x31
  s_cbranch_scc1 L_p29_4
  s_cmpk_gt_i32 s69, 0xffed
  s_cbranch_scc1 L_p29_1
  s_waitcnt vmcnt(6)
L_p29_1:
  s_waitcnt vmcnt(9)
L_p29_4:
  s_waitcnt vmcnt(11)
  buffer_load_dwordx4 v[104:107], v233, s[32:35], s80 offen nt
  v_perm_b32 v189, v194, v192, s56
  v_perm_b32 v194, v194, v192, s57
  v_perm_b32 v192, v195, v193, s56
  v_perm_b32 v195, v195, v193, s57
  v_dot2_f32_bf16 v22, v189, v48, 0
  v_add_f32_dpp v34, v18, v18 row_ror:8 row_mask:0xf bank_mask:0xc
  v_add_f32_dpp v34, v20, v20 row_ror:8 row_mask:0xf bank_mask:0x3
  v_dot2_f32_bf16 v23, v194, v49, 0
  v_dot2_f32_bf16 v24, v192, v50, 0
  v_dot2_f32_bf16 v25, v195, v51, 0
  v_cvt_f32_i32 v72, v72
  v_cvt_f32_i32 v73, v73
  v_cvt_f32_i32 v74, v74
  v_cvt_f32_i32 v75, v75
  v_pk_mul_f32 v[20:21], v[72:73], v[22:23]
  v_pk_add_f32 v[18:19], v[22:23], v[24:25]
  v_pk_fma_f32 v[20:21], v[74:75], v[24:25], v[20:21]
  v_add_f32 v18, v18, v19
  v_add_f32 v20, v20, v21
  s_cmpk_gt_i32 s69, 0x31
  s_cbranch_scc1 L_p30_4
  s_cmpk_gt_i32 s69, 0xb
  s_cbranch_scc1 L_p30_2
  s_waitcnt vmcnt(7)
L_p30_2:
  s_waitcnt vmcnt(10)
L_p30_4:
  s_waitcnt vmcnt(12)
  buffer_load_dwordx4 v[108:111], v234, s[32:35], s80 offen nt
  v_perm_b32 v193, v198, v196, s56
  v_perm_b32 v198, v198, v196, s57
  v_perm_b32 v196, v199, v197, s56
  v_perm_b32 v199, v199, v197, s57
  v_dot2_f32_bf16 v22, v193, v52, 0
  v_add_f32_dpp v21, v18, v18 row_ror:8 row_mask:0xf bank_mask:0xc
  v_add_f32_dpp v21, v20, v20 row_ror:8 row_mask:0xf bank_mask:0x3
  v_add_f32_dpp v20, v34, v34 row_half_mirror row_mask:0xf bank_mask:0x5
  v_dot2_f32_bf16 v23, v198, v53, 0
  v_add_f32_dpp v20, v21, v21 row_half_mirror row_mask:0xf bank_mask:0xa
  v_dot2_f32_bf16 v24, v196, v54, 0
  v_dot2_f32_bf16 v25, v199, v55, 0
  v_add_f32_dpp v20, v20, v20 quad_perm:[2,3,0,1] row_mask:0xf bank_mask:0xf
  v_cvt_f32_i32 v76, v76
  v_cvt_f32_i32 v77, v77
  v_add_f32_dpp v20, v20, v20 quad_perm:[1,0,3,2] row_mask:0xf bank_mask:0xf
  v_cndmask_b32_e64 v32, v32, v20, s[50:51]
  v_cvt_f32_i32 v78, v78
  v_cvt_f32_i32 v79, v79
  v_pk_mul_f32 v[20:21], v[76:77], v[22:23]
  v_pk_add_f32 v[18:19], v[22:23], v[24:25]
  v_pk_fma_f32 v[20:21], v[78:79], v[24:25], v[20:21]
  v_add_f32 v18, v18, v19
  v_add_f32 v20, v20, v21
  s_cmpk_gt_i32 s69, 0x31
  s_cbranch_scc1 L_p31_4
  s_cmpk_gt_i32 s69, 0x1d
  s_cbranch_scc1 L_p31_3
  s_cmpk_gt_i32 s69, 0xffcd
  s_cbranch_scc1 L_p31_0
  s_waitcnt vmcnt(6)
L_p31_0:
  s_waitcnt vmcnt(8)
L_p31_3:
  s_waitcnt vmcnt(11)
L_p31_4:
  s_waitcnt vmcnt(13)
  buffer_load_dwordx4 v[112:115], v235, s[32:35], s80 offen nt
L_it13:
  s_waitcnt lgkmcnt(0)
  ds_read_b128 v[44:47], v251 offset:512
  ds_read_b128 v[48:51], v250 offset:512
  ds_read_b128 v[52:55], v249 offset:512
  s_waitcnt vmcnt(8)
  s_add_u32 s44, s78, 0x03030303
  v_msad_u8 v9, s78, v40, 0
  v_msad_u8 v10, s44, v40, 0
  v_msad_u8 v9, s78, v41, v9
  v_msad_u8 v10, s44, v41, v10
  v_msad_u8 v9, s78, v42, v9
  v_msad_u8 v10, s44, v42, v10
  s_mov_b64 exec, 3
  global_load_dwordx2 v[26:27], v11, s[30:31] sc1
  global_store_byte v7, v8, s[30:31]
  global_load_dwordx3 v[40:42], v237, s[30:31] sc1
  v_sub_u32 v9, v9, v10
  v_add_u32 v8, 1, v8
  s_mov_b64 exec, -1
  v_readlane_b32 s66, v9, 0
  v_readlane_b32 s67, v9, 1
  s_add_u32 s78, s78, 0x01010101
  s_lshl1_add_u32 s69, s91, s95
  s_add_u32 s95, s66, s67
  s_add_u32 s69, s69, s95
  v_dot2_f32_bf16 v22, v185, v56, 0
  v_add_f32_dpp v34, v18, v18 row_ror:8 row_mask:0xf bank_mask:0xc
  v_add_f32_dpp v34, v20, v20 row_ror:8 row_mask:0xf bank_mask:0x3
  v_dot2_f32_bf16 v23, v190, v57, 0
  v_dot2_f32_bf16 v24, v188, v58, 0
  v_dot2_f32_bf16 v25, v191, v59, 0
  v_cvt_f32_i32 v80, v80
  v_cvt_f32_i32 v81, v81
  v_cvt_f32_i32 v82, v82
  v_cvt_f32_i32 v83, v83
  v_pk_mul_f32 v[20:21], v[80:81], v[22:23]
  v_pk_add_f32 v[18:19], v[22:23], v[24:25]
  v_pk_fma_f32 v[20:21], v[82:83], v[24:25], v[20:21]
  v_add_f32 v18, v18, v19
  v_add_f32 v20, v20, v21
  s_cmpk_gt_i32 s69, 0x31
  s_cbranch_scc1 L_p32_4
  s_cmpk_gt_i32 s69, 0xffed
  s_cbranch_scc1 L_p32_1
  s_waitcnt vmcnt(6)
L_p32_1:
  s_waitcnt vmcnt(9)
L_p32_4:
  s_waitcnt vmcnt(10)
  buffer_load_dwordx4 v[68:71], v212, s[32:35], s3 offen nt
  v_dot2_f32_bf16 v22, v189, v60, 0
  v_add_f32_dpp v35, v18, v18 row_ror:8 row_mask:0xf bank_mask:0xc
  v_add_f32_dpp v35, v20, v20 row_ror:8 row_mask:0xf bank_mask:0x3
  v_dot2_f32_bf16 v23, v194, v61, 0
  v_dot2_f32_bf16 v24, v192, v62, 0
  v_dot2_f32_bf16 v25, v195, v63, 0
  v_cvt_f32_i32 v84, v84
  v_cvt_f32_i32 v85, v85
  v_cvt_f32_i32 v86, v86
  v_cvt_f32_i32 v87, v87
  v_pk_mul_f32 v[20:21], v[84:85], v[22:23]
  v_pk_add_f32 v[18:19], v[22:23], v[24:25]
  v_pk_fma_f32 v[20:21], v[86:87], v[24:25], v[20:21]
  v_add_f32 v18, v18, v19
  v_add_f32 v20, v20, v21
  s_cmpk_gt_i32 s69, 0x31
  s_cbranch_scc1 L_p33_4
  s_cmpk_gt_i32 s69, 0xb
  s_cbranch_scc1 L_p33_2
  s_waitcnt vmcnt(7)
L_p33_2:
  s_waitcnt vmcnt(10)
L_p33_4:
  s_waitcnt vmcnt(11)
  buffer_load_dwordx4 v[72:75], v213, s[32:35], s3 offen nt
  s_waitcnt vmcnt(10)
  ds_read_b64 v[200:201], v12 offset:21504
  ds_read_b64 v[202:203], v12 offset:21632
  ds_read_b64 v[204:205], v12 offset:22528
  ds_read_b64 v[206:207], v12 offset:22656
  ds_read_b64 v[208:209], v12 offset:23552
  ds_read_b64 v[210:211], v12 offset:23680
  v_dot2_f32_bf16 v22, v193, v64, 0
  v_add_f32_dpp v21, v18, v18 row_ror:8 row_mask:0xf bank_mask:0xc
  v_add_f32_dpp v21, v20, v20 row_ror:8 row_mask:0xf bank_mask:0x3
  v_add_f32_dpp v20, v35, v35 row_half_mirror row_mask:0xf bank_mask:0x5
  v_dot2_f32_bf16 v23, v198, v65, 0
  v_add_f32_dpp v20, v21, v21 row_half_mirror row_mask:0xf bank_mask:0xa
  v_dot2_f32_bf16 v24, v196, v66, 0
  v_dot2_f32_bf16 v25, v199, v67, 0
  v_add_f32_dpp v20, v20, v20 quad_perm:[2,3,0,1] row_mask:0xf bank_mask:0xf
  v_cvt_f32_i32 v88, v88
  v_cvt_f32_i32 v89, v89
  v_add_f32_dpp v20, v20, v20 quad_perm:[1,0,3,2] row_mask:0xf bank_mask:0xf
  v_cndmask_b32_e64 v33, v33, v20, s[50:51]
  v_cvt_f32_i32 v90, v90
  v_cvt_f32_i32 v91, v91
  v_pk_mul_f32 v[20:21], v[88:89], v[22:23]
  v_pk_add_f32 v[18:19], v[22:23], v[24:25]
  v_pk_fma_f32 v[20:21], v[90:91], v[24:25], v[20:21]
  v_add_f32 v18, v18, v19
  v_add_f32 v20, v20, v21
  s_cmpk_gt_i32 s69, 0x31
  s_cbranch_scc1 L_p34_4
  s_cmpk_gt_i32 s69, 0x1d
  s_cbranch_scc1 L_p34_3
  s_cmpk_gt_i32 s69, 0xffcd
  s_cbranch_scc1 L_p34_0
  s_waitcnt vmcnt(7)
L_p34_0:
  s_waitcnt vmcnt(8)
L_p34_3:
  s_waitcnt vmcnt(11)
L_p34_4:
  s_waitcnt vmcnt(12)
  buffer_load_dwordx4 v[76:79], v214, s[32:35], s3 offen nt
L_it14:
  s_waitcnt lgkmcnt(0)
  ds_read_b128 v[56:59], v251 offset:1536
  ds_read_b128 v[60:63], v250 offset:1536
  ds_read_b128 v[64:67], v249 offset:1536
  ds_read_b32 v4, v14 offset:16
  s_waitcnt vmcnt(8)
  s_add_u32 s44, s78, 0x03030303
  v_msad_u8 v9, s78, v36, 0
  v_msad_u8 v10, s44, v36, 0
  v_msad_u8 v9, s78, v37, v9
  v_msad_u8 v10, s44, v37, v10
  v_msad_u8 v9, s78, v38, v9
  v_msad_u8 v10, s44, v38, v10
  s_mov_b64 exec, 3
  global_store_byte v7, v8, s[30:31]
  global_load_dwordx3 v[36:38], v238, s[30:31] sc1
  v_sub_u32 v9, v9, v10
  v_add_u32 v8, 1, v8
  s_mov_b64 exec, -1
  v_readlane_b32 s66, v9, 0
  v_readlane_b32 s67, v9, 1
  s_add_u32 s78, s78, 0x01010101
  s_lshl1_add_u32 s69, s91, s95
  s_add_u32 s95, s66, s67
  s_add_u32 s69, s69, s95
  v_perm_b32 v197, v202, v200, s56
  v_perm_b32 v202, v202, v200, s57
  v_perm_b32 v200, v203, v201, s56
  v_perm_b32 v203, v203, v201, s57
  v_dot2_f32_bf16 v22, v197, v44, 0
  v_add_f32_dpp v35, v18, v18 row_ror:8 row_mask:0xf bank_mask:0xc
  v_add_f32_dpp v35, v20, v20 row_ror:8 row_mask:0xf bank_mask:0x3
  v_dot2_f32_bf16 v23, v202, v45, 0
  v_dot2_f32_bf16 v24, v200, v46, 0
  v_dot2_f32_bf16 v25, v203, v47, 0
  v_cvt_f32_i32 v92, v92
  v_cvt_f32_i32 v93, v93
  v_cvt_f32_i32 v94, v94
  v_cvt_f32_i32 v95, v95
  v_pk_mul_f32 v[20:21], v[92:93], v[22:23]
  v_pk_add_f32 v[18:19], v[22:23], v[24:25]
  v_pk_fma_f32 v[20:21], v[94:95], v[24:25], v[20:21]
  v_add_f32 v18, v18, v19
  v_add_f32 v20, v20, v21
  s_cmpk_gt_i32 s69, 0x31
  s_cbranch_scc1 L_p35_4
  s_cmpk_gt_i32 s69, 0xffed
  s_cbranch_scc1 L_p35_1
  s_waitcnt vmcnt(5)
L_p35_1:
  s_waitcnt vmcnt(9)
L_p35_4:
  s_waitcnt vmcnt(10)
  buffer_load_dwordx4 v[80:83], v215, s[32:35], s3 offen nt
  v_perm_b32 v201, v206, v204, s56
  v_perm_b32 v206, v206, v204, s57
  v_perm_b32 v204, v207, v205, s56
  v_perm_b32 v207, v207, v205, s57
  v_dot2_f32_bf16 v22, v201, v48, 0
  v_add_f32_dpp v21, v18, v18 row_ror:8 row_mask:0xf bank_mask:0xc
  v_add_f32_dpp v21, v20, v20 row_ror:8 row_mask:0xf bank_mask:0x3
  v_add_f32_dpp v20, v34, v34 row_half_mirror row_mask:0xf bank_mask:0x5
  v_dot2_f32_bf16 v23, v206, v49, 0
  v_add_f32_dpp v20, v21, v21 row_half_mirror row_mask:0xf bank_mask:0xa
  v_dot2_f32_bf16 v24, v204, v50, 0
  v_dot2_f32_bf16 v25, v207, v51, 0
  v_add_f32_dpp v20, v20, v20 quad_perm:[2,3,0,1] row_mask:0xf bank_mask:0xf
  v_cvt_f32_i32 v96, v96
  v_cvt_f32_i32 v97, v97
  v_add_f32_dpp v20, v20, v20 quad_perm:[1,0,3,2] row_mask:0xf bank_mask:0xf
  v_cndmask_b32_e64 v32, v32, v20, s[52:53]
  v_cvt_f32_i32 v98, v98
  v_cvt_f32_i32 v99, v99
  v_pk_mul_f32 v[20:21], v[96:97], v[22:23]
  v_pk_add_f32 v[18:19], v[22:23], v[24:25]
  v_pk_fma_f32 v[20:21], v[98:99], v[24:25], v[20:21]
  v_add_f32 v18, v18, v19
  v_add_f32 v20, v20, v21
  s_cmpk_gt_i32 s69, 0x31
  s_cbranch_scc1 L_p36_4
  s_cmpk_gt_i32 s69, 0xb
  s_cbranch_scc1 L_p36_2
  s_waitcnt vmcnt(6)
L_p36_2:
  s_waitcnt vmcnt(10)
L_p36_4:
  s_waitcnt vmcnt(11)
  buffer_load_dwordx4 v[84:87], v216, s[32:35], s3 offen nt
  v_perm_b32 v205, v210, v208, s56
  v_perm_b32 v210, v210, v208, s57
  v_perm_b32 v208, v211, v209, s56
  v_perm_b32 v211, v211, v209, s57
  v_dot2_f32_bf16 v22, v205, v52, 0
  v_add_f32_dpp v34, v18, v18 row_ror:8 row_mask:0xf bank_mask:0xc
  v_add_f32_dpp v34, v20, v20 row_ror:8 row_mask:0xf bank_mask:0x3
  v_dot2_f32_bf16 v23, v210, v53, 0
  v_dot2_f32_bf16 v24, v208, v54, 0
  v_dot2_f32_bf16 v25, v211, v55, 0
  v_cvt_f32_i32 v100, v100
  v_cvt_f32_i32 v101, v101
  v_cvt_f32_i32 v102, v102
  v_cvt_f32_i32 v103, v103
  v_pk_mul_f32 v[20:21], v[100:101], v[22:23]
  v_pk_add_f32 v[18:19], v[22:23], v[24:25]
  v_pk_fma_f32 v[20:21], v[102:103], v[24:25], v[20:21]
  v_add_f32 v18, v18, v19
  v_add_f32 v20, v20, v21
  s_cmpk_gt_i32 s69, 0x31
  s_cbranch_scc1 L_p37_4
  s_cmpk_gt_i32 s69, 0x1d
  s_cbranch_scc1 L_p37_3
  s_cmpk_gt_i32 s69, 0xffcd
  s_cbranch_scc1 L_p37_0
  s_waitcnt vmcnt(6)
L_p37_0:
  s_waitcnt vmcnt(7)
L_p37_3:
  s_waitcnt vmcnt(11)
L_p37_4:
  s_waitcnt vmcnt(12)
  buffer_load_dwordx4 v[88:91], v217, s[32:35], s3 offen nt
L_it15:
  s_mov_b32 s47, 3
L_fq15:
  s_waitcnt lgkmcnt(0)
  v_readfirstlane_b32 s46, v4
  s_cmp_ge_u32 s46, s47
  s_cbranch_scc1 L_fq15_ok
  s_cmp_eq_u32 s94, 0
  s_cbranch_scc1 L_fq15_ok
  s_sub_u32 s94, s94, 1
  ds_read_b32 v4, v14 offset:16
  s_branch L_fq15
L_fq15_ok:
  ds_read_b128 v[44:47], v246 offset:2560
  ds_read_b128 v[48:51], v247 offset:2560
  ds_read_b128 v[52:55], v248 offset:2560
  s_waitcnt vmcnt(7)
  s_add_u32 s44, s78, 0x03030303
  v_msad_u8 v9, s78, v40, 0
  v_msad_u8 v10, s44, v40, 0
  v_msad_u8 v9, s78, v41, v9
  v_msad_u8 v10, s44, v41, v10
  v_msad_u8 v9, s78, v42, v9
  v_msad_u8 v10, s44, v42, v10
  s_mov_b64 exec, 3
  global_store_byte v7, v8, s[30:31]
  global_load_dwordx3 v[40:42], v239, s[30:31] sc1
  v_sub_u32 v9, v9, v10
  v_add3_u32 v10, v26, v27, s58
  v_add_u32 v8, 1, v8
  s_mov_b64 exec, -1
  v_readlane_b32 s66, v9, 0
  v_readlane_b32 s67, v9, 1
  v_readlane_b32 s91, v10, 0
  s_add_u32 s78, s78, 0x01010101
  s_lshl1_add_u32 s69, s91, s95
  s_add_u32 s95, s66, s67
  s_add_u32 s69, s69, s95
  v_dot2_f32_bf16 v22, v197, v56, 0
  v_add_f32_dpp v21, v18, v18 row_ror:8 row_mask:0xf bank_mask:0xc
  v_add_f32_dpp v21, v20, v20 row_ror:8 row_mask:0xf bank_mask:0x3
  v_add_f32_dpp v20, v34, v34 row_half_mirror row_mask:0xf bank_mask:0x5
  v_dot2_f32_bf16 v23, v202, v57, 0
  v_add_f32_dpp v20, v21, v21 row_half_mirror row_mask:0xf bank_mask:0xa
  v_dot2_f32_bf16 v24, v200, v58, 0
  v_dot2_f32_bf16 v25, v203, v59, 0
  v_add_f32_dpp v20, v20, v20 quad_perm:[2,3,0,1] row_mask:0xf bank_mask:0xf
  v_cvt_f32_i32 v104, v104
  v_cvt_f32_i32 v105, v105
  v_add_f32_dpp v20, v20, v20 quad_perm:[1,0,3,2] row_mask:0xf bank_mask:0xf
  v_cndmask_b32_e64 v32, v32, v20, s[54:55]
  ds_write_b32 v17, v32 offset:0
  v_cvt_f32_i32 v106, v106
  v_cvt_f32_i32 v107, v107
  v_pk_mul_f32 v[20:21], v[104:105], v[22:23]
  v_pk_add_f32 v[18:19], v[22:23], v[24:25]
  v_pk_fma_f32 v[20:21], v[106:107], v[24:25], v[20:21]
  v_add_f32 v18, v18, v19
  v_add_f32 v20, v20, v21
  s_cmpk_gt_i32 s69, 0x31
  s_cbranch_scc1 L_p38_4
  s_cmpk_gt_i32 s69, 0xffed
  s_cbranch_scc1 L_p38_1
  s_waitcnt vmcnt(5)
L_p38_1:
  s_waitcnt vmcnt(8)
L_p38_4:
  s_waitcnt vmcnt(9)
  buffer_load_dwordx4 v[92:95], v218, s[32:35], s3 offen nt
  v_dot2_f32_bf16 v22, v201, v60, 0
  v_add_f32_dpp v21, v18, v18 row_ror:8 row_mask:0xf bank_mask:0xc
  v_add_f32_dpp v21, v20, v20 row_ror:8 row_mask:0xf bank_mask:0x3
  v_add_f32_dpp v20, v35, v35 row_half_mirror row_mask:0xf bank_mask:0x5
  v_dot2_f32_bf16 v23, v206, v61, 0
  v_add_f32_dpp v20, v21, v21 row_half_mirror row_mask:0xf bank_mask:0xa
  v_dot2_f32_bf16 v24, v204, v62, 0
  v_dot2_f32_bf16 v25, v207, v63, 0
  v_add_f32_dpp v20, v20, v20 quad_perm:[2,3,0,1] row_mask:0xf bank_mask:0xf
  v_cvt_f32_i32 v108, v108
  v_cvt_f32_i32 v109, v109
  v_add_f32_dpp v20, v20, v20 quad_perm:[1,0,3,2] row_mask:0xf bank_mask:0xf
  v_cndmask_b32_e64 v33, v33, v20, s[52:53]
  v_cvt_f32_i32 v110, v110
  v_cvt_f32_i32 v111, v111
  v_pk_mul_f32 v[20:21], v[108:109], v[22:23]
  v_pk_add_f32 v[18:19], v[22:23], v[24:25]
  v_pk_fma_f32 v[20:21], v[110:111], v[24:25], v[20:21]
  v_add_f32 v18, v18, v19
  v_add_f32 v20, v20, v21
  s_cmpk_gt_i32 s69, 0x31
  s_cbranch_scc1 L_p39_4
  s_cmpk_gt_i32 s69, 0xb
  s_cbranch_scc1 L_p39_2
  s_waitcnt vmcnt(6)
L_p39_2:
  s_waitcnt vmcnt(9)
L_p39_4:
  s_waitcnt vmcnt(10)
  buffer_load_dwordx4 v[96:99], v219, s[32:35], s3 offen nt
  v_dot2_f32_bf16 v22, v205, v64, 0
  v_add_f32_dpp v35, v18, v18 row_ror:8 row_mask:0xf bank_mask:0xc
  v_add_f32_dpp v35, v20, v20 row_ror:8 row_mask:0xf bank_mask:0x3
  v_dot2_f32_bf16 v23, v210, v65, 0
  v_dot2_f32_bf16 v24, v208, v66, 0
  v_dot2_f32_bf16 v25, v211, v67, 0
  v_cvt_f32_i32 v112, v112
  v_cvt_f32_i32 v113, v113
  v_cvt_f32_i32 v114, v114
  v_cvt_f32_i32 v115, v115
  v_pk_mul_f32 v[20:21], v[112:113], v[22:23]
  v_pk_add_f32 v[18:19], v[22:23], v[24:25]
  v_pk_fma_f32 v[20:21], v[114:115], v[24:25], v[20:21]
  v_add_f32 v18, v18, v19
  v_add_f32 v20, v20, v21
  s_cmpk_gt_i32 s69, 0x31
  s_cbranch_scc1 L_p40_4
  s_cmpk_gt_i32 s69, 0x1d
  s_cbranch_scc1 L_p40_3
  s_cmpk_gt_i32 s69, 0xffcd
  s_cbranch_scc1 L_p40_0
  s_waitcnt vmcnt(6)
L_p40_0:
  s_waitcnt vmcnt(7)
L_p40_3:
  s_waitcnt vmcnt(10)
L_p40_4:
  s_waitcnt vmcnt(11)
  buffer_load_dwordx4 v[100:103], v220, s[32:35], s3 offen nt
  s_nop 0
  v_add_f32_dpp v21, v18, v18 row_ror:8 row_mask:0xf bank_mask:0xc
  v_add_f32_dpp v21, v20, v20 row_ror:8 row_mask:0xf bank_mask:0x3
  v_add_f32_dpp v20, v35, v35 row_half_mirror row_mask:0xf bank_mask:0x5
  s_nop 0
  v_add_f32_dpp v20, v21, v21 row_half_mirror row_mask:0xf bank_mask:0xa
  s_nop 1
  v_add_f32_dpp v20, v20, v20 quad_perm:[2,3,0,1] row_mask:0xf bank_mask:0xf
  s_nop 1
  v_add_f32_dpp v20, v20, v20 quad_perm:[1,0,3,2] row_mask:0xf bank_mask:0xf
  v_cndmask_b32_e64 v33, v33, v20, s[54:55]
  ds_write_b32 v17, v33 offset:3072
  v_mov_b32 v9, 2
  ds_write_b32 v6, v9 offset:0
  ds_read_b128 v[56:59], v249 offset:2560
  ds_read_b128 v[60:63], v250 offset:2560
  ds_read_b128 v[64:67], v251 offset:2560
  s_movk_i32 s59, 2048
  s_mov_b32 s43, 2
  s_movk_i32 s101, 6144
  s_mov_b32 s34, 1572864
  s_add_u32 s32, s32, s3
  s_addc_u32 s33, s33, 0
  s_mov_b32 s68, 3
  s_lshl_b32 s44, s68, 2
  s_lshr_b64 s[64:65], s[96:97], s44
  s_and_b32 s64, s64, 15
  s_lshl4_add_u32 s68, s68, s64
  s_mul_i32 s44, s68, 1572864
  s_add_u32 s36, s6, s44
  s_addc_u32 s37, s7, 0
.p2align 6
L_k:
  s_add_u32 s44, s43, 2
  s_min_u32 s47, s44, 16
  s_addk_i32 s59, 1024
  s_and_b32 s59, s59, 0xfff
  s_waitcnt lgkmcnt(0)
  s_waitcnt vmcnt(8)
  s_add_u32 s44, s78, 0x03030303
  v_msad_u8 v9, s78, v36, 0
  v_msad_u8 v10, s44, v36, 0
  v_msad_u8 v9, s78, v37, v9
  v_msad_u8 v10, s44, v37, v10
  v_msad_u8 v9, s78, v38, v9
  v_msad_u8 v10, s44, v38, v10
  s_mov_b64 exec, 3
  global_store_byte v7, v8, s[30:31]
  global_load_dwordx3 v[36:38], v236, s[30:31] sc1
  v_sub_u32 v9, v9, v10
  v_add_u32 v8, 1, v8
  s_mov_b64 exec, -1
  v_readlane_b32 s66, v9, 0
  v_readlane_b32 s67, v9, 1
  s_add_u32 s78, s78, 0x01010101
  s_lshl1_add_u32 s69, s91, s95
  s_add_u32 s95, s66, s67
  s_add_u32 s69, s69, s95
  v_dot2_f32_bf16 v22, v13, v44, 0
  v_dot2_f32_bf16 v23, v118, v45, 0
  v_dot2_f32_bf16 v24, v116, v46, 0
  v_dot2_f32_bf16 v25, v119, v47, 0
  v_cvt_f32_i32 v68, v68
  v_cvt_f32_i32 v69, v69
  v_cvt_f32_i32 v70, v70
  v_cvt_f32_i32 v71, v71
  v_pk_mul_f32 v[20:21], v[68:69], v[22:23]
  v_pk_add_f32 v[18:19], v[22:23], v[24:25]
  v_pk_fma_f32 v[20:21], v[70:71], v[24:25], v[20:21]
  v_add_f32 v18, v18, v19
  v_add_f32 v20, v20, v21
  s_cmpk_gt_i32 s69, 0x29
  s_cbranch_scc1 L_p41_4
  s_cmpk_gt_i32 s69, 0xffe5
  s_cbranch_scc1 L_p41_1
  s_waitcnt vmcnt(5)
L_p41_1:
  s_waitcnt vmcnt(8)
L_p41_4:
  s_waitcnt vmcnt(9)
  buffer_load_dwordx4 v[104:107], v221, s[32:35], 0 offen nt
  v_dot2_f32_bf16 v22, v117, v52, 0
  v_add_f32_dpp v34, v18, v18 row_ror:8 row_mask:0xf bank_mask:0xc
  v_add_f32_dpp v34, v20, v20 row_ror:8 row_mask:0xf bank_mask:0x3
  v_dot2_f32_bf16 v23, v122, v53, 0
  v_dot2_f32_bf16 v24, v120, v54, 0
  v_dot2_f32_bf16 v25, v123, v55, 0
  v_cvt_f32_i32 v72, v72
  v_cvt_f32_i32 v73, v73
  v_cvt_f32_i32 v74, v74
  v_cvt_f32_i32 v75, v75
  v_pk_mul_f32 v[20:21], v[72:73], v[22:23]
  v_pk_add_f32 v[18:19], v[22:23], v[24:25]
  v_pk_fma_f32 v[20:21], v[74:75], v[24:25], v[20:21]
  v_add_f32 v18, v18, v19
  v_add_f32 v20, v20, v21
  s_cmpk_gt_i32 s69, 0x29
  s_cbranch_scc1 L_p42_4
  s_cmpk_gt_i32 s69, 0x3
  s_cbranch_scc1 L_p42_2
  s_waitcnt vmcnt(6)
L_p42_2:
  s_waitcnt vmcnt(9)
L_p42_4:
  s_waitcnt vmcnt(10)
  buffer_load_dwordx4 v[108:111], v222, s[32:35], 0 offen nt
  v_dot2_f32_bf16 v22, v121, v48, 0
  v_add_f32_dpp v21, v18, v18 row_ror:8 row_mask:0xf bank_mask:0xc
  v_add_f32_dpp v21, v20, v20 row_ror:8 row_mask:0xf bank_mask:0x3
  v_add_f32_dpp v20, v34, v34 row_half_mirror row_mask:0xf bank_mask:0x5
  v_dot2_f32_bf16 v23, v126, v49, 0
  v_add_f32_dpp v20, v21, v21 row_half_mirror row_mask:0xf bank_mask:0xa
  v_dot2_f32_bf16 v24, v124, v50, 0
  v_dot2_f32_bf16 v25, v127, v51, 0
  v_add_f32_dpp v20, v20, v20 quad_perm:[2,3,0,1] row_mask:0xf bank_mask:0xf
  v_cvt_f32_i32 v76, v76
  v_cvt_f32_i32 v77, v77
  v_add_f32_dpp v20, v20, v20 quad_perm:[1,0,3,2] row_mask:0xf bank_mask:0xf
  v_cndmask_b32_e64 v32, v32, v20, s[48:49]
  v_cvt_f32_i32 v78, v78
  v_cvt_f32_i32 v79, v79
  v_pk_mul_f32 v[20:21], v[76:77], v[22:23]
  v_pk_add_f32 v[18:19], v[22:23], v[24:25]
  v_pk_fma_f32 v[20:21], v[78:79], v[24:25], v[20:21]
  v_add_f32 v18, v18, v19
  v_add_f32 v20, v20, v21
  s_cmpk_gt_i32 s69, 0x29
  s_cbranch_scc1 L_p43_4
  s_cmpk_gt_i32 s69, 0x15
  s_cbranch_scc1 L_p43_3
  s_cmpk_gt_i32 s69, 0xffc5
  s_cbranch_scc1 L_p43_0
  s_waitcnt vmcnt(6)
L_p43_0:
  s_waitcnt vmcnt(7)
L_p43_3:
  s_waitcnt vmcnt(10)
L_p43_4:
  s_waitcnt vmcnt(11)
  buffer_load_dwordx4 v[112:115], v223, s[32:35], 0 offen nt
  s_waitcnt vmcnt(8)
  s_add_u32 s44, s78, 0x03030303
  v_msad_u8 v9, s78, v40, 0
  v_msad_u8 v10, s44, v40, 0
  v_msad_u8 v9, s78, v41, v9
  v_msad_u8 v10, s44, v41, v10
  v_msad_u8 v9, s78, v42, v9
  v_msad_u8 v10, s44, v42, v10
  s_mov_b64 exec, 3
  global_store_byte v7, v8, s[30:31]
  global_load_dwordx3 v[40:42], v237, s[30:31] sc1
  v_sub_u32 v9, v9, v10
  v_add_u32 v8, 1, v8
  s_mov_b64 exec, -1
  v_readlane_b32 s66, v9, 0
  v_readlane_b32 s67, v9, 1
  s_add_u32 s78, s78, 0x01010101
  s_lshl1_add_u32 s69, s91, s95
  s_add_u32 s95, s66, s67
  s_add_u32 s69, s69, s95
  v_dot2_f32_bf16 v22, v125, v44, 0
  v_add_f32_dpp v34, v18, v18 row_ror:8 row_mask:0xf bank_mask:0xc
  v_add_f32_dpp v34, v20, v20 row_ror:8 row_mask:0xf bank_mask:0x3
  v_dot2_f32_bf16 v23, v130, v45, 0
  v_dot2_f32_bf16 v24, v128, v46, 0
  v_dot2_f32_bf16 v25, v131, v47, 0
  v_cvt_f32_i32 v80, v80
  v_cvt_f32_i32 v81, v81
  v_cvt_f32_i32 v82, v82
  v_cvt_f32_i32 v83, v83
  v_pk_mul_f32 v[20:21], v[80:81], v[22:23]
  v_pk_add_f32 v[18:19], v[22:23], v[24:25]
  v_pk_fma_f32 v[20:21], v[82:83], v[24:25], v[20:21]
  v_add_f32 v18, v18, v19
  v_add_f32 v20, v20, v21
  s_cmpk_gt_i32 s69, 0x29
  s_cbranch_scc1 L_p44_4
  s_cmpk_gt_i32 s69, 0xffe5
  s_cbranch_scc1 L_p44_1
  s_waitcnt vmcnt(5)
L_p44_1:
  s_waitcnt vmcnt(8)
L_p44_4:
  s_waitcnt vmcnt(9)
  buffer_load_dwordx4 v[68:71], v224, s[32:35], 0 offen nt
  v_dot2_f32_bf16 v22, v129, v60, 0
  v_add_f32_dpp v21, v18, v18 row_ror:8 row_mask:0xf bank_mask:0xc
  v_add_f32_dpp v21, v20, v20 row_ror:8 row_mask:0xf bank_mask:0x3
  v_add_f32_dpp v20, v34, v34 row_half_mirror row_mask:0xf bank_mask:0x5
  v_dot2_f32_bf16 v23, v134, v61, 0
  v_add_f32_dpp v20, v21, v21 row_half_mirror row_mask:0xf bank_mask:0xa
  v_dot2_f32_bf16 v24, v132, v62, 0
  v_dot2_f32_bf16 v25, v135, v63, 0
  v_add_f32_dpp v20, v20, v20 quad_perm:[2,3,0,1] row_mask:0xf bank_mask:0xf
  v_cvt_f32_i32 v84, v84
  v_cvt_f32_i32 v85, v85
  v_add_f32_dpp v20, v20, v20 quad_perm:[1,0,3,2] row_mask:0xf bank_mask:0xf
  v_cndmask_b32_e64 v32, v32, v20, s[50:51]
  v_cvt_f32_i32 v86, v86
  v_cvt_f32_i32 v87, v87
  v_pk_mul_f32 v[20:21], v[84:85], v[22:23]
  v_pk_add_f32 v[18:19], v[22:23], v[24:25]
  v_pk_fma_f32 v[20:21], v[86:87], v[24:25], v[20:21]
  v_add_f32 v18, v18, v19
  v_add_f32 v20, v20, v21
  s_cmpk_gt_i32 s69, 0x29
  s_cbranch_scc1 L_p45_4
  s_cmpk_gt_i32 s69, 0x3
  s_cbranch_scc1 L_p45_2
  s_waitcnt vmcnt(6)
L_p45_2:
  s_waitcnt vmcnt(9)
L_p45_4:
  s_waitcnt vmcnt(10)
  buffer_load_dwordx4 v[72:75], v225, s[32:35], 0 offen nt
  v_dot2_f32_bf16 v22, v133, v56, 0
  v_add_f32_dpp v34, v18, v18 row_ror:8 row_mask:0xf bank_mask:0xc
  v_add_f32_dpp v34, v20, v20 row_ror:8 row_mask:0xf bank_mask:0x3
  v_dot2_f32_bf16 v23, v138, v57, 0
  v_dot2_f32_bf16 v24, v136, v58, 0
  v_dot2_f32_bf16 v25, v139, v59, 0
  v_cvt_f32_i32 v88, v88
  v_cvt_f32_i32 v89, v89
  v_cvt_f32_i32 v90, v90
  v_cvt_f32_i32 v91, v91
  v_pk_mul_f32 v[20:21], v[88:89], v[22:23]
  v_pk_add_f32 v[18:19], v[22:23], v[24:25]
  v_pk_fma_f32 v[20:21], v[90:91], v[24:25], v[20:21]
  v_add_f32 v18, v18, v19
  v_add_f32 v20, v20, v21
  s_cmpk_gt_i32 s69, 0x29
  s_cbranch_scc1 L_p46_4
  s_cmpk_gt_i32 s69, 0x15
  s_cbranch_scc1 L_p46_3
  s_cmpk_gt_i32 s69, 0xffc5
  s_cbranch_scc1 L_p46_0
  s_waitcnt vmcnt(6)
L_p46_0:
  s_waitcnt vmcnt(7)
L_p46_3:
  s_waitcnt vmcnt(10)
L_p46_4:
  s_waitcnt vmcnt(11)
  buffer_load_dwordx4 v[76:79], v226, s[32:35], 0 offen nt
  v_mov_b32 v9, s43
  ds_write_b32 v14, v9 offset:28
  s_waitcnt vmcnt(8)
  s_add_u32 s44, s78, 0x03030303
  v_msad_u8 v9, s78, v36, 0
  v_msad_u8 v10, s44, v36, 0
  v_msad_u8 v9, s78, v37, v9
  v_msad_u8 v10, s44, v37, v10
  v_msad_u8 v9, s78, v38, v9
  v_msad_u8 v10, s44, v38, v10
  s_mov_b64 exec, 3
  global_store_byte v7, v8, s[30:31]
  global_load_dwordx3 v[36:38], v238, s[30:31] sc1
  v_sub_u32 v9, v9, v10
  v_add_u32 v8, 1, v8
  s_mov_b64 exec, -1
  v_readlane_b32 s66, v9, 0
  v_readlane_b32 s67, v9, 1
  s_add_u32 s78, s78, 0x01010101
  s_lshl1_add_u32 s69, s91, s95
  s_add_u32 s95, s66, s67
  s_add_u32 s69, s69, s95
  v_dot2_f32_bf16 v22, v137, v64, 0
  v_add_f32_dpp v21, v18, v18 row_ror:8 row_mask:0xf bank_mask:0xc
  v_add_f32_dpp v21, v20, v20 row_ror:8 row_mask:0xf bank_mask:0x3
  v_add_f32_dpp v20, v34, v34 row_half_mirror row_mask:0xf bank_mask:0x5
  v_dot2_f32_bf16 v23, v142, v65, 0
  v_add_f32_dpp v20, v21, v21 row_half_mirror row_mask:0xf bank_mask:0xa
  v_dot2_f32_bf16 v24, v140, v66, 0
  v_dot2_f32_bf16 v25, v143, v67, 0
  v_add_f32_dpp v20, v20, v20 quad_perm:[2,3,0,1] row_mask:0xf bank_mask:0xf
  v_cvt_f32_i32 v92, v92
  v_cvt_f32_i32 v93, v93
  v_add_f32_dpp v20, v20, v20 quad_perm:[1,0,3,2] row_mask:0xf bank_mask:0xf
  v_cndmask_b32_e64 v32, v32, v20, s[52:53]
  v_cvt_f32_i32 v94, v94
  v_cvt_f32_i32 v95, v95
  v_pk_mul_f32 v[20:21], v[92:93], v[22:23]
  v_pk_add_f32 v[18:19], v[22:23], v[24:25]
  v_pk_fma_f32 v[20:21], v[94:95], v[24:25], v[20:21]
  v_add_f32 v18, v18, v19
  v_add_f32 v20, v20, v21
  s_cmpk_gt_i32 s69, 0x29
  s_cbranch_scc1 L_p47_4
  s_cmpk_gt_i32 s69, 0xffe5
  s_cbranch_scc1 L_p47_1
  s_waitcnt vmcnt(5)
L_p47_1:
  s_waitcnt vmcnt(8)
L_p47_4:
  s_waitcnt vmcnt(9)
  buffer_load_dwordx4 v[80:83], v227, s[32:35], 0 offen nt
  v_dot2_f32_bf16 v22, v141, v60, 0
  v_add_f32_dpp v34, v18, v18 row_ror:8 row_mask:0xf bank_mask:0xc
  v_add_f32_dpp v34, v20, v20 row_ror:8 row_mask:0xf bank_mask:0x3
  v_dot2_f32_bf16 v23, v146, v61, 0
  v_dot2_f32_bf16 v24, v144, v62, 0
  v_dot2_f32_bf16 v25, v147, v63, 0
  v_cvt_f32_i32 v96, v96
  v_cvt_f32_i32 v97, v97
  v_cvt_f32_i32 v98, v98
  v_cvt_f32_i32 v99, v99
  v_pk_mul_f32 v[20:21], v[96:97], v[22:23]
  v_pk_add_f32 v[18:19], v[22:23], v[24:25]
  v_pk_fma_f32 v[20:21], v[98:99], v[24:25], v[20:21]
  v_add_f32 v18, v18, v19
  v_add_f32 v20, v20, v21
  s_cmpk_gt_i32 s69, 0x29
  s_cbranch_scc1 L_p48_4
  s_cmpk_gt_i32 s69, 0x3
  s_cbranch_scc1 L_p48_2
  s_waitcnt vmcnt(6)
L_p48_2:
  s_waitcnt vmcnt(9)
L_p48_4:
  s_waitcnt vmcnt(10)
  buffer_load_dwordx4 v[84:87], v228, s[32:35], 0 offen nt
  v_dot2_f32_bf16 v22, v145, v48, 0
  v_add_f32_dpp v21, v18, v18 row_ror:8 row_mask:0xf bank_mask:0xc
  v_add_f32_dpp v21, v20, v20 row_ror:8 row_mask:0xf bank_mask:0x3
  v_add_f32_dpp v20, v34, v34 row_half_mirror row_mask:0xf bank_mask:0x5
  v_dot2_f32_bf16 v23, v150, v49, 0
  v_add_f32_dpp v20, v21, v21 row_half_mirror row_mask:0xf bank_mask:0xa
  v_dot2_f32_bf16 v24, v148, v50, 0
  v_dot2_f32_bf16 v25, v151, v51, 0
  v_add_f32_dpp v20, v20, v20 quad_perm:[2,3,0,1] row_mask:0xf bank_mask:0xf
  v_cvt_f32_i32 v100, v100
  v_cvt_f32_i32 v101, v101
  v_add_f32_dpp v20, v20, v20 quad_perm:[1,0,3,2] row_mask:0xf bank_mask:0xf
  v_cndmask_b32_e64 v32, v32, v20, s[54:55]
  v_add_u32 v2, s101, v15
  ds_write_b32 v2, v32
  v_cvt_f32_i32 v102, v102
  v_cvt_f32_i32 v103, v103
  v_pk_mul_f32 v[20:21], v[100:101], v[22:23]
  v_pk_add_f32 v[18:19], v[22:23], v[24:25]
  v_pk_fma_f32 v[20:21], v[102:103], v[24:25], v[20:21]
  v_add_f32 v18, v18, v19
  v_add_f32 v20, v20, v21
  s_cmpk_gt_i32 s69, 0x29
  s_cbranch_scc1 L_p49_4
  s_cmpk_gt_i32 s69, 0x15
  s_cbranch_scc1 L_p49_3
  s_cmpk_gt_i32 s69, 0xffc5
  s_cbranch_scc1 L_p49_0
  s_waitcnt vmcnt(6)
L_p49_0:
  s_waitcnt vmcnt(7)
L_p49_3:
  s_waitcnt vmcnt(10)
L_p49_4:
  s_waitcnt vmcnt(11)
  buffer_load_dwordx4 v[88:91], v229, s[32:35], 0 offen nt
  s_waitcnt vmcnt(8)
  s_add_u32 s44, s78, 0x03030303
  v_msad_u8 v9, s78, v40, 0
  v_msad_u8 v10, s44, v40, 0
  v_msad_u8 v9, s78, v41, v9
  v_msad_u8 v10, s44, v41, v10
  v_msad_u8 v9, s78, v42, v9
  v_msad_u8 v10, s44, v42, v10
  s_mov_b64 exec, 3
  global_store_byte v7, v8, s[30:31]
  global_load_dwordx3 v[40:42], v239, s[30:31] sc1
  v_sub_u32 v9, v9, v10
  v_add_u32 v8, 1, v8
  s_mov_b64 exec, -1
  v_readlane_b32 s66, v9, 0
  v_readlane_b32 s67, v9, 1
  s_add_u32 s78, s78, 0x01010101
  s_lshl1_add_u32 s69, s91, s95
  s_add_u32 s95, s66, s67
  s_add_u32 s69, s69, s95
  v_dot2_f32_bf16 v22, v149, v44, 0
  v_add_f32_dpp v34, v18, v18 row_ror:8 row_mask:0xf bank_mask:0xc
  v_add_f32_dpp v34, v20, v20 row_ror:8 row_mask:0xf bank_mask:0x3
  v_dot2_f32_bf16 v23, v154, v45, 0
  v_dot2_f32_bf16 v24, v152, v46, 0
  v_dot2_f32_bf16 v25, v155, v47, 0
  v_cvt_f32_i32 v104, v104
  v_cvt_f32_i32 v105, v105
  v_cvt_f32_i32 v106, v106
  v_cvt_f32_i32 v107, v107
  v_pk_mul_f32 v[20:21], v[104:105], v[22:23]
  v_pk_add_f32 v[18:19], v[22:23], v[24:25]
  v_pk_fma_f32 v[20:21], v[106:107], v[24:25], v[20:21]
  v_add_f32 v18, v18, v19
  v_add_f32 v20, v20, v21
  s_cmpk_gt_i32 s69, 0x29
  s_cbranch_scc1 L_p50_4
  s_cmpk_gt_i32 s69, 0xffe5
  s_cbranch_scc1 L_p50_1
  s_waitcnt vmcnt(5)
L_p50_1:
  s_waitcnt vmcnt(8)
L_p50_4:
  s_waitcnt vmcnt(9)
  buffer_load_dwordx4 v[92:95], v230, s[32:35], 0 offen nt
  v_dot2_f32_bf16 v22, v153, v52, 0
  v_add_f32_dpp v21, v18, v18 row_ror:8 row_mask:0xf bank_mask:0xc
  v_add_f32_dpp v21, v20, v20 row_ror:8 row_mask:0xf bank_mask:0x3
  v_add_f32_dpp v20, v34, v34 row_half_mirror row_mask:0xf bank_mask:0x5
  v_dot2_f32_bf16 v23, v158, v53, 0
  v_add_f32_dpp v20, v21, v21 row_half_mirror row_mask:0xf bank_mask:0xa
  v_dot2_f32_bf16 v24, v156, v54, 0
  v_dot2_f32_bf16 v25, v159, v55, 0
  v_add_f32_dpp v20, v20, v20 quad_perm:[2,3,0,1] row_mask:0xf bank_mask:0xf
  v_cvt_f32_i32 v108, v108
  v_cvt_f32_i32 v109, v109
  v_add_f32_dpp v20, v20, v20 quad_perm:[1,0,3,2] row_mask:0xf bank_mask:0xf
  v_cndmask_b32_e64 v32, v32, v20, s[48:49]
  v_cvt_f32_i32 v110, v110
  v_cvt_f32_i32 v111, v111
  v_pk_mul_f32 v[20:21], v[108:109], v[22:23]
  v_pk_add_f32 v[18:19], v[22:23], v[24:25]
  v_pk_fma_f32 v[20:21], v[110:111], v[24:25], v[20:21]
  v_add_f32 v18, v18, v19
  v_add_f32 v20, v20, v21
  s_cmpk_gt_i32 s69, 0x29
  s_cbranch_scc1 L_p51_4
  s_cmpk_gt_i32 s69, 0x3
  s_cbranch_scc1 L_p51_2
  s_waitcnt vmcnt(6)
L_p51_2:
  s_waitcnt vmcnt(9)
L_p51_4:
  s_waitcnt vmcnt(10)
  buffer_load_dwordx4 v[96:99], v231, s[32:35], 0 offen nt
  v_dot2_f32_bf16 v22, v157, v48, 0
  v_add_f32_dpp v34, v18, v18 row_ror:8 row_mask:0xf bank_mask:0xc
  v_add_f32_dpp v34, v20, v20 row_ror:8 row_mask:0xf bank_mask:0x3
  v_dot2_f32_bf16 v23, v162, v49, 0
  v_dot2_f32_bf16 v24, v160, v50, 0
  v_dot2_f32_bf16 v25, v163, v51, 0
  v_cvt_f32_i32 v112, v112
  v_cvt_f32_i32 v113, v113
  v_cvt_f32_i32 v114, v114
  v_cvt_f32_i32 v115, v115
  v_pk_mul_f32 v[20:21], v[112:113], v[22:23]
  v_pk_add_f32 v[18:19], v[22:23], v[24:25]
  v_pk_fma_f32 v[20:21], v[114:115], v[24:25], v[20:21]
  v_add_f32 v18, v18, v19
  v_add_f32 v20, v20, v21
  s_cmpk_gt_i32 s69, 0x29
  s_cbranch_scc1 L_p52_4
  s_cmpk_gt_i32 s69, 0x15
  s_cbranch_scc1 L_p52_3
  s_cmpk_gt_i32 s69, 0xffc5
  s_cbranch_scc1 L_p52_0
  s_waitcnt vmcnt(6)
L_p52_0:
  s_waitcnt vmcnt(7)
L_p52_3:
  s_waitcnt vmcnt(10)
L_p52_4:
  s_waitcnt vmcnt(11)
  buffer_load_dwordx4 v[100:103], v232, s[32:35], 0 offen nt
  s_waitcnt vmcnt(8)
  s_add_u32 s44, s78, 0x03030303
  v_msad_u8 v9, s78, v36, 0
  v_msad_u8 v10, s44, v36, 0
  v_msad_u8 v9, s78, v37, v9
  v_msad_u8 v10, s44, v37, v10
  v_msad_u8 v9, s78, v38, v9
  v_msad_u8 v10, s44, v38, v10
  s_mov_b64 exec, 3
  global_store_byte v7, v8, s[30:31]
  global_load_dwordx3 v[36:38], v236, s[30:31] sc1
  v_sub_u32 v9, v9, v10
  v_add_u32 v8, 1, v8
  s_mov_b64 exec, -1
  v_readlane_b32 s66, v9, 0
  v_readlane_b32 s67, v9, 1
  s_add_u32 s78, s78, 0x01010101
  s_lshl1_add_u32 s69, s91, s95
  s_add_u32 s95, s66, s67
  s_add_u32 s69, s69, s95
  v_dot2_f32_bf16 v22, v161, v64, 0
  v_add_f32_dpp v21, v18, v18 row_ror:8 row_mask:0xf bank_mask:0xc
  v_add_f32_dpp v21, v20, v20 row_ror:8 row_mask:0xf bank_mask:0x3
  v_add_f32_dpp v20, v34, v34 row_half_mirror row_mask:0xf bank_mask:0x5
  v_dot2_f32_bf16 v23, v166, v65, 0
  v_add_f32_dpp v20, v21, v21 row_half_mirror row_mask:0xf bank_mask:0xa
  v_dot2_f32_bf16 v24, v164, v66, 0
  v_dot2_f32_bf16 v25, v167, v67, 0
  v_add_f32_dpp v20, v20, v20 quad_perm:[2,3,0,1] row_mask:0xf bank_mask:0xf
  v_cvt_f32_i32 v68, v68
  v_cvt_f32_i32 v69, v69
  v_add_f32_dpp v20, v20, v20 quad_perm:[1,0,3,2] row_mask:0xf bank_mask:0xf
  v_cndmask_b32_e64 v32, v32, v20, s[50:51]
  v_cvt_f32_i32 v70, v70
  v_cvt_f32_i32 v71, v71
  v_pk_mul_f32 v[20:21], v[68:69], v[22:23]
  v_pk_add_f32 v[18:19], v[22:23], v[24:25]
  v_pk_fma_f32 v[20:21], v[70:71], v[24:25], v[20:21]
  v_add_f32 v18, v18, v19
  v_add_f32 v20, v20, v21
  s_cmpk_gt_i32 s69, 0x29
  s_cbranch_scc1 L_p53_4
  s_cmpk_gt_i32 s69, 0xffe5
  s_cbranch_scc1 L_p53_1
  s_waitcnt vmcnt(5)
L_p53_1:
  s_waitcnt vmcnt(8)
L_p53_4:
  s_waitcnt vmcnt(9)
  buffer_load_dwordx4 v[104:107], v233, s[32:35], 0 offen nt
  v_dot2_f32_bf16 v22, v165, v60, 0
  v_add_f32_dpp v34, v18, v18 row_ror:8 row_mask:0xf bank_mask:0xc
  v_add_f32_dpp v34, v20, v20 row_ror:8 row_mask:0xf bank_mask:0x3
  v_dot2_f32_bf16 v23, v170, v61, 0
  v_dot2_f32_bf16 v24, v168, v62, 0
  v_dot2_f32_bf16 v25, v171, v63, 0
  v_cvt_f32_i32 v72, v72
  v_cvt_f32_i32 v73, v73
  v_cvt_f32_i32 v74, v74
  v_cvt_f32_i32 v75, v75
  v_pk_mul_f32 v[20:21], v[72:73], v[22:23]
  v_pk_add_f32 v[18:19], v[22:23], v[24:25]
  v_pk_fma_f32 v[20:21], v[74:75], v[24:25], v[20:21]
  v_add_f32 v18, v18, v19
  v_add_f32 v20, v20, v21
  s_cmpk_gt_i32 s69, 0x29
  s_cbranch_scc1 L_p54_4
  s_cmpk_gt_i32 s69, 0x3
  s_cbranch_scc1 L_p54_2
  s_waitcnt vmcnt(6)
L_p54_2:
  s_waitcnt vmcnt(9)
L_p54_4:
  s_waitcnt vmcnt(10)
  buffer_load_dwordx4 v[108:111], v234, s[32:35], 0 offen nt
  v_dot2_f32_bf16 v22, v169, v56, 0
  v_add_f32_dpp v21, v18, v18 row_ror:8 row_mask:0xf bank_mask:0xc
  v_add_f32_dpp v21, v20, v20 row_ror:8 row_mask:0xf bank_mask:0x3
  v_add_f32_dpp v20, v34, v34 row_half_mirror row_mask:0xf bank_mask:0x5
  v_dot2_f32_bf16 v23, v174, v57, 0
  v_add_f32_dpp v20, v21, v21 row_half_mirror row_mask:0xf bank_mask:0xa
  v_dot2_f32_bf16 v24, v172, v58, 0
  v_dot2_f32_bf16 v25, v175, v59, 0
  v_add_f32_dpp v20, v20, v20 quad_perm:[2,3,0,1] row_mask:0xf bank_mask:0xf
  v_cvt_f32_i32 v76, v76
  v_cvt_f32_i32 v77, v77
  v_add_f32_dpp v20, v20, v20 quad_perm:[1,0,3,2] row_mask:0xf bank_mask:0xf
  v_cndmask_b32_e64 v32, v32, v20, s[52:53]
  v_cvt_f32_i32 v78, v78
  v_cvt_f32_i32 v79, v79
  v_pk_mul_f32 v[20:21], v[76:77], v[22:23]
  v_pk_add_f32 v[18:19], v[22:23], v[24:25]
  v_pk_fma_f32 v[20:21], v[78:79], v[24:25], v[20:21]
  v_add_f32 v18, v18, v19
  v_add_f32 v20, v20, v21
  s_cmpk_gt_i32 s69, 0x29
  s_cbranch_scc1 L_p55_4
  s_cmpk_gt_i32 s69, 0x15
  s_cbranch_scc1 L_p55_3
  s_cmpk_gt_i32 s69, 0xffc5
  s_cbranch_scc1 L_p55_0
  s_waitcnt vmcnt(6)
L_p55_0:
  s_waitcnt vmcnt(7)
L_p55_3:
  s_waitcnt vmcnt(10)
L_p55_4:
  s_waitcnt vmcnt(11)
  buffer_load_dwordx4 v[112:115], v235, s[32:35], 0 offen nt
  s_waitcnt vmcnt(8)
  s_add_u32 s44, s78, 0x03030303
  v_msad_u8 v9, s78, v40, 0
  v_msad_u8 v10, s44, v40, 0
  v_msad_u8 v9, s78, v41, v9
  v_msad_u8 v10, s44, v41, v10
  v_msad_u8 v9, s78, v42, v9
  v_msad_u8 v10, s44, v42, v10
  s_mov_b64 exec, 3
  global_load_dwordx2 v[26:27], v11, s[30:31] sc1
  global_store_byte v7, v8, s[30:31]
  global_load_dwordx3 v[40:42], v237, s[30:31] sc1
  v_sub_u32 v9, v9, v10
  v_add_u32 v8, 1, v8
  s_mov_b64 exec, -1
  v_readlane_b32 s66, v9, 0
  v_readlane_b32 s67, v9, 1
  s_add_u32 s78, s78, 0x01010101
  s_lshl1_add_u32 s69, s91, s95
  s_add_u32 s95, s66, s67
  s_add_u32 s69, s69, s95
  v_dot2_f32_bf16 v22, v173, v64, 0
  v_add_f32_dpp v34, v18, v18 row_ror:8 row_mask:0xf bank_mask:0xc
  v_add_f32_dpp v34, v20, v20 row_ror:8 row_mask:0xf bank_mask:0x3
  v_dot2_f32_bf16 v23, v178, v65, 0
  v_dot2_f32_bf16 v24, v176, v66, 0
  v_dot2_f32_bf16 v25, v179, v67, 0
  v_cvt_f32_i32 v80, v80
  v_cvt_f32_i32 v81, v81
  v_cvt_f32_i32 v82, v82
  v_cvt_f32_i32 v83, v83
  v_pk_mul_f32 v[20:21], v[80:81], v[22:23]
  v_pk_add_f32 v[18:19], v[22:23], v[24:25]
  v_pk_fma_f32 v[20:21], v[82:83], v[24:25], v[20:21]
  v_add_f32 v18, v18, v19
  v_add_f32 v20, v20, v21
  s_cmpk_gt_i32 s69, 0x29
  s_cbranch_scc1 L_p56_4
  s_cmpk_gt_i32 s69, 0xffe5
  s_cbranch_scc1 L_p56_1
  s_waitcnt vmcnt(6)
L_p56_1:
  s_waitcnt vmcnt(9)
L_p56_4:
  s_waitcnt vmcnt(10)
  buffer_load_dwordx4 v[68:71], v212, s[36:39], 0 offen nt
  v_dot2_f32_bf16 v22, v177, v52, 0
  v_add_f32_dpp v21, v18, v18 row_ror:8 row_mask:0xf bank_mask:0xc
  v_add_f32_dpp v21, v20, v20 row_ror:8 row_mask:0xf bank_mask:0x3
  v_add_f32_dpp v20, v34, v34 row_half_mirror row_mask:0xf bank_mask:0x5
  v_dot2_f32_bf16 v23, v182, v53, 0
  v_add_f32_dpp v20, v21, v21 row_half_mirror row_mask:0xf bank_mask:0xa
  v_dot2_f32_bf16 v24, v180, v54, 0
  v_dot2_f32_bf16 v25, v183, v55, 0
  v_add_f32_dpp v20, v20, v20 quad_perm:[2,3,0,1] row_mask:0xf bank_mask:0xf
  v_cvt_f32_i32 v84, v84
  v_cvt_f32_i32 v85, v85
  v_add_f32_dpp v20, v20, v20 quad_perm:[1,0,3,2] row_mask:0xf bank_mask:0xf
  v_cndmask_b32_e64 v32, v32, v20, s[54:55]
  v_add_u32 v2, s101, v16
  ds_write_b32 v2, v32
  v_cvt_f32_i32 v86, v86
  v_cvt_f32_i32 v87, v87
  v_pk_mul_f32 v[20:21], v[84:85], v[22:23]
  v_pk_add_f32 v[18:19], v[22:23], v[24:25]
  v_pk_fma_f32 v[20:21], v[86:87], v[24:25], v[20:21]
  v_add_f32 v18, v18, v19
  v_add_f32 v20, v20, v21
  s_cmpk_gt_i32 s69, 0x29
  s_cbranch_scc1 L_p57_4
  s_cmpk_gt_i32 s69, 0x3
  s_cbranch_scc1 L_p57_2
  s_waitcnt vmcnt(7)
L_p57_2:
  s_waitcnt vmcnt(10)
L_p57_4:
  s_waitcnt vmcnt(11)
  buffer_load_dwordx4 v[72:75], v213, s[36:39], 0 offen nt
  v_dot2_f32_bf16 v22, v181, v48, 0
  v_add_f32_dpp v34, v18, v18 row_ror:8 row_mask:0xf bank_mask:0xc
  v_add_f32_dpp v34, v20, v20 row_ror:8 row_mask:0xf bank_mask:0x3
  v_dot2_f32_bf16 v23, v186, v49, 0
  v_dot2_f32_bf16 v24, v184, v50, 0
  v_dot2_f32_bf16 v25, v187, v51, 0
  v_cvt_f32_i32 v88, v88
  v_cvt_f32_i32 v89, v89
  v_cvt_f32_i32 v90, v90
  v_cvt_f32_i32 v91, v91
  v_pk_mul_f32 v[20:21], v[88:89], v[22:23]
  v_pk_add_f32 v[18:19], v[22:23], v[24:25]
  v_pk_fma_f32 v[20:21], v[90:91], v[24:25], v[20:21]
  v_add_f32 v18, v18, v19
  v_add_f32 v20, v20, v21
  s_cmpk_gt_i32 s69, 0x29
  s_cbranch_scc1 L_p58_4
  s_cmpk_gt_i32 s69, 0x15
  s_cbranch_scc1 L_p58_3
  s_cmpk_gt_i32 s69, 0xffc5
  s_cbranch_scc1 L_p58_0
  s_waitcnt vmcnt(7)
L_p58_0:
  s_waitcnt vmcnt(8)
L_p58_3:
  s_waitcnt vmcnt(11)
L_p58_4:
  s_waitcnt vmcnt(12)
  buffer_load_dwordx4 v[76:79], v214, s[36:39], 0 offen nt
  ds_read_b32 v4, v14 offset:16
  s_waitcnt vmcnt(9)
  s_add_u32 s44, s78, 0x03030303
  v_msad_u8 v9, s78, v36, 0
  v_msad_u8 v10, s44, v36, 0
  v_msad_u8 v9, s78, v37, v9
  v_msad_u8 v10, s44, v37, v10
  v_msad_u8 v9, s78, v38, v9
  v_msad_u8 v10, s44, v38, v10
  s_mov_b64 exec, 3
  global_store_byte v7, v8, s[30:31]
  global_load_dwordx3 v[36:38], v238, s[30:31] sc1
  v_sub_u32 v9, v9, v10
  v_add_u32 v8, 1, v8
  s_mov_b64 exec, -1
  v_readlane_b32 s66, v9, 0
  v_readlane_b32 s67, v9, 1
  s_add_u32 s78, s78, 0x01010101
  s_lshl1_add_u32 s69, s91, s95
  s_add_u32 s95, s66, s67
  s_add_u32 s69, s69, s95
  v_dot2_f32_bf16 v22, v185, v44, 0
  v_add_f32_dpp v21, v18, v18 row_ror:8 row_mask:0xf bank_mask:0xc
  v_add_f32_dpp v21, v20, v20 row_ror:8 row_mask:0xf bank_mask:0x3
  v_add_f32_dpp v20, v34, v34 row_half_mirror row_mask:0xf bank_mask:0x5
  v_dot2_f32_bf16 v23, v190, v45, 0
  v_add_f32_dpp v20, v21, v21 row_half_mirror row_mask:0xf bank_mask:0xa
  v_dot2_f32_bf16 v24, v188, v46, 0
  v_dot2_f32_bf16 v25, v191, v47, 0
  v_add_f32_dpp v20, v20, v20 quad_perm:[2,3,0,1] row_mask:0xf bank_mask:0xf
  v_cvt_f32_i32 v92, v92
  v_cvt_f32_i32 v93, v93
  v_add_f32_dpp v20, v20, v20 quad_perm:[1,0,3,2] row_mask:0xf bank_mask:0xf
  v_cndmask_b32_e64 v32, v32, v20, s[48:49]
  v_cvt_f32_i32 v94, v94
  v_cvt_f32_i32 v95, v95
  v_pk_mul_f32 v[20:21], v[92:93], v[22:23]
  v_pk_add_f32 v[18:19], v[22:23], v[24:25]
  v_pk_fma_f32 v[20:21], v[94:95], v[24:25], v[20:21]
  v_add_f32 v18, v18, v19
  v_add_f32 v20, v20, v21
  s_cmpk_gt_i32 s69, 0x29
  s_cbranch_scc1 L_p59_4
  s_cmpk_gt_i32 s69, 0xffe5
  s_cbranch_scc1 L_p59_1
  s_waitcnt vmcnt(5)
L_p59_1:
  s_waitcnt vmcnt(9)
L_p59_4:
  s_waitcnt vmcnt(10)
  buffer_load_dwordx4 v[80:83], v215, s[36:39], 0 offen nt
  v_dot2_f32_bf16 v22, v189, v52, 0
  v_add_f32_dpp v34, v18, v18 row_ror:8 row_mask:0xf bank_mask:0xc
  v_add_f32_dpp v34, v20, v20 row_ror:8 row_mask:0xf bank_mask:0x3
  v_dot2_f32_bf16 v23, v194, v53, 0
  v_dot2_f32_bf16 v24, v192, v54, 0
  v_dot2_f32_bf16 v25, v195, v55, 0
  v_cvt_f32_i32 v96, v96
  v_cvt_f32_i32 v97, v97
  v_cvt_f32_i32 v98, v98
  v_cvt_f32_i32 v99, v99
  v_pk_mul_f32 v[20:21], v[96:97], v[22:23]
  v_pk_add_f32 v[18:19], v[22:23], v[24:25]
  v_pk_fma_f32 v[20:21], v[98:99], v[24:25], v[20:21]
  v_add_f32 v18, v18, v19
  v_add_f32 v20, v20, v21
  s_cmpk_gt_i32 s69, 0x29
  s_cbranch_scc1 L_p60_4
  s_cmpk_gt_i32 s69, 0x3
  s_cbranch_scc1 L_p60_2
  s_waitcnt vmcnt(6)
L_p60_2:
  s_waitcnt vmcnt(10)
L_p60_4:
  s_waitcnt vmcnt(11)
  buffer_load_dwordx4 v[84:87], v216, s[36:39], 0 offen nt
  v_dot2_f32_bf16 v22, v193, v56, 0
  v_add_f32_dpp v21, v18, v18 row_ror:8 row_mask:0xf bank_mask:0xc
  v_add_f32_dpp v21, v20, v20 row_ror:8 row_mask:0xf bank_mask:0x3
  v_add_f32_dpp v20, v34, v34 row_half_mirror row_mask:0xf bank_mask:0x5
  v_dot2_f32_bf16 v23, v198, v57, 0
  v_add_f32_dpp v20, v21, v21 row_half_mirror row_mask:0xf bank_mask:0xa
  v_dot2_f32_bf16 v24, v196, v58, 0
  v_dot2_f32_bf16 v25, v199, v59, 0
  v_add_f32_dpp v20, v20, v20 quad_perm:[2,3,0,1] row_mask:0xf bank_mask:0xf
  v_cvt_f32_i32 v100, v100
  v_cvt_f32_i32 v101, v101
  v_add_f32_dpp v20, v20, v20 quad_perm:[1,0,3,2] row_mask:0xf bank_mask:0xf
  v_cndmask_b32_e64 v32, v32, v20, s[50:51]
  v_cvt_f32_i32 v102, v102
  v_cvt_f32_i32 v103, v103
  v_pk_mul_f32 v[20:21], v[100:101], v[22:23]
  v_pk_add_f32 v[18:19], v[22:23], v[24:25]
  v_pk_fma_f32 v[20:21], v[102:103], v[24:25], v[20:21]
  v_add_f32 v18, v18, v19
  v_add_f32 v20, v20, v21
  s_cmpk_gt_i32 s69, 0x29
  s_cbranch_scc1 L_p61_4
  s_cmpk_gt_i32 s69, 0x15
  s_cbranch_scc1 L_p61_3
  s_cmpk_gt_i32 s69, 0xffc5
  s_cbranch_scc1 L_p61_0
  s_waitcnt vmcnt(6)
L_p61_0:
  s_waitcnt vmcnt(7)
L_p61_3:
  s_waitcnt vmcnt(11)
L_p61_4:
  s_waitcnt vmcnt(12)
  buffer_load_dwordx4 v[88:91], v217, s[36:39], 0 offen nt
L_qn:
  s_waitcnt lgkmcnt(0)
  v_readfirstlane_b32 s46, v4
  s_cmp_ge_u32 s46, s47
  s_cbranch_scc1 L_qn_ok
  s_cmp_eq_u32 s94, 0
  s_cbranch_scc1 L_qn_ok
  s_sub_u32 s94, s94, 1
  ds_read_b32 v4, v14 offset:16
  s_branch L_qn
L_qn_ok:
  v_add_u32 v10, s59, v246
  ds_read_b128 v[44:47], v10 offset:512
  v_add_u32 v10, s59, v247
  ds_read_b128 v[48:51], v10 offset:512
  v_add_u32 v10, s59, v248
  ds_read_b128 v[52:55], v10 offset:512
  s_waitcnt vmcnt(8)
  s_add_u32 s44, s78, 0x03030303
  v_msad_u8 v9, s78, v40, 0
  v_msad_u8 v10, s44, v40, 0
  v_msad_u8 v9, s78, v41, v9
  v_msad_u8 v10, s44, v41, v10
  v_msad_u8 v9, s78, v42, v9
  v_msad_u8 v10, s44, v42, v10
  s_mov_b64 exec, 3
  global_store_byte v7, v8, s[30:31]
  global_load_dwordx3 v[40:42], v239, s[30:31] sc1
  v_sub_u32 v9, v9, v10
  v_add3_u32 v10, v26, v27, s58
  v_add_u32 v8, 1, v8
  s_mov_b64 exec, -1
  v_readlane_b32 s66, v9, 0
  v_readlane_b32 s67, v9, 1
  v_readlane_b32 s91, v10, 0
  s_add_u32 s78, s78, 0x01010101
  s_lshl1_add_u32 s69, s91, s95
  s_add_u32 s95, s66, s67
  s_add_u32 s69, s69, s95
  v_dot2_f32_bf16 v22, v197, v64, 0
  v_add_f32_dpp v34, v18, v18 row_ror:8 row_mask:0xf bank_mask:0xc
  v_add_f32_dpp v34, v20, v20 row_ror:8 row_mask:0xf bank_mask:0x3
  v_dot2_f32_bf16 v23, v202, v65, 0
  v_dot2_f32_bf16 v24, v200, v66, 0
  v_dot2_f32_bf16 v25, v203, v67, 0
  v_cvt_f32_i32 v104, v104
  v_cvt_f32_i32 v105, v105
  v_cvt_f32_i32 v106, v106
  v_cvt_f32_i32 v107, v107
  v_add_u32 v10, s59, v251
  ds_read_b128 v[64:67], v10 offset:512
  v_pk_mul_f32 v[20:21], v[104:105], v[22:23]
  v_pk_add_f32 v[18:19], v[22:23], v[24:25]
  v_pk_fma_f32 v[20:21], v[106:107], v[24:25], v[20:21]
  v_add_f32 v18, v18, v19
  v_add_f32 v20, v20, v21
  s_cmpk_gt_i32 s69, 0x29
  s_cbranch_scc1 L_p62_4
  s_cmpk_gt_i32 s69, 0xffe5
  s_cbranch_scc1 L_p62_1
  s_waitcnt vmcnt(5)
L_p62_1:
  s_waitcnt vmcnt(8)
L_p62_4:
  s_waitcnt vmcnt(9)
  buffer_load_dwordx4 v[92:95], v218, s[36:39], 0 offen nt
  v_dot2_f32_bf16 v22, v201, v60, 0
  v_add_f32_dpp v21, v18, v18 row_ror:8 row_mask:0xf bank_mask:0xc
  v_add_f32_dpp v21, v20, v20 row_ror:8 row_mask:0xf bank_mask:0x3
  v_add_f32_dpp v20, v34, v34 row_half_mirror row_mask:0xf bank_mask:0x5
  v_dot2_f32_bf16 v23, v206, v61, 0
  v_add_f32_dpp v20, v21, v21 row_half_mirror row_mask:0xf bank_mask:0xa
  v_dot2_f32_bf16 v24, v204, v62, 0
  v_dot2_f32_bf16 v25, v207, v63, 0
  v_add_f32_dpp v20, v20, v20 quad_perm:[2,3,0,1] row_mask:0xf bank_mask:0xf
  v_cvt_f32_i32 v108, v108
  v_cvt_f32_i32 v109, v109
  v_add_f32_dpp v20, v20, v20 quad_perm:[1,0,3,2] row_mask:0xf bank_mask:0xf
  v_cndmask_b32_e64 v32, v32, v20, s[52:53]
  v_cvt_f32_i32 v110, v110
  v_cvt_f32_i32 v111, v111
  v_add_u32 v10, s59, v250
  ds_read_b128 v[60:63], v10 offset:512
  v_pk_mul_f32 v[20:21], v[108:109], v[22:23]
  v_pk_add_f32 v[18:19], v[22:23], v[24:25]
  v_pk_fma_f32 v[20:21], v[110:111], v[24:25], v[20:21]
  v_add_f32 v18, v18, v19
  v_add_f32 v20, v20, v21
  s_cmpk_gt_i32 s69, 0x29
  s_cbranch_scc1 L_p63_4
  s_cmpk_gt_i32 s69, 0x3
  s_cbranch_scc1 L_p63_2
  s_waitcnt vmcnt(6)
L_p63_2:
  s_waitcnt vmcnt(9)
L_p63_4:
  s_waitcnt vmcnt(10)
  buffer_load_dwordx4 v[96:99], v219, s[36:39], 0 offen nt
  v_dot2_f32_bf16 v22, v205, v56, 0
  v_add_f32_dpp v34, v18, v18 row_ror:8 row_mask:0xf bank_mask:0xc
  v_add_f32_dpp v34, v20, v20 row_ror:8 row_mask:0xf bank_mask:0x3
  v_dot2_f32_bf16 v23, v210, v57, 0
  v_dot2_f32_bf16 v24, v208, v58, 0
  v_dot2_f32_bf16 v25, v211, v59, 0
  v_cvt_f32_i32 v112, v112
  v_cvt_f32_i32 v113, v113
  v_cvt_f32_i32 v114, v114
  v_cvt_f32_i32 v115, v115
  v_add_u32 v10, s59, v249
  ds_read_b128 v[56:59], v10 offset:512
  v_pk_mul_f32 v[20:21], v[112:113], v[22:23]
  v_pk_add_f32 v[18:19], v[22:23], v[24:25]
  v_pk_fma_f32 v[20:21], v[114:115], v[24:25], v[20:21]
  v_add_f32 v18, v18, v19
  v_add_f32 v20, v20, v21
  s_cmpk_gt_i32 s69, 0x29
  s_cbranch_scc1 L_p64_4
  s_cmpk_gt_i32 s69, 0x15
  s_cbranch_scc1 L_p64_3
  s_cmpk_gt_i32 s69, 0xffc5
  s_cbranch_scc1 L_p64_0
  s_waitcnt vmcnt(6)
L_p64_0:
  s_waitcnt vmcnt(7)
L_p64_3:
  s_waitcnt vmcnt(10)
L_p64_4:
  s_waitcnt vmcnt(11)
  buffer_load_dwordx4 v[100:103], v220, s[36:39], 0 offen nt
  s_nop 0
  v_add_f32_dpp v21, v18, v18 row_ror:8 row_mask:0xf bank_mask:0xc
  v_add_f32_dpp v21, v20, v20 row_ror:8 row_mask:0xf bank_mask:0x3
  v_add_f32_dpp v20, v34, v34 row_half_mirror row_mask:0xf bank_mask:0x5
  s_nop 0
  v_add_f32_dpp v20, v21, v21 row_half_mirror row_mask:0xf bank_mask:0xa
  s_nop 1
  v_add_f32_dpp v20, v20, v20 quad_perm:[2,3,0,1] row_mask:0xf bank_mask:0xf
  s_nop 1
  v_add_f32_dpp v20, v20, v20 quad_perm:[1,0,3,2] row_mask:0xf bank_mask:0xf
  v_cndmask_b32_e64 v32, v32, v20, s[54:55]
  v_add_u32 v2, s101, v17
  ds_write_b32 v2, v32
  s_addk_i32 s101, 3072
  s_cmpk_eq_u32 s101, 18432
  s_cselect_b32 s101, 0, s101
  s_add_u32 s43, s43, 1
  v_mov_b32 v4, s43
  ds_write_b32 v6, v4 offset:0
  s_mov_b64 s[32:33], s[36:37]
  s_add_u32 s68, s43, 1
  s_sub_u32 s45, s68, 16
  s_lshl_b32 s46, s45, 2
  s_lshr_b64 s[64:65], s[92:93], s46
  s_and_b32 s46, s64, 15
  s_cmp_lt_u32 s68, 16
  s_cselect_b32 s68, s68, s46
  s_cselect_b32 s70, s6, s12
  s_cselect_b32 s71, s7, s13
  s_lshl_b32 s44, s68, 2
  s_lshr_b64 s[64:65], s[96:97], s44
  s_and_b32 s64, s64, 15
  s_lshl4_add_u32 s68, s68, s64
  s_mul_i32 s44, s68, 1572864
  s_add_u32 s36, s70, s44
  s_addc_u32 s37, s71, 0
  s_cmp_lt_u32 s43, 16
  s_cbranch_scc1 L_k
L_vpre:
  v_subrev_u32 v120, 45568, v15
  v_mul_u32_u24 v120, 683, v120
  v_lshrrev_b32 v120, 13, v120
  v_lshlrev_b32 v120, 2, v120
  v_subrev_u32 v121, 45568, v16
  v_mul_u32_u24 v121, 683, v121
  v_lshrrev_b32 v121, 13, v121
  v_lshlrev_b32 v121, 2, v121
  v_subrev_u32 v122, 45568, v17
  v_mul_u32_u24 v122, 683, v122
  v_lshrrev_b32 v122, 13, v122
  v_lshlrev_b32 v122, 2, v122
  s_mov_b64 vcc, 0
  s_mov_b32 s43, 0
  s_lshl_b32 s68, s43, 2
  s_lshr_b64 s[64:65], s[92:93], s68
  s_and_b32 s68, s64, 15
  s_add_u32 s47, s68, 1
  ds_read_b32 v4, v14 offset:20
L_a0:
  s_waitcnt lgkmcnt(0)
  v_readfirstlane_b32 s46, v4
  s_cmp_ge_u32 s46, s47
  s_cbranch_scc1 L_a0_ok
  s_cmp_eq_u32 s94, 0
  s_cbranch_scc1 L_a0_ok
  s_sub_u32 s94, s94, 1
  ds_read_b32 v4, v14 offset:20
  s_branch L_a0
L_a0_ok:
  v_lshl_add_u32 v124, s68, 9, v120
  v_lshl_add_u32 v125, s68, 9, v121
  v_lshl_add_u32 v126, s68, 9, v122
  ds_read_b32 v116, v124 offset:37376
  ds_read_b32 v117, v125 offset:37376
  ds_read_b32 v118, v126 offset:37376
.p2align 6
L_v:
  s_cmp_eq_u32 s43, 8
  s_cselect_b32 s44, 6, 0
  s_sub_u32 s58, s58, s44
  s_add_u32 s45, s43, 1
  s_min_u32 s45, s45, 15
  s_lshl_b32 s68, s45, 2
  s_lshr_b64 s[64:65], s[92:93], s68
  s_and_b32 s68, s64, 15
  s_add_u32 s47, s68, 1
  v_lshl_add_u32 v124, s68, 9, v120
  v_lshl_add_u32 v125, s68, 9, v121
  v_lshl_add_u32 v126, s68, 9, v122
  s_waitcnt lgkmcnt(0)
  s_waitcnt vmcnt(8)
  s_add_u32 s44, s78, 0x03030303
  v_msad_u8 v9, s78, v36, 0
  v_msad_u8 v10, s44, v36, 0
  v_msad_u8 v9, s78, v37, v9
  v_msad_u8 v10, s44, v37, v10
  v_msad_u8 v9, s78, v38, v9
  v_msad_u8 v10, s44, v38, v10
  s_mov_b64 exec, 3
  global_store_byte v7, v8, s[30:31]
  global_load_dwordx3 v[36:38], v236, s[30:31] sc1
  v_sub_u32 v9, v9, v10
  v_add_u32 v8, 1, v8
  s_mov_b64 exec, -1
  v_readlane_b32 s66, v9, 0
  v_readlane_b32 s67, v9, 1
  s_add_u32 s78, s78, 0x01010101
  s_lshl1_add_u32 s69, s91, s95
  s_add_u32 s95, s66, s67
  s_add_u32 s69, s69, s95
  v_mov_b32_dpp v18, v116 row_newbcast:0 row_mask:0xf bank_mask:0xf
  v_cvt_f32_i32 v68, v68
  v_cvt_f32_i32 v69, v69
  v_cvt_f32_i32 v70, v70
  v_cvt_f32_i32 v71, v71
  v_pk_mul_f32 v[44:45], v[68:69], v[18:19] op_sel_hi:[1,0]
  v_pk_mul_f32 v[46:47], v[70:71], v[18:19] op_sel_hi:[1,0]
  s_cmpk_gt_i32 s69, 0x31
  s_cbranch_scc1 L_p65_4
  s_cmpk_gt_i32 s69, 0xffed
  s_cbranch_scc1 L_p65_1
  s_waitcnt vmcnt(5)
L_p65_1:
  s_waitcnt vmcnt(8)
L_p65_4:
  s_waitcnt vmcnt(9)
  buffer_load_dwordx4 v[104:107], v221, s[32:35], 0 offen nt
  v_mov_b32_dpp v18, v116 row_newbcast:4 row_mask:0xf bank_mask:0xf
  v_cvt_f32_i32 v72, v72
  v_cvt_f32_i32 v73, v73
  v_cvt_f32_i32 v74, v74
  v_cvt_f32_i32 v75, v75
  v_pk_mul_f32 v[52:53], v[72:73], v[18:19] op_sel_hi:[1,0]
  v_pk_mul_f32 v[54:55], v[74:75], v[18:19] op_sel_hi:[1,0]
  s_cmpk_gt_i32 s69, 0x31
  s_cbranch_scc1 L_p66_4
  s_cmpk_gt_i32 s69, 0xb
  s_cbranch_scc1 L_p66_2
  s_waitcnt vmcnt(6)
L_p66_2:
  s_waitcnt vmcnt(9)
L_p66_4:
  s_waitcnt vmcnt(10)
  buffer_load_dwordx4 v[108:111], v222, s[32:35], 0 offen nt
  v_mov_b32_dpp v18, v116 row_newbcast:1 row_mask:0xf bank_mask:0xf
  v_cvt_f32_i32 v76, v76
  v_cvt_f32_i32 v77, v77
  v_cvt_f32_i32 v78, v78
  v_cvt_f32_i32 v79, v79
  v_pk_mul_f32 v[48:49], v[76:77], v[18:19] op_sel_hi:[1,0]
  v_pk_mul_f32 v[50:51], v[78:79], v[18:19] op_sel_hi:[1,0]
  s_cmpk_gt_i32 s69, 0x31
  s_cbranch_scc1 L_p67_4
  s_cmpk_gt_i32 s69, 0x1d
  s_cbranch_scc1 L_p67_3
  s_cmpk_gt_i32 s69, 0xffcd
  s_cbranch_scc1 L_p67_0
  s_waitcnt vmcnt(6)
L_p67_0:
  s_waitcnt vmcnt(7)
L_p67_3:
  s_waitcnt vmcnt(10)
L_p67_4:
  s_waitcnt vmcnt(11)
  buffer_load_dwordx4 v[112:115], v223, s[32:35], 0 offen nt
  s_waitcnt vmcnt(8)
  s_add_u32 s44, s78, 0x03030303
  v_msad_u8 v9, s78, v40, 0
  v_msad_u8 v10, s44, v40, 0
  v_msad_u8 v9, s78, v41, v9
  v_msad_u8 v10, s44, v41, v10
  v_msad_u8 v9, s78, v42, v9
  v_msad_u8 v10, s44, v42, v10
  s_mov_b64 exec, 3
  global_store_byte v7, v8, s[30:31]
  global_load_dwordx3 v[40:42], v237, s[30:31] sc1
  v_sub_u32 v9, v9, v10
  v_add_u32 v8, 1, v8
  s_mov_b64 exec, -1
  v_readlane_b32 s66, v9, 0
  v_readlane_b32 s67, v9, 1
  s_add_u32 s78, s78, 0x01010101
  s_lshl1_add_u32 s69, s91, s95
  s_add_u32 s95, s66, s67
  s_add_u32 s69, s69, s95
  v_mov_b32_dpp v18, v116 row_newbcast:5 row_mask:0xf bank_mask:0xf
  v_cvt_f32_i32 v80, v80
  v_cvt_f32_i32 v81, v81
  v_cvt_f32_i32 v82, v82
  v_cvt_f32_i32 v83, v83
  v_pk_fma_f32 v[44:45], v[80:81], v[18:19], v[44:45] op_sel_hi:[1,0,1]
  v_pk_fma_f32 v[46:47], v[82:83], v[18:19], v[46:47] op_sel_hi:[1,0,1]
  s_cmpk_gt_i32 s69, 0x31
  s_cbranch_scc1 L_p68_4
  s_cmpk_gt_i32 s69, 0xffed
  s_cbranch_scc1 L_p68_1
  s_waitcnt vmcnt(5)
L_p68_1:
  s_waitcnt vmcnt(8)
L_p68_4:
  s_waitcnt vmcnt(9)
  buffer_load_dwordx4 v[68:71], v224, s[32:35], 0 offen nt
  v_mov_b32_dpp v18, v116 row_newbcast:2 row_mask:0xf bank_mask:0xf
  v_cvt_f32_i32 v84, v84
  v_cvt_f32_i32 v85, v85
  v_cvt_f32_i32 v86, v86
  v_cvt_f32_i32 v87, v87
  v_pk_mul_f32 v[60:61], v[84:85], v[18:19] op_sel_hi:[1,0]
  v_pk_mul_f32 v[62:63], v[86:87], v[18:19] op_sel_hi:[1,0]
  s_cmpk_gt_i32 s69, 0x31
  s_cbranch_scc1 L_p69_4
  s_cmpk_gt_i32 s69, 0xb
  s_cbranch_scc1 L_p69_2
  s_waitcnt vmcnt(6)
L_p69_2:
  s_waitcnt vmcnt(9)
L_p69_4:
  s_waitcnt vmcnt(10)
  buffer_load_dwordx4 v[72:75], v225, s[32:35], 0 offen nt
  v_mov_b32_dpp v18, v116 row_newbcast:6 row_mask:0xf bank_mask:0xf
  v_cvt_f32_i32 v88, v88
  v_cvt_f32_i32 v89, v89
  v_cvt_f32_i32 v90, v90
  v_cvt_f32_i32 v91, v91
  v_pk_mul_f32 v[56:57], v[88:89], v[18:19] op_sel_hi:[1,0]
  v_pk_mul_f32 v[58:59], v[90:91], v[18:19] op_sel_hi:[1,0]
  s_cmpk_gt_i32 s69, 0x31
  s_cbranch_scc1 L_p70_4
  s_cmpk_gt_i32 s69, 0x1d
  s_cbranch_scc1 L_p70_3
  s_cmpk_gt_i32 s69, 0xffcd
  s_cbranch_scc1 L_p70_0
  s_waitcnt vmcnt(6)
L_p70_0:
  s_waitcnt vmcnt(7)
L_p70_3:
  s_waitcnt vmcnt(10)
L_p70_4:
  s_waitcnt vmcnt(11)
  buffer_load_dwordx4 v[76:79], v226, s[32:35], 0 offen nt
  v_add_u32_e64 v9, s43, 16
  ds_write_b32 v14, v9 offset:28
  s_waitcnt vmcnt(8)
  s_add_u32 s44, s78, 0x03030303
  v_msad_u8 v9, s78, v36, 0
  v_msad_u8 v10, s44, v36, 0
  v_msad_u8 v9, s78, v37, v9
  v_msad_u8 v10, s44, v37, v10
  v_msad_u8 v9, s78, v38, v9
  v_msad_u8 v10, s44, v38, v10
  s_mov_b64 exec, 3
  global_store_byte v7, v8, s[30:31]
  global_load_dwordx3 v[36:38], v238, s[30:31] sc1
  v_sub_u32 v9, v9, v10
  v_add_u32 v8, 1, v8
  s_mov_b64 exec, -1
  v_readlane_b32 s66, v9, 0
  v_readlane_b32 s67, v9, 1
  s_add_u32 s78, s78, 0x01010101
  s_lshl1_add_u32 s69, s91, s95
  s_add_u32 s95, s66, s67
  s_add_u32 s69, s69, s95
  v_mov_b32_dpp v18, v116 row_newbcast:3 row_mask:0xf bank_mask:0xf
  v_cvt_f32_i32 v92, v92
  v_cvt_f32_i32 v93, v93
  v_cvt_f32_i32 v94, v94
  v_cvt_f32_i32 v95, v95
  v_pk_mul_f32 v[64:65], v[92:93], v[18:19] op_sel_hi:[1,0]
  v_pk_mul_f32 v[66:67], v[94:95], v[18:19] op_sel_hi:[1,0]
  s_cmpk_gt_i32 s69, 0x31
  s_cbranch_scc1 L_p71_4
  s_cmpk_gt_i32 s69, 0xffed
  s_cbranch_scc1 L_p71_1
  s_waitcnt vmcnt(5)
L_p71_1:
  s_waitcnt vmcnt(8)
L_p71_4:
  s_waitcnt vmcnt(9)
  buffer_load_dwordx4 v[80:83], v227, s[32:35], 0 offen nt
  v_mov_b32_dpp v18, v116 row_newbcast:7 row_mask:0xf bank_mask:0xf
  v_cvt_f32_i32 v96, v96
  v_cvt_f32_i32 v97, v97
  v_cvt_f32_i32 v98, v98
  v_cvt_f32_i32 v99, v99
  v_pk_fma_f32 v[60:61], v[96:97], v[18:19], v[60:61] op_sel_hi:[1,0,1]
  v_pk_fma_f32 v[62:63], v[98:99], v[18:19], v[62:63] op_sel_hi:[1,0,1]
  s_cmpk_gt_i32 s69, 0x31
  s_cbranch_scc1 L_p72_4
  s_cmpk_gt_i32 s69, 0xb
  s_cbranch_scc1 L_p72_2
  s_waitcnt vmcnt(6)
L_p72_2:
  s_waitcnt vmcnt(9)
L_p72_4:
  s_waitcnt vmcnt(10)
  buffer_load_dwordx4 v[84:87], v228, s[32:35], 0 offen nt
  v_mov_b32_dpp v18, v117 row_newbcast:0 row_mask:0xf bank_mask:0xf
  v_cvt_f32_i32 v100, v100
  v_cvt_f32_i32 v101, v101
  v_cvt_f32_i32 v102, v102
  v_cvt_f32_i32 v103, v103
  v_pk_fma_f32 v[48:49], v[100:101], v[18:19], v[48:49] op_sel_hi:[1,0,1]
  v_pk_fma_f32 v[50:51], v[102:103], v[18:19], v[50:51] op_sel_hi:[1,0,1]
  s_cmpk_gt_i32 s69, 0x31
  s_cbranch_scc1 L_p73_4
  s_cmpk_gt_i32 s69, 0x1d
  s_cbranch_scc1 L_p73_3
  s_cmpk_gt_i32 s69, 0xffcd
  s_cbranch_scc1 L_p73_0
  s_waitcnt vmcnt(6)
L_p73_0:
  s_waitcnt vmcnt(7)
L_p73_3:
  s_waitcnt vmcnt(10)
L_p73_4:
  s_waitcnt vmcnt(11)
  buffer_load_dwordx4 v[88:91], v229, s[32:35], 0 offen nt
  s_waitcnt vmcnt(8)
  s_add_u32 s44, s78, 0x03030303
  v_msad_u8 v9, s78, v40, 0
  v_msad_u8 v10, s44, v40, 0
  v_msad_u8 v9, s78, v41, v9
  v_msad_u8 v10, s44, v41, v10
  v_msad_u8 v9, s78, v42, v9
  v_msad_u8 v10, s44, v42, v10
  s_mov_b64 exec, 3
  global_store_byte v7, v8, s[30:31]
  global_load_dwordx3 v[40:42], v239, s[30:31] sc1
  v_sub_u32 v9, v9, v10
  v_add_u32 v8, 1, v8
  s_mov_b64 exec, -1
  v_readlane_b32 s66, v9, 0
  v_readlane_b32 s67, v9, 1
  s_add_u32 s78, s78, 0x01010101
  s_lshl1_add_u32 s69, s91, s95
  s_add_u32 s95, s66, s67
  s_add_u32 s69, s69, s95
  v_mov_b32_dpp v18, v117 row_newbcast:4 row_mask:0xf bank_mask:0xf
  v_cvt_f32_i32 v104, v104
  v_cvt_f32_i32 v105, v105
  v_cvt_f32_i32 v106, v106
  v_cvt_f32_i32 v107, v107
  v_pk_fma_f32 v[44:45], v[104:105], v[18:19], v[44:45] op_sel_hi:[1,0,1]
  v_pk_fma_f32 v[46:47], v[106:107], v[18:19], v[46:47] op_sel_hi:[1,0,1]
  s_cmpk_gt_i32 s69, 0x31
  s_cbranch_scc1 L_p74_4
  s_cmpk_gt_i32 s69, 0xffed
  s_cbranch_scc1 L_p74_1
  s_waitcnt vmcnt(5)
L_p74_1:
  s_waitcnt vmcnt(8)
L_p74_4:
  s_waitcnt vmcnt(9)
  buffer_load_dwordx4 v[92:95], v230, s[32:35], 0 offen nt
  v_mov_b32_dpp v18, v117 row_newbcast:1 row_mask:0xf bank_mask:0xf
  v_cvt_f32_i32 v108, v108
  v_cvt_f32_i32 v109, v109
  v_cvt_f32_i32 v110, v110
  v_cvt_f32_i32 v111, v111
  v_pk_fma_f32 v[52:53], v[108:109], v[18:19], v[52:53] op_sel_hi:[1,0,1]
  v_pk_fma_f32 v[54:55], v[110:111], v[18:19], v[54:55] op_sel_hi:[1,0,1]
  s_cmpk_gt_i32 s69, 0x31
  s_cbranch_scc1 L_p75_4
  s_cmpk_gt_i32 s69, 0xb
  s_cbranch_scc1 L_p75_2
  s_waitcnt vmcnt(6)
L_p75_2:
  s_waitcnt vmcnt(9)
L_p75_4:
  s_waitcnt vmcnt(10)
  buffer_load_dwordx4 v[96:99], v231, s[32:35], 0 offen nt
  v_mov_b32_dpp v18, v117 row_newbcast:5 row_mask:0xf bank_mask:0xf
  v_cvt_f32_i32 v112, v112
  v_cvt_f32_i32 v113, v113
  v_cvt_f32_i32 v114, v114
  v_cvt_f32_i32 v115, v115
  v_pk_fma_f32 v[48:49], v[112:113], v[18:19], v[48:49] op_sel_hi:[1,0,1]
  v_pk_fma_f32 v[50:51], v[114:115], v[18:19], v[50:51] op_sel_hi:[1,0,1]
  s_cmpk_gt_i32 s69, 0x31
  s_cbranch_scc1 L_p76_4
  s_cmpk_gt_i32 s69, 0x1d
  s_cbranch_scc1 L_p76_3
  s_cmpk_gt_i32 s69, 0xffcd
  s_cbranch_scc1 L_p76_0
  s_waitcnt vmcnt(6)
L_p76_0:
  s_waitcnt vmcnt(7)
L_p76_3:
  s_waitcnt vmcnt(10)
L_p76_4:
  s_waitcnt vmcnt(11)
  buffer_load_dwordx4 v[100:103], v232, s[32:35], 0 offen nt
  s_waitcnt vmcnt(8)
  s_add_u32 s44, s78, 0x03030303
  v_msad_u8 v9, s78, v36, 0
  v_msad_u8 v10, s44, v36, 0
  v_msad_u8 v9, s78, v37, v9
  v_msad_u8 v10, s44, v37, v10
  v_msad_u8 v9, s78, v38, v9
  v_msad_u8 v10, s44, v38, v10
  s_mov_b64 exec, 3
  global_store_byte v7, v8, s[30:31]
  global_load_dwordx3 v[36:38], v236, s[30:31] sc1
  v_sub_u32 v9, v9, v10
  v_add_u32 v8, 1, v8
  s_mov_b64 exec, -1
  v_readlane_b32 s66, v9, 0
  v_readlane_b32 s67, v9, 1
  s_add_u32 s78, s78, 0x01010101
  s_lshl1_add_u32 s69, s91, s95
  s_add_u32 s95, s66, s67
  s_add_u32 s69, s69, s95
  v_mov_b32_dpp v18, v117 row_newbcast:2 row_mask:0xf bank_mask:0xf
  v_cvt_f32_i32 v68, v68
  v_cvt_f32_i32 v69, v69
  v_cvt_f32_i32 v70, v70
  v_cvt_f32_i32 v71, v71
  v_pk_fma_f32 v[64:65], v[68:69], v[18:19], v[64:65] op_sel_hi:[1,0,1]
  v_pk_fma_f32 v[66:67], v[70:71], v[18:19], v[66:67] op_sel_hi:[1,0,1]
  s_cmpk_gt_i32 s69, 0x31
  s_cbranch_scc1 L_p77_4
  s_cmpk_gt_i32 s69, 0xffed
  s_cbranch_scc1 L_p77_1
  s_waitcnt vmcnt(5)
L_p77_1:
  s_waitcnt vmcnt(8)
L_p77_4:
  s_waitcnt vmcnt(9)
  buffer_load_dwordx4 v[104:107], v233, s[32:35], 0 offen nt
  v_mov_b32_dpp v18, v117 row_newbcast:6 row_mask:0xf bank_mask:0xf
  v_cvt_f32_i32 v72, v72
  v_cvt_f32_i32 v73, v73
  v_cvt_f32_i32 v74, v74
  v_cvt_f32_i32 v75, v75
  v_pk_fma_f32 v[60:61], v[72:73], v[18:19], v[60:61] op_sel_hi:[1,0,1]
  v_pk_fma_f32 v[62:63], v[74:75], v[18:19], v[62:63] op_sel_hi:[1,0,1]
  s_cmpk_gt_i32 s69, 0x31
  s_cbranch_scc1 L_p78_4
  s_cmpk_gt_i32 s69, 0xb
  s_cbranch_scc1 L_p78_2
  s_waitcnt vmcnt(6)
L_p78_2:
  s_waitcnt vmcnt(9)
L_p78_4:
  s_waitcnt vmcnt(10)
  buffer_load_dwordx4 v[108:111], v234, s[32:35], 0 offen nt
  v_mov_b32_dpp v18, v117 row_newbcast:3 row_mask:0xf bank_mask:0xf
  v_cvt_f32_i32 v76, v76
  v_cvt_f32_i32 v77, v77
  v_cvt_f32_i32 v78, v78
  v_cvt_f32_i32 v79, v79
  v_pk_fma_f32 v[56:57], v[76:77], v[18:19], v[56:57] op_sel_hi:[1,0,1]
  v_pk_fma_f32 v[58:59], v[78:79], v[18:19], v[58:59] op_sel_hi:[1,0,1]
  s_cmpk_gt_i32 s69, 0x31
  s_cbranch_scc1 L_p79_4
  s_cmpk_gt_i32 s69, 0x1d
  s_cbranch_scc1 L_p79_3
  s_cmpk_gt_i32 s69, 0xffcd
  s_cbranch_scc1 L_p79_0
  s_waitcnt vmcnt(6)
L_p79_0:
  s_waitcnt vmcnt(7)
L_p79_3:
  s_waitcnt vmcnt(10)
L_p79_4:
  s_waitcnt vmcnt(11)
  buffer_load_dwordx4 v[112:115], v235, s[32:35], 0 offen nt
  s_cbranch_vccnz L_vtail
  ds_read_b32 v4, v14 offset:20
  s_waitcnt vmcnt(8)
  s_add_u32 s44, s78, 0x03030303
  v_msad_u8 v9, s78, v40, 0
  v_msad_u8 v10, s44, v40, 0
  v_msad_u8 v9, s78, v41, v9
  v_msad_u8 v10, s44, v41, v10
  v_msad_u8 v9, s78, v42, v9
  v_msad_u8 v10, s44, v42, v10
  s_mov_b64 exec, 3
  global_load_dwordx2 v[26:27], v11, s[30:31] sc1
  global_store_byte v7, v8, s[30:31]
  global_load_dwordx3 v[40:42], v237, s[30:31] sc1
  v_sub_u32 v9, v9, v10
  v_add_u32 v8, 1, v8
  s_mov_b64 exec, -1
  v_readlane_b32 s66, v9, 0
  v_readlane_b32 s67, v9, 1
  s_add_u32 s78, s78, 0x01010101
  s_lshl1_add_u32 s69, s91, s95
  s_add_u32 s95, s66, s67
  s_add_u32 s69, s69, s95
  v_mov_b32_dpp v18, v117 row_newbcast:7 row_mask:0xf bank_mask:0xf
  v_cvt_f32_i32 v80, v80
  v_cvt_f32_i32 v81, v81
  v_cvt_f32_i32 v82, v82
  v_cvt_f32_i32 v83, v83
  v_pk_fma_f32 v[64:65], v[80:81], v[18:19], v[64:65] op_sel_hi:[1,0,1]
  v_pk_fma_f32 v[66:67], v[82:83], v[18:19], v[66:67] op_sel_hi:[1,0,1]
  s_cmpk_gt_i32 s69, 0x31
  s_cbranch_scc1 L_p80_4
  s_cmpk_gt_i32 s69, 0xffed
  s_cbranch_scc1 L_p80_1
  s_waitcnt vmcnt(6)
L_p80_1:
  s_waitcnt vmcnt(9)
L_p80_4:
  s_waitcnt vmcnt(10)
  buffer_load_dwordx4 v[68:71], v212, s[36:39], 0 offen nt
  v_mov_b32_dpp v18, v118 row_newbcast:0 row_mask:0xf bank_mask:0xf
  v_cvt_f32_i32 v84, v84
  v_cvt_f32_i32 v85, v85
  v_cvt_f32_i32 v86, v86
  v_cvt_f32_i32 v87, v87
  v_pk_fma_f32 v[52:53], v[84:85], v[18:19], v[52:53] op_sel_hi:[1,0,1]
  v_pk_fma_f32 v[54:55], v[86:87], v[18:19], v[54:55] op_sel_hi:[1,0,1]
  s_cmpk_gt_i32 s69, 0x31
  s_cbranch_scc1 L_p81_4
  s_cmpk_gt_i32 s69, 0xb
  s_cbranch_scc1 L_p81_2
  s_waitcnt vmcnt(7)
L_p81_2:
  s_waitcnt vmcnt(10)
L_p81_4:
  s_waitcnt vmcnt(11)
  buffer_load_dwordx4 v[72:75], v213, s[36:39], 0 offen nt
  v_mov_b32_dpp v18, v118 row_newbcast:4 row_mask:0xf bank_mask:0xf
  v_cvt_f32_i32 v88, v88
  v_cvt_f32_i32 v89, v89
  v_cvt_f32_i32 v90, v90
  v_cvt_f32_i32 v91, v91
  v_pk_fma_f32 v[48:49], v[88:89], v[18:19], v[48:49] op_sel_hi:[1,0,1]
  v_pk_fma_f32 v[50:51], v[90:91], v[18:19], v[50:51] op_sel_hi:[1,0,1]
  s_cmpk_gt_i32 s69, 0x31
  s_cbranch_scc1 L_p82_4
  s_cmpk_gt_i32 s69, 0x1d
  s_cbranch_scc1 L_p82_3
  s_cmpk_gt_i32 s69, 0xffcd
  s_cbranch_scc1 L_p82_0
  s_waitcnt vmcnt(7)
L_p82_0:
  s_waitcnt vmcnt(8)
L_p82_3:
  s_waitcnt vmcnt(11)
L_p82_4:
  s_waitcnt vmcnt(12)
  buffer_load_dwordx4 v[76:79], v214, s[36:39], 0 offen nt
L_an:
  s_waitcnt lgkmcnt(0)
  v_readfirstlane_b32 s46, v4
  s_cmp_ge_u32 s46, s47
  s_cbranch_scc1 L_an_ok
  s_cmp_eq_u32 s94, 0
  s_cbranch_scc1 L_an_ok
  s_sub_u32 s94, s94, 1
  ds_read_b32 v4, v14 offset:20
  s_branch L_an
L_an_ok:
  ds_read_b32 v116, v124 offset:37376
  ds_read_b32 v117, v125 offset:37376
  ds_read_b32 v119, v126 offset:37376
  s_waitcnt vmcnt(9)
  s_add_u32 s44, s78, 0x03030303
  v_msad_u8 v9, s78, v36, 0
  v_msad_u8 v10, s44, v36, 0
  v_msad_u8 v9, s78, v37, v9
  v_msad_u8 v10, s44, v37, v10
  v_msad_u8 v9, s78, v38, v9
  v_msad_u8 v10, s44, v38, v10
  s_mov_b64 exec, 3
  global_store_byte v7, v8, s[30:31]
  global_load_dwordx3 v[36:38], v238, s[30:31] sc1
  v_sub_u32 v9, v9, v10
  v_add_u32 v8, 1, v8
  s_mov_b64 exec, -1
  v_readlane_b32 s66, v9, 0
  v_readlane_b32 s67, v9, 1
  s_add_u32 s78, s78, 0x01010101
  s_lshl1_add_u32 s69, s91, s95
  s_add_u32 s95, s66, s67
  s_add_u32 s69, s69, s95
  v_mov_b32_dpp v18, v118 row_newbcast:1 row_mask:0xf bank_mask:0xf
  v_cvt_f32_i32 v92, v92
  v_cvt_f32_i32 v93, v93
  v_cvt_f32_i32 v94, v94
  v_cvt_f32_i32 v95, v95
  v_pk_fma_f32 v[44:45], v[92:93], v[18:19], v[44:45] op_sel_hi:[1,0,1]
  v_pk_fma_f32 v[46:47], v[94:95], v[18:19], v[46:47] op_sel_hi:[1,0,1]
  s_cmpk_gt_i32 s69, 0x31
  s_cbranch_scc1 L_p83_4
  s_cmpk_gt_i32 s69, 0xffed
  s_cbranch_scc1 L_p83_1
  s_waitcnt vmcnt(5)
L_p83_1:
  s_waitcnt vmcnt(9)
L_p83_4:
  s_waitcnt vmcnt(10)
  buffer_load_dwordx4 v[80:83], v215, s[36:39], 0 offen nt
  v_mov_b32_dpp v18, v118 row_newbcast:5 row_mask:0xf bank_mask:0xf
  v_cvt_f32_i32 v96, v96
  v_cvt_f32_i32 v97, v97
  v_cvt_f32_i32 v98, v98
  v_cvt_f32_i32 v99, v99
  v_pk_fma_f32 v[52:53], v[96:97], v[18:19], v[52:53] op_sel_hi:[1,0,1]
  v_pk_fma_f32 v[54:55], v[98:99], v[18:19], v[54:55] op_sel_hi:[1,0,1]
  s_cmpk_gt_i32 s69, 0x31
  s_cbranch_scc1 L_p84_4
  s_cmpk_gt_i32 s69, 0xb
  s_cbranch_scc1 L_p84_2
  s_waitcnt vmcnt(6)
L_p84_2:
  s_waitcnt vmcnt(10)
L_p84_4:
  s_waitcnt vmcnt(11)
  buffer_load_dwordx4 v[84:87], v216, s[36:39], 0 offen nt
  v_mov_b32_dpp v18, v118 row_newbcast:2 row_mask:0xf bank_mask:0xf
  v_cvt_f32_i32 v100, v100
  v_cvt_f32_i32 v101, v101
  v_cvt_f32_i32 v102, v102
  v_cvt_f32_i32 v103, v103
  v_pk_fma_f32 v[56:57], v[100:101], v[18:19], v[56:57] op_sel_hi:[1,0,1]
  v_pk_fma_f32 v[58:59], v[102:103], v[18:19], v[58:59] op_sel_hi:[1,0,1]
  s_cmpk_gt_i32 s69, 0x31
  s_cbranch_scc1 L_p85_4
  s_cmpk_gt_i32 s69, 0x1d
  s_cbranch_scc1 L_p85_3
  s_cmpk_gt_i32 s69, 0xffcd
  s_cbranch_scc1 L_p85_0
  s_waitcnt vmcnt(6)
L_p85_0:
  s_waitcnt vmcnt(7)
L_p85_3:
  s_waitcnt vmcnt(11)
L_p85_4:
  s_waitcnt vmcnt(12)
  buffer_load_dwordx4 v[88:91], v217, s[36:39], 0 offen nt
  s_cmp_eq_u32 s62, 0
  s_cbranch_scc1 L_flv
  v_pk_add_f32 v[56:57], v[56:57], v[48:49]
  v_pk_add_f32 v[58:59], v[58:59], v[50:51]
  v_pk_add_f32 v[60:61], v[60:61], v[52:53]
  v_pk_add_f32 v[62:63], v[62:63], v[54:55]
  v_pk_add_f32 v[64:65], v[64:65], v[44:45]
  v_pk_add_f32 v[66:67], v[66:67], v[46:47]
  s_branch L_fmv
L_flv:
  v_pk_add_f32 v[56:57], v[56:57], v[44:45]
  v_pk_add_f32 v[58:59], v[58:59], v[46:47]
  v_pk_add_f32 v[60:61], v[60:61], v[48:49]
  v_pk_add_f32 v[62:63], v[62:63], v[50:51]
  v_pk_add_f32 v[64:65], v[64:65], v[52:53]
  v_pk_add_f32 v[66:67], v[66:67], v[54:55]
L_fmv:
  v_add_u32_e64 v9, s43, 16
  ds_write_b32 v14, v9 offset:24
  s_waitcnt vmcnt(8)
  s_add_u32 s44, s78, 0x03030303
  v_msad_u8 v9, s78, v40, 0
  v_msad_u8 v10, s44, v40, 0
  v_msad_u8 v9, s78, v41, v9
  v_msad_u8 v10, s44, v41, v10
  v_msad_u8 v9, s78, v42, v9
  v_msad_u8 v10, s44, v42, v10
  s_mov_b64 exec, 3
  global_store_byte v7, v8, s[30:31]
  global_load_dwordx3 v[40:42], v239, s[30:31] sc1
  v_sub_u32 v9, v9, v10
  v_add3_u32 v10, v26, v27, s58
  v_add_u32 v8, 1, v8
  s_mov_b64 exec, -1
  v_readlane_b32 s66, v9, 0
  v_readlane_b32 s67, v9, 1
  v_readlane_b32 s91, v10, 0
  s_add_u32 s78, s78, 0x01010101
  s_lshl1_add_u32 s69, s91, s95
  s_add_u32 s95, s66, s67
  s_add_u32 s69, s69, s95
  v_mov_b32_dpp v18, v118 row_newbcast:6 row_mask:0xf bank_mask:0xf
  v_cvt_f32_i32 v104, v104
  v_cvt_f32_i32 v105, v105
  v_cvt_f32_i32 v106, v106
  v_cvt_f32_i32 v107, v107
  v_pk_fma_f32 v[64:65], v[104:105], v[18:19], v[64:65] op_sel_hi:[1,0,1]
  v_pk_fma_f32 v[66:67], v[106:107], v[18:19], v[66:67] op_sel_hi:[1,0,1]
  s_cmpk_gt_i32 s69, 0x31
  s_cbranch_scc1 L_p86_4
  s_cmpk_gt_i32 s69, 0xffed
  s_cbranch_scc1 L_p86_1
  s_waitcnt vmcnt(5)
L_p86_1:
  s_waitcnt vmcnt(8)
L_p86_4:
  s_waitcnt vmcnt(9)
  buffer_load_dwordx4 v[92:95], v218, s[36:39], 0 offen nt
  v_mov_b32_dpp v18, v118 row_newbcast:3 row_mask:0xf bank_mask:0xf
  v_cvt_f32_i32 v108, v108
  v_cvt_f32_i32 v109, v109
  v_cvt_f32_i32 v110, v110
  v_cvt_f32_i32 v111, v111
  v_pk_fma_f32 v[60:61], v[108:109], v[18:19], v[60:61] op_sel_hi:[1,0,1]
  v_pk_fma_f32 v[62:63], v[110:111], v[18:19], v[62:63] op_sel_hi:[1,0,1]
  s_cmpk_gt_i32 s69, 0x31
  s_cbranch_scc1 L_p87_4
  s_cmpk_gt_i32 s69, 0xb
  s_cbranch_scc1 L_p87_2
  s_waitcnt vmcnt(6)
L_p87_2:
  s_waitcnt vmcnt(9)
L_p87_4:
  s_waitcnt vmcnt(10)
  buffer_load_dwordx4 v[96:99], v219, s[36:39], 0 offen nt
  v_mov_b32_dpp v18, v118 row_newbcast:7 row_mask:0xf bank_mask:0xf
  v_cvt_f32_i32 v112, v112
  v_cvt_f32_i32 v113, v113
  v_cvt_f32_i32 v114, v114
  v_cvt_f32_i32 v115, v115
  v_pk_fma_f32 v[56:57], v[112:113], v[18:19], v[56:57] op_sel_hi:[1,0,1]
  v_pk_fma_f32 v[58:59], v[114:115], v[18:19], v[58:59] op_sel_hi:[1,0,1]
  s_cmpk_gt_i32 s69, 0x31
  s_cbranch_scc1 L_p88_4
  s_cmpk_gt_i32 s69, 0x1d
  s_cbranch_scc1 L_p88_3
  s_cmpk_gt_i32 s69, 0xffcd
  s_cbranch_scc1 L_p88_0
  s_waitcnt vmcnt(6)
L_p88_0:
  s_waitcnt vmcnt(7)
L_p88_3:
  s_waitcnt vmcnt(10)
L_p88_4:
  s_waitcnt vmcnt(11)
  buffer_load_dwordx4 v[100:103], v220, s[36:39], 0 offen nt
  s_add_u32 s43, s43, 1
  v_permlane32_swap_b32 v56, v58
  v_permlane32_swap_b32 v57, v59
  v_permlane32_swap_b32 v60, v62
  v_permlane32_swap_b32 v61, v63
  v_permlane32_swap_b32 v64, v66
  v_permlane32_swap_b32 v65, v67
  v_add_f32 v56, v56, v62
  v_add_f32 v57, v57, v63
  v_add_f32 v60, v60, v66
  v_add_f32 v61, v61, v67
  v_add_f32 v64, v64, v58
  v_add_f32 v65, v65, v59
  s_add_u32 s44, s43, 16
  s_cmp_eq_u32 s43, 15
  s_cselect_b64 vcc, -1, 0
  v_mov_b32 v4, s44
  v_permlane16_swap_b32 v56, v57
  v_permlane16_swap_b32 v60, v61
  v_permlane16_swap_b32 v64, v65
  v_add_f32 v56, v56, v65
  v_add_f32 v60, v60, v57
  v_add_f32 v64, v64, v61
  s_waitcnt lgkmcnt(0)
  ds_write_b32 v3, v56 offset:0
  ds_write_b32 v3, v60 offset:256
  ds_write_b32 v3, v64 offset:512
  ds_write_b32 v6, v4 offset:0
  v_mov_b32 v118, v119
  v_add_u32 v3, 3072, v3
  s_mov_b64 s[32:33], s[36:37]
  s_add_u32 s45, s43, 1
  s_min_u32 s45, s45, 15
  s_lshl_b32 s68, s45, 2
  s_lshr_b64 s[64:65], s[92:93], s68
  s_and_b32 s68, s64, 15
  s_lshl_b32 s44, s68, 2
  s_lshr_b64 s[64:65], s[96:97], s44
  s_and_b32 s64, s64, 15
  s_lshl4_add_u32 s68, s68, s64
  s_mul_i32 s44, s68, 1572864
  s_add_u32 s36, s12, s44
  s_addc_u32 s37, s13, 0
  s_branch L_v
L_vtail:
  s_waitcnt vmcnt(10)
  v_mov_b32_dpp v18, v117 row_newbcast:7 row_mask:0xf bank_mask:0xf
  v_cvt_f32_i32 v80, v80
  v_cvt_f32_i32 v81, v81
  v_cvt_f32_i32 v82, v82
  v_cvt_f32_i32 v83, v83
  v_pk_fma_f32 v[64:65], v[80:81], v[18:19], v[64:65] op_sel_hi:[1,0,1]
  v_pk_fma_f32 v[66:67], v[82:83], v[18:19], v[66:67] op_sel_hi:[1,0,1]
  s_waitcnt vmcnt(9)
  v_mov_b32_dpp v18, v118 row_newbcast:0 row_mask:0xf bank_mask:0xf
  v_cvt_f32_i32 v84, v84
  v_cvt_f32_i32 v85, v85
  v_cvt_f32_i32 v86, v86
  v_cvt_f32_i32 v87, v87
  v_pk_fma_f32 v[52:53], v[84:85], v[18:19], v[52:53] op_sel_hi:[1,0,1]
  v_pk_fma_f32 v[54:55], v[86:87], v[18:19], v[54:55] op_sel_hi:[1,0,1]
  s_waitcnt vmcnt(8)
  v_mov_b32_dpp v18, v118 row_newbcast:4 row_mask:0xf bank_mask:0xf
  v_cvt_f32_i32 v88, v88
  v_cvt_f32_i32 v89, v89
  v_cvt_f32_i32 v90, v90
  v_cvt_f32_i32 v91, v91
  v_pk_fma_f32 v[48:49], v[88:89], v[18:19], v[48:49] op_sel_hi:[1,0,1]
  v_pk_fma_f32 v[50:51], v[90:91], v[18:19], v[50:51] op_sel_hi:[1,0,1]
  s_waitcnt vmcnt(6)
  v_mov_b32_dpp v18, v118 row_newbcast:1 row_mask:0xf bank_mask:0xf
  v_cvt_f32_i32 v92, v92
  v_cvt_f32_i32 v93, v93
  v_cvt_f32_i32 v94, v94
  v_cvt_f32_i32 v95, v95
  v_pk_fma_f32 v[44:45], v[92:93], v[18:19], v[44:45] op_sel_hi:[1,0,1]
  v_pk_fma_f32 v[46:47], v[94:95], v[18:19], v[46:47] op_sel_hi:[1,0,1]
  s_waitcnt vmcnt(5)
  v_mov_b32_dpp v18, v118 row_newbcast:5 row_mask:0xf bank_mask:0xf
  v_cvt_f32_i32 v96, v96
  v_cvt_f32_i32 v97, v97
  v_cvt_f32_i32 v98, v98
  v_cvt_f32_i32 v99, v99
  v_pk_fma_f32 v[52:53], v[96:97], v[18:19], v[52:53] op_sel_hi:[1,0,1]
  v_pk_fma_f32 v[54:55], v[98:99], v[18:19], v[54:55] op_sel_hi:[1,0,1]
  s_cmp_eq_u32 s62, 0
  s_cbranch_scc1 L_flt
  v_pk_add_f32 v[56:57], v[56:57], v[48:49]
  v_pk_add_f32 v[58:59], v[58:59], v[50:51]
  v_pk_add_f32 v[60:61], v[60:61], v[52:53]
  v_pk_add_f32 v[62:63], v[62:63], v[54:55]
  v_pk_add_f32 v[64:65], v[64:65], v[44:45]
  v_pk_add_f32 v[66:67], v[66:67], v[46:47]
  s_branch L_fmt
L_flt:
  v_pk_add_f32 v[56:57], v[56:57], v[44:45]
  v_pk_add_f32 v[58:59], v[58:59], v[46:47]
  v_pk_add_f32 v[60:61], v[60:61], v[48:49]
  v_pk_add_f32 v[62:63], v[62:63], v[50:51]
  v_pk_add_f32 v[64:65], v[64:65], v[52:53]
  v_pk_add_f32 v[66:67], v[66:67], v[54:55]
L_fmt:
  s_waitcnt vmcnt(4)
  v_mov_b32_dpp v18, v118 row_newbcast:2 row_mask:0xf bank_mask:0xf
  v_cvt_f32_i32 v100, v100
  v_cvt_f32_i32 v101, v101
  v_cvt_f32_i32 v102, v102
  v_cvt_f32_i32 v103, v103
  v_pk_fma_f32 v[56:57], v[100:101], v[18:19], v[56:57] op_sel_hi:[1,0,1]
  v_pk_fma_f32 v[58:59], v[102:103], v[18:19], v[58:59] op_sel_hi:[1,0,1]
  s_waitcnt vmcnt(2)
  v_mov_b32_dpp v18, v118 row_newbcast:6 row_mask:0xf bank_mask:0xf
  v_cvt_f32_i32 v104, v104
  v_cvt_f32_i32 v105, v105
  v_cvt_f32_i32 v106, v106
  v_cvt_f32_i32 v107, v107
  v_pk_fma_f32 v[64:65], v[104:105], v[18:19], v[64:65] op_sel_hi:[1,0,1]
  v_pk_fma_f32 v[66:67], v[106:107], v[18:19], v[66:67] op_sel_hi:[1,0,1]
  s_waitcnt vmcnt(1)
  v_mov_b32_dpp v18, v118 row_newbcast:3 row_mask:0xf bank_mask:0xf
  v_cvt_f32_i32 v108, v108
  v_cvt_f32_i32 v109, v109
  v_cvt_f32_i32 v110, v110
  v_cvt_f32_i32 v111, v111
  v_pk_fma_f32 v[60:61], v[108:109], v[18:19], v[60:61] op_sel_hi:[1,0,1]
  v_pk_fma_f32 v[62:63], v[110:111], v[18:19], v[62:63] op_sel_hi:[1,0,1]
  v_permlane32_swap_b32 v64, v66
  v_permlane32_swap_b32 v65, v67
  v_permlane32_swap_b32 v60, v62
  v_permlane32_swap_b32 v61, v63
  v_add_f32 v60, v60, v66
  v_add_f32 v61, v61, v67
  s_waitcnt vmcnt(0)
  v_mov_b32_dpp v18, v118 row_newbcast:7 row_mask:0xf bank_mask:0xf
  v_cvt_f32_i32 v112, v112
  v_cvt_f32_i32 v113, v113
  v_cvt_f32_i32 v114, v114
  v_cvt_f32_i32 v115, v115
  v_pk_fma_f32 v[56:57], v[112:113], v[18:19], v[56:57] op_sel_hi:[1,0,1]
  v_pk_fma_f32 v[58:59], v[114:115], v[18:19], v[58:59] op_sel_hi:[1,0,1]
  v_permlane16_swap_b32 v60, v61
  s_nop 0
  v_permlane32_swap_b32 v56, v58
  v_permlane32_swap_b32 v57, v59
  v_add_f32 v64, v64, v58
  v_add_f32 v65, v65, v59
  v_add_f32 v56, v56, v62
  v_add_f32 v57, v57, v63
  v_permlane16_swap_b32 v64, v65
  v_add_f32 v64, v64, v61
  v_permlane16_swap_b32 v56, v57
  ds_write_b32 v3, v64 offset:512
  v_add_f32 v60, v60, v57
  v_add_f32 v56, v56, v65
  ds_write_b32 v3, v60 offset:256
  ds_write_b32 v3, v56 offset:0
  s_waitcnt lgkmcnt(0)
  s_barrier
  s_endpgm
L_helper:
  s_getreg_b32 s81, hwreg(HW_REG_HW_ID, 13, 2)
  s_getreg_b32 s79, hwreg(HW_REG_HW_ID, 8, 4)
  s_getreg_b32 s46, hwreg(HW_REG_XCC_ID, 0, 3)
  s_mul_i32 s46, s46, 4352
  s_add_u32 s46, s46, 8126464
  v_lshrrev_b32 v24, 1, v20
  v_lshl_add_u32 v42, v24, 8, s46
  v_and_b32 v24, 1, v20
  v_lshl_add_u32 v42, v24, 4, v42
  s_mov_b64 exec, 0x3ffff
  global_store_dwordx4 v42, v[48:51], s[30:31]
  s_mov_b64 exec, -1
  s_add_u32 s68, s42, 32
  s_mul_i32 s44, s68, 384
  s_add_u32 s32, s4, s44
  s_addc_u32 s33, s5, 0
  global_load_dwordx2 v[68:69], v26, s[32:33]
  global_load_dwordx2 v[70:71], v27, s[32:33]
  s_setprio 0
  s_getpc_b64 s[82:83]
L_pc89:
  s_lshl_b32 s44, s2, 6
  s_add_u32 s44, s44, L_order-L_pc89
  s_add_u32 s82, s82, s44
  s_addc_u32 s83, s83, 0
  s_load_dwordx2 s[92:93], s[82:83], 0
  s_load_dwordx2 s[96:97], s[82:83], 8
  s_mov_b32 s94, 4000000
  s_and_b32 s41, s2, 7
  s_lshl_b32 s41, s41, 1
  s_bitcmp1_b32 s2, 3
  s_addc_u32 s41, s41, 0
  s_load_dword s3, s[82:83], 24
  s_load_dwordx2 s[98:99], s[82:83], 16
  s_waitcnt vmcnt(0)
  ds_write_b32 v14, v38 offset:24
  s_waitcnt lgkmcnt(0)
  v_min_u32 v22, 2, v20
  v_lshlrev_b32 v23, 3, v22
  v_bfe_u32 v23, s99, v23, 8
  v_mul_u32_u24 v36, 4352, v23
  v_add_u32 v36, 7340032, v36
  v_and_b32 v23, 15, v23
  v_lshlrev_b32 v37, 4, v23
  v_lshl_add_u32 v22, v22, 4, s42
  v_mul_u32_u24 v45, 4352, v22
  v_add_u32 v45, 7340032, v45
  s_and_b32 s45, s81, 2
  s_lshl_b32 s44, s45, 9
  s_add_u32 s44, s44, s46
  v_add_u32 v44, s44, v20
  s_lshl_b32 s45, s45, 1
  s_add_u32 s46, s46, s45
  s_add_u32 s46, s46, 2048
  v_mov_b32 v43, s46
  v_mul_u32_u24 v39, 384, v20
  v_add_u32 v39, 7864320, v39
  v_mov_b32 v40, 0
  s_mov_b32 s47, 0
  s_mov_b32 s90, 0
  s_mov_b32 s80, 0
  v_add_u32 v33, 0, v20
  s_and_b32 s44, s41, 1
  v_add_u32 v23, s44, v33
  v_cmp_le_u32 vcc, 43, v23
  s_add_u32 s45, s44, 42
  v_mov_b32 v24, s45
  v_cndmask_b32 v24, 0, v24, vcc
  v_cmp_le_u32 vcc, 86, v23
  v_add_u32 v22, v33, v24
  s_sub_u32 s45, 43, s44
  v_mov_b32 v24, s45
  v_cndmask_b32 v24, 0, v24, vcc
  s_mul_i32 s44, s44, 43
  s_lshr_b32 s45, s41, 1
  s_lshl_b32 s45, s45, 8
  s_add_u32 s44, s44, s45
  v_add3_u32 v22, v22, v24, s44
  v_and_b32 v33, 255, v22
  v_lshlrev_b32 v33, 1, v33
  v_add_u32 v34, 64, v20
  s_and_b32 s44, s41, 1
  v_add_u32 v23, s44, v34
  v_cmp_le_u32 vcc, 43, v23
  s_add_u32 s45, s44, 42
  v_mov_b32 v24, s45
  v_cndmask_b32 v24, 0, v24, vcc
  v_cmp_le_u32 vcc, 86, v23
  v_add_u32 v22, v34, v24
  s_sub_u32 s45, 43, s44
  v_mov_b32 v24, s45
  v_cndmask_b32 v24, 0, v24, vcc
  s_mul_i32 s44, s44, 43
  s_lshr_b32 s45, s41, 1
  s_lshl_b32 s45, s45, 8
  s_add_u32 s44, s44, s45
  v_add3_u32 v22, v22, v24, s44
  v_and_b32 v34, 255, v22
  v_lshlrev_b32 v34, 1, v34
  v_lshlrev_b32 v46, 2, v20
  v_mul_u32_u24 v199, 12, v20
  v_add_u32 v199, 45568, v199
  s_mov_b32 s101, 0
  v_mov_b32 v47, 118912
  v_mov_b32 v51, -1
  v_mov_b32 v60, 0
  v_mov_b32 v61, 0
  v_mov_b32 v62, 0
  v_mov_b32 v63, 0
  v_mov_b32 v64, 0
  v_mov_b32 v65, 0
  v_mov_b32 v66, 0
  v_mov_b32 v67, 0
  s_and_b32 s45, s2, 7
  s_lshl_b32 s45, s45, 9
  v_and_b32 v22, 31, v20
  v_lshl_add_u32 v22, v22, 4, s45
  v_lshrrev_b32 v23, 5, v20
  v_lshl_add_u32 v22, v23, 16, v22
  v_lshlrev_b32 v23, 2, v23
  s_lshr_b32 s44, s96, 0
  v_bfe_u32 v24, s44, v23, 4
  v_lshl_add_u32 v188, v24, 12, v22
  v_add_u32 v22, 0x20000, v22
  s_lshr_b32 s44, s96, 8
  v_bfe_u32 v24, s44, v23, 4
  v_lshl_add_u32 v189, v24, 12, v22
  v_add_u32 v22, 0x20000, v22
  s_lshr_b32 s44, s96, 16
  v_bfe_u32 v24, s44, v23, 4
  v_lshl_add_u32 v190, v24, 12, v22
  v_add_u32 v22, 0x20000, v22
  s_lshr_b32 s44, s96, 24
  v_bfe_u32 v24, s44, v23, 4
  v_lshl_add_u32 v191, v24, 12, v22
  v_add_u32 v22, 0x20000, v22
  s_lshr_b32 s44, s97, 0
  v_bfe_u32 v24, s44, v23, 4
  v_lshl_add_u32 v192, v24, 12, v22
  v_add_u32 v22, 0x20000, v22
  s_lshr_b32 s44, s97, 8
  v_bfe_u32 v24, s44, v23, 4
  v_lshl_add_u32 v193, v24, 12, v22
  v_add_u32 v22, 0x20000, v22
  s_lshr_b32 s44, s97, 16
  v_bfe_u32 v24, s44, v23, 4
  v_lshl_add_u32 v194, v24, 12, v22
  v_add_u32 v22, 0x20000, v22
  s_lshr_b32 s44, s97, 24
  v_bfe_u32 v24, s44, v23, 4
  v_lshl_add_u32 v195, v24, 12, v22
  s_mov_b32 s69, 0
  s_movk_i32 m0, 4608
  s_branch L_hq_nl
L_hk:
  s_sub_u32 s47, s43, 1
L_hsw:
  ds_read_b128 v[104:107], v14 offset:0
  s_waitcnt lgkmcnt(0)
  v_min_u32 v104, v104, v105
  v_min3_u32 v104, v104, v106, v107
  s_nop 0
  v_readfirstlane_b32 s46, v104
  s_cmp_ge_u32 s46, s47
  s_cbranch_scc1 L_hsw_ok
  s_cmp_eq_u32 s94, 0
  s_cbranch_scc1 L_hsw_ok
  s_sub_u32 s94, s94, 1
  s_sleep 1
  s_branch L_hsw
L_hsw_ok:
  s_bitcmp1_b32 s80, s47
  s_cbranch_scc0 L_fas
  s_mul_i32 s44, s47, 384
  s_add_u32 s44, s44, 7864320
  s_movk_i32 s78, 1
  s_atomic_add s78, s[30:31], s44 glc
  s_mov_b64 exec, 1
  global_load_dword v41, v43, s[30:31] offset:8 sc1
  s_mov_b64 exec, -1
L_fas:
  s_cmp_lt_u32 s43, 5
  s_cbranch_scc1 L_hs_done
  s_add_u32 s68, s69, 2
  s_min_u32 s68, s68, s47
L_hs:
  ds_read_u16_d16_hi v60, v33 offset:4608
  ds_read_u16_d16_hi v61, v34 offset:4608
  ds_read_u16_d16_hi v62, v33 offset:12800
  ds_read_u16_d16_hi v63, v34 offset:12800
  ds_read_u16_d16_hi v64, v33 offset:20992
  ds_read_u16_d16_hi v65, v34 offset:20992
  ds_read_u16_d16_hi v66, v33 offset:29184
  ds_read_u16_d16_hi v67, v34 offset:29184
  v_add_u32 v200, s101, v199
  v_add_u32 v201, 1536, v200
  s_addk_i32 s101, 3072
  s_cmpk_eq_u32 s101, 18432
  s_cselect_b32 s101, 0, s101
  s_add_u32 s69, s69, 1
  s_waitcnt lgkmcnt(4)
  ds_read2_b32 v[76:77], v200 offset0:0 offset1:1
  ds_read_b32 v72, v200 offset:8
  ds_read2_b32 v[78:79], v200 offset0:192 offset1:193
  ds_read_b32 v73, v200 offset:776
  ds_read2_b32 v[80:81], v201 offset0:0 offset1:1
  ds_read_b32 v74, v201 offset:8
  ds_read2_b32 v[82:83], v201 offset0:192 offset1:193
  ds_read_b32 v75, v201 offset:776
  s_waitcnt lgkmcnt(0)
  v_add_f32 v76, v76, v77
  v_add_f32 v78, v78, v79
  v_add_f32 v80, v80, v81
  v_add_f32 v82, v82, v83
  v_add_f32 v72, v72, v76
  v_add_f32 v73, v73, v78
  v_add_f32 v74, v74, v80
  v_add_f32 v75, v75, v82
  v_fma_f32 v72, -v62, v74, v72
  v_fma_f32 v73, -v63, v75, v73
  v_mul_f32 v74, s67, v60
  v_mul_f32 v75, s67, v61
  v_mul_f32 v72, v72, v74
  v_mul_f32 v73, v73, v75
  v_max_f32 v48, v72, v73
  s_nop 1
  v_max_f32_dpp v48, v48, v48 row_ror:8 row_mask:0xf bank_mask:0xf
  s_nop 1
  v_max_f32_dpp v48, v48, v48 row_ror:4 row_mask:0xf bank_mask:0xf
  s_nop 1
  v_max_f32_dpp v48, v48, v48 row_ror:2 row_mask:0xf bank_mask:0xf
  s_nop 1
  v_max_f32_dpp v48, v48, v48 row_ror:1 row_mask:0xf bank_mask:0xf
  v_mov_b32 v22, v48
  s_nop 1
  v_permlane16_swap_b32 v48, v22
  v_max_f32 v48, v48, v22
  v_mov_b32 v22, v48
  s_nop 1
  v_permlane32_swap_b32 v48, v22
  v_max_f32 v48, v48, v22
  v_sub_f32 v72, v72, v48
  v_sub_f32 v73, v73, v48
  v_exp_f32 v72, v72
  v_exp_f32 v73, v73
  s_nop 0
  v_add_f32 v49, v72, v73
  v_mul_f32 v72, v72, v64
  v_mul_f32 v73, v73, v65
  v_mul_f32 v50, v72, v66
  v_fmac_f32 v50, v73, v67
  ds_write_b32 v46, v72 offset:37376
  ds_write_b32 v46, v73 offset:37632
  s_nop 1
  v_add_f32_dpp v49, v49, v49 row_ror:8 row_mask:0xf bank_mask:0xf
  s_nop 1
  v_add_f32_dpp v49, v49, v49 row_ror:4 row_mask:0xf bank_mask:0xf
  s_nop 1
  v_add_f32_dpp v49, v49, v49 row_ror:2 row_mask:0xf bank_mask:0xf
  s_nop 1
  v_add_f32_dpp v49, v49, v49 row_ror:1 row_mask:0xf bank_mask:0xf
  v_mov_b32 v22, v49
  s_nop 1
  v_permlane16_swap_b32 v49, v22
  v_add_f32 v49, v49, v22
  v_mov_b32 v22, v49
  s_nop 1
  v_permlane32_swap_b32 v49, v22
  v_add_f32 v49, v49, v22
  s_nop 1
  v_add_f32_dpp v50, v50, v50 row_ror:8 row_mask:0xf bank_mask:0xf
  s_nop 1
  v_add_f32_dpp v50, v50, v50 row_ror:4 row_mask:0xf bank_mask:0xf
  s_nop 1
  v_add_f32_dpp v50, v50, v50 row_ror:2 row_mask:0xf bank_mask:0xf
  s_nop 1
  v_add_f32_dpp v50, v50, v50 row_ror:1 row_mask:0xf bank_mask:0xf
  v_mov_b32 v22, v50
  s_nop 1
  v_permlane16_swap_b32 v50, v22
  v_add_f32 v50, v50, v22
  v_mov_b32 v22, v50
  s_nop 1
  v_permlane32_swap_b32 v50, v22
  v_add_f32 v50, v50, v22
  v_mov_b32 v22, s69
  ds_write_b128 v47, v[48:51]
  ds_write_b32 v14, v22 offset:20
  v_add_u32 v46, 512, v46
  v_add_u32 v47, 16, v47
  v_add_u32 v33, 512, v33
  v_add_u32 v34, 512, v34
  s_cmp_lt_u32 s69, s68
  s_cbranch_scc1 L_hs
L_hs_done:
  s_bitcmp1_b32 s80, s47
  s_cbranch_scc0 L_fbs
  s_waitcnt vmcnt(0) lgkmcnt(0)
  v_readlane_b32 s46, v40, s47
  s_sub_u32 s78, s78, s46
  s_bfe_u32 s46, s78, 0x80000
  s_min_u32 s46, s46, 15
  s_lshl_b32 s46, s46, 1
  s_sub_u32 s46, s46, 15
  v_readfirstlane_b32 s95, v41
  s_mul_i32 s45, s46, 6
  s_ashr_i32 s44, s95, 3
  s_sub_u32 s95, s95, s44
  s_cmp_lt_i32 s46, 0
  s_cselect_b32 s95, s95, 0
  s_cselect_b32 s45, -48, 0
  s_add_u32 s45, s45, s95
  v_mov_b32 v41, s45
  s_lshl4_add_u32 s46, s46, s95
  s_cmp_gt_i32 s46, 0
  s_cselect_b32 s44, 3, 6
  s_mul_i32 s46, s46, s44
  s_add_u32 s46, s46, 128
  s_ashr_i32 s46, s46, 8
  v_mov_b32 v42, s46
  s_mov_b64 exec, 1
  global_store_dword v43, v42, s[30:31]
  global_store_dword v43, v41, s[30:31] offset:8
  s_mov_b64 exec, -1
L_fbs:
  s_cmp_eq_u32 s47, 1
  s_cbranch_scc0 L_el
  s_bitcmp0_b32 s81, 0
  s_cbranch_scc0 L_el
  s_mov_b64 exec, 0xffff
  global_load_ubyte v42, v44, s[30:31] sc1
  s_waitcnt vmcnt(0)
  v_cmp_ne_u32 s[64:65], 0, v42
  s_lshr_b32 s44, s64, s79
  s_bcnt1_i32_b32 s44, s44
  s_sub_u32 s45, s44, 1
  s_cmp_lt_u32 s45, 7
  s_cbranch_scc0 L_el
  s_lshl_b32 s80, 0x10204081, s45
  s_and_b32 s80, s80, 0x7ffffffc
  s_mov_b32 exec_lo, s80
  global_load_dword v40, v39, s[30:31] sc1
L_el:
  s_mov_b64 exec, -1
L_hq:
  s_add_u32 s43, s43, 1
  s_cmp_gt_u32 s43, 16
  s_cbranch_scc1 L_hq_nl
  s_waitcnt vmcnt(0)
  v_lshlrev_b32 v76, 16, v68
  v_and_b32 v77, s66, v68
  v_lshlrev_b32 v78, 16, v69
  v_and_b32 v79, s66, v69
  v_lshlrev_b32 v80, 16, v70
  v_and_b32 v81, s66, v70
  v_lshlrev_b32 v82, 16, v71
  v_and_b32 v83, s66, v71
  v_mul_f32 v76, v76, v52
  v_mul_f32 v77, v77, v53
  v_mul_f32 v78, v78, v54
  v_mul_f32 v79, v79, v55
  v_mul_f32 v80, v80, v56
  v_mul_f32 v81, v81, v57
  v_mul_f32 v82, v82, v58
  v_mul_f32 v83, v83, v59
  v_cvt_pk_bf16_f32 v84, v76, v80
  v_cvt_pk_bf16_f32 v85, v77, v81
  v_cvt_pk_bf16_f32 v86, v78, v82
  v_cvt_pk_bf16_f32 v87, v79, v83
  v_lshlrev_b32 v76, 16, v84
  v_and_b32 v80, s66, v84
  v_lshlrev_b32 v77, 16, v85
  v_and_b32 v81, s66, v85
  v_lshlrev_b32 v78, 16, v86
  v_and_b32 v82, s66, v86
  v_lshlrev_b32 v79, 16, v87
  v_and_b32 v83, s66, v87
  v_fma_f32 v76, v80, v30, v76
  v_fma_f32 v77, v81, v30, v77
  v_fma_f32 v78, v82, v30, v78
  v_fma_f32 v79, v83, v30, v79
  v_cvt_pk_bf16_f32 v84, v76, v77
  v_cvt_pk_bf16_f32 v85, v78, v79
  v_xor_b32 v86, v31, v84
  v_xor_b32 v87, v31, v85
  v_mov_b32 v22, s43
  ds_write_b16 v28, v84 offset:512
  ds_write_b16_d16_hi v28, v84 offset:516
  ds_write_b16 v28, v85 offset:520
  ds_write_b16_d16_hi v28, v85 offset:524
  ds_write_b16 v29, v86 offset:514
  ds_write_b16_d16_hi v29, v86 offset:518
  ds_write_b16 v29, v87 offset:522
  ds_write_b16_d16_hi v29, v87 offset:526
  ds_write_b32 v14, v22 offset:16
  v_add_u32 v28, 1024, v28
  v_add_u32 v29, 1024, v29
  v_and_b32 v28, 0xfff, v28
  v_and_b32 v29, 0xfff, v29
  s_cmp_eq_u32 s43, 16
  s_cbranch_scc1 L_hq_nl
  s_lshl_b32 s44, s43, 2
  s_lshr_b64 s[64:65], s[96:97], s44
  s_and_b32 s64, s64, 15
  s_lshl4_add_u32 s68, s43, s64
  s_mul_i32 s44, s68, 384
  s_add_u32 s32, s4, s44
  s_addc_u32 s33, s5, 0
  global_load_dwordx2 v[68:69], v26, s[32:33]
  global_load_dwordx2 v[70:71], v27, s[32:33]
L_hq_nl:
  s_sub_u32 s44, s43, 4
  s_cmp_lt_u32 s44, 2
  s_cbranch_scc0 L_sc_done
  global_load_lds_dwordx4 v188, s[8:9]
  s_addk_i32 m0, 1024
  s_waitcnt vmcnt(3)
  global_load_lds_dwordx4 v189, s[8:9]
  s_addk_i32 m0, 1024
  s_waitcnt vmcnt(3)
  global_load_lds_dwordx4 v190, s[8:9]
  s_addk_i32 m0, 1024
  s_waitcnt vmcnt(3)
  global_load_lds_dwordx4 v191, s[8:9]
  s_addk_i32 m0, 1024
  s_waitcnt vmcnt(3)
  global_load_lds_dwordx4 v192, s[8:9]
  s_addk_i32 m0, 1024
  s_waitcnt vmcnt(3)
  global_load_lds_dwordx4 v193, s[8:9]
  s_addk_i32 m0, 1024
  s_waitcnt vmcnt(3)
  global_load_lds_dwordx4 v194, s[8:9]
  s_addk_i32 m0, 1024
  s_waitcnt vmcnt(3)
  global_load_lds_dwordx4 v195, s[8:9]
  s_addk_i32 m0, 1024
  s_mov_b64 s[8:9], s[10:11]
  s_mov_b64 s[10:11], s[14:15]
  s_mov_b64 s[14:15], s[16:17]
  s_waitcnt vmcnt(3)
  global_load_lds_dwordx4 v188, s[8:9]
  s_addk_i32 m0, 1024
  s_waitcnt vmcnt(3)
  global_load_lds_dwordx4 v189, s[8:9]
  s_addk_i32 m0, 1024
  s_waitcnt vmcnt(3)
  global_load_lds_dwordx4 v190, s[8:9]
  s_addk_i32 m0, 1024
  s_waitcnt vmcnt(3)
  global_load_lds_dwordx4 v191, s[8:9]
  s_addk_i32 m0, 1024
  s_waitcnt vmcnt(3)
  global_load_lds_dwordx4 v192, s[8:9]
  s_addk_i32 m0, 1024
  s_waitcnt vmcnt(3)
  global_load_lds_dwordx4 v193, s[8:9]
  s_addk_i32 m0, 1024
  s_waitcnt vmcnt(3)
  global_load_lds_dwordx4 v194, s[8:9]
  s_addk_i32 m0, 1024
  s_waitcnt vmcnt(3)
  global_load_lds_dwordx4 v195, s[8:9]
  s_addk_i32 m0, 1024
  s_mov_b64 s[8:9], s[10:11]
  s_mov_b64 s[10:11], s[14:15]
  s_mov_b64 s[14:15], s[16:17]
  s_cmp_eq_u32 s43, 5
  s_cbranch_scc0 L_sc_done
  s_waitcnt vmcnt(0)
L_sc_done:
  s_cmp_eq_u32 s43, 16
  s_cbranch_scc0 L_hq_skip
  s_cmp_eq_u32 s3, 0
  s_cbranch_scc0 L_hq_skip
  s_mov_b64 exec, 7
  global_store_dword v45, v14, s[30:31] sc1
  s_waitcnt vmcnt(0)
  s_mov_b64 exec, 1
  global_store_dword v37, v38, s[28:29] sc1
  s_mov_b64 exec, -1
L_hq_skip:
  s_waitcnt lgkmcnt(0)
  s_cmp_lt_u32 s43, 18
  s_cbranch_scc1 L_hk
  v_and_b32 v24, 15, v20
  v_lshlrev_b32 v24, 1, v24
  global_load_ushort v25, v24, s[82:83] offset:32
  s_mov_b32 s43, 0
  v_min_u32 v28, 23, v20
  v_lshlrev_b32 v28, 4, v28
  v_lshlrev_b32 v22, 1, v28
  s_and_b32 s44, s41, 1
  v_lshl_add_u32 v196, s44, 8, v22
  v_subrev_u32 v197, 768, v196
  v_min_u32 v196, v196, v197
  v_subrev_u32 v29, 256, v196
  v_add_u32 v197, 512, v196
  v_min_u32 v197, v29, v197
  v_subrev_u32 v29, 512, v196
  v_add_u32 v198, 256, v196
  v_min_u32 v198, v29, v198
  v_add_u32 v196, 64000, v196
  v_add_u32 v197, 64000, v197
  v_add_u32 v198, 64000, v198
  v_add_u32 v28, 113152, v28
  v_lshlrev_b32 v32, 4, v20
  v_add_u32 v30, 113152, v32
  v_cmp_gt_u32 vcc, 24, v20
  v_lshrrev_b32 v21, 1, v35
  s_mul_i32 s44, s98, 384
  s_add_u32 s26, s26, s44
  s_addc_u32 s27, s27, 0
  v_mov_b32 v31, s2
  v_mul_u32_u24 v31, 6144, v31
  v_add_u32 v31, 8388608, v31
  v_add_u32 v23, 0, v32
  v_add_u32 v188, v23, v31
  v_add_u32 v23, 1024, v32
  v_add_u32 v189, v23, v31
  v_add_u32 v23, 2048, v32
  v_add_u32 v190, v23, v31
  v_add_u32 v23, 3072, v32
  v_add_u32 v191, v23, v31
  v_add_u32 v23, 4096, v32
  v_add_u32 v192, v23, v31
  v_add_u32 v23, 5120, v32
  v_add_u32 v193, v23, v31
  s_mov_b32 s45, 14
  s_lshl_b32 s68, s45, 2
  s_lshr_b64 s[64:65], s[92:93], s68
  s_and_b32 s68, s64, 15
  v_lshl_add_u32 v23, s68, 4, v32
  v_cndmask_b32 v23, v23, v32, vcc
  v_add_u32 v23, 5376, v23
  v_add_u32 v168, v23, v31
  s_waitcnt vmcnt(0)
  v_lshrrev_b32 v31, 4, v25
  v_mul_u32_u24 v31, 6144, v31
  v_add_u32 v31, 8388608, v31
  v_and_b32 v25, 15, v25
  v_mul_u32_u24 v25, 384, v25
  s_lshl4_add_u32 s44, s3, 5760
  v_mov_b32 v23, s44
  v_add_u32 v187, v23, v31
  v_add_u32_dpp v23, v25, v21 row_newbcast:0 row_mask:0xf bank_mask:0xf
  v_mov_b32_dpp v29, v31 row_newbcast:0 row_mask:0xf bank_mask:0xf
  v_add_u32 v172, v23, v29
  v_add_u32_dpp v23, v25, v21 row_newbcast:1 row_mask:0xf bank_mask:0xf
  v_mov_b32_dpp v29, v31 row_newbcast:1 row_mask:0xf bank_mask:0xf
  v_add_u32 v173, v23, v29
  v_add_u32_dpp v23, v25, v21 row_newbcast:2 row_mask:0xf bank_mask:0xf
  v_mov_b32_dpp v29, v31 row_newbcast:2 row_mask:0xf bank_mask:0xf
  v_add_u32 v174, v23, v29
  v_add_u32_dpp v23, v25, v21 row_newbcast:3 row_mask:0xf bank_mask:0xf
  v_mov_b32_dpp v29, v31 row_newbcast:3 row_mask:0xf bank_mask:0xf
  v_add_u32 v175, v23, v29
  v_add_u32_dpp v23, v25, v21 row_newbcast:4 row_mask:0xf bank_mask:0xf
  v_mov_b32_dpp v29, v31 row_newbcast:4 row_mask:0xf bank_mask:0xf
  v_add_u32 v176, v23, v29
  v_add_u32_dpp v23, v25, v21 row_newbcast:5 row_mask:0xf bank_mask:0xf
  v_mov_b32_dpp v29, v31 row_newbcast:5 row_mask:0xf bank_mask:0xf
  v_add_u32 v177, v23, v29
  v_add_u32_dpp v23, v25, v21 row_newbcast:6 row_mask:0xf bank_mask:0xf
  v_mov_b32_dpp v29, v31 row_newbcast:6 row_mask:0xf bank_mask:0xf
  v_add_u32 v178, v23, v29
  v_add_u32_dpp v23, v25, v21 row_newbcast:7 row_mask:0xf bank_mask:0xf
  v_mov_b32_dpp v29, v31 row_newbcast:7 row_mask:0xf bank_mask:0xf
  v_add_u32 v179, v23, v29
  v_add_u32_dpp v23, v25, v21 row_newbcast:8 row_mask:0xf bank_mask:0xf
  v_mov_b32_dpp v29, v31 row_newbcast:8 row_mask:0xf bank_mask:0xf
  v_add_u32 v180, v23, v29
  v_add_u32_dpp v23, v25, v21 row_newbcast:9 row_mask:0xf bank_mask:0xf
  v_mov_b32_dpp v29, v31 row_newbcast:9 row_mask:0xf bank_mask:0xf
  v_add_u32 v181, v23, v29
  v_add_u32_dpp v23, v25, v21 row_newbcast:10 row_mask:0xf bank_mask:0xf
  v_mov_b32_dpp v29, v31 row_newbcast:10 row_mask:0xf bank_mask:0xf
  v_add_u32 v182, v23, v29
  v_add_u32_dpp v23, v25, v21 row_newbcast:11 row_mask:0xf bank_mask:0xf
  v_mov_b32_dpp v29, v31 row_newbcast:11 row_mask:0xf bank_mask:0xf
  v_add_u32 v183, v23, v29
  v_add_u32_dpp v23, v25, v21 row_newbcast:12 row_mask:0xf bank_mask:0xf
  v_mov_b32_dpp v29, v31 row_newbcast:12 row_mask:0xf bank_mask:0xf
  v_add_u32 v184, v23, v29
  v_add_u32_dpp v23, v25, v21 row_newbcast:13 row_mask:0xf bank_mask:0xf
  v_mov_b32_dpp v29, v31 row_newbcast:13 row_mask:0xf bank_mask:0xf
  v_add_u32 v185, v23, v29
  v_add_u32_dpp v23, v25, v21 row_newbcast:14 row_mask:0xf bank_mask:0xf
  v_mov_b32_dpp v29, v31 row_newbcast:14 row_mask:0xf bank_mask:0xf
  v_add_u32 v186, v23, v29
  v_mov_b32 v108, -1
  v_mov_b32 v109, -1
  v_mov_b32 v110, -1
  v_mov_b32 v111, -1
  s_lshl4_add_u32 s44, s3, 118912
  v_mov_b32 v23, s44
  ds_write_b128 v28, v[108:111] offset:5376
  ds_write_b32 v23, v38 offset:12
L_hp:
  s_min_u32 s44, s3, 13
  s_cmp_eq_u32 s44, s43
  s_cbranch_scc0 L_hc_ok
L_hc:
  global_load_dword v104, v37, s[28:29] sc1
  s_waitcnt vmcnt(0)
  v_cmp_ne_u32 s[64:65], 1, v104
  s_cmp_eq_u64 s[64:65], 0
  s_cbranch_scc1 L_hc_ok
  s_cmp_eq_u32 s94, 0
  s_cbranch_scc1 L_hc_ok
  s_sub_u32 s94, s94, 1
  s_sleep 64
  s_branch L_hc
L_hc_ok:
  s_lshl_b32 s68, s43, 2
  s_lshr_b64 s[64:65], s[92:93], s68
  s_and_b32 s68, s64, 15
  s_lshl4_add_u32 s44, s68, 118912
  v_mov_b32 v23, s44
  s_cmp_eq_u32 s43, 14
  s_cbranch_scc0 L_hp_mid
  ds_read_b128 v[144:147], v30 offset:0
  ds_read_b128 v[148:151], v30 offset:1024
  ds_read_b128 v[152:155], v30 offset:2048
  ds_read_b128 v[156:159], v30 offset:3072
  ds_read_b128 v[160:163], v30 offset:4096
  ds_read_b128 v[164:167], v30 offset:5120
L_hm:
  ds_read_b32 v104, v14 offset:24
  s_waitcnt lgkmcnt(0)
  v_readfirstlane_b32 s46, v104
  s_cmp_ge_u32 s46, 30
  s_cbranch_scc1 L_hm_ok
  s_cmp_eq_u32 s94, 0
  s_cbranch_scc1 L_hm_ok
  s_sub_u32 s94, s94, 1
  s_sleep 1
  s_branch L_hm
L_hm_ok:
  global_store_dwordx4 v188, v[144:147], s[30:31] sc1
  global_store_dwordx4 v189, v[148:151], s[30:31] sc1
  global_store_dwordx4 v190, v[152:155], s[30:31] sc1
  global_store_dwordx4 v191, v[156:159], s[30:31] sc1
  global_store_dwordx4 v192, v[160:163], s[30:31] sc1
  s_mov_b32 exec_hi, 0xffffff
  global_store_dwordx4 v193, v[164:167], s[30:31] sc1
  s_mov_b64 exec, 7
  s_waitcnt vmcnt(0)
  global_atomic_add v36, v38, s[30:31] sc1
  s_mov_b64 exec, -1
L_hp_mid:
  s_add_u32 s43, s43, 1
  s_add_u32 s47, s43, 16
L_hpw:
  ds_read_b128 v[104:107], v14 offset:0
  s_waitcnt lgkmcnt(0)
  v_min_u32 v104, v104, v105
  v_min3_u32 v104, v104, v106, v107
  s_nop 0
  v_readfirstlane_b32 s46, v104
  s_cmp_ge_u32 s46, s47
  s_cbranch_scc1 L_hpw_ok
  s_cmp_eq_u32 s94, 0
  s_cbranch_scc1 L_hpw_ok
  s_sub_u32 s94, s94, 1
  s_sleep 1
  s_branch L_hpw
L_hpw_ok:
  s_bitcmp1_b32 s80, s47
  s_cbranch_scc0 L_fap
  s_mul_i32 s44, s47, 384
  s_add_u32 s44, s44, 7864320
  s_movk_i32 s78, 1
  s_atomic_add s78, s[30:31], s44 glc
  s_mov_b64 exec, 1
  global_load_dword v41, v43, s[30:31] offset:8 sc1
  s_mov_b64 exec, -1
L_fap:
  ds_read_b128 v[72:75], v196 offset:0
  ds_read_b128 v[76:79], v196 offset:16
  ds_read_b128 v[80:83], v197 offset:768
  ds_read_b128 v[84:87], v197 offset:784
  ds_read_b128 v[88:91], v197 offset:1536
  ds_read_b128 v[92:95], v197 offset:1552
  ds_read_b128 v[96:99], v198 offset:2304
  ds_read_b128 v[100:103], v198 offset:2320
  ds_read_b128 v[48:51], v23
  s_waitcnt lgkmcnt(0)
  v_pk_add_f32 v[72:73], v[72:73], v[80:81]
  v_pk_add_f32 v[88:89], v[88:89], v[96:97]
  v_pk_add_f32 v[74:75], v[74:75], v[82:83]
  v_pk_add_f32 v[90:91], v[90:91], v[98:99]
  v_pk_add_f32 v[76:77], v[76:77], v[84:85]
  v_pk_add_f32 v[92:93], v[92:93], v[100:101]
  v_pk_add_f32 v[78:79], v[78:79], v[86:87]
  v_pk_add_f32 v[94:95], v[94:95], v[102:103]
  v_pk_add_f32 v[72:73], v[72:73], v[88:89]
  v_pk_add_f32 v[74:75], v[74:75], v[90:91]
  v_pk_add_f32 v[76:77], v[76:77], v[92:93]
  v_pk_add_f32 v[78:79], v[78:79], v[94:95]
  v_pk_add_f32 v[72:73], v[72:73], v[50:51] op_sel_hi:[1,0] neg_lo:[0,1] neg_hi:[0,1]
  v_pk_add_f32 v[74:75], v[74:75], v[50:51] op_sel_hi:[1,0] neg_lo:[0,1] neg_hi:[0,1]
  v_pk_add_f32 v[76:77], v[76:77], v[50:51] op_sel_hi:[1,0] neg_lo:[0,1] neg_hi:[0,1]
  v_pk_add_f32 v[78:79], v[78:79], v[50:51] op_sel_hi:[1,0] neg_lo:[0,1] neg_hi:[0,1]
  v_max3_f32 v25, |v72|, |v73|, |v74|
  v_max3_f32 v25, v25, |v75|, |v76|
  v_max3_f32 v25, v25, |v77|, |v78|
  v_max_f32_e64 v25, v25, |v79|
  s_nop 1
  v_max_f32_dpp v25, v25, v25 row_ror:8 row_mask:0xf bank_mask:0xf
  s_nop 1
  v_max_f32_dpp v25, v25, v25 row_ror:4 row_mask:0xf bank_mask:0xf
  s_nop 1
  v_max_f32_dpp v25, v25, v25 row_ror:2 row_mask:0xf bank_mask:0xf
  s_nop 1
  v_max_f32_dpp v25, v25, v25 row_ror:1 row_mask:0xf bank_mask:0xf
  v_mov_b32 v29, v25
  s_nop 1
  v_permlane16_swap_b32 v25, v29
  v_max_f32 v25, v25, v29
  v_mov_b32 v29, v25
  s_nop 1
  v_permlane32_swap_b32 v25, v29
  v_max_f32 v25, v25, v29
  v_frexp_exp_i32_f32 v25, v25
  v_sub_u32 v29, 14, v25
  v_add_u32 v51, 242, v25
  v_ldexp_f32 v72, v72, v29
  v_ldexp_f32 v73, v73, v29
  v_ldexp_f32 v74, v74, v29
  v_ldexp_f32 v75, v75, v29
  v_ldexp_f32 v76, v76, v29
  v_ldexp_f32 v77, v77, v29
  v_ldexp_f32 v78, v78, v29
  v_ldexp_f32 v79, v79, v29
  v_cvt_pk_f16_f32 v108, v72, v73
  v_cvt_pk_f16_f32 v109, v74, v75
  v_cvt_pk_f16_f32 v110, v76, v77
  v_cvt_pk_f16_f32 v111, v78, v79
  v_min_u32 v108, -2, v108
  v_min_u32 v109, -2, v109
  v_min_u32 v110, -2, v110
  v_min_u32 v111, -2, v111
  s_cmp_eq_u32 s43, 15
  s_cbranch_scc1 L_hp_last
  ds_write_b32 v23, v51 offset:12
  v_add_u32 v196, 3072, v196
  v_add_u32 v197, 3072, v197
  v_add_u32 v198, 3072, v198
  ds_write_b128 v28, v[108:111]
  v_add_u32 v28, 384, v28
  s_bitcmp1_b32 s80, s47
  s_cbranch_scc0 L_fbp
  s_waitcnt vmcnt(0) lgkmcnt(0)
  v_readlane_b32 s46, v40, s47
  s_sub_u32 s78, s78, s46
  s_bfe_u32 s46, s78, 0x80000
  s_min_u32 s46, s46, 15
  s_lshl_b32 s46, s46, 1
  s_sub_u32 s46, s46, 15
  v_readfirstlane_b32 s95, v41
  s_mul_i32 s45, s46, 6
  s_ashr_i32 s44, s95, 3
  s_sub_u32 s95, s95, s44
  s_cmp_lt_i32 s46, 0
  s_cselect_b32 s95, s95, 0
  s_cselect_b32 s45, -48, 0
  s_add_u32 s45, s45, s95
  v_mov_b32 v41, s45
  s_lshl4_add_u32 s46, s46, s95
  s_cmp_gt_i32 s46, 0
  s_cselect_b32 s44, 3, 6
  s_mul_i32 s46, s46, s44
  s_add_u32 s46, s46, 128
  s_ashr_i32 s46, s46, 8
  v_mov_b32 v42, s46
  s_mov_b64 exec, 1
  global_store_dword v43, v42, s[30:31]
  global_store_dword v43, v41, s[30:31] offset:8
  s_mov_b64 exec, -1
L_fbp:
  s_branch L_hp
L_hp_last:
  v_cndmask_b32 v108, v48, v108, vcc
  v_cndmask_b32 v109, v49, v109, vcc
  v_cndmask_b32 v110, v50, v110, vcc
  v_cndmask_b32 v111, v51, v111, vcc
  s_mov_b64 exec, 0x1ffffff
  global_store_dwordx4 v168, v[108:111], s[30:31] sc1
  s_mov_b64 exec, -1
  s_and_b32 s44, s41, 1
  v_lshl_add_u32 v196, s44, 8, v35
  v_subrev_u32 v197, 768, v196
  v_min_u32 v196, v196, v197
  v_subrev_u32 v29, 256, v196
  v_add_u32 v197, 512, v196
  v_min_u32 v197, v29, v197
  v_subrev_u32 v29, 512, v196
  v_add_u32 v198, 256, v196
  v_min_u32 v198, v29, v198
  v_add_u32 v196, 110080, v196
  v_add_u32 v197, 110080, v197
  v_add_u32 v198, 110080, v198
L_hn:
  ds_read_b32 v104, v14 offset:28
  s_waitcnt lgkmcnt(0)
  v_readfirstlane_b32 s46, v104
  s_cmp_ge_u32 s46, 31
  s_cbranch_scc1 L_hn_ok
  s_cmp_eq_u32 s94, 0
  s_cbranch_scc1 L_hn_ok
  s_sub_u32 s94, s94, 1
  s_sleep 1
  s_branch L_hn
L_hn_ok:
  s_mov_b64 exec, 1
L_hw:
  global_atomic_add v68, v36, v14, s[30:31] sc0 sc1
  s_waitcnt vmcnt(0)
  v_readfirstlane_b32 s46, v68
  s_cmp_ge_u32 s46, 16
  s_cbranch_scc1 L_hw_ok
  s_cmp_eq_u32 s94, 0
  s_cbranch_scc1 L_hw_ok
  s_sub_u32 s94, s94, 1
  s_branch L_hw
L_hw_ok:
  s_mov_b64 exec, -1
L_hg:
  global_load_dwordx4 v[52:55], v187, s[30:31] sc1
  global_load_dwordx2 v[112:113], v172, s[30:31] sc1
  global_load_dwordx2 v[114:115], v173, s[30:31] sc1
  global_load_dwordx2 v[116:117], v174, s[30:31] sc1
  global_load_dwordx2 v[118:119], v175, s[30:31] sc1
  global_load_dwordx2 v[120:121], v176, s[30:31] sc1
  global_load_dwordx2 v[122:123], v177, s[30:31] sc1
  global_load_dwordx2 v[124:125], v178, s[30:31] sc1
  global_load_dwordx2 v[126:127], v179, s[30:31] sc1
  global_load_dwordx2 v[128:129], v180, s[30:31] sc1
  global_load_dwordx2 v[130:131], v181, s[30:31] sc1
  global_load_dwordx2 v[132:133], v182, s[30:31] sc1
  global_load_dwordx2 v[134:135], v183, s[30:31] sc1
  global_load_dwordx2 v[136:137], v184, s[30:31] sc1
  global_load_dwordx2 v[138:139], v185, s[30:31] sc1
  global_load_dwordx2 v[140:141], v186, s[30:31] sc1
  s_waitcnt vmcnt(15)
  v_mov_b32 v23, v55
  v_mov_b32 v24, v52
  s_nop 1
  v_max_f32_dpp v24, v24, v24 row_ror:8 row_mask:0xf bank_mask:0xf
  s_nop 1
  v_max_f32_dpp v24, v24, v24 row_ror:4 row_mask:0xf bank_mask:0xf
  s_nop 1
  v_max_f32_dpp v24, v24, v24 row_ror:2 row_mask:0xf bank_mask:0xf
  s_nop 1
  v_max_f32_dpp v24, v24, v24 row_ror:1 row_mask:0xf bank_mask:0xf
  v_sub_f32 v24, v52, v24
  v_exp_f32 v24, v24
  v_subrev_u32 v55, 256, v55
  v_mul_f32 v25, v24, v53
  s_nop 1
  v_add_f32_dpp v25, v25, v25 row_ror:8 row_mask:0xf bank_mask:0xf
  s_nop 1
  v_add_f32_dpp v25, v25, v25 row_ror:4 row_mask:0xf bank_mask:0xf
  s_nop 1
  v_add_f32_dpp v25, v25, v25 row_ror:2 row_mask:0xf bank_mask:0xf
  s_nop 1
  v_add_f32_dpp v25, v25, v25 row_ror:1 row_mask:0xf bank_mask:0xf
  v_rcp_f32 v25, v25
  s_nop 0
  v_mul_f32 v24, v24, v25
  v_ldexp_f32 v25, v24, v55
  v_mul_f32_e64 v54, v24, -v54
  v_readlane_b32 s63, v24, 15
  v_readlane_b32 s44, v54, 15
  v_readlane_b32 s48, v25, 0
  v_readlane_b32 s49, v25, 1
  v_readlane_b32 s50, v25, 2
  v_readlane_b32 s51, v25, 3
  v_readlane_b32 s52, v25, 4
  v_readlane_b32 s53, v25, 5
  v_readlane_b32 s54, v25, 6
  v_readlane_b32 s55, v25, 7
  v_readlane_b32 s56, v25, 8
  v_readlane_b32 s57, v25, 9
  v_readlane_b32 s58, v25, 10
  v_readlane_b32 s59, v25, 11
  v_readlane_b32 s60, v25, 12
  v_readlane_b32 s61, v25, 13
  v_readlane_b32 s62, v25, 14
  v_mov_b32 v108, s44
  v_mov_b32 v109, s44
  v_mov_b32 v110, s44
  v_mov_b32 v111, s44
  s_waitcnt vmcnt(14)
  v_max3_u32 v23, v23, v112, v113
  v_fma_mix_f32 v108, v112, s48, v108 op_sel:[0,0,0] op_sel_hi:[1,0,0]
  v_fma_mix_f32 v109, v112, s48, v109 op_sel:[1,0,0] op_sel_hi:[1,0,0]
  v_fma_mix_f32 v110, v113, s48, v110 op_sel:[0,0,0] op_sel_hi:[1,0,0]
  v_fma_mix_f32 v111, v113, s48, v111 op_sel:[1,0,0] op_sel_hi:[1,0,0]
  s_waitcnt vmcnt(13)
  v_max3_u32 v23, v23, v114, v115
  v_fma_mix_f32 v108, v114, s49, v108 op_sel:[0,0,0] op_sel_hi:[1,0,0]
  v_fma_mix_f32 v109, v114, s49, v109 op_sel:[1,0,0] op_sel_hi:[1,0,0]
  v_fma_mix_f32 v110, v115, s49, v110 op_sel:[0,0,0] op_sel_hi:[1,0,0]
  v_fma_mix_f32 v111, v115, s49, v111 op_sel:[1,0,0] op_sel_hi:[1,0,0]
  s_waitcnt vmcnt(12)
  v_max3_u32 v23, v23, v116, v117
  v_fma_mix_f32 v108, v116, s50, v108 op_sel:[0,0,0] op_sel_hi:[1,0,0]
  v_fma_mix_f32 v109, v116, s50, v109 op_sel:[1,0,0] op_sel_hi:[1,0,0]
  v_fma_mix_f32 v110, v117, s50, v110 op_sel:[0,0,0] op_sel_hi:[1,0,0]
  v_fma_mix_f32 v111, v117, s50, v111 op_sel:[1,0,0] op_sel_hi:[1,0,0]
  s_waitcnt vmcnt(11)
  v_max3_u32 v23, v23, v118, v119
  v_fma_mix_f32 v108, v118, s51, v108 op_sel:[0,0,0] op_sel_hi:[1,0,0]
  v_fma_mix_f32 v109, v118, s51, v109 op_sel:[1,0,0] op_sel_hi:[1,0,0]
  v_fma_mix_f32 v110, v119, s51, v110 op_sel:[0,0,0] op_sel_hi:[1,0,0]
  v_fma_mix_f32 v111, v119, s51, v111 op_sel:[1,0,0] op_sel_hi:[1,0,0]
  s_waitcnt vmcnt(10)
  v_max3_u32 v23, v23, v120, v121
  v_fma_mix_f32 v108, v120, s52, v108 op_sel:[0,0,0] op_sel_hi:[1,0,0]
  v_fma_mix_f32 v109, v120, s52, v109 op_sel:[1,0,0] op_sel_hi:[1,0,0]
  v_fma_mix_f32 v110, v121, s52, v110 op_sel:[0,0,0] op_sel_hi:[1,0,0]
  v_fma_mix_f32 v111, v121, s52, v111 op_sel:[1,0,0] op_sel_hi:[1,0,0]
  s_waitcnt vmcnt(9)
  v_max3_u32 v23, v23, v122, v123
  v_fma_mix_f32 v108, v122, s53, v108 op_sel:[0,0,0] op_sel_hi:[1,0,0]
  v_fma_mix_f32 v109, v122, s53, v109 op_sel:[1,0,0] op_sel_hi:[1,0,0]
  v_fma_mix_f32 v110, v123, s53, v110 op_sel:[0,0,0] op_sel_hi:[1,0,0]
  v_fma_mix_f32 v111, v123, s53, v111 op_sel:[1,0,0] op_sel_hi:[1,0,0]
  s_waitcnt vmcnt(8)
  v_max3_u32 v23, v23, v124, v125
  v_fma_mix_f32 v108, v124, s54, v108 op_sel:[0,0,0] op_sel_hi:[1,0,0]
  v_fma_mix_f32 v109, v124, s54, v109 op_sel:[1,0,0] op_sel_hi:[1,0,0]
  v_fma_mix_f32 v110, v125, s54, v110 op_sel:[0,0,0] op_sel_hi:[1,0,0]
  v_fma_mix_f32 v111, v125, s54, v111 op_sel:[1,0,0] op_sel_hi:[1,0,0]
  s_waitcnt vmcnt(7)
  v_max3_u32 v23, v23, v126, v127
  v_fma_mix_f32 v108, v126, s55, v108 op_sel:[0,0,0] op_sel_hi:[1,0,0]
  v_fma_mix_f32 v109, v126, s55, v109 op_sel:[1,0,0] op_sel_hi:[1,0,0]
  v_fma_mix_f32 v110, v127, s55, v110 op_sel:[0,0,0] op_sel_hi:[1,0,0]
  v_fma_mix_f32 v111, v127, s55, v111 op_sel:[1,0,0] op_sel_hi:[1,0,0]
  s_waitcnt vmcnt(6)
  v_max3_u32 v23, v23, v128, v129
  v_fma_mix_f32 v108, v128, s56, v108 op_sel:[0,0,0] op_sel_hi:[1,0,0]
  v_fma_mix_f32 v109, v128, s56, v109 op_sel:[1,0,0] op_sel_hi:[1,0,0]
  v_fma_mix_f32 v110, v129, s56, v110 op_sel:[0,0,0] op_sel_hi:[1,0,0]
  v_fma_mix_f32 v111, v129, s56, v111 op_sel:[1,0,0] op_sel_hi:[1,0,0]
  s_waitcnt vmcnt(5)
  v_max3_u32 v23, v23, v130, v131
  v_fma_mix_f32 v108, v130, s57, v108 op_sel:[0,0,0] op_sel_hi:[1,0,0]
  v_fma_mix_f32 v109, v130, s57, v109 op_sel:[1,0,0] op_sel_hi:[1,0,0]
  v_fma_mix_f32 v110, v131, s57, v110 op_sel:[0,0,0] op_sel_hi:[1,0,0]
  v_fma_mix_f32 v111, v131, s57, v111 op_sel:[1,0,0] op_sel_hi:[1,0,0]
  s_waitcnt vmcnt(4)
  v_max3_u32 v23, v23, v132, v133
  v_fma_mix_f32 v108, v132, s58, v108 op_sel:[0,0,0] op_sel_hi:[1,0,0]
  v_fma_mix_f32 v109, v132, s58, v109 op_sel:[1,0,0] op_sel_hi:[1,0,0]
  v_fma_mix_f32 v110, v133, s58, v110 op_sel:[0,0,0] op_sel_hi:[1,0,0]
  v_fma_mix_f32 v111, v133, s58, v111 op_sel:[1,0,0] op_sel_hi:[1,0,0]
  s_waitcnt vmcnt(3)
  v_max3_u32 v23, v23, v134, v135
  v_fma_mix_f32 v108, v134, s59, v108 op_sel:[0,0,0] op_sel_hi:[1,0,0]
  v_fma_mix_f32 v109, v134, s59, v109 op_sel:[1,0,0] op_sel_hi:[1,0,0]
  v_fma_mix_f32 v110, v135, s59, v110 op_sel:[0,0,0] op_sel_hi:[1,0,0]
  v_fma_mix_f32 v111, v135, s59, v111 op_sel:[1,0,0] op_sel_hi:[1,0,0]
  s_waitcnt vmcnt(2)
  v_max3_u32 v23, v23, v136, v137
  v_fma_mix_f32 v108, v136, s60, v108 op_sel:[0,0,0] op_sel_hi:[1,0,0]
  v_fma_mix_f32 v109, v136, s60, v109 op_sel:[1,0,0] op_sel_hi:[1,0,0]
  v_fma_mix_f32 v110, v137, s60, v110 op_sel:[0,0,0] op_sel_hi:[1,0,0]
  v_fma_mix_f32 v111, v137, s60, v111 op_sel:[1,0,0] op_sel_hi:[1,0,0]
  s_waitcnt vmcnt(1)
  v_max3_u32 v23, v23, v138, v139
  v_fma_mix_f32 v108, v138, s61, v108 op_sel:[0,0,0] op_sel_hi:[1,0,0]
  v_fma_mix_f32 v109, v138, s61, v109 op_sel:[1,0,0] op_sel_hi:[1,0,0]
  v_fma_mix_f32 v110, v139, s61, v110 op_sel:[0,0,0] op_sel_hi:[1,0,0]
  v_fma_mix_f32 v111, v139, s61, v111 op_sel:[1,0,0] op_sel_hi:[1,0,0]
  s_waitcnt vmcnt(0)
  v_max3_u32 v23, v23, v140, v141
  v_cmp_eq_u32 s[64:65], -1, v23
  v_fma_mix_f32 v108, v140, s62, v108 op_sel:[0,0,0] op_sel_hi:[1,0,0]
  v_fma_mix_f32 v109, v140, s62, v109 op_sel:[1,0,0] op_sel_hi:[1,0,0]
  v_fma_mix_f32 v110, v141, s62, v110 op_sel:[0,0,0] op_sel_hi:[1,0,0]
  v_fma_mix_f32 v111, v141, s62, v111 op_sel:[1,0,0] op_sel_hi:[1,0,0]
  s_cmp_eq_u64 s[64:65], 0
  s_cbranch_scc1 L_hg_ok
  s_cmp_eq_u32 s94, 0
  s_cbranch_scc1 L_hg_ok
  s_sub_u32 s94, s94, 1
  s_branch L_hg
L_hg_ok:
  v_mov_b32 v168, s63
  s_mov_b32 exec_hi, 0xffff
  s_barrier
  ds_read_b128 v[72:75], v196 offset:0
  ds_read_b128 v[76:79], v197 offset:768
  ds_read_b128 v[80:83], v197 offset:1536
  ds_read_b128 v[84:87], v198 offset:2304
  s_waitcnt lgkmcnt(3)
  v_pk_fma_f32 v[108:109], v[72:73], v[168:169], v[108:109] op_sel_hi:[1,0,1]
  v_pk_fma_f32 v[110:111], v[74:75], v[168:169], v[110:111] op_sel_hi:[1,0,1]
  s_waitcnt lgkmcnt(2)
  v_pk_fma_f32 v[108:109], v[76:77], v[168:169], v[108:109] op_sel_hi:[1,0,1]
  v_pk_fma_f32 v[110:111], v[78:79], v[168:169], v[110:111] op_sel_hi:[1,0,1]
  s_waitcnt lgkmcnt(1)
  v_pk_fma_f32 v[108:109], v[80:81], v[168:169], v[108:109] op_sel_hi:[1,0,1]
  v_pk_fma_f32 v[110:111], v[82:83], v[168:169], v[110:111] op_sel_hi:[1,0,1]
  s_waitcnt lgkmcnt(0)
  v_pk_fma_f32 v[108:109], v[84:85], v[168:169], v[108:109] op_sel_hi:[1,0,1]
  v_pk_fma_f32 v[110:111], v[86:87], v[168:169], v[110:111] op_sel_hi:[1,0,1]
  v_cvt_pk_bf16_f32 v108, v108, v109
  v_cvt_pk_bf16_f32 v109, v110, v111
  global_store_dwordx2 v21, v[108:109], s[26:27]
L_end:
  s_endpgm
.p2align 6
.type L_order,@object
L_order:
  .long 0x76afedcb, 0x45321098, 0x500000, 0x300, 0x40, 0x251300, 0x4, 0x0
  .long 0x2e001e, 0x4e003e, 0x6e005e, 0x8d007e, 0xae009e, 0xce00be, 0xee00de, 0xf00fe
  .long 0x96afedcb, 0x74321058, 0x700000, 0x700, 0x70, 0x271700, 0x7, 0x0
  .long 0x270007, 0x470037, 0x670057, 0x870077, 0xa70097, 0xc700b7, 0xe700d7, 0x1f00f7
  .long 0x765aedfb, 0xc4321098, 0xd00000, 0xf00, 0xc0, 0x2d1f00, 0xc, 0x0
  .long 0x110001, 0x410031, 0x610051, 0x810071, 0xa10091, 0xc100b1, 0xe100d1, 0x2f00f1
  .long 0x785fedcb, 0x6432109a, 0x900000, 0x200, 0x60, 0x291200, 0x6, 0x0
  .long 0x160006, 0x460026, 0x660056, 0x860076, 0xa60096, 0xc600b6, 0xe600d6, 0x3f00f6
  .long 0x765faecb, 0xd4321098, 0xf00000, 0xd00, 0xd0, 0x2f1d00, 0xd, 0x0
  .long 0x120002, 0x320022, 0x620052, 0x820072, 0xa20092, 0xc200b2, 0xe200d2, 0x4f00f2
  .long 0x765fedca, 0xb4321098, 0x800000, 0xf00, 0xb0, 0x281f00, 0xb, 0x0
  .long 0x100000, 0x300020, 0x600040, 0x800070, 0xa00090, 0xc000b0, 0xe000d0, 0x5f00f0
  .long 0x76afedcb, 0x24351098, 0x400000, 0x0, 0x20, 0x241000, 0x2, 0x0
  .long 0x1c000c, 0x3c002c, 0x5c004c, 0x8c007c, 0xac009c, 0xcc00bc, 0xea00dc, 0x6f00fc
  .long 0x76afedcb, 0x14325098, 0x400000, 0x400, 0x10, 0x241400, 0x1, 0x0
  .long 0x1b000b, 0x3b002b, 0x5b004b, 0x8b006b, 0xab009b, 0xcb00bb, 0xeb00db, 0x7f00fb
  .long 0x76afedcb, 0x35421098, 0x500000, 0x300, 0x30, 0x251300, 0x3, 0x0
  .long 0x1d000d, 0x3d002d, 0x5d004d, 0x7d006d, 0xad009d, 0xcd00bd, 0xed00dd, 0x8f00fd
  .long 0x76afedcb, 0x94321058, 0x700000, 0x700, 0x90, 0x271700, 0x9, 0x0
  .long 0x170009, 0x390029, 0x590049, 0x790069, 0xa90089, 0xc900b9, 0xe900d9, 0x9f00f9
  .long 0x765aedcb, 0xf4321098, 0xd00000, 0xf00, 0xf0, 0x2d1f00, 0xf, 0x0
  .long 0x140004, 0x340021, 0x540044, 0x740064, 0x940084, 0xc400b4, 0xe400d4, 0xaf00f4
  .long 0x765fedcb, 0x8432109a, 0x900000, 0x200, 0x80, 0x291200, 0x8, 0x0
  .long 0x180008, 0x360028, 0x580048, 0x780068, 0x980088, 0xc800a8, 0xe800d8, 0xbf00f8
  .long 0x765fadcb, 0xe4321098, 0xf00000, 0xd00, 0xe0, 0x2f1d00, 0xe, 0x0
  .long 0x130003, 0x330023, 0x530042, 0x730063, 0x930083, 0xb300a3, 0xe300d3, 0xcf00f3
  .long 0x765fedcb, 0xa4321098, 0x800000, 0xf00, 0xaf, 0x28001f, 0xa, 0x0
  .long 0x500024, 0x14400a4, 0x2b40234, 0x6f40674, 0x7830703, 0xc1408c2, 0xd630c94, 0xdf0de3
  .long 0x76afedcb, 0x4351298, 0x400000, 0x0, 0x0, 0x241000, 0x0, 0x0
  .long 0x1a000a, 0x3a002a, 0x5a004a, 0x7a006a, 0x9a008a, 0xba00aa, 0xda00ca, 0xef00fa
  .long 0x76afedcb, 0x54321098, 0x400000, 0x400, 0x54, 0x140024, 0x5, 0x0
  .long 0x7b006c, 0x1cc00ec, 0x4be043e, 0x58d050d, 0x7de075e, 0xe1c084d, 0xe9c0e2e, 0xff0eae
  .long 0x765fadce, 0xb4321098, 0x11911111, 0x11111e11, 0xb1, 0x291e01, 0xb, 0x0
  .long 0x1200110, 0x1400130, 0x1600150, 0x1800170, 0x1a00190, 0x1c001b0, 0x1e001d0, 0x10f01f0
  .long 0x76afedcb, 0x94321058, 0x11b11111, 0x11111011, 0x91, 0x2b1001, 0x9, 0x0
  .long 0x1290109, 0x1490139, 0x1690159, 0x1890179, 0x1a90199, 0x1c901b9, 0x1e901d9, 0x11f01f9
  .long 0x765fedcb, 0x8432109a, 0x11a11111, 0x11111111, 0x81, 0x2a1101, 0x8, 0x0
  .long 0x1180108, 0x1480138, 0x1680158, 0x1880178, 0x1a70198, 0x1c801b8, 0x1e801d8, 0x12f01f8
  .long 0x765feadb, 0xc4321098, 0x11811111, 0x11111e11, 0xc1, 0x281e01, 0xc, 0x0
  .long 0x1110101, 0x1410121, 0x1610151, 0x1810171, 0x1a10191, 0x1c101b1, 0x1e101d1, 0x13f01f1
  .long 0x765aedcb, 0xf4321098, 0x11e11111, 0x11111f11, 0xf1, 0x2e1f01, 0xf, 0x0
  .long 0x1140104, 0x1340124, 0x1640154, 0x1840174, 0x1a40194, 0x1c401b4, 0x1e401d4, 0x14f01f4
  .long 0x76afedcb, 0x45321098, 0x11311111, 0x11111811, 0x41, 0x231801, 0x4, 0x0
  .long 0x11e010e, 0x13e012e, 0x16e014e, 0x18e017e, 0x1ae019e, 0x1ce01be, 0x1ee01dd, 0x15f01fe
  .long 0x7a5fedcb, 0x64321098, 0x11811111, 0x11111311, 0x61, 0x281301, 0x6, 0x0
  .long 0x1160106, 0x1360126, 0x1560146, 0x1860176, 0x1a60196, 0x1c601b6, 0x1e601d6, 0x16f01f6
  .long 0x76afedcb, 0x14325098, 0x11011111, 0x11111311, 0x11, 0x201301, 0x1, 0x0
  .long 0x11b010b, 0x13b012b, 0x15b014b, 0x18b016b, 0x1ab019b, 0x1cb01bb, 0x1eb01db, 0x17f01fa
  .long 0x765fadcb, 0xe4321098, 0x11911111, 0x11111e11, 0xe1, 0x291e01, 0xe, 0x0
  .long 0x1130100, 0x1330123, 0x1530143, 0x1730163, 0x1a30193, 0x1c301b3, 0x1e301d3, 0x18f01f3
  .long 0x76afedcb, 0x54321098, 0x11b11111, 0x11111011, 0x5b, 0x10012b, 0x5, 0x0
  .long 0x3090119, 0x5450389, 0xc2505c5, 0xd650ca5, 0xe750de5, 0xf380ef5, 0xfb80f55, 0x19f0fd5
  .long 0x865fedcb, 0x7432109a, 0x11a11111, 0x11111111, 0x71, 0x2a1101, 0x7, 0x0
  .long 0x1170107, 0x1370127, 0x1570147, 0x1770167, 0x1970187, 0x1c701b7, 0x1e701d7, 0x1af01f7
  .long 0x765feacb, 0xd4321098, 0x11811111, 0x11111e11, 0xd1, 0x281e01, 0xd, 0x0
  .long 0x1120102, 0x1310122, 0x1520142, 0x1720162, 0x1920182, 0x1c201a2, 0x1e201d2, 0x1bf01f2
  .long 0x76afedcb, 0x24351098, 0x11411111, 0x11111711, 0x21, 0x241701, 0x2, 0x0
  .long 0x11c010c, 0x13c012c, 0x15c014c, 0x17c016c, 0x19c018c, 0x1bc01ac, 0x1ec01dc, 0x1cf01fc
  .long 0x76afedcb, 0x35421098, 0x11311111, 0x11111811, 0x31, 0x231801, 0x3, 0x0
  .long 0x11d010d, 0x13d012d, 0x15d014d, 0x17d016d, 0x19d018d, 0x1bd01ad, 0x1ed01cd, 0x1df01fd
  .long 0x765fedcb, 0xa4321098, 0x11811111, 0x11111311, 0xa3, 0x280113, 0xa, 0x0
  .long 0x850005, 0x1750166, 0x62501f5, 0x74506a5, 0xbd507c5, 0xd350d15, 0xdb50d95, 0x1ef0e55
  .long 0x76afedcb, 0x4325198, 0x11011111, 0x11111311, 0x1, 0x201301, 0x0, 0x0
  .long 0x11a010a, 0x13a012a, 0x15a014a, 0x17a016a, 0x19a018a, 0x1ba01aa, 0x1da01ca, 0x1ff01ea
  .long 0x76afedcb, 0x45321098, 0x22222222, 0x22222a22, 0x42, 0x221a02, 0x4, 0x0
  .long 0x22e021e, 0x24e023e, 0x26e025e, 0x28b027e, 0x2ae029e, 0x2ce02be, 0x2ee02de, 0x20f02fe
  .long 0x7a5fedcb, 0x64321098, 0x22c22222, 0x22222622, 0x62, 0x2c1602, 0x6, 0x0
  .long 0x2260206, 0x2460236, 0x2660256, 0x2860276, 0x2a60296, 0x2c602b6, 0x2e602d6, 0x21f02f6
  .long 0x76afedcb, 0x54321098, 0x22922222, 0x22222522, 0x59, 0x150229, 0x5, 0x0
  .long 0xb50035, 0x1850105, 0x2f502a8, 0x3550315, 0x3d50395, 0x6650575, 0x94506e5, 0x22f09c5
  .long 0x765aedcb, 0xf4321098, 0x22f22222, 0x22222f22, 0xf2, 0x2f1f02, 0xf, 0x0
  .long 0x2140204, 0x2440224, 0x2640254, 0x2840274, 0x2a40294, 0x2c402b2, 0x2e402d4, 0x23f02f4
  .long 0x76afedcb, 0x24351098, 0x22222222, 0x22222522, 0x22, 0x221502, 0x2, 0x0
  .long 0x21c020c, 0x23c022c, 0x26c025c, 0x28c027c, 0x2ac029c, 0x2ca02bc, 0x2ec02dc, 0x24f02fc
  .long 0x965fedcb, 0x743210a8, 0x22722222, 0x22222022, 0x72, 0x271002, 0x7, 0x0
  .long 0x2170207, 0x2370227, 0x2670247, 0x2870277, 0x2a70297, 0x2c702b7, 0x2e702d7, 0x25f02f7
  .long 0x765fadce, 0xb4321098, 0x22a22222, 0x22222e22, 0xb2, 0x2a1e02, 0xb, 0x0
  .long 0x2100200, 0x2300220, 0x2500240, 0x2800270, 0x2a00290, 0x2c002b0, 0x2e002d0, 0x26f02f0
  .long 0x76afedcb, 0x34521098, 0x22222222, 0x22222822, 0x32, 0x221802, 0x3, 0x0
  .long 0x21d020d, 0x23d022d, 0x25d024d, 0x28d026d, 0x2ad029d, 0x2cd02bd, 0x2ed02dd, 0x27f02fd
  .long 0x76afedcb, 0x15324098, 0x22222222, 0x22222a22, 0x12, 0x221a02, 0x1, 0x0
  .long 0x21b020b, 0x23b022b, 0x25b024b, 0x27b026b, 0x2ab029b, 0x2cb02bb, 0x2eb02db, 0x28f02fb
  .long 0x765fedcb, 0xa4321098, 0x22c22222, 0x22222622, 0xa6, 0x2c0216, 0xa, 0x0
  .long 0x3650216, 0x42503e5, 0x73504a5, 0x7750755, 0x7d507b5, 0xb4507f5, 0xd050bc5, 0x29f0d85
  .long 0x76afedcb, 0x84321095, 0x22922222, 0x22222522, 0x82, 0x291502, 0x8, 0x0
  .long 0x2180208, 0x2380228, 0x2580248, 0x2780268, 0x2980288, 0x2c802b8, 0x2e802d8, 0x2af02f8
  .long 0x765aefcb, 0xd4321098, 0x22f22222, 0x22222f22, 0xd2, 0x2f1f02, 0xd, 0x0
  .long 0x2120202, 0x2320222, 0x2520242, 0x2720262, 0x2920282, 0x2c202a2, 0x2e202d2, 0x2bf02f2
  .long 0x76afedcb, 0x4351298, 0x22222222, 0x22222522, 0x2, 0x221502, 0x0, 0x0
  .long 0x21a020a, 0x23a022a, 0x25a024a, 0x27a026a, 0x29a028a, 0x2ba02aa, 0x2ea02da, 0x2cf02fa
  .long 0x765fedcb, 0x943210a8, 0x22722222, 0x22222022, 0x92, 0x271002, 0x9, 0x0
  .long 0x2190209, 0x2390229, 0x2570249, 0x2790269, 0x2990289, 0x2b902a9, 0x2e902c9, 0x2df02f9
  .long 0x765fadcb, 0xe4321098, 0x22a22222, 0x22222e22, 0xe2, 0x2a1e02, 0xe, 0x0
  .long 0x2130203, 0x2330223, 0x2530243, 0x2730260, 0x2930283, 0x2b302a3, 0x2d302c3, 0x2ef02f3
  .long 0x765fedab, 0xc4321098, 0x22922222, 0x22222d22, 0xc2, 0x291d02, 0xc, 0x0
  .long 0x2110201, 0x2310221, 0x2510241, 0x2710261, 0x2910281, 0x2b102a1, 0x2d102c1, 0x2ff02e1
  .long 0x76afedcb, 0x84321059, 0x33b33333, 0x33333133, 0x83, 0x2b1103, 0x8, 0x0
  .long 0x3280318, 0x3480338, 0x3680358, 0x3880378, 0x3a80398, 0x3c803b8, 0x3e803d8, 0x30f03f8
  .long 0x765aedcb, 0xf4321098, 0x33933333, 0x33333e33, 0xf3, 0x291e03, 0xf, 0x0
  .long 0x3240304, 0x3440334, 0x3640354, 0x3840374, 0x3a40394, 0x3c403b4, 0x3e403d4, 0x31f03f4
  .long 0x76afedcb, 0x4321598, 0x33033333, 0x33333233, 0x3, 0x201203, 0x0, 0x0
  .long 0x31a030a, 0x34a033a, 0x36a035a, 0x38a037a, 0x3aa039a, 0x3ca03ba, 0x3ea03da, 0x32f03fa
  .long 0x765fedac, 0xb4321098, 0x33a33333, 0x33333b33, 0xb3, 0x2a1b03, 0xb, 0x0
  .long 0x3100300, 0x3400320, 0x3600350, 0x3800370, 0x3a00390, 0x3c003b0, 0x3e003d0, 0x33f03f0
  .long 0x76afedcb, 0x24531098, 0x33133333, 0x33333a33, 0x23, 0x211a03, 0x2, 0x0
  .long 0x31c030c, 0x33c032c, 0x36c035c, 0x38c037c, 0x3ac039c, 0x3cc03bc, 0x3ec03dc, 0x34f03fc
  .long 0xa65fedcb, 0x74321098, 0x33933333, 0x33333133, 0x73, 0x291103, 0x7, 0x0
  .long 0x3170307, 0x3370327, 0x3670347, 0x3870377, 0x3a70397, 0x3c703b7, 0x3e703d6, 0x35f03f7
  .long 0x76afedcb, 0x15324098, 0x33333333, 0x33333633, 0x13, 0x231603, 0x1, 0x0
  .long 0x31b030b, 0x33b032b, 0x35b034b, 0x38b037b, 0x3ab039b, 0x3cb03bb, 0x3eb03db, 0x36f03fb
  .long 0x765fadcb, 0xe4321098, 0x33e33333, 0x33333a33, 0xe3, 0x2e1a03, 0xe, 0x0
  .long 0x3130303, 0x3330323, 0x3530343, 0x3830363, 0x3a30393, 0x3c303b3, 0x3e303d3, 0x37f03f2
  .long 0x76afedcb, 0x94321058, 0x33b33333, 0x33333133, 0x93, 0x2b1103, 0x9, 0x0
  .long 0x3190308, 0x3390329, 0x3590349, 0x3790369, 0x3a90399, 0x3c903b9, 0x3e903d9, 0x38f03f9
  .long 0x765fedcb, 0xa4321098, 0x33933333, 0x33333e33, 0xae, 0x29031e, 0xa, 0x0
  .long 0x1320103, 0x1b20183, 0x2e30263, 0x4740314, 0x82304f4, 0xd5208a3, 0xe420dd2, 0x39f0ec2
  .long 0x76afedcb, 0x54321098, 0x33033333, 0x33333233, 0x50, 0x120320, 0x5, 0x0
  .long 0x1fb017b, 0x65e032a, 0x73c06de, 0xaeb07bc, 0xc6a0c4d, 0xd0c0ccd, 0xf1e0d8c, 0x3af0f9e
  .long 0x765fedab, 0xc4321098, 0x33a33333, 0x33333b33, 0xc3, 0x2a1b03, 0xc, 0x0
  .long 0x3110301, 0x3300321, 0x3510341, 0x3710361, 0x3910381, 0x3c103a1, 0x3e103d1, 0x3bf03f1
  .long 0x76afedcb, 0x34521098, 0x33133333, 0x33333a33, 0x33, 0x211a03, 0x3, 0x0
  .long 0x31d030d, 0x33d032d, 0x35d034c, 0x37d036d, 0x39d038d, 0x3bd03ad, 0x3ed03dd, 0x3cf03fd
  .long 0xa75fedcb, 0x64321098, 0x33933333, 0x33333133, 0x63, 0x291103, 0x6, 0x0
  .long 0x3160306, 0x3360326, 0x3560346, 0x3760366, 0x3960386, 0x3b603a6, 0x3e603c6, 0x3df03f6
  .long 0x76afedcb, 0x45321098, 0x33333333, 0x33333633, 0x43, 0x231603, 0x4, 0x0
  .long 0x31e030e, 0x33e032e, 0x35e034e, 0x37e036b, 0x39e038e, 0x3be03ae, 0x3de03ce, 0x3ef03fe
  .long 0x765faecb, 0xd4321098, 0x33e33333, 0x33333a33, 0xd3, 0x2e1a03, 0xd, 0x0
  .long 0x3120302, 0x3320322, 0x3520342, 0x3720362, 0x3920382, 0x3b203a2, 0x3d203c2, 0x3ff03e2
  .long 0x765fedcb, 0x8432109a, 0x44a44444, 0x44444944, 0x84, 0x2a1904, 0x8, 0x0
  .long 0x4280418, 0x4480438, 0x4680458, 0x4870478, 0x4a80498, 0x4c804b8, 0x4e804d8, 0x40f04f8
  .long 0x76afedcb, 0x4521398, 0x44544444, 0x44444544, 0x4, 0x251504, 0x0, 0x0
  .long 0x42a040a, 0x44a043a, 0x46a045a, 0x48a047a, 0x4aa049a, 0x4ca04ba, 0x4ea04da, 0x41f04fa
  .long 0x76afedcb, 0x24351098, 0x44344444, 0x44444644, 0x24, 0x231604, 0x2, 0x0
  .long 0x41c040c, 0x44c043c, 0x46c045c, 0x48c047c, 0x4ac049c, 0x4cc04bc, 0x4ec04dc, 0x42f04fc
  .long 0x76afedcb, 0x45321098, 0x44444444, 0x44444a44, 0x44, 0x241a04, 0x4, 0x0
  .long 0x41e040e, 0x44e042e, 0x46e045e, 0x48e047e, 0x4ae049e, 0x4ce04bb, 0x4ee04de, 0x43f04fe
  .long 0x765fadce, 0xb4321098, 0x44744444, 0x44444b44, 0xb4, 0x271b04, 0xb, 0x0
  .long 0x4100400, 0x4300420, 0x4600450, 0x4800470, 0x4a00490, 0x4c004b0, 0x4e004d0, 0x44f04f0
  .long 0x765feacb, 0xd4321098, 0x44644444, 0x44444c44, 0xd4, 0x261c04, 0xd, 0x0
  .long 0x4120402, 0x4320422, 0x4620442, 0x4820472, 0x4a20492, 0x4c204b2, 0x4e204d2, 0x45f04f2
  .long 0x79afedcb, 0x64321058, 0x44744444, 0x44444744, 0x64, 0x271704, 0x6, 0x0
  .long 0x4160406, 0x4360426, 0x4560446, 0x4860476, 0x4a60496, 0x4c604b6, 0x4e604d6, 0x46f04f6
  .long 0x765aedcb, 0xf4321098, 0x44644444, 0x44444e44, 0xf4, 0x261e04, 0xf, 0x0
  .long 0x4140404, 0x4340424, 0x4540444, 0x4840464, 0x4a40494, 0x4c404b4, 0x4e404d4, 0x47f04f1
  .long 0x865fedcb, 0x7432109a, 0x44a44444, 0x44444944, 0x74, 0x2a1904, 0x7, 0x0
  .long 0x4170407, 0x4370427, 0x4570447, 0x4770467, 0x4a70497, 0x4c704b7, 0x4e704d7, 0x48f04f7
  .long 0x76afedcb, 0x34521098, 0x44544444, 0x44444544, 0x34, 0x251504, 0x3, 0x0
  .long 0x41a040d, 0x43d042d, 0x45d044d, 0x47d046d, 0x4ad048d, 0x4cd04bd, 0x4ed04dd, 0x49f04fd
  .long 0x76afedcb, 0x54321098, 0x44344444, 0x44444644, 0x53, 0x160423, 0x5, 0x0
  .long 0x1de015e, 0x3ee036e, 0x81b042c, 0x89b087e, 0x93d08fe, 0xd4e09bd, 0xf0d0dce, 0x4af0f8d
  .long 0x76afedcb, 0x15324098, 0x44444444, 0x44444a44, 0x14, 0x241a04, 0x1, 0x0
  .long 0x41b040b, 0x43b042b, 0x45b044b, 0x47b046b, 0x49b048b, 0x4cb04ab, 0x4eb04db, 0x4bf04fb
  .long 0x765fadcb, 0xe4321098, 0x44744444, 0x44444b44, 0xe4, 0x271b04, 0xe, 0x0
  .long 0x4130403, 0x4330423, 0x4530440, 0x4730463, 0x4930483, 0x4b304a3, 0x4e304d3, 0x4cf04f3
  .long 0x765fedcb, 0xa4321098, 0x44644444, 0x44444c44, 0xac, 0x26041c, 0xa, 0x0
  .long 0x5230452, 0x76405a3, 0x94207e4, 0xb1109c2, 0xb910b34, 0xc030bb4, 0xf740c83, 0x4df0ff4
  .long 0x76afedcb, 0x94321058, 0x44744444, 0x44444744, 0x94, 0x271704, 0x9, 0x0
  .long 0x4190409, 0x4390429, 0x4590449, 0x4790466, 0x4990489, 0x4b904a9, 0x4d904c9, 0x4ef04f9
  .long 0x765aedfb, 0xc4321098, 0x44644444, 0x44444e44, 0xc4, 0x261e04, 0xc, 0x0
  .long 0x4110401, 0x4310421, 0x4510441, 0x4710461, 0x4910481, 0x4b104a1, 0x4d104c1, 0x4ff04e1
  .long 0x76afedcb, 0x34521098, 0x55455555, 0x55555855, 0x35, 0x241805, 0x3, 0x0
  .long 0x52d051d, 0x54d053d, 0x56d055d, 0x58c057d, 0x5ad059d, 0x5cd05bd, 0x5ed05dd, 0x50f05fd
  .long 0x765fedcb, 0x943210a8, 0x55f55555, 0x55555a55, 0x95, 0x2f1a05, 0x9, 0x0
  .long 0x5290509, 0x5490539, 0x5690559, 0x5890579, 0x5a90596, 0x5c905b9, 0x5e905d9, 0x51f05f9
  .long 0x765fadeb, 0xc4321098, 0x55755555, 0x55555c55, 0xc5, 0x271c05, 0xc, 0x0
  .long 0x5110501, 0x5410531, 0x5610551, 0x5810571, 0x5a10591, 0x5c105b1, 0x5e105d1, 0x52f05f1
  .long 0x765feacd, 0xb4321098, 0x55c55555, 0x55555d55, 0xb5, 0x2c1d05, 0xb, 0x0
  .long 0x5100500, 0x5400520, 0x5600550, 0x5800570, 0x5a00590, 0x5c005b0, 0x5e005d0, 0x53f05f0
  .long 0xa65fedcb, 0x74321098, 0x55b55555, 0x55555455, 0x75, 0x2b1405, 0x7, 0x0
  .long 0x5170507, 0x5370527, 0x5670557, 0x5870577, 0x5a70597, 0x5c705b7, 0x5e705d7, 0x54f05f7
  .long 0x76afedcb, 0x84321095, 0x55f55555, 0x55555755, 0x85, 0x2f1705, 0x8, 0x0
  .long 0x5180508, 0x5380528, 0x5680548, 0x5880578, 0x5a80598, 0x5c805b8, 0x5e805d8, 0x55f05f8
  .long 0x76afedcb, 0x4325198, 0x55255555, 0x55555255, 0x5, 0x221205, 0x0, 0x0
  .long 0x51a050a, 0x53a052a, 0x55a054a, 0x58a057a, 0x5aa059a, 0x5ca05ba, 0x5ea05da, 0x56f05fa
  .long 0x765aedcb, 0xf4321098, 0x55955555, 0x55555d55, 0xf5, 0x291d05, 0xf, 0x0
  .long 0x5140504, 0x5340524, 0x5540544, 0x5840564, 0x5a40594, 0x5c405b4, 0x5e405d4, 0x57f05f4
  .long 0x76afedcb, 0x24531098, 0x55455555, 0x55555855, 0x25, 0x241805, 0x2, 0x0
  .long 0x51c050c, 0x53c052c, 0x55c054c, 0x57c056c, 0x5ac059c, 0x5cc05bc, 0x5ec05dc, 0x58f05fc
  .long 0x795fedcb, 0x643210a8, 0x55f55555, 0x55555a55, 0x65, 0x2f1a05, 0x6, 0x0
  .long 0x5160506, 0x5360526, 0x5560546, 0x5760566, 0x5a60586, 0x5c605b6, 0x5e605d6, 0x59f05f6
  .long 0x765fadcb, 0xe4321098, 0x55755555, 0x55555c55, 0xe5, 0x271c05, 0xe, 0x0
  .long 0x5130503, 0x5330521, 0x5530543, 0x5730563, 0x5930583, 0x5c305b3, 0x5e305d3, 0x5af05f3
  .long 0x765feacb, 0xd4321098, 0x55c55555, 0x55555d55, 0xd5, 0x2c1d05, 0xd, 0x0
  .long 0x5120502, 0x5300522, 0x5520542, 0x5720562, 0x5920582, 0x5c205a2, 0x5e205d2, 0x5bf05f2
  .long 0x765fedcb, 0xa4321098, 0x55b55555, 0x55555455, 0xa4, 0x2b0514, 0xa, 0x0
  .long 0xf50075, 0x6350547, 0x81506b5, 0x8950855, 0xb6508d5, 0xc290be5, 0xf050ca9, 0x5cf0f85
  .long 0x76afedcb, 0x54321098, 0x55f55555, 0x55555755, 0x5f, 0x17052f, 0x5, 0x0
  .long 0xc50045, 0x2b50235, 0x5580515, 0x8650595, 0xd2508e5, 0xdf50d75, 0xe850e05, 0x5df0fa5
  .long 0x76afedcb, 0x14325098, 0x55255555, 0x55555255, 0x15, 0x221205, 0x1, 0x0
  .long 0x51b050b, 0x53b052b, 0x55b054b, 0x57b056a, 0x59b058b, 0x5bb05ab, 0x5db05cb, 0x5ef05fb
  .long 0x76afedcb, 0x45321098, 0x55255555, 0x55555855, 0x45, 0x221805, 0x4, 0x0
  .long 0x51e050e, 0x53e052e, 0x55e054e, 0x57e056e, 0x59e058e, 0x5be05ae, 0x5de05ce, 0x5ff05ee
  .long 0x76afedcb, 0x24351098, 0x66166666, 0x66666566, 0x26, 0x211506, 0x2, 0x0
  .long 0x62c061c, 0x64c063c, 0x66c065c, 0x68c067c, 0x6ac069c, 0x6cc06bc, 0x6ec06dc, 0x60f06fc
  .long 0x765feacd, 0xb4321098, 0x66a66666, 0x66666b66, 0xb6, 0x2a1b06, 0xb, 0x0
  .long 0x6200600, 0x6400630, 0x6600650, 0x6800670, 0x6a00690, 0x6c006b0, 0x6e006d0, 0x61f06f0
  .long 0x76afedcb, 0x94321058, 0x66e66666, 0x66666366, 0x96, 0x2e1306, 0x9, 0x0
  .long 0x6190609, 0x6490639, 0x6690659, 0x6890679, 0x6a70699, 0x6c906b9, 0x6e906d9, 0x62f06f9
  .long 0x76afedcb, 0x4325198, 0x66166666, 0x66666466, 0x6, 0x211406, 0x0, 0x0
  .long 0x61a060a, 0x64a062a, 0x66a065a, 0x68a067a, 0x6aa069a, 0x6ca06ba, 0x6ea06da, 0x63f06fa
  .long 0x76afedcb, 0x84321095, 0x66566666, 0x66666966, 0x86, 0x251906, 0x8, 0x0
  .long 0x6180608, 0x6380628, 0x6680658, 0x6880678, 0x6a80698, 0x6c606b8, 0x6e806d8, 0x64f06f8
  .long 0x76afedcb, 0x45321098, 0x66066666, 0x66666566, 0x46, 0x201506, 0x4, 0x0
  .long 0x61e060e, 0x63e062e, 0x66e064e, 0x68e067e, 0x6ae069e, 0x6ce06be, 0x6ee06dd, 0x65f06fe
  .long 0x765fedcb, 0xa4321098, 0x66966666, 0x66666a66, 0xaa, 0x29061a, 0xa, 0x0
  .long 0x2850205, 0x3730345, 0x3f303c5, 0x4b50435, 0x5990519, 0x92506e3, 0xb5209a5, 0x66f0ed4
  .long 0x765aedfb, 0xc4321098, 0x66866666, 0x66666f66, 0xc6, 0x281f06, 0xc, 0x0
  .long 0x6110601, 0x6310621, 0x6510641, 0x6810661, 0x6a10691, 0x6c106b1, 0x6e106d1, 0x67f06f1
  .long 0x76afedcb, 0x54321098, 0x66166666, 0x66666566, 0x51, 0x150621, 0x5, 0x0
  .long 0x3cd034d, 0x63b060c, 0x91e06bb, 0xa2d099e, 0xb6d0aad, 0xbdc0b7e, 0xbfe0bed, 0x68f0e5d
  .long 0x765feacb, 0xd4321098, 0x66a66666, 0x66666b66, 0xd6, 0x2a1b06, 0xd, 0x0
  .long 0x6100602, 0x6320622, 0x6520642, 0x6720662, 0x6a20682, 0x6c206b2, 0x6e206d2, 0x69f06f2
  .long 0x96afedcb, 0x74321058, 0x66e66666, 0x66666366, 0x76, 0x2e1306, 0x7, 0x0
  .long 0x6170607, 0x6370627, 0x6570647, 0x6770667, 0x6970687, 0x6c706b7, 0x6e706d7, 0x6af06f7
  .long 0x76afedcb, 0x14325098, 0x66166666, 0x66666466, 0x16, 0x211406, 0x1, 0x0
  .long 0x61b060b, 0x63a062b, 0x65b064b, 0x67b066b, 0x69b068b, 0x6cb06ab, 0x6eb06db, 0x6bf06fb
  .long 0x78afedcb, 0x64321095, 0x66566666, 0x66666966, 0x66, 0x251906, 0x6, 0x0
  .long 0x6160606, 0x6360626, 0x6560646, 0x6760666, 0x6960686, 0x6b606a6, 0x6e606d6, 0x6cf06f6
  .long 0x76afedcb, 0x35421098, 0x66066666, 0x66666566, 0x36, 0x201506, 0x3, 0x0
  .long 0x61d060d, 0x63d062d, 0x65d064d, 0x67d066d, 0x69d068d, 0x6bd06ad, 0x6ed06cd, 0x6df06fd
  .long 0x765fadcb, 0xe4321098, 0x66966666, 0x66666a66, 0xe6, 0x291a06, 0xe, 0x0
  .long 0x6130603, 0x6330623, 0x6530643, 0x6730663, 0x6930683, 0x6b306a3, 0x6d306c3, 0x6ef06f3
  .long 0x765aedcb, 0xf4321098, 0x66866666, 0x66666f66, 0xf6, 0x281f06, 0xf, 0x0
  .long 0x6140604, 0x6340624, 0x6540644, 0x6710664, 0x6940684, 0x6b406a4, 0x6d406c4, 0x6ff06e4
  .long 0x765fadcb, 0xe4321098, 0x77d77777, 0x77777f77, 0xe7, 0x2d1f07, 0xe, 0x0
  .long 0x7230713, 0x7430733, 0x7630753, 0x7800773, 0x7a30793, 0x7c307b3, 0x7e307d3, 0x70f07f3
  .long 0x76afedcb, 0x4321598, 0x77277777, 0x77777177, 0x7, 0x221107, 0x0, 0x0
  .long 0x72a070a, 0x74a073a, 0x76a075a, 0x78a077a, 0x7aa079a, 0x7ca07ba, 0x7ea07da, 0x71f07fa
  .long 0x765fedcb, 0xa4321098, 0x77877777, 0x77777d77, 0xad, 0x28071d, 0xa, 0x0
  .long 0xc30043, 0x53202f1, 0x5b20574, 0x96307a1, 0xa0409e3, 0xa840a13, 0xf520a93, 0x72f0fd2
  .long 0x76afedcb, 0x24351098, 0x77077777, 0x77777677, 0x27, 0x201607, 0x2, 0x0
  .long 0x71c070c, 0x74c072c, 0x76c075c, 0x78c077c, 0x7ac079c, 0x7cc07bb, 0x7ec07dc, 0x73f07fc
  .long 0x56afedcb, 0x74321098, 0x77677777, 0x77777377, 0x77, 0x261307, 0x7, 0x0
  .long 0x7170707, 0x7370727, 0x7670757, 0x7870777, 0x7a70797, 0x7c607b7, 0x7e707d7, 0x74f07f7
  .long 0x76afedcb, 0x45321098, 0x77477777, 0x77777677, 0x47, 0x241607, 0x4, 0x0
  .long 0x71e070e, 0x73e072e, 0x76e074e, 0x78e077e, 0x7ae079e, 0x7ce07be, 0x7ee07dd, 0x75f07fe
  .long 0x765aefcb, 0xd4321098, 0x77e77777, 0x77777c77, 0xd7, 0x2e1c07, 0xd, 0x0
  .long 0x7120702, 0x7320722, 0x7520742, 0x7820772, 0x7a20792, 0x7c207b2, 0x7e207d2, 0x76f07f2
  .long 0x76afedcb, 0x94321058, 0x77c77777, 0x77777677, 0x97, 0x2c1607, 0x9, 0x0
  .long 0x7190709, 0x7390729, 0x7590749, 0x7890769, 0x7a90799, 0x7c907b9, 0x7e907d9, 0x77f07f8
  .long 0x765fadce, 0xb4321098, 0x77d77777, 0x77777f77, 0xb7, 0x2d1f07, 0xb, 0x0
  .long 0x7100700, 0x7300720, 0x7500740, 0x7700760, 0x7a00790, 0x7c007b0, 0x7e007d0, 0x78f07f0
  .long 0x76afedcb, 0x54321098, 0x77277777, 0x77777177, 0x52, 0x110722, 0x5, 0x0
  .long 0x24c020e, 0x28e027d, 0x56b02cc, 0x5fe05eb, 0xa3e071a, 0xc5e0abe, 0xdad0cde, 0x79f0f2a
  .long 0x765fedab, 0xc4321098, 0x77877777, 0x77777d77, 0xc7, 0x281d07, 0xc, 0x0
  .long 0x7110701, 0x7310721, 0x7510741, 0x7710761, 0x7910781, 0x7c107b1, 0x7e107d1, 0x7af07f1
  .long 0x76afedcb, 0x14352098, 0x77077777, 0x77777677, 0x17, 0x201607, 0x1, 0x0
  .long 0x71b070b, 0x73b072b, 0x75b074b, 0x77b076b, 0x79b078b, 0x7cb07ab, 0x7eb07db, 0x7bf07fb
  .long 0x57afedcb, 0x64321098, 0x77677777, 0x77777377, 0x67, 0x261307, 0x6, 0x0
  .long 0x7160706, 0x7360726, 0x7560746, 0x7760766, 0x7960786, 0x7b607a6, 0x7e607d6, 0x7cf07f6
  .long 0x76afedcb, 0x35421098, 0x77477777, 0x77777677, 0x37, 0x241607, 0x3, 0x0
  .long 0x71d070d, 0x73d072d, 0x75d074d, 0x77d076d, 0x79d078d, 0x7bd07ad, 0x7ed07cd, 0x7df07fd
  .long 0x765aedcb, 0xf4321098, 0x77e77777, 0x77777c77, 0xf7, 0x2e1c07, 0xf, 0x0
  .long 0x7140704, 0x7340724, 0x7540744, 0x7740762, 0x7940784, 0x7b407a4, 0x7d407c4, 0x7ef07f4
  .long 0x76afedcb, 0x84321059, 0x77c77777, 0x77777677, 0x87, 0x2c1607, 0x8, 0x0
  .long 0x7180708, 0x7380728, 0x7580748, 0x7780768, 0x7980788, 0x7b807a8, 0x7d807c8, 0x7ff07e8
  .long 0x765aedcb, 0xf4321098, 0x88e88888, 0x88888b88, 0xf8, 0x2e1b08, 0xf, 0x0
  .long 0x8240814, 0x8440834, 0x8640854, 0x8810874, 0x8a40894, 0x8c408b4, 0x8e408d4, 0x80f08f4
  .long 0x76afedcb, 0x14325098, 0x88388888, 0x88888488, 0x18, 0x231408, 0x1, 0x0
  .long 0x82b080b, 0x84b083b, 0x86b085b, 0x88b087b, 0x8ab089a, 0x8cb08bb, 0x8eb08db, 0x81f08fb
  .long 0x765fadcb, 0xe4321098, 0x88688888, 0x88888e88, 0xe8, 0x261e08, 0xe, 0x0
  .long 0x8130803, 0x8430833, 0x8630853, 0x8830873, 0x8a00893, 0x8c308b3, 0x8e308d3, 0x82f08f3
  .long 0x96afedcb, 0x74321058, 0x88788888, 0x88888888, 0x78, 0x271808, 0x7, 0x0
  .long 0x8170807, 0x8470827, 0x8670857, 0x8870877, 0x8a70897, 0x8c708b7, 0x8e708d7, 0x83f08f7
  .long 0x76afedcb, 0x34521098, 0x88488888, 0x88888788, 0x38, 0x241708, 0x3, 0x0
  .long 0x81d080d, 0x83d082d, 0x86d085d, 0x88d087d, 0x8ad089d, 0x8cd08bd, 0x8ed08dd, 0x84f08fd
  .long 0x76afedcb, 0x54321098, 0x88e88888, 0x88888488, 0x5e, 0x14082e, 0x5, 0x0
  .long 0x3750145, 0x62903f5, 0x76506a9, 0x80507e5, 0x8c50885, 0xa1508d6, 0xc350a95, 0x85f0cb5
  .long 0x765fedcb, 0x8432109a, 0x88f88888, 0x88888988, 0x88, 0x2f1908, 0x8, 0x0
  .long 0x8180808, 0x8380828, 0x8580848, 0x8880878, 0x8a80898, 0x8c808b8, 0x8e808d8, 0x86f08f8
  .long 0x76afedcb, 0x45321098, 0x88388888, 0x88888788, 0x48, 0x231708, 0x4, 0x0
  .long 0x81e080e, 0x83e082e, 0x85e084e, 0x88e086e, 0x8ae089e, 0x8ce08be, 0x8ee08de, 0x87f08fc
  .long 0x765aedfb, 0xc4321098, 0x88e88888, 0x88888b88, 0xc8, 0x2e1b08, 0xc, 0x0
  .long 0x8110801, 0x8310821, 0x8510841, 0x8710861, 0x8a10891, 0x8c108b1, 0x8e108d1, 0x88f08f1
  .long 0x76afedcb, 0x4325198, 0x88388888, 0x88888488, 0x8, 0x231408, 0x0, 0x0
  .long 0x81a080a, 0x83a082a, 0x85a084a, 0x87a086a, 0x8aa088a, 0x8ca08ba, 0x8ea08da, 0x89f08fa
  .long 0x765fadce, 0xb4321098, 0x88688888, 0x88888e88, 0xb8, 0x261e08, 0xb, 0x0
  .long 0x8100800, 0x8300820, 0x8500840, 0x8700860, 0x8900880, 0x8c008b0, 0x8e008d0, 0x8af08f0
  .long 0x76afedcb, 0x94321058, 0x88788888, 0x88888888, 0x98, 0x271808, 0x9, 0x0
  .long 0x8190809, 0x8370829, 0x8590849, 0x8790869, 0x8990889, 0x8c908a9, 0x8e908d9, 0x8bf08f9
  .long 0x765feacb, 0xd4321098, 0x88e88888, 0x88888f88, 0xd8, 0x2e1f08, 0xd, 0x0
  .long 0x8120802, 0x8320822, 0x8520842, 0x8720862, 0x8920882, 0x8b208a2, 0x8e208d2, 0x8cf08f2
  .long 0x75afedcb, 0x64321098, 0x88e88888, 0x88888488, 0x68, 0x2e1408, 0x6, 0x0
  .long 0x8160806, 0x8360826, 0x8560846, 0x8760866, 0x8960886, 0x8b608a6, 0x8e608c6, 0x8df08f6
  .long 0x765fedcb, 0xa4321098, 0x88f88888, 0x88888988, 0xa9, 0x2f0819, 0xa, 0x0
  .long 0x4880408, 0x6c50645, 0xa350868, 0xc550ab5, 0xcd50c75, 0xe250cf5, 0xf150ea5, 0x8ef0f95
  .long 0x76afedcb, 0x25341098, 0x88388888, 0x88888788, 0x28, 0x231708, 0x2, 0x0
  .long 0x81c080c, 0x83c082c, 0x85c084c, 0x87c086c, 0x89c088c, 0x8bc08ac, 0x8dc08cc, 0x8ff08ec
  .long 0x78afedcb, 0x64321095, 0x99799999, 0x99999099, 0x69, 0x271009, 0x6, 0x0
  .long 0x9260916, 0x9460936, 0x9660956, 0x9860976, 0x9a60996, 0x9c609b6, 0x9e609d6, 0x90f09f6
  .long 0x76afedcb, 0x45321098, 0x99199999, 0x99999899, 0x49, 0x211809, 0x4, 0x0
  .long 0x92e090e, 0x94e093e, 0x96e095e, 0x98e097e, 0x9ae099c, 0x9ce09be, 0x9ee09de, 0x91f09fe
  .long 0x76afedcb, 0x14325098, 0x99599999, 0x99999a99, 0x19, 0x251a09, 0x1, 0x0
  .long 0x91b090b, 0x94b093b, 0x96b095b, 0x98b097b, 0x9ab099b, 0x9cb09bb, 0x9eb09db, 0x92f09fb
  .long 0x76afedcb, 0x4521398, 0x99399999, 0x99999599, 0x9, 0x231509, 0x0, 0x0
  .long 0x91a090a, 0x94a092a, 0x96a095a, 0x98a097a, 0x9aa099a, 0x9ca09ba, 0x9ea09da, 0x93f09fa
  .long 0x765feacb, 0xd4321098, 0x99999999, 0x99999c99, 0xd9, 0x291c09, 0xd, 0x0
  .long 0x9120902, 0x9320922, 0x9620952, 0x9820972, 0x9a20992, 0x9c009b2, 0x9e209d2, 0x94f09f2
  .long 0x765aedcb, 0xf4321098, 0x99c99999, 0x99999b99, 0xf9, 0x2c1b09, 0xf, 0x0
  .long 0x9140904, 0x9340924, 0x9640944, 0x9840974, 0x9a40994, 0x9c409b4, 0x9e409d4, 0x95f09f4
  .long 0x765fadcb, 0xe4321098, 0x99599999, 0x99999d99, 0xe9, 0x251d09, 0xe, 0x0
  .long 0x9130903, 0x9330923, 0x9530943, 0x9830973, 0x9a30993, 0x9c309b3, 0x9e109d3, 0x96f09f3
  .long 0x76afedcb, 0x94321058, 0x99d99999, 0x99999599, 0x99, 0x2d1509, 0x9, 0x0
  .long 0x9190909, 0x9390929, 0x9590949, 0x9890969, 0x9a90999, 0x9c909b9, 0x9e909d9, 0x97f09f7
  .long 0x76afedcb, 0x84321095, 0x99799999, 0x99999099, 0x89, 0x271009, 0x8, 0x0
  .long 0x9180906, 0x9380928, 0x9580948, 0x9780968, 0x9a80998, 0x9c809b8, 0x9e809d8, 0x98f09f8
  .long 0x76afedcb, 0x25341098, 0x99199999, 0x99999899, 0x29, 0x211809, 0x2, 0x0
  .long 0x91c090c, 0x93c092c, 0x95c094c, 0x97c096c, 0x9ac098c, 0x9cc09bc, 0x9ec09dc, 0x99f09fc
  .long 0x76afedcb, 0x54321098, 0x99599999, 0x99999a99, 0x55, 0x1a0925, 0x5, 0x0
  .long 0x8e000e, 0x49d041d, 0x6c80648, 0x965092b, 0xb5509e5, 0xeb80e38, 0xf750ed5, 0x9af0ff5
  .long 0x76afedcb, 0x34521098, 0x99399999, 0x99999599, 0x39, 0x231509, 0x3, 0x0
  .long 0x91d090d, 0x93a092d, 0x95d094d, 0x97d096d, 0x99d098d, 0x9cd09ad, 0x9ed09dd, 0x9bf09fd
  .long 0x765feacd, 0xb4321098, 0x99999999, 0x99999c99, 0xb9, 0x291c09, 0xb, 0x0
  .long 0x9100900, 0x9300920, 0x9500940, 0x9700960, 0x9900980, 0x9b009a0, 0x9e009d0, 0x9cf09f0
  .long 0x765fedcb, 0xa4321098, 0x99c99999, 0x99999b99, 0xab, 0x2c091b, 0xa, 0x0
  .long 0x3b10331, 0x4c30443, 0x6920612, 0x8840804, 0xa610954, 0xd240ce2, 0xef30e73, 0x9df0fa3
  .long 0x765fadeb, 0xc4321098, 0x99599999, 0x99999d99, 0xc9, 0x251d09, 0xc, 0x0
  .long 0x9110901, 0x9310921, 0x9510941, 0x9710961, 0x9910981, 0x9b109a1, 0x9d109c1, 0x9ef09f1
  .long 0x96afedcb, 0x74321058, 0x99d99999, 0x99999599, 0x79, 0x2d1509, 0x7, 0x0
  .long 0x9170907, 0x9370927, 0x9570947, 0x9770967, 0x9970987, 0x9b709a7, 0x9d709c7, 0x9ff09e7
  .long 0x765aedcb, 0xf4321098, 0xaa6aaaaa, 0xaaaaadaa, 0xfa, 0x261d0a, 0xf, 0x0
  .long 0xa240a14, 0xa440a34, 0xa640a54, 0xa820a74, 0xaa40a94, 0xac40ab4, 0xae40ad4, 0xa0f0af4
  .long 0x765fadce, 0xb4321098, 0xaaeaaaaa, 0xaaaaadaa, 0xba, 0x2e1d0a, 0xb, 0x0
  .long 0xa200a00, 0xa400a30, 0xa600a50, 0xa800a70, 0xaa00a90, 0xac00ab0, 0xae00ad0, 0xa1f0af0
  .long 0x76afedcb, 0x34521098, 0xaa1aaaaa, 0xaaaaa7aa, 0x3a, 0x21170a, 0x3, 0x0
  .long 0xa1d0a0d, 0xa4d0a3d, 0xa6d0a5d, 0xa8d0a7d, 0xaac0a9d, 0xacd0abd, 0xaed0add, 0xa2f0afd
  .long 0x76afedcb, 0x45321098, 0xaa2aaaaa, 0xaaaaa9aa, 0x4a, 0x22190a, 0x4, 0x0
  .long 0xa1e0a0e, 0xa4e0a2e, 0xa6e0a5e, 0xa8e0a7e, 0xaae0a9e, 0xace0aba, 0xaee0ade, 0xa3f0afe
  .long 0x765fedcb, 0xa4321098, 0xaaaaaaaa, 0xaaaaa8aa, 0xa8, 0x2a0a18, 0xa, 0x0
  .long 0x1d50155, 0x5050275, 0x5f50585, 0x8b50835, 0x9950915, 0xda50ac5, 0xee50e65, 0xa4f0f25
  .long 0x86afedcb, 0x74321095, 0xaadaaaaa, 0xaaaaa2aa, 0x7a, 0x2d120a, 0x7, 0x0
  .long 0xa170a07, 0xa370a27, 0xa670a47, 0xa870a77, 0xaa70a97, 0xac70ab7, 0xae70ad7, 0xa5f0af7
  .long 0x765fedab, 0xc4321098, 0xaa6aaaaa, 0xaaaaabaa, 0xca, 0x261b0a, 0xc, 0x0
  .long 0xa110a01, 0xa310a21, 0xa510a41, 0xa810a71, 0xaa10a91, 0xac10ab1, 0xae10ad1, 0xa6f0af1
  .long 0x765fedcb, 0x943210a8, 0xaaaaaaaa, 0xaaaaa1aa, 0x9a, 0x2a110a, 0x9, 0x0
  .long 0xa190a09, 0xa390a29, 0xa590a49, 0xa890a69, 0xaa90a99, 0xac90ab9, 0xae90ad9, 0xa7f0af6
  .long 0x765aefcb, 0xd4321098, 0xaa6aaaaa, 0xaaaaadaa, 0xda, 0x261d0a, 0xd, 0x0
  .long 0xa120a02, 0xa320a22, 0xa520a42, 0xa720a62, 0xaa20a92, 0xac20ab2, 0xae20ad2, 0xa8f0af2
  .long 0x765fadcb, 0xe4321098, 0xaaeaaaaa, 0xaaaaadaa, 0xea, 0x2e1d0a, 0xe, 0x0
  .long 0xa100a03, 0xa330a23, 0xa530a43, 0xa730a63, 0xaa30a83, 0xac30ab3, 0xae30ad3, 0xa9f0af3
  .long 0x76afedcb, 0x24531098, 0xaa1aaaaa, 0xaaaaa7aa, 0x2a, 0x21170a, 0x2, 0x0
  .long 0xa1c0a0c, 0xa3c0a2c, 0xa5c0a4c, 0xa7c0a6c, 0xa9c0a8c, 0xacc0abc, 0xaec0adc, 0xaaf0afc
  .long 0x76afedcb, 0x5321498, 0xaa2aaaaa, 0xaaaaa9aa, 0xa, 0x22190a, 0x0, 0x0
  .long 0xa1a0a0a, 0xa3a0a2a, 0xa5a0a4a, 0xa7a0a6a, 0xa9a0a8a, 0xaca0aaa, 0xaea0ada, 0xabf0afa
  .long 0x76afedcb, 0x54321098, 0xaaaaaaaa, 0xaaaaa8aa, 0x5a, 0x180a2a, 0x5, 0x0
  .long 0x1a50125, 0x2e50265, 0x3b50335, 0x4850405, 0x6950615, 0xa750a45, 0xd550af5, 0xacf0dd5
  .long 0x76afedcb, 0x84321095, 0xaadaaaaa, 0xaaaaa2aa, 0x8a, 0x2d120a, 0x8, 0x0
  .long 0xa180a08, 0xa380a28, 0xa570a48, 0xa780a68, 0xa980a88, 0xab80aa8, 0xae80ac8, 0xadf0af8
  .long 0x76afedcb, 0x14325098, 0xaa0aaaaa, 0xaaaaa1aa, 0x1a, 0x20110a, 0x1, 0x0
  .long 0xa1b0a0b, 0xa3b0a2b, 0xa5b0a4b, 0xa7b0a6b, 0xa9b0a8b, 0xabb0aab, 0xadb0acb, 0xaef0afb
  .long 0x795fedcb, 0x643210a8, 0xaaaaaaaa, 0xaaaaa1aa, 0x6a, 0x2a110a, 0x6, 0x0
  .long 0xa160a06, 0xa360a26, 0xa560a46, 0xa760a66, 0xa960a86, 0xab60aa6, 0xad60ac6, 0xaff0ae6
  .long 0x765fedcb, 0xa4321098, 0xbb8bbbbb, 0xbbbbb7bb, 0xa7, 0x280b17, 0xa, 0x0
  .long 0x950015, 0x46501c5, 0x55504e5, 0x84505d5, 0x8f50875, 0xaa50a25, 0xf350b86, 0xb0f0fb5
  .long 0x765fedac, 0xb4321098, 0xbbdbbbbb, 0xbbbbbcbb, 0xbb, 0x2d1c0b, 0xb, 0x0
  .long 0xb200b00, 0xb400b30, 0xb600b50, 0xb800b70, 0xba00b90, 0xbc00bb0, 0xbe00bd0, 0xb1f0bf0
  .long 0x765fedcb, 0x943210a8, 0xbbcbbbbb, 0xbbbbb0bb, 0x9b, 0x2c100b, 0x9, 0x0
  .long 0xb190b09, 0xb490b39, 0xb690b59, 0xb890b79, 0xba70b99, 0xbc90bb9, 0xbe90bd9, 0xb2f0bf9
  .long 0x765afdcb, 0xe4321098, 0xbb6bbbbb, 0xbbbbbcbb, 0xeb, 0x261c0b, 0xe, 0x0
  .long 0xb130b03, 0xb430b23, 0xb630b53, 0xb830b73, 0xba30b93, 0xbc30bb3, 0xbe30bd3, 0xb3f0bf3
  .long 0x76afedcb, 0x84321095, 0xbb8bbbbb, 0xbbbbb6bb, 0x8b, 0x28160b, 0x8, 0x0
  .long 0xb180b08, 0xb380b28, 0xb680b58, 0xb880b78, 0xba80b98, 0xbc80bb8, 0xbe80bd8, 0xb4f0bf8
  .long 0x765feacb, 0xd4321098, 0xbb5bbbbb, 0xbbbbbabb, 0xdb, 0x251a0b, 0xd, 0x0
  .long 0xb120b02, 0xb320b22, 0xb620b42, 0xb820b72, 0xba20b92, 0xbc20bb2, 0xbe20bd2, 0xb5f0bf2
  .long 0x76afedcb, 0x34521098, 0xbb1bbbbb, 0xbbbbb4bb, 0x3b, 0x21140b, 0x3, 0x0
  .long 0xb1d0b0d, 0xb3d0b2d, 0xb5d0b4d, 0xb8d0b7d, 0xbad0b9d, 0xbcd0bbd, 0xbeb0bdd, 0xb6f0bfd
  .long 0x76afedcb, 0x5321498, 0xbb1bbbbb, 0xbbbbb2bb, 0xb, 0x21120b, 0x0, 0x0
  .long 0xb1a0b0a, 0xb3a0b2a, 0xb5a0b4a, 0xb8a0b6a, 0xbaa0b9a, 0xbca0bba, 0xbea0bda, 0xb7f0bfa
  .long 0x7a5fedcb, 0x64321098, 0xbb8bbbbb, 0xbbbbb7bb, 0x6b, 0x28170b, 0x6, 0x0
  .long 0xb160b06, 0xb360b26, 0xb560b46, 0xb760b66, 0xba60b96, 0xbc60bb6, 0xbe60bd6, 0xb8f0bf6
  .long 0x765fedab, 0xc4321098, 0xbbdbbbbb, 0xbbbbbcbb, 0xcb, 0x2d1c0b, 0xc, 0x0
  .long 0xb100b01, 0xb310b21, 0xb510b41, 0xb710b61, 0xba10b81, 0xbc10bb1, 0xbe10bd1, 0xb9f0bf1
  .long 0x965fedcb, 0x743210a8, 0xbbcbbbbb, 0xbbbbb0bb, 0x7b, 0x2c100b, 0x7, 0x0
  .long 0xb170b07, 0xb370b27, 0xb570b47, 0xb770b67, 0xb970b87, 0xbc70bb7, 0xbe70bd7, 0xbaf0bf7
  .long 0x765aedcb, 0xf4321098, 0xbb6bbbbb, 0xbbbbbcbb, 0xfb, 0x261c0b, 0xf, 0x0
  .long 0xb140b04, 0xb330b24, 0xb540b44, 0xb740b64, 0xb940b84, 0xbc40ba4, 0xbe40bd4, 0xbbf0bf4
  .long 0x76afedcb, 0x54321098, 0xbb8bbbbb, 0xbbbbb6bb, 0x58, 0x160b28, 0x5, 0x0
  .long 0xd50055, 0x1650135, 0x1e501b5, 0x6f50675, 0x7a50725, 0xb480b05, 0xc150b85, 0xbcf0c95
  .long 0x76afedcb, 0x24351098, 0xbb1bbbbb, 0xbbbbb3bb, 0x2b, 0x21130b, 0x2, 0x0
  .long 0xb1c0b0c, 0xb3c0b2c, 0xb5c0b4c, 0xb7c0b6c, 0xb9c0b8c, 0xbbc0bac, 0xbec0bcc, 0xbdf0bfc
  .long 0x76afedcb, 0x14523098, 0xbb1bbbbb, 0xbbbbb4bb, 0x1b, 0x21140b, 0x1, 0x0
  .long 0xb1b0b0b, 0xb3b0b2b, 0xb5b0b4b, 0xb7b0b6b, 0xb9b0b8b, 0xbbb0bab, 0xbdb0bcb, 0xbef0bfb
  .long 0x76afedcb, 0x45321098, 0xbb1bbbbb, 0xbbbbb2bb, 0x4b, 0x21120b, 0x4, 0x0
  .long 0xb1e0b0e, 0xb3e0b2e, 0xb5e0b4e, 0xb7a0b6e, 0xb9e0b8e, 0xbbe0bae, 0xbde0bce, 0xbff0bee
  .long 0x765fadce, 0xb4321098, 0xcccccccc, 0xcccccccc, 0xbc, 0x2c1c0c, 0xb, 0x0
  .long 0xc200c10, 0xc400c30, 0xc600c50, 0xc800c70, 0xca00c90, 0xcc00cb0, 0xce00cd0, 0xc0f0cf0
  .long 0x765aedfb, 0xc4321098, 0xcc8ccccc, 0xcccccfcc, 0xcc, 0x281f0c, 0xc, 0x0
  .long 0xc210c01, 0xc410c31, 0xc610c51, 0xc810c71, 0xca10c91, 0xcc10cb1, 0xce10cd1, 0xc1f0cf1
  .long 0x765fedcb, 0x843210a9, 0xccbccccc, 0xccccc4cc, 0x8c, 0x2b140c, 0x8, 0x0
  .long 0xc180c08, 0xc480c38, 0xc680c58, 0xc880c78, 0xca80c98, 0xcc80cb8, 0xce80cd8, 0xc2f0cf8
  .long 0x765fedcb, 0xa4321098, 0xcceccccc, 0xccccc1cc, 0xa1, 0x2e0c11, 0xa, 0x0
  .long 0x1a80128, 0x3570305, 0x3d70385, 0x7950715, 0xae50a79, 0xc450af9, 0xcb70c65, 0xc3f0cc5
  .long 0x76afedcb, 0x34521098, 0xcc0ccccc, 0xccccc1cc, 0x3c, 0x20110c, 0x3, 0x0
  .long 0xc1d0c0d, 0xc3d0c2d, 0xc6d0c5d, 0xc8d0c7d, 0xcad0c9d, 0xccb0cbd, 0xced0cdd, 0xc4f0cfd
  .long 0x76afedcb, 0x25341098, 0xcc2ccccc, 0xccccc9cc, 0x2c, 0x22190c, 0x2, 0x0
  .long 0xc1c0c0c, 0xc3c0c2c, 0xc6c0c4c, 0xc8c0c7c, 0xcac0c9c, 0xccc0cbc, 0xcec0cdc, 0xc5f0cfc
  .long 0x76afedcb, 0x4321598, 0xcc0ccccc, 0xccccc1cc, 0xc, 0x20110c, 0x0, 0x0
  .long 0xc1a0c0a, 0xc3a0c2a, 0xc5a0c4a, 0xc8a0c7a, 0xcaa0c9a, 0xcca0cba, 0xcea0cda, 0xc6f0cfa
  .long 0x76afedcb, 0x54321098, 0xcc7ccccc, 0xccccc9cc, 0x57, 0x190c27, 0x5, 0x0
  .long 0x990019, 0x2d50255, 0x4690445, 0x4e904c5, 0x5a50525, 0x8b90839, 0x9880908, 0xc7f0cf6
  .long 0x765fadcb, 0xe4321098, 0xcccccccc, 0xcccccccc, 0xec, 0x2c1c0c, 0xe, 0x0
  .long 0xc130c00, 0xc330c23, 0xc530c43, 0xc730c63, 0xca30c93, 0xcc30cb3, 0xce30cd3, 0xc8f0cf3
  .long 0x765aedcb, 0xf4321098, 0xcc8ccccc, 0xcccccfcc, 0xfc, 0x281f0c, 0xf, 0x0
  .long 0xc110c04, 0xc340c24, 0xc540c44, 0xc740c64, 0xca40c84, 0xcc40cb4, 0xce40cd4, 0xc9f0cf4
  .long 0x765fedcb, 0x943210a8, 0xccbccccc, 0xccccc4cc, 0x9c, 0x2b140c, 0x9, 0x0
  .long 0xc190c09, 0xc390c28, 0xc590c49, 0xc790c69, 0xc990c89, 0xcc90cb9, 0xce90cd9, 0xcaf0cf9
  .long 0xa65fedcb, 0x74321098, 0xcceccccc, 0xccccc1cc, 0x7c, 0x2e110c, 0x7, 0x0
  .long 0xc170c07, 0xc370c27, 0xc570c47, 0xc770c67, 0xc970c87, 0xcc70ca7, 0xce70cd7, 0xcbf0cf7
  .long 0x76afedcb, 0x14523098, 0xcc0ccccc, 0xccccc1cc, 0x1c, 0x20110c, 0x1, 0x0
  .long 0xc1b0c0b, 0xc3b0c2b, 0xc5b0c4b, 0xc7b0c6b, 0xc9b0c8b, 0xcbb0cab, 0xceb0cdb, 0xccf0cfb
  .long 0x76afedcb, 0x45321098, 0xcc2ccccc, 0xccccc9cc, 0x4c, 0x22190c, 0x4, 0x0
  .long 0xc1e0c0e, 0xc3e0c2e, 0xc5c0c4e, 0xc7e0c6e, 0xc9e0c8e, 0xcbe0cae, 0xcee0cce, 0xcdf0cfe
  .long 0x765feacb, 0xd4321098, 0xcc6ccccc, 0xcccccbcc, 0xdc, 0x261b0c, 0xd, 0x0
  .long 0xc120c02, 0xc320c22, 0xc520c42, 0xc720c62, 0xc920c82, 0xcb20ca2, 0xcd20cc2, 0xcef0cf2
  .long 0x75afedcb, 0x64321098, 0xcc7ccccc, 0xccccc9cc, 0x6c, 0x27190c, 0x6, 0x0
  .long 0xc160c06, 0xc360c26, 0xc560c46, 0xc760c66, 0xc960c86, 0xcb60ca6, 0xcd60cc6, 0xcff0ce6
  .long 0x76afedcb, 0x24351098, 0xdd0ddddd, 0xddddd6dd, 0x2d, 0x20160d, 0x2, 0x0
  .long 0xd2c0d1c, 0xd4c0d3c, 0xd6c0d5c, 0xd8b0d7c, 0xdac0d9c, 0xdcc0dbc, 0xdec0ddc, 0xd0f0dfc
  .long 0x56afedcb, 0x74321098, 0xdd6ddddd, 0xddddd3dd, 0x7d, 0x26130d, 0x7, 0x0
  .long 0xd270d07, 0xd470d37, 0xd670d57, 0xd870d77, 0xda70d97, 0xdc70db7, 0xde70dd7, 0xd1f0df7
  .long 0x765aedcb, 0xf4321098, 0xddfddddd, 0xdddddbdd, 0xfd, 0x2f1b0d, 0xf, 0x0
  .long 0xd140d04, 0xd440d34, 0xd640d54, 0xd840d74, 0xda40d94, 0xdc40db4, 0xde40dd4, 0xd2f0df4
  .long 0x76afedcb, 0x94321058, 0xdddddddd, 0xddddd3dd, 0x9d, 0x2d130d, 0x9, 0x0
  .long 0xd190d09, 0xd490d29, 0xd690d59, 0xd890d79, 0xda90d99, 0xdc90db6, 0xde90dd9, 0xd3f0df9
  .long 0x76afedcb, 0x45321098, 0xdd3ddddd, 0xddddd0dd, 0x4d, 0x23100d, 0x4, 0x0
  .long 0xd1e0d0e, 0xd3e0d2e, 0xd6e0d5e, 0xd8e0d7e, 0xdae0d9e, 0xdca0dbe, 0xdee0dde, 0xd4f0dfe
  .long 0x765feadb, 0xc4321098, 0xddaddddd, 0xdddddedd, 0xcd, 0x2a1e0d, 0xc, 0x0
  .long 0xd110d01, 0xd310d21, 0xd610d41, 0xd810d71, 0xda10d91, 0xdc10db1, 0xde10dd1, 0xd5f0df1
  .long 0x765fadce, 0xb4321098, 0xddbddddd, 0xdddddfdd, 0xbd, 0x2b1f0d, 0xb, 0x0
  .long 0xd100d00, 0xd300d20, 0xd500d40, 0xd800d70, 0xda00d90, 0xdc00db0, 0xde00dd0, 0xd6f0df0
  .long 0x765fedcb, 0xa4321098, 0xddfddddd, 0xddddd0dd, 0xa0, 0x2f0d10, 0xa, 0x0
  .long 0xe50065, 0x1950115, 0x2d90259, 0x9850905, 0xba90b29, 0xdc50d45, 0xe350df8, 0xd7f0eb5
  .long 0x76afedcb, 0x14352098, 0xdd0ddddd, 0xddddd6dd, 0x1d, 0x20160d, 0x1, 0x0
  .long 0xd1b0d0b, 0xd3b0d2b, 0xd5b0d4b, 0xd7b0d6b, 0xdab0d9b, 0xdcb0dbb, 0xdeb0ddb, 0xd8f0dfb
  .long 0x76afedcb, 0x54321098, 0xdd6ddddd, 0xddddd3dd, 0x56, 0x130d26, 0x5, 0x0
  .long 0x4750455, 0x4f504d5, 0x7c70747, 0x8a50825, 0xa650a05, 0xb350a85, 0xce50bb5, 0xd9f0d17
  .long 0x76afedcb, 0x34521098, 0xdd2ddddd, 0xddddd8dd, 0x3d, 0x22180d, 0x3, 0x0
  .long 0xd1d0d0d, 0xd3d0d2d, 0xd5d0d4d, 0xd7d0d6d, 0xd9d0d8d, 0xdcd0dbd, 0xded0ddd, 0xdaf0dfd
  .long 0x79afedcb, 0x64321058, 0xdddddddd, 0xddddd3dd, 0x6d, 0x2d130d, 0x6, 0x0
  .long 0xd160d06, 0xd360d26, 0xd560d46, 0xd760d66, 0xd960d86, 0xdc60da6, 0xde60dd6, 0xdbf0df6
  .long 0x76afedcb, 0x5321498, 0xdd3ddddd, 0xddddd0dd, 0xd, 0x23100d, 0x0, 0x0
  .long 0xd1a0d0a, 0xd3a0d2a, 0xd5a0d4a, 0xd7a0d6a, 0xd9a0d8a, 0xdba0daa, 0xdea0dda, 0xdcf0dfa
  .long 0x765feacb, 0xd4321098, 0xddaddddd, 0xdddddedd, 0xdd, 0x2a1e0d, 0xd, 0x0
  .long 0xd120d02, 0xd320d22, 0xd510d42, 0xd720d62, 0xd920d82, 0xdb20da2, 0xde20dc2, 0xddf0df2
  .long 0x765fadcb, 0xe4321098, 0xddbddddd, 0xdddddfdd, 0xed, 0x2b1f0d, 0xe, 0x0
  .long 0xd130d03, 0xd330d23, 0xd530d43, 0xd730d60, 0xd930d83, 0xdb30da3, 0xdd30dc3, 0xdef0df3
  .long 0x765fedcb, 0x8432109a, 0xddfddddd, 0xddddd0dd, 0x8d, 0x2f100d, 0x8, 0x0
  .long 0xd180d08, 0xd380d28, 0xd580d48, 0xd780d68, 0xd980d88, 0xdb80da8, 0xdd80dc8, 0xdff0de8
  .long 0x7a5fedcb, 0x64321098, 0xeefeeeee, 0xeeeee2ee, 0x6e, 0x2f120e, 0x6, 0x0
  .long 0xe260e16, 0xe460e36, 0xe660e56, 0xe860e76, 0xea60e96, 0xec60eb6, 0xee60ed6, 0xe0f0ef6
  .long 0x76afedcb, 0x4351298, 0xee4eeeee, 0xeeeee2ee, 0xe, 0x24120e, 0x0, 0x0
  .long 0xe2a0e0a, 0xe4a0e3a, 0xe6a0e5a, 0xe8a0e7a, 0xeaa0e9a, 0xeca0eba, 0xeea0eda, 0xe1f0efa
  .long 0x76afedcb, 0x45321098, 0xee4eeeee, 0xeeeee9ee, 0x4e, 0x24190e, 0x4, 0x0
  .long 0xe1e0e0e, 0xe4e0e3e, 0xe6e0e5e, 0xe8e0e7e, 0xeab0e9e, 0xece0ebe, 0xeee0ede, 0xe2f0efe
  .long 0x76afedcb, 0x84321095, 0xee5eeeee, 0xeeeee0ee, 0x8e, 0x25100e, 0x8, 0x0
  .long 0xe180e08, 0xe480e28, 0xe680e58, 0xe880e78, 0xea80e98, 0xec80eb7, 0xee80ed8, 0xe3f0ef8
  .long 0x765feadb, 0xc4321098, 0xeeceeeee, 0xeeeeeeee, 0xce, 0x2c1e0e, 0xc, 0x0
  .long 0xe110e01, 0xe310e21, 0xe610e51, 0xe810e71, 0xea10e91, 0xec10eb1, 0xee10ed1, 0xe4f0ef1
  .long 0x76afedcb, 0x34521098, 0xee1eeeee, 0xeeeee3ee, 0x3e, 0x21130e, 0x3, 0x0
  .long 0xe1d0e0d, 0xe3d0e2d, 0xe6d0e4d, 0xe8d0e7d, 0xead0e9d, 0xecd0ebd, 0xeed0edd, 0xe5f0efd
  .long 0x76afedcb, 0x54321098, 0xeedeeeee, 0xeeeee8ee, 0x5d, 0x180e2d, 0x5, 0x0
  .long 0xa50025, 0x7850705, 0x9f90979, 0xad80a58, 0xb950b15, 0xdb90d39, 0xf450ee9, 0xe6f0fc5
  .long 0x765fadce, 0xb4321098, 0xeebeeeee, 0xeeeeebee, 0xbe, 0x2b1b0e, 0xb, 0x0
  .long 0xe100e00, 0xe300e20, 0xe500e40, 0xe800e60, 0xea00e90, 0xec00eb0, 0xee00ed0, 0xe7f0ef0
  .long 0x765fedcb, 0xa4321098, 0xeefeeeee, 0xeeeee2ee, 0xa2, 0x2f0e12, 0xa, 0x0
  .long 0xb80038, 0x3a50325, 0x5e50565, 0xad50a55, 0xbf50b75, 0xe150e06, 0xf490e95, 0xe8f0fc9
  .long 0x76afedcb, 0x24351098, 0xee4eeeee, 0xeeeee2ee, 0x2e, 0x24120e, 0x2, 0x0
  .long 0xe1a0e0c, 0xe3c0e2c, 0xe5c0e4c, 0xe7c0e6c, 0xeac0e8c, 0xecc0ebc, 0xeec0edc, 0xe9f0efc
  .long 0x76afedcb, 0x15324098, 0xee4eeeee, 0xeeeee9ee, 0x1e, 0x24190e, 0x1, 0x0
  .long 0xe1b0e0b, 0xe3b0e2b, 0xe5b0e4b, 0xe7b0e6b, 0xe9b0e8b, 0xecb0ebb, 0xeeb0edb, 0xeaf0efb
  .long 0x86afedcb, 0x74321095, 0xee5eeeee, 0xeeeee0ee, 0x7e, 0x25100e, 0x7, 0x0
  .long 0xe170e07, 0xe370e27, 0xe570e47, 0xe770e67, 0xe970e87, 0xec70ea7, 0xee70ed7, 0xebf0ef7
  .long 0x765feacb, 0xd4321098, 0xeeceeeee, 0xeeeeeeee, 0xde, 0x2c1e0e, 0xd, 0x0
  .long 0xe120e02, 0xe320e22, 0xe520e41, 0xe720e62, 0xe920e82, 0xeb20ea2, 0xee20ed2, 0xecf0ef2
  .long 0x765aedcb, 0xf4321098, 0xee5eeeee, 0xeeeeeaee, 0xfe, 0x251a0e, 0xf, 0x0
  .long 0xe140e04, 0xe340e24, 0xe540e44, 0xe740e64, 0xe940e84, 0xeb40ea4, 0xee40ec4, 0xedf0ef4
  .long 0x76afedcb, 0x94321058, 0xeedeeeee, 0xeeeee8ee, 0x9e, 0x2d180e, 0x9, 0x0
  .long 0xe190e09, 0xe390e29, 0xe590e49, 0xe790e69, 0xe990e89, 0xeb90ea9, 0xed90ec9, 0xeef0ef9
  .long 0x765fadcb, 0xe4321098, 0xeebeeeee, 0xeeeeebee, 0xee, 0x2b1b0e, 0xe, 0x0
  .long 0xe130e03, 0xe330e23, 0xe530e43, 0xe700e63, 0xe930e83, 0xeb30ea3, 0xed30ec3, 0xeff0ee3
  .long 0x76afedcb, 0x34521098, 0xff3fffff, 0xfffff4ff, 0x3f, 0x23140f, 0x3, 0x0
  .long 0xf2d0f1d, 0xf4d0f3d, 0xf6d0f5d, 0xf8b0f7d, 0xfad0f9d, 0xfcd0fbd, 0xfed0fdd, 0xf0f0ffd
  .long 0x76afedcb, 0x25341098, 0xff0fffff, 0xfffff9ff, 0x2f, 0x20190f, 0x2, 0x0
  .long 0xf2c0f0c, 0xf4c0f3c, 0xf6c0f5c, 0xf8c0f7c, 0xfac0f9c, 0xfcc0fbc, 0xfec0fdc, 0xf1f0ffc
  .long 0x76afedcb, 0x4321598, 0xff2fffff, 0xfffff8ff, 0xf, 0x22180f, 0x0, 0x0
  .long 0xf1a0f0a, 0xf4a0f3a, 0xf6a0f5a, 0xf8a0f7a, 0xfaa0f9a, 0xfca0fba, 0xfea0fda, 0xf2f0ffa
  .long 0x86afedcb, 0x74321095, 0xffbfffff, 0xfffff7ff, 0x7f, 0x2b170f, 0x7, 0x0
  .long 0xf170f07, 0xf470f27, 0xf670f57, 0xf870f77, 0xfa70f97, 0xfc70fb7, 0xfe70fd7, 0xf3f0ff7
  .long 0x795fedcb, 0x643210a8, 0xffdfffff, 0xfffff2ff, 0x6f, 0x2d120f, 0x6, 0x0
  .long 0xf160f06, 0xf360f26, 0xf660f56, 0xf860f76, 0xfa60f96, 0xfc60fb6, 0xfe60fd6, 0xf4f0ff6
  .long 0x765feacb, 0xd4321098, 0xffbfffff, 0xfffffdff, 0xdf, 0x2b1d0f, 0xd, 0x0
  .long 0xf120f02, 0xf320f22, 0xf620f42, 0xf820f72, 0xfa20f92, 0xfc20fb2, 0xfe20fd1, 0xf5f0ff2
  .long 0x76afedcb, 0x54321098, 0xffcfffff, 0xfffff5ff, 0x5c, 0x150f2c, 0x5, 0x0
  .long 0x2950215, 0x5b50535, 0x7f90779, 0x9d50955, 0xba50b25, 0xc850c05, 0xec50e45, 0xf6f0fe5
  .long 0x765aedcf, 0xb4321098, 0xff5fffff, 0xfffffcff, 0xbf, 0x251c0f, 0xb, 0x0
  .long 0xf100f00, 0xf300f20, 0xf500f40, 0xf800f60, 0xfa00f90, 0xfc00fb0, 0xfe00fd0, 0xf7f0ff0
  .long 0x76afedcb, 0x14523098, 0xff3fffff, 0xfffff4ff, 0x1f, 0x23140f, 0x1, 0x0
  .long 0xf1b0f0b, 0xf3b0f2b, 0xf5b0f4b, 0xf7b0f6b, 0xfab0f9b, 0xfcb0fbb, 0xfeb0fdb, 0xf8f0ffb
  .long 0x76afedcb, 0x45321098, 0xff0fffff, 0xfffff9ff, 0x4f, 0x20190f, 0x4, 0x0
  .long 0xf1c0f0e, 0xf3e0f2e, 0xf5e0f4e, 0xf7e0f6e, 0xfae0f8e, 0xfce0fbe, 0xfee0fde, 0xf9f0ffe
  .long 0x765fadcb, 0xe4321098, 0xffffffff, 0xfffffbff, 0xef, 0x2f1b0f, 0xe, 0x0
  .long 0xf130f03, 0xf330f23, 0xf530f43, 0xf730f63, 0xf930f83, 0xfc30fb3, 0xfe30fd3, 0xfaf0ff3
  .long 0x76afedcb, 0x84321095, 0xffbfffff, 0xfffff7ff, 0x8f, 0x2b170f, 0x8, 0x0
  .long 0xf180f08, 0xf370f28, 0xf580f48, 0xf780f68, 0xf980f88, 0xfc80fa8, 0xfe80fd8, 0xfbf0ff8
  .long 0x765fedcb, 0x943210a8, 0xffdfffff, 0xfffff2ff, 0x9f, 0x2d120f, 0x9, 0x0
  .long 0xf190f09, 0xf390f29, 0xf590f46, 0xf790f69, 0xf990f89, 0xfb90fa9, 0xfe90fd9, 0xfcf0ff9
  .long 0x765feadb, 0xc4321098, 0xffbfffff, 0xfffffdff, 0xcf, 0x2b1d0f, 0xc, 0x0
  .long 0xf110f01, 0xf310f21, 0xf510f41, 0xf710f61, 0xf910f81, 0xfb10fa1, 0xfe10fc1, 0xfdf0ff1
  .long 0x765fedcb, 0xa4321098, 0xffcfffff, 0xfffff5ff, 0xa5, 0x2c0f15, 0xa, 0x0
  .long 0x2450225, 0x2c502a5, 0x4950415, 0x6550605, 0x6d50685, 0x9750935, 0x9f509b5, 0xfef0f65
  .long 0x765aedcb, 0xf4321098, 0xff5fffff, 0xfffffcff, 0xff, 0x251c0f, 0xf, 0x0
  .long 0xf140f04, 0xf340f24, 0xf540f44, 0xf700f64, 0xf940f84, 0xfb40fa4, 0xfd40fc4, 0xfff0fe4
L_order_end:
.section .rodata,"a"
.p2align 6
.amdhsa_kernel standalone__kv_cache_quant_pre_rope_vs_post_rope__sampling_kernel
  .amdhsa_next_free_vgpr 252
  .amdhsa_next_free_sgpr 102
  .amdhsa_accum_offset 252
  .amdhsa_group_segment_fixed_size 0
  .amdhsa_kernarg_size 112
  .amdhsa_user_sgpr_count 2
  .amdhsa_user_sgpr_kernarg_segment_ptr 1
  .amdhsa_system_sgpr_workgroup_id_x 1
.end_amdhsa_kernel
```

```asm
; @launch grid=(256,1,1) block=(320,1,1) lds=162304
.amdgcn_target "amdgcn-amd-amdhsa--gfx950"
.text
.globl standalone__kv_cache_quant_pre_rope_vs_post_rope__sampling_kernel
.p2align 12
.type L_pad,@object
L_pad:
.fill 832, 4, 0xbf810000
.p2align 8
.type standalone__kv_cache_quant_pre_rope_vs_post_rope__sampling_kernel,@function
standalone__kv_cache_quant_pre_rope_vs_post_rope__sampling_kernel:
  s_cmpk_ge_u32 s2, 0x100
  s_cbranch_scc1 L_end
  s_load_dwordx16 s[4:19], s[0:1], 0
  s_load_dwordx8 s[20:27], s[0:1], 64
  s_load_dwordx4 s[28:31], s[0:1], 96
  v_readfirstlane_b32 s40, v0
  s_lshr_b32 s42, s2, 4
  s_cmp_lg_u32 s40, 0
  s_cbranch_scc1 L_s0
  s_setprio 3
  s_getpc_b64 s[64:65]
L_pc0:
  s_and_b32 s44, s2, 56
  v_and_b32 v20, 63, v0
  v_lshl_add_u32 v1, v20, 6, s44
  v_lshlrev_b32 v1, 4, v1
  v_min_u32 v1, L_order_end-L_pc0-1028, v1
  s_bfm_b64 exec, 50, 0
  global_load_dword v2, v1, s[64:65] offset:1024
  s_mov_b64 exec, -1
  v_min_u32 v21, 47, v20
  v_add_u32 v22, 24, v21
  v_subrev_u32 v23, 24, v21
  v_min_u32 v27, v22, v23
  s_mul_i32 s44, s42, 48
  v_add_lshl_u32 v22, v21, s44, 3
  v_add_lshl_u32 v23, v27, s44, 3
  v_lshlrev_b32 v26, 3, v21
  s_and_b32 s44, s2, 7
  s_lshr_b32 s45, s2, 3
  v_and_b32 v12, 15, v21
  v_and_b32 v4, 48, v21
  v_lshl_add_u32 v12, v4, 5, v12
  s_mul_i32 s68, s44, 96
  s_and_b32 s46, s45, 30
  s_add_u32 s68, s68, s46
  v_lshl_add_u32 v3, s68, 4, v12
  v_lshlrev_b32 v3, 6, v3
  v_lshl_add_u32 v12, s45, 4, v12
  v_lshlrev_b32 v12, 6, v12
  s_lshr_b32 s68, s45, 2
  s_lshl_b32 s68, s68, 8
  s_add_u32 s44, s44, s68
  v_and_b32 v4, 7, v20
  v_lshl_add_u32 v4, s44, 3, v4
  v_and_b32 v5, 24, v20
  v_lshl_add_u32 v4, v5, 6, v4
  v_and_b32 v5, 32, v20
  v_lshl_add_u32 v4, v5, 1, v4
  v_lshlrev_b32 v4, 6, v4
  v_add_u32 v15, 8192, v4
  v_add_u32 v16, 16384, v4
  v_add_u32 v17, 24576, v4
  v_lshlrev_b32 v27, 3, v27
  s_waitcnt lgkmcnt(0)
  s_bitcmp1_b32 s2, 3
  s_cselect_b64 s[70:71], s[24:25], s[22:23]
  global_load_dword v5, v3, s[70:71]
  global_load_dword v6, v3, s[70:71] offset:1024
  global_load_dword v11, v12, s[4:5]
  global_load_dwordx2 v[108:109], v22, s[4:5]
  global_load_dwordx2 v[110:111], v23, s[4:5]
  global_load_dwordx2 v[104:105], v26, s[18:19]
  global_load_dwordx2 v[106:107], v26, s[20:21]
  s_add_u32 s68, s42, 16
  s_mul_i32 s44, s68, 384
  s_add_u32 s32, s4, s44
  s_addc_u32 s33, s5, 0
  global_load_dwordx2 v[112:113], v26, s[32:33]
  global_load_dwordx2 v[114:115], v27, s[32:33]
  s_add_u32 s68, s42, 32
  s_mul_i32 s44, s68, 384
  s_add_u32 s32, s4, s44
  s_addc_u32 s33, s5, 0
  global_load_dwordx2 v[116:117], v26, s[32:33]
  global_load_dwordx2 v[118:119], v27, s[32:33]
  s_bitcmp1_b32 s2, 3
  s_cselect_b64 s[70:71], s[10:11], s[8:9]
  s_cselect_b64 s[64:65], s[16:17], s[14:15]
  s_bitcmp1_b32 s2, 4
  s_cselect_b64 s[64:65], s[64:65], s[70:71]
  global_load_dword v7, v4, s[64:65]
  global_load_dword v8, v15, s[64:65]
  global_load_dword v9, v16, s[64:65]
  global_load_dword v10, v17, s[64:65]
  v_mov_b32 v14, 0
  v_cmp_gt_u32 vcc, 24, v21
  v_mov_b32 v48, 0
  v_mov_b32 v49, 0
  v_mov_b32 v50, 0
  v_mov_b32 v51, 0
  ds_write_b128 v14, v[48:51] offset:0
  ds_write_b128 v14, v[48:51] offset:16
  s_waitcnt lgkmcnt(0)
  s_barrier
  s_mov_b32 s66, 0xffff0000
  s_mov_b32 s67, 0x3dd53b95
  v_cndmask_b32_e64 v30, 1.0, -1.0, vcc
  v_lshlrev_b32 v35, 4, v21
  v_mov_b32 v28, v35
  v_lshlrev_b32 v29, 1, v27
  v_mov_b32 v22, 0x80008000
  v_cndmask_b32 v31, v14, v22, vcc
  v_mov_b32 v38, 1
  s_mov_b32 s43, 1
  s_waitcnt vmcnt(8)
  v_lshlrev_b32 v52, 16, v104
  v_and_b32 v53, s66, v104
  v_lshlrev_b32 v54, 16, v105
  v_and_b32 v55, s66, v105
  v_lshlrev_b32 v56, 16, v106
  v_and_b32 v57, s66, v106
  v_lshlrev_b32 v58, 16, v107
  v_and_b32 v59, s66, v107
L_hr:
  v_lshlrev_b32 v76, 16, v108
  v_and_b32 v77, s66, v108
  v_lshlrev_b32 v78, 16, v109
  v_and_b32 v79, s66, v109
  v_lshlrev_b32 v80, 16, v110
  v_and_b32 v81, s66, v110
  v_lshlrev_b32 v82, 16, v111
  v_and_b32 v83, s66, v111
  v_mul_f32 v76, v76, v52
  v_mul_f32 v77, v77, v53
  v_mul_f32 v78, v78, v54
  v_mul_f32 v79, v79, v55
  v_mul_f32 v80, v80, v56
  v_mul_f32 v81, v81, v57
  v_mul_f32 v82, v82, v58
  v_mul_f32 v83, v83, v59
  v_cvt_pk_bf16_f32 v84, v76, v80
  v_cvt_pk_bf16_f32 v85, v77, v81
  v_cvt_pk_bf16_f32 v86, v78, v82
  v_cvt_pk_bf16_f32 v87, v79, v83
  v_lshlrev_b32 v76, 16, v84
  v_and_b32 v80, s66, v84
  v_lshlrev_b32 v77, 16, v85
  v_and_b32 v81, s66, v85
  v_lshlrev_b32 v78, 16, v86
  v_and_b32 v82, s66, v86
  v_lshlrev_b32 v79, 16, v87
  v_and_b32 v83, s66, v87
  v_fma_f32 v76, v80, v30, v76
  v_fma_f32 v77, v81, v30, v77
  v_fma_f32 v78, v82, v30, v78
  v_fma_f32 v79, v83, v30, v79
  v_cvt_pk_bf16_f32 v84, v76, v77
  v_cvt_pk_bf16_f32 v85, v78, v79
  v_xor_b32 v86, v31, v84
  v_xor_b32 v87, v31, v85
  v_mov_b32 v22, s43
  ds_write_b16 v28, v84 offset:512
  ds_write_b16_d16_hi v28, v84 offset:516
  ds_write_b16 v28, v85 offset:520
  ds_write_b16_d16_hi v28, v85 offset:524
  ds_write_b16 v29, v86 offset:514
  ds_write_b16_d16_hi v29, v86 offset:518
  ds_write_b16 v29, v87 offset:522
  ds_write_b16_d16_hi v29, v87 offset:526
  ds_write_b32 v14, v22 offset:16
  v_add_u32 v28, 1024, v28
  v_add_u32 v29, 1024, v29
  v_and_b32 v28, 0xfff, v28
  v_and_b32 v29, 0xfff, v29
  s_cmp_eq_u32 s43, 3
  s_cbranch_scc1 L_helper
  s_add_u32 s43, s43, 1
  s_waitcnt vmcnt(4) lgkmcnt(0)
  v_mov_b32 v108, v112
  v_mov_b32 v109, v113
  v_mov_b32 v110, v114
  v_mov_b32 v111, v115
  v_mov_b32 v112, v116
  v_mov_b32 v113, v117
  v_mov_b32 v114, v118
  v_mov_b32 v115, v119
  s_branch L_hr
L_s0:
  v_subrev_u32 v0, 64, v0
  s_sub_u32 s40, s40, 64
  s_and_b32 s44, s2, 7
  s_mul_i32 s44, s44, 6
  s_bfe_u32 s41, s2, 0x10003
  s_add_u32 s44, s44, s41
  s_lshl_b32 s44, s44, 15
  s_lshr_b32 s40, s40, 6
  s_cmp_ge_u32 s40, 2
  s_cselect_b64 s[62:63], -1, 0
  s_and_b32 s45, s62, 16384
  s_sub_u32 s68, s44, s45
  s_add_u32 s44, s44, s45
  v_lshl_add_u32 v16, v0, 4, s68
  v_lshl_add_u32 v15, v0, 4, s44
  v_lshrrev_b32 v25, 4, v0
  v_and_b32 v24, 15, v0
  v_add_u32 v208, 0, v15
  v_add_u32 v209, 8192, v15
  v_add_u32 v210, 4096, v15
  s_sub_u32 s45, s41, 0
  s_mul_i32 s45, s45, 98304
  v_cmp_eq_u32 s[64:65], v25, 0
  v_add_u32 v20, s45, v208
  s_nop 0
  v_cndmask_b32_e64 v208, v208, v20, s[64:65]
  v_lshl_add_u32 v22, s41, 1, v25
  v_subrev_u32 v22, s62, v22
  v_mul_u32_u24 v20, 11, v22
  v_lshrrev_b32 v20, 5, v20
  v_mad_i32_i24 v20, v20, -3, v22
  v_lshlrev_b32 v21, 4, v24
  v_lshl_add_u32 v248, v20, 8, v21
  v_add_u32 v20, 256, v248
  v_subrev_u32 v21, 512, v248
  v_min_u32 v249, v20, v21
  v_add_u32 v20, 512, v248
  v_subrev_u32 v21, 256, v248
  v_min_u32 v250, v20, v21
  v_cmp_gt_u32 vcc, 8, v24
  v_lshlrev_b32 v23, 3, v24
  v_lshrrev_b32 v22, 1, v248
  v_add3_u32 v20, v22, v23, 64
  v_subrev_u32 v21, 384, v20
  v_min_u32 v20, v20, v21
  v_sub_u32 v20, v20, v22
  v_cndmask_b32 v242, v20, v23, vcc
  v_lshrrev_b32 v22, 1, v249
  v_add3_u32 v20, v22, v23, 64
  v_subrev_u32 v21, 384, v20
  v_min_u32 v20, v20, v21
  v_sub_u32 v20, v20, v22
  v_cndmask_b32 v243, v20, v23, vcc
  v_lshrrev_b32 v22, 1, v250
  v_add3_u32 v20, v22, v23, 64
  v_subrev_u32 v21, 384, v20
  v_min_u32 v20, v20, v21
  v_sub_u32 v20, v20, v22
  v_cndmask_b32 v244, v20, v23, vcc
  s_mul_i32 s100, s40, 24576
  s_add_u32 s100, s100, 64000
  s_mul_i32 s44, s42, 1572864
  s_mov_b32 s34, 77070336
  s_mov_b32 s35, 0x20000
  s_mov_b32 s80, 25165824
  s_mov_b32 s3, 50331648
  s_mov_b32 s98, 75497472
  s_waitcnt lgkmcnt(0)
  s_add_u32 s32, s6, s44
  s_addc_u32 s33, s7, 0
  v_mov_b32 v21, s22
  v_mov_b32 v28, s24
  v_cndmask_b32 v28, v28, v21, vcc
  v_mov_b32 v21, s23
  v_mov_b32 v29, s25
  v_cndmask_b32 v29, v29, v21, vcc
  s_add_u32 m0, s100, 0
  v_lshrrev_b32 v10, 1, v208
  v_add_u32 v10, v10, v242
  v_mad_u64_u32 v[30:31], s[64:65], v10, 1, v[28:29]
  global_load_lds_dwordx4 v[30:31], off
  buffer_load_dwordx4 v[64:67], v208, s[32:35], 0 offen nt
  buffer_load_dwordx4 v[68:71], v209, s[32:35], 0 offen nt
  s_add_u32 m0, s100, 1024
  v_lshrrev_b32 v10, 1, v209
  v_add_u32 v10, v10, v244
  v_mad_u64_u32 v[30:31], s[64:65], v10, 1, v[28:29]
  global_load_lds_dwordx4 v[30:31], off
  buffer_load_dwordx4 v[72:75], v208, s[32:35], s80 offen nt
  buffer_load_dwordx4 v[76:79], v209, s[32:35], s80 offen nt
  s_add_u32 m0, s100, 2048
  v_lshrrev_b32 v10, 1, v210
  v_add_u32 v10, v10, v243
  v_mad_u64_u32 v[30:31], s[64:65], v10, 1, v[28:29]
  global_load_lds_dwordx4 v[30:31], off
  buffer_load_dwordx4 v[80:83], v208, s[32:35], s3 offen nt
  s_barrier
  s_getpc_b64 s[82:83]
L_pc1:
  s_lshl_b32 s44, s2, 6
  s_add_u32 s44, s44, L_order-L_pc1
  s_add_u32 s82, s82, s44
  s_addc_u32 s83, s83, 0
  s_load_dwordx2 s[92:93], s[82:83], 0
  s_load_dwordx2 s[96:97], s[82:83], 8
  s_mov_b32 s94, 4000000
  v_add_u32 v211, 12288, v15
  v_add_u32 v212, 16384, v16
  v_add_u32 v213, 24576, v16
  v_add_u32 v214, 20480, v16
  v_add_u32 v215, 28672, v16
  v_add_u32 v216, 65536, v15
  v_add_u32 v217, 73728, v15
  v_add_u32 v218, 69632, v15
  v_add_u32 v219, 77824, v15
  v_add_u32 v220, 81920, v16
  v_add_u32 v221, 90112, v16
  v_add_u32 v222, 86016, v16
  v_add_u32 v223, 94208, v16
  v_add_u32 v224, 131072, v15
  v_add_u32 v225, 139264, v15
  v_add_u32 v226, 135168, v15
  v_add_u32 v227, 143360, v15
  v_add_u32 v228, 147456, v16
  v_add_u32 v229, 155648, v16
  v_add_u32 v230, 151552, v16
  v_add_u32 v231, 159744, v16
  s_sub_u32 s45, s41, 0
  s_mul_i32 s45, s45, 98304
  v_cmp_eq_u32 s[64:65], v25, 15
  v_add_u32 v20, s45, v211
  s_nop 0
  v_cndmask_b32_e64 v211, v211, v20, s[64:65]
  s_sub_u32 s45, s41, 1
  s_mul_i32 s45, s45, 98304
  v_cmp_eq_u32 s[64:65], v25, 0
  v_add_u32 v20, s45, v224
  s_nop 0
  v_cndmask_b32_e64 v224, v224, v20, s[64:65]
  s_sub_u32 s45, s41, 1
  s_mul_i32 s45, s45, 98304
  v_cmp_eq_u32 s[64:65], v25, 15
  v_add_u32 v20, s45, v227
  s_nop 0
  v_cndmask_b32_e64 v227, v227, v20, s[64:65]
  v_cndmask_b32_e64 v251, v248, v249, s[62:63]
  v_cndmask_b32_e64 v252, v249, v250, s[62:63]
  v_cndmask_b32_e64 v253, v250, v248, s[62:63]
  v_cndmask_b32_e64 v245, v242, v243, s[62:63]
  v_cndmask_b32_e64 v246, v243, v244, s[62:63]
  v_cndmask_b32_e64 v247, v244, v242, s[62:63]
  v_lshrrev_b32 v22, 6, v0
  v_bfe_u32 v23, v0, 4, 2
  v_mov_b32 v14, 0
  v_and_b32 v20, 2, v0
  v_lshl_add_u32 v21, v20, 5, v25
  v_and_b32 v20, 1, v0
  v_lshl_add_u32 v21, v20, 4, v21
  v_and_b32 v20, 4, v0
  v_lshl_add_u32 v21, v20, 3, v21
  s_and_b32 s44, s62, 64
  v_xor_b32 v21, s44, v21
  v_cmp_eq_u32 s[48:49], 0, v21
  v_cmp_eq_u32 vcc, 127, v21
  s_cmp_eq_u32 s41, 0
  s_cselect_b32 s44, 0, -1
  v_add_u32 v15, s44, v21
  s_cselect_b32 s44, 2, -2
  v_add_u32 v16, s44, v21
  s_cselect_b32 s44, 1, 0
  v_add_u32 v17, s44, v21
  s_cselect_b64 s[50:51], 0, s[48:49]
  s_cselect_b64 s[52:53], 0, vcc
  s_cselect_b64 s[48:49], s[48:49], 0
  s_cselect_b64 vcc, vcc, 0
  v_mov_b32 v20, 254
  v_cndmask_b32_e64 v15, v15, v20, s[50:51]
  v_mov_b32 v20, 255
  v_cndmask_b32_e64 v15, v15, v20, s[52:53]
  v_mov_b32 v20, -128
  v_cndmask_b32_e64 v17, v17, v20, s[48:49]
  v_mov_b32 v20, -127
  v_cndmask_b32_e64 v17, v17, v20, vcc
  v_and_b32 v20, 8, v0
  v_mul_u32_u24 v20, 48, v20
  v_add_lshl_u32 v15, v15, v20, 2
  v_add_u32 v15, 45568, v15
  v_add_lshl_u32 v16, v16, v20, 2
  v_add_u32 v16, 46080, v16
  v_add_lshl_u32 v17, v17, v20, 2
  v_add_u32 v17, 46592, v17
  v_lshl_add_u32 v21, v24, 2, v23
  v_mul_u32_u24 v20, 192, v22
  v_add_lshl_u32 v3, v20, v21, 2
  v_add_u32 v3, 64000, v3
  v_lshlrev_b32 v6, 2, v22
  v_mov_b32 v236, 0
  v_mov_b32 v239, 0
  v_mov_b32 v237, 0
  v_mov_b32 v240, 0
  v_mov_b32 v238, 0
  v_mov_b32 v241, 0
  s_mov_b32 s48, 0x11111111
  s_mov_b32 s49, s48
  s_mov_b32 s50, 0x22222222
  s_mov_b32 s51, s50
  s_mov_b32 s52, 0x44444444
  s_mov_b32 s53, s52
  s_mov_b32 s54, 0x88888888
  s_mov_b32 s55, s54
  s_mov_b32 s56, 0x05040100
  s_mov_b32 s57, 0x07060302
  s_mov_b32 s38, 1572864
  s_mov_b32 s39, 0x20000
  v_lshlrev_b32 v21, 8, v23
  v_add_u32 v21, s100, v21
  v_lshl_add_u32 v12, v24, 3, v21
  s_getreg_b32 s81, hwreg(HW_REG_HW_ID, 13, 2)
  s_getreg_b32 s79, hwreg(HW_REG_HW_ID, 8, 4)
  s_getreg_b32 s46, hwreg(HW_REG_XCC_ID, 0, 3)
  s_mul_i32 s46, s46, 4352
  s_add_u32 s46, s46, 8126464
  s_add_u32 s44, s46, 2048
  v_mov_b32 v11, s44
  s_and_b32 s45, s81, 2
  s_lshl_b32 s45, s45, 9
  s_lshl_b32 s44, s40, 8
  s_add_u32 s44, s44, s45
  s_add_u32 s44, s44, s46
  s_add_u32 s44, s44, s79
  s_and_b32 s81, s81, 1
  s_lshl_b32 s81, s81, 4
  s_add_u32 s44, s44, s81
  v_mov_b32 v7, s44
  s_xor_b32 s45, s45, 1024
  s_add_u32 s46, s46, s45
  v_and_b32 v8, 1, v0
  v_lshl_add_u32 v8, v8, 4, s46
  v_bfe_u32 v21, v0, 1, 2
  v_mad_u32_u24 v21, v21, 4, v22
  v_add_u32 v9, 0, v21
  v_and_b32 v9, 3, v9
  v_lshl_add_u32 v232, v9, 8, v8
  v_add_u32 v9, 1, v21
  v_and_b32 v9, 3, v9
  v_lshl_add_u32 v233, v9, 8, v8
  v_add_u32 v9, 2, v21
  v_and_b32 v9, 3, v9
  v_lshl_add_u32 v234, v9, 8, v8
  v_add_u32 v9, 3, v21
  v_and_b32 v9, 3, v9
  v_lshl_add_u32 v235, v9, 8, v8
  s_mov_b32 s78, 0xfefefeff
  v_mov_b32 v32, 0
  v_mov_b32 v33, 0
  v_mov_b32 v34, 0
  v_mov_b32 v35, 0
  v_mov_b32 v36, 0
  v_mov_b32 v37, 0
  v_mov_b32 v38, 0
  v_mov_b32 v39, 0
  v_mov_b32 v26, 0
  v_mov_b32 v27, 0
  v_mov_b32 v8, 3
  s_cmp_lt_u32 s40, 4
  s_cselect_b64 s[60:61], 1, 0
  s_getreg_b32 s58, hwreg(HW_REG_XCC_ID, 0, 1)
  s_mul_i32 s58, s58, -5
  s_add_u32 s58, s58, 3
  s_mov_b32 s91, s58
  s_mov_b32 s69, 8
  s_mov_b32 s95, 0
  buffer_load_dwordx4 v[84:87], v209, s[32:35], s3 offen nt
  s_add_u32 m0, s100, 3072
  v_lshrrev_b32 v10, 1, v211
  v_add_u32 v10, v10, v242
  v_mad_u64_u32 v[30:31], s[64:65], v10, 1, v[28:29]
  s_waitcnt vmcnt(8)
  global_load_lds_dwordx4 v[30:31], off
  s_waitcnt vmcnt(8)
  buffer_load_dwordx4 v[88:91], v210, s[32:35], 0 offen nt
  s_waitcnt vmcnt(8)
  buffer_load_dwordx4 v[92:95], v211, s[32:35], 0 offen nt
  s_mov_b32 s47, 2
  ds_read_b32 v4, v14 offset:16
L_fqz:
  s_waitcnt lgkmcnt(0)
  v_readfirstlane_b32 s46, v4
  s_cmp_ge_u32 s46, s47
  s_cbranch_scc1 L_fqz_ok
  s_cmp_eq_u32 s94, 0
  s_cbranch_scc1 L_fqz_ok
  s_sub_u32 s94, s94, 1
  ds_read_b32 v4, v14 offset:16
  s_branch L_fqz
L_fqz_ok:
  ds_read_b128 v[40:43], v248 offset:512
  ds_read_b128 v[44:47], v250 offset:512
  ds_read_b128 v[48:51], v248 offset:1536
  s_add_u32 m0, s100, 4096
  v_lshrrev_b32 v10, 1, v212
  v_add_u32 v10, v10, v246
  v_mad_u64_u32 v[30:31], s[64:65], v10, 1, v[28:29]
  s_waitcnt vmcnt(8)
  global_load_lds_dwordx4 v[30:31], off
  ds_read_b64 v[112:113], v12 offset:0
  ds_read_b64 v[114:115], v12 offset:128
  ds_read_b64 v[116:117], v12 offset:1024
  ds_read_b64 v[118:119], v12 offset:1152
  s_waitcnt vmcnt(8)
  buffer_load_dwordx4 v[96:99], v210, s[32:35], s80 offen nt
L_it0:
  s_mov_b32 s47, 3
  ds_read_b32 v4, v14 offset:16
L_fq0:
  s_waitcnt lgkmcnt(0)
  v_readfirstlane_b32 s46, v4
  s_cmp_ge_u32 s46, s47
  s_cbranch_scc1 L_fq0_ok
  s_cmp_eq_u32 s94, 0
  s_cbranch_scc1 L_fq0_ok
  s_sub_u32 s94, s94, 1
  ds_read_b32 v4, v14 offset:16
  s_branch L_fq0
L_fq0_ok:
  ds_read_b128 v[52:55], v250 offset:1536
  ds_read_b128 v[56:59], v248 offset:2560
  ds_read_b128 v[60:63], v250 offset:2560
  v_perm_b32 v13, v114, v112, s56
  v_perm_b32 v114, v114, v112, s57
  v_perm_b32 v112, v115, v113, s56
  v_perm_b32 v115, v115, v113, s57
  v_dot2_f32_bf16 v22, v13, v40, 0
  v_dot2_f32_bf16 v23, v114, v41, 0
  v_dot2_f32_bf16 v24, v112, v42, 0
  v_dot2_f32_bf16 v25, v115, v43, 0
  v_cvt_f32_i32 v64, v64
  v_cvt_f32_i32 v65, v65
  v_cvt_f32_i32 v66, v66
  v_cvt_f32_i32 v67, v67
  v_pk_mul_f32 v[20:21], v[64:65], v[22:23]
  v_pk_add_f32 v[18:19], v[22:23], v[24:25]
  v_pk_fma_f32 v[20:21], v[66:67], v[24:25], v[20:21]
  v_add_f32 v18, v18, v19
  v_add_f32 v20, v20, v21
  s_add_u32 m0, s100, 5120
  v_lshrrev_b32 v10, 1, v213
  v_add_u32 v10, v10, v245
  v_mad_u64_u32 v[30:31], s[64:65], v10, 1, v[28:29]
  s_waitcnt vmcnt(8)
  global_load_lds_dwordx4 v[30:31], off
  s_waitcnt vmcnt(8)
  buffer_load_dwordx4 v[100:103], v211, s[32:35], s80 offen nt
  v_perm_b32 v113, v118, v116, s56
  v_perm_b32 v118, v118, v116, s57
  v_perm_b32 v116, v119, v117, s56
  v_perm_b32 v119, v119, v117, s57
  v_dot2_f32_bf16 v22, v113, v44, 0
  v_add_f32_dpp v239, v18, v18 row_ror:8 row_mask:0xf bank_mask:0xc
  v_add_f32_dpp v239, v20, v20 row_ror:8 row_mask:0xf bank_mask:0x3
  v_dot2_f32_bf16 v23, v118, v45, 0
  v_dot2_f32_bf16 v24, v116, v46, 0
  v_dot2_f32_bf16 v25, v119, v47, 0
  v_cvt_f32_i32 v68, v68
  v_cvt_f32_i32 v69, v69
  v_cvt_f32_i32 v70, v70
  v_cvt_f32_i32 v71, v71
  v_pk_mul_f32 v[20:21], v[68:69], v[22:23]
  v_pk_add_f32 v[18:19], v[22:23], v[24:25]
  v_pk_fma_f32 v[20:21], v[70:71], v[24:25], v[20:21]
  v_add_f32 v18, v18, v19
  v_add_f32 v20, v20, v21
  s_waitcnt vmcnt(8)
  buffer_load_dwordx4 v[104:107], v210, s[32:35], s3 offen nt
  v_dot2_f32_bf16 v22, v13, v48, 0
  v_add_f32_dpp v21, v18, v18 row_ror:8 row_mask:0xf bank_mask:0xc
  v_add_f32_dpp v21, v20, v20 row_ror:8 row_mask:0xf bank_mask:0x3
  v_add_f32_dpp v20, v239, v239 row_half_mirror row_mask:0xf bank_mask:0x5
  v_dot2_f32_bf16 v23, v114, v49, 0
  v_add_f32_dpp v20, v21, v21 row_half_mirror row_mask:0xf bank_mask:0xa
  v_dot2_f32_bf16 v24, v112, v50, 0
  v_dot2_f32_bf16 v25, v115, v51, 0
  v_add_f32_dpp v20, v20, v20 quad_perm:[2,3,0,1] row_mask:0xf bank_mask:0xf
  v_cvt_f32_i32 v72, v72
  v_cvt_f32_i32 v73, v73
  v_add_f32_dpp v20, v20, v20 quad_perm:[1,0,3,2] row_mask:0xf bank_mask:0xf
  v_cndmask_b32_e64 v236, v236, v20, s[48:49]
  v_cvt_f32_i32 v74, v74
  v_cvt_f32_i32 v75, v75
  v_pk_mul_f32 v[20:21], v[72:73], v[22:23]
  v_pk_add_f32 v[18:19], v[22:23], v[24:25]
  v_pk_fma_f32 v[20:21], v[74:75], v[24:25], v[20:21]
  v_add_f32 v18, v18, v19
  v_add_f32 v20, v20, v21
  s_waitcnt vmcnt(8)
  buffer_load_dwordx4 v[108:111], v211, s[32:35], s3 offen nt
L_it1:
  s_waitcnt lgkmcnt(0)
  ds_read_b128 v[40:43], v249 offset:512
  ds_read_b128 v[44:47], v248 offset:512
  ds_read_b128 v[48:51], v249 offset:1536
  v_dot2_f32_bf16 v22, v113, v52, 0
  v_add_f32_dpp v240, v18, v18 row_ror:8 row_mask:0xf bank_mask:0xc
  v_add_f32_dpp v240, v20, v20 row_ror:8 row_mask:0xf bank_mask:0x3
  v_dot2_f32_bf16 v23, v118, v53, 0
  v_dot2_f32_bf16 v24, v116, v54, 0
  v_dot2_f32_bf16 v25, v119, v55, 0
  v_cvt_f32_i32 v76, v76
  v_cvt_f32_i32 v77, v77
  v_cvt_f32_i32 v78, v78
  v_cvt_f32_i32 v79, v79
  v_pk_mul_f32 v[20:21], v[76:77], v[22:23]
  v_pk_add_f32 v[18:19], v[22:23], v[24:25]
  v_pk_fma_f32 v[20:21], v[78:79], v[24:25], v[20:21]
  v_add_f32 v18, v18, v19
  v_add_f32 v20, v20, v21
  s_add_u32 m0, s100, 6144
  v_lshrrev_b32 v10, 1, v214
  v_add_u32 v10, v10, v247
  v_mad_u64_u32 v[30:31], s[64:65], v10, 1, v[28:29]
  s_waitcnt vmcnt(8)
  global_load_lds_dwordx4 v[30:31], off
  s_waitcnt vmcnt(8)
  buffer_load_dwordx4 v[64:67], v212, s[32:35], 0 offen nt
  v_dot2_f32_bf16 v22, v13, v56, 0
  v_add_f32_dpp v21, v18, v18 row_ror:8 row_mask:0xf bank_mask:0xc
  v_add_f32_dpp v21, v20, v20 row_ror:8 row_mask:0xf bank_mask:0x3
  v_add_f32_dpp v20, v240, v240 row_half_mirror row_mask:0xf bank_mask:0x5
  v_dot2_f32_bf16 v23, v114, v57, 0
  v_add_f32_dpp v20, v21, v21 row_half_mirror row_mask:0xf bank_mask:0xa
  v_dot2_f32_bf16 v24, v112, v58, 0
  v_dot2_f32_bf16 v25, v115, v59, 0
  v_add_f32_dpp v20, v20, v20 quad_perm:[2,3,0,1] row_mask:0xf bank_mask:0xf
  v_cvt_f32_i32 v80, v80
  v_cvt_f32_i32 v81, v81
  v_add_f32_dpp v20, v20, v20 quad_perm:[1,0,3,2] row_mask:0xf bank_mask:0xf
  v_cndmask_b32_e64 v237, v237, v20, s[48:49]
  v_cvt_f32_i32 v82, v82
  v_cvt_f32_i32 v83, v83
  v_pk_mul_f32 v[20:21], v[80:81], v[22:23]
  v_pk_add_f32 v[18:19], v[22:23], v[24:25]
  v_pk_fma_f32 v[20:21], v[82:83], v[24:25], v[20:21]
  v_add_f32 v18, v18, v19
  v_add_f32 v20, v20, v21
  s_waitcnt vmcnt(8)
  buffer_load_dwordx4 v[68:71], v213, s[32:35], 0 offen nt
  ds_read_b64 v[120:121], v12 offset:2048
  ds_read_b64 v[122:123], v12 offset:2176
  ds_read_b64 v[124:125], v12 offset:3072
  ds_read_b64 v[126:127], v12 offset:3200
  v_dot2_f32_bf16 v22, v113, v60, 0
  v_add_f32_dpp v241, v18, v18 row_ror:8 row_mask:0xf bank_mask:0xc
  v_add_f32_dpp v241, v20, v20 row_ror:8 row_mask:0xf bank_mask:0x3
  v_dot2_f32_bf16 v23, v118, v61, 0
  v_dot2_f32_bf16 v24, v116, v62, 0
  v_dot2_f32_bf16 v25, v119, v63, 0
  v_cvt_f32_i32 v84, v84
  v_cvt_f32_i32 v85, v85
  v_cvt_f32_i32 v86, v86
  v_cvt_f32_i32 v87, v87
  v_pk_mul_f32 v[20:21], v[84:85], v[22:23]
  v_pk_add_f32 v[18:19], v[22:23], v[24:25]
  v_pk_fma_f32 v[20:21], v[86:87], v[24:25], v[20:21]
  v_add_f32 v18, v18, v19
  v_add_f32 v20, v20, v21
  s_waitcnt vmcnt(7)
  buffer_load_dwordx4 v[72:75], v212, s[32:35], s80 offen nt
L_it2:
  s_waitcnt lgkmcnt(0)
  ds_read_b128 v[52:55], v248 offset:1536
  ds_read_b128 v[56:59], v249 offset:2560
  ds_read_b128 v[60:63], v248 offset:2560
  ds_read_b32 v4, v14 offset:24
  v_perm_b32 v117, v122, v120, s56
  v_perm_b32 v122, v122, v120, s57
  v_perm_b32 v120, v123, v121, s56
  v_perm_b32 v123, v123, v121, s57
  v_dot2_f32_bf16 v22, v117, v40, 0
  v_add_f32_dpp v21, v18, v18 row_ror:8 row_mask:0xf bank_mask:0xc
  v_add_f32_dpp v21, v20, v20 row_ror:8 row_mask:0xf bank_mask:0x3
  v_add_f32_dpp v20, v241, v241 row_half_mirror row_mask:0xf bank_mask:0x5
  v_dot2_f32_bf16 v23, v122, v41, 0
  v_add_f32_dpp v20, v21, v21 row_half_mirror row_mask:0xf bank_mask:0xa
  v_dot2_f32_bf16 v24, v120, v42, 0
  v_dot2_f32_bf16 v25, v123, v43, 0
  v_add_f32_dpp v20, v20, v20 quad_perm:[2,3,0,1] row_mask:0xf bank_mask:0xf
  v_cvt_f32_i32 v88, v88
  v_cvt_f32_i32 v89, v89
  v_add_f32_dpp v20, v20, v20 quad_perm:[1,0,3,2] row_mask:0xf bank_mask:0xf
  v_cndmask_b32_e64 v238, v238, v20, s[48:49]
  v_cvt_f32_i32 v90, v90
  v_cvt_f32_i32 v91, v91
  v_pk_mul_f32 v[20:21], v[88:89], v[22:23]
  v_pk_add_f32 v[18:19], v[22:23], v[24:25]
  v_pk_fma_f32 v[20:21], v[90:91], v[24:25], v[20:21]
  v_add_f32 v18, v18, v19
  v_add_f32 v20, v20, v21
  s_add_u32 m0, s100, 7168
  v_lshrrev_b32 v10, 1, v215
  v_add_u32 v10, v10, v246
  v_mad_u64_u32 v[30:31], s[64:65], v10, 1, v[28:29]
  global_load_lds_dwordx4 v[30:31], off
  s_waitcnt vmcnt(7)
  buffer_load_dwordx4 v[76:79], v213, s[32:35], s80 offen nt
  v_perm_b32 v121, v126, v124, s56
  v_perm_b32 v126, v126, v124, s57
  v_perm_b32 v124, v127, v125, s56
  v_perm_b32 v127, v127, v125, s57
  v_dot2_f32_bf16 v22, v121, v44, 0
  v_add_f32_dpp v239, v18, v18 row_ror:8 row_mask:0xf bank_mask:0xc
  v_add_f32_dpp v239, v20, v20 row_ror:8 row_mask:0xf bank_mask:0x3
  v_dot2_f32_bf16 v23, v126, v45, 0
  v_dot2_f32_bf16 v24, v124, v46, 0
  v_dot2_f32_bf16 v25, v127, v47, 0
  v_cvt_f32_i32 v92, v92
  v_cvt_f32_i32 v93, v93
  v_cvt_f32_i32 v94, v94
  v_cvt_f32_i32 v95, v95
  v_pk_mul_f32 v[20:21], v[92:93], v[22:23]
  v_pk_add_f32 v[18:19], v[22:23], v[24:25]
  v_pk_fma_f32 v[20:21], v[94:95], v[24:25], v[20:21]
  v_add_f32 v18, v18, v19
  v_add_f32 v20, v20, v21
  s_waitcnt vmcnt(7)
  buffer_load_dwordx4 v[80:83], v212, s[32:35], s3 offen nt
  v_dot2_f32_bf16 v22, v117, v48, 0
  v_add_f32_dpp v21, v18, v18 row_ror:8 row_mask:0xf bank_mask:0xc
  v_add_f32_dpp v21, v20, v20 row_ror:8 row_mask:0xf bank_mask:0x3
  v_add_f32_dpp v20, v239, v239 row_half_mirror row_mask:0xf bank_mask:0x5
  v_dot2_f32_bf16 v23, v122, v49, 0
  v_add_f32_dpp v20, v21, v21 row_half_mirror row_mask:0xf bank_mask:0xa
  v_dot2_f32_bf16 v24, v120, v50, 0
  v_dot2_f32_bf16 v25, v123, v51, 0
  v_add_f32_dpp v20, v20, v20 quad_perm:[2,3,0,1] row_mask:0xf bank_mask:0xf
  v_cvt_f32_i32 v96, v96
  v_cvt_f32_i32 v97, v97
  v_add_f32_dpp v20, v20, v20 quad_perm:[1,0,3,2] row_mask:0xf bank_mask:0xf
  v_cndmask_b32_e64 v236, v236, v20, s[50:51]
  v_cvt_f32_i32 v98, v98
  v_cvt_f32_i32 v99, v99
  v_pk_mul_f32 v[20:21], v[96:97], v[22:23]
  v_pk_add_f32 v[18:19], v[22:23], v[24:25]
  v_pk_fma_f32 v[20:21], v[98:99], v[24:25], v[20:21]
  v_add_f32 v18, v18, v19
  v_add_f32 v20, v20, v21
  s_waitcnt vmcnt(7)
  buffer_load_dwordx4 v[84:87], v213, s[32:35], s3 offen nt
L_it3:
  s_mov_b32 s47, 1
L_fc:
  s_waitcnt lgkmcnt(0)
  v_readfirstlane_b32 s46, v4
  s_cmp_ge_u32 s46, s47
  s_cbranch_scc1 L_fc_ok
  s_cmp_eq_u32 s94, 0
  s_cbranch_scc1 L_fc_ok
  s_sub_u32 s94, s94, 1
  ds_read_b32 v4, v14 offset:24
  s_branch L_fc
L_fc_ok:
  ds_read_b128 v[40:43], v252 offset:512
  ds_read_b128 v[44:47], v251 offset:512
  ds_read_b128 v[48:51], v252 offset:1536
  s_add_u32 s44, s78, 0x03030303
  v_msad_u8 v9, s78, v36, 0
  v_msad_u8 v10, s44, v36, 0
  v_msad_u8 v9, s78, v37, v9
  v_msad_u8 v10, s44, v37, v10
  v_msad_u8 v9, s78, v38, v9
  v_msad_u8 v10, s44, v38, v10
  s_mov_b64 exec, 3
  global_store_byte v7, v8, s[30:31]
  global_load_dwordx3 v[36:38], v235, s[30:31] sc1
  v_sub_u32 v9, v9, v10
  v_add_u32 v8, 1, v8
  s_mov_b64 exec, -1
  v_readlane_b32 s66, v9, 0
  v_readlane_b32 s67, v9, 1
  s_add_u32 s78, s78, 0x01010101
  s_lshl1_add_u32 s69, s91, s95
  s_add_u32 s95, s66, s67
  s_mov_b32 s69, 8
  v_dot2_f32_bf16 v22, v121, v52, 0
  v_add_f32_dpp v240, v18, v18 row_ror:8 row_mask:0xf bank_mask:0xc
  v_add_f32_dpp v240, v20, v20 row_ror:8 row_mask:0xf bank_mask:0x3
  v_dot2_f32_bf16 v23, v126, v53, 0
  v_dot2_f32_bf16 v24, v124, v54, 0
  v_dot2_f32_bf16 v25, v127, v55, 0
  v_cvt_f32_i32 v100, v100
  v_cvt_f32_i32 v101, v101
  v_cvt_f32_i32 v102, v102
  v_cvt_f32_i32 v103, v103
  v_pk_mul_f32 v[20:21], v[100:101], v[22:23]
  v_pk_add_f32 v[18:19], v[22:23], v[24:25]
  v_pk_fma_f32 v[20:21], v[102:103], v[24:25], v[20:21]
  v_add_f32 v18, v18, v19
  v_add_f32 v20, v20, v21
  s_add_u32 m0, s100, 8192
  v_lshrrev_b32 v10, 1, v216
  v_add_u32 v10, v10, v243
  v_mad_u64_u32 v[30:31], s[64:65], v10, 1, v[28:29]
  global_load_lds_dwordx4 v[30:31], off
  v_dot2_f32_bf16 v22, v117, v56, 0
  v_add_f32_dpp v21, v18, v18 row_ror:8 row_mask:0xf bank_mask:0xc
  v_add_f32_dpp v21, v20, v20 row_ror:8 row_mask:0xf bank_mask:0x3
  v_add_f32_dpp v20, v240, v240 row_half_mirror row_mask:0xf bank_mask:0x5
  v_dot2_f32_bf16 v23, v122, v57, 0
  v_add_f32_dpp v20, v21, v21 row_half_mirror row_mask:0xf bank_mask:0xa
  v_dot2_f32_bf16 v24, v120, v58, 0
  v_dot2_f32_bf16 v25, v123, v59, 0
  v_add_f32_dpp v20, v20, v20 quad_perm:[2,3,0,1] row_mask:0xf bank_mask:0xf
  v_cvt_f32_i32 v104, v104
  v_cvt_f32_i32 v105, v105
  v_add_f32_dpp v20, v20, v20 quad_perm:[1,0,3,2] row_mask:0xf bank_mask:0xf
  v_cndmask_b32_e64 v237, v237, v20, s[50:51]
  v_cvt_f32_i32 v106, v106
  v_cvt_f32_i32 v107, v107
  v_pk_mul_f32 v[20:21], v[104:105], v[22:23]
  v_pk_add_f32 v[18:19], v[22:23], v[24:25]
  v_pk_fma_f32 v[20:21], v[106:107], v[24:25], v[20:21]
  v_add_f32 v18, v18, v19
  v_add_f32 v20, v20, v21
  s_cmpk_gt_i32 s69, 0x1f
  s_cbranch_scc1 L_p2_4
  s_cmpk_gt_i32 s69, 0xffdb
  s_cbranch_scc1 L_p2_1
  s_waitcnt vmcnt(6)
L_p2_1:
  s_waitcnt vmcnt(8)
L_p2_4:
  s_waitcnt vmcnt(9)
  buffer_load_dwordx4 v[88:91], v214, s[32:35], 0 offen nt
  ds_read_b64 v[128:129], v12 offset:4096
  ds_read_b64 v[130:131], v12 offset:4224
  ds_read_b64 v[132:133], v12 offset:5120
  ds_read_b64 v[134:135], v12 offset:5248
  v_dot2_f32_bf16 v22, v121, v60, 0
  v_add_f32_dpp v241, v18, v18 row_ror:8 row_mask:0xf bank_mask:0xc
  v_add_f32_dpp v241, v20, v20 row_ror:8 row_mask:0xf bank_mask:0x3
  v_dot2_f32_bf16 v23, v126, v61, 0
  v_dot2_f32_bf16 v24, v124, v62, 0
  v_dot2_f32_bf16 v25, v127, v63, 0
  v_cvt_f32_i32 v108, v108
  v_cvt_f32_i32 v109, v109
  v_cvt_f32_i32 v110, v110
  v_cvt_f32_i32 v111, v111
  v_pk_mul_f32 v[20:21], v[108:109], v[22:23]
  v_pk_add_f32 v[18:19], v[22:23], v[24:25]
  v_pk_fma_f32 v[20:21], v[110:111], v[24:25], v[20:21]
  v_add_f32 v18, v18, v19
  v_add_f32 v20, v20, v21
  s_cmpk_gt_i32 s69, 0x1f
  s_cbranch_scc1 L_p3_4
  s_cmpk_gt_i32 s69, 0xfff9
  s_cbranch_scc1 L_p3_2
  s_waitcnt vmcnt(7)
L_p3_2:
  s_waitcnt vmcnt(9)
L_p3_4:
  s_waitcnt vmcnt(10)
  buffer_load_dwordx4 v[92:95], v215, s[32:35], 0 offen nt
  s_cmpk_gt_i32 s69, 0x1f
  s_cbranch_scc1 L_p4_4
  s_cmpk_gt_i32 s69, 0xb
  s_cbranch_scc1 L_p4_3
  s_cmpk_gt_i32 s69, 0xffbb
  s_cbranch_scc1 L_p4_0
  s_waitcnt vmcnt(7)
L_p4_0:
  s_waitcnt vmcnt(8)
L_p4_3:
  s_waitcnt vmcnt(10)
L_p4_4:
  s_waitcnt vmcnt(11)
  buffer_load_dwordx4 v[96:99], v214, s[32:35], s80 offen nt
L_it4:
  s_waitcnt lgkmcnt(0)
  ds_read_b128 v[52:55], v251 offset:1536
  ds_read_b128 v[56:59], v252 offset:2560
  ds_read_b128 v[60:63], v251 offset:2560
  s_add_u32 s44, s78, 0x03030303
  v_msad_u8 v9, s78, v32, 0
  v_msad_u8 v10, s44, v32, 0
  v_msad_u8 v9, s78, v33, v9
  v_msad_u8 v10, s44, v33, v10
  v_msad_u8 v9, s78, v34, v9
  v_msad_u8 v10, s44, v34, v10
  s_mov_b64 exec, 3
  global_store_byte v7, v8, s[30:31]
  global_load_dwordx3 v[32:34], v232, s[30:31] sc1
  v_sub_u32 v9, v9, v10
  v_add_u32 v8, 1, v8
  s_mov_b64 exec, -1
  v_readlane_b32 s66, v9, 0
  v_readlane_b32 s67, v9, 1
  s_add_u32 s78, s78, 0x01010101
  s_lshl1_add_u32 s69, s91, s95
  s_add_u32 s95, s66, s67
  s_mov_b32 s69, 8
  v_perm_b32 v125, v130, v128, s56
  v_perm_b32 v130, v130, v128, s57
  v_perm_b32 v128, v131, v129, s56
  v_perm_b32 v131, v131, v129, s57
  s_waitcnt vmcnt(12)
  v_dot2_f32_bf16 v22, v125, v40, 0
  v_add_f32_dpp v21, v18, v18 row_ror:8 row_mask:0xf bank_mask:0xc
  v_add_f32_dpp v21, v20, v20 row_ror:8 row_mask:0xf bank_mask:0x3
  v_add_f32_dpp v20, v241, v241 row_half_mirror row_mask:0xf bank_mask:0x5
  v_dot2_f32_bf16 v23, v130, v41, 0
  v_add_f32_dpp v20, v21, v21 row_half_mirror row_mask:0xf bank_mask:0xa
  v_dot2_f32_bf16 v24, v128, v42, 0
  v_dot2_f32_bf16 v25, v131, v43, 0
  v_add_f32_dpp v20, v20, v20 quad_perm:[2,3,0,1] row_mask:0xf bank_mask:0xf
  v_cvt_f32_i32 v64, v64
  v_cvt_f32_i32 v65, v65
  v_add_f32_dpp v20, v20, v20 quad_perm:[1,0,3,2] row_mask:0xf bank_mask:0xf
  v_cndmask_b32_e64 v238, v238, v20, s[50:51]
  v_cvt_f32_i32 v66, v66
  v_cvt_f32_i32 v67, v67
  v_pk_mul_f32 v[20:21], v[64:65], v[22:23]
  v_pk_add_f32 v[18:19], v[22:23], v[24:25]
  v_pk_fma_f32 v[20:21], v[66:67], v[24:25], v[20:21]
  v_add_f32 v18, v18, v19
  v_add_f32 v20, v20, v21
  s_add_u32 m0, s100, 9216
  v_lshrrev_b32 v10, 1, v217
  v_add_u32 v10, v10, v242
  v_mad_u64_u32 v[30:31], s[64:65], v10, 1, v[28:29]
  global_load_lds_dwordx4 v[30:31], off
  v_perm_b32 v129, v134, v132, s56
  v_perm_b32 v134, v134, v132, s57
  v_perm_b32 v132, v135, v133, s56
  v_perm_b32 v135, v135, v133, s57
  s_waitcnt vmcnt(12)
  v_dot2_f32_bf16 v22, v129, v44, 0
  v_add_f32_dpp v239, v18, v18 row_ror:8 row_mask:0xf bank_mask:0xc
  v_add_f32_dpp v239, v20, v20 row_ror:8 row_mask:0xf bank_mask:0x3
  v_dot2_f32_bf16 v23, v134, v45, 0
  v_dot2_f32_bf16 v24, v132, v46, 0
  v_dot2_f32_bf16 v25, v135, v47, 0
  v_cvt_f32_i32 v68, v68
  v_cvt_f32_i32 v69, v69
  v_cvt_f32_i32 v70, v70
  v_cvt_f32_i32 v71, v71
  v_pk_mul_f32 v[20:21], v[68:69], v[22:23]
  v_pk_add_f32 v[18:19], v[22:23], v[24:25]
  v_pk_fma_f32 v[20:21], v[70:71], v[24:25], v[20:21]
  v_add_f32 v18, v18, v19
  v_add_f32 v20, v20, v21
  s_cmpk_gt_i32 s69, 0x1f
  s_cbranch_scc1 L_p5_4
  s_cmpk_gt_i32 s69, 0xffdb
  s_cbranch_scc1 L_p5_1
  s_waitcnt vmcnt(6)
L_p5_1:
  s_waitcnt vmcnt(10)
L_p5_4:
  s_waitcnt vmcnt(11)
  buffer_load_dwordx4 v[100:103], v215, s[32:35], s80 offen nt
  v_dot2_f32_bf16 v22, v125, v48, 0
  v_add_f32_dpp v21, v18, v18 row_ror:8 row_mask:0xf bank_mask:0xc
  v_add_f32_dpp v21, v20, v20 row_ror:8 row_mask:0xf bank_mask:0x3
  v_add_f32_dpp v20, v239, v239 row_half_mirror row_mask:0xf bank_mask:0x5
  v_dot2_f32_bf16 v23, v130, v49, 0
  v_add_f32_dpp v20, v21, v21 row_half_mirror row_mask:0xf bank_mask:0xa
  v_dot2_f32_bf16 v24, v128, v50, 0
  v_dot2_f32_bf16 v25, v131, v51, 0
  v_add_f32_dpp v20, v20, v20 quad_perm:[2,3,0,1] row_mask:0xf bank_mask:0xf
  v_cvt_f32_i32 v72, v72
  v_cvt_f32_i32 v73, v73
  v_add_f32_dpp v20, v20, v20 quad_perm:[1,0,3,2] row_mask:0xf bank_mask:0xf
  v_cndmask_b32_e64 v236, v236, v20, s[52:53]
  v_cvt_f32_i32 v74, v74
  v_cvt_f32_i32 v75, v75
  v_pk_mul_f32 v[20:21], v[72:73], v[22:23]
  v_pk_add_f32 v[18:19], v[22:23], v[24:25]
  v_pk_fma_f32 v[20:21], v[74:75], v[24:25], v[20:21]
  v_add_f32 v18, v18, v19
  v_add_f32 v20, v20, v21
  s_cmpk_gt_i32 s69, 0x1f
  s_cbranch_scc1 L_p6_4
  s_cmpk_gt_i32 s69, 0xfff9
  s_cbranch_scc1 L_p6_2
  s_waitcnt vmcnt(7)
L_p6_2:
  s_waitcnt vmcnt(11)
L_p6_4:
  s_waitcnt vmcnt(12)
  buffer_load_dwordx4 v[104:107], v214, s[32:35], s3 offen nt
  s_cmpk_gt_i32 s69, 0x1f
  s_cbranch_scc1 L_p7_4
  s_cmpk_gt_i32 s69, 0xb
  s_cbranch_scc1 L_p7_3
  s_cmpk_gt_i32 s69, 0xffbb
  s_cbranch_scc1 L_p7_0
  s_waitcnt vmcnt(7)
L_p7_0:
  s_waitcnt vmcnt(8)
L_p7_3:
  s_waitcnt vmcnt(12)
L_p7_4:
  s_waitcnt vmcnt(13)
  buffer_load_dwordx4 v[108:111], v215, s[32:35], s3 offen nt
L_it5:
  s_waitcnt lgkmcnt(0)
  ds_read_b128 v[40:43], v253 offset:512
  ds_read_b128 v[44:47], v252 offset:512
  ds_read_b128 v[48:51], v253 offset:1536
  s_waitcnt vmcnt(9)
  s_add_u32 s44, s78, 0x03030303
  v_msad_u8 v9, s78, v36, 0
  v_msad_u8 v10, s44, v36, 0
  v_msad_u8 v9, s78, v37, v9
  v_msad_u8 v10, s44, v37, v10
  v_msad_u8 v9, s78, v38, v9
  v_msad_u8 v10, s44, v38, v10
  s_mov_b64 exec, 3
  global_load_dwordx2 v[26:27], v11, s[30:31] sc1
  global_store_byte v7, v8, s[30:31]
  global_load_dwordx3 v[36:38], v233, s[30:31] sc1
  v_sub_u32 v9, v9, v10
  v_add_u32 v8, 1, v8
  s_mov_b64 exec, -1
  v_readlane_b32 s66, v9, 0
  v_readlane_b32 s67, v9, 1
  s_add_u32 s78, s78, 0x01010101
  s_lshl1_add_u32 s69, s91, s95
  s_add_u32 s95, s66, s67
  s_add_u32 s69, s69, s95
  v_dot2_f32_bf16 v22, v129, v52, 0
  v_add_f32_dpp v240, v18, v18 row_ror:8 row_mask:0xf bank_mask:0xc
  v_add_f32_dpp v240, v20, v20 row_ror:8 row_mask:0xf bank_mask:0x3
  v_dot2_f32_bf16 v23, v134, v53, 0
  v_dot2_f32_bf16 v24, v132, v54, 0
  v_dot2_f32_bf16 v25, v135, v55, 0
  v_cvt_f32_i32 v76, v76
  v_cvt_f32_i32 v77, v77
  v_cvt_f32_i32 v78, v78
  v_cvt_f32_i32 v79, v79
  v_pk_mul_f32 v[20:21], v[76:77], v[22:23]
  v_pk_add_f32 v[18:19], v[22:23], v[24:25]
  v_pk_fma_f32 v[20:21], v[78:79], v[24:25], v[20:21]
  v_add_f32 v18, v18, v19
  v_add_f32 v20, v20, v21
  s_add_u32 m0, s100, 10240
  v_lshrrev_b32 v10, 1, v218
  v_add_u32 v10, v10, v244
  v_mad_u64_u32 v[30:31], s[64:65], v10, 1, v[28:29]
  global_load_lds_dwordx4 v[30:31], off
  v_dot2_f32_bf16 v22, v125, v56, 0
  v_add_f32_dpp v21, v18, v18 row_ror:8 row_mask:0xf bank_mask:0xc
  v_add_f32_dpp v21, v20, v20 row_ror:8 row_mask:0xf bank_mask:0x3
  v_add_f32_dpp v20, v240, v240 row_half_mirror row_mask:0xf bank_mask:0x5
  v_dot2_f32_bf16 v23, v130, v57, 0
  v_add_f32_dpp v20, v21, v21 row_half_mirror row_mask:0xf bank_mask:0xa
  v_dot2_f32_bf16 v24, v128, v58, 0
  v_dot2_f32_bf16 v25, v131, v59, 0
  v_add_f32_dpp v20, v20, v20 quad_perm:[2,3,0,1] row_mask:0xf bank_mask:0xf
  v_cvt_f32_i32 v80, v80
  v_cvt_f32_i32 v81, v81
  v_add_f32_dpp v20, v20, v20 quad_perm:[1,0,3,2] row_mask:0xf bank_mask:0xf
  v_cndmask_b32_e64 v237, v237, v20, s[52:53]
  v_cvt_f32_i32 v82, v82
  v_cvt_f32_i32 v83, v83
  v_pk_mul_f32 v[20:21], v[80:81], v[22:23]
  v_pk_add_f32 v[18:19], v[22:23], v[24:25]
  v_pk_fma_f32 v[20:21], v[82:83], v[24:25], v[20:21]
  v_add_f32 v18, v18, v19
  v_add_f32 v20, v20, v21
  s_cmpk_gt_i32 s69, 0x1f
  s_cbranch_scc1 L_p8_4
  s_cmpk_gt_i32 s69, 0xffdb
  s_cbranch_scc1 L_p8_1
  s_waitcnt vmcnt(7)
L_p8_1:
  s_waitcnt vmcnt(11)
L_p8_4:
  s_waitcnt vmcnt(12)
  buffer_load_dwordx4 v[64:67], v216, s[32:35], 0 offen nt
  ds_read_b64 v[136:137], v12 offset:6144
  ds_read_b64 v[138:139], v12 offset:6272
  ds_read_b64 v[140:141], v12 offset:7168
  ds_read_b64 v[142:143], v12 offset:7296
  v_dot2_f32_bf16 v22, v129, v60, 0
  v_add_f32_dpp v241, v18, v18 row_ror:8 row_mask:0xf bank_mask:0xc
  v_add_f32_dpp v241, v20, v20 row_ror:8 row_mask:0xf bank_mask:0x3
  v_dot2_f32_bf16 v23, v134, v61, 0
  v_dot2_f32_bf16 v24, v132, v62, 0
  v_dot2_f32_bf16 v25, v135, v63, 0
  v_cvt_f32_i32 v84, v84
  v_cvt_f32_i32 v85, v85
  v_cvt_f32_i32 v86, v86
  v_cvt_f32_i32 v87, v87
  v_pk_mul_f32 v[20:21], v[84:85], v[22:23]
  v_pk_add_f32 v[18:19], v[22:23], v[24:25]
  v_pk_fma_f32 v[20:21], v[86:87], v[24:25], v[20:21]
  v_add_f32 v18, v18, v19
  v_add_f32 v20, v20, v21
  s_cmpk_gt_i32 s69, 0x1f
  s_cbranch_scc1 L_p9_4
  s_cmpk_gt_i32 s69, 0xfff9
  s_cbranch_scc1 L_p9_2
  s_waitcnt vmcnt(8)
L_p9_2:
  s_waitcnt vmcnt(12)
L_p9_4:
  s_waitcnt vmcnt(13)
  buffer_load_dwordx4 v[68:71], v217, s[32:35], 0 offen nt
  s_cmpk_gt_i32 s69, 0x1f
  s_cbranch_scc1 L_p10_4
  s_cmpk_gt_i32 s69, 0xb
  s_cbranch_scc1 L_p10_3
  s_cmpk_gt_i32 s69, 0xffbb
  s_cbranch_scc1 L_p10_0
  s_waitcnt vmcnt(8)
L_p10_0:
  s_waitcnt vmcnt(9)
L_p10_3:
  s_waitcnt vmcnt(13)
L_p10_4:
  s_waitcnt vmcnt(14)
  buffer_load_dwordx4 v[72:75], v216, s[32:35], s80 offen nt
L_it6:
  s_waitcnt lgkmcnt(0)
  ds_read_b128 v[52:55], v252 offset:1536
  ds_read_b128 v[56:59], v253 offset:2560
  ds_read_b128 v[60:63], v252 offset:2560
  s_waitcnt vmcnt(10)
  s_add_u32 s44, s78, 0x03030303
  v_msad_u8 v9, s78, v32, 0
  v_msad_u8 v10, s44, v32, 0
  v_msad_u8 v9, s78, v33, v9
  v_msad_u8 v10, s44, v33, v10
  v_msad_u8 v9, s78, v34, v9
  v_msad_u8 v10, s44, v34, v10
  s_mov_b64 exec, 3
  global_store_byte v7, v8, s[30:31]
  global_load_dwordx3 v[32:34], v234, s[30:31] sc1
  v_sub_u32 v9, v9, v10
  v_add_u32 v8, 1, v8
  s_mov_b64 exec, -1
  v_readlane_b32 s66, v9, 0
  v_readlane_b32 s67, v9, 1
  s_add_u32 s78, s78, 0x01010101
  s_lshl1_add_u32 s69, s91, s95
  s_add_u32 s95, s66, s67
  s_add_u32 s69, s69, s95
  v_perm_b32 v133, v138, v136, s56
  v_perm_b32 v138, v138, v136, s57
  v_perm_b32 v136, v139, v137, s56
  v_perm_b32 v139, v139, v137, s57
  v_dot2_f32_bf16 v22, v133, v40, 0
  v_add_f32_dpp v21, v18, v18 row_ror:8 row_mask:0xf bank_mask:0xc
  v_add_f32_dpp v21, v20, v20 row_ror:8 row_mask:0xf bank_mask:0x3
  v_add_f32_dpp v20, v241, v241 row_half_mirror row_mask:0xf bank_mask:0x5
  v_dot2_f32_bf16 v23, v138, v41, 0
  v_add_f32_dpp v20, v21, v21 row_half_mirror row_mask:0xf bank_mask:0xa
  v_dot2_f32_bf16 v24, v136, v42, 0
  v_dot2_f32_bf16 v25, v139, v43, 0
  v_add_f32_dpp v20, v20, v20 quad_perm:[2,3,0,1] row_mask:0xf bank_mask:0xf
  v_cvt_f32_i32 v88, v88
  v_cvt_f32_i32 v89, v89
  v_add_f32_dpp v20, v20, v20 quad_perm:[1,0,3,2] row_mask:0xf bank_mask:0xf
  v_cndmask_b32_e64 v238, v238, v20, s[52:53]
  v_cvt_f32_i32 v90, v90
  v_cvt_f32_i32 v91, v91
  v_pk_mul_f32 v[20:21], v[88:89], v[22:23]
  v_pk_add_f32 v[18:19], v[22:23], v[24:25]
  v_pk_fma_f32 v[20:21], v[90:91], v[24:25], v[20:21]
  v_add_f32 v18, v18, v19
  v_add_f32 v20, v20, v21
  s_add_u32 m0, s100, 11264
  v_lshrrev_b32 v10, 1, v219
  v_add_u32 v10, v10, v243
  v_mad_u64_u32 v[30:31], s[64:65], v10, 1, v[28:29]
  global_load_lds_dwordx4 v[30:31], off
  v_perm_b32 v137, v142, v140, s56
  v_perm_b32 v142, v142, v140, s57
  v_perm_b32 v140, v143, v141, s56
  v_perm_b32 v143, v143, v141, s57
  v_dot2_f32_bf16 v22, v137, v44, 0
  v_add_f32_dpp v239, v18, v18 row_ror:8 row_mask:0xf bank_mask:0xc
  v_add_f32_dpp v239, v20, v20 row_ror:8 row_mask:0xf bank_mask:0x3
  v_dot2_f32_bf16 v23, v142, v45, 0
  v_dot2_f32_bf16 v24, v140, v46, 0
  v_dot2_f32_bf16 v25, v143, v47, 0
  v_cvt_f32_i32 v92, v92
  v_cvt_f32_i32 v93, v93
  v_cvt_f32_i32 v94, v94
  v_cvt_f32_i32 v95, v95
  v_pk_mul_f32 v[20:21], v[92:93], v[22:23]
  v_pk_add_f32 v[18:19], v[22:23], v[24:25]
  v_pk_fma_f32 v[20:21], v[94:95], v[24:25], v[20:21]
  v_add_f32 v18, v18, v19
  v_add_f32 v20, v20, v21
  s_cmpk_gt_i32 s69, 0x1f
  s_cbranch_scc1 L_p11_4
  s_cmpk_gt_i32 s69, 0xffdb
  s_cbranch_scc1 L_p11_1
  s_waitcnt vmcnt(6)
L_p11_1:
  s_waitcnt vmcnt(11)
L_p11_4:
  s_waitcnt vmcnt(12)
  buffer_load_dwordx4 v[76:79], v217, s[32:35], s80 offen nt
  v_dot2_f32_bf16 v22, v133, v48, 0
  v_add_f32_dpp v21, v18, v18 row_ror:8 row_mask:0xf bank_mask:0xc
  v_add_f32_dpp v21, v20, v20 row_ror:8 row_mask:0xf bank_mask:0x3
  v_add_f32_dpp v20, v239, v239 row_half_mirror row_mask:0xf bank_mask:0x5
  v_dot2_f32_bf16 v23, v138, v49, 0
  v_add_f32_dpp v20, v21, v21 row_half_mirror row_mask:0xf bank_mask:0xa
  v_dot2_f32_bf16 v24, v136, v50, 0
  v_dot2_f32_bf16 v25, v139, v51, 0
  v_add_f32_dpp v20, v20, v20 quad_perm:[2,3,0,1] row_mask:0xf bank_mask:0xf
  v_cvt_f32_i32 v96, v96
  v_cvt_f32_i32 v97, v97
  v_add_f32_dpp v20, v20, v20 quad_perm:[1,0,3,2] row_mask:0xf bank_mask:0xf
  v_cndmask_b32_e64 v236, v236, v20, s[54:55]
  ds_write_b32 v15, v236 offset:0
  v_cvt_f32_i32 v98, v98
  v_cvt_f32_i32 v99, v99
  v_pk_mul_f32 v[20:21], v[96:97], v[22:23]
  v_pk_add_f32 v[18:19], v[22:23], v[24:25]
  v_pk_fma_f32 v[20:21], v[98:99], v[24:25], v[20:21]
  v_add_f32 v18, v18, v19
  v_add_f32 v20, v20, v21
  s_cmpk_gt_i32 s69, 0x1f
  s_cbranch_scc1 L_p12_4
  s_cmpk_gt_i32 s69, 0xfff9
  s_cbranch_scc1 L_p12_2
  s_waitcnt vmcnt(7)
L_p12_2:
  s_waitcnt vmcnt(12)
L_p12_4:
  s_waitcnt vmcnt(13)
  buffer_load_dwordx4 v[80:83], v216, s[32:35], s3 offen nt
  s_cmpk_gt_i32 s69, 0x1f
  s_cbranch_scc1 L_p13_4
  s_cmpk_gt_i32 s69, 0xb
  s_cbranch_scc1 L_p13_3
  s_cmpk_gt_i32 s69, 0xffbb
  s_cbranch_scc1 L_p13_0
  s_waitcnt vmcnt(7)
L_p13_0:
  s_waitcnt vmcnt(8)
L_p13_3:
  s_waitcnt vmcnt(13)
L_p13_4:
  s_waitcnt vmcnt(14)
  buffer_load_dwordx4 v[84:87], v217, s[32:35], s3 offen nt
L_it7:
  s_waitcnt lgkmcnt(0)
  ds_read_b128 v[40:43], v249 offset:512
  ds_read_b128 v[44:47], v248 offset:512
  ds_read_b128 v[48:51], v249 offset:1536
  s_waitcnt vmcnt(9)
  s_add_u32 s44, s78, 0x03030303
  v_msad_u8 v9, s78, v36, 0
  v_msad_u8 v10, s44, v36, 0
  v_msad_u8 v9, s78, v37, v9
  v_msad_u8 v10, s44, v37, v10
  v_msad_u8 v9, s78, v38, v9
  v_msad_u8 v10, s44, v38, v10
  s_mov_b64 exec, 3
  global_store_byte v7, v8, s[30:31]
  global_load_dwordx3 v[36:38], v235, s[30:31] sc1
  v_sub_u32 v9, v9, v10
  v_add3_u32 v10, v26, v27, s58
  v_add_u32 v8, 1, v8
  s_mov_b64 exec, -1
  v_readlane_b32 s66, v9, 0
  v_readlane_b32 s67, v9, 1
  v_readlane_b32 s91, v10, 0
  s_add_u32 s78, s78, 0x01010101
  s_lshl1_add_u32 s69, s91, s95
  s_add_u32 s95, s66, s67
  s_add_u32 s69, s69, s95
  v_dot2_f32_bf16 v22, v137, v52, 0
  v_add_f32_dpp v240, v18, v18 row_ror:8 row_mask:0xf bank_mask:0xc
  v_add_f32_dpp v240, v20, v20 row_ror:8 row_mask:0xf bank_mask:0x3
  v_dot2_f32_bf16 v23, v142, v53, 0
  v_dot2_f32_bf16 v24, v140, v54, 0
  v_dot2_f32_bf16 v25, v143, v55, 0
  v_cvt_f32_i32 v100, v100
  v_cvt_f32_i32 v101, v101
  v_cvt_f32_i32 v102, v102
  v_cvt_f32_i32 v103, v103
  v_pk_mul_f32 v[20:21], v[100:101], v[22:23]
  v_pk_add_f32 v[18:19], v[22:23], v[24:25]
  v_pk_fma_f32 v[20:21], v[102:103], v[24:25], v[20:21]
  v_add_f32 v18, v18, v19
  v_add_f32 v20, v20, v21
  s_add_u32 m0, s100, 12288
  v_lshrrev_b32 v10, 1, v220
  v_add_u32 v10, v10, v247
  v_mad_u64_u32 v[30:31], s[64:65], v10, 1, v[28:29]
  global_load_lds_dwordx4 v[30:31], off
  v_dot2_f32_bf16 v22, v133, v56, 0
  v_add_f32_dpp v21, v18, v18 row_ror:8 row_mask:0xf bank_mask:0xc
  v_add_f32_dpp v21, v20, v20 row_ror:8 row_mask:0xf bank_mask:0x3
  v_add_f32_dpp v20, v240, v240 row_half_mirror row_mask:0xf bank_mask:0x5
  v_dot2_f32_bf16 v23, v138, v57, 0
  v_add_f32_dpp v20, v21, v21 row_half_mirror row_mask:0xf bank_mask:0xa
  v_dot2_f32_bf16 v24, v136, v58, 0
  v_dot2_f32_bf16 v25, v139, v59, 0
  v_add_f32_dpp v20, v20, v20 quad_perm:[2,3,0,1] row_mask:0xf bank_mask:0xf
  v_cvt_f32_i32 v104, v104
  v_cvt_f32_i32 v105, v105
  v_add_f32_dpp v20, v20, v20 quad_perm:[1,0,3,2] row_mask:0xf bank_mask:0xf
  v_cndmask_b32_e64 v237, v237, v20, s[54:55]
  ds_write_b32 v15, v237 offset:3072
  v_cvt_f32_i32 v106, v106
  v_cvt_f32_i32 v107, v107
  v_pk_mul_f32 v[20:21], v[104:105], v[22:23]
  v_pk_add_f32 v[18:19], v[22:23], v[24:25]
  v_pk_fma_f32 v[20:21], v[106:107], v[24:25], v[20:21]
  v_add_f32 v18, v18, v19
  v_add_f32 v20, v20, v21
  s_cmpk_gt_i32 s69, 0x1f
  s_cbranch_scc1 L_p14_4
  s_cmpk_gt_i32 s69, 0xffdb
  s_cbranch_scc1 L_p14_1
  s_waitcnt vmcnt(6)
L_p14_1:
  s_waitcnt vmcnt(10)
L_p14_4:
  s_waitcnt vmcnt(11)
  buffer_load_dwordx4 v[88:91], v218, s[32:35], 0 offen nt
  ds_read_b64 v[144:145], v12 offset:8192
  ds_read_b64 v[146:147], v12 offset:8320
  ds_read_b64 v[148:149], v12 offset:9216
  ds_read_b64 v[150:151], v12 offset:9344
  v_dot2_f32_bf16 v22, v137, v60, 0
  v_add_f32_dpp v241, v18, v18 row_ror:8 row_mask:0xf bank_mask:0xc
  v_add_f32_dpp v241, v20, v20 row_ror:8 row_mask:0xf bank_mask:0x3
  v_dot2_f32_bf16 v23, v142, v61, 0
  v_dot2_f32_bf16 v24, v140, v62, 0
  v_dot2_f32_bf16 v25, v143, v63, 0
  v_cvt_f32_i32 v108, v108
  v_cvt_f32_i32 v109, v109
  v_cvt_f32_i32 v110, v110
  v_cvt_f32_i32 v111, v111
  v_pk_mul_f32 v[20:21], v[108:109], v[22:23]
  v_pk_add_f32 v[18:19], v[22:23], v[24:25]
  v_pk_fma_f32 v[20:21], v[110:111], v[24:25], v[20:21]
  v_add_f32 v18, v18, v19
  v_add_f32 v20, v20, v21
  s_cmpk_gt_i32 s69, 0x1f
  s_cbranch_scc1 L_p15_4
  s_cmpk_gt_i32 s69, 0xfff9
  s_cbranch_scc1 L_p15_2
  s_waitcnt vmcnt(7)
L_p15_2:
  s_waitcnt vmcnt(11)
L_p15_4:
  s_waitcnt vmcnt(12)
  buffer_load_dwordx4 v[92:95], v219, s[32:35], 0 offen nt
  s_cmpk_gt_i32 s69, 0x1f
  s_cbranch_scc1 L_p16_4
  s_cmpk_gt_i32 s69, 0xb
  s_cbranch_scc1 L_p16_3
  s_cmpk_gt_i32 s69, 0xffbb
  s_cbranch_scc1 L_p16_0
  s_waitcnt vmcnt(7)
L_p16_0:
  s_waitcnt vmcnt(8)
L_p16_3:
  s_waitcnt vmcnt(12)
L_p16_4:
  s_waitcnt vmcnt(13)
  buffer_load_dwordx4 v[96:99], v218, s[32:35], s80 offen nt
  v_mov_b32 v9, 1
  ds_write_b32 v6, v9 offset:0
L_it8:
  s_waitcnt lgkmcnt(0)
  ds_read_b128 v[52:55], v248 offset:1536
  ds_read_b128 v[56:59], v249 offset:2560
  ds_read_b128 v[60:63], v248 offset:2560
  s_waitcnt vmcnt(9)
  s_add_u32 s44, s78, 0x03030303
  v_msad_u8 v9, s78, v32, 0
  v_msad_u8 v10, s44, v32, 0
  v_msad_u8 v9, s78, v33, v9
  v_msad_u8 v10, s44, v33, v10
  v_msad_u8 v9, s78, v34, v9
  v_msad_u8 v10, s44, v34, v10
  s_mov_b64 exec, 3
  global_store_byte v7, v8, s[30:31]
  global_load_dwordx3 v[32:34], v232, s[30:31] sc1
  v_sub_u32 v9, v9, v10
  v_add_u32 v8, 1, v8
  s_mov_b64 exec, -1
  v_readlane_b32 s66, v9, 0
  v_readlane_b32 s67, v9, 1
  s_add_u32 s78, s78, 0x01010101
  s_lshl1_add_u32 s69, s91, s95
  s_add_u32 s95, s66, s67
  s_add_u32 s69, s69, s95
  v_perm_b32 v141, v146, v144, s56
  v_perm_b32 v146, v146, v144, s57
  v_perm_b32 v144, v147, v145, s56
  v_perm_b32 v147, v147, v145, s57
  v_dot2_f32_bf16 v22, v141, v40, 0
  v_add_f32_dpp v21, v18, v18 row_ror:8 row_mask:0xf bank_mask:0xc
  v_add_f32_dpp v21, v20, v20 row_ror:8 row_mask:0xf bank_mask:0x3
  v_add_f32_dpp v20, v241, v241 row_half_mirror row_mask:0xf bank_mask:0x5
  v_dot2_f32_bf16 v23, v146, v41, 0
  v_add_f32_dpp v20, v21, v21 row_half_mirror row_mask:0xf bank_mask:0xa
  v_dot2_f32_bf16 v24, v144, v42, 0
  v_dot2_f32_bf16 v25, v147, v43, 0
  v_add_f32_dpp v20, v20, v20 quad_perm:[2,3,0,1] row_mask:0xf bank_mask:0xf
  v_cvt_f32_i32 v64, v64
  v_cvt_f32_i32 v65, v65
  v_add_f32_dpp v20, v20, v20 quad_perm:[1,0,3,2] row_mask:0xf bank_mask:0xf
  v_cndmask_b32_e64 v238, v238, v20, s[54:55]
  ds_write_b32 v15, v238 offset:6144
  v_cvt_f32_i32 v66, v66
  v_cvt_f32_i32 v67, v67
  v_pk_mul_f32 v[20:21], v[64:65], v[22:23]
  v_pk_add_f32 v[18:19], v[22:23], v[24:25]
  v_pk_fma_f32 v[20:21], v[66:67], v[24:25], v[20:21]
  v_add_f32 v18, v18, v19
  v_add_f32 v20, v20, v21
  s_add_u32 m0, s100, 13312
  v_lshrrev_b32 v10, 1, v221
  v_add_u32 v10, v10, v246
  v_mad_u64_u32 v[30:31], s[64:65], v10, 1, v[28:29]
  global_load_lds_dwordx4 v[30:31], off
  v_perm_b32 v145, v150, v148, s56
  v_perm_b32 v150, v150, v148, s57
  v_perm_b32 v148, v151, v149, s56
  v_perm_b32 v151, v151, v149, s57
  v_dot2_f32_bf16 v22, v145, v44, 0
  v_add_f32_dpp v239, v18, v18 row_ror:8 row_mask:0xf bank_mask:0xc
  v_add_f32_dpp v239, v20, v20 row_ror:8 row_mask:0xf bank_mask:0x3
  v_dot2_f32_bf16 v23, v150, v45, 0
  v_dot2_f32_bf16 v24, v148, v46, 0
  v_dot2_f32_bf16 v25, v151, v47, 0
  v_cvt_f32_i32 v68, v68
  v_cvt_f32_i32 v69, v69
  v_cvt_f32_i32 v70, v70
  v_cvt_f32_i32 v71, v71
  v_pk_mul_f32 v[20:21], v[68:69], v[22:23]
  v_pk_add_f32 v[18:19], v[22:23], v[24:25]
  v_pk_fma_f32 v[20:21], v[70:71], v[24:25], v[20:21]
  v_add_f32 v18, v18, v19
  v_add_f32 v20, v20, v21
  s_cmpk_gt_i32 s69, 0x1f
  s_cbranch_scc1 L_p17_4
  s_cmpk_gt_i32 s69, 0xffdb
  s_cbranch_scc1 L_p17_1
  s_waitcnt vmcnt(6)
L_p17_1:
  s_waitcnt vmcnt(10)
L_p17_4:
  s_waitcnt vmcnt(11)
  buffer_load_dwordx4 v[100:103], v219, s[32:35], s80 offen nt
  v_dot2_f32_bf16 v22, v141, v48, 0
  v_add_f32_dpp v21, v18, v18 row_ror:8 row_mask:0xf bank_mask:0xc
  v_add_f32_dpp v21, v20, v20 row_ror:8 row_mask:0xf bank_mask:0x3
  v_add_f32_dpp v20, v239, v239 row_half_mirror row_mask:0xf bank_mask:0x5
  v_dot2_f32_bf16 v23, v146, v49, 0
  v_add_f32_dpp v20, v21, v21 row_half_mirror row_mask:0xf bank_mask:0xa
  v_dot2_f32_bf16 v24, v144, v50, 0
  v_dot2_f32_bf16 v25, v147, v51, 0
  v_add_f32_dpp v20, v20, v20 quad_perm:[2,3,0,1] row_mask:0xf bank_mask:0xf
  v_cvt_f32_i32 v72, v72
  v_cvt_f32_i32 v73, v73
  v_add_f32_dpp v20, v20, v20 quad_perm:[1,0,3,2] row_mask:0xf bank_mask:0xf
  v_cndmask_b32_e64 v236, v236, v20, s[48:49]
  v_cvt_f32_i32 v74, v74
  v_cvt_f32_i32 v75, v75
  v_pk_mul_f32 v[20:21], v[72:73], v[22:23]
  v_pk_add_f32 v[18:19], v[22:23], v[24:25]
  v_pk_fma_f32 v[20:21], v[74:75], v[24:25], v[20:21]
  v_add_f32 v18, v18, v19
  v_add_f32 v20, v20, v21
  s_cmpk_gt_i32 s69, 0x1f
  s_cbranch_scc1 L_p18_4
  s_cmpk_gt_i32 s69, 0xfff9
  s_cbranch_scc1 L_p18_2
  s_waitcnt vmcnt(7)
L_p18_2:
  s_waitcnt vmcnt(11)
L_p18_4:
  s_waitcnt vmcnt(12)
  buffer_load_dwordx4 v[104:107], v218, s[32:35], s3 offen nt
  s_cmpk_gt_i32 s69, 0x1f
  s_cbranch_scc1 L_p19_4
  s_cmpk_gt_i32 s69, 0xb
  s_cbranch_scc1 L_p19_3
  s_cmpk_gt_i32 s69, 0xffbb
  s_cbranch_scc1 L_p19_0
  s_waitcnt vmcnt(7)
L_p19_0:
  s_waitcnt vmcnt(8)
L_p19_3:
  s_waitcnt vmcnt(12)
L_p19_4:
  s_waitcnt vmcnt(13)
  buffer_load_dwordx4 v[108:111], v219, s[32:35], s3 offen nt
L_it9:
  s_waitcnt lgkmcnt(0)
  ds_read_b128 v[40:43], v250 offset:512
  ds_read_b128 v[44:47], v249 offset:512
  ds_read_b128 v[48:51], v250 offset:1536
  s_waitcnt vmcnt(9)
  s_add_u32 s44, s78, 0x03030303
  v_msad_u8 v9, s78, v36, 0
  v_msad_u8 v10, s44, v36, 0
  v_msad_u8 v9, s78, v37, v9
  v_msad_u8 v10, s44, v37, v10
  v_msad_u8 v9, s78, v38, v9
  v_msad_u8 v10, s44, v38, v10
  s_mov_b64 exec, 3
  global_store_byte v7, v8, s[30:31]
  global_load_dwordx3 v[36:38], v233, s[30:31] sc1
  v_sub_u32 v9, v9, v10
  v_add_u32 v8, 1, v8
  s_mov_b64 exec, -1
  v_readlane_b32 s66, v9, 0
  v_readlane_b32 s67, v9, 1
  s_add_u32 s78, s78, 0x01010101
  s_lshl1_add_u32 s69, s91, s95
  s_add_u32 s95, s66, s67
  s_add_u32 s69, s69, s95
  v_dot2_f32_bf16 v22, v145, v52, 0
  v_add_f32_dpp v240, v18, v18 row_ror:8 row_mask:0xf bank_mask:0xc
  v_add_f32_dpp v240, v20, v20 row_ror:8 row_mask:0xf bank_mask:0x3
  v_dot2_f32_bf16 v23, v150, v53, 0
  v_dot2_f32_bf16 v24, v148, v54, 0
  v_dot2_f32_bf16 v25, v151, v55, 0
  v_cvt_f32_i32 v76, v76
  v_cvt_f32_i32 v77, v77
  v_cvt_f32_i32 v78, v78
  v_cvt_f32_i32 v79, v79
  v_pk_mul_f32 v[20:21], v[76:77], v[22:23]
  v_pk_add_f32 v[18:19], v[22:23], v[24:25]
  v_pk_fma_f32 v[20:21], v[78:79], v[24:25], v[20:21]
  v_add_f32 v18, v18, v19
  v_add_f32 v20, v20, v21
  s_add_u32 m0, s100, 14336
  v_lshrrev_b32 v10, 1, v222
  v_add_u32 v10, v10, v245
  v_mad_u64_u32 v[30:31], s[64:65], v10, 1, v[28:29]
  global_load_lds_dwordx4 v[30:31], off
  v_dot2_f32_bf16 v22, v141, v56, 0
  v_add_f32_dpp v21, v18, v18 row_ror:8 row_mask:0xf bank_mask:0xc
  v_add_f32_dpp v21, v20, v20 row_ror:8 row_mask:0xf bank_mask:0x3
  v_add_f32_dpp v20, v240, v240 row_half_mirror row_mask:0xf bank_mask:0x5
  v_dot2_f32_bf16 v23, v146, v57, 0
  v_add_f32_dpp v20, v21, v21 row_half_mirror row_mask:0xf bank_mask:0xa
  v_dot2_f32_bf16 v24, v144, v58, 0
  v_dot2_f32_bf16 v25, v147, v59, 0
  v_add_f32_dpp v20, v20, v20 quad_perm:[2,3,0,1] row_mask:0xf bank_mask:0xf
  v_cvt_f32_i32 v80, v80
  v_cvt_f32_i32 v81, v81
  v_add_f32_dpp v20, v20, v20 quad_perm:[1,0,3,2] row_mask:0xf bank_mask:0xf
  v_cndmask_b32_e64 v237, v237, v20, s[48:49]
  v_cvt_f32_i32 v82, v82
  v_cvt_f32_i32 v83, v83
  v_pk_mul_f32 v[20:21], v[80:81], v[22:23]
  v_pk_add_f32 v[18:19], v[22:23], v[24:25]
  v_pk_fma_f32 v[20:21], v[82:83], v[24:25], v[20:21]
  v_add_f32 v18, v18, v19
  v_add_f32 v20, v20, v21
  s_cmpk_gt_i32 s69, 0x1f
  s_cbranch_scc1 L_p20_4
  s_cmpk_gt_i32 s69, 0xffdb
  s_cbranch_scc1 L_p20_1
  s_waitcnt vmcnt(6)
L_p20_1:
  s_waitcnt vmcnt(10)
L_p20_4:
  s_waitcnt vmcnt(11)
  buffer_load_dwordx4 v[64:67], v220, s[32:35], 0 offen nt
  ds_read_b64 v[152:153], v12 offset:10240
  ds_read_b64 v[154:155], v12 offset:10368
  ds_read_b64 v[156:157], v12 offset:11264
  ds_read_b64 v[158:159], v12 offset:11392
  v_dot2_f32_bf16 v22, v145, v60, 0
  v_add_f32_dpp v241, v18, v18 row_ror:8 row_mask:0xf bank_mask:0xc
  v_add_f32_dpp v241, v20, v20 row_ror:8 row_mask:0xf bank_mask:0x3
  v_dot2_f32_bf16 v23, v150, v61, 0
  v_dot2_f32_bf16 v24, v148, v62, 0
  v_dot2_f32_bf16 v25, v151, v63, 0
  v_cvt_f32_i32 v84, v84
  v_cvt_f32_i32 v85, v85
  v_cvt_f32_i32 v86, v86
  v_cvt_f32_i32 v87, v87
  v_pk_mul_f32 v[20:21], v[84:85], v[22:23]
  v_pk_add_f32 v[18:19], v[22:23], v[24:25]
  v_pk_fma_f32 v[20:21], v[86:87], v[24:25], v[20:21]
  v_add_f32 v18, v18, v19
  v_add_f32 v20, v20, v21
  s_cmpk_gt_i32 s69, 0x1f
  s_cbranch_scc1 L_p21_4
  s_cmpk_gt_i32 s69, 0xfff9
  s_cbranch_scc1 L_p21_2
  s_waitcnt vmcnt(7)
L_p21_2:
  s_waitcnt vmcnt(11)
L_p21_4:
  s_waitcnt vmcnt(12)
  buffer_load_dwordx4 v[68:71], v221, s[32:35], 0 offen nt
  s_cmpk_gt_i32 s69, 0x1f
  s_cbranch_scc1 L_p22_4
  s_cmpk_gt_i32 s69, 0xb
  s_cbranch_scc1 L_p22_3
  s_cmpk_gt_i32 s69, 0xffbb
  s_cbranch_scc1 L_p22_0
  s_waitcnt vmcnt(7)
L_p22_0:
  s_waitcnt vmcnt(8)
L_p22_3:
  s_waitcnt vmcnt(12)
L_p22_4:
  s_waitcnt vmcnt(13)
  buffer_load_dwordx4 v[72:75], v220, s[32:35], s80 offen nt
L_it10:
  s_waitcnt lgkmcnt(0)
  ds_read_b128 v[52:55], v249 offset:1536
  ds_read_b128 v[56:59], v250 offset:2560
  ds_read_b128 v[60:63], v249 offset:2560
  s_waitcnt vmcnt(9)
  s_add_u32 s44, s78, 0x03030303
  v_msad_u8 v9, s78, v32, 0
  v_msad_u8 v10, s44, v32, 0
  v_msad_u8 v9, s78, v33, v9
  v_msad_u8 v10, s44, v33, v10
  v_msad_u8 v9, s78, v34, v9
  v_msad_u8 v10, s44, v34, v10
  s_mov_b64 exec, 3
  global_store_byte v7, v8, s[30:31]
  global_load_dwordx3 v[32:34], v234, s[30:31] sc1
  v_sub_u32 v9, v9, v10
  v_add_u32 v8, 1, v8
  s_mov_b64 exec, -1
  v_readlane_b32 s66, v9, 0
  v_readlane_b32 s67, v9, 1
  s_add_u32 s78, s78, 0x01010101
  s_lshl1_add_u32 s69, s91, s95
  s_add_u32 s95, s66, s67
  s_add_u32 s69, s69, s95
  v_perm_b32 v149, v154, v152, s56
  v_perm_b32 v154, v154, v152, s57
  v_perm_b32 v152, v155, v153, s56
  v_perm_b32 v155, v155, v153, s57
  v_dot2_f32_bf16 v22, v149, v40, 0
  v_add_f32_dpp v21, v18, v18 row_ror:8 row_mask:0xf bank_mask:0xc
  v_add_f32_dpp v21, v20, v20 row_ror:8 row_mask:0xf bank_mask:0x3
  v_add_f32_dpp v20, v241, v241 row_half_mirror row_mask:0xf bank_mask:0x5
  v_dot2_f32_bf16 v23, v154, v41, 0
  v_add_f32_dpp v20, v21, v21 row_half_mirror row_mask:0xf bank_mask:0xa
  v_dot2_f32_bf16 v24, v152, v42, 0
  v_dot2_f32_bf16 v25, v155, v43, 0
  v_add_f32_dpp v20, v20, v20 quad_perm:[2,3,0,1] row_mask:0xf bank_mask:0xf
  v_cvt_f32_i32 v88, v88
  v_cvt_f32_i32 v89, v89
  v_add_f32_dpp v20, v20, v20 quad_perm:[1,0,3,2] row_mask:0xf bank_mask:0xf
  v_cndmask_b32_e64 v238, v238, v20, s[48:49]
  v_cvt_f32_i32 v90, v90
  v_cvt_f32_i32 v91, v91
  v_pk_mul_f32 v[20:21], v[88:89], v[22:23]
  v_pk_add_f32 v[18:19], v[22:23], v[24:25]
  v_pk_fma_f32 v[20:21], v[90:91], v[24:25], v[20:21]
  v_add_f32 v18, v18, v19
  v_add_f32 v20, v20, v21
  s_add_u32 m0, s100, 15360
  v_lshrrev_b32 v10, 1, v223
  v_add_u32 v10, v10, v247
  v_mad_u64_u32 v[30:31], s[64:65], v10, 1, v[28:29]
  global_load_lds_dwordx4 v[30:31], off
  v_perm_b32 v153, v158, v156, s56
  v_perm_b32 v158, v158, v156, s57
  v_perm_b32 v156, v159, v157, s56
  v_perm_b32 v159, v159, v157, s57
  v_dot2_f32_bf16 v22, v153, v44, 0
  v_add_f32_dpp v239, v18, v18 row_ror:8 row_mask:0xf bank_mask:0xc
  v_add_f32_dpp v239, v20, v20 row_ror:8 row_mask:0xf bank_mask:0x3
  v_dot2_f32_bf16 v23, v158, v45, 0
  v_dot2_f32_bf16 v24, v156, v46, 0
  v_dot2_f32_bf16 v25, v159, v47, 0
  v_cvt_f32_i32 v92, v92
  v_cvt_f32_i32 v93, v93
  v_cvt_f32_i32 v94, v94
  v_cvt_f32_i32 v95, v95
  v_pk_mul_f32 v[20:21], v[92:93], v[22:23]
  v_pk_add_f32 v[18:19], v[22:23], v[24:25]
  v_pk_fma_f32 v[20:21], v[94:95], v[24:25], v[20:21]
  v_add_f32 v18, v18, v19
  v_add_f32 v20, v20, v21
  s_cmpk_gt_i32 s69, 0x1f
  s_cbranch_scc1 L_p23_4
  s_cmpk_gt_i32 s69, 0xffdb
  s_cbranch_scc1 L_p23_1
  s_waitcnt vmcnt(6)
L_p23_1:
  s_waitcnt vmcnt(10)
L_p23_4:
  s_waitcnt vmcnt(11)
  buffer_load_dwordx4 v[76:79], v221, s[32:35], s80 offen nt
  v_dot2_f32_bf16 v22, v149, v48, 0
  v_add_f32_dpp v21, v18, v18 row_ror:8 row_mask:0xf bank_mask:0xc
  v_add_f32_dpp v21, v20, v20 row_ror:8 row_mask:0xf bank_mask:0x3
  v_add_f32_dpp v20, v239, v239 row_half_mirror row_mask:0xf bank_mask:0x5
  v_dot2_f32_bf16 v23, v154, v49, 0
  v_add_f32_dpp v20, v21, v21 row_half_mirror row_mask:0xf bank_mask:0xa
  v_dot2_f32_bf16 v24, v152, v50, 0
  v_dot2_f32_bf16 v25, v155, v51, 0
  v_add_f32_dpp v20, v20, v20 quad_perm:[2,3,0,1] row_mask:0xf bank_mask:0xf
  v_cvt_f32_i32 v96, v96
  v_cvt_f32_i32 v97, v97
  v_add_f32_dpp v20, v20, v20 quad_perm:[1,0,3,2] row_mask:0xf bank_mask:0xf
  v_cndmask_b32_e64 v236, v236, v20, s[50:51]
  v_cvt_f32_i32 v98, v98
  v_cvt_f32_i32 v99, v99
  v_pk_mul_f32 v[20:21], v[96:97], v[22:23]
  v_pk_add_f32 v[18:19], v[22:23], v[24:25]
  v_pk_fma_f32 v[20:21], v[98:99], v[24:25], v[20:21]
  v_add_f32 v18, v18, v19
  v_add_f32 v20, v20, v21
  s_cmpk_gt_i32 s69, 0x1f
  s_cbranch_scc1 L_p24_4
  s_cmpk_gt_i32 s69, 0xfff9
  s_cbranch_scc1 L_p24_2
  s_waitcnt vmcnt(7)
L_p24_2:
  s_waitcnt vmcnt(11)
L_p24_4:
  s_waitcnt vmcnt(12)
  buffer_load_dwordx4 v[80:83], v220, s[32:35], s3 offen nt
  s_cmpk_gt_i32 s69, 0x1f
  s_cbranch_scc1 L_p25_4
  s_cmpk_gt_i32 s69, 0xb
  s_cbranch_scc1 L_p25_3
  s_cmpk_gt_i32 s69, 0xffbb
  s_cbranch_scc1 L_p25_0
  s_waitcnt vmcnt(7)
L_p25_0:
  s_waitcnt vmcnt(8)
L_p25_3:
  s_waitcnt vmcnt(12)
L_p25_4:
  s_waitcnt vmcnt(13)
  buffer_load_dwordx4 v[84:87], v221, s[32:35], s3 offen nt
L_it11:
  s_waitcnt lgkmcnt(0)
  ds_read_b128 v[40:43], v253 offset:512
  ds_read_b128 v[44:47], v252 offset:512
  ds_read_b128 v[48:51], v253 offset:1536
  s_waitcnt vmcnt(9)
  s_add_u32 s44, s78, 0x03030303
  v_msad_u8 v9, s78, v36, 0
  v_msad_u8 v10, s44, v36, 0
  v_msad_u8 v9, s78, v37, v9
  v_msad_u8 v10, s44, v37, v10
  v_msad_u8 v9, s78, v38, v9
  v_msad_u8 v10, s44, v38, v10
  s_mov_b64 exec, 3
  global_store_byte v7, v8, s[30:31]
  global_load_dwordx3 v[36:38], v235, s[30:31] sc1
  v_sub_u32 v9, v9, v10
  v_add_u32 v8, 1, v8
  s_mov_b64 exec, -1
  v_readlane_b32 s66, v9, 0
  v_readlane_b32 s67, v9, 1
  s_add_u32 s78, s78, 0x01010101
  s_lshl1_add_u32 s69, s91, s95
  s_add_u32 s95, s66, s67
  s_add_u32 s69, s69, s95
  v_dot2_f32_bf16 v22, v153, v52, 0
  v_add_f32_dpp v240, v18, v18 row_ror:8 row_mask:0xf bank_mask:0xc
  v_add_f32_dpp v240, v20, v20 row_ror:8 row_mask:0xf bank_mask:0x3
  v_dot2_f32_bf16 v23, v158, v53, 0
  v_dot2_f32_bf16 v24, v156, v54, 0
  v_dot2_f32_bf16 v25, v159, v55, 0
  v_cvt_f32_i32 v100, v100
  v_cvt_f32_i32 v101, v101
  v_cvt_f32_i32 v102, v102
  v_cvt_f32_i32 v103, v103
  v_pk_mul_f32 v[20:21], v[100:101], v[22:23]
  v_pk_add_f32 v[18:19], v[22:23], v[24:25]
  v_pk_fma_f32 v[20:21], v[102:103], v[24:25], v[20:21]
  v_add_f32 v18, v18, v19
  v_add_f32 v20, v20, v21
  s_add_u32 m0, s100, 16384
  v_lshrrev_b32 v10, 1, v224
  v_add_u32 v10, v10, v244
  v_mad_u64_u32 v[30:31], s[64:65], v10, 1, v[28:29]
  global_load_lds_dwordx4 v[30:31], off
  v_dot2_f32_bf16 v22, v149, v56, 0
  v_add_f32_dpp v21, v18, v18 row_ror:8 row_mask:0xf bank_mask:0xc
  v_add_f32_dpp v21, v20, v20 row_ror:8 row_mask:0xf bank_mask:0x3
  v_add_f32_dpp v20, v240, v240 row_half_mirror row_mask:0xf bank_mask:0x5
  v_dot2_f32_bf16 v23, v154, v57, 0
  v_add_f32_dpp v20, v21, v21 row_half_mirror row_mask:0xf bank_mask:0xa
  v_dot2_f32_bf16 v24, v152, v58, 0
  v_dot2_f32_bf16 v25, v155, v59, 0
  v_add_f32_dpp v20, v20, v20 quad_perm:[2,3,0,1] row_mask:0xf bank_mask:0xf
  v_cvt_f32_i32 v104, v104
  v_cvt_f32_i32 v105, v105
  v_add_f32_dpp v20, v20, v20 quad_perm:[1,0,3,2] row_mask:0xf bank_mask:0xf
  v_cndmask_b32_e64 v237, v237, v20, s[50:51]
  v_cvt_f32_i32 v106, v106
  v_cvt_f32_i32 v107, v107
  v_pk_mul_f32 v[20:21], v[104:105], v[22:23]
  v_pk_add_f32 v[18:19], v[22:23], v[24:25]
  v_pk_fma_f32 v[20:21], v[106:107], v[24:25], v[20:21]
  v_add_f32 v18, v18, v19
  v_add_f32 v20, v20, v21
  s_cmpk_gt_i32 s69, 0x1f
  s_cbranch_scc1 L_p26_4
  s_cmpk_gt_i32 s69, 0xffdb
  s_cbranch_scc1 L_p26_1
  s_waitcnt vmcnt(6)
L_p26_1:
  s_waitcnt vmcnt(10)
L_p26_4:
  s_waitcnt vmcnt(11)
  buffer_load_dwordx4 v[88:91], v222, s[32:35], 0 offen nt
  ds_read_b64 v[160:161], v12 offset:12288
  ds_read_b64 v[162:163], v12 offset:12416
  ds_read_b64 v[164:165], v12 offset:13312
  ds_read_b64 v[166:167], v12 offset:13440
  v_dot2_f32_bf16 v22, v153, v60, 0
  v_add_f32_dpp v241, v18, v18 row_ror:8 row_mask:0xf bank_mask:0xc
  v_add_f32_dpp v241, v20, v20 row_ror:8 row_mask:0xf bank_mask:0x3
  v_dot2_f32_bf16 v23, v158, v61, 0
  v_dot2_f32_bf16 v24, v156, v62, 0
  v_dot2_f32_bf16 v25, v159, v63, 0
  v_cvt_f32_i32 v108, v108
  v_cvt_f32_i32 v109, v109
  v_cvt_f32_i32 v110, v110
  v_cvt_f32_i32 v111, v111
  v_pk_mul_f32 v[20:21], v[108:109], v[22:23]
  v_pk_add_f32 v[18:19], v[22:23], v[24:25]
  v_pk_fma_f32 v[20:21], v[110:111], v[24:25], v[20:21]
  v_add_f32 v18, v18, v19
  v_add_f32 v20, v20, v21
  s_cmpk_gt_i32 s69, 0x1f
  s_cbranch_scc1 L_p27_4
  s_cmpk_gt_i32 s69, 0xfff9
  s_cbranch_scc1 L_p27_2
  s_waitcnt vmcnt(7)
L_p27_2:
  s_waitcnt vmcnt(11)
L_p27_4:
  s_waitcnt vmcnt(12)
  buffer_load_dwordx4 v[92:95], v223, s[32:35], 0 offen nt
  s_cmpk_gt_i32 s69, 0x1f
  s_cbranch_scc1 L_p28_4
  s_cmpk_gt_i32 s69, 0xb
  s_cbranch_scc1 L_p28_3
  s_cmpk_gt_i32 s69, 0xffbb
  s_cbranch_scc1 L_p28_0
  s_waitcnt vmcnt(7)
L_p28_0:
  s_waitcnt vmcnt(8)
L_p28_3:
  s_waitcnt vmcnt(12)
L_p28_4:
  s_waitcnt vmcnt(13)
  buffer_load_dwordx4 v[96:99], v222, s[32:35], s80 offen nt
L_it12:
  s_waitcnt lgkmcnt(0)
  ds_read_b128 v[52:55], v252 offset:1536
  ds_read_b128 v[56:59], v253 offset:2560
  ds_read_b128 v[60:63], v252 offset:2560
  s_waitcnt vmcnt(9)
  s_add_u32 s44, s78, 0x03030303
  v_msad_u8 v9, s78, v32, 0
  v_msad_u8 v10, s44, v32, 0
  v_msad_u8 v9, s78, v33, v9
  v_msad_u8 v10, s44, v33, v10
  v_msad_u8 v9, s78, v34, v9
  v_msad_u8 v10, s44, v34, v10
  s_mov_b64 exec, 3
  global_store_byte v7, v8, s[30:31]
  global_load_dwordx3 v[32:34], v232, s[30:31] sc1
  v_sub_u32 v9, v9, v10
  v_add_u32 v8, 1, v8
  s_mov_b64 exec, -1
  v_readlane_b32 s66, v9, 0
  v_readlane_b32 s67, v9, 1
  s_add_u32 s78, s78, 0x01010101
  s_lshl1_add_u32 s69, s91, s95
  s_add_u32 s95, s66, s67
  s_add_u32 s69, s69, s95
  v_perm_b32 v157, v162, v160, s56
  v_perm_b32 v162, v162, v160, s57
  v_perm_b32 v160, v163, v161, s56
  v_perm_b32 v163, v163, v161, s57
  v_dot2_f32_bf16 v22, v157, v40, 0
  v_add_f32_dpp v21, v18, v18 row_ror:8 row_mask:0xf bank_mask:0xc
  v_add_f32_dpp v21, v20, v20 row_ror:8 row_mask:0xf bank_mask:0x3
  v_add_f32_dpp v20, v241, v241 row_half_mirror row_mask:0xf bank_mask:0x5
  v_dot2_f32_bf16 v23, v162, v41, 0
  v_add_f32_dpp v20, v21, v21 row_half_mirror row_mask:0xf bank_mask:0xa
  v_dot2_f32_bf16 v24, v160, v42, 0
  v_dot2_f32_bf16 v25, v163, v43, 0
  v_add_f32_dpp v20, v20, v20 quad_perm:[2,3,0,1] row_mask:0xf bank_mask:0xf
  v_cvt_f32_i32 v64, v64
  v_cvt_f32_i32 v65, v65
  v_add_f32_dpp v20, v20, v20 quad_perm:[1,0,3,2] row_mask:0xf bank_mask:0xf
  v_cndmask_b32_e64 v238, v238, v20, s[50:51]
  v_cvt_f32_i32 v66, v66
  v_cvt_f32_i32 v67, v67
  v_pk_mul_f32 v[20:21], v[64:65], v[22:23]
  v_pk_add_f32 v[18:19], v[22:23], v[24:25]
  v_pk_fma_f32 v[20:21], v[66:67], v[24:25], v[20:21]
  v_add_f32 v18, v18, v19
  v_add_f32 v20, v20, v21
  s_add_u32 m0, s100, 17408
  v_lshrrev_b32 v10, 1, v225
  v_add_u32 v10, v10, v243
  v_mad_u64_u32 v[30:31], s[64:65], v10, 1, v[28:29]
  global_load_lds_dwordx4 v[30:31], off
  v_perm_b32 v161, v166, v164, s56
  v_perm_b32 v166, v166, v164, s57
  v_perm_b32 v164, v167, v165, s56
  v_perm_b32 v167, v167, v165, s57
  v_dot2_f32_bf16 v22, v161, v44, 0
  v_add_f32_dpp v239, v18, v18 row_ror:8 row_mask:0xf bank_mask:0xc
  v_add_f32_dpp v239, v20, v20 row_ror:8 row_mask:0xf bank_mask:0x3
  v_dot2_f32_bf16 v23, v166, v45, 0
  v_dot2_f32_bf16 v24, v164, v46, 0
  v_dot2_f32_bf16 v25, v167, v47, 0
  v_cvt_f32_i32 v68, v68
  v_cvt_f32_i32 v69, v69
  v_cvt_f32_i32 v70, v70
  v_cvt_f32_i32 v71, v71
  v_pk_mul_f32 v[20:21], v[68:69], v[22:23]
  v_pk_add_f32 v[18:19], v[22:23], v[24:25]
  v_pk_fma_f32 v[20:21], v[70:71], v[24:25], v[20:21]
  v_add_f32 v18, v18, v19
  v_add_f32 v20, v20, v21
  s_cmpk_gt_i32 s69, 0x1f
  s_cbranch_scc1 L_p29_4
  s_cmpk_gt_i32 s69, 0xffdb
  s_cbranch_scc1 L_p29_1
  s_waitcnt vmcnt(6)
L_p29_1:
  s_waitcnt vmcnt(10)
L_p29_4:
  s_waitcnt vmcnt(11)
  buffer_load_dwordx4 v[100:103], v223, s[32:35], s80 offen nt
  v_dot2_f32_bf16 v22, v157, v48, 0
  v_add_f32_dpp v21, v18, v18 row_ror:8 row_mask:0xf bank_mask:0xc
  v_add_f32_dpp v21, v20, v20 row_ror:8 row_mask:0xf bank_mask:0x3
  v_add_f32_dpp v20, v239, v239 row_half_mirror row_mask:0xf bank_mask:0x5
  v_dot2_f32_bf16 v23, v162, v49, 0
  v_add_f32_dpp v20, v21, v21 row_half_mirror row_mask:0xf bank_mask:0xa
  v_dot2_f32_bf16 v24, v160, v50, 0
  v_dot2_f32_bf16 v25, v163, v51, 0
  v_add_f32_dpp v20, v20, v20 quad_perm:[2,3,0,1] row_mask:0xf bank_mask:0xf
  v_cvt_f32_i32 v72, v72
  v_cvt_f32_i32 v73, v73
  v_add_f32_dpp v20, v20, v20 quad_perm:[1,0,3,2] row_mask:0xf bank_mask:0xf
  v_cndmask_b32_e64 v236, v236, v20, s[52:53]
  v_cvt_f32_i32 v74, v74
  v_cvt_f32_i32 v75, v75
  v_pk_mul_f32 v[20:21], v[72:73], v[22:23]
  v_pk_add_f32 v[18:19], v[22:23], v[24:25]
  v_pk_fma_f32 v[20:21], v[74:75], v[24:25], v[20:21]
  v_add_f32 v18, v18, v19
  v_add_f32 v20, v20, v21
  s_cmpk_gt_i32 s69, 0x1f
  s_cbranch_scc1 L_p30_4
  s_cmpk_gt_i32 s69, 0xfff9
  s_cbranch_scc1 L_p30_2
  s_waitcnt vmcnt(7)
L_p30_2:
  s_waitcnt vmcnt(11)
L_p30_4:
  s_waitcnt vmcnt(12)
  buffer_load_dwordx4 v[104:107], v222, s[32:35], s3 offen nt
  s_cmpk_gt_i32 s69, 0x1f
  s_cbranch_scc1 L_p31_4
  s_cmpk_gt_i32 s69, 0xb
  s_cbranch_scc1 L_p31_3
  s_cmpk_gt_i32 s69, 0xffbb
  s_cbranch_scc1 L_p31_0
  s_waitcnt vmcnt(7)
L_p31_0:
  s_waitcnt vmcnt(8)
L_p31_3:
  s_waitcnt vmcnt(12)
L_p31_4:
  s_waitcnt vmcnt(13)
  buffer_load_dwordx4 v[108:111], v223, s[32:35], s3 offen nt
L_it13:
  s_waitcnt lgkmcnt(0)
  ds_read_b128 v[40:43], v251 offset:512
  ds_read_b128 v[44:47], v253 offset:512
  ds_read_b128 v[48:51], v251 offset:1536
  s_waitcnt vmcnt(9)
  s_add_u32 s44, s78, 0x03030303
  v_msad_u8 v9, s78, v36, 0
  v_msad_u8 v10, s44, v36, 0
  v_msad_u8 v9, s78, v37, v9
  v_msad_u8 v10, s44, v37, v10
  v_msad_u8 v9, s78, v38, v9
  v_msad_u8 v10, s44, v38, v10
  s_mov_b64 exec, 3
  global_load_dwordx2 v[26:27], v11, s[30:31] sc1
  global_store_byte v7, v8, s[30:31]
  global_load_dwordx3 v[36:38], v233, s[30:31] sc1
  v_sub_u32 v9, v9, v10
  v_add_u32 v8, 1, v8
  s_mov_b64 exec, -1
  v_readlane_b32 s66, v9, 0
  v_readlane_b32 s67, v9, 1
  s_add_u32 s78, s78, 0x01010101
  s_lshl1_add_u32 s69, s91, s95
  s_add_u32 s95, s66, s67
  s_add_u32 s69, s69, s95
  v_dot2_f32_bf16 v22, v161, v52, 0
  v_add_f32_dpp v240, v18, v18 row_ror:8 row_mask:0xf bank_mask:0xc
  v_add_f32_dpp v240, v20, v20 row_ror:8 row_mask:0xf bank_mask:0x3
  v_dot2_f32_bf16 v23, v166, v53, 0
  v_dot2_f32_bf16 v24, v164, v54, 0
  v_dot2_f32_bf16 v25, v167, v55, 0
  v_cvt_f32_i32 v76, v76
  v_cvt_f32_i32 v77, v77
  v_cvt_f32_i32 v78, v78
  v_cvt_f32_i32 v79, v79
  v_pk_mul_f32 v[20:21], v[76:77], v[22:23]
  v_pk_add_f32 v[18:19], v[22:23], v[24:25]
  v_pk_fma_f32 v[20:21], v[78:79], v[24:25], v[20:21]
  v_add_f32 v18, v18, v19
  v_add_f32 v20, v20, v21
  s_add_u32 m0, s100, 18432
  v_lshrrev_b32 v10, 1, v226
  v_add_u32 v10, v10, v242
  v_mad_u64_u32 v[30:31], s[64:65], v10, 1, v[28:29]
  global_load_lds_dwordx4 v[30:31], off
  v_dot2_f32_bf16 v22, v157, v56, 0
  v_add_f32_dpp v21, v18, v18 row_ror:8 row_mask:0xf bank_mask:0xc
  v_add_f32_dpp v21, v20, v20 row_ror:8 row_mask:0xf bank_mask:0x3
  v_add_f32_dpp v20, v240, v240 row_half_mirror row_mask:0xf bank_mask:0x5
  v_dot2_f32_bf16 v23, v162, v57, 0
  v_add_f32_dpp v20, v21, v21 row_half_mirror row_mask:0xf bank_mask:0xa
  v_dot2_f32_bf16 v24, v160, v58, 0
  v_dot2_f32_bf16 v25, v163, v59, 0
  v_add_f32_dpp v20, v20, v20 quad_perm:[2,3,0,1] row_mask:0xf bank_mask:0xf
  v_cvt_f32_i32 v80, v80
  v_cvt_f32_i32 v81, v81
  v_add_f32_dpp v20, v20, v20 quad_perm:[1,0,3,2] row_mask:0xf bank_mask:0xf
  v_cndmask_b32_e64 v237, v237, v20, s[52:53]
  v_cvt_f32_i32 v82, v82
  v_cvt_f32_i32 v83, v83
  v_pk_mul_f32 v[20:21], v[80:81], v[22:23]
  v_pk_add_f32 v[18:19], v[22:23], v[24:25]
  v_pk_fma_f32 v[20:21], v[82:83], v[24:25], v[20:21]
  v_add_f32 v18, v18, v19
  v_add_f32 v20, v20, v21
  s_cmpk_gt_i32 s69, 0x1f
  s_cbranch_scc1 L_p32_4
  s_cmpk_gt_i32 s69, 0xffdb
  s_cbranch_scc1 L_p32_1
  s_waitcnt vmcnt(7)
L_p32_1:
  s_waitcnt vmcnt(11)
L_p32_4:
  s_waitcnt vmcnt(12)
  buffer_load_dwordx4 v[64:67], v224, s[32:35], 0 offen nt
  ds_read_b64 v[168:169], v12 offset:14336
  ds_read_b64 v[170:171], v12 offset:14464
  ds_read_b64 v[172:173], v12 offset:15360
  ds_read_b64 v[174:175], v12 offset:15488
  v_dot2_f32_bf16 v22, v161, v60, 0
  v_add_f32_dpp v241, v18, v18 row_ror:8 row_mask:0xf bank_mask:0xc
  v_add_f32_dpp v241, v20, v20 row_ror:8 row_mask:0xf bank_mask:0x3
  v_dot2_f32_bf16 v23, v166, v61, 0
  v_dot2_f32_bf16 v24, v164, v62, 0
  v_dot2_f32_bf16 v25, v167, v63, 0
  v_cvt_f32_i32 v84, v84
  v_cvt_f32_i32 v85, v85
  v_cvt_f32_i32 v86, v86
  v_cvt_f32_i32 v87, v87
  v_pk_mul_f32 v[20:21], v[84:85], v[22:23]
  v_pk_add_f32 v[18:19], v[22:23], v[24:25]
  v_pk_fma_f32 v[20:21], v[86:87], v[24:25], v[20:21]
  v_add_f32 v18, v18, v19
  v_add_f32 v20, v20, v21
  s_cmpk_gt_i32 s69, 0x1f
  s_cbranch_scc1 L_p33_4
  s_cmpk_gt_i32 s69, 0xfff9
  s_cbranch_scc1 L_p33_2
  s_waitcnt vmcnt(8)
L_p33_2:
  s_waitcnt vmcnt(12)
L_p33_4:
  s_waitcnt vmcnt(13)
  buffer_load_dwordx4 v[68:71], v225, s[32:35], 0 offen nt
  s_cmpk_gt_i32 s69, 0x1f
  s_cbranch_scc1 L_p34_4
  s_cmpk_gt_i32 s69, 0xb
  s_cbranch_scc1 L_p34_3
  s_cmpk_gt_i32 s69, 0xffbb
  s_cbranch_scc1 L_p34_0
  s_waitcnt vmcnt(8)
L_p34_0:
  s_waitcnt vmcnt(9)
L_p34_3:
  s_waitcnt vmcnt(13)
L_p34_4:
  s_waitcnt vmcnt(14)
  buffer_load_dwordx4 v[72:75], v224, s[32:35], s80 offen nt
L_it14:
  s_waitcnt lgkmcnt(0)
  ds_read_b128 v[52:55], v253 offset:1536
  ds_read_b128 v[56:59], v251 offset:2560
  ds_read_b128 v[60:63], v253 offset:2560
  s_waitcnt vmcnt(10)
  s_add_u32 s44, s78, 0x03030303
  v_msad_u8 v9, s78, v32, 0
  v_msad_u8 v10, s44, v32, 0
  v_msad_u8 v9, s78, v33, v9
  v_msad_u8 v10, s44, v33, v10
  v_msad_u8 v9, s78, v34, v9
  v_msad_u8 v10, s44, v34, v10
  s_mov_b64 exec, 3
  global_store_byte v7, v8, s[30:31]
  global_load_dwordx3 v[32:34], v234, s[30:31] sc1
  v_sub_u32 v9, v9, v10
  v_add_u32 v8, 1, v8
  s_mov_b64 exec, -1
  v_readlane_b32 s66, v9, 0
  v_readlane_b32 s67, v9, 1
  s_add_u32 s78, s78, 0x01010101
  s_lshl1_add_u32 s69, s91, s95
  s_add_u32 s95, s66, s67
  s_add_u32 s69, s69, s95
  v_perm_b32 v165, v170, v168, s56
  v_perm_b32 v170, v170, v168, s57
  v_perm_b32 v168, v171, v169, s56
  v_perm_b32 v171, v171, v169, s57
  v_dot2_f32_bf16 v22, v165, v40, 0
  v_add_f32_dpp v21, v18, v18 row_ror:8 row_mask:0xf bank_mask:0xc
  v_add_f32_dpp v21, v20, v20 row_ror:8 row_mask:0xf bank_mask:0x3
  v_add_f32_dpp v20, v241, v241 row_half_mirror row_mask:0xf bank_mask:0x5
  v_dot2_f32_bf16 v23, v170, v41, 0
  v_add_f32_dpp v20, v21, v21 row_half_mirror row_mask:0xf bank_mask:0xa
  v_dot2_f32_bf16 v24, v168, v42, 0
  v_dot2_f32_bf16 v25, v171, v43, 0
  v_add_f32_dpp v20, v20, v20 quad_perm:[2,3,0,1] row_mask:0xf bank_mask:0xf
  v_cvt_f32_i32 v88, v88
  v_cvt_f32_i32 v89, v89
  v_add_f32_dpp v20, v20, v20 quad_perm:[1,0,3,2] row_mask:0xf bank_mask:0xf
  v_cndmask_b32_e64 v238, v238, v20, s[52:53]
  v_cvt_f32_i32 v90, v90
  v_cvt_f32_i32 v91, v91
  v_pk_mul_f32 v[20:21], v[88:89], v[22:23]
  v_pk_add_f32 v[18:19], v[22:23], v[24:25]
  v_pk_fma_f32 v[20:21], v[90:91], v[24:25], v[20:21]
  v_add_f32 v18, v18, v19
  v_add_f32 v20, v20, v21
  s_add_u32 m0, s100, 19456
  v_lshrrev_b32 v10, 1, v227
  v_add_u32 v10, v10, v244
  v_mad_u64_u32 v[30:31], s[64:65], v10, 1, v[28:29]
  global_load_lds_dwordx4 v[30:31], off
  v_perm_b32 v169, v174, v172, s56
  v_perm_b32 v174, v174, v172, s57
  v_perm_b32 v172, v175, v173, s56
  v_perm_b32 v175, v175, v173, s57
  v_dot2_f32_bf16 v22, v169, v44, 0
  v_add_f32_dpp v239, v18, v18 row_ror:8 row_mask:0xf bank_mask:0xc
  v_add_f32_dpp v239, v20, v20 row_ror:8 row_mask:0xf bank_mask:0x3
  v_dot2_f32_bf16 v23, v174, v45, 0
  v_dot2_f32_bf16 v24, v172, v46, 0
  v_dot2_f32_bf16 v25, v175, v47, 0
  v_cvt_f32_i32 v92, v92
  v_cvt_f32_i32 v93, v93
  v_cvt_f32_i32 v94, v94
  v_cvt_f32_i32 v95, v95
  v_pk_mul_f32 v[20:21], v[92:93], v[22:23]
  v_pk_add_f32 v[18:19], v[22:23], v[24:25]
  v_pk_fma_f32 v[20:21], v[94:95], v[24:25], v[20:21]
  v_add_f32 v18, v18, v19
  v_add_f32 v20, v20, v21
  s_cmpk_gt_i32 s69, 0x1f
  s_cbranch_scc1 L_p35_4
  s_cmpk_gt_i32 s69, 0xffdb
  s_cbranch_scc1 L_p35_1
  s_waitcnt vmcnt(6)
L_p35_1:
  s_waitcnt vmcnt(11)
L_p35_4:
  s_waitcnt vmcnt(12)
  buffer_load_dwordx4 v[76:79], v225, s[32:35], s80 offen nt
  v_dot2_f32_bf16 v22, v165, v48, 0
  v_add_f32_dpp v21, v18, v18 row_ror:8 row_mask:0xf bank_mask:0xc
  v_add_f32_dpp v21, v20, v20 row_ror:8 row_mask:0xf bank_mask:0x3
  v_add_f32_dpp v20, v239, v239 row_half_mirror row_mask:0xf bank_mask:0x5
  v_dot2_f32_bf16 v23, v170, v49, 0
  v_add_f32_dpp v20, v21, v21 row_half_mirror row_mask:0xf bank_mask:0xa
  v_dot2_f32_bf16 v24, v168, v50, 0
  v_dot2_f32_bf16 v25, v171, v51, 0
  v_add_f32_dpp v20, v20, v20 quad_perm:[2,3,0,1] row_mask:0xf bank_mask:0xf
  v_cvt_f32_i32 v96, v96
  v_cvt_f32_i32 v97, v97
  v_add_f32_dpp v20, v20, v20 quad_perm:[1,0,3,2] row_mask:0xf bank_mask:0xf
  v_cndmask_b32_e64 v236, v236, v20, s[54:55]
  ds_write_b32 v16, v236 offset:0
  v_cvt_f32_i32 v98, v98
  v_cvt_f32_i32 v99, v99
  v_pk_mul_f32 v[20:21], v[96:97], v[22:23]
  v_pk_add_f32 v[18:19], v[22:23], v[24:25]
  v_pk_fma_f32 v[20:21], v[98:99], v[24:25], v[20:21]
  v_add_f32 v18, v18, v19
  v_add_f32 v20, v20, v21
  s_cmpk_gt_i32 s69, 0x1f
  s_cbranch_scc1 L_p36_4
  s_cmpk_gt_i32 s69, 0xfff9
  s_cbranch_scc1 L_p36_2
  s_waitcnt vmcnt(7)
L_p36_2:
  s_waitcnt vmcnt(12)
L_p36_4:
  s_waitcnt vmcnt(13)
  buffer_load_dwordx4 v[80:83], v224, s[32:35], s3 offen nt
  s_cmpk_gt_i32 s69, 0x1f
  s_cbranch_scc1 L_p37_4
  s_cmpk_gt_i32 s69, 0xb
  s_cbranch_scc1 L_p37_3
  s_cmpk_gt_i32 s69, 0xffbb
  s_cbranch_scc1 L_p37_0
  s_waitcnt vmcnt(7)
L_p37_0:
  s_waitcnt vmcnt(8)
L_p37_3:
  s_waitcnt vmcnt(13)
L_p37_4:
  s_waitcnt vmcnt(14)
  buffer_load_dwordx4 v[84:87], v225, s[32:35], s3 offen nt
L_it15:
  s_waitcnt lgkmcnt(0)
  ds_read_b128 v[40:43], v250 offset:512
  ds_read_b128 v[44:47], v249 offset:512
  ds_read_b128 v[48:51], v250 offset:1536
  s_waitcnt vmcnt(9)
  s_add_u32 s44, s78, 0x03030303
  v_msad_u8 v9, s78, v36, 0
  v_msad_u8 v10, s44, v36, 0
  v_msad_u8 v9, s78, v37, v9
  v_msad_u8 v10, s44, v37, v10
  v_msad_u8 v9, s78, v38, v9
  v_msad_u8 v10, s44, v38, v10
  s_mov_b64 exec, 3
  global_store_byte v7, v8, s[30:31]
  global_load_dwordx3 v[36:38], v235, s[30:31] sc1
  v_sub_u32 v9, v9, v10
  v_add3_u32 v10, v26, v27, s58
  v_add_u32 v8, 1, v8
  s_mov_b64 exec, -1
  v_readlane_b32 s66, v9, 0
  v_readlane_b32 s67, v9, 1
  v_readlane_b32 s91, v10, 0
  s_add_u32 s78, s78, 0x01010101
  s_lshl1_add_u32 s69, s91, s95
  s_add_u32 s95, s66, s67
  s_add_u32 s69, s69, s95
  v_dot2_f32_bf16 v22, v169, v52, 0
  v_add_f32_dpp v240, v18, v18 row_ror:8 row_mask:0xf bank_mask:0xc
  v_add_f32_dpp v240, v20, v20 row_ror:8 row_mask:0xf bank_mask:0x3
  v_dot2_f32_bf16 v23, v174, v53, 0
  v_dot2_f32_bf16 v24, v172, v54, 0
  v_dot2_f32_bf16 v25, v175, v55, 0
  v_cvt_f32_i32 v100, v100
  v_cvt_f32_i32 v101, v101
  v_cvt_f32_i32 v102, v102
  v_cvt_f32_i32 v103, v103
  v_pk_mul_f32 v[20:21], v[100:101], v[22:23]
  v_pk_add_f32 v[18:19], v[22:23], v[24:25]
  v_pk_fma_f32 v[20:21], v[102:103], v[24:25], v[20:21]
  v_add_f32 v18, v18, v19
  v_add_f32 v20, v20, v21
  s_add_u32 m0, s100, 20480
  v_lshrrev_b32 v10, 1, v228
  v_add_u32 v10, v10, v245
  v_mad_u64_u32 v[30:31], s[64:65], v10, 1, v[28:29]
  global_load_lds_dwordx4 v[30:31], off
  v_dot2_f32_bf16 v22, v165, v56, 0
  v_add_f32_dpp v21, v18, v18 row_ror:8 row_mask:0xf bank_mask:0xc
  v_add_f32_dpp v21, v20, v20 row_ror:8 row_mask:0xf bank_mask:0x3
  v_add_f32_dpp v20, v240, v240 row_half_mirror row_mask:0xf bank_mask:0x5
  v_dot2_f32_bf16 v23, v170, v57, 0
  v_add_f32_dpp v20, v21, v21 row_half_mirror row_mask:0xf bank_mask:0xa
  v_dot2_f32_bf16 v24, v168, v58, 0
  v_dot2_f32_bf16 v25, v171, v59, 0
  v_add_f32_dpp v20, v20, v20 quad_perm:[2,3,0,1] row_mask:0xf bank_mask:0xf
  v_cvt_f32_i32 v104, v104
  v_cvt_f32_i32 v105, v105
  v_add_f32_dpp v20, v20, v20 quad_perm:[1,0,3,2] row_mask:0xf bank_mask:0xf
  v_cndmask_b32_e64 v237, v237, v20, s[54:55]
  ds_write_b32 v16, v237 offset:3072
  v_cvt_f32_i32 v106, v106
  v_cvt_f32_i32 v107, v107
  v_pk_mul_f32 v[20:21], v[104:105], v[22:23]
  v_pk_add_f32 v[18:19], v[22:23], v[24:25]
  v_pk_fma_f32 v[20:21], v[106:107], v[24:25], v[20:21]
  v_add_f32 v18, v18, v19
  v_add_f32 v20, v20, v21
  s_cmpk_gt_i32 s69, 0x1f
  s_cbranch_scc1 L_p38_4
  s_cmpk_gt_i32 s69, 0xffdb
  s_cbranch_scc1 L_p38_1
  s_waitcnt vmcnt(6)
L_p38_1:
  s_waitcnt vmcnt(10)
L_p38_4:
  s_waitcnt vmcnt(11)
  buffer_load_dwordx4 v[88:91], v226, s[32:35], 0 offen nt
  ds_read_b64 v[176:177], v12 offset:16384
  ds_read_b64 v[178:179], v12 offset:16512
  ds_read_b64 v[180:181], v12 offset:17408
  ds_read_b64 v[182:183], v12 offset:17536
  v_dot2_f32_bf16 v22, v169, v60, 0
  v_add_f32_dpp v241, v18, v18 row_ror:8 row_mask:0xf bank_mask:0xc
  v_add_f32_dpp v241, v20, v20 row_ror:8 row_mask:0xf bank_mask:0x3
  v_dot2_f32_bf16 v23, v174, v61, 0
  v_dot2_f32_bf16 v24, v172, v62, 0
  v_dot2_f32_bf16 v25, v175, v63, 0
  v_cvt_f32_i32 v108, v108
  v_cvt_f32_i32 v109, v109
  v_cvt_f32_i32 v110, v110
  v_cvt_f32_i32 v111, v111
  v_pk_mul_f32 v[20:21], v[108:109], v[22:23]
  v_pk_add_f32 v[18:19], v[22:23], v[24:25]
  v_pk_fma_f32 v[20:21], v[110:111], v[24:25], v[20:21]
  v_add_f32 v18, v18, v19
  v_add_f32 v20, v20, v21
  s_cmpk_gt_i32 s69, 0x1f
  s_cbranch_scc1 L_p39_4
  s_cmpk_gt_i32 s69, 0xfff9
  s_cbranch_scc1 L_p39_2
  s_waitcnt vmcnt(7)
L_p39_2:
  s_waitcnt vmcnt(11)
L_p39_4:
  s_waitcnt vmcnt(12)
  buffer_load_dwordx4 v[92:95], v227, s[32:35], 0 offen nt
  s_cmpk_gt_i32 s69, 0x1f
  s_cbranch_scc1 L_p40_4
  s_cmpk_gt_i32 s69, 0xb
  s_cbranch_scc1 L_p40_3
  s_cmpk_gt_i32 s69, 0xffbb
  s_cbranch_scc1 L_p40_0
  s_waitcnt vmcnt(7)
L_p40_0:
  s_waitcnt vmcnt(8)
L_p40_3:
  s_waitcnt vmcnt(12)
L_p40_4:
  s_waitcnt vmcnt(13)
  buffer_load_dwordx4 v[96:99], v226, s[32:35], s80 offen nt
  v_mov_b32 v9, 2
  ds_write_b32 v6, v9 offset:0
L_it16:
  s_waitcnt lgkmcnt(0)
  ds_read_b128 v[52:55], v249 offset:1536
  ds_read_b128 v[56:59], v250 offset:2560
  ds_read_b128 v[60:63], v249 offset:2560
  s_waitcnt vmcnt(9)
  s_add_u32 s44, s78, 0x03030303
  v_msad_u8 v9, s78, v32, 0
  v_msad_u8 v10, s44, v32, 0
  v_msad_u8 v9, s78, v33, v9
  v_msad_u8 v10, s44, v33, v10
  v_msad_u8 v9, s78, v34, v9
  v_msad_u8 v10, s44, v34, v10
  s_mov_b64 exec, 3
  global_store_byte v7, v8, s[30:31]
  global_load_dwordx3 v[32:34], v232, s[30:31] sc1
  v_sub_u32 v9, v9, v10
  v_add_u32 v8, 1, v8
  s_mov_b64 exec, -1
  v_readlane_b32 s66, v9, 0
  v_readlane_b32 s67, v9, 1
  s_add_u32 s78, s78, 0x01010101
  s_lshl1_add_u32 s69, s91, s95
  s_add_u32 s95, s66, s67
  s_add_u32 s69, s69, s95
  v_perm_b32 v173, v178, v176, s56
  v_perm_b32 v178, v178, v176, s57
  v_perm_b32 v176, v179, v177, s56
  v_perm_b32 v179, v179, v177, s57
  v_dot2_f32_bf16 v22, v173, v40, 0
  v_add_f32_dpp v21, v18, v18 row_ror:8 row_mask:0xf bank_mask:0xc
  v_add_f32_dpp v21, v20, v20 row_ror:8 row_mask:0xf bank_mask:0x3
  v_add_f32_dpp v20, v241, v241 row_half_mirror row_mask:0xf bank_mask:0x5
  v_dot2_f32_bf16 v23, v178, v41, 0
  v_add_f32_dpp v20, v21, v21 row_half_mirror row_mask:0xf bank_mask:0xa
  v_dot2_f32_bf16 v24, v176, v42, 0
  v_dot2_f32_bf16 v25, v179, v43, 0
  v_add_f32_dpp v20, v20, v20 quad_perm:[2,3,0,1] row_mask:0xf bank_mask:0xf
  v_cvt_f32_i32 v64, v64
  v_cvt_f32_i32 v65, v65
  v_add_f32_dpp v20, v20, v20 quad_perm:[1,0,3,2] row_mask:0xf bank_mask:0xf
  v_cndmask_b32_e64 v238, v238, v20, s[54:55]
  ds_write_b32 v16, v238 offset:6144
  v_cvt_f32_i32 v66, v66
  v_cvt_f32_i32 v67, v67
  v_pk_mul_f32 v[20:21], v[64:65], v[22:23]
  v_pk_add_f32 v[18:19], v[22:23], v[24:25]
  v_pk_fma_f32 v[20:21], v[66:67], v[24:25], v[20:21]
  v_add_f32 v18, v18, v19
  v_add_f32 v20, v20, v21
  s_add_u32 m0, s100, 21504
  v_lshrrev_b32 v10, 1, v229
  v_add_u32 v10, v10, v247
  v_mad_u64_u32 v[30:31], s[64:65], v10, 1, v[28:29]
  global_load_lds_dwordx4 v[30:31], off
  v_perm_b32 v177, v182, v180, s56
  v_perm_b32 v182, v182, v180, s57
  v_perm_b32 v180, v183, v181, s56
  v_perm_b32 v183, v183, v181, s57
  v_dot2_f32_bf16 v22, v177, v44, 0
  v_add_f32_dpp v239, v18, v18 row_ror:8 row_mask:0xf bank_mask:0xc
  v_add_f32_dpp v239, v20, v20 row_ror:8 row_mask:0xf bank_mask:0x3
  v_dot2_f32_bf16 v23, v182, v45, 0
  v_dot2_f32_bf16 v24, v180, v46, 0
  v_dot2_f32_bf16 v25, v183, v47, 0
  v_cvt_f32_i32 v68, v68
  v_cvt_f32_i32 v69, v69
  v_cvt_f32_i32 v70, v70
  v_cvt_f32_i32 v71, v71
  v_pk_mul_f32 v[20:21], v[68:69], v[22:23]
  v_pk_add_f32 v[18:19], v[22:23], v[24:25]
  v_pk_fma_f32 v[20:21], v[70:71], v[24:25], v[20:21]
  v_add_f32 v18, v18, v19
  v_add_f32 v20, v20, v21
  s_cmpk_gt_i32 s69, 0x1f
  s_cbranch_scc1 L_p41_4
  s_cmpk_gt_i32 s69, 0xffdb
  s_cbranch_scc1 L_p41_1
  s_waitcnt vmcnt(6)
L_p41_1:
  s_waitcnt vmcnt(10)
L_p41_4:
  s_waitcnt vmcnt(11)
  buffer_load_dwordx4 v[100:103], v227, s[32:35], s80 offen nt
  v_dot2_f32_bf16 v22, v173, v48, 0
  v_add_f32_dpp v21, v18, v18 row_ror:8 row_mask:0xf bank_mask:0xc
  v_add_f32_dpp v21, v20, v20 row_ror:8 row_mask:0xf bank_mask:0x3
  v_add_f32_dpp v20, v239, v239 row_half_mirror row_mask:0xf bank_mask:0x5
  v_dot2_f32_bf16 v23, v178, v49, 0
  v_add_f32_dpp v20, v21, v21 row_half_mirror row_mask:0xf bank_mask:0xa
  v_dot2_f32_bf16 v24, v176, v50, 0
  v_dot2_f32_bf16 v25, v179, v51, 0
  v_add_f32_dpp v20, v20, v20 quad_perm:[2,3,0,1] row_mask:0xf bank_mask:0xf
  v_cvt_f32_i32 v72, v72
  v_cvt_f32_i32 v73, v73
  v_add_f32_dpp v20, v20, v20 quad_perm:[1,0,3,2] row_mask:0xf bank_mask:0xf
  v_cndmask_b32_e64 v236, v236, v20, s[48:49]
  v_cvt_f32_i32 v74, v74
  v_cvt_f32_i32 v75, v75
  v_pk_mul_f32 v[20:21], v[72:73], v[22:23]
  v_pk_add_f32 v[18:19], v[22:23], v[24:25]
  v_pk_fma_f32 v[20:21], v[74:75], v[24:25], v[20:21]
  v_add_f32 v18, v18, v19
  v_add_f32 v20, v20, v21
  s_cmpk_gt_i32 s69, 0x1f
  s_cbranch_scc1 L_p42_4
  s_cmpk_gt_i32 s69, 0xfff9
  s_cbranch_scc1 L_p42_2
  s_waitcnt vmcnt(7)
L_p42_2:
  s_waitcnt vmcnt(11)
L_p42_4:
  s_waitcnt vmcnt(12)
  buffer_load_dwordx4 v[104:107], v226, s[32:35], s3 offen nt
  s_cmpk_gt_i32 s69, 0x1f
  s_cbranch_scc1 L_p43_4
  s_cmpk_gt_i32 s69, 0xb
  s_cbranch_scc1 L_p43_3
  s_cmpk_gt_i32 s69, 0xffbb
  s_cbranch_scc1 L_p43_0
  s_waitcnt vmcnt(7)
L_p43_0:
  s_waitcnt vmcnt(8)
L_p43_3:
  s_waitcnt vmcnt(12)
L_p43_4:
  s_waitcnt vmcnt(13)
  buffer_load_dwordx4 v[108:111], v227, s[32:35], s3 offen nt
L_it17:
  s_waitcnt lgkmcnt(0)
  ds_read_b128 v[40:43], v248 offset:512
  ds_read_b128 v[44:47], v250 offset:512
  ds_read_b128 v[48:51], v248 offset:1536
  s_waitcnt vmcnt(9)
  s_add_u32 s44, s78, 0x03030303
  v_msad_u8 v9, s78, v36, 0
  v_msad_u8 v10, s44, v36, 0
  v_msad_u8 v9, s78, v37, v9
  v_msad_u8 v10, s44, v37, v10
  v_msad_u8 v9, s78, v38, v9
  v_msad_u8 v10, s44, v38, v10
  s_mov_b64 exec, 3
  global_store_byte v7, v8, s[30:31]
  global_load_dwordx3 v[36:38], v233, s[30:31] sc1
  v_sub_u32 v9, v9, v10
  v_add_u32 v8, 1, v8
  s_mov_b64 exec, -1
  v_readlane_b32 s66, v9, 0
  v_readlane_b32 s67, v9, 1
  s_add_u32 s78, s78, 0x01010101
  s_lshl1_add_u32 s69, s91, s95
  s_add_u32 s95, s66, s67
  s_add_u32 s69, s69, s95
  v_dot2_f32_bf16 v22, v177, v52, 0
  v_add_f32_dpp v240, v18, v18 row_ror:8 row_mask:0xf bank_mask:0xc
  v_add_f32_dpp v240, v20, v20 row_ror:8 row_mask:0xf bank_mask:0x3
  v_dot2_f32_bf16 v23, v182, v53, 0
  v_dot2_f32_bf16 v24, v180, v54, 0
  v_dot2_f32_bf16 v25, v183, v55, 0
  v_cvt_f32_i32 v76, v76
  v_cvt_f32_i32 v77, v77
  v_cvt_f32_i32 v78, v78
  v_cvt_f32_i32 v79, v79
  v_pk_mul_f32 v[20:21], v[76:77], v[22:23]
  v_pk_add_f32 v[18:19], v[22:23], v[24:25]
  v_pk_fma_f32 v[20:21], v[78:79], v[24:25], v[20:21]
  v_add_f32 v18, v18, v19
  v_add_f32 v20, v20, v21
  s_add_u32 m0, s100, 22528
  v_lshrrev_b32 v10, 1, v230
  v_add_u32 v10, v10, v246
  v_mad_u64_u32 v[30:31], s[64:65], v10, 1, v[28:29]
  global_load_lds_dwordx4 v[30:31], off
  v_dot2_f32_bf16 v22, v173, v56, 0
  v_add_f32_dpp v21, v18, v18 row_ror:8 row_mask:0xf bank_mask:0xc
  v_add_f32_dpp v21, v20, v20 row_ror:8 row_mask:0xf bank_mask:0x3
  v_add_f32_dpp v20, v240, v240 row_half_mirror row_mask:0xf bank_mask:0x5
  v_dot2_f32_bf16 v23, v178, v57, 0
  v_add_f32_dpp v20, v21, v21 row_half_mirror row_mask:0xf bank_mask:0xa
  v_dot2_f32_bf16 v24, v176, v58, 0
  v_dot2_f32_bf16 v25, v179, v59, 0
  v_add_f32_dpp v20, v20, v20 quad_perm:[2,3,0,1] row_mask:0xf bank_mask:0xf
  v_cvt_f32_i32 v80, v80
  v_cvt_f32_i32 v81, v81
  v_add_f32_dpp v20, v20, v20 quad_perm:[1,0,3,2] row_mask:0xf bank_mask:0xf
  v_cndmask_b32_e64 v237, v237, v20, s[48:49]
  v_cvt_f32_i32 v82, v82
  v_cvt_f32_i32 v83, v83
  v_pk_mul_f32 v[20:21], v[80:81], v[22:23]
  v_pk_add_f32 v[18:19], v[22:23], v[24:25]
  v_pk_fma_f32 v[20:21], v[82:83], v[24:25], v[20:21]
  v_add_f32 v18, v18, v19
  v_add_f32 v20, v20, v21
  s_cmpk_gt_i32 s69, 0x1f
  s_cbranch_scc1 L_p44_4
  s_cmpk_gt_i32 s69, 0xffdb
  s_cbranch_scc1 L_p44_1
  s_waitcnt vmcnt(6)
L_p44_1:
  s_waitcnt vmcnt(10)
L_p44_4:
  s_waitcnt vmcnt(11)
  buffer_load_dwordx4 v[64:67], v228, s[32:35], 0 offen nt
  ds_read_b64 v[184:185], v12 offset:18432
  ds_read_b64 v[186:187], v12 offset:18560
  ds_read_b64 v[188:189], v12 offset:19456
  ds_read_b64 v[190:191], v12 offset:19584
  v_dot2_f32_bf16 v22, v177, v60, 0
  v_add_f32_dpp v241, v18, v18 row_ror:8 row_mask:0xf bank_mask:0xc
  v_add_f32_dpp v241, v20, v20 row_ror:8 row_mask:0xf bank_mask:0x3
  v_dot2_f32_bf16 v23, v182, v61, 0
  v_dot2_f32_bf16 v24, v180, v62, 0
  v_dot2_f32_bf16 v25, v183, v63, 0
  v_cvt_f32_i32 v84, v84
  v_cvt_f32_i32 v85, v85
  v_cvt_f32_i32 v86, v86
  v_cvt_f32_i32 v87, v87
  v_pk_mul_f32 v[20:21], v[84:85], v[22:23]
  v_pk_add_f32 v[18:19], v[22:23], v[24:25]
  v_pk_fma_f32 v[20:21], v[86:87], v[24:25], v[20:21]
  v_add_f32 v18, v18, v19
  v_add_f32 v20, v20, v21
  s_cmpk_gt_i32 s69, 0x1f
  s_cbranch_scc1 L_p45_4
  s_cmpk_gt_i32 s69, 0xfff9
  s_cbranch_scc1 L_p45_2
  s_waitcnt vmcnt(7)
L_p45_2:
  s_waitcnt vmcnt(11)
L_p45_4:
  s_waitcnt vmcnt(12)
  buffer_load_dwordx4 v[68:71], v229, s[32:35], 0 offen nt
  s_cmpk_gt_i32 s69, 0x1f
  s_cbranch_scc1 L_p46_4
  s_cmpk_gt_i32 s69, 0xb
  s_cbranch_scc1 L_p46_3
  s_cmpk_gt_i32 s69, 0xffbb
  s_cbranch_scc1 L_p46_0
  s_waitcnt vmcnt(7)
L_p46_0:
  s_waitcnt vmcnt(8)
L_p46_3:
  s_waitcnt vmcnt(12)
L_p46_4:
  s_waitcnt vmcnt(13)
  buffer_load_dwordx4 v[72:75], v228, s[32:35], s80 offen nt
L_it18:
  s_waitcnt lgkmcnt(0)
  ds_read_b128 v[52:55], v250 offset:1536
  ds_read_b128 v[56:59], v248 offset:2560
  ds_read_b128 v[60:63], v250 offset:2560
  s_waitcnt vmcnt(9)
  s_add_u32 s44, s78, 0x03030303
  v_msad_u8 v9, s78, v32, 0
  v_msad_u8 v10, s44, v32, 0
  v_msad_u8 v9, s78, v33, v9
  v_msad_u8 v10, s44, v33, v10
  v_msad_u8 v9, s78, v34, v9
  v_msad_u8 v10, s44, v34, v10
  s_mov_b64 exec, 3
  global_store_byte v7, v8, s[30:31]
  global_load_dwordx3 v[32:34], v234, s[30:31] sc1
  v_sub_u32 v9, v9, v10
  v_add_u32 v8, 1, v8
  s_mov_b64 exec, -1
  v_readlane_b32 s66, v9, 0
  v_readlane_b32 s67, v9, 1
  s_add_u32 s78, s78, 0x01010101
  s_lshl1_add_u32 s69, s91, s95
  s_add_u32 s95, s66, s67
  s_add_u32 s69, s69, s95
  v_perm_b32 v181, v186, v184, s56
  v_perm_b32 v186, v186, v184, s57
  v_perm_b32 v184, v187, v185, s56
  v_perm_b32 v187, v187, v185, s57
  v_dot2_f32_bf16 v22, v181, v40, 0
  v_add_f32_dpp v21, v18, v18 row_ror:8 row_mask:0xf bank_mask:0xc
  v_add_f32_dpp v21, v20, v20 row_ror:8 row_mask:0xf bank_mask:0x3
  v_add_f32_dpp v20, v241, v241 row_half_mirror row_mask:0xf bank_mask:0x5
  v_dot2_f32_bf16 v23, v186, v41, 0
  v_add_f32_dpp v20, v21, v21 row_half_mirror row_mask:0xf bank_mask:0xa
  v_dot2_f32_bf16 v24, v184, v42, 0
  v_dot2_f32_bf16 v25, v187, v43, 0
  v_add_f32_dpp v20, v20, v20 quad_perm:[2,3,0,1] row_mask:0xf bank_mask:0xf
  v_cvt_f32_i32 v88, v88
  v_cvt_f32_i32 v89, v89
  v_add_f32_dpp v20, v20, v20 quad_perm:[1,0,3,2] row_mask:0xf bank_mask:0xf
  v_cndmask_b32_e64 v238, v238, v20, s[48:49]
  v_cvt_f32_i32 v90, v90
  v_cvt_f32_i32 v91, v91
  v_pk_mul_f32 v[20:21], v[88:89], v[22:23]
  v_pk_add_f32 v[18:19], v[22:23], v[24:25]
  v_pk_fma_f32 v[20:21], v[90:91], v[24:25], v[20:21]
  v_add_f32 v18, v18, v19
  v_add_f32 v20, v20, v21
  s_add_u32 m0, s100, 23552
  v_lshrrev_b32 v10, 1, v231
  v_add_u32 v10, v10, v245
  v_mad_u64_u32 v[30:31], s[64:65], v10, 1, v[28:29]
  global_load_lds_dwordx4 v[30:31], off
  v_perm_b32 v185, v190, v188, s56
  v_perm_b32 v190, v190, v188, s57
  v_perm_b32 v188, v191, v189, s56
  v_perm_b32 v191, v191, v189, s57
  v_dot2_f32_bf16 v22, v185, v44, 0
  v_add_f32_dpp v239, v18, v18 row_ror:8 row_mask:0xf bank_mask:0xc
  v_add_f32_dpp v239, v20, v20 row_ror:8 row_mask:0xf bank_mask:0x3
  v_dot2_f32_bf16 v23, v190, v45, 0
  v_dot2_f32_bf16 v24, v188, v46, 0
  v_dot2_f32_bf16 v25, v191, v47, 0
  v_cvt_f32_i32 v92, v92
  v_cvt_f32_i32 v93, v93
  v_cvt_f32_i32 v94, v94
  v_cvt_f32_i32 v95, v95
  v_pk_mul_f32 v[20:21], v[92:93], v[22:23]
  v_pk_add_f32 v[18:19], v[22:23], v[24:25]
  v_pk_fma_f32 v[20:21], v[94:95], v[24:25], v[20:21]
  v_add_f32 v18, v18, v19
  v_add_f32 v20, v20, v21
  s_cmpk_gt_i32 s69, 0x1f
  s_cbranch_scc1 L_p47_4
  s_cmpk_gt_i32 s69, 0xffdb
  s_cbranch_scc1 L_p47_1
  s_waitcnt vmcnt(6)
L_p47_1:
  s_waitcnt vmcnt(10)
L_p47_4:
  s_waitcnt vmcnt(11)
  buffer_load_dwordx4 v[76:79], v229, s[32:35], s80 offen nt
  v_dot2_f32_bf16 v22, v181, v48, 0
  v_add_f32_dpp v21, v18, v18 row_ror:8 row_mask:0xf bank_mask:0xc
  v_add_f32_dpp v21, v20, v20 row_ror:8 row_mask:0xf bank_mask:0x3
  v_add_f32_dpp v20, v239, v239 row_half_mirror row_mask:0xf bank_mask:0x5
  v_dot2_f32_bf16 v23, v186, v49, 0
  v_add_f32_dpp v20, v21, v21 row_half_mirror row_mask:0xf bank_mask:0xa
  v_dot2_f32_bf16 v24, v184, v50, 0
  v_dot2_f32_bf16 v25, v187, v51, 0
  v_add_f32_dpp v20, v20, v20 quad_perm:[2,3,0,1] row_mask:0xf bank_mask:0xf
  v_cvt_f32_i32 v96, v96
  v_cvt_f32_i32 v97, v97
  v_add_f32_dpp v20, v20, v20 quad_perm:[1,0,3,2] row_mask:0xf bank_mask:0xf
  v_cndmask_b32_e64 v236, v236, v20, s[50:51]
  v_cvt_f32_i32 v98, v98
  v_cvt_f32_i32 v99, v99
  v_pk_mul_f32 v[20:21], v[96:97], v[22:23]
  v_pk_add_f32 v[18:19], v[22:23], v[24:25]
  v_pk_fma_f32 v[20:21], v[98:99], v[24:25], v[20:21]
  v_add_f32 v18, v18, v19
  v_add_f32 v20, v20, v21
  s_cmpk_gt_i32 s69, 0x1f
  s_cbranch_scc1 L_p48_4
  s_cmpk_gt_i32 s69, 0xfff9
  s_cbranch_scc1 L_p48_2
  s_waitcnt vmcnt(7)
L_p48_2:
  s_waitcnt vmcnt(11)
L_p48_4:
  s_waitcnt vmcnt(12)
  buffer_load_dwordx4 v[80:83], v228, s[32:35], s3 offen nt
  s_cmpk_gt_i32 s69, 0x1f
  s_cbranch_scc1 L_p49_4
  s_cmpk_gt_i32 s69, 0xb
  s_cbranch_scc1 L_p49_3
  s_cmpk_gt_i32 s69, 0xffbb
  s_cbranch_scc1 L_p49_0
  s_waitcnt vmcnt(7)
L_p49_0:
  s_waitcnt vmcnt(8)
L_p49_3:
  s_waitcnt vmcnt(12)
L_p49_4:
  s_waitcnt vmcnt(13)
  buffer_load_dwordx4 v[84:87], v229, s[32:35], s3 offen nt
L_it19:
  s_waitcnt lgkmcnt(0)
  ds_read_b128 v[40:43], v251 offset:512
  ds_read_b128 v[44:47], v253 offset:512
  ds_read_b128 v[48:51], v251 offset:1536
  s_waitcnt vmcnt(9)
  s_add_u32 s44, s78, 0x03030303
  v_msad_u8 v9, s78, v36, 0
  v_msad_u8 v10, s44, v36, 0
  v_msad_u8 v9, s78, v37, v9
  v_msad_u8 v10, s44, v37, v10
  v_msad_u8 v9, s78, v38, v9
  v_msad_u8 v10, s44, v38, v10
  s_mov_b64 exec, 3
  global_store_byte v7, v8, s[30:31]
  global_load_dwordx3 v[36:38], v235, s[30:31] sc1
  v_sub_u32 v9, v9, v10
  v_add_u32 v8, 1, v8
  s_mov_b64 exec, -1
  v_readlane_b32 s66, v9, 0
  v_readlane_b32 s67, v9, 1
  s_add_u32 s78, s78, 0x01010101
  s_lshl1_add_u32 s69, s91, s95
  s_add_u32 s95, s66, s67
  s_add_u32 s69, s69, s95
  v_dot2_f32_bf16 v22, v185, v52, 0
  v_add_f32_dpp v240, v18, v18 row_ror:8 row_mask:0xf bank_mask:0xc
  v_add_f32_dpp v240, v20, v20 row_ror:8 row_mask:0xf bank_mask:0x3
  v_dot2_f32_bf16 v23, v190, v53, 0
  v_dot2_f32_bf16 v24, v188, v54, 0
  v_dot2_f32_bf16 v25, v191, v55, 0
  v_cvt_f32_i32 v100, v100
  v_cvt_f32_i32 v101, v101
  v_cvt_f32_i32 v102, v102
  v_cvt_f32_i32 v103, v103
  v_pk_mul_f32 v[20:21], v[100:101], v[22:23]
  v_pk_add_f32 v[18:19], v[22:23], v[24:25]
  v_pk_fma_f32 v[20:21], v[102:103], v[24:25], v[20:21]
  v_add_f32 v18, v18, v19
  v_add_f32 v20, v20, v21
  v_dot2_f32_bf16 v22, v181, v56, 0
  v_add_f32_dpp v21, v18, v18 row_ror:8 row_mask:0xf bank_mask:0xc
  v_add_f32_dpp v21, v20, v20 row_ror:8 row_mask:0xf bank_mask:0x3
  v_add_f32_dpp v20, v240, v240 row_half_mirror row_mask:0xf bank_mask:0x5
  v_dot2_f32_bf16 v23, v186, v57, 0
  v_add_f32_dpp v20, v21, v21 row_half_mirror row_mask:0xf bank_mask:0xa
  v_dot2_f32_bf16 v24, v184, v58, 0
  v_dot2_f32_bf16 v25, v187, v59, 0
  v_add_f32_dpp v20, v20, v20 quad_perm:[2,3,0,1] row_mask:0xf bank_mask:0xf
  v_cvt_f32_i32 v104, v104
  v_cvt_f32_i32 v105, v105
  v_add_f32_dpp v20, v20, v20 quad_perm:[1,0,3,2] row_mask:0xf bank_mask:0xf
  v_cndmask_b32_e64 v237, v237, v20, s[50:51]
  v_cvt_f32_i32 v106, v106
  v_cvt_f32_i32 v107, v107
  v_pk_mul_f32 v[20:21], v[104:105], v[22:23]
  v_pk_add_f32 v[18:19], v[22:23], v[24:25]
  v_pk_fma_f32 v[20:21], v[106:107], v[24:25], v[20:21]
  v_add_f32 v18, v18, v19
  v_add_f32 v20, v20, v21
  s_cmpk_gt_i32 s69, 0x1f
  s_cbranch_scc1 L_p50_4
  s_cmpk_gt_i32 s69, 0xffdb
  s_cbranch_scc1 L_p50_1
  s_waitcnt vmcnt(5)
L_p50_1:
  s_waitcnt vmcnt(9)
L_p50_4:
  s_waitcnt vmcnt(10)
  buffer_load_dwordx4 v[88:91], v230, s[32:35], 0 offen nt
  ds_read_b64 v[192:193], v12 offset:20480
  ds_read_b64 v[194:195], v12 offset:20608
  ds_read_b64 v[196:197], v12 offset:21504
  ds_read_b64 v[198:199], v12 offset:21632
  v_dot2_f32_bf16 v22, v185, v60, 0
  v_add_f32_dpp v241, v18, v18 row_ror:8 row_mask:0xf bank_mask:0xc
  v_add_f32_dpp v241, v20, v20 row_ror:8 row_mask:0xf bank_mask:0x3
  v_dot2_f32_bf16 v23, v190, v61, 0
  v_dot2_f32_bf16 v24, v188, v62, 0
  v_dot2_f32_bf16 v25, v191, v63, 0
  v_cvt_f32_i32 v108, v108
  v_cvt_f32_i32 v109, v109
  v_cvt_f32_i32 v110, v110
  v_cvt_f32_i32 v111, v111
  v_pk_mul_f32 v[20:21], v[108:109], v[22:23]
  v_pk_add_f32 v[18:19], v[22:23], v[24:25]
  v_pk_fma_f32 v[20:21], v[110:111], v[24:25], v[20:21]
  v_add_f32 v18, v18, v19
  v_add_f32 v20, v20, v21
  s_cmpk_gt_i32 s69, 0x1f
  s_cbranch_scc1 L_p51_4
  s_cmpk_gt_i32 s69, 0xfff9
  s_cbranch_scc1 L_p51_2
  s_waitcnt vmcnt(6)
L_p51_2:
  s_waitcnt vmcnt(10)
L_p51_4:
  s_waitcnt vmcnt(11)
  buffer_load_dwordx4 v[92:95], v231, s[32:35], 0 offen nt
  s_cmpk_gt_i32 s69, 0x1f
  s_cbranch_scc1 L_p52_4
  s_cmpk_gt_i32 s69, 0xb
  s_cbranch_scc1 L_p52_3
  s_cmpk_gt_i32 s69, 0xffbb
  s_cbranch_scc1 L_p52_0
  s_waitcnt vmcnt(6)
L_p52_0:
  s_waitcnt vmcnt(7)
L_p52_3:
  s_waitcnt vmcnt(11)
L_p52_4:
  s_waitcnt vmcnt(12)
  buffer_load_dwordx4 v[96:99], v230, s[32:35], s80 offen nt
L_it20:
  s_waitcnt lgkmcnt(0)
  ds_read_b128 v[52:55], v253 offset:1536
  ds_read_b128 v[56:59], v251 offset:2560
  ds_read_b128 v[60:63], v253 offset:2560
  s_waitcnt vmcnt(8)
  s_add_u32 s44, s78, 0x03030303
  v_msad_u8 v9, s78, v32, 0
  v_msad_u8 v10, s44, v32, 0
  v_msad_u8 v9, s78, v33, v9
  v_msad_u8 v10, s44, v33, v10
  v_msad_u8 v9, s78, v34, v9
  v_msad_u8 v10, s44, v34, v10
  s_mov_b64 exec, 3
  global_store_byte v7, v8, s[30:31]
  global_load_dwordx3 v[32:34], v232, s[30:31] sc1
  v_sub_u32 v9, v9, v10
  v_add_u32 v8, 1, v8
  s_mov_b64 exec, -1
  v_readlane_b32 s66, v9, 0
  v_readlane_b32 s67, v9, 1
  s_add_u32 s78, s78, 0x01010101
  s_lshl1_add_u32 s69, s91, s95
  s_add_u32 s95, s66, s67
  s_add_u32 s69, s69, s95
  v_perm_b32 v189, v194, v192, s56
  v_perm_b32 v194, v194, v192, s57
  v_perm_b32 v192, v195, v193, s56
  v_perm_b32 v195, v195, v193, s57
  v_dot2_f32_bf16 v22, v189, v40, 0
  v_add_f32_dpp v21, v18, v18 row_ror:8 row_mask:0xf bank_mask:0xc
  v_add_f32_dpp v21, v20, v20 row_ror:8 row_mask:0xf bank_mask:0x3
  v_add_f32_dpp v20, v241, v241 row_half_mirror row_mask:0xf bank_mask:0x5
  v_dot2_f32_bf16 v23, v194, v41, 0
  v_add_f32_dpp v20, v21, v21 row_half_mirror row_mask:0xf bank_mask:0xa
  v_dot2_f32_bf16 v24, v192, v42, 0
  v_dot2_f32_bf16 v25, v195, v43, 0
  v_add_f32_dpp v20, v20, v20 quad_perm:[2,3,0,1] row_mask:0xf bank_mask:0xf
  v_cvt_f32_i32 v64, v64
  v_cvt_f32_i32 v65, v65
  v_add_f32_dpp v20, v20, v20 quad_perm:[1,0,3,2] row_mask:0xf bank_mask:0xf
  v_cndmask_b32_e64 v238, v238, v20, s[50:51]
  v_cvt_f32_i32 v66, v66
  v_cvt_f32_i32 v67, v67
  v_pk_mul_f32 v[20:21], v[64:65], v[22:23]
  v_pk_add_f32 v[18:19], v[22:23], v[24:25]
  v_pk_fma_f32 v[20:21], v[66:67], v[24:25], v[20:21]
  v_add_f32 v18, v18, v19
  v_add_f32 v20, v20, v21
  v_perm_b32 v193, v198, v196, s56
  v_perm_b32 v198, v198, v196, s57
  v_perm_b32 v196, v199, v197, s56
  v_perm_b32 v199, v199, v197, s57
  v_dot2_f32_bf16 v22, v193, v44, 0
  v_add_f32_dpp v239, v18, v18 row_ror:8 row_mask:0xf bank_mask:0xc
  v_add_f32_dpp v239, v20, v20 row_ror:8 row_mask:0xf bank_mask:0x3
  v_dot2_f32_bf16 v23, v198, v45, 0
  v_dot2_f32_bf16 v24, v196, v46, 0
  v_dot2_f32_bf16 v25, v199, v47, 0
  v_cvt_f32_i32 v68, v68
  v_cvt_f32_i32 v69, v69
  v_cvt_f32_i32 v70, v70
  v_cvt_f32_i32 v71, v71
  v_pk_mul_f32 v[20:21], v[68:69], v[22:23]
  v_pk_add_f32 v[18:19], v[22:23], v[24:25]
  v_pk_fma_f32 v[20:21], v[70:71], v[24:25], v[20:21]
  v_add_f32 v18, v18, v19
  v_add_f32 v20, v20, v21
  s_cmpk_gt_i32 s69, 0x1f
  s_cbranch_scc1 L_p53_4
  s_cmpk_gt_i32 s69, 0xffdb
  s_cbranch_scc1 L_p53_1
  s_waitcnt vmcnt(5)
L_p53_1:
  s_waitcnt vmcnt(8)
L_p53_4:
  s_waitcnt vmcnt(9)
  buffer_load_dwordx4 v[100:103], v231, s[32:35], s80 offen nt
  v_dot2_f32_bf16 v22, v189, v48, 0
  v_add_f32_dpp v21, v18, v18 row_ror:8 row_mask:0xf bank_mask:0xc
  v_add_f32_dpp v21, v20, v20 row_ror:8 row_mask:0xf bank_mask:0x3
  v_add_f32_dpp v20, v239, v239 row_half_mirror row_mask:0xf bank_mask:0x5
  v_dot2_f32_bf16 v23, v194, v49, 0
  v_add_f32_dpp v20, v21, v21 row_half_mirror row_mask:0xf bank_mask:0xa
  v_dot2_f32_bf16 v24, v192, v50, 0
  v_dot2_f32_bf16 v25, v195, v51, 0
  v_add_f32_dpp v20, v20, v20 quad_perm:[2,3,0,1] row_mask:0xf bank_mask:0xf
  v_cvt_f32_i32 v72, v72
  v_cvt_f32_i32 v73, v73
  v_add_f32_dpp v20, v20, v20 quad_perm:[1,0,3,2] row_mask:0xf bank_mask:0xf
  v_cndmask_b32_e64 v236, v236, v20, s[52:53]
  v_cvt_f32_i32 v74, v74
  v_cvt_f32_i32 v75, v75
  v_pk_mul_f32 v[20:21], v[72:73], v[22:23]
  v_pk_add_f32 v[18:19], v[22:23], v[24:25]
  v_pk_fma_f32 v[20:21], v[74:75], v[24:25], v[20:21]
  v_add_f32 v18, v18, v19
  v_add_f32 v20, v20, v21
  s_cmpk_gt_i32 s69, 0x1f
  s_cbranch_scc1 L_p54_4
  s_cmpk_gt_i32 s69, 0xfff9
  s_cbranch_scc1 L_p54_2
  s_waitcnt vmcnt(6)
L_p54_2:
  s_waitcnt vmcnt(9)
L_p54_4:
  s_waitcnt vmcnt(10)
  buffer_load_dwordx4 v[104:107], v230, s[32:35], s3 offen nt
  s_cmpk_gt_i32 s69, 0x1f
  s_cbranch_scc1 L_p55_4
  s_cmpk_gt_i32 s69, 0xb
  s_cbranch_scc1 L_p55_3
  s_cmpk_gt_i32 s69, 0xffbb
  s_cbranch_scc1 L_p55_0
  s_waitcnt vmcnt(6)
L_p55_0:
  s_waitcnt vmcnt(7)
L_p55_3:
  s_waitcnt vmcnt(10)
L_p55_4:
  s_waitcnt vmcnt(11)
  buffer_load_dwordx4 v[108:111], v231, s[32:35], s3 offen nt
L_it21:
  s_waitcnt lgkmcnt(0)
  ds_read_b128 v[40:43], v252 offset:512
  ds_read_b128 v[44:47], v251 offset:512
  ds_read_b128 v[48:51], v252 offset:1536
  s_waitcnt vmcnt(7)
  s_add_u32 s44, s78, 0x03030303
  v_msad_u8 v9, s78, v36, 0
  v_msad_u8 v10, s44, v36, 0
  v_msad_u8 v9, s78, v37, v9
  v_msad_u8 v10, s44, v37, v10
  v_msad_u8 v9, s78, v38, v9
  v_msad_u8 v10, s44, v38, v10
  s_mov_b64 exec, 3
  global_load_dwordx2 v[26:27], v11, s[30:31] sc1
  global_store_byte v7, v8, s[30:31]
  global_load_dwordx3 v[36:38], v233, s[30:31] sc1
  v_sub_u32 v9, v9, v10
  v_add_u32 v8, 1, v8
  s_mov_b64 exec, -1
  v_readlane_b32 s66, v9, 0
  v_readlane_b32 s67, v9, 1
  s_add_u32 s78, s78, 0x01010101
  s_lshl1_add_u32 s69, s91, s95
  s_add_u32 s95, s66, s67
  s_add_u32 s69, s69, s95
  v_dot2_f32_bf16 v22, v193, v52, 0
  v_add_f32_dpp v240, v18, v18 row_ror:8 row_mask:0xf bank_mask:0xc
  v_add_f32_dpp v240, v20, v20 row_ror:8 row_mask:0xf bank_mask:0x3
  v_dot2_f32_bf16 v23, v198, v53, 0
  v_dot2_f32_bf16 v24, v196, v54, 0
  v_dot2_f32_bf16 v25, v199, v55, 0
  v_cvt_f32_i32 v76, v76
  v_cvt_f32_i32 v77, v77
  v_cvt_f32_i32 v78, v78
  v_cvt_f32_i32 v79, v79
  v_pk_mul_f32 v[20:21], v[76:77], v[22:23]
  v_pk_add_f32 v[18:19], v[22:23], v[24:25]
  v_pk_fma_f32 v[20:21], v[78:79], v[24:25], v[20:21]
  v_add_f32 v18, v18, v19
  v_add_f32 v20, v20, v21
  v_dot2_f32_bf16 v22, v189, v56, 0
  v_add_f32_dpp v21, v18, v18 row_ror:8 row_mask:0xf bank_mask:0xc
  v_add_f32_dpp v21, v20, v20 row_ror:8 row_mask:0xf bank_mask:0x3
  v_add_f32_dpp v20, v240, v240 row_half_mirror row_mask:0xf bank_mask:0x5
  v_dot2_f32_bf16 v23, v194, v57, 0
  v_add_f32_dpp v20, v21, v21 row_half_mirror row_mask:0xf bank_mask:0xa
  v_dot2_f32_bf16 v24, v192, v58, 0
  v_dot2_f32_bf16 v25, v195, v59, 0
  v_add_f32_dpp v20, v20, v20 quad_perm:[2,3,0,1] row_mask:0xf bank_mask:0xf
  v_cvt_f32_i32 v80, v80
  v_cvt_f32_i32 v81, v81
  v_add_f32_dpp v20, v20, v20 quad_perm:[1,0,3,2] row_mask:0xf bank_mask:0xf
  v_cndmask_b32_e64 v237, v237, v20, s[52:53]
  v_cvt_f32_i32 v82, v82
  v_cvt_f32_i32 v83, v83
  v_pk_mul_f32 v[20:21], v[80:81], v[22:23]
  v_pk_add_f32 v[18:19], v[22:23], v[24:25]
  v_pk_fma_f32 v[20:21], v[82:83], v[24:25], v[20:21]
  v_add_f32 v18, v18, v19
  v_add_f32 v20, v20, v21
  s_cmpk_gt_i32 s69, 0x1f
  s_cbranch_scc1 L_p56_4
  s_cmpk_gt_i32 s69, 0xffdb
  s_cbranch_scc1 L_p56_1
  s_waitcnt vmcnt(6)
L_p56_1:
  s_waitcnt vmcnt(9)
L_p56_4:
  s_waitcnt vmcnt(10)
  buffer_load_dwordx4 v[64:67], v208, s[32:35], s98 offen nt
  ds_read_b64 v[200:201], v12 offset:22528
  ds_read_b64 v[202:203], v12 offset:22656
  ds_read_b64 v[204:205], v12 offset:23552
  ds_read_b64 v[206:207], v12 offset:23680
  v_dot2_f32_bf16 v22, v193, v60, 0
  v_add_f32_dpp v241, v18, v18 row_ror:8 row_mask:0xf bank_mask:0xc
  v_add_f32_dpp v241, v20, v20 row_ror:8 row_mask:0xf bank_mask:0x3
  v_dot2_f32_bf16 v23, v198, v61, 0
  v_dot2_f32_bf16 v24, v196, v62, 0
  v_dot2_f32_bf16 v25, v199, v63, 0
  v_cvt_f32_i32 v84, v84
  v_cvt_f32_i32 v85, v85
  v_cvt_f32_i32 v86, v86
  v_cvt_f32_i32 v87, v87
  v_pk_mul_f32 v[20:21], v[84:85], v[22:23]
  v_pk_add_f32 v[18:19], v[22:23], v[24:25]
  v_pk_fma_f32 v[20:21], v[86:87], v[24:25], v[20:21]
  v_add_f32 v18, v18, v19
  v_add_f32 v20, v20, v21
  s_cmpk_gt_i32 s69, 0x1f
  s_cbranch_scc1 L_p57_4
  s_cmpk_gt_i32 s69, 0xfff9
  s_cbranch_scc1 L_p57_2
  s_waitcnt vmcnt(7)
L_p57_2:
  s_waitcnt vmcnt(10)
L_p57_4:
  s_waitcnt vmcnt(11)
  buffer_load_dwordx4 v[68:71], v209, s[32:35], s98 offen nt
  s_cmpk_gt_i32 s69, 0x1f
  s_cbranch_scc1 L_p58_4
  s_cmpk_gt_i32 s69, 0xb
  s_cbranch_scc1 L_p58_3
  s_cmpk_gt_i32 s69, 0xffbb
  s_cbranch_scc1 L_p58_0
  s_waitcnt vmcnt(7)
L_p58_0:
  s_waitcnt vmcnt(8)
L_p58_3:
  s_waitcnt vmcnt(11)
L_p58_4:
  s_waitcnt vmcnt(12)
  buffer_load_dwordx4 v[72:75], v210, s[32:35], s98 offen nt
L_it22:
  s_waitcnt lgkmcnt(0)
  ds_read_b128 v[52:55], v251 offset:1536
  ds_read_b128 v[56:59], v252 offset:2560
  ds_read_b128 v[60:63], v251 offset:2560
  ds_read_b32 v4, v14 offset:16
  s_waitcnt vmcnt(8)
  s_add_u32 s44, s78, 0x03030303
  v_msad_u8 v9, s78, v32, 0
  v_msad_u8 v10, s44, v32, 0
  v_msad_u8 v9, s78, v33, v9
  v_msad_u8 v10, s44, v33, v10
  v_msad_u8 v9, s78, v34, v9
  v_msad_u8 v10, s44, v34, v10
  s_mov_b64 exec, 3
  global_store_byte v7, v8, s[30:31]
  global_load_dwordx3 v[32:34], v234, s[30:31] sc1
  v_sub_u32 v9, v9, v10
  v_add_u32 v8, 1, v8
  s_mov_b64 exec, -1
  v_readlane_b32 s66, v9, 0
  v_readlane_b32 s67, v9, 1
  s_add_u32 s78, s78, 0x01010101
  s_lshl1_add_u32 s69, s91, s95
  s_add_u32 s95, s66, s67
  s_add_u32 s69, s69, s95
  v_perm_b32 v197, v202, v200, s56
  v_perm_b32 v202, v202, v200, s57
  v_perm_b32 v200, v203, v201, s56
  v_perm_b32 v203, v203, v201, s57
  v_dot2_f32_bf16 v22, v197, v40, 0
  v_add_f32_dpp v21, v18, v18 row_ror:8 row_mask:0xf bank_mask:0xc
  v_add_f32_dpp v21, v20, v20 row_ror:8 row_mask:0xf bank_mask:0x3
  v_add_f32_dpp v20, v241, v241 row_half_mirror row_mask:0xf bank_mask:0x5
  v_dot2_f32_bf16 v23, v202, v41, 0
  v_add_f32_dpp v20, v21, v21 row_half_mirror row_mask:0xf bank_mask:0xa
  v_dot2_f32_bf16 v24, v200, v42, 0
  v_dot2_f32_bf16 v25, v203, v43, 0
  v_add_f32_dpp v20, v20, v20 quad_perm:[2,3,0,1] row_mask:0xf bank_mask:0xf
  v_cvt_f32_i32 v88, v88
  v_cvt_f32_i32 v89, v89
  v_add_f32_dpp v20, v20, v20 quad_perm:[1,0,3,2] row_mask:0xf bank_mask:0xf
  v_cndmask_b32_e64 v238, v238, v20, s[52:53]
  v_cvt_f32_i32 v90, v90
  v_cvt_f32_i32 v91, v91
  v_pk_mul_f32 v[20:21], v[88:89], v[22:23]
  v_pk_add_f32 v[18:19], v[22:23], v[24:25]
  v_pk_fma_f32 v[20:21], v[90:91], v[24:25], v[20:21]
  v_add_f32 v18, v18, v19
  v_add_f32 v20, v20, v21
  v_perm_b32 v201, v206, v204, s56
  v_perm_b32 v206, v206, v204, s57
  v_perm_b32 v204, v207, v205, s56
  v_perm_b32 v207, v207, v205, s57
  v_dot2_f32_bf16 v22, v201, v44, 0
  v_add_f32_dpp v239, v18, v18 row_ror:8 row_mask:0xf bank_mask:0xc
  v_add_f32_dpp v239, v20, v20 row_ror:8 row_mask:0xf bank_mask:0x3
  v_dot2_f32_bf16 v23, v206, v45, 0
  v_dot2_f32_bf16 v24, v204, v46, 0
  v_dot2_f32_bf16 v25, v207, v47, 0
  v_cvt_f32_i32 v92, v92
  v_cvt_f32_i32 v93, v93
  v_cvt_f32_i32 v94, v94
  v_cvt_f32_i32 v95, v95
  v_pk_mul_f32 v[20:21], v[92:93], v[22:23]
  v_pk_add_f32 v[18:19], v[22:23], v[24:25]
  v_pk_fma_f32 v[20:21], v[94:95], v[24:25], v[20:21]
  v_add_f32 v18, v18, v19
  v_add_f32 v20, v20, v21
  s_cmpk_gt_i32 s69, 0x1f
  s_cbranch_scc1 L_p59_4
  s_cmpk_gt_i32 s69, 0xffdb
  s_cbranch_scc1 L_p59_1
  s_waitcnt vmcnt(5)
L_p59_1:
  s_waitcnt vmcnt(9)
L_p59_4:
  s_waitcnt vmcnt(10)
  buffer_load_dwordx4 v[76:79], v211, s[32:35], s98 offen nt
  v_dot2_f32_bf16 v22, v197, v48, 0
  v_add_f32_dpp v21, v18, v18 row_ror:8 row_mask:0xf bank_mask:0xc
  v_add_f32_dpp v21, v20, v20 row_ror:8 row_mask:0xf bank_mask:0x3
  v_add_f32_dpp v20, v239, v239 row_half_mirror row_mask:0xf bank_mask:0x5
  v_dot2_f32_bf16 v23, v202, v49, 0
  v_add_f32_dpp v20, v21, v21 row_half_mirror row_mask:0xf bank_mask:0xa
  v_dot2_f32_bf16 v24, v200, v50, 0
  v_dot2_f32_bf16 v25, v203, v51, 0
  v_add_f32_dpp v20, v20, v20 quad_perm:[2,3,0,1] row_mask:0xf bank_mask:0xf
  v_cvt_f32_i32 v96, v96
  v_cvt_f32_i32 v97, v97
  v_add_f32_dpp v20, v20, v20 quad_perm:[1,0,3,2] row_mask:0xf bank_mask:0xf
  v_cndmask_b32_e64 v236, v236, v20, s[54:55]
  ds_write_b32 v17, v236 offset:0
  v_cvt_f32_i32 v98, v98
  v_cvt_f32_i32 v99, v99
  v_pk_mul_f32 v[20:21], v[96:97], v[22:23]
  v_pk_add_f32 v[18:19], v[22:23], v[24:25]
  v_pk_fma_f32 v[20:21], v[98:99], v[24:25], v[20:21]
  v_add_f32 v18, v18, v19
  v_add_f32 v20, v20, v21
  s_cmpk_gt_i32 s69, 0x1f
  s_cbranch_scc1 L_p60_4
  s_cmpk_gt_i32 s69, 0xfff9
  s_cbranch_scc1 L_p60_2
  s_waitcnt vmcnt(6)
L_p60_2:
  s_waitcnt vmcnt(10)
L_p60_4:
  s_waitcnt vmcnt(11)
  buffer_load_dwordx4 v[80:83], v212, s[32:35], s98 offen nt
  s_cmpk_gt_i32 s69, 0x1f
  s_cbranch_scc1 L_p61_4
  s_cmpk_gt_i32 s69, 0xb
  s_cbranch_scc1 L_p61_3
  s_cmpk_gt_i32 s69, 0xffbb
  s_cbranch_scc1 L_p61_0
  s_waitcnt vmcnt(6)
L_p61_0:
  s_waitcnt vmcnt(7)
L_p61_3:
  s_waitcnt vmcnt(11)
L_p61_4:
  s_waitcnt vmcnt(12)
  buffer_load_dwordx4 v[84:87], v213, s[32:35], s98 offen nt
L_it23:
  s_mov_b32 s47, 4
L_fq23:
  s_waitcnt lgkmcnt(0)
  v_readfirstlane_b32 s46, v4
  s_cmp_ge_u32 s46, s47
  s_cbranch_scc1 L_fq23_ok
  s_cmp_eq_u32 s94, 0
  s_cbranch_scc1 L_fq23_ok
  s_sub_u32 s94, s94, 1
  ds_read_b32 v4, v14 offset:16
  s_branch L_fq23
L_fq23_ok:
  ds_read_b128 v[40:43], v248 offset:3584
  ds_read_b128 v[44:47], v249 offset:3584
  ds_read_b128 v[48:51], v250 offset:3584
  s_waitcnt vmcnt(7)
  s_add_u32 s44, s78, 0x03030303
  v_msad_u8 v9, s78, v36, 0
  v_msad_u8 v10, s44, v36, 0
  v_msad_u8 v9, s78, v37, v9
  v_msad_u8 v10, s44, v37, v10
  v_msad_u8 v9, s78, v38, v9
  v_msad_u8 v10, s44, v38, v10
  s_mov_b64 exec, 3
  global_store_byte v7, v8, s[30:31]
  global_load_dwordx3 v[36:38], v235, s[30:31] sc1
  v_sub_u32 v9, v9, v10
  v_add3_u32 v10, v26, v27, s58
  v_add_u32 v8, 1, v8
  s_mov_b64 exec, -1
  v_readlane_b32 s66, v9, 0
  v_readlane_b32 s67, v9, 1
  v_readlane_b32 s91, v10, 0
  s_add_u32 s78, s78, 0x01010101
  s_lshl1_add_u32 s69, s91, s95
  s_add_u32 s95, s66, s67
  s_add_u32 s69, s69, s95
  v_dot2_f32_bf16 v22, v201, v52, 0
  v_add_f32_dpp v240, v18, v18 row_ror:8 row_mask:0xf bank_mask:0xc
  v_add_f32_dpp v240, v20, v20 row_ror:8 row_mask:0xf bank_mask:0x3
  v_dot2_f32_bf16 v23, v206, v53, 0
  v_dot2_f32_bf16 v24, v204, v54, 0
  v_dot2_f32_bf16 v25, v207, v55, 0
  v_cvt_f32_i32 v100, v100
  v_cvt_f32_i32 v101, v101
  v_cvt_f32_i32 v102, v102
  v_cvt_f32_i32 v103, v103
  v_pk_mul_f32 v[20:21], v[100:101], v[22:23]
  v_pk_add_f32 v[18:19], v[22:23], v[24:25]
  v_pk_fma_f32 v[20:21], v[102:103], v[24:25], v[20:21]
  v_add_f32 v18, v18, v19
  v_add_f32 v20, v20, v21
  v_dot2_f32_bf16 v22, v197, v56, 0
  v_add_f32_dpp v21, v18, v18 row_ror:8 row_mask:0xf bank_mask:0xc
  v_add_f32_dpp v21, v20, v20 row_ror:8 row_mask:0xf bank_mask:0x3
  v_add_f32_dpp v20, v240, v240 row_half_mirror row_mask:0xf bank_mask:0x5
  v_dot2_f32_bf16 v23, v202, v57, 0
  v_add_f32_dpp v20, v21, v21 row_half_mirror row_mask:0xf bank_mask:0xa
  v_dot2_f32_bf16 v24, v200, v58, 0
  v_dot2_f32_bf16 v25, v203, v59, 0
  v_add_f32_dpp v20, v20, v20 quad_perm:[2,3,0,1] row_mask:0xf bank_mask:0xf
  v_cvt_f32_i32 v104, v104
  v_cvt_f32_i32 v105, v105
  v_add_f32_dpp v20, v20, v20 quad_perm:[1,0,3,2] row_mask:0xf bank_mask:0xf
  v_cndmask_b32_e64 v237, v237, v20, s[54:55]
  ds_write_b32 v17, v237 offset:3072
  v_cvt_f32_i32 v106, v106
  v_cvt_f32_i32 v107, v107
  v_pk_mul_f32 v[20:21], v[104:105], v[22:23]
  v_pk_add_f32 v[18:19], v[22:23], v[24:25]
  v_pk_fma_f32 v[20:21], v[106:107], v[24:25], v[20:21]
  v_add_f32 v18, v18, v19
  v_add_f32 v20, v20, v21
  s_cmpk_gt_i32 s69, 0x1f
  s_cbranch_scc1 L_p62_4
  s_cmpk_gt_i32 s69, 0xffdb
  s_cbranch_scc1 L_p62_1
  s_waitcnt vmcnt(5)
L_p62_1:
  s_waitcnt vmcnt(8)
L_p62_4:
  s_waitcnt vmcnt(9)
  buffer_load_dwordx4 v[88:91], v214, s[32:35], s98 offen nt
  v_dot2_f32_bf16 v22, v201, v60, 0
  v_add_f32_dpp v241, v18, v18 row_ror:8 row_mask:0xf bank_mask:0xc
  v_add_f32_dpp v241, v20, v20 row_ror:8 row_mask:0xf bank_mask:0x3
  v_dot2_f32_bf16 v23, v206, v61, 0
  v_dot2_f32_bf16 v24, v204, v62, 0
  v_dot2_f32_bf16 v25, v207, v63, 0
  v_cvt_f32_i32 v108, v108
  v_cvt_f32_i32 v109, v109
  v_cvt_f32_i32 v110, v110
  v_cvt_f32_i32 v111, v111
  v_pk_mul_f32 v[20:21], v[108:109], v[22:23]
  v_pk_add_f32 v[18:19], v[22:23], v[24:25]
  v_pk_fma_f32 v[20:21], v[110:111], v[24:25], v[20:21]
  v_add_f32 v18, v18, v19
  v_add_f32 v20, v20, v21
  s_cmpk_gt_i32 s69, 0x1f
  s_cbranch_scc1 L_p63_4
  s_cmpk_gt_i32 s69, 0xfff9
  s_cbranch_scc1 L_p63_2
  s_waitcnt vmcnt(6)
L_p63_2:
  s_waitcnt vmcnt(9)
L_p63_4:
  s_waitcnt vmcnt(10)
  buffer_load_dwordx4 v[92:95], v215, s[32:35], s98 offen nt
  s_cmpk_gt_i32 s69, 0x1f
  s_cbranch_scc1 L_p64_4
  s_cmpk_gt_i32 s69, 0xb
  s_cbranch_scc1 L_p64_3
  s_cmpk_gt_i32 s69, 0xffbb
  s_cbranch_scc1 L_p64_0
  s_waitcnt vmcnt(6)
L_p64_0:
  s_waitcnt vmcnt(7)
L_p64_3:
  s_waitcnt vmcnt(10)
L_p64_4:
  s_waitcnt vmcnt(11)
  buffer_load_dwordx4 v[96:99], v216, s[32:35], s98 offen nt
  s_nop 0
  v_add_f32_dpp v21, v18, v18 row_ror:8 row_mask:0xf bank_mask:0xc
  v_add_f32_dpp v21, v20, v20 row_ror:8 row_mask:0xf bank_mask:0x3
  v_add_f32_dpp v20, v241, v241 row_half_mirror row_mask:0xf bank_mask:0x5
  s_nop 0
  v_add_f32_dpp v20, v21, v21 row_half_mirror row_mask:0xf bank_mask:0xa
  s_nop 1
  v_add_f32_dpp v20, v20, v20 quad_perm:[2,3,0,1] row_mask:0xf bank_mask:0xf
  s_nop 1
  v_add_f32_dpp v20, v20, v20 quad_perm:[1,0,3,2] row_mask:0xf bank_mask:0xf
  v_cndmask_b32_e64 v238, v238, v20, s[54:55]
  ds_write_b32 v17, v238 offset:6144
  v_mov_b32 v9, 3
  ds_write_b32 v6, v9 offset:0
  ds_read_b128 v[52:55], v251 offset:3584
  ds_read_b128 v[56:59], v252 offset:3584
  ds_read_b128 v[60:63], v253 offset:3584
  s_movk_i32 s59, 3072
  s_mov_b32 s43, 3
  s_movk_i32 s101, 9216
  s_mov_b32 s34, 1572864
  s_add_u32 s32, s32, s98
  s_addc_u32 s33, s33, 0
  s_mov_b32 s68, 4
  s_lshl_b32 s44, s68, 2
  s_lshr_b64 s[64:65], s[96:97], s44
  s_and_b32 s64, s64, 15
  s_lshl4_add_u32 s68, s68, s64
  s_mul_i32 s44, s68, 1572864
  s_add_u32 s36, s6, s44
  s_addc_u32 s37, s7, 0
.p2align 6
L_k:
  s_add_u32 s44, s43, 2
  s_min_u32 s47, s44, 16
  s_addk_i32 s59, 1024
  s_cmpk_eq_u32 s59, 4096
  s_cselect_b32 s59, 0, s59
  s_waitcnt lgkmcnt(0)
  s_waitcnt vmcnt(8)
  s_add_u32 s44, s78, 0x03030303
  v_msad_u8 v9, s78, v32, 0
  v_msad_u8 v10, s44, v32, 0
  v_msad_u8 v9, s78, v33, v9
  v_msad_u8 v10, s44, v33, v10
  v_msad_u8 v9, s78, v34, v9
  v_msad_u8 v10, s44, v34, v10
  s_mov_b64 exec, 3
  global_store_byte v7, v8, s[30:31]
  global_load_dwordx3 v[32:34], v232, s[30:31] sc1
  v_sub_u32 v9, v9, v10
  v_add_u32 v8, 1, v8
  s_mov_b64 exec, -1
  v_readlane_b32 s66, v9, 0
  v_readlane_b32 s67, v9, 1
  s_add_u32 s78, s78, 0x01010101
  s_lshl1_add_u32 s69, s91, s95
  s_add_u32 s95, s66, s67
  s_add_u32 s69, s69, s95
  v_dot2_f32_bf16 v22, v13, v40, 0
  v_dot2_f32_bf16 v23, v114, v41, 0
  v_dot2_f32_bf16 v24, v112, v42, 0
  v_dot2_f32_bf16 v25, v115, v43, 0
  v_cvt_f32_i32 v64, v64
  v_cvt_f32_i32 v65, v65
  v_cvt_f32_i32 v66, v66
  v_cvt_f32_i32 v67, v67
  v_pk_mul_f32 v[20:21], v[64:65], v[22:23]
  v_pk_add_f32 v[18:19], v[22:23], v[24:25]
  v_pk_fma_f32 v[20:21], v[66:67], v[24:25], v[20:21]
  v_add_f32 v18, v18, v19
  v_add_f32 v20, v20, v21
  s_cmpk_gt_i32 s69, 0x29
  s_cbranch_scc1 L_p65_4
  s_cmpk_gt_i32 s69, 0xffe5
  s_cbranch_scc1 L_p65_1
  s_waitcnt vmcnt(5)
L_p65_1:
  s_waitcnt vmcnt(8)
L_p65_4:
  s_waitcnt vmcnt(9)
  buffer_load_dwordx4 v[100:103], v217, s[32:35], 0 offen nt
  v_dot2_f32_bf16 v22, v113, v48, 0
  v_add_f32_dpp v239, v18, v18 row_ror:8 row_mask:0xf bank_mask:0xc
  v_add_f32_dpp v239, v20, v20 row_ror:8 row_mask:0xf bank_mask:0x3
  v_dot2_f32_bf16 v23, v118, v49, 0
  v_dot2_f32_bf16 v24, v116, v50, 0
  v_dot2_f32_bf16 v25, v119, v51, 0
  v_cvt_f32_i32 v68, v68
  v_cvt_f32_i32 v69, v69
  v_cvt_f32_i32 v70, v70
  v_cvt_f32_i32 v71, v71
  v_pk_mul_f32 v[20:21], v[68:69], v[22:23]
  v_pk_add_f32 v[18:19], v[22:23], v[24:25]
  v_pk_fma_f32 v[20:21], v[70:71], v[24:25], v[20:21]
  v_add_f32 v18, v18, v19
  v_add_f32 v20, v20, v21
  s_cmpk_gt_i32 s69, 0x29
  s_cbranch_scc1 L_p66_4
  s_cmpk_gt_i32 s69, 0x3
  s_cbranch_scc1 L_p66_2
  s_waitcnt vmcnt(6)
L_p66_2:
  s_waitcnt vmcnt(9)
L_p66_4:
  s_waitcnt vmcnt(10)
  buffer_load_dwordx4 v[104:107], v218, s[32:35], 0 offen nt
  v_dot2_f32_bf16 v22, v117, v44, 0
  v_add_f32_dpp v21, v18, v18 row_ror:8 row_mask:0xf bank_mask:0xc
  v_add_f32_dpp v21, v20, v20 row_ror:8 row_mask:0xf bank_mask:0x3
  v_add_f32_dpp v20, v239, v239 row_half_mirror row_mask:0xf bank_mask:0x5
  v_dot2_f32_bf16 v23, v122, v45, 0
  v_add_f32_dpp v20, v21, v21 row_half_mirror row_mask:0xf bank_mask:0xa
  v_dot2_f32_bf16 v24, v120, v46, 0
  v_dot2_f32_bf16 v25, v123, v47, 0
  v_add_f32_dpp v20, v20, v20 quad_perm:[2,3,0,1] row_mask:0xf bank_mask:0xf
  v_cvt_f32_i32 v72, v72
  v_cvt_f32_i32 v73, v73
  v_add_f32_dpp v20, v20, v20 quad_perm:[1,0,3,2] row_mask:0xf bank_mask:0xf
  v_cndmask_b32_e64 v236, v236, v20, s[48:49]
  v_cvt_f32_i32 v74, v74
  v_cvt_f32_i32 v75, v75
  v_pk_mul_f32 v[20:21], v[72:73], v[22:23]
  v_pk_add_f32 v[18:19], v[22:23], v[24:25]
  v_pk_fma_f32 v[20:21], v[74:75], v[24:25], v[20:21]
  v_add_f32 v18, v18, v19
  v_add_f32 v20, v20, v21
  s_cmpk_gt_i32 s69, 0x29
  s_cbranch_scc1 L_p67_4
  s_cmpk_gt_i32 s69, 0x15
  s_cbranch_scc1 L_p67_3
  s_cmpk_gt_i32 s69, 0xffc5
  s_cbranch_scc1 L_p67_0
  s_waitcnt vmcnt(6)
L_p67_0:
  s_waitcnt vmcnt(7)
L_p67_3:
  s_waitcnt vmcnt(10)
L_p67_4:
  s_waitcnt vmcnt(11)
  buffer_load_dwordx4 v[108:111], v219, s[32:35], 0 offen nt
  s_waitcnt vmcnt(8)
  s_add_u32 s44, s78, 0x03030303
  v_msad_u8 v9, s78, v36, 0
  v_msad_u8 v10, s44, v36, 0
  v_msad_u8 v9, s78, v37, v9
  v_msad_u8 v10, s44, v37, v10
  v_msad_u8 v9, s78, v38, v9
  v_msad_u8 v10, s44, v38, v10
  s_mov_b64 exec, 3
  global_store_byte v7, v8, s[30:31]
  global_load_dwordx3 v[36:38], v233, s[30:31] sc1
  v_sub_u32 v9, v9, v10
  v_add_u32 v8, 1, v8
  s_mov_b64 exec, -1
  v_readlane_b32 s66, v9, 0
  v_readlane_b32 s67, v9, 1
  s_add_u32 s78, s78, 0x01010101
  s_lshl1_add_u32 s69, s91, s95
  s_add_u32 s95, s66, s67
  s_add_u32 s69, s69, s95
  v_dot2_f32_bf16 v22, v121, v40, 0
  v_add_f32_dpp v239, v18, v18 row_ror:8 row_mask:0xf bank_mask:0xc
  v_add_f32_dpp v239, v20, v20 row_ror:8 row_mask:0xf bank_mask:0x3
  v_dot2_f32_bf16 v23, v126, v41, 0
  v_dot2_f32_bf16 v24, v124, v42, 0
  v_dot2_f32_bf16 v25, v127, v43, 0
  v_cvt_f32_i32 v76, v76
  v_cvt_f32_i32 v77, v77
  v_cvt_f32_i32 v78, v78
  v_cvt_f32_i32 v79, v79
  v_pk_mul_f32 v[20:21], v[76:77], v[22:23]
  v_pk_add_f32 v[18:19], v[22:23], v[24:25]
  v_pk_fma_f32 v[20:21], v[78:79], v[24:25], v[20:21]
  v_add_f32 v18, v18, v19
  v_add_f32 v20, v20, v21
  s_cmpk_gt_i32 s69, 0x29
  s_cbranch_scc1 L_p68_4
  s_cmpk_gt_i32 s69, 0xffe5
  s_cbranch_scc1 L_p68_1
  s_waitcnt vmcnt(5)
L_p68_1:
  s_waitcnt vmcnt(8)
L_p68_4:
  s_waitcnt vmcnt(9)
  buffer_load_dwordx4 v[64:67], v220, s[32:35], 0 offen nt
  v_dot2_f32_bf16 v22, v125, v56, 0
  v_add_f32_dpp v21, v18, v18 row_ror:8 row_mask:0xf bank_mask:0xc
  v_add_f32_dpp v21, v20, v20 row_ror:8 row_mask:0xf bank_mask:0x3
  v_add_f32_dpp v20, v239, v239 row_half_mirror row_mask:0xf bank_mask:0x5
  v_dot2_f32_bf16 v23, v130, v57, 0
  v_add_f32_dpp v20, v21, v21 row_half_mirror row_mask:0xf bank_mask:0xa
  v_dot2_f32_bf16 v24, v128, v58, 0
  v_dot2_f32_bf16 v25, v131, v59, 0
  v_add_f32_dpp v20, v20, v20 quad_perm:[2,3,0,1] row_mask:0xf bank_mask:0xf
  v_cvt_f32_i32 v80, v80
  v_cvt_f32_i32 v81, v81
  v_add_f32_dpp v20, v20, v20 quad_perm:[1,0,3,2] row_mask:0xf bank_mask:0xf
  v_cndmask_b32_e64 v236, v236, v20, s[50:51]
  v_cvt_f32_i32 v82, v82
  v_cvt_f32_i32 v83, v83
  v_pk_mul_f32 v[20:21], v[80:81], v[22:23]
  v_pk_add_f32 v[18:19], v[22:23], v[24:25]
  v_pk_fma_f32 v[20:21], v[82:83], v[24:25], v[20:21]
  v_add_f32 v18, v18, v19
  v_add_f32 v20, v20, v21
  s_cmpk_gt_i32 s69, 0x29
  s_cbranch_scc1 L_p69_4
  s_cmpk_gt_i32 s69, 0x3
  s_cbranch_scc1 L_p69_2
  s_waitcnt vmcnt(6)
L_p69_2:
  s_waitcnt vmcnt(9)
L_p69_4:
  s_waitcnt vmcnt(10)
  buffer_load_dwordx4 v[68:71], v221, s[32:35], 0 offen nt
  v_dot2_f32_bf16 v22, v129, v52, 0
  v_add_f32_dpp v239, v18, v18 row_ror:8 row_mask:0xf bank_mask:0xc
  v_add_f32_dpp v239, v20, v20 row_ror:8 row_mask:0xf bank_mask:0x3
  v_dot2_f32_bf16 v23, v134, v53, 0
  v_dot2_f32_bf16 v24, v132, v54, 0
  v_dot2_f32_bf16 v25, v135, v55, 0
  v_cvt_f32_i32 v84, v84
  v_cvt_f32_i32 v85, v85
  v_cvt_f32_i32 v86, v86
  v_cvt_f32_i32 v87, v87
  v_pk_mul_f32 v[20:21], v[84:85], v[22:23]
  v_pk_add_f32 v[18:19], v[22:23], v[24:25]
  v_pk_fma_f32 v[20:21], v[86:87], v[24:25], v[20:21]
  v_add_f32 v18, v18, v19
  v_add_f32 v20, v20, v21
  s_cmpk_gt_i32 s69, 0x29
  s_cbranch_scc1 L_p70_4
  s_cmpk_gt_i32 s69, 0x15
  s_cbranch_scc1 L_p70_3
  s_cmpk_gt_i32 s69, 0xffc5
  s_cbranch_scc1 L_p70_0
  s_waitcnt vmcnt(6)
L_p70_0:
  s_waitcnt vmcnt(7)
L_p70_3:
  s_waitcnt vmcnt(10)
L_p70_4:
  s_waitcnt vmcnt(11)
  buffer_load_dwordx4 v[72:75], v222, s[32:35], 0 offen nt
  v_mov_b32 v9, s43
  ds_write_b32 v14, v9 offset:28
  s_waitcnt vmcnt(8)
  s_add_u32 s44, s78, 0x03030303
  v_msad_u8 v9, s78, v32, 0
  v_msad_u8 v10, s44, v32, 0
  v_msad_u8 v9, s78, v33, v9
  v_msad_u8 v10, s44, v33, v10
  v_msad_u8 v9, s78, v34, v9
  v_msad_u8 v10, s44, v34, v10
  s_mov_b64 exec, 3
  global_store_byte v7, v8, s[30:31]
  global_load_dwordx3 v[32:34], v234, s[30:31] sc1
  v_sub_u32 v9, v9, v10
  v_add_u32 v8, 1, v8
  s_mov_b64 exec, -1
  v_readlane_b32 s66, v9, 0
  v_readlane_b32 s67, v9, 1
  s_add_u32 s78, s78, 0x01010101
  s_lshl1_add_u32 s69, s91, s95
  s_add_u32 s95, s66, s67
  s_add_u32 s69, s69, s95
  v_dot2_f32_bf16 v22, v133, v60, 0
  v_add_f32_dpp v21, v18, v18 row_ror:8 row_mask:0xf bank_mask:0xc
  v_add_f32_dpp v21, v20, v20 row_ror:8 row_mask:0xf bank_mask:0x3
  v_add_f32_dpp v20, v239, v239 row_half_mirror row_mask:0xf bank_mask:0x5
  v_dot2_f32_bf16 v23, v138, v61, 0
  v_add_f32_dpp v20, v21, v21 row_half_mirror row_mask:0xf bank_mask:0xa
  v_dot2_f32_bf16 v24, v136, v62, 0
  v_dot2_f32_bf16 v25, v139, v63, 0
  v_add_f32_dpp v20, v20, v20 quad_perm:[2,3,0,1] row_mask:0xf bank_mask:0xf
  v_cvt_f32_i32 v88, v88
  v_cvt_f32_i32 v89, v89
  v_add_f32_dpp v20, v20, v20 quad_perm:[1,0,3,2] row_mask:0xf bank_mask:0xf
  v_cndmask_b32_e64 v236, v236, v20, s[52:53]
  v_cvt_f32_i32 v90, v90
  v_cvt_f32_i32 v91, v91
  v_pk_mul_f32 v[20:21], v[88:89], v[22:23]
  v_pk_add_f32 v[18:19], v[22:23], v[24:25]
  v_pk_fma_f32 v[20:21], v[90:91], v[24:25], v[20:21]
  v_add_f32 v18, v18, v19
  v_add_f32 v20, v20, v21
  s_cmpk_gt_i32 s69, 0x29
  s_cbranch_scc1 L_p71_4
  s_cmpk_gt_i32 s69, 0xffe5
  s_cbranch_scc1 L_p71_1
  s_waitcnt vmcnt(5)
L_p71_1:
  s_waitcnt vmcnt(8)
L_p71_4:
  s_waitcnt vmcnt(9)
  buffer_load_dwordx4 v[76:79], v223, s[32:35], 0 offen nt
  v_dot2_f32_bf16 v22, v137, v56, 0
  v_add_f32_dpp v239, v18, v18 row_ror:8 row_mask:0xf bank_mask:0xc
  v_add_f32_dpp v239, v20, v20 row_ror:8 row_mask:0xf bank_mask:0x3
  v_dot2_f32_bf16 v23, v142, v57, 0
  v_dot2_f32_bf16 v24, v140, v58, 0
  v_dot2_f32_bf16 v25, v143, v59, 0
  v_cvt_f32_i32 v92, v92
  v_cvt_f32_i32 v93, v93
  v_cvt_f32_i32 v94, v94
  v_cvt_f32_i32 v95, v95
  v_pk_mul_f32 v[20:21], v[92:93], v[22:23]
  v_pk_add_f32 v[18:19], v[22:23], v[24:25]
  v_pk_fma_f32 v[20:21], v[94:95], v[24:25], v[20:21]
  v_add_f32 v18, v18, v19
  v_add_f32 v20, v20, v21
  s_cmpk_gt_i32 s69, 0x29
  s_cbranch_scc1 L_p72_4
  s_cmpk_gt_i32 s69, 0x3
  s_cbranch_scc1 L_p72_2
  s_waitcnt vmcnt(6)
L_p72_2:
  s_waitcnt vmcnt(9)
L_p72_4:
  s_waitcnt vmcnt(10)
  buffer_load_dwordx4 v[80:83], v224, s[32:35], 0 offen nt
  v_dot2_f32_bf16 v22, v141, v44, 0
  v_add_f32_dpp v21, v18, v18 row_ror:8 row_mask:0xf bank_mask:0xc
  v_add_f32_dpp v21, v20, v20 row_ror:8 row_mask:0xf bank_mask:0x3
  v_add_f32_dpp v20, v239, v239 row_half_mirror row_mask:0xf bank_mask:0x5
  v_dot2_f32_bf16 v23, v146, v45, 0
  v_add_f32_dpp v20, v21, v21 row_half_mirror row_mask:0xf bank_mask:0xa
  v_dot2_f32_bf16 v24, v144, v46, 0
  v_dot2_f32_bf16 v25, v147, v47, 0
  v_add_f32_dpp v20, v20, v20 quad_perm:[2,3,0,1] row_mask:0xf bank_mask:0xf
  v_cvt_f32_i32 v96, v96
  v_cvt_f32_i32 v97, v97
  v_add_f32_dpp v20, v20, v20 quad_perm:[1,0,3,2] row_mask:0xf bank_mask:0xf
  v_cndmask_b32_e64 v236, v236, v20, s[54:55]
  v_add_u32 v2, s101, v15
  ds_write_b32 v2, v236
  v_cvt_f32_i32 v98, v98
  v_cvt_f32_i32 v99, v99
  v_pk_mul_f32 v[20:21], v[96:97], v[22:23]
  v_pk_add_f32 v[18:19], v[22:23], v[24:25]
  v_pk_fma_f32 v[20:21], v[98:99], v[24:25], v[20:21]
  v_add_f32 v18, v18, v19
  v_add_f32 v20, v20, v21
  s_cmpk_gt_i32 s69, 0x29
  s_cbranch_scc1 L_p73_4
  s_cmpk_gt_i32 s69, 0x15
  s_cbranch_scc1 L_p73_3
  s_cmpk_gt_i32 s69, 0xffc5
  s_cbranch_scc1 L_p73_0
  s_waitcnt vmcnt(6)
L_p73_0:
  s_waitcnt vmcnt(7)
L_p73_3:
  s_waitcnt vmcnt(10)
L_p73_4:
  s_waitcnt vmcnt(11)
  buffer_load_dwordx4 v[84:87], v225, s[32:35], 0 offen nt
  s_waitcnt vmcnt(8)
  s_add_u32 s44, s78, 0x03030303
  v_msad_u8 v9, s78, v36, 0
  v_msad_u8 v10, s44, v36, 0
  v_msad_u8 v9, s78, v37, v9
  v_msad_u8 v10, s44, v37, v10
  v_msad_u8 v9, s78, v38, v9
  v_msad_u8 v10, s44, v38, v10
  s_mov_b64 exec, 3
  global_store_byte v7, v8, s[30:31]
  global_load_dwordx3 v[36:38], v235, s[30:31] sc1
  v_sub_u32 v9, v9, v10
  v_add_u32 v8, 1, v8
  s_mov_b64 exec, -1
  v_readlane_b32 s66, v9, 0
  v_readlane_b32 s67, v9, 1
  s_add_u32 s78, s78, 0x01010101
  s_lshl1_add_u32 s69, s91, s95
  s_add_u32 s95, s66, s67
  s_add_u32 s69, s69, s95
  v_dot2_f32_bf16 v22, v145, v40, 0
  v_add_f32_dpp v239, v18, v18 row_ror:8 row_mask:0xf bank_mask:0xc
  v_add_f32_dpp v239, v20, v20 row_ror:8 row_mask:0xf bank_mask:0x3
  v_dot2_f32_bf16 v23, v150, v41, 0
  v_dot2_f32_bf16 v24, v148, v42, 0
  v_dot2_f32_bf16 v25, v151, v43, 0
  v_cvt_f32_i32 v100, v100
  v_cvt_f32_i32 v101, v101
  v_cvt_f32_i32 v102, v102
  v_cvt_f32_i32 v103, v103
  v_pk_mul_f32 v[20:21], v[100:101], v[22:23]
  v_pk_add_f32 v[18:19], v[22:23], v[24:25]
  v_pk_fma_f32 v[20:21], v[102:103], v[24:25], v[20:21]
  v_add_f32 v18, v18, v19
  v_add_f32 v20, v20, v21
  s_cmpk_gt_i32 s69, 0x29
  s_cbranch_scc1 L_p74_4
  s_cmpk_gt_i32 s69, 0xffe5
  s_cbranch_scc1 L_p74_1
  s_waitcnt vmcnt(5)
L_p74_1:
  s_waitcnt vmcnt(8)
L_p74_4:
  s_waitcnt vmcnt(9)
  buffer_load_dwordx4 v[88:91], v226, s[32:35], 0 offen nt
  v_dot2_f32_bf16 v22, v149, v48, 0
  v_add_f32_dpp v21, v18, v18 row_ror:8 row_mask:0xf bank_mask:0xc
  v_add_f32_dpp v21, v20, v20 row_ror:8 row_mask:0xf bank_mask:0x3
  v_add_f32_dpp v20, v239, v239 row_half_mirror row_mask:0xf bank_mask:0x5
  v_dot2_f32_bf16 v23, v154, v49, 0
  v_add_f32_dpp v20, v21, v21 row_half_mirror row_mask:0xf bank_mask:0xa
  v_dot2_f32_bf16 v24, v152, v50, 0
  v_dot2_f32_bf16 v25, v155, v51, 0
  v_add_f32_dpp v20, v20, v20 quad_perm:[2,3,0,1] row_mask:0xf bank_mask:0xf
  v_cvt_f32_i32 v104, v104
  v_cvt_f32_i32 v105, v105
  v_add_f32_dpp v20, v20, v20 quad_perm:[1,0,3,2] row_mask:0xf bank_mask:0xf
  v_cndmask_b32_e64 v236, v236, v20, s[48:49]
  v_cvt_f32_i32 v106, v106
  v_cvt_f32_i32 v107, v107
  v_pk_mul_f32 v[20:21], v[104:105], v[22:23]
  v_pk_add_f32 v[18:19], v[22:23], v[24:25]
  v_pk_fma_f32 v[20:21], v[106:107], v[24:25], v[20:21]
  v_add_f32 v18, v18, v19
  v_add_f32 v20, v20, v21
  s_cmpk_gt_i32 s69, 0x29
  s_cbranch_scc1 L_p75_4
  s_cmpk_gt_i32 s69, 0x3
  s_cbranch_scc1 L_p75_2
  s_waitcnt vmcnt(6)
L_p75_2:
  s_waitcnt vmcnt(9)
L_p75_4:
  s_waitcnt vmcnt(10)
  buffer_load_dwordx4 v[92:95], v227, s[32:35], 0 offen nt
  v_dot2_f32_bf16 v22, v153, v44, 0
  v_add_f32_dpp v239, v18, v18 row_ror:8 row_mask:0xf bank_mask:0xc
  v_add_f32_dpp v239, v20, v20 row_ror:8 row_mask:0xf bank_mask:0x3
  v_dot2_f32_bf16 v23, v158, v45, 0
  v_dot2_f32_bf16 v24, v156, v46, 0
  v_dot2_f32_bf16 v25, v159, v47, 0
  v_cvt_f32_i32 v108, v108
  v_cvt_f32_i32 v109, v109
  v_cvt_f32_i32 v110, v110
  v_cvt_f32_i32 v111, v111
  v_pk_mul_f32 v[20:21], v[108:109], v[22:23]
  v_pk_add_f32 v[18:19], v[22:23], v[24:25]
  v_pk_fma_f32 v[20:21], v[110:111], v[24:25], v[20:21]
  v_add_f32 v18, v18, v19
  v_add_f32 v20, v20, v21
  s_cmpk_gt_i32 s69, 0x29
  s_cbranch_scc1 L_p76_4
  s_cmpk_gt_i32 s69, 0x15
  s_cbranch_scc1 L_p76_3
  s_cmpk_gt_i32 s69, 0xffc5
  s_cbranch_scc1 L_p76_0
  s_waitcnt vmcnt(6)
L_p76_0:
  s_waitcnt vmcnt(7)
L_p76_3:
  s_waitcnt vmcnt(10)
L_p76_4:
  s_waitcnt vmcnt(11)
  buffer_load_dwordx4 v[96:99], v228, s[32:35], 0 offen nt
  s_waitcnt vmcnt(8)
  s_add_u32 s44, s78, 0x03030303
  v_msad_u8 v9, s78, v32, 0
  v_msad_u8 v10, s44, v32, 0
  v_msad_u8 v9, s78, v33, v9
  v_msad_u8 v10, s44, v33, v10
  v_msad_u8 v9, s78, v34, v9
  v_msad_u8 v10, s44, v34, v10
  s_mov_b64 exec, 3
  global_store_byte v7, v8, s[30:31]
  global_load_dwordx3 v[32:34], v232, s[30:31] sc1
  v_sub_u32 v9, v9, v10
  v_add_u32 v8, 1, v8
  s_mov_b64 exec, -1
  v_readlane_b32 s66, v9, 0
  v_readlane_b32 s67, v9, 1
  s_add_u32 s78, s78, 0x01010101
  s_lshl1_add_u32 s69, s91, s95
  s_add_u32 s95, s66, s67
  s_add_u32 s69, s69, s95
  v_dot2_f32_bf16 v22, v157, v60, 0
  v_add_f32_dpp v21, v18, v18 row_ror:8 row_mask:0xf bank_mask:0xc
  v_add_f32_dpp v21, v20, v20 row_ror:8 row_mask:0xf bank_mask:0x3
  v_add_f32_dpp v20, v239, v239 row_half_mirror row_mask:0xf bank_mask:0x5
  v_dot2_f32_bf16 v23, v162, v61, 0
  v_add_f32_dpp v20, v21, v21 row_half_mirror row_mask:0xf bank_mask:0xa
  v_dot2_f32_bf16 v24, v160, v62, 0
  v_dot2_f32_bf16 v25, v163, v63, 0
  v_add_f32_dpp v20, v20, v20 quad_perm:[2,3,0,1] row_mask:0xf bank_mask:0xf
  v_cvt_f32_i32 v64, v64
  v_cvt_f32_i32 v65, v65
  v_add_f32_dpp v20, v20, v20 quad_perm:[1,0,3,2] row_mask:0xf bank_mask:0xf
  v_cndmask_b32_e64 v236, v236, v20, s[50:51]
  v_cvt_f32_i32 v66, v66
  v_cvt_f32_i32 v67, v67
  v_pk_mul_f32 v[20:21], v[64:65], v[22:23]
  v_pk_add_f32 v[18:19], v[22:23], v[24:25]
  v_pk_fma_f32 v[20:21], v[66:67], v[24:25], v[20:21]
  v_add_f32 v18, v18, v19
  v_add_f32 v20, v20, v21
  s_cmpk_gt_i32 s69, 0x29
  s_cbranch_scc1 L_p77_4
  s_cmpk_gt_i32 s69, 0xffe5
  s_cbranch_scc1 L_p77_1
  s_waitcnt vmcnt(5)
L_p77_1:
  s_waitcnt vmcnt(8)
L_p77_4:
  s_waitcnt vmcnt(9)
  buffer_load_dwordx4 v[100:103], v229, s[32:35], 0 offen nt
  v_dot2_f32_bf16 v22, v161, v56, 0
  v_add_f32_dpp v239, v18, v18 row_ror:8 row_mask:0xf bank_mask:0xc
  v_add_f32_dpp v239, v20, v20 row_ror:8 row_mask:0xf bank_mask:0x3
  v_dot2_f32_bf16 v23, v166, v57, 0
  v_dot2_f32_bf16 v24, v164, v58, 0
  v_dot2_f32_bf16 v25, v167, v59, 0
  v_cvt_f32_i32 v68, v68
  v_cvt_f32_i32 v69, v69
  v_cvt_f32_i32 v70, v70
  v_cvt_f32_i32 v71, v71
  v_pk_mul_f32 v[20:21], v[68:69], v[22:23]
  v_pk_add_f32 v[18:19], v[22:23], v[24:25]
  v_pk_fma_f32 v[20:21], v[70:71], v[24:25], v[20:21]
  v_add_f32 v18, v18, v19
  v_add_f32 v20, v20, v21
  s_cmpk_gt_i32 s69, 0x29
  s_cbranch_scc1 L_p78_4
  s_cmpk_gt_i32 s69, 0x3
  s_cbranch_scc1 L_p78_2
  s_waitcnt vmcnt(6)
L_p78_2:
  s_waitcnt vmcnt(9)
L_p78_4:
  s_waitcnt vmcnt(10)
  buffer_load_dwordx4 v[104:107], v230, s[32:35], 0 offen nt
  v_dot2_f32_bf16 v22, v165, v52, 0
  v_add_f32_dpp v21, v18, v18 row_ror:8 row_mask:0xf bank_mask:0xc
  v_add_f32_dpp v21, v20, v20 row_ror:8 row_mask:0xf bank_mask:0x3
  v_add_f32_dpp v20, v239, v239 row_half_mirror row_mask:0xf bank_mask:0x5
  v_dot2_f32_bf16 v23, v170, v53, 0
  v_add_f32_dpp v20, v21, v21 row_half_mirror row_mask:0xf bank_mask:0xa
  v_dot2_f32_bf16 v24, v168, v54, 0
  v_dot2_f32_bf16 v25, v171, v55, 0
  v_add_f32_dpp v20, v20, v20 quad_perm:[2,3,0,1] row_mask:0xf bank_mask:0xf
  v_cvt_f32_i32 v72, v72
  v_cvt_f32_i32 v73, v73
  v_add_f32_dpp v20, v20, v20 quad_perm:[1,0,3,2] row_mask:0xf bank_mask:0xf
  v_cndmask_b32_e64 v236, v236, v20, s[52:53]
  v_cvt_f32_i32 v74, v74
  v_cvt_f32_i32 v75, v75
  v_pk_mul_f32 v[20:21], v[72:73], v[22:23]
  v_pk_add_f32 v[18:19], v[22:23], v[24:25]
  v_pk_fma_f32 v[20:21], v[74:75], v[24:25], v[20:21]
  v_add_f32 v18, v18, v19
  v_add_f32 v20, v20, v21
  s_cmpk_gt_i32 s69, 0x29
  s_cbranch_scc1 L_p79_4
  s_cmpk_gt_i32 s69, 0x15
  s_cbranch_scc1 L_p79_3
  s_cmpk_gt_i32 s69, 0xffc5
  s_cbranch_scc1 L_p79_0
  s_waitcnt vmcnt(6)
L_p79_0:
  s_waitcnt vmcnt(7)
L_p79_3:
  s_waitcnt vmcnt(10)
L_p79_4:
  s_waitcnt vmcnt(11)
  buffer_load_dwordx4 v[108:111], v231, s[32:35], 0 offen nt
  s_waitcnt vmcnt(8)
  s_add_u32 s44, s78, 0x03030303
  v_msad_u8 v9, s78, v36, 0
  v_msad_u8 v10, s44, v36, 0
  v_msad_u8 v9, s78, v37, v9
  v_msad_u8 v10, s44, v37, v10
  v_msad_u8 v9, s78, v38, v9
  v_msad_u8 v10, s44, v38, v10
  s_mov_b64 exec, 3
  global_load_dwordx2 v[26:27], v11, s[30:31] sc1
  global_store_byte v7, v8, s[30:31]
  global_load_dwordx3 v[36:38], v233, s[30:31] sc1
  v_sub_u32 v9, v9, v10
  v_add_u32 v8, 1, v8
  s_mov_b64 exec, -1
  v_readlane_b32 s66, v9, 0
  v_readlane_b32 s67, v9, 1
  s_add_u32 s78, s78, 0x01010101
  s_lshl1_add_u32 s69, s91, s95
  s_add_u32 s95, s66, s67
  s_add_u32 s69, s69, s95
  v_dot2_f32_bf16 v22, v169, v60, 0
  v_add_f32_dpp v239, v18, v18 row_ror:8 row_mask:0xf bank_mask:0xc
  v_add_f32_dpp v239, v20, v20 row_ror:8 row_mask:0xf bank_mask:0x3
  v_dot2_f32_bf16 v23, v174, v61, 0
  v_dot2_f32_bf16 v24, v172, v62, 0
  v_dot2_f32_bf16 v25, v175, v63, 0
  v_cvt_f32_i32 v76, v76
  v_cvt_f32_i32 v77, v77
  v_cvt_f32_i32 v78, v78
  v_cvt_f32_i32 v79, v79
  v_pk_mul_f32 v[20:21], v[76:77], v[22:23]
  v_pk_add_f32 v[18:19], v[22:23], v[24:25]
  v_pk_fma_f32 v[20:21], v[78:79], v[24:25], v[20:21]
  v_add_f32 v18, v18, v19
  v_add_f32 v20, v20, v21
  s_cmpk_gt_i32 s69, 0x29
  s_cbranch_scc1 L_p80_4
  s_cmpk_gt_i32 s69, 0xffe5
  s_cbranch_scc1 L_p80_1
  s_waitcnt vmcnt(6)
L_p80_1:
  s_waitcnt vmcnt(9)
L_p80_4:
  s_waitcnt vmcnt(10)
  buffer_load_dwordx4 v[64:67], v208, s[36:39], 0 offen nt
  v_dot2_f32_bf16 v22, v173, v48, 0
  v_add_f32_dpp v21, v18, v18 row_ror:8 row_mask:0xf bank_mask:0xc
  v_add_f32_dpp v21, v20, v20 row_ror:8 row_mask:0xf bank_mask:0x3
  v_add_f32_dpp v20, v239, v239 row_half_mirror row_mask:0xf bank_mask:0x5
  v_dot2_f32_bf16 v23, v178, v49, 0
  v_add_f32_dpp v20, v21, v21 row_half_mirror row_mask:0xf bank_mask:0xa
  v_dot2_f32_bf16 v24, v176, v50, 0
  v_dot2_f32_bf16 v25, v179, v51, 0
  v_add_f32_dpp v20, v20, v20 quad_perm:[2,3,0,1] row_mask:0xf bank_mask:0xf
  v_cvt_f32_i32 v80, v80
  v_cvt_f32_i32 v81, v81
  v_add_f32_dpp v20, v20, v20 quad_perm:[1,0,3,2] row_mask:0xf bank_mask:0xf
  v_cndmask_b32_e64 v236, v236, v20, s[54:55]
  v_add_u32 v2, s101, v16
  ds_write_b32 v2, v236
  v_cvt_f32_i32 v82, v82
  v_cvt_f32_i32 v83, v83
  v_pk_mul_f32 v[20:21], v[80:81], v[22:23]
  v_pk_add_f32 v[18:19], v[22:23], v[24:25]
  v_pk_fma_f32 v[20:21], v[82:83], v[24:25], v[20:21]
  v_add_f32 v18, v18, v19
  v_add_f32 v20, v20, v21
  s_cmpk_gt_i32 s69, 0x29
  s_cbranch_scc1 L_p81_4
  s_cmpk_gt_i32 s69, 0x3
  s_cbranch_scc1 L_p81_2
  s_waitcnt vmcnt(7)
L_p81_2:
  s_waitcnt vmcnt(10)
L_p81_4:
  s_waitcnt vmcnt(11)
  buffer_load_dwordx4 v[68:71], v209, s[36:39], 0 offen nt
  v_dot2_f32_bf16 v22, v177, v44, 0
  v_add_f32_dpp v239, v18, v18 row_ror:8 row_mask:0xf bank_mask:0xc
  v_add_f32_dpp v239, v20, v20 row_ror:8 row_mask:0xf bank_mask:0x3
  v_dot2_f32_bf16 v23, v182, v45, 0
  v_dot2_f32_bf16 v24, v180, v46, 0
  v_dot2_f32_bf16 v25, v183, v47, 0
  v_cvt_f32_i32 v84, v84
  v_cvt_f32_i32 v85, v85
  v_cvt_f32_i32 v86, v86
  v_cvt_f32_i32 v87, v87
  v_pk_mul_f32 v[20:21], v[84:85], v[22:23]
  v_pk_add_f32 v[18:19], v[22:23], v[24:25]
  v_pk_fma_f32 v[20:21], v[86:87], v[24:25], v[20:21]
  v_add_f32 v18, v18, v19
  v_add_f32 v20, v20, v21
  s_cmpk_gt_i32 s69, 0x29
  s_cbranch_scc1 L_p82_4
  s_cmpk_gt_i32 s69, 0x15
  s_cbranch_scc1 L_p82_3
  s_cmpk_gt_i32 s69, 0xffc5
  s_cbranch_scc1 L_p82_0
  s_waitcnt vmcnt(7)
L_p82_0:
  s_waitcnt vmcnt(8)
L_p82_3:
  s_waitcnt vmcnt(11)
L_p82_4:
  s_waitcnt vmcnt(12)
  buffer_load_dwordx4 v[72:75], v210, s[36:39], 0 offen nt
  ds_read_b32 v4, v14 offset:16
  s_waitcnt vmcnt(9)
  s_add_u32 s44, s78, 0x03030303
  v_msad_u8 v9, s78, v32, 0
  v_msad_u8 v10, s44, v32, 0
  v_msad_u8 v9, s78, v33, v9
  v_msad_u8 v10, s44, v33, v10
  v_msad_u8 v9, s78, v34, v9
  v_msad_u8 v10, s44, v34, v10
  s_mov_b64 exec, 3
  global_store_byte v7, v8, s[30:31]
  global_load_dwordx3 v[32:34], v234, s[30:31] sc1
  v_sub_u32 v9, v9, v10
  v_add_u32 v8, 1, v8
  s_mov_b64 exec, -1
  v_readlane_b32 s66, v9, 0
  v_readlane_b32 s67, v9, 1
  s_add_u32 s78, s78, 0x01010101
  s_lshl1_add_u32 s69, s91, s95
  s_add_u32 s95, s66, s67
  s_add_u32 s69, s69, s95
  v_dot2_f32_bf16 v22, v181, v40, 0
  v_add_f32_dpp v21, v18, v18 row_ror:8 row_mask:0xf bank_mask:0xc
  v_add_f32_dpp v21, v20, v20 row_ror:8 row_mask:0xf bank_mask:0x3
  v_add_f32_dpp v20, v239, v239 row_half_mirror row_mask:0xf bank_mask:0x5
  v_dot2_f32_bf16 v23, v186, v41, 0
  v_add_f32_dpp v20, v21, v21 row_half_mirror row_mask:0xf bank_mask:0xa
  v_dot2_f32_bf16 v24, v184, v42, 0
  v_dot2_f32_bf16 v25, v187, v43, 0
  v_add_f32_dpp v20, v20, v20 quad_perm:[2,3,0,1] row_mask:0xf bank_mask:0xf
  v_cvt_f32_i32 v88, v88
  v_cvt_f32_i32 v89, v89
  v_add_f32_dpp v20, v20, v20 quad_perm:[1,0,3,2] row_mask:0xf bank_mask:0xf
  v_cndmask_b32_e64 v236, v236, v20, s[48:49]
  v_cvt_f32_i32 v90, v90
  v_cvt_f32_i32 v91, v91
  v_pk_mul_f32 v[20:21], v[88:89], v[22:23]
  v_pk_add_f32 v[18:19], v[22:23], v[24:25]
  v_pk_fma_f32 v[20:21], v[90:91], v[24:25], v[20:21]
  v_add_f32 v18, v18, v19
  v_add_f32 v20, v20, v21
  s_cmpk_gt_i32 s69, 0x29
  s_cbranch_scc1 L_p83_4
  s_cmpk_gt_i32 s69, 0xffe5
  s_cbranch_scc1 L_p83_1
  s_waitcnt vmcnt(5)
L_p83_1:
  s_waitcnt vmcnt(9)
L_p83_4:
  s_waitcnt vmcnt(10)
  buffer_load_dwordx4 v[76:79], v211, s[36:39], 0 offen nt
  v_dot2_f32_bf16 v22, v185, v48, 0
  v_add_f32_dpp v239, v18, v18 row_ror:8 row_mask:0xf bank_mask:0xc
  v_add_f32_dpp v239, v20, v20 row_ror:8 row_mask:0xf bank_mask:0x3
  v_dot2_f32_bf16 v23, v190, v49, 0
  v_dot2_f32_bf16 v24, v188, v50, 0
  v_dot2_f32_bf16 v25, v191, v51, 0
  v_cvt_f32_i32 v92, v92
  v_cvt_f32_i32 v93, v93
  v_cvt_f32_i32 v94, v94
  v_cvt_f32_i32 v95, v95
  v_pk_mul_f32 v[20:21], v[92:93], v[22:23]
  v_pk_add_f32 v[18:19], v[22:23], v[24:25]
  v_pk_fma_f32 v[20:21], v[94:95], v[24:25], v[20:21]
  v_add_f32 v18, v18, v19
  v_add_f32 v20, v20, v21
  s_cmpk_gt_i32 s69, 0x29
  s_cbranch_scc1 L_p84_4
  s_cmpk_gt_i32 s69, 0x3
  s_cbranch_scc1 L_p84_2
  s_waitcnt vmcnt(6)
L_p84_2:
  s_waitcnt vmcnt(10)
L_p84_4:
  s_waitcnt vmcnt(11)
  buffer_load_dwordx4 v[80:83], v212, s[36:39], 0 offen nt
  v_dot2_f32_bf16 v22, v189, v52, 0
  v_add_f32_dpp v21, v18, v18 row_ror:8 row_mask:0xf bank_mask:0xc
  v_add_f32_dpp v21, v20, v20 row_ror:8 row_mask:0xf bank_mask:0x3
  v_add_f32_dpp v20, v239, v239 row_half_mirror row_mask:0xf bank_mask:0x5
  v_dot2_f32_bf16 v23, v194, v53, 0
  v_add_f32_dpp v20, v21, v21 row_half_mirror row_mask:0xf bank_mask:0xa
  v_dot2_f32_bf16 v24, v192, v54, 0
  v_dot2_f32_bf16 v25, v195, v55, 0
  v_add_f32_dpp v20, v20, v20 quad_perm:[2,3,0,1] row_mask:0xf bank_mask:0xf
  v_cvt_f32_i32 v96, v96
  v_cvt_f32_i32 v97, v97
  v_add_f32_dpp v20, v20, v20 quad_perm:[1,0,3,2] row_mask:0xf bank_mask:0xf
  v_cndmask_b32_e64 v236, v236, v20, s[50:51]
  v_cvt_f32_i32 v98, v98
  v_cvt_f32_i32 v99, v99
  v_pk_mul_f32 v[20:21], v[96:97], v[22:23]
  v_pk_add_f32 v[18:19], v[22:23], v[24:25]
  v_pk_fma_f32 v[20:21], v[98:99], v[24:25], v[20:21]
  v_add_f32 v18, v18, v19
  v_add_f32 v20, v20, v21
  s_cmpk_gt_i32 s69, 0x29
  s_cbranch_scc1 L_p85_4
  s_cmpk_gt_i32 s69, 0x15
  s_cbranch_scc1 L_p85_3
  s_cmpk_gt_i32 s69, 0xffc5
  s_cbranch_scc1 L_p85_0
  s_waitcnt vmcnt(6)
L_p85_0:
  s_waitcnt vmcnt(7)
L_p85_3:
  s_waitcnt vmcnt(11)
L_p85_4:
  s_waitcnt vmcnt(12)
  buffer_load_dwordx4 v[84:87], v213, s[36:39], 0 offen nt
L_qn:
  s_waitcnt lgkmcnt(0)
  v_readfirstlane_b32 s46, v4
  s_cmp_ge_u32 s46, s47
  s_cbranch_scc1 L_qn_ok
  s_cmp_eq_u32 s94, 0
  s_cbranch_scc1 L_qn_ok
  s_sub_u32 s94, s94, 1
  ds_read_b32 v4, v14 offset:16
  s_branch L_qn
L_qn_ok:
  v_add_u32 v10, s59, v248
  ds_read_b128 v[40:43], v10 offset:512
  v_add_u32 v10, s59, v249
  ds_read_b128 v[44:47], v10 offset:512
  v_add_u32 v10, s59, v250
  ds_read_b128 v[48:51], v10 offset:512
  s_waitcnt vmcnt(8)
  s_add_u32 s44, s78, 0x03030303
  v_msad_u8 v9, s78, v36, 0
  v_msad_u8 v10, s44, v36, 0
  v_msad_u8 v9, s78, v37, v9
  v_msad_u8 v10, s44, v37, v10
  v_msad_u8 v9, s78, v38, v9
  v_msad_u8 v10, s44, v38, v10
  s_mov_b64 exec, 3
  global_store_byte v7, v8, s[30:31]
  global_load_dwordx3 v[36:38], v235, s[30:31] sc1
  v_sub_u32 v9, v9, v10
  v_add3_u32 v10, v26, v27, s58
  v_add_u32 v8, 1, v8
  s_mov_b64 exec, -1
  v_readlane_b32 s66, v9, 0
  v_readlane_b32 s67, v9, 1
  v_readlane_b32 s91, v10, 0
  s_add_u32 s78, s78, 0x01010101
  s_lshl1_add_u32 s69, s91, s95
  s_add_u32 s95, s66, s67
  s_add_u32 s69, s69, s95
  v_dot2_f32_bf16 v22, v193, v60, 0
  v_add_f32_dpp v239, v18, v18 row_ror:8 row_mask:0xf bank_mask:0xc
  v_add_f32_dpp v239, v20, v20 row_ror:8 row_mask:0xf bank_mask:0x3
  v_dot2_f32_bf16 v23, v198, v61, 0
  v_dot2_f32_bf16 v24, v196, v62, 0
  v_dot2_f32_bf16 v25, v199, v63, 0
  v_cvt_f32_i32 v100, v100
  v_cvt_f32_i32 v101, v101
  v_cvt_f32_i32 v102, v102
  v_cvt_f32_i32 v103, v103
  v_add_u32 v10, s59, v253
  ds_read_b128 v[60:63], v10 offset:512
  v_pk_mul_f32 v[20:21], v[100:101], v[22:23]
  v_pk_add_f32 v[18:19], v[22:23], v[24:25]
  v_pk_fma_f32 v[20:21], v[102:103], v[24:25], v[20:21]
  v_add_f32 v18, v18, v19
  v_add_f32 v20, v20, v21
  s_cmpk_gt_i32 s69, 0x29
  s_cbranch_scc1 L_p86_4
  s_cmpk_gt_i32 s69, 0xffe5
  s_cbranch_scc1 L_p86_1
  s_waitcnt vmcnt(5)
L_p86_1:
  s_waitcnt vmcnt(8)
L_p86_4:
  s_waitcnt vmcnt(9)
  buffer_load_dwordx4 v[88:91], v214, s[36:39], 0 offen nt
  v_dot2_f32_bf16 v22, v197, v56, 0
  v_add_f32_dpp v21, v18, v18 row_ror:8 row_mask:0xf bank_mask:0xc
  v_add_f32_dpp v21, v20, v20 row_ror:8 row_mask:0xf bank_mask:0x3
  v_add_f32_dpp v20, v239, v239 row_half_mirror row_mask:0xf bank_mask:0x5
  v_dot2_f32_bf16 v23, v202, v57, 0
  v_add_f32_dpp v20, v21, v21 row_half_mirror row_mask:0xf bank_mask:0xa
  v_dot2_f32_bf16 v24, v200, v58, 0
  v_dot2_f32_bf16 v25, v203, v59, 0
  v_add_f32_dpp v20, v20, v20 quad_perm:[2,3,0,1] row_mask:0xf bank_mask:0xf
  v_cvt_f32_i32 v104, v104
  v_cvt_f32_i32 v105, v105
  v_add_f32_dpp v20, v20, v20 quad_perm:[1,0,3,2] row_mask:0xf bank_mask:0xf
  v_cndmask_b32_e64 v236, v236, v20, s[52:53]
  v_cvt_f32_i32 v106, v106
  v_cvt_f32_i32 v107, v107
  v_add_u32 v10, s59, v252
  ds_read_b128 v[56:59], v10 offset:512
  v_pk_mul_f32 v[20:21], v[104:105], v[22:23]
  v_pk_add_f32 v[18:19], v[22:23], v[24:25]
  v_pk_fma_f32 v[20:21], v[106:107], v[24:25], v[20:21]
  v_add_f32 v18, v18, v19
  v_add_f32 v20, v20, v21
  s_cmpk_gt_i32 s69, 0x29
  s_cbranch_scc1 L_p87_4
  s_cmpk_gt_i32 s69, 0x3
  s_cbranch_scc1 L_p87_2
  s_waitcnt vmcnt(6)
L_p87_2:
  s_waitcnt vmcnt(9)
L_p87_4:
  s_waitcnt vmcnt(10)
  buffer_load_dwordx4 v[92:95], v215, s[36:39], 0 offen nt
  v_dot2_f32_bf16 v22, v201, v52, 0
  v_add_f32_dpp v239, v18, v18 row_ror:8 row_mask:0xf bank_mask:0xc
  v_add_f32_dpp v239, v20, v20 row_ror:8 row_mask:0xf bank_mask:0x3
  v_dot2_f32_bf16 v23, v206, v53, 0
  v_dot2_f32_bf16 v24, v204, v54, 0
  v_dot2_f32_bf16 v25, v207, v55, 0
  v_cvt_f32_i32 v108, v108
  v_cvt_f32_i32 v109, v109
  v_cvt_f32_i32 v110, v110
  v_cvt_f32_i32 v111, v111
  v_add_u32 v10, s59, v251
  ds_read_b128 v[52:55], v10 offset:512
  v_pk_mul_f32 v[20:21], v[108:109], v[22:23]
  v_pk_add_f32 v[18:19], v[22:23], v[24:25]
  v_pk_fma_f32 v[20:21], v[110:111], v[24:25], v[20:21]
  v_add_f32 v18, v18, v19
  v_add_f32 v20, v20, v21
  s_cmpk_gt_i32 s69, 0x29
  s_cbranch_scc1 L_p88_4
  s_cmpk_gt_i32 s69, 0x15
  s_cbranch_scc1 L_p88_3
  s_cmpk_gt_i32 s69, 0xffc5
  s_cbranch_scc1 L_p88_0
  s_waitcnt vmcnt(6)
L_p88_0:
  s_waitcnt vmcnt(7)
L_p88_3:
  s_waitcnt vmcnt(10)
L_p88_4:
  s_waitcnt vmcnt(11)
  buffer_load_dwordx4 v[96:99], v216, s[36:39], 0 offen nt
  s_nop 0
  v_add_f32_dpp v21, v18, v18 row_ror:8 row_mask:0xf bank_mask:0xc
  v_add_f32_dpp v21, v20, v20 row_ror:8 row_mask:0xf bank_mask:0x3
  v_add_f32_dpp v20, v239, v239 row_half_mirror row_mask:0xf bank_mask:0x5
  s_nop 0
  v_add_f32_dpp v20, v21, v21 row_half_mirror row_mask:0xf bank_mask:0xa
  s_nop 1
  v_add_f32_dpp v20, v20, v20 quad_perm:[2,3,0,1] row_mask:0xf bank_mask:0xf
  s_nop 1
  v_add_f32_dpp v20, v20, v20 quad_perm:[1,0,3,2] row_mask:0xf bank_mask:0xf
  v_cndmask_b32_e64 v236, v236, v20, s[54:55]
  v_add_u32 v2, s101, v17
  ds_write_b32 v2, v236
  s_addk_i32 s101, 3072
  s_cmpk_eq_u32 s101, 18432
  s_cselect_b32 s101, 0, s101
  s_add_u32 s43, s43, 1
  v_mov_b32 v4, s43
  ds_write_b32 v6, v4 offset:0
  s_mov_b64 s[32:33], s[36:37]
  s_add_u32 s68, s43, 1
  s_sub_u32 s45, s68, 16
  s_lshl_b32 s46, s45, 2
  s_lshr_b64 s[64:65], s[92:93], s46
  s_and_b32 s46, s64, 15
  s_cmp_lt_u32 s68, 16
  s_cselect_b32 s68, s68, s46
  s_cselect_b32 s70, s6, s12
  s_cselect_b32 s71, s7, s13
  s_lshl_b32 s44, s68, 2
  s_lshr_b64 s[64:65], s[96:97], s44
  s_and_b32 s64, s64, 15
  s_lshl4_add_u32 s68, s68, s64
  s_mul_i32 s44, s68, 1572864
  s_add_u32 s36, s70, s44
  s_addc_u32 s37, s71, 0
  s_cmp_lt_u32 s43, 16
  s_cbranch_scc1 L_k
L_vpre:
  v_subrev_u32 v116, 45568, v15
  v_mul_u32_u24 v116, 683, v116
  v_lshrrev_b32 v116, 13, v116
  v_lshlrev_b32 v116, 2, v116
  v_subrev_u32 v117, 45568, v16
  v_mul_u32_u24 v117, 683, v117
  v_lshrrev_b32 v117, 13, v117
  v_lshlrev_b32 v117, 2, v117
  v_subrev_u32 v118, 45568, v17
  v_mul_u32_u24 v118, 683, v118
  v_lshrrev_b32 v118, 13, v118
  v_lshlrev_b32 v118, 2, v118
  s_mov_b64 vcc, 0
  s_mov_b32 s43, 0
  s_lshl_b32 s68, s43, 2
  s_lshr_b64 s[64:65], s[92:93], s68
  s_and_b32 s68, s64, 15
  s_add_u32 s47, s68, 1
  ds_read_b32 v4, v14 offset:20
L_a0:
  s_waitcnt lgkmcnt(0)
  v_readfirstlane_b32 s46, v4
  s_cmp_ge_u32 s46, s47
  s_cbranch_scc1 L_a0_ok
  s_cmp_eq_u32 s94, 0
  s_cbranch_scc1 L_a0_ok
  s_sub_u32 s94, s94, 1
  ds_read_b32 v4, v14 offset:20
  s_branch L_a0
L_a0_ok:
  v_lshl_add_u32 v120, s68, 9, v116
  v_lshl_add_u32 v121, s68, 9, v117
  v_lshl_add_u32 v122, s68, 9, v118
  ds_read_b32 v112, v120 offset:37376
  ds_read_b32 v113, v121 offset:37376
  ds_read_b32 v114, v122 offset:37376
.p2align 6
L_v:
  s_cmp_eq_u32 s43, 8
  s_cselect_b32 s44, 6, 0
  s_sub_u32 s58, s58, s44
  s_add_u32 s45, s43, 1
  s_min_u32 s45, s45, 15
  s_lshl_b32 s68, s45, 2
  s_lshr_b64 s[64:65], s[92:93], s68
  s_and_b32 s68, s64, 15
  s_add_u32 s47, s68, 1
  v_lshl_add_u32 v120, s68, 9, v116
  v_lshl_add_u32 v121, s68, 9, v117
  v_lshl_add_u32 v122, s68, 9, v118
  s_waitcnt lgkmcnt(0)
  s_waitcnt vmcnt(8)
  s_add_u32 s44, s78, 0x03030303
  v_msad_u8 v9, s78, v32, 0
  v_msad_u8 v10, s44, v32, 0
  v_msad_u8 v9, s78, v33, v9
  v_msad_u8 v10, s44, v33, v10
  v_msad_u8 v9, s78, v34, v9
  v_msad_u8 v10, s44, v34, v10
  s_mov_b64 exec, 3
  global_store_byte v7, v8, s[30:31]
  global_load_dwordx3 v[32:34], v232, s[30:31] sc1
  v_sub_u32 v9, v9, v10
  v_add_u32 v8, 1, v8
  s_mov_b64 exec, -1
  v_readlane_b32 s66, v9, 0
  v_readlane_b32 s67, v9, 1
  s_add_u32 s78, s78, 0x01010101
  s_lshl1_add_u32 s69, s91, s95
  s_add_u32 s95, s66, s67
  s_add_u32 s69, s69, s95
  v_mov_b32_dpp v18, v112 row_newbcast:0 row_mask:0xf bank_mask:0xf
  v_cvt_f32_i32 v64, v64
  v_cvt_f32_i32 v65, v65
  v_cvt_f32_i32 v66, v66
  v_cvt_f32_i32 v67, v67
  v_pk_mul_f32 v[40:41], v[64:65], v[18:19] op_sel_hi:[1,0]
  v_pk_mul_f32 v[42:43], v[66:67], v[18:19] op_sel_hi:[1,0]
  s_cmpk_gt_i32 s69, 0x31
  s_cbranch_scc1 L_p89_4
  s_cmpk_gt_i32 s69, 0xffed
  s_cbranch_scc1 L_p89_1
  s_waitcnt vmcnt(5)
L_p89_1:
  s_waitcnt vmcnt(8)
L_p89_4:
  s_waitcnt vmcnt(9)
  buffer_load_dwordx4 v[100:103], v217, s[32:35], 0 offen nt
  v_mov_b32_dpp v18, v112 row_newbcast:4 row_mask:0xf bank_mask:0xf
  v_cvt_f32_i32 v68, v68
  v_cvt_f32_i32 v69, v69
  v_cvt_f32_i32 v70, v70
  v_cvt_f32_i32 v71, v71
  v_pk_mul_f32 v[48:49], v[68:69], v[18:19] op_sel_hi:[1,0]
  v_pk_mul_f32 v[50:51], v[70:71], v[18:19] op_sel_hi:[1,0]
  s_cmpk_gt_i32 s69, 0x31
  s_cbranch_scc1 L_p90_4
  s_cmpk_gt_i32 s69, 0xb
  s_cbranch_scc1 L_p90_2
  s_waitcnt vmcnt(6)
L_p90_2:
  s_waitcnt vmcnt(9)
L_p90_4:
  s_waitcnt vmcnt(10)
  buffer_load_dwordx4 v[104:107], v218, s[32:35], 0 offen nt
  v_mov_b32_dpp v18, v112 row_newbcast:1 row_mask:0xf bank_mask:0xf
  v_cvt_f32_i32 v72, v72
  v_cvt_f32_i32 v73, v73
  v_cvt_f32_i32 v74, v74
  v_cvt_f32_i32 v75, v75
  v_pk_mul_f32 v[44:45], v[72:73], v[18:19] op_sel_hi:[1,0]
  v_pk_mul_f32 v[46:47], v[74:75], v[18:19] op_sel_hi:[1,0]
  s_cmpk_gt_i32 s69, 0x31
  s_cbranch_scc1 L_p91_4
  s_cmpk_gt_i32 s69, 0x1d
  s_cbranch_scc1 L_p91_3
  s_cmpk_gt_i32 s69, 0xffcd
  s_cbranch_scc1 L_p91_0
  s_waitcnt vmcnt(6)
L_p91_0:
  s_waitcnt vmcnt(7)
L_p91_3:
  s_waitcnt vmcnt(10)
L_p91_4:
  s_waitcnt vmcnt(11)
  buffer_load_dwordx4 v[108:111], v219, s[32:35], 0 offen nt
  s_waitcnt vmcnt(8)
  s_add_u32 s44, s78, 0x03030303
  v_msad_u8 v9, s78, v36, 0
  v_msad_u8 v10, s44, v36, 0
  v_msad_u8 v9, s78, v37, v9
  v_msad_u8 v10, s44, v37, v10
  v_msad_u8 v9, s78, v38, v9
  v_msad_u8 v10, s44, v38, v10
  s_mov_b64 exec, 3
  global_store_byte v7, v8, s[30:31]
  global_load_dwordx3 v[36:38], v233, s[30:31] sc1
  v_sub_u32 v9, v9, v10
  v_add_u32 v8, 1, v8
  s_mov_b64 exec, -1
  v_readlane_b32 s66, v9, 0
  v_readlane_b32 s67, v9, 1
  s_add_u32 s78, s78, 0x01010101
  s_lshl1_add_u32 s69, s91, s95
  s_add_u32 s95, s66, s67
  s_add_u32 s69, s69, s95
  v_mov_b32_dpp v18, v112 row_newbcast:5 row_mask:0xf bank_mask:0xf
  v_cvt_f32_i32 v76, v76
  v_cvt_f32_i32 v77, v77
  v_cvt_f32_i32 v78, v78
  v_cvt_f32_i32 v79, v79
  v_pk_fma_f32 v[40:41], v[76:77], v[18:19], v[40:41] op_sel_hi:[1,0,1]
  v_pk_fma_f32 v[42:43], v[78:79], v[18:19], v[42:43] op_sel_hi:[1,0,1]
  s_cmpk_gt_i32 s69, 0x31
  s_cbranch_scc1 L_p92_4
  s_cmpk_gt_i32 s69, 0xffed
  s_cbranch_scc1 L_p92_1
  s_waitcnt vmcnt(5)
L_p92_1:
  s_waitcnt vmcnt(8)
L_p92_4:
  s_waitcnt vmcnt(9)
  buffer_load_dwordx4 v[64:67], v220, s[32:35], 0 offen nt
  v_mov_b32_dpp v18, v112 row_newbcast:2 row_mask:0xf bank_mask:0xf
  v_cvt_f32_i32 v80, v80
  v_cvt_f32_i32 v81, v81
  v_cvt_f32_i32 v82, v82
  v_cvt_f32_i32 v83, v83
  v_pk_mul_f32 v[56:57], v[80:81], v[18:19] op_sel_hi:[1,0]
  v_pk_mul_f32 v[58:59], v[82:83], v[18:19] op_sel_hi:[1,0]
  s_cmpk_gt_i32 s69, 0x31
  s_cbranch_scc1 L_p93_4
  s_cmpk_gt_i32 s69, 0xb
  s_cbranch_scc1 L_p93_2
  s_waitcnt vmcnt(6)
L_p93_2:
  s_waitcnt vmcnt(9)
L_p93_4:
  s_waitcnt vmcnt(10)
  buffer_load_dwordx4 v[68:71], v221, s[32:35], 0 offen nt
  v_mov_b32_dpp v18, v112 row_newbcast:6 row_mask:0xf bank_mask:0xf
  v_cvt_f32_i32 v84, v84
  v_cvt_f32_i32 v85, v85
  v_cvt_f32_i32 v86, v86
  v_cvt_f32_i32 v87, v87
  v_pk_mul_f32 v[52:53], v[84:85], v[18:19] op_sel_hi:[1,0]
  v_pk_mul_f32 v[54:55], v[86:87], v[18:19] op_sel_hi:[1,0]
  s_cmpk_gt_i32 s69, 0x31
  s_cbranch_scc1 L_p94_4
  s_cmpk_gt_i32 s69, 0x1d
  s_cbranch_scc1 L_p94_3
  s_cmpk_gt_i32 s69, 0xffcd
  s_cbranch_scc1 L_p94_0
  s_waitcnt vmcnt(6)
L_p94_0:
  s_waitcnt vmcnt(7)
L_p94_3:
  s_waitcnt vmcnt(10)
L_p94_4:
  s_waitcnt vmcnt(11)
  buffer_load_dwordx4 v[72:75], v222, s[32:35], 0 offen nt
  v_add_u32_e64 v9, s43, 16
  ds_write_b32 v14, v9 offset:28
  s_waitcnt vmcnt(8)
  s_add_u32 s44, s78, 0x03030303
  v_msad_u8 v9, s78, v32, 0
  v_msad_u8 v10, s44, v32, 0
  v_msad_u8 v9, s78, v33, v9
  v_msad_u8 v10, s44, v33, v10
  v_msad_u8 v9, s78, v34, v9
  v_msad_u8 v10, s44, v34, v10
  s_mov_b64 exec, 3
  global_store_byte v7, v8, s[30:31]
  global_load_dwordx3 v[32:34], v234, s[30:31] sc1
  v_sub_u32 v9, v9, v10
  v_add_u32 v8, 1, v8
  s_mov_b64 exec, -1
  v_readlane_b32 s66, v9, 0
  v_readlane_b32 s67, v9, 1
  s_add_u32 s78, s78, 0x01010101
  s_lshl1_add_u32 s69, s91, s95
  s_add_u32 s95, s66, s67
  s_add_u32 s69, s69, s95
  v_mov_b32_dpp v18, v112 row_newbcast:3 row_mask:0xf bank_mask:0xf
  v_cvt_f32_i32 v88, v88
  v_cvt_f32_i32 v89, v89
  v_cvt_f32_i32 v90, v90
  v_cvt_f32_i32 v91, v91
  v_pk_mul_f32 v[60:61], v[88:89], v[18:19] op_sel_hi:[1,0]
  v_pk_mul_f32 v[62:63], v[90:91], v[18:19] op_sel_hi:[1,0]
  s_cmpk_gt_i32 s69, 0x31
  s_cbranch_scc1 L_p95_4
  s_cmpk_gt_i32 s69, 0xffed
  s_cbranch_scc1 L_p95_1
  s_waitcnt vmcnt(5)
L_p95_1:
  s_waitcnt vmcnt(8)
L_p95_4:
  s_waitcnt vmcnt(9)
  buffer_load_dwordx4 v[76:79], v223, s[32:35], 0 offen nt
  v_mov_b32_dpp v18, v112 row_newbcast:7 row_mask:0xf bank_mask:0xf
  v_cvt_f32_i32 v92, v92
  v_cvt_f32_i32 v93, v93
  v_cvt_f32_i32 v94, v94
  v_cvt_f32_i32 v95, v95
  v_pk_fma_f32 v[56:57], v[92:93], v[18:19], v[56:57] op_sel_hi:[1,0,1]
  v_pk_fma_f32 v[58:59], v[94:95], v[18:19], v[58:59] op_sel_hi:[1,0,1]
  s_cmpk_gt_i32 s69, 0x31
  s_cbranch_scc1 L_p96_4
  s_cmpk_gt_i32 s69, 0xb
  s_cbranch_scc1 L_p96_2
  s_waitcnt vmcnt(6)
L_p96_2:
  s_waitcnt vmcnt(9)
L_p96_4:
  s_waitcnt vmcnt(10)
  buffer_load_dwordx4 v[80:83], v224, s[32:35], 0 offen nt
  v_mov_b32_dpp v18, v113 row_newbcast:0 row_mask:0xf bank_mask:0xf
  v_cvt_f32_i32 v96, v96
  v_cvt_f32_i32 v97, v97
  v_cvt_f32_i32 v98, v98
  v_cvt_f32_i32 v99, v99
  v_pk_fma_f32 v[44:45], v[96:97], v[18:19], v[44:45] op_sel_hi:[1,0,1]
  v_pk_fma_f32 v[46:47], v[98:99], v[18:19], v[46:47] op_sel_hi:[1,0,1]
  s_cmpk_gt_i32 s69, 0x31
  s_cbranch_scc1 L_p97_4
  s_cmpk_gt_i32 s69, 0x1d
  s_cbranch_scc1 L_p97_3
  s_cmpk_gt_i32 s69, 0xffcd
  s_cbranch_scc1 L_p97_0
  s_waitcnt vmcnt(6)
L_p97_0:
  s_waitcnt vmcnt(7)
L_p97_3:
  s_waitcnt vmcnt(10)
L_p97_4:
  s_waitcnt vmcnt(11)
  buffer_load_dwordx4 v[84:87], v225, s[32:35], 0 offen nt
  s_waitcnt vmcnt(8)
  s_add_u32 s44, s78, 0x03030303
  v_msad_u8 v9, s78, v36, 0
  v_msad_u8 v10, s44, v36, 0
  v_msad_u8 v9, s78, v37, v9
  v_msad_u8 v10, s44, v37, v10
  v_msad_u8 v9, s78, v38, v9
  v_msad_u8 v10, s44, v38, v10
  s_mov_b64 exec, 3
  global_store_byte v7, v8, s[30:31]
  global_load_dwordx3 v[36:38], v235, s[30:31] sc1
  v_sub_u32 v9, v9, v10
  v_add_u32 v8, 1, v8
  s_mov_b64 exec, -1
  v_readlane_b32 s66, v9, 0
  v_readlane_b32 s67, v9, 1
  s_add_u32 s78, s78, 0x01010101
  s_lshl1_add_u32 s69, s91, s95
  s_add_u32 s95, s66, s67
  s_add_u32 s69, s69, s95
  v_mov_b32_dpp v18, v113 row_newbcast:4 row_mask:0xf bank_mask:0xf
  v_cvt_f32_i32 v100, v100
  v_cvt_f32_i32 v101, v101
  v_cvt_f32_i32 v102, v102
  v_cvt_f32_i32 v103, v103
  v_pk_fma_f32 v[40:41], v[100:101], v[18:19], v[40:41] op_sel_hi:[1,0,1]
  v_pk_fma_f32 v[42:43], v[102:103], v[18:19], v[42:43] op_sel_hi:[1,0,1]
  s_cmpk_gt_i32 s69, 0x31
  s_cbranch_scc1 L_p98_4
  s_cmpk_gt_i32 s69, 0xffed
  s_cbranch_scc1 L_p98_1
  s_waitcnt vmcnt(5)
L_p98_1:
  s_waitcnt vmcnt(8)
L_p98_4:
  s_waitcnt vmcnt(9)
  buffer_load_dwordx4 v[88:91], v226, s[32:35], 0 offen nt
  v_mov_b32_dpp v18, v113 row_newbcast:1 row_mask:0xf bank_mask:0xf
  v_cvt_f32_i32 v104, v104
  v_cvt_f32_i32 v105, v105
  v_cvt_f32_i32 v106, v106
  v_cvt_f32_i32 v107, v107
  v_pk_fma_f32 v[48:49], v[104:105], v[18:19], v[48:49] op_sel_hi:[1,0,1]
  v_pk_fma_f32 v[50:51], v[106:107], v[18:19], v[50:51] op_sel_hi:[1,0,1]
  s_cmpk_gt_i32 s69, 0x31
  s_cbranch_scc1 L_p99_4
  s_cmpk_gt_i32 s69, 0xb
  s_cbranch_scc1 L_p99_2
  s_waitcnt vmcnt(6)
L_p99_2:
  s_waitcnt vmcnt(9)
L_p99_4:
  s_waitcnt vmcnt(10)
  buffer_load_dwordx4 v[92:95], v227, s[32:35], 0 offen nt
  v_mov_b32_dpp v18, v113 row_newbcast:5 row_mask:0xf bank_mask:0xf
  v_cvt_f32_i32 v108, v108
  v_cvt_f32_i32 v109, v109
  v_cvt_f32_i32 v110, v110
  v_cvt_f32_i32 v111, v111
  v_pk_fma_f32 v[44:45], v[108:109], v[18:19], v[44:45] op_sel_hi:[1,0,1]
  v_pk_fma_f32 v[46:47], v[110:111], v[18:19], v[46:47] op_sel_hi:[1,0,1]
  s_cmpk_gt_i32 s69, 0x31
  s_cbranch_scc1 L_p100_4
  s_cmpk_gt_i32 s69, 0x1d
  s_cbranch_scc1 L_p100_3
  s_cmpk_gt_i32 s69, 0xffcd
  s_cbranch_scc1 L_p100_0
  s_waitcnt vmcnt(6)
L_p100_0:
  s_waitcnt vmcnt(7)
L_p100_3:
  s_waitcnt vmcnt(10)
L_p100_4:
  s_waitcnt vmcnt(11)
  buffer_load_dwordx4 v[96:99], v228, s[32:35], 0 offen nt
  s_waitcnt vmcnt(8)
  s_add_u32 s44, s78, 0x03030303
  v_msad_u8 v9, s78, v32, 0
  v_msad_u8 v10, s44, v32, 0
  v_msad_u8 v9, s78, v33, v9
  v_msad_u8 v10, s44, v33, v10
  v_msad_u8 v9, s78, v34, v9
  v_msad_u8 v10, s44, v34, v10
  s_mov_b64 exec, 3
  global_store_byte v7, v8, s[30:31]
  global_load_dwordx3 v[32:34], v232, s[30:31] sc1
  v_sub_u32 v9, v9, v10
  v_add_u32 v8, 1, v8
  s_mov_b64 exec, -1
  v_readlane_b32 s66, v9, 0
  v_readlane_b32 s67, v9, 1
  s_add_u32 s78, s78, 0x01010101
  s_lshl1_add_u32 s69, s91, s95
  s_add_u32 s95, s66, s67
  s_add_u32 s69, s69, s95
  v_mov_b32_dpp v18, v113 row_newbcast:2 row_mask:0xf bank_mask:0xf
  v_cvt_f32_i32 v64, v64
  v_cvt_f32_i32 v65, v65
  v_cvt_f32_i32 v66, v66
  v_cvt_f32_i32 v67, v67
  v_pk_fma_f32 v[60:61], v[64:65], v[18:19], v[60:61] op_sel_hi:[1,0,1]
  v_pk_fma_f32 v[62:63], v[66:67], v[18:19], v[62:63] op_sel_hi:[1,0,1]
  s_cmpk_gt_i32 s69, 0x31
  s_cbranch_scc1 L_p101_4
  s_cmpk_gt_i32 s69, 0xffed
  s_cbranch_scc1 L_p101_1
  s_waitcnt vmcnt(5)
L_p101_1:
  s_waitcnt vmcnt(8)
L_p101_4:
  s_waitcnt vmcnt(9)
  buffer_load_dwordx4 v[100:103], v229, s[32:35], 0 offen nt
  v_mov_b32_dpp v18, v113 row_newbcast:6 row_mask:0xf bank_mask:0xf
  v_cvt_f32_i32 v68, v68
  v_cvt_f32_i32 v69, v69
  v_cvt_f32_i32 v70, v70
  v_cvt_f32_i32 v71, v71
  v_pk_fma_f32 v[56:57], v[68:69], v[18:19], v[56:57] op_sel_hi:[1,0,1]
  v_pk_fma_f32 v[58:59], v[70:71], v[18:19], v[58:59] op_sel_hi:[1,0,1]
  s_cmpk_gt_i32 s69, 0x31
  s_cbranch_scc1 L_p102_4
  s_cmpk_gt_i32 s69, 0xb
  s_cbranch_scc1 L_p102_2
  s_waitcnt vmcnt(6)
L_p102_2:
  s_waitcnt vmcnt(9)
L_p102_4:
  s_waitcnt vmcnt(10)
  buffer_load_dwordx4 v[104:107], v230, s[32:35], 0 offen nt
  v_mov_b32_dpp v18, v113 row_newbcast:3 row_mask:0xf bank_mask:0xf
  v_cvt_f32_i32 v72, v72
  v_cvt_f32_i32 v73, v73
  v_cvt_f32_i32 v74, v74
  v_cvt_f32_i32 v75, v75
  v_pk_fma_f32 v[52:53], v[72:73], v[18:19], v[52:53] op_sel_hi:[1,0,1]
  v_pk_fma_f32 v[54:55], v[74:75], v[18:19], v[54:55] op_sel_hi:[1,0,1]
  s_cmpk_gt_i32 s69, 0x31
  s_cbranch_scc1 L_p103_4
  s_cmpk_gt_i32 s69, 0x1d
  s_cbranch_scc1 L_p103_3
  s_cmpk_gt_i32 s69, 0xffcd
  s_cbranch_scc1 L_p103_0
  s_waitcnt vmcnt(6)
L_p103_0:
  s_waitcnt vmcnt(7)
L_p103_3:
  s_waitcnt vmcnt(10)
L_p103_4:
  s_waitcnt vmcnt(11)
  buffer_load_dwordx4 v[108:111], v231, s[32:35], 0 offen nt
  s_cbranch_vccnz L_vtail
  ds_read_b32 v4, v14 offset:20
  s_waitcnt vmcnt(8)
  s_add_u32 s44, s78, 0x03030303
  v_msad_u8 v9, s78, v36, 0
  v_msad_u8 v10, s44, v36, 0
  v_msad_u8 v9, s78, v37, v9
  v_msad_u8 v10, s44, v37, v10
  v_msad_u8 v9, s78, v38, v9
  v_msad_u8 v10, s44, v38, v10
  s_mov_b64 exec, 3
  global_load_dwordx2 v[26:27], v11, s[30:31] sc1
  global_store_byte v7, v8, s[30:31]
  global_load_dwordx3 v[36:38], v233, s[30:31] sc1
  v_sub_u32 v9, v9, v10
  v_add_u32 v8, 1, v8
  s_mov_b64 exec, -1
  v_readlane_b32 s66, v9, 0
  v_readlane_b32 s67, v9, 1
  s_add_u32 s78, s78, 0x01010101
  s_lshl1_add_u32 s69, s91, s95
  s_add_u32 s95, s66, s67
  s_add_u32 s69, s69, s95
  v_mov_b32_dpp v18, v113 row_newbcast:7 row_mask:0xf bank_mask:0xf
  v_cvt_f32_i32 v76, v76
  v_cvt_f32_i32 v77, v77
  v_cvt_f32_i32 v78, v78
  v_cvt_f32_i32 v79, v79
  v_pk_fma_f32 v[60:61], v[76:77], v[18:19], v[60:61] op_sel_hi:[1,0,1]
  v_pk_fma_f32 v[62:63], v[78:79], v[18:19], v[62:63] op_sel_hi:[1,0,1]
  s_cmpk_gt_i32 s69, 0x31
  s_cbranch_scc1 L_p104_4
  s_cmpk_gt_i32 s69, 0xffed
  s_cbranch_scc1 L_p104_1
  s_waitcnt vmcnt(6)
L_p104_1:
  s_waitcnt vmcnt(9)
L_p104_4:
  s_waitcnt vmcnt(10)
  buffer_load_dwordx4 v[64:67], v208, s[36:39], 0 offen nt
  v_mov_b32_dpp v18, v114 row_newbcast:0 row_mask:0xf bank_mask:0xf
  v_cvt_f32_i32 v80, v80
  v_cvt_f32_i32 v81, v81
  v_cvt_f32_i32 v82, v82
  v_cvt_f32_i32 v83, v83
  v_pk_fma_f32 v[48:49], v[80:81], v[18:19], v[48:49] op_sel_hi:[1,0,1]
  v_pk_fma_f32 v[50:51], v[82:83], v[18:19], v[50:51] op_sel_hi:[1,0,1]
  s_cmpk_gt_i32 s69, 0x31
  s_cbranch_scc1 L_p105_4
  s_cmpk_gt_i32 s69, 0xb
  s_cbranch_scc1 L_p105_2
  s_waitcnt vmcnt(7)
L_p105_2:
  s_waitcnt vmcnt(10)
L_p105_4:
  s_waitcnt vmcnt(11)
  buffer_load_dwordx4 v[68:71], v209, s[36:39], 0 offen nt
  v_mov_b32_dpp v18, v114 row_newbcast:4 row_mask:0xf bank_mask:0xf
  v_cvt_f32_i32 v84, v84
  v_cvt_f32_i32 v85, v85
  v_cvt_f32_i32 v86, v86
  v_cvt_f32_i32 v87, v87
  v_pk_fma_f32 v[44:45], v[84:85], v[18:19], v[44:45] op_sel_hi:[1,0,1]
  v_pk_fma_f32 v[46:47], v[86:87], v[18:19], v[46:47] op_sel_hi:[1,0,1]
  s_cmpk_gt_i32 s69, 0x31
  s_cbranch_scc1 L_p106_4
  s_cmpk_gt_i32 s69, 0x1d
  s_cbranch_scc1 L_p106_3
  s_cmpk_gt_i32 s69, 0xffcd
  s_cbranch_scc1 L_p106_0
  s_waitcnt vmcnt(7)
L_p106_0:
  s_waitcnt vmcnt(8)
L_p106_3:
  s_waitcnt vmcnt(11)
L_p106_4:
  s_waitcnt vmcnt(12)
  buffer_load_dwordx4 v[72:75], v210, s[36:39], 0 offen nt
L_an:
  s_waitcnt lgkmcnt(0)
  v_readfirstlane_b32 s46, v4
  s_cmp_ge_u32 s46, s47
  s_cbranch_scc1 L_an_ok
  s_cmp_eq_u32 s94, 0
  s_cbranch_scc1 L_an_ok
  s_sub_u32 s94, s94, 1
  ds_read_b32 v4, v14 offset:20
  s_branch L_an
L_an_ok:
  ds_read_b32 v112, v120 offset:37376
  ds_read_b32 v113, v121 offset:37376
  ds_read_b32 v115, v122 offset:37376
  s_waitcnt vmcnt(9)
  s_add_u32 s44, s78, 0x03030303
  v_msad_u8 v9, s78, v32, 0
  v_msad_u8 v10, s44, v32, 0
  v_msad_u8 v9, s78, v33, v9
  v_msad_u8 v10, s44, v33, v10
  v_msad_u8 v9, s78, v34, v9
  v_msad_u8 v10, s44, v34, v10
  s_mov_b64 exec, 3
  global_store_byte v7, v8, s[30:31]
  global_load_dwordx3 v[32:34], v234, s[30:31] sc1
  v_sub_u32 v9, v9, v10
  v_add_u32 v8, 1, v8
  s_mov_b64 exec, -1
  v_readlane_b32 s66, v9, 0
  v_readlane_b32 s67, v9, 1
  s_add_u32 s78, s78, 0x01010101
  s_lshl1_add_u32 s69, s91, s95
  s_add_u32 s95, s66, s67
  s_add_u32 s69, s69, s95
  v_mov_b32_dpp v18, v114 row_newbcast:1 row_mask:0xf bank_mask:0xf
  v_cvt_f32_i32 v88, v88
  v_cvt_f32_i32 v89, v89
  v_cvt_f32_i32 v90, v90
  v_cvt_f32_i32 v91, v91
  v_pk_fma_f32 v[40:41], v[88:89], v[18:19], v[40:41] op_sel_hi:[1,0,1]
  v_pk_fma_f32 v[42:43], v[90:91], v[18:19], v[42:43] op_sel_hi:[1,0,1]
  s_cmpk_gt_i32 s69, 0x31
  s_cbranch_scc1 L_p107_4
  s_cmpk_gt_i32 s69, 0xffed
  s_cbranch_scc1 L_p107_1
  s_waitcnt vmcnt(5)
L_p107_1:
  s_waitcnt vmcnt(9)
L_p107_4:
  s_waitcnt vmcnt(10)
  buffer_load_dwordx4 v[76:79], v211, s[36:39], 0 offen nt
  v_mov_b32_dpp v18, v114 row_newbcast:5 row_mask:0xf bank_mask:0xf
  v_cvt_f32_i32 v92, v92
  v_cvt_f32_i32 v93, v93
  v_cvt_f32_i32 v94, v94
  v_cvt_f32_i32 v95, v95
  v_pk_fma_f32 v[48:49], v[92:93], v[18:19], v[48:49] op_sel_hi:[1,0,1]
  v_pk_fma_f32 v[50:51], v[94:95], v[18:19], v[50:51] op_sel_hi:[1,0,1]
  s_cmpk_gt_i32 s69, 0x31
  s_cbranch_scc1 L_p108_4
  s_cmpk_gt_i32 s69, 0xb
  s_cbranch_scc1 L_p108_2
  s_waitcnt vmcnt(6)
L_p108_2:
  s_waitcnt vmcnt(10)
L_p108_4:
  s_waitcnt vmcnt(11)
  buffer_load_dwordx4 v[80:83], v212, s[36:39], 0 offen nt
  v_mov_b32_dpp v18, v114 row_newbcast:2 row_mask:0xf bank_mask:0xf
  v_cvt_f32_i32 v96, v96
  v_cvt_f32_i32 v97, v97
  v_cvt_f32_i32 v98, v98
  v_cvt_f32_i32 v99, v99
  v_pk_fma_f32 v[52:53], v[96:97], v[18:19], v[52:53] op_sel_hi:[1,0,1]
  v_pk_fma_f32 v[54:55], v[98:99], v[18:19], v[54:55] op_sel_hi:[1,0,1]
  s_cmpk_gt_i32 s69, 0x31
  s_cbranch_scc1 L_p109_4
  s_cmpk_gt_i32 s69, 0x1d
  s_cbranch_scc1 L_p109_3
  s_cmpk_gt_i32 s69, 0xffcd
  s_cbranch_scc1 L_p109_0
  s_waitcnt vmcnt(6)
L_p109_0:
  s_waitcnt vmcnt(7)
L_p109_3:
  s_waitcnt vmcnt(11)
L_p109_4:
  s_waitcnt vmcnt(12)
  buffer_load_dwordx4 v[84:87], v213, s[36:39], 0 offen nt
  s_cmp_eq_u32 s62, 0
  s_cbranch_scc1 L_flv
  v_pk_add_f32 v[52:53], v[52:53], v[44:45]
  v_pk_add_f32 v[54:55], v[54:55], v[46:47]
  v_pk_add_f32 v[56:57], v[56:57], v[48:49]
  v_pk_add_f32 v[58:59], v[58:59], v[50:51]
  v_pk_add_f32 v[60:61], v[60:61], v[40:41]
  v_pk_add_f32 v[62:63], v[62:63], v[42:43]
  s_branch L_fmv
L_flv:
  v_pk_add_f32 v[52:53], v[52:53], v[40:41]
  v_pk_add_f32 v[54:55], v[54:55], v[42:43]
  v_pk_add_f32 v[56:57], v[56:57], v[44:45]
  v_pk_add_f32 v[58:59], v[58:59], v[46:47]
  v_pk_add_f32 v[60:61], v[60:61], v[48:49]
  v_pk_add_f32 v[62:63], v[62:63], v[50:51]
L_fmv:
  v_add_u32_e64 v9, s43, 16
  ds_write_b32 v14, v9 offset:24
  s_waitcnt vmcnt(8)
  s_add_u32 s44, s78, 0x03030303
  v_msad_u8 v9, s78, v36, 0
  v_msad_u8 v10, s44, v36, 0
  v_msad_u8 v9, s78, v37, v9
  v_msad_u8 v10, s44, v37, v10
  v_msad_u8 v9, s78, v38, v9
  v_msad_u8 v10, s44, v38, v10
  s_mov_b64 exec, 3
  global_store_byte v7, v8, s[30:31]
  global_load_dwordx3 v[36:38], v235, s[30:31] sc1
  v_sub_u32 v9, v9, v10
  v_add3_u32 v10, v26, v27, s58
  v_add_u32 v8, 1, v8
  s_mov_b64 exec, -1
  v_readlane_b32 s66, v9, 0
  v_readlane_b32 s67, v9, 1
  v_readlane_b32 s91, v10, 0
  s_add_u32 s78, s78, 0x01010101
  s_lshl1_add_u32 s69, s91, s95
  s_add_u32 s95, s66, s67
  s_add_u32 s69, s69, s95
  v_mov_b32_dpp v18, v114 row_newbcast:6 row_mask:0xf bank_mask:0xf
  v_cvt_f32_i32 v100, v100
  v_cvt_f32_i32 v101, v101
  v_cvt_f32_i32 v102, v102
  v_cvt_f32_i32 v103, v103
  v_pk_fma_f32 v[60:61], v[100:101], v[18:19], v[60:61] op_sel_hi:[1,0,1]
  v_pk_fma_f32 v[62:63], v[102:103], v[18:19], v[62:63] op_sel_hi:[1,0,1]
  s_cmpk_gt_i32 s69, 0x31
  s_cbranch_scc1 L_p110_4
  s_cmpk_gt_i32 s69, 0xffed
  s_cbranch_scc1 L_p110_1
  s_waitcnt vmcnt(5)
L_p110_1:
  s_waitcnt vmcnt(8)
L_p110_4:
  s_waitcnt vmcnt(9)
  buffer_load_dwordx4 v[88:91], v214, s[36:39], 0 offen nt
  v_mov_b32_dpp v18, v114 row_newbcast:3 row_mask:0xf bank_mask:0xf
  v_cvt_f32_i32 v104, v104
  v_cvt_f32_i32 v105, v105
  v_cvt_f32_i32 v106, v106
  v_cvt_f32_i32 v107, v107
  v_pk_fma_f32 v[56:57], v[104:105], v[18:19], v[56:57] op_sel_hi:[1,0,1]
  v_pk_fma_f32 v[58:59], v[106:107], v[18:19], v[58:59] op_sel_hi:[1,0,1]
  s_cmpk_gt_i32 s69, 0x31
  s_cbranch_scc1 L_p111_4
  s_cmpk_gt_i32 s69, 0xb
  s_cbranch_scc1 L_p111_2
  s_waitcnt vmcnt(6)
L_p111_2:
  s_waitcnt vmcnt(9)
L_p111_4:
  s_waitcnt vmcnt(10)
  buffer_load_dwordx4 v[92:95], v215, s[36:39], 0 offen nt
  v_mov_b32_dpp v18, v114 row_newbcast:7 row_mask:0xf bank_mask:0xf
  v_cvt_f32_i32 v108, v108
  v_cvt_f32_i32 v109, v109
  v_cvt_f32_i32 v110, v110
  v_cvt_f32_i32 v111, v111
  v_pk_fma_f32 v[52:53], v[108:109], v[18:19], v[52:53] op_sel_hi:[1,0,1]
  v_pk_fma_f32 v[54:55], v[110:111], v[18:19], v[54:55] op_sel_hi:[1,0,1]
  s_cmpk_gt_i32 s69, 0x31
  s_cbranch_scc1 L_p112_4
  s_cmpk_gt_i32 s69, 0x1d
  s_cbranch_scc1 L_p112_3
  s_cmpk_gt_i32 s69, 0xffcd
  s_cbranch_scc1 L_p112_0
  s_waitcnt vmcnt(6)
L_p112_0:
  s_waitcnt vmcnt(7)
L_p112_3:
  s_waitcnt vmcnt(10)
L_p112_4:
  s_waitcnt vmcnt(11)
  buffer_load_dwordx4 v[96:99], v216, s[36:39], 0 offen nt
  s_add_u32 s43, s43, 1
  v_permlane32_swap_b32 v52, v54
  v_permlane32_swap_b32 v53, v55
  v_permlane32_swap_b32 v56, v58
  v_permlane32_swap_b32 v57, v59
  v_permlane32_swap_b32 v60, v62
  v_permlane32_swap_b32 v61, v63
  v_add_f32 v52, v52, v58
  v_add_f32 v53, v53, v59
  v_add_f32 v56, v56, v62
  v_add_f32 v57, v57, v63
  v_add_f32 v60, v60, v54
  v_add_f32 v61, v61, v55
  s_add_u32 s44, s43, 16
  s_cmp_eq_u32 s43, 15
  s_cselect_b64 vcc, -1, 0
  v_mov_b32 v4, s44
  v_permlane16_swap_b32 v52, v53
  v_permlane16_swap_b32 v56, v57
  v_permlane16_swap_b32 v60, v61
  v_add_f32 v52, v52, v61
  v_add_f32 v56, v56, v53
  v_add_f32 v60, v60, v57
  s_waitcnt lgkmcnt(0)
  ds_write_b32 v3, v52 offset:0
  ds_write_b32 v3, v56 offset:256
  ds_write_b32 v3, v60 offset:512
  ds_write_b32 v6, v4 offset:0
  v_mov_b32 v114, v115
  v_add_u32 v3, 3072, v3
  s_mov_b64 s[32:33], s[36:37]
  s_add_u32 s45, s43, 1
  s_min_u32 s45, s45, 15
  s_lshl_b32 s68, s45, 2
  s_lshr_b64 s[64:65], s[92:93], s68
  s_and_b32 s68, s64, 15
  s_lshl_b32 s44, s68, 2
  s_lshr_b64 s[64:65], s[96:97], s44
  s_and_b32 s64, s64, 15
  s_lshl4_add_u32 s68, s68, s64
  s_mul_i32 s44, s68, 1572864
  s_add_u32 s36, s12, s44
  s_addc_u32 s37, s13, 0
  s_branch L_v
L_vtail:
  s_waitcnt vmcnt(10)
  v_mov_b32_dpp v18, v113 row_newbcast:7 row_mask:0xf bank_mask:0xf
  v_cvt_f32_i32 v76, v76
  v_cvt_f32_i32 v77, v77
  v_cvt_f32_i32 v78, v78
  v_cvt_f32_i32 v79, v79
  v_pk_fma_f32 v[60:61], v[76:77], v[18:19], v[60:61] op_sel_hi:[1,0,1]
  v_pk_fma_f32 v[62:63], v[78:79], v[18:19], v[62:63] op_sel_hi:[1,0,1]
  s_waitcnt vmcnt(9)
  v_mov_b32_dpp v18, v114 row_newbcast:0 row_mask:0xf bank_mask:0xf
  v_cvt_f32_i32 v80, v80
  v_cvt_f32_i32 v81, v81
  v_cvt_f32_i32 v82, v82
  v_cvt_f32_i32 v83, v83
  v_pk_fma_f32 v[48:49], v[80:81], v[18:19], v[48:49] op_sel_hi:[1,0,1]
  v_pk_fma_f32 v[50:51], v[82:83], v[18:19], v[50:51] op_sel_hi:[1,0,1]
  s_waitcnt vmcnt(8)
  v_mov_b32_dpp v18, v114 row_newbcast:4 row_mask:0xf bank_mask:0xf
  v_cvt_f32_i32 v84, v84
  v_cvt_f32_i32 v85, v85
  v_cvt_f32_i32 v86, v86
  v_cvt_f32_i32 v87, v87
  v_pk_fma_f32 v[44:45], v[84:85], v[18:19], v[44:45] op_sel_hi:[1,0,1]
  v_pk_fma_f32 v[46:47], v[86:87], v[18:19], v[46:47] op_sel_hi:[1,0,1]
  s_waitcnt vmcnt(6)
  v_mov_b32_dpp v18, v114 row_newbcast:1 row_mask:0xf bank_mask:0xf
  v_cvt_f32_i32 v88, v88
  v_cvt_f32_i32 v89, v89
  v_cvt_f32_i32 v90, v90
  v_cvt_f32_i32 v91, v91
  v_pk_fma_f32 v[40:41], v[88:89], v[18:19], v[40:41] op_sel_hi:[1,0,1]
  v_pk_fma_f32 v[42:43], v[90:91], v[18:19], v[42:43] op_sel_hi:[1,0,1]
  s_waitcnt vmcnt(5)
  v_mov_b32_dpp v18, v114 row_newbcast:5 row_mask:0xf bank_mask:0xf
  v_cvt_f32_i32 v92, v92
  v_cvt_f32_i32 v93, v93
  v_cvt_f32_i32 v94, v94
  v_cvt_f32_i32 v95, v95
  v_pk_fma_f32 v[48:49], v[92:93], v[18:19], v[48:49] op_sel_hi:[1,0,1]
  v_pk_fma_f32 v[50:51], v[94:95], v[18:19], v[50:51] op_sel_hi:[1,0,1]
  s_cmp_eq_u32 s62, 0
  s_cbranch_scc1 L_flt
  v_pk_add_f32 v[52:53], v[52:53], v[44:45]
  v_pk_add_f32 v[54:55], v[54:55], v[46:47]
  v_pk_add_f32 v[56:57], v[56:57], v[48:49]
  v_pk_add_f32 v[58:59], v[58:59], v[50:51]
  v_pk_add_f32 v[60:61], v[60:61], v[40:41]
  v_pk_add_f32 v[62:63], v[62:63], v[42:43]
  s_branch L_fmt
L_flt:
  v_pk_add_f32 v[52:53], v[52:53], v[40:41]
  v_pk_add_f32 v[54:55], v[54:55], v[42:43]
  v_pk_add_f32 v[56:57], v[56:57], v[44:45]
  v_pk_add_f32 v[58:59], v[58:59], v[46:47]
  v_pk_add_f32 v[60:61], v[60:61], v[48:49]
  v_pk_add_f32 v[62:63], v[62:63], v[50:51]
L_fmt:
  s_waitcnt vmcnt(4)
  v_mov_b32_dpp v18, v114 row_newbcast:2 row_mask:0xf bank_mask:0xf
  v_cvt_f32_i32 v96, v96
  v_cvt_f32_i32 v97, v97
  v_cvt_f32_i32 v98, v98
  v_cvt_f32_i32 v99, v99
  v_pk_fma_f32 v[52:53], v[96:97], v[18:19], v[52:53] op_sel_hi:[1,0,1]
  v_pk_fma_f32 v[54:55], v[98:99], v[18:19], v[54:55] op_sel_hi:[1,0,1]
  s_waitcnt vmcnt(2)
  v_mov_b32_dpp v18, v114 row_newbcast:6 row_mask:0xf bank_mask:0xf
  v_cvt_f32_i32 v100, v100
  v_cvt_f32_i32 v101, v101
  v_cvt_f32_i32 v102, v102
  v_cvt_f32_i32 v103, v103
  v_pk_fma_f32 v[60:61], v[100:101], v[18:19], v[60:61] op_sel_hi:[1,0,1]
  v_pk_fma_f32 v[62:63], v[102:103], v[18:19], v[62:63] op_sel_hi:[1,0,1]
  s_waitcnt vmcnt(1)
  v_mov_b32_dpp v18, v114 row_newbcast:3 row_mask:0xf bank_mask:0xf
  v_cvt_f32_i32 v104, v104
  v_cvt_f32_i32 v105, v105
  v_cvt_f32_i32 v106, v106
  v_cvt_f32_i32 v107, v107
  v_pk_fma_f32 v[56:57], v[104:105], v[18:19], v[56:57] op_sel_hi:[1,0,1]
  v_pk_fma_f32 v[58:59], v[106:107], v[18:19], v[58:59] op_sel_hi:[1,0,1]
  v_permlane32_swap_b32 v60, v62
  v_permlane32_swap_b32 v61, v63
  v_permlane32_swap_b32 v56, v58
  v_permlane32_swap_b32 v57, v59
  v_add_f32 v56, v56, v62
  v_add_f32 v57, v57, v63
  s_waitcnt vmcnt(0)
  v_mov_b32_dpp v18, v114 row_newbcast:7 row_mask:0xf bank_mask:0xf
  v_cvt_f32_i32 v108, v108
  v_cvt_f32_i32 v109, v109
  v_cvt_f32_i32 v110, v110
  v_cvt_f32_i32 v111, v111
  v_pk_fma_f32 v[52:53], v[108:109], v[18:19], v[52:53] op_sel_hi:[1,0,1]
  v_pk_fma_f32 v[54:55], v[110:111], v[18:19], v[54:55] op_sel_hi:[1,0,1]
  v_permlane16_swap_b32 v56, v57
  s_nop 0
  v_permlane32_swap_b32 v52, v54
  v_permlane32_swap_b32 v53, v55
  v_add_f32 v60, v60, v54
  v_add_f32 v61, v61, v55
  v_add_f32 v52, v52, v58
  v_add_f32 v53, v53, v59
  v_permlane16_swap_b32 v60, v61
  v_add_f32 v60, v60, v57
  v_permlane16_swap_b32 v52, v53
  ds_write_b32 v3, v60 offset:512
  v_add_f32 v56, v56, v53
  v_add_f32 v52, v52, v61
  ds_write_b32 v3, v56 offset:256
  ds_write_b32 v3, v52 offset:0
  s_waitcnt lgkmcnt(0)
  s_barrier
  s_endpgm
L_helper:
  s_getreg_b32 s81, hwreg(HW_REG_HW_ID, 13, 2)
  s_getreg_b32 s79, hwreg(HW_REG_HW_ID, 8, 4)
  s_getreg_b32 s46, hwreg(HW_REG_XCC_ID, 0, 3)
  s_mul_i32 s46, s46, 4352
  s_add_u32 s46, s46, 8126464
  v_lshrrev_b32 v24, 1, v20
  v_lshl_add_u32 v42, v24, 8, s46
  v_and_b32 v24, 1, v20
  v_lshl_add_u32 v42, v24, 4, v42
  s_mov_b64 exec, 0x3ffff
  global_store_dwordx4 v42, v[48:51], s[30:31]
  s_mov_b64 exec, -1
  s_mov_b32 s43, 2
  s_add_u32 s68, s42, 48
  s_mul_i32 s44, s68, 384
  s_add_u32 s32, s4, s44
  s_addc_u32 s33, s5, 0
  global_load_dwordx2 v[68:69], v26, s[32:33]
  global_load_dwordx2 v[70:71], v27, s[32:33]
  s_setprio 0
  s_getpc_b64 s[82:83]
L_pc113:
  s_lshl_b32 s44, s2, 6
  s_add_u32 s44, s44, L_order-L_pc113
  s_add_u32 s82, s82, s44
  s_addc_u32 s83, s83, 0
  s_load_dwordx2 s[92:93], s[82:83], 0
  s_load_dwordx2 s[96:97], s[82:83], 8
  s_mov_b32 s94, 4000000
  s_and_b32 s41, s2, 7
  s_lshl_b32 s41, s41, 1
  s_bitcmp1_b32 s2, 3
  s_addc_u32 s41, s41, 0
  s_load_dword s3, s[82:83], 24
  s_load_dwordx2 s[98:99], s[82:83], 16
  s_waitcnt vmcnt(0)
  ds_write_b32 v14, v38 offset:24
  s_waitcnt lgkmcnt(0)
  v_min_u32 v22, 2, v20
  v_lshlrev_b32 v23, 3, v22
  v_bfe_u32 v23, s99, v23, 8
  v_mul_u32_u24 v36, 4352, v23
  v_add_u32 v36, 7340032, v36
  v_and_b32 v23, 15, v23
  v_lshlrev_b32 v37, 4, v23
  v_lshl_add_u32 v22, v22, 4, s42
  v_mul_u32_u24 v45, 4352, v22
  v_add_u32 v45, 7340032, v45
  s_and_b32 s45, s81, 2
  s_lshl_b32 s44, s45, 9
  s_add_u32 s44, s44, s46
  v_add_u32 v44, s44, v20
  s_lshl_b32 s45, s45, 1
  s_add_u32 s46, s46, s45
  s_add_u32 s46, s46, 2048
  v_mov_b32 v43, s46
  v_mul_u32_u24 v39, 384, v20
  v_add_u32 v39, 7864320, v39
  v_mov_b32 v40, 0
  s_mov_b32 s47, 0
  s_mov_b32 s90, 0
  s_mov_b32 s80, 0
  v_add_u32 v33, 0, v20
  s_and_b32 s44, s41, 1
  v_add_u32 v23, s44, v33
  v_cmp_le_u32 vcc, 43, v23
  s_add_u32 s45, s44, 42
  v_mov_b32 v24, s45
  v_cndmask_b32 v24, 0, v24, vcc
  v_cmp_le_u32 vcc, 86, v23
  v_add_u32 v22, v33, v24
  s_sub_u32 s45, 43, s44
  v_mov_b32 v24, s45
  v_cndmask_b32 v24, 0, v24, vcc
  s_mul_i32 s44, s44, 43
  s_lshr_b32 s45, s41, 1
  s_lshl_b32 s45, s45, 8
  s_add_u32 s44, s44, s45
  v_add3_u32 v22, v22, v24, s44
  v_and_b32 v33, 255, v22
  v_lshlrev_b32 v33, 1, v33
  v_add_u32 v34, 64, v20
  s_and_b32 s44, s41, 1
  v_add_u32 v23, s44, v34
  v_cmp_le_u32 vcc, 43, v23
  s_add_u32 s45, s44, 42
  v_mov_b32 v24, s45
  v_cndmask_b32 v24, 0, v24, vcc
  v_cmp_le_u32 vcc, 86, v23
  v_add_u32 v22, v34, v24
  s_sub_u32 s45, 43, s44
  v_mov_b32 v24, s45
  v_cndmask_b32 v24, 0, v24, vcc
  s_mul_i32 s44, s44, 43
  s_lshr_b32 s45, s41, 1
  s_lshl_b32 s45, s45, 8
  s_add_u32 s44, s44, s45
  v_add3_u32 v22, v22, v24, s44
  v_and_b32 v34, 255, v22
  v_lshlrev_b32 v34, 1, v34
  v_lshlrev_b32 v46, 2, v20
  v_mul_u32_u24 v199, 12, v20
  v_add_u32 v199, 45568, v199
  s_mov_b32 s101, 0
  v_mov_b32 v47, 118912
  v_mov_b32 v51, -1
  v_mov_b32 v60, 0
  v_mov_b32 v61, 0
  v_mov_b32 v62, 0
  v_mov_b32 v63, 0
  v_mov_b32 v64, 0
  v_mov_b32 v65, 0
  v_mov_b32 v66, 0
  v_mov_b32 v67, 0
  s_and_b32 s45, s2, 7
  s_lshl_b32 s45, s45, 9
  v_and_b32 v22, 31, v20
  v_lshl_add_u32 v22, v22, 4, s45
  v_lshrrev_b32 v23, 5, v20
  v_lshl_add_u32 v22, v23, 16, v22
  v_lshlrev_b32 v23, 2, v23
  s_lshr_b32 s44, s96, 0
  v_bfe_u32 v24, s44, v23, 4
  v_lshl_add_u32 v188, v24, 12, v22
  v_add_u32 v22, 0x20000, v22
  s_lshr_b32 s44, s96, 8
  v_bfe_u32 v24, s44, v23, 4
  v_lshl_add_u32 v189, v24, 12, v22
  v_add_u32 v22, 0x20000, v22
  s_lshr_b32 s44, s96, 16
  v_bfe_u32 v24, s44, v23, 4
  v_lshl_add_u32 v190, v24, 12, v22
  v_add_u32 v22, 0x20000, v22
  s_lshr_b32 s44, s96, 24
  v_bfe_u32 v24, s44, v23, 4
  v_lshl_add_u32 v191, v24, 12, v22
  v_add_u32 v22, 0x20000, v22
  s_lshr_b32 s44, s97, 0
  v_bfe_u32 v24, s44, v23, 4
  v_lshl_add_u32 v192, v24, 12, v22
  v_add_u32 v22, 0x20000, v22
  s_lshr_b32 s44, s97, 8
  v_bfe_u32 v24, s44, v23, 4
  v_lshl_add_u32 v193, v24, 12, v22
  v_add_u32 v22, 0x20000, v22
  s_lshr_b32 s44, s97, 16
  v_bfe_u32 v24, s44, v23, 4
  v_lshl_add_u32 v194, v24, 12, v22
  v_add_u32 v22, 0x20000, v22
  s_lshr_b32 s44, s97, 24
  v_bfe_u32 v24, s44, v23, 4
  v_lshl_add_u32 v195, v24, 12, v22
  s_mov_b32 s69, 0
  s_movk_i32 m0, 4608
  s_branch L_hq_nl
L_hk:
  s_sub_u32 s47, s43, 1
L_hsw:
  ds_read_b128 v[104:107], v14 offset:0
  s_waitcnt lgkmcnt(0)
  v_min_u32 v104, v104, v105
  v_min3_u32 v104, v104, v106, v107
  s_nop 0
  v_readfirstlane_b32 s46, v104
  s_cmp_ge_u32 s46, s47
  s_cbranch_scc1 L_hsw_ok
  s_cmp_eq_u32 s94, 0
  s_cbranch_scc1 L_hsw_ok
  s_sub_u32 s94, s94, 1
  s_sleep 1
  s_branch L_hsw
L_hsw_ok:
  s_bitcmp1_b32 s80, s47
  s_cbranch_scc0 L_fas
  s_mul_i32 s44, s47, 384
  s_add_u32 s44, s44, 7864320
  s_movk_i32 s78, 1
  s_atomic_add s78, s[30:31], s44 glc
  s_mov_b64 exec, 1
  global_load_dword v41, v43, s[30:31] offset:8 sc1
  s_mov_b64 exec, -1
L_fas:
  s_cmp_lt_u32 s43, 6
  s_cbranch_scc1 L_hs_done
  s_add_u32 s68, s69, 2
  s_min_u32 s68, s68, s47
L_hs:
  ds_read_u16_d16_hi v60, v33 offset:4608
  ds_read_u16_d16_hi v61, v34 offset:4608
  ds_read_u16_d16_hi v62, v33 offset:12800
  ds_read_u16_d16_hi v63, v34 offset:12800
  ds_read_u16_d16_hi v64, v33 offset:20992
  ds_read_u16_d16_hi v65, v34 offset:20992
  ds_read_u16_d16_hi v66, v33 offset:29184
  ds_read_u16_d16_hi v67, v34 offset:29184
  v_add_u32 v200, s101, v199
  v_add_u32 v201, 1536, v200
  s_addk_i32 s101, 3072
  s_cmpk_eq_u32 s101, 18432
  s_cselect_b32 s101, 0, s101
  s_add_u32 s69, s69, 1
  s_waitcnt lgkmcnt(4)
  ds_read2_b32 v[76:77], v200 offset0:0 offset1:1
  ds_read_b32 v72, v200 offset:8
  ds_read2_b32 v[78:79], v200 offset0:192 offset1:193
  ds_read_b32 v73, v200 offset:776
  ds_read2_b32 v[80:81], v201 offset0:0 offset1:1
  ds_read_b32 v74, v201 offset:8
  ds_read2_b32 v[82:83], v201 offset0:192 offset1:193
  ds_read_b32 v75, v201 offset:776
  s_waitcnt lgkmcnt(0)
  v_add_f32 v76, v76, v77
  v_add_f32 v78, v78, v79
  v_add_f32 v80, v80, v81
  v_add_f32 v82, v82, v83
  v_add_f32 v72, v72, v76
  v_add_f32 v73, v73, v78
  v_add_f32 v74, v74, v80
  v_add_f32 v75, v75, v82
  v_fma_f32 v72, -v62, v74, v72
  v_fma_f32 v73, -v63, v75, v73
  v_mul_f32 v74, s67, v60
  v_mul_f32 v75, s67, v61
  v_mul_f32 v72, v72, v74
  v_mul_f32 v73, v73, v75
  v_max_f32 v48, v72, v73
  s_nop 1
  v_max_f32_dpp v48, v48, v48 row_ror:8 row_mask:0xf bank_mask:0xf
  s_nop 1
  v_max_f32_dpp v48, v48, v48 row_ror:4 row_mask:0xf bank_mask:0xf
  s_nop 1
  v_max_f32_dpp v48, v48, v48 row_ror:2 row_mask:0xf bank_mask:0xf
  s_nop 1
  v_max_f32_dpp v48, v48, v48 row_ror:1 row_mask:0xf bank_mask:0xf
  v_mov_b32 v22, v48
  s_nop 1
  v_permlane16_swap_b32 v48, v22
  v_max_f32 v48, v48, v22
  v_mov_b32 v22, v48
  s_nop 1
  v_permlane32_swap_b32 v48, v22
  v_max_f32 v48, v48, v22
  v_sub_f32 v72, v72, v48
  v_sub_f32 v73, v73, v48
  v_exp_f32 v72, v72
  v_exp_f32 v73, v73
  s_nop 0
  v_add_f32 v49, v72, v73
  v_mul_f32 v72, v72, v64
  v_mul_f32 v73, v73, v65
  v_mul_f32 v50, v72, v66
  v_fmac_f32 v50, v73, v67
  ds_write_b32 v46, v72 offset:37376
  ds_write_b32 v46, v73 offset:37632
  s_nop 1
  v_add_f32_dpp v49, v49, v49 row_ror:8 row_mask:0xf bank_mask:0xf
  s_nop 1
  v_add_f32_dpp v49, v49, v49 row_ror:4 row_mask:0xf bank_mask:0xf
  s_nop 1
  v_add_f32_dpp v49, v49, v49 row_ror:2 row_mask:0xf bank_mask:0xf
  s_nop 1
  v_add_f32_dpp v49, v49, v49 row_ror:1 row_mask:0xf bank_mask:0xf
  v_mov_b32 v22, v49
  s_nop 1
  v_permlane16_swap_b32 v49, v22
  v_add_f32 v49, v49, v22
  v_mov_b32 v22, v49
  s_nop 1
  v_permlane32_swap_b32 v49, v22
  v_add_f32 v49, v49, v22
  s_nop 1
  v_add_f32_dpp v50, v50, v50 row_ror:8 row_mask:0xf bank_mask:0xf
  s_nop 1
  v_add_f32_dpp v50, v50, v50 row_ror:4 row_mask:0xf bank_mask:0xf
  s_nop 1
  v_add_f32_dpp v50, v50, v50 row_ror:2 row_mask:0xf bank_mask:0xf
  s_nop 1
  v_add_f32_dpp v50, v50, v50 row_ror:1 row_mask:0xf bank_mask:0xf
  v_mov_b32 v22, v50
  s_nop 1
  v_permlane16_swap_b32 v50, v22
  v_add_f32 v50, v50, v22
  v_mov_b32 v22, v50
  s_nop 1
  v_permlane32_swap_b32 v50, v22
  v_add_f32 v50, v50, v22
  v_mov_b32 v22, s69
  ds_write_b128 v47, v[48:51]
  ds_write_b32 v14, v22 offset:20
  v_add_u32 v46, 512, v46
  v_add_u32 v47, 16, v47
  v_add_u32 v33, 512, v33
  v_add_u32 v34, 512, v34
  s_cmp_lt_u32 s69, s68
  s_cbranch_scc1 L_hs
L_hs_done:
  s_bitcmp1_b32 s80, s47
  s_cbranch_scc0 L_fbs
  s_waitcnt vmcnt(0) lgkmcnt(0)
  v_readlane_b32 s46, v40, s47
  s_sub_u32 s78, s78, s46
  s_bfe_u32 s46, s78, 0x80000
  s_min_u32 s46, s46, 15
  s_lshl_b32 s46, s46, 1
  s_sub_u32 s46, s46, 15
  v_readfirstlane_b32 s95, v41
  s_mul_i32 s45, s46, 6
  s_ashr_i32 s44, s95, 3
  s_sub_u32 s95, s95, s44
  s_cmp_lt_i32 s46, 0
  s_cselect_b32 s95, s95, 0
  s_cselect_b32 s45, -48, 0
  s_add_u32 s45, s45, s95
  v_mov_b32 v41, s45
  s_lshl4_add_u32 s46, s46, s95
  s_cmp_gt_i32 s46, 0
  s_cselect_b32 s44, 3, 6
  s_mul_i32 s46, s46, s44
  s_add_u32 s46, s46, 128
  s_ashr_i32 s46, s46, 8
  v_mov_b32 v42, s46
  s_mov_b64 exec, 1
  global_store_dword v43, v42, s[30:31]
  global_store_dword v43, v41, s[30:31] offset:8
  s_mov_b64 exec, -1
L_fbs:
  s_cmp_eq_u32 s47, 1
  s_cbranch_scc0 L_el
  s_bitcmp0_b32 s81, 0
  s_cbranch_scc0 L_el
  s_mov_b64 exec, 0xffff
  global_load_ubyte v42, v44, s[30:31] sc1
  s_waitcnt vmcnt(0)
  v_cmp_ne_u32 s[64:65], 0, v42
  s_lshr_b32 s44, s64, s79
  s_bcnt1_i32_b32 s44, s44
  s_sub_u32 s45, s44, 1
  s_cmp_lt_u32 s45, 7
  s_cbranch_scc0 L_el
  s_lshl_b32 s80, 0x10204081, s45
  s_and_b32 s80, s80, 0x7ffffffc
  s_mov_b32 exec_lo, s80
  global_load_dword v40, v39, s[30:31] sc1
L_el:
  s_mov_b64 exec, -1
L_hq:
  s_add_u32 s43, s43, 1
  s_sub_u32 s44, s43, 4
  s_cmp_gt_u32 s44, 12
  s_cbranch_scc1 L_hq_nl
  s_waitcnt vmcnt(0)
  v_lshlrev_b32 v76, 16, v68
  v_and_b32 v77, s66, v68
  v_lshlrev_b32 v78, 16, v69
  v_and_b32 v79, s66, v69
  v_lshlrev_b32 v80, 16, v70
  v_and_b32 v81, s66, v70
  v_lshlrev_b32 v82, 16, v71
  v_and_b32 v83, s66, v71
  v_mul_f32 v76, v76, v52
  v_mul_f32 v77, v77, v53
  v_mul_f32 v78, v78, v54
  v_mul_f32 v79, v79, v55
  v_mul_f32 v80, v80, v56
  v_mul_f32 v81, v81, v57
  v_mul_f32 v82, v82, v58
  v_mul_f32 v83, v83, v59
  v_cvt_pk_bf16_f32 v84, v76, v80
  v_cvt_pk_bf16_f32 v85, v77, v81
  v_cvt_pk_bf16_f32 v86, v78, v82
  v_cvt_pk_bf16_f32 v87, v79, v83
  v_lshlrev_b32 v76, 16, v84
  v_and_b32 v80, s66, v84
  v_lshlrev_b32 v77, 16, v85
  v_and_b32 v81, s66, v85
  v_lshlrev_b32 v78, 16, v86
  v_and_b32 v82, s66, v86
  v_lshlrev_b32 v79, 16, v87
  v_and_b32 v83, s66, v87
  v_fma_f32 v76, v80, v30, v76
  v_fma_f32 v77, v81, v30, v77
  v_fma_f32 v78, v82, v30, v78
  v_fma_f32 v79, v83, v30, v79
  v_cvt_pk_bf16_f32 v84, v76, v77
  v_cvt_pk_bf16_f32 v85, v78, v79
  v_xor_b32 v86, v31, v84
  v_xor_b32 v87, v31, v85
  v_mov_b32 v22, s43
  ds_write_b16 v28, v84 offset:512
  ds_write_b16_d16_hi v28, v84 offset:516
  ds_write_b16 v28, v85 offset:520
  ds_write_b16_d16_hi v28, v85 offset:524
  ds_write_b16 v29, v86 offset:514
  ds_write_b16_d16_hi v29, v86 offset:518
  ds_write_b16 v29, v87 offset:522
  ds_write_b16_d16_hi v29, v87 offset:526
  ds_write_b32 v14, v22 offset:16
  v_add_u32 v28, 1024, v28
  v_add_u32 v29, 1024, v29
  v_and_b32 v28, 0xfff, v28
  v_and_b32 v29, 0xfff, v29
  s_cmp_eq_u32 s43, 16
  s_cbranch_scc1 L_hq_nl
  s_lshl_b32 s44, s43, 2
  s_lshr_b64 s[64:65], s[96:97], s44
  s_and_b32 s64, s64, 15
  s_lshl4_add_u32 s68, s43, s64
  s_mul_i32 s44, s68, 384
  s_add_u32 s32, s4, s44
  s_addc_u32 s33, s5, 0
  global_load_dwordx2 v[68:69], v26, s[32:33]
  global_load_dwordx2 v[70:71], v27, s[32:33]
L_hq_nl:
  s_sub_u32 s44, s43, 5
  s_cmp_lt_u32 s44, 2
  s_cbranch_scc0 L_sc_done
  global_load_lds_dwordx4 v188, s[8:9]
  s_addk_i32 m0, 1024
  s_waitcnt vmcnt(3)
  global_load_lds_dwordx4 v189, s[8:9]
  s_addk_i32 m0, 1024
  s_waitcnt vmcnt(3)
  global_load_lds_dwordx4 v190, s[8:9]
  s_addk_i32 m0, 1024
  s_waitcnt vmcnt(3)
  global_load_lds_dwordx4 v191, s[8:9]
  s_addk_i32 m0, 1024
  s_waitcnt vmcnt(3)
  global_load_lds_dwordx4 v192, s[8:9]
  s_addk_i32 m0, 1024
  s_waitcnt vmcnt(3)
  global_load_lds_dwordx4 v193, s[8:9]
  s_addk_i32 m0, 1024
  s_waitcnt vmcnt(3)
  global_load_lds_dwordx4 v194, s[8:9]
  s_addk_i32 m0, 1024
  s_waitcnt vmcnt(3)
  global_load_lds_dwordx4 v195, s[8:9]
  s_addk_i32 m0, 1024
  s_mov_b64 s[8:9], s[10:11]
  s_mov_b64 s[10:11], s[14:15]
  s_mov_b64 s[14:15], s[16:17]
  s_waitcnt vmcnt(3)
  global_load_lds_dwordx4 v188, s[8:9]
  s_addk_i32 m0, 1024
  s_waitcnt vmcnt(3)
  global_load_lds_dwordx4 v189, s[8:9]
  s_addk_i32 m0, 1024
  s_waitcnt vmcnt(3)
  global_load_lds_dwordx4 v190, s[8:9]
  s_addk_i32 m0, 1024
  s_waitcnt vmcnt(3)
  global_load_lds_dwordx4 v191, s[8:9]
  s_addk_i32 m0, 1024
  s_waitcnt vmcnt(3)
  global_load_lds_dwordx4 v192, s[8:9]
  s_addk_i32 m0, 1024
  s_waitcnt vmcnt(3)
  global_load_lds_dwordx4 v193, s[8:9]
  s_addk_i32 m0, 1024
  s_waitcnt vmcnt(3)
  global_load_lds_dwordx4 v194, s[8:9]
  s_addk_i32 m0, 1024
  s_waitcnt vmcnt(3)
  global_load_lds_dwordx4 v195, s[8:9]
  s_addk_i32 m0, 1024
  s_mov_b64 s[8:9], s[10:11]
  s_mov_b64 s[10:11], s[14:15]
  s_mov_b64 s[14:15], s[16:17]
  s_cmp_eq_u32 s43, 6
  s_cbranch_scc0 L_sc_done
  s_waitcnt vmcnt(0)
L_sc_done:
  s_cmp_eq_u32 s43, 16
  s_cbranch_scc0 L_hq_skip
  s_cmp_eq_u32 s3, 0
  s_cbranch_scc0 L_hq_skip
  s_mov_b64 exec, 7
  global_store_dword v45, v14, s[30:31] sc1
  s_waitcnt vmcnt(0)
  s_mov_b64 exec, 1
  global_store_dword v37, v38, s[28:29] sc1
  s_mov_b64 exec, -1
L_hq_skip:
  s_waitcnt lgkmcnt(0)
  s_cmp_lt_u32 s43, 18
  s_cbranch_scc1 L_hk
  v_and_b32 v24, 15, v20
  v_lshlrev_b32 v24, 1, v24
  global_load_ushort v25, v24, s[82:83] offset:32
  s_mov_b32 s43, 0
  v_min_u32 v28, 23, v20
  v_lshlrev_b32 v28, 4, v28
  v_lshlrev_b32 v22, 1, v28
  s_and_b32 s44, s41, 1
  v_lshl_add_u32 v196, s44, 8, v22
  v_subrev_u32 v197, 768, v196
  v_min_u32 v196, v196, v197
  v_subrev_u32 v29, 256, v196
  v_add_u32 v197, 512, v196
  v_min_u32 v197, v29, v197
  v_subrev_u32 v29, 512, v196
  v_add_u32 v198, 256, v196
  v_min_u32 v198, v29, v198
  v_add_u32 v196, 64000, v196
  v_add_u32 v197, 64000, v197
  v_add_u32 v198, 64000, v198
  v_add_u32 v28, 113152, v28
  v_lshlrev_b32 v32, 4, v20
  v_add_u32 v30, 113152, v32
  v_cmp_gt_u32 vcc, 24, v20
  v_lshrrev_b32 v21, 1, v35
  s_mul_i32 s44, s98, 384
  s_add_u32 s26, s26, s44
  s_addc_u32 s27, s27, 0
  v_mov_b32 v31, s2
  v_mul_u32_u24 v31, 6144, v31
  v_add_u32 v31, 8388608, v31
  v_add_u32 v23, 0, v32
  v_add_u32 v188, v23, v31
  v_add_u32 v23, 1024, v32
  v_add_u32 v189, v23, v31
  v_add_u32 v23, 2048, v32
  v_add_u32 v190, v23, v31
  v_add_u32 v23, 3072, v32
  v_add_u32 v191, v23, v31
  v_add_u32 v23, 4096, v32
  v_add_u32 v192, v23, v31
  v_add_u32 v23, 5120, v32
  v_add_u32 v193, v23, v31
  s_mov_b32 s45, 14
  s_lshl_b32 s68, s45, 2
  s_lshr_b64 s[64:65], s[92:93], s68
  s_and_b32 s68, s64, 15
  v_lshl_add_u32 v23, s68, 4, v32
  v_cndmask_b32 v23, v23, v32, vcc
  v_add_u32 v23, 5376, v23
  v_add_u32 v168, v23, v31
  s_waitcnt vmcnt(0)
  v_lshrrev_b32 v31, 4, v25
  v_mul_u32_u24 v31, 6144, v31
  v_add_u32 v31, 8388608, v31
  v_and_b32 v25, 15, v25
  v_mul_u32_u24 v25, 384, v25
  s_lshl4_add_u32 s44, s3, 5760
  v_mov_b32 v23, s44
  v_add_u32 v187, v23, v31
  v_add_u32_dpp v23, v25, v21 row_newbcast:0 row_mask:0xf bank_mask:0xf
  v_mov_b32_dpp v29, v31 row_newbcast:0 row_mask:0xf bank_mask:0xf
  v_add_u32 v172, v23, v29
  v_add_u32_dpp v23, v25, v21 row_newbcast:1 row_mask:0xf bank_mask:0xf
  v_mov_b32_dpp v29, v31 row_newbcast:1 row_mask:0xf bank_mask:0xf
  v_add_u32 v173, v23, v29
  v_add_u32_dpp v23, v25, v21 row_newbcast:2 row_mask:0xf bank_mask:0xf
  v_mov_b32_dpp v29, v31 row_newbcast:2 row_mask:0xf bank_mask:0xf
  v_add_u32 v174, v23, v29
  v_add_u32_dpp v23, v25, v21 row_newbcast:3 row_mask:0xf bank_mask:0xf
  v_mov_b32_dpp v29, v31 row_newbcast:3 row_mask:0xf bank_mask:0xf
  v_add_u32 v175, v23, v29
  v_add_u32_dpp v23, v25, v21 row_newbcast:4 row_mask:0xf bank_mask:0xf
  v_mov_b32_dpp v29, v31 row_newbcast:4 row_mask:0xf bank_mask:0xf
  v_add_u32 v176, v23, v29
  v_add_u32_dpp v23, v25, v21 row_newbcast:5 row_mask:0xf bank_mask:0xf
  v_mov_b32_dpp v29, v31 row_newbcast:5 row_mask:0xf bank_mask:0xf
  v_add_u32 v177, v23, v29
  v_add_u32_dpp v23, v25, v21 row_newbcast:6 row_mask:0xf bank_mask:0xf
  v_mov_b32_dpp v29, v31 row_newbcast:6 row_mask:0xf bank_mask:0xf
  v_add_u32 v178, v23, v29
  v_add_u32_dpp v23, v25, v21 row_newbcast:7 row_mask:0xf bank_mask:0xf
  v_mov_b32_dpp v29, v31 row_newbcast:7 row_mask:0xf bank_mask:0xf
  v_add_u32 v179, v23, v29
  v_add_u32_dpp v23, v25, v21 row_newbcast:8 row_mask:0xf bank_mask:0xf
  v_mov_b32_dpp v29, v31 row_newbcast:8 row_mask:0xf bank_mask:0xf
  v_add_u32 v180, v23, v29
  v_add_u32_dpp v23, v25, v21 row_newbcast:9 row_mask:0xf bank_mask:0xf
  v_mov_b32_dpp v29, v31 row_newbcast:9 row_mask:0xf bank_mask:0xf
  v_add_u32 v181, v23, v29
  v_add_u32_dpp v23, v25, v21 row_newbcast:10 row_mask:0xf bank_mask:0xf
  v_mov_b32_dpp v29, v31 row_newbcast:10 row_mask:0xf bank_mask:0xf
  v_add_u32 v182, v23, v29
  v_add_u32_dpp v23, v25, v21 row_newbcast:11 row_mask:0xf bank_mask:0xf
  v_mov_b32_dpp v29, v31 row_newbcast:11 row_mask:0xf bank_mask:0xf
  v_add_u32 v183, v23, v29
  v_add_u32_dpp v23, v25, v21 row_newbcast:12 row_mask:0xf bank_mask:0xf
  v_mov_b32_dpp v29, v31 row_newbcast:12 row_mask:0xf bank_mask:0xf
  v_add_u32 v184, v23, v29
  v_add_u32_dpp v23, v25, v21 row_newbcast:13 row_mask:0xf bank_mask:0xf
  v_mov_b32_dpp v29, v31 row_newbcast:13 row_mask:0xf bank_mask:0xf
  v_add_u32 v185, v23, v29
  v_add_u32_dpp v23, v25, v21 row_newbcast:14 row_mask:0xf bank_mask:0xf
  v_mov_b32_dpp v29, v31 row_newbcast:14 row_mask:0xf bank_mask:0xf
  v_add_u32 v186, v23, v29
  v_mov_b32 v108, -1
  v_mov_b32 v109, -1
  v_mov_b32 v110, -1
  v_mov_b32 v111, -1
  s_lshl4_add_u32 s44, s3, 118912
  v_mov_b32 v23, s44
  ds_write_b128 v28, v[108:111] offset:5376
  ds_write_b32 v23, v38 offset:12
L_hp:
  s_min_u32 s44, s3, 13
  s_cmp_eq_u32 s44, s43
  s_cbranch_scc0 L_hc_ok
L_hc:
  global_load_dword v104, v37, s[28:29] sc1
  s_waitcnt vmcnt(0)
  v_cmp_ne_u32 s[64:65], 1, v104
  s_cmp_eq_u64 s[64:65], 0
  s_cbranch_scc1 L_hc_ok
  s_cmp_eq_u32 s94, 0
  s_cbranch_scc1 L_hc_ok
  s_sub_u32 s94, s94, 1
  s_sleep 64
  s_branch L_hc
L_hc_ok:
  s_lshl_b32 s68, s43, 2
  s_lshr_b64 s[64:65], s[92:93], s68
  s_and_b32 s68, s64, 15
  s_lshl4_add_u32 s44, s68, 118912
  v_mov_b32 v23, s44
  s_cmp_eq_u32 s43, 14
  s_cbranch_scc0 L_hp_mid
  ds_read_b128 v[144:147], v30 offset:0
  ds_read_b128 v[148:151], v30 offset:1024
  ds_read_b128 v[152:155], v30 offset:2048
  ds_read_b128 v[156:159], v30 offset:3072
  ds_read_b128 v[160:163], v30 offset:4096
  ds_read_b128 v[164:167], v30 offset:5120
L_hm:
  ds_read_b32 v104, v14 offset:24
  s_waitcnt lgkmcnt(0)
  v_readfirstlane_b32 s46, v104
  s_cmp_ge_u32 s46, 30
  s_cbranch_scc1 L_hm_ok
  s_cmp_eq_u32 s94, 0
  s_cbranch_scc1 L_hm_ok
  s_sub_u32 s94, s94, 1
  s_sleep 1
  s_branch L_hm
L_hm_ok:
  global_store_dwordx4 v188, v[144:147], s[30:31] sc1
  global_store_dwordx4 v189, v[148:151], s[30:31] sc1
  global_store_dwordx4 v190, v[152:155], s[30:31] sc1
  global_store_dwordx4 v191, v[156:159], s[30:31] sc1
  global_store_dwordx4 v192, v[160:163], s[30:31] sc1
  s_mov_b32 exec_hi, 0xffffff
  global_store_dwordx4 v193, v[164:167], s[30:31] sc1
  s_mov_b64 exec, 7
  s_waitcnt vmcnt(0)
  global_atomic_add v36, v38, s[30:31] sc1
  s_mov_b64 exec, -1
L_hp_mid:
  s_add_u32 s43, s43, 1
  s_add_u32 s47, s43, 16
L_hpw:
  ds_read_b128 v[104:107], v14 offset:0
  s_waitcnt lgkmcnt(0)
  v_min_u32 v104, v104, v105
  v_min3_u32 v104, v104, v106, v107
  s_nop 0
  v_readfirstlane_b32 s46, v104
  s_cmp_ge_u32 s46, s47
  s_cbranch_scc1 L_hpw_ok
  s_cmp_eq_u32 s94, 0
  s_cbranch_scc1 L_hpw_ok
  s_sub_u32 s94, s94, 1
  s_sleep 1
  s_branch L_hpw
L_hpw_ok:
  s_bitcmp1_b32 s80, s47
  s_cbranch_scc0 L_fap
  s_mul_i32 s44, s47, 384
  s_add_u32 s44, s44, 7864320
  s_movk_i32 s78, 1
  s_atomic_add s78, s[30:31], s44 glc
  s_mov_b64 exec, 1
  global_load_dword v41, v43, s[30:31] offset:8 sc1
  s_mov_b64 exec, -1
L_fap:
  ds_read_b128 v[72:75], v196 offset:0
  ds_read_b128 v[76:79], v196 offset:16
  ds_read_b128 v[80:83], v197 offset:768
  ds_read_b128 v[84:87], v197 offset:784
  ds_read_b128 v[88:91], v197 offset:1536
  ds_read_b128 v[92:95], v197 offset:1552
  ds_read_b128 v[96:99], v198 offset:2304
  ds_read_b128 v[100:103], v198 offset:2320
  ds_read_b128 v[48:51], v23
  s_waitcnt lgkmcnt(0)
  v_pk_add_f32 v[72:73], v[72:73], v[80:81]
  v_pk_add_f32 v[88:89], v[88:89], v[96:97]
  v_pk_add_f32 v[74:75], v[74:75], v[82:83]
  v_pk_add_f32 v[90:91], v[90:91], v[98:99]
  v_pk_add_f32 v[76:77], v[76:77], v[84:85]
  v_pk_add_f32 v[92:93], v[92:93], v[100:101]
  v_pk_add_f32 v[78:79], v[78:79], v[86:87]
  v_pk_add_f32 v[94:95], v[94:95], v[102:103]
  v_pk_add_f32 v[72:73], v[72:73], v[88:89]
  v_pk_add_f32 v[74:75], v[74:75], v[90:91]
  v_pk_add_f32 v[76:77], v[76:77], v[92:93]
  v_pk_add_f32 v[78:79], v[78:79], v[94:95]
  v_pk_add_f32 v[72:73], v[72:73], v[50:51] op_sel_hi:[1,0] neg_lo:[0,1] neg_hi:[0,1]
  v_pk_add_f32 v[74:75], v[74:75], v[50:51] op_sel_hi:[1,0] neg_lo:[0,1] neg_hi:[0,1]
  v_pk_add_f32 v[76:77], v[76:77], v[50:51] op_sel_hi:[1,0] neg_lo:[0,1] neg_hi:[0,1]
  v_pk_add_f32 v[78:79], v[78:79], v[50:51] op_sel_hi:[1,0] neg_lo:[0,1] neg_hi:[0,1]
  v_max3_f32 v25, |v72|, |v73|, |v74|
  v_max3_f32 v25, v25, |v75|, |v76|
  v_max3_f32 v25, v25, |v77|, |v78|
  v_max_f32_e64 v25, v25, |v79|
  s_nop 1
  v_max_f32_dpp v25, v25, v25 row_ror:8 row_mask:0xf bank_mask:0xf
  s_nop 1
  v_max_f32_dpp v25, v25, v25 row_ror:4 row_mask:0xf bank_mask:0xf
  s_nop 1
  v_max_f32_dpp v25, v25, v25 row_ror:2 row_mask:0xf bank_mask:0xf
  s_nop 1
  v_max_f32_dpp v25, v25, v25 row_ror:1 row_mask:0xf bank_mask:0xf
  v_mov_b32 v29, v25
  s_nop 1
  v_permlane16_swap_b32 v25, v29
  v_max_f32 v25, v25, v29
  v_mov_b32 v29, v25
  s_nop 1
  v_permlane32_swap_b32 v25, v29
  v_max_f32 v25, v25, v29
  v_frexp_exp_i32_f32 v25, v25
  v_sub_u32 v29, 14, v25
  v_add_u32 v51, 242, v25
  v_ldexp_f32 v72, v72, v29
  v_ldexp_f32 v73, v73, v29
  v_ldexp_f32 v74, v74, v29
  v_ldexp_f32 v75, v75, v29
  v_ldexp_f32 v76, v76, v29
  v_ldexp_f32 v77, v77, v29
  v_ldexp_f32 v78, v78, v29
  v_ldexp_f32 v79, v79, v29
  v_cvt_pk_f16_f32 v108, v72, v73
  v_cvt_pk_f16_f32 v109, v74, v75
  v_cvt_pk_f16_f32 v110, v76, v77
  v_cvt_pk_f16_f32 v111, v78, v79
  v_min_u32 v108, -2, v108
  v_min_u32 v109, -2, v109
  v_min_u32 v110, -2, v110
  v_min_u32 v111, -2, v111
  s_cmp_eq_u32 s43, 15
  s_cbranch_scc1 L_hp_last
  ds_write_b32 v23, v51 offset:12
  v_add_u32 v196, 3072, v196
  v_add_u32 v197, 3072, v197
  v_add_u32 v198, 3072, v198
  ds_write_b128 v28, v[108:111]
  v_add_u32 v28, 384, v28
  s_bitcmp1_b32 s80, s47
  s_cbranch_scc0 L_fbp
  s_waitcnt vmcnt(0) lgkmcnt(0)
  v_readlane_b32 s46, v40, s47
  s_sub_u32 s78, s78, s46
  s_bfe_u32 s46, s78, 0x80000
  s_min_u32 s46, s46, 15
  s_lshl_b32 s46, s46, 1
  s_sub_u32 s46, s46, 15
  v_readfirstlane_b32 s95, v41
  s_mul_i32 s45, s46, 6
  s_ashr_i32 s44, s95, 3
  s_sub_u32 s95, s95, s44
  s_cmp_lt_i32 s46, 0
  s_cselect_b32 s95, s95, 0
  s_cselect_b32 s45, -48, 0
  s_add_u32 s45, s45, s95
  v_mov_b32 v41, s45
  s_lshl4_add_u32 s46, s46, s95
  s_cmp_gt_i32 s46, 0
  s_cselect_b32 s44, 3, 6
  s_mul_i32 s46, s46, s44
  s_add_u32 s46, s46, 128
  s_ashr_i32 s46, s46, 8
  v_mov_b32 v42, s46
  s_mov_b64 exec, 1
  global_store_dword v43, v42, s[30:31]
  global_store_dword v43, v41, s[30:31] offset:8
  s_mov_b64 exec, -1
L_fbp:
  s_branch L_hp
L_hp_last:
  v_cndmask_b32 v108, v48, v108, vcc
  v_cndmask_b32 v109, v49, v109, vcc
  v_cndmask_b32 v110, v50, v110, vcc
  v_cndmask_b32 v111, v51, v111, vcc
  s_mov_b64 exec, 0x1ffffff
  global_store_dwordx4 v168, v[108:111], s[30:31] sc1
  s_mov_b64 exec, -1
  s_and_b32 s44, s41, 1
  v_lshl_add_u32 v196, s44, 8, v35
  v_subrev_u32 v197, 768, v196
  v_min_u32 v196, v196, v197
  v_subrev_u32 v29, 256, v196
  v_add_u32 v197, 512, v196
  v_min_u32 v197, v29, v197
  v_subrev_u32 v29, 512, v196
  v_add_u32 v198, 256, v196
  v_min_u32 v198, v29, v198
  v_add_u32 v196, 110080, v196
  v_add_u32 v197, 110080, v197
  v_add_u32 v198, 110080, v198
L_hn:
  ds_read_b32 v104, v14 offset:28
  s_waitcnt lgkmcnt(0)
  v_readfirstlane_b32 s46, v104
  s_cmp_ge_u32 s46, 31
  s_cbranch_scc1 L_hn_ok
  s_cmp_eq_u32 s94, 0
  s_cbranch_scc1 L_hn_ok
  s_sub_u32 s94, s94, 1
  s_sleep 1
  s_branch L_hn
L_hn_ok:
  s_mov_b64 exec, 1
L_hw:
  global_atomic_add v68, v36, v14, s[30:31] sc0 sc1
  s_waitcnt vmcnt(0)
  v_readfirstlane_b32 s46, v68
  s_cmp_ge_u32 s46, 16
  s_cbranch_scc1 L_hw_ok
  s_cmp_eq_u32 s94, 0
  s_cbranch_scc1 L_hw_ok
  s_sub_u32 s94, s94, 1
  s_branch L_hw
L_hw_ok:
  s_mov_b64 exec, -1
L_hg:
  global_load_dwordx4 v[52:55], v187, s[30:31] sc1
  global_load_dwordx2 v[112:113], v172, s[30:31] sc1
  global_load_dwordx2 v[114:115], v173, s[30:31] sc1
  global_load_dwordx2 v[116:117], v174, s[30:31] sc1
  global_load_dwordx2 v[118:119], v175, s[30:31] sc1
  global_load_dwordx2 v[120:121], v176, s[30:31] sc1
  global_load_dwordx2 v[122:123], v177, s[30:31] sc1
  global_load_dwordx2 v[124:125], v178, s[30:31] sc1
  global_load_dwordx2 v[126:127], v179, s[30:31] sc1
  global_load_dwordx2 v[128:129], v180, s[30:31] sc1
  global_load_dwordx2 v[130:131], v181, s[30:31] sc1
  global_load_dwordx2 v[132:133], v182, s[30:31] sc1
  global_load_dwordx2 v[134:135], v183, s[30:31] sc1
  global_load_dwordx2 v[136:137], v184, s[30:31] sc1
  global_load_dwordx2 v[138:139], v185, s[30:31] sc1
  global_load_dwordx2 v[140:141], v186, s[30:31] sc1
  s_waitcnt vmcnt(15)
  v_mov_b32 v23, v55
  v_mov_b32 v24, v52
  s_nop 1
  v_max_f32_dpp v24, v24, v24 row_ror:8 row_mask:0xf bank_mask:0xf
  s_nop 1
  v_max_f32_dpp v24, v24, v24 row_ror:4 row_mask:0xf bank_mask:0xf
  s_nop 1
  v_max_f32_dpp v24, v24, v24 row_ror:2 row_mask:0xf bank_mask:0xf
  s_nop 1
  v_max_f32_dpp v24, v24, v24 row_ror:1 row_mask:0xf bank_mask:0xf
  v_sub_f32 v24, v52, v24
  v_exp_f32 v24, v24
  v_subrev_u32 v55, 256, v55
  v_mul_f32 v25, v24, v53
  s_nop 1
  v_add_f32_dpp v25, v25, v25 row_ror:8 row_mask:0xf bank_mask:0xf
  s_nop 1
  v_add_f32_dpp v25, v25, v25 row_ror:4 row_mask:0xf bank_mask:0xf
  s_nop 1
  v_add_f32_dpp v25, v25, v25 row_ror:2 row_mask:0xf bank_mask:0xf
  s_nop 1
  v_add_f32_dpp v25, v25, v25 row_ror:1 row_mask:0xf bank_mask:0xf
  v_rcp_f32 v25, v25
  s_nop 0
  v_mul_f32 v24, v24, v25
  v_ldexp_f32 v25, v24, v55
  v_mul_f32_e64 v54, v24, -v54
  v_readlane_b32 s63, v24, 15
  v_readlane_b32 s44, v54, 15
  v_readlane_b32 s48, v25, 0
  v_readlane_b32 s49, v25, 1
  v_readlane_b32 s50, v25, 2
  v_readlane_b32 s51, v25, 3
  v_readlane_b32 s52, v25, 4
  v_readlane_b32 s53, v25, 5
  v_readlane_b32 s54, v25, 6
  v_readlane_b32 s55, v25, 7
  v_readlane_b32 s56, v25, 8
  v_readlane_b32 s57, v25, 9
  v_readlane_b32 s58, v25, 10
  v_readlane_b32 s59, v25, 11
  v_readlane_b32 s60, v25, 12
  v_readlane_b32 s61, v25, 13
  v_readlane_b32 s62, v25, 14
  v_mov_b32 v108, s44
  v_mov_b32 v109, s44
  v_mov_b32 v110, s44
  v_mov_b32 v111, s44
  s_waitcnt vmcnt(14)
  v_max3_u32 v23, v23, v112, v113
  v_fma_mix_f32 v108, v112, s48, v108 op_sel:[0,0,0] op_sel_hi:[1,0,0]
  v_fma_mix_f32 v109, v112, s48, v109 op_sel:[1,0,0] op_sel_hi:[1,0,0]
  v_fma_mix_f32 v110, v113, s48, v110 op_sel:[0,0,0] op_sel_hi:[1,0,0]
  v_fma_mix_f32 v111, v113, s48, v111 op_sel:[1,0,0] op_sel_hi:[1,0,0]
  s_waitcnt vmcnt(13)
  v_max3_u32 v23, v23, v114, v115
  v_fma_mix_f32 v108, v114, s49, v108 op_sel:[0,0,0] op_sel_hi:[1,0,0]
  v_fma_mix_f32 v109, v114, s49, v109 op_sel:[1,0,0] op_sel_hi:[1,0,0]
  v_fma_mix_f32 v110, v115, s49, v110 op_sel:[0,0,0] op_sel_hi:[1,0,0]
  v_fma_mix_f32 v111, v115, s49, v111 op_sel:[1,0,0] op_sel_hi:[1,0,0]
  s_waitcnt vmcnt(12)
  v_max3_u32 v23, v23, v116, v117
  v_fma_mix_f32 v108, v116, s50, v108 op_sel:[0,0,0] op_sel_hi:[1,0,0]
  v_fma_mix_f32 v109, v116, s50, v109 op_sel:[1,0,0] op_sel_hi:[1,0,0]
  v_fma_mix_f32 v110, v117, s50, v110 op_sel:[0,0,0] op_sel_hi:[1,0,0]
  v_fma_mix_f32 v111, v117, s50, v111 op_sel:[1,0,0] op_sel_hi:[1,0,0]
  s_waitcnt vmcnt(11)
  v_max3_u32 v23, v23, v118, v119
  v_fma_mix_f32 v108, v118, s51, v108 op_sel:[0,0,0] op_sel_hi:[1,0,0]
  v_fma_mix_f32 v109, v118, s51, v109 op_sel:[1,0,0] op_sel_hi:[1,0,0]
  v_fma_mix_f32 v110, v119, s51, v110 op_sel:[0,0,0] op_sel_hi:[1,0,0]
  v_fma_mix_f32 v111, v119, s51, v111 op_sel:[1,0,0] op_sel_hi:[1,0,0]
  s_waitcnt vmcnt(10)
  v_max3_u32 v23, v23, v120, v121
  v_fma_mix_f32 v108, v120, s52, v108 op_sel:[0,0,0] op_sel_hi:[1,0,0]
  v_fma_mix_f32 v109, v120, s52, v109 op_sel:[1,0,0] op_sel_hi:[1,0,0]
  v_fma_mix_f32 v110, v121, s52, v110 op_sel:[0,0,0] op_sel_hi:[1,0,0]
  v_fma_mix_f32 v111, v121, s52, v111 op_sel:[1,0,0] op_sel_hi:[1,0,0]
  s_waitcnt vmcnt(9)
  v_max3_u32 v23, v23, v122, v123
  v_fma_mix_f32 v108, v122, s53, v108 op_sel:[0,0,0] op_sel_hi:[1,0,0]
  v_fma_mix_f32 v109, v122, s53, v109 op_sel:[1,0,0] op_sel_hi:[1,0,0]
  v_fma_mix_f32 v110, v123, s53, v110 op_sel:[0,0,0] op_sel_hi:[1,0,0]
  v_fma_mix_f32 v111, v123, s53, v111 op_sel:[1,0,0] op_sel_hi:[1,0,0]
  s_waitcnt vmcnt(8)
  v_max3_u32 v23, v23, v124, v125
  v_fma_mix_f32 v108, v124, s54, v108 op_sel:[0,0,0] op_sel_hi:[1,0,0]
  v_fma_mix_f32 v109, v124, s54, v109 op_sel:[1,0,0] op_sel_hi:[1,0,0]
  v_fma_mix_f32 v110, v125, s54, v110 op_sel:[0,0,0] op_sel_hi:[1,0,0]
  v_fma_mix_f32 v111, v125, s54, v111 op_sel:[1,0,0] op_sel_hi:[1,0,0]
  s_waitcnt vmcnt(7)
  v_max3_u32 v23, v23, v126, v127
  v_fma_mix_f32 v108, v126, s55, v108 op_sel:[0,0,0] op_sel_hi:[1,0,0]
  v_fma_mix_f32 v109, v126, s55, v109 op_sel:[1,0,0] op_sel_hi:[1,0,0]
  v_fma_mix_f32 v110, v127, s55, v110 op_sel:[0,0,0] op_sel_hi:[1,0,0]
  v_fma_mix_f32 v111, v127, s55, v111 op_sel:[1,0,0] op_sel_hi:[1,0,0]
  s_waitcnt vmcnt(6)
  v_max3_u32 v23, v23, v128, v129
  v_fma_mix_f32 v108, v128, s56, v108 op_sel:[0,0,0] op_sel_hi:[1,0,0]
  v_fma_mix_f32 v109, v128, s56, v109 op_sel:[1,0,0] op_sel_hi:[1,0,0]
  v_fma_mix_f32 v110, v129, s56, v110 op_sel:[0,0,0] op_sel_hi:[1,0,0]
  v_fma_mix_f32 v111, v129, s56, v111 op_sel:[1,0,0] op_sel_hi:[1,0,0]
  s_waitcnt vmcnt(5)
  v_max3_u32 v23, v23, v130, v131
  v_fma_mix_f32 v108, v130, s57, v108 op_sel:[0,0,0] op_sel_hi:[1,0,0]
  v_fma_mix_f32 v109, v130, s57, v109 op_sel:[1,0,0] op_sel_hi:[1,0,0]
  v_fma_mix_f32 v110, v131, s57, v110 op_sel:[0,0,0] op_sel_hi:[1,0,0]
  v_fma_mix_f32 v111, v131, s57, v111 op_sel:[1,0,0] op_sel_hi:[1,0,0]
  s_waitcnt vmcnt(4)
  v_max3_u32 v23, v23, v132, v133
  v_fma_mix_f32 v108, v132, s58, v108 op_sel:[0,0,0] op_sel_hi:[1,0,0]
  v_fma_mix_f32 v109, v132, s58, v109 op_sel:[1,0,0] op_sel_hi:[1,0,0]
  v_fma_mix_f32 v110, v133, s58, v110 op_sel:[0,0,0] op_sel_hi:[1,0,0]
  v_fma_mix_f32 v111, v133, s58, v111 op_sel:[1,0,0] op_sel_hi:[1,0,0]
  s_waitcnt vmcnt(3)
  v_max3_u32 v23, v23, v134, v135
  v_fma_mix_f32 v108, v134, s59, v108 op_sel:[0,0,0] op_sel_hi:[1,0,0]
  v_fma_mix_f32 v109, v134, s59, v109 op_sel:[1,0,0] op_sel_hi:[1,0,0]
  v_fma_mix_f32 v110, v135, s59, v110 op_sel:[0,0,0] op_sel_hi:[1,0,0]
  v_fma_mix_f32 v111, v135, s59, v111 op_sel:[1,0,0] op_sel_hi:[1,0,0]
  s_waitcnt vmcnt(2)
  v_max3_u32 v23, v23, v136, v137
  v_fma_mix_f32 v108, v136, s60, v108 op_sel:[0,0,0] op_sel_hi:[1,0,0]
  v_fma_mix_f32 v109, v136, s60, v109 op_sel:[1,0,0] op_sel_hi:[1,0,0]
  v_fma_mix_f32 v110, v137, s60, v110 op_sel:[0,0,0] op_sel_hi:[1,0,0]
  v_fma_mix_f32 v111, v137, s60, v111 op_sel:[1,0,0] op_sel_hi:[1,0,0]
  s_waitcnt vmcnt(1)
  v_max3_u32 v23, v23, v138, v139
  v_fma_mix_f32 v108, v138, s61, v108 op_sel:[0,0,0] op_sel_hi:[1,0,0]
  v_fma_mix_f32 v109, v138, s61, v109 op_sel:[1,0,0] op_sel_hi:[1,0,0]
  v_fma_mix_f32 v110, v139, s61, v110 op_sel:[0,0,0] op_sel_hi:[1,0,0]
  v_fma_mix_f32 v111, v139, s61, v111 op_sel:[1,0,0] op_sel_hi:[1,0,0]
  s_waitcnt vmcnt(0)
  v_max3_u32 v23, v23, v140, v141
  v_cmp_eq_u32 s[64:65], -1, v23
  v_fma_mix_f32 v108, v140, s62, v108 op_sel:[0,0,0] op_sel_hi:[1,0,0]
  v_fma_mix_f32 v109, v140, s62, v109 op_sel:[1,0,0] op_sel_hi:[1,0,0]
  v_fma_mix_f32 v110, v141, s62, v110 op_sel:[0,0,0] op_sel_hi:[1,0,0]
  v_fma_mix_f32 v111, v141, s62, v111 op_sel:[1,0,0] op_sel_hi:[1,0,0]
  s_cmp_eq_u64 s[64:65], 0
  s_cbranch_scc1 L_hg_ok
  s_cmp_eq_u32 s94, 0
  s_cbranch_scc1 L_hg_ok
  s_sub_u32 s94, s94, 1
  s_branch L_hg
L_hg_ok:
  v_mov_b32 v168, s63
  s_mov_b32 exec_hi, 0xffff
  s_barrier
  ds_read_b128 v[72:75], v196 offset:0
  ds_read_b128 v[76:79], v197 offset:768
  ds_read_b128 v[80:83], v197 offset:1536
  ds_read_b128 v[84:87], v198 offset:2304
  s_waitcnt lgkmcnt(3)
  v_pk_fma_f32 v[108:109], v[72:73], v[168:169], v[108:109] op_sel_hi:[1,0,1]
  v_pk_fma_f32 v[110:111], v[74:75], v[168:169], v[110:111] op_sel_hi:[1,0,1]
  s_waitcnt lgkmcnt(2)
  v_pk_fma_f32 v[108:109], v[76:77], v[168:169], v[108:109] op_sel_hi:[1,0,1]
  v_pk_fma_f32 v[110:111], v[78:79], v[168:169], v[110:111] op_sel_hi:[1,0,1]
  s_waitcnt lgkmcnt(1)
  v_pk_fma_f32 v[108:109], v[80:81], v[168:169], v[108:109] op_sel_hi:[1,0,1]
  v_pk_fma_f32 v[110:111], v[82:83], v[168:169], v[110:111] op_sel_hi:[1,0,1]
  s_waitcnt lgkmcnt(0)
  v_pk_fma_f32 v[108:109], v[84:85], v[168:169], v[108:109] op_sel_hi:[1,0,1]
  v_pk_fma_f32 v[110:111], v[86:87], v[168:169], v[110:111] op_sel_hi:[1,0,1]
  v_cvt_pk_bf16_f32 v108, v108, v109
  v_cvt_pk_bf16_f32 v109, v110, v111
  global_store_dwordx2 v21, v[108:109], s[26:27]
L_end:
  s_endpgm
.p2align 6
.type L_order,@object
L_order:
  .long 0x76afedcb, 0x45321098, 0x500000, 0x300, 0x40, 0x251300, 0x4, 0x0
  .long 0x2e001e, 0x4e003e, 0x6e005e, 0x8d007e, 0xae009e, 0xce00be, 0xee00de, 0xf00fe
  .long 0x96afedcb, 0x74321058, 0x700000, 0x700, 0x70, 0x271700, 0x7, 0x0
  .long 0x270007, 0x470037, 0x670057, 0x870077, 0xa70097, 0xc700b7, 0xe700d7, 0x1f00f7
  .long 0x765aedfb, 0xc4321098, 0xd00000, 0xf00, 0xc0, 0x2d1f00, 0xc, 0x0
  .long 0x110001, 0x410031, 0x610051, 0x810071, 0xa10091, 0xc100b1, 0xe100d1, 0x2f00f1
  .long 0x785fedcb, 0x6432109a, 0x900000, 0x200, 0x60, 0x291200, 0x6, 0x0
  .long 0x160006, 0x460026, 0x660056, 0x860076, 0xa60096, 0xc600b6, 0xe600d6, 0x3f00f6
  .long 0x765faecb, 0xd4321098, 0xf00000, 0xd00, 0xd0, 0x2f1d00, 0xd, 0x0
  .long 0x120002, 0x320022, 0x620052, 0x820072, 0xa20092, 0xc200b2, 0xe200d2, 0x4f00f2
  .long 0x765fedca, 0xb4321098, 0x800000, 0xf00, 0xb0, 0x281f00, 0xb, 0x0
  .long 0x100000, 0x300020, 0x600040, 0x800070, 0xa00090, 0xc000b0, 0xe000d0, 0x5f00f0
  .long 0x76afedcb, 0x24351098, 0x400000, 0x0, 0x20, 0x241000, 0x2, 0x0
  .long 0x1c000c, 0x3c002c, 0x5c004c, 0x8c007c, 0xac009c, 0xcc00bc, 0xea00dc, 0x6f00fc
  .long 0x76afedcb, 0x14325098, 0x400000, 0x400, 0x10, 0x241400, 0x1, 0x0
  .long 0x1b000b, 0x3b002b, 0x5b004b, 0x8b006b, 0xab009b, 0xcb00bb, 0xeb00db, 0x7f00fb
  .long 0x76afedcb, 0x35421098, 0x500000, 0x300, 0x30, 0x251300, 0x3, 0x0
  .long 0x1d000d, 0x3d002d, 0x5d004d, 0x7d006d, 0xad009d, 0xcd00bd, 0xed00dd, 0x8f00fd
  .long 0x76afedcb, 0x94321058, 0x700000, 0x700, 0x90, 0x271700, 0x9, 0x0
  .long 0x170009, 0x390029, 0x590049, 0x790069, 0xa90089, 0xc900b9, 0xe900d9, 0x9f00f9
  .long 0x765aedcb, 0xf4321098, 0xd00000, 0xf00, 0xf0, 0x2d1f00, 0xf, 0x0
  .long 0x140004, 0x340021, 0x540044, 0x740064, 0x940084, 0xc400b4, 0xe400d4, 0xaf00f4
  .long 0x765fedcb, 0x8432109a, 0x900000, 0x200, 0x80, 0x291200, 0x8, 0x0
  .long 0x180008, 0x360028, 0x580048, 0x780068, 0x980088, 0xc800a8, 0xe800d8, 0xbf00f8
  .long 0x765fadcb, 0xe4321098, 0xf00000, 0xd00, 0xe0, 0x2f1d00, 0xe, 0x0
  .long 0x130003, 0x330023, 0x530042, 0x730063, 0x930083, 0xb300a3, 0xe300d3, 0xcf00f3
  .long 0x765fedcb, 0xa4321098, 0x800000, 0xf00, 0xaf, 0x28001f, 0xa, 0x0
  .long 0x500024, 0x14400a4, 0x2b40234, 0x6f40674, 0x7830703, 0xc1408c2, 0xd630c94, 0xdf0de3
  .long 0x76afedcb, 0x4351298, 0x400000, 0x0, 0x0, 0x241000, 0x0, 0x0
  .long 0x1a000a, 0x3a002a, 0x5a004a, 0x7a006a, 0x9a008a, 0xba00aa, 0xda00ca, 0xef00fa
  .long 0x76afedcb, 0x54321098, 0x400000, 0x400, 0x54, 0x140024, 0x5, 0x0
  .long 0x7b006c, 0x1cc00ec, 0x4be043e, 0x58d050d, 0x7de075e, 0xe1c084d, 0xe9c0e2e, 0xff0eae
  .long 0x765fadce, 0xb4321098, 0x11911111, 0x11111e11, 0xb1, 0x291e01, 0xb, 0x0
  .long 0x1200110, 0x1400130, 0x1600150, 0x1800170, 0x1a00190, 0x1c001b0, 0x1e001d0, 0x10f01f0
  .long 0x76afedcb, 0x94321058, 0x11b11111, 0x11111011, 0x91, 0x2b1001, 0x9, 0x0
  .long 0x1290109, 0x1490139, 0x1690159, 0x1890179, 0x1a90199, 0x1c901b9, 0x1e901d9, 0x11f01f9
  .long 0x765fedcb, 0x8432109a, 0x11a11111, 0x11111111, 0x81, 0x2a1101, 0x8, 0x0
  .long 0x1180108, 0x1480138, 0x1680158, 0x1880178, 0x1a70198, 0x1c801b8, 0x1e801d8, 0x12f01f8
  .long 0x765feadb, 0xc4321098, 0x11811111, 0x11111e11, 0xc1, 0x281e01, 0xc, 0x0
  .long 0x1110101, 0x1410121, 0x1610151, 0x1810171, 0x1a10191, 0x1c101b1, 0x1e101d1, 0x13f01f1
  .long 0x765aedcb, 0xf4321098, 0x11e11111, 0x11111f11, 0xf1, 0x2e1f01, 0xf, 0x0
  .long 0x1140104, 0x1340124, 0x1640154, 0x1840174, 0x1a40194, 0x1c401b4, 0x1e401d4, 0x14f01f4
  .long 0x76afedcb, 0x45321098, 0x11311111, 0x11111811, 0x41, 0x231801, 0x4, 0x0
  .long 0x11e010e, 0x13e012e, 0x16e014e, 0x18e017e, 0x1ae019e, 0x1ce01be, 0x1ee01dd, 0x15f01fe
  .long 0x7a5fedcb, 0x64321098, 0x11811111, 0x11111311, 0x61, 0x281301, 0x6, 0x0
  .long 0x1160106, 0x1360126, 0x1560146, 0x1860176, 0x1a60196, 0x1c601b6, 0x1e601d6, 0x16f01f6
  .long 0x76afedcb, 0x14325098, 0x11011111, 0x11111311, 0x11, 0x201301, 0x1, 0x0
  .long 0x11b010b, 0x13b012b, 0x15b014b, 0x18b016b, 0x1ab019b, 0x1cb01bb, 0x1eb01db, 0x17f01fa
  .long 0x765fadcb, 0xe4321098, 0x11911111, 0x11111e11, 0xe1, 0x291e01, 0xe, 0x0
  .long 0x1130100, 0x1330123, 0x1530143, 0x1730163, 0x1a30193, 0x1c301b3, 0x1e301d3, 0x18f01f3
  .long 0x76afedcb, 0x54321098, 0x11b11111, 0x11111011, 0x5b, 0x10012b, 0x5, 0x0
  .long 0x3090119, 0x5450389, 0xc2505c5, 0xd650ca5, 0xe750de5, 0xf380ef5, 0xfb80f55, 0x19f0fd5
  .long 0x865fedcb, 0x7432109a, 0x11a11111, 0x11111111, 0x71, 0x2a1101, 0x7, 0x0
  .long 0x1170107, 0x1370127, 0x1570147, 0x1770167, 0x1970187, 0x1c701b7, 0x1e701d7, 0x1af01f7
  .long 0x765feacb, 0xd4321098, 0x11811111, 0x11111e11, 0xd1, 0x281e01, 0xd, 0x0
  .long 0x1120102, 0x1310122, 0x1520142, 0x1720162, 0x1920182, 0x1c201a2, 0x1e201d2, 0x1bf01f2
  .long 0x76afedcb, 0x24351098, 0x11411111, 0x11111711, 0x21, 0x241701, 0x2, 0x0
  .long 0x11c010c, 0x13c012c, 0x15c014c, 0x17c016c, 0x19c018c, 0x1bc01ac, 0x1ec01dc, 0x1cf01fc
  .long 0x76afedcb, 0x35421098, 0x11311111, 0x11111811, 0x31, 0x231801, 0x3, 0x0
  .long 0x11d010d, 0x13d012d, 0x15d014d, 0x17d016d, 0x19d018d, 0x1bd01ad, 0x1ed01cd, 0x1df01fd
  .long 0x765fedcb, 0xa4321098, 0x11811111, 0x11111311, 0xa3, 0x280113, 0xa, 0x0
  .long 0x850005, 0x1750166, 0x62501f5, 0x74506a5, 0xbd507c5, 0xd350d15, 0xdb50d95, 0x1ef0e55
  .long 0x76afedcb, 0x4325198, 0x11011111, 0x11111311, 0x1, 0x201301, 0x0, 0x0
  .long 0x11a010a, 0x13a012a, 0x15a014a, 0x17a016a, 0x19a018a, 0x1ba01aa, 0x1da01ca, 0x1ff01ea
  .long 0x76afedcb, 0x45321098, 0x22222222, 0x22222a22, 0x42, 0x221a02, 0x4, 0x0
  .long 0x22e021e, 0x24e023e, 0x26e025e, 0x28b027e, 0x2ae029e, 0x2ce02be, 0x2ee02de, 0x20f02fe
  .long 0x7a5fedcb, 0x64321098, 0x22c22222, 0x22222622, 0x62, 0x2c1602, 0x6, 0x0
  .long 0x2260206, 0x2460236, 0x2660256, 0x2860276, 0x2a60296, 0x2c602b6, 0x2e602d6, 0x21f02f6
  .long 0x76afedcb, 0x54321098, 0x22922222, 0x22222522, 0x59, 0x150229, 0x5, 0x0
  .long 0xb50035, 0x1850105, 0x2f502a8, 0x3550315, 0x3d50395, 0x6650575, 0x94506e5, 0x22f09c5
  .long 0x765aedcb, 0xf4321098, 0x22f22222, 0x22222f22, 0xf2, 0x2f1f02, 0xf, 0x0
  .long 0x2140204, 0x2440224, 0x2640254, 0x2840274, 0x2a40294, 0x2c402b2, 0x2e402d4, 0x23f02f4
  .long 0x76afedcb, 0x24351098, 0x22222222, 0x22222522, 0x22, 0x221502, 0x2, 0x0
  .long 0x21c020c, 0x23c022c, 0x26c025c, 0x28c027c, 0x2ac029c, 0x2ca02bc, 0x2ec02dc, 0x24f02fc
  .long 0x965fedcb, 0x743210a8, 0x22722222, 0x22222022, 0x72, 0x271002, 0x7, 0x0
  .long 0x2170207, 0x2370227, 0x2670247, 0x2870277, 0x2a70297, 0x2c702b7, 0x2e702d7, 0x25f02f7
  .long 0x765fadce, 0xb4321098, 0x22a22222, 0x22222e22, 0xb2, 0x2a1e02, 0xb, 0x0
  .long 0x2100200, 0x2300220, 0x2500240, 0x2800270, 0x2a00290, 0x2c002b0, 0x2e002d0, 0x26f02f0
  .long 0x76afedcb, 0x34521098, 0x22222222, 0x22222822, 0x32, 0x221802, 0x3, 0x0
  .long 0x21d020d, 0x23d022d, 0x25d024d, 0x28d026d, 0x2ad029d, 0x2cd02bd, 0x2ed02dd, 0x27f02fd
  .long 0x76afedcb, 0x15324098, 0x22222222, 0x22222a22, 0x12, 0x221a02, 0x1, 0x0
  .long 0x21b020b, 0x23b022b, 0x25b024b, 0x27b026b, 0x2ab029b, 0x2cb02bb, 0x2eb02db, 0x28f02fb
  .long 0x765fedcb, 0xa4321098, 0x22c22222, 0x22222622, 0xa6, 0x2c0216, 0xa, 0x0
  .long 0x3650216, 0x42503e5, 0x73504a5, 0x7750755, 0x7d507b5, 0xb4507f5, 0xd050bc5, 0x29f0d85
  .long 0x76afedcb, 0x84321095, 0x22922222, 0x22222522, 0x82, 0x291502, 0x8, 0x0
  .long 0x2180208, 0x2380228, 0x2580248, 0x2780268, 0x2980288, 0x2c802b8, 0x2e802d8, 0x2af02f8
  .long 0x765aefcb, 0xd4321098, 0x22f22222, 0x22222f22, 0xd2, 0x2f1f02, 0xd, 0x0
  .long 0x2120202, 0x2320222, 0x2520242, 0x2720262, 0x2920282, 0x2c202a2, 0x2e202d2, 0x2bf02f2
  .long 0x76afedcb, 0x4351298, 0x22222222, 0x22222522, 0x2, 0x221502, 0x0, 0x0
  .long 0x21a020a, 0x23a022a, 0x25a024a, 0x27a026a, 0x29a028a, 0x2ba02aa, 0x2ea02da, 0x2cf02fa
  .long 0x765fedcb, 0x943210a8, 0x22722222, 0x22222022, 0x92, 0x271002, 0x9, 0x0
  .long 0x2190209, 0x2390229, 0x2570249, 0x2790269, 0x2990289, 0x2b902a9, 0x2e902c9, 0x2df02f9
  .long 0x765fadcb, 0xe4321098, 0x22a22222, 0x22222e22, 0xe2, 0x2a1e02, 0xe, 0x0
  .long 0x2130203, 0x2330223, 0x2530243, 0x2730260, 0x2930283, 0x2b302a3, 0x2d302c3, 0x2ef02f3
  .long 0x765fedab, 0xc4321098, 0x22922222, 0x22222d22, 0xc2, 0x291d02, 0xc, 0x0
  .long 0x2110201, 0x2310221, 0x2510241, 0x2710261, 0x2910281, 0x2b102a1, 0x2d102c1, 0x2ff02e1
  .long 0x76afedcb, 0x84321059, 0x33b33333, 0x33333133, 0x83, 0x2b1103, 0x8, 0x0
  .long 0x3280318, 0x3480338, 0x3680358, 0x3880378, 0x3a80398, 0x3c803b8, 0x3e803d8, 0x30f03f8
  .long 0x765aedcb, 0xf4321098, 0x33933333, 0x33333e33, 0xf3, 0x291e03, 0xf, 0x0
  .long 0x3240304, 0x3440334, 0x3640354, 0x3840374, 0x3a40394, 0x3c403b4, 0x3e403d4, 0x31f03f4
  .long 0x76afedcb, 0x4321598, 0x33033333, 0x33333233, 0x3, 0x201203, 0x0, 0x0
  .long 0x31a030a, 0x34a033a, 0x36a035a, 0x38a037a, 0x3aa039a, 0x3ca03ba, 0x3ea03da, 0x32f03fa
  .long 0x765fedac, 0xb4321098, 0x33a33333, 0x33333b33, 0xb3, 0x2a1b03, 0xb, 0x0
  .long 0x3100300, 0x3400320, 0x3600350, 0x3800370, 0x3a00390, 0x3c003b0, 0x3e003d0, 0x33f03f0
  .long 0x76afedcb, 0x24531098, 0x33133333, 0x33333a33, 0x23, 0x211a03, 0x2, 0x0
  .long 0x31c030c, 0x33c032c, 0x36c035c, 0x38c037c, 0x3ac039c, 0x3cc03bc, 0x3ec03dc, 0x34f03fc
  .long 0xa65fedcb, 0x74321098, 0x33933333, 0x33333133, 0x73, 0x291103, 0x7, 0x0
  .long 0x3170307, 0x3370327, 0x3670347, 0x3870377, 0x3a70397, 0x3c703b7, 0x3e703d6, 0x35f03f7
  .long 0x76afedcb, 0x15324098, 0x33333333, 0x33333633, 0x13, 0x231603, 0x1, 0x0
  .long 0x31b030b, 0x33b032b, 0x35b034b, 0x38b037b, 0x3ab039b, 0x3cb03bb, 0x3eb03db, 0x36f03fb
  .long 0x765fadcb, 0xe4321098, 0x33e33333, 0x33333a33, 0xe3, 0x2e1a03, 0xe, 0x0
  .long 0x3130303, 0x3330323, 0x3530343, 0x3830363, 0x3a30393, 0x3c303b3, 0x3e303d3, 0x37f03f2
  .long 0x76afedcb, 0x94321058, 0x33b33333, 0x33333133, 0x93, 0x2b1103, 0x9, 0x0
  .long 0x3190308, 0x3390329, 0x3590349, 0x3790369, 0x3a90399, 0x3c903b9, 0x3e903d9, 0x38f03f9
  .long 0x765fedcb, 0xa4321098, 0x33933333, 0x33333e33, 0xae, 0x29031e, 0xa, 0x0
  .long 0x1320103, 0x1b20183, 0x2e30263, 0x4740314, 0x82304f4, 0xd5208a3, 0xe420dd2, 0x39f0ec2
  .long 0x76afedcb, 0x54321098, 0x33033333, 0x33333233, 0x50, 0x120320, 0x5, 0x0
  .long 0x1fb017b, 0x65e032a, 0x73c06de, 0xaeb07bc, 0xc6a0c4d, 0xd0c0ccd, 0xf1e0d8c, 0x3af0f9e
  .long 0x765fedab, 0xc4321098, 0x33a33333, 0x33333b33, 0xc3, 0x2a1b03, 0xc, 0x0
  .long 0x3110301, 0x3300321, 0x3510341, 0x3710361, 0x3910381, 0x3c103a1, 0x3e103d1, 0x3bf03f1
  .long 0x76afedcb, 0x34521098, 0x33133333, 0x33333a33, 0x33, 0x211a03, 0x3, 0x0
  .long 0x31d030d, 0x33d032d, 0x35d034c, 0x37d036d, 0x39d038d, 0x3bd03ad, 0x3ed03dd, 0x3cf03fd
  .long 0xa75fedcb, 0x64321098, 0x33933333, 0x33333133, 0x63, 0x291103, 0x6, 0x0
  .long 0x3160306, 0x3360326, 0x3560346, 0x3760366, 0x3960386, 0x3b603a6, 0x3e603c6, 0x3df03f6
  .long 0x76afedcb, 0x45321098, 0x33333333, 0x33333633, 0x43, 0x231603, 0x4, 0x0
  .long 0x31e030e, 0x33e032e, 0x35e034e, 0x37e036b, 0x39e038e, 0x3be03ae, 0x3de03ce, 0x3ef03fe
  .long 0x765faecb, 0xd4321098, 0x33e33333, 0x33333a33, 0xd3, 0x2e1a03, 0xd, 0x0
  .long 0x3120302, 0x3320322, 0x3520342, 0x3720362, 0x3920382, 0x3b203a2, 0x3d203c2, 0x3ff03e2
  .long 0x765fedcb, 0x8432109a, 0x44a44444, 0x44444944, 0x84, 0x2a1904, 0x8, 0x0
  .long 0x4280418, 0x4480438, 0x4680458, 0x4870478, 0x4a80498, 0x4c804b8, 0x4e804d8, 0x40f04f8
  .long 0x76afedcb, 0x4521398, 0x44544444, 0x44444544, 0x4, 0x251504, 0x0, 0x0
  .long 0x42a040a, 0x44a043a, 0x46a045a, 0x48a047a, 0x4aa049a, 0x4ca04ba, 0x4ea04da, 0x41f04fa
  .long 0x76afedcb, 0x24351098, 0x44344444, 0x44444644, 0x24, 0x231604, 0x2, 0x0
  .long 0x41c040c, 0x44c043c, 0x46c045c, 0x48c047c, 0x4ac049c, 0x4cc04bc, 0x4ec04dc, 0x42f04fc
  .long 0x76afedcb, 0x45321098, 0x44444444, 0x44444a44, 0x44, 0x241a04, 0x4, 0x0
  .long 0x41e040e, 0x44e042e, 0x46e045e, 0x48e047e, 0x4ae049e, 0x4ce04bb, 0x4ee04de, 0x43f04fe
  .long 0x765fadce, 0xb4321098, 0x44744444, 0x44444b44, 0xb4, 0x271b04, 0xb, 0x0
  .long 0x4100400, 0x4300420, 0x4600450, 0x4800470, 0x4a00490, 0x4c004b0, 0x4e004d0, 0x44f04f0
  .long 0x765feacb, 0xd4321098, 0x44644444, 0x44444c44, 0xd4, 0x261c04, 0xd, 0x0
  .long 0x4120402, 0x4320422, 0x4620442, 0x4820472, 0x4a20492, 0x4c204b2, 0x4e204d2, 0x45f04f2
  .long 0x79afedcb, 0x64321058, 0x44744444, 0x44444744, 0x64, 0x271704, 0x6, 0x0
  .long 0x4160406, 0x4360426, 0x4560446, 0x4860476, 0x4a60496, 0x4c604b6, 0x4e604d6, 0x46f04f6
  .long 0x765aedcb, 0xf4321098, 0x44644444, 0x44444e44, 0xf4, 0x261e04, 0xf, 0x0
  .long 0x4140404, 0x4340424, 0x4540444, 0x4840464, 0x4a40494, 0x4c404b4, 0x4e404d4, 0x47f04f1
  .long 0x865fedcb, 0x7432109a, 0x44a44444, 0x44444944, 0x74, 0x2a1904, 0x7, 0x0
  .long 0x4170407, 0x4370427, 0x4570447, 0x4770467, 0x4a70497, 0x4c704b7, 0x4e704d7, 0x48f04f7
  .long 0x76afedcb, 0x34521098, 0x44544444, 0x44444544, 0x34, 0x251504, 0x3, 0x0
  .long 0x41a040d, 0x43d042d, 0x45d044d, 0x47d046d, 0x4ad048d, 0x4cd04bd, 0x4ed04dd, 0x49f04fd
  .long 0x76afedcb, 0x54321098, 0x44344444, 0x44444644, 0x53, 0x160423, 0x5, 0x0
  .long 0x1de015e, 0x3ee036e, 0x81b042c, 0x89b087e, 0x93d08fe, 0xd4e09bd, 0xf0d0dce, 0x4af0f8d
  .long 0x76afedcb, 0x15324098, 0x44444444, 0x44444a44, 0x14, 0x241a04, 0x1, 0x0
  .long 0x41b040b, 0x43b042b, 0x45b044b, 0x47b046b, 0x49b048b, 0x4cb04ab, 0x4eb04db, 0x4bf04fb
  .long 0x765fadcb, 0xe4321098, 0x44744444, 0x44444b44, 0xe4, 0x271b04, 0xe, 0x0
  .long 0x4130403, 0x4330423, 0x4530440, 0x4730463, 0x4930483, 0x4b304a3, 0x4e304d3, 0x4cf04f3
  .long 0x765fedcb, 0xa4321098, 0x44644444, 0x44444c44, 0xac, 0x26041c, 0xa, 0x0
  .long 0x5230452, 0x76405a3, 0x94207e4, 0xb1109c2, 0xb910b34, 0xc030bb4, 0xf740c83, 0x4df0ff4
  .long 0x76afedcb, 0x94321058, 0x44744444, 0x44444744, 0x94, 0x271704, 0x9, 0x0
  .long 0x4190409, 0x4390429, 0x4590449, 0x4790466, 0x4990489, 0x4b904a9, 0x4d904c9, 0x4ef04f9
  .long 0x765aedfb, 0xc4321098, 0x44644444, 0x44444e44, 0xc4, 0x261e04, 0xc, 0x0
  .long 0x4110401, 0x4310421, 0x4510441, 0x4710461, 0x4910481, 0x4b104a1, 0x4d104c1, 0x4ff04e1
  .long 0x76afedcb, 0x34521098, 0x55455555, 0x55555855, 0x35, 0x241805, 0x3, 0x0
  .long 0x52d051d, 0x54d053d, 0x56d055d, 0x58c057d, 0x5ad059d, 0x5cd05bd, 0x5ed05dd, 0x50f05fd
  .long 0x765fedcb, 0x943210a8, 0x55f55555, 0x55555a55, 0x95, 0x2f1a05, 0x9, 0x0
  .long 0x5290509, 0x5490539, 0x5690559, 0x5890579, 0x5a90596, 0x5c905b9, 0x5e905d9, 0x51f05f9
  .long 0x765fadeb, 0xc4321098, 0x55755555, 0x55555c55, 0xc5, 0x271c05, 0xc, 0x0
  .long 0x5110501, 0x5410531, 0x5610551, 0x5810571, 0x5a10591, 0x5c105b1, 0x5e105d1, 0x52f05f1
  .long 0x765feacd, 0xb4321098, 0x55c55555, 0x55555d55, 0xb5, 0x2c1d05, 0xb, 0x0
  .long 0x5100500, 0x5400520, 0x5600550, 0x5800570, 0x5a00590, 0x5c005b0, 0x5e005d0, 0x53f05f0
  .long 0xa65fedcb, 0x74321098, 0x55b55555, 0x55555455, 0x75, 0x2b1405, 0x7, 0x0
  .long 0x5170507, 0x5370527, 0x5670557, 0x5870577, 0x5a70597, 0x5c705b7, 0x5e705d7, 0x54f05f7
  .long 0x76afedcb, 0x84321095, 0x55f55555, 0x55555755, 0x85, 0x2f1705, 0x8, 0x0
  .long 0x5180508, 0x5380528, 0x5680548, 0x5880578, 0x5a80598, 0x5c805b8, 0x5e805d8, 0x55f05f8
  .long 0x76afedcb, 0x4325198, 0x55255555, 0x55555255, 0x5, 0x221205, 0x0, 0x0
  .long 0x51a050a, 0x53a052a, 0x55a054a, 0x58a057a, 0x5aa059a, 0x5ca05ba, 0x5ea05da, 0x56f05fa
  .long 0x765aedcb, 0xf4321098, 0x55955555, 0x55555d55, 0xf5, 0x291d05, 0xf, 0x0
  .long 0x5140504, 0x5340524, 0x5540544, 0x5840564, 0x5a40594, 0x5c405b4, 0x5e405d4, 0x57f05f4
  .long 0x76afedcb, 0x24531098, 0x55455555, 0x55555855, 0x25, 0x241805, 0x2, 0x0
  .long 0x51c050c, 0x53c052c, 0x55c054c, 0x57c056c, 0x5ac059c, 0x5cc05bc, 0x5ec05dc, 0x58f05fc
  .long 0x795fedcb, 0x643210a8, 0x55f55555, 0x55555a55, 0x65, 0x2f1a05, 0x6, 0x0
  .long 0x5160506, 0x5360526, 0x5560546, 0x5760566, 0x5a60586, 0x5c605b6, 0x5e605d6, 0x59f05f6
  .long 0x765fadcb, 0xe4321098, 0x55755555, 0x55555c55, 0xe5, 0x271c05, 0xe, 0x0
  .long 0x5130503, 0x5330521, 0x5530543, 0x5730563, 0x5930583, 0x5c305b3, 0x5e305d3, 0x5af05f3
  .long 0x765feacb, 0xd4321098, 0x55c55555, 0x55555d55, 0xd5, 0x2c1d05, 0xd, 0x0
  .long 0x5120502, 0x5300522, 0x5520542, 0x5720562, 0x5920582, 0x5c205a2, 0x5e205d2, 0x5bf05f2
  .long 0x765fedcb, 0xa4321098, 0x55b55555, 0x55555455, 0xa4, 0x2b0514, 0xa, 0x0
  .long 0xf50075, 0x6350547, 0x81506b5, 0x8950855, 0xb6508d5, 0xc290be5, 0xf050ca9, 0x5cf0f85
  .long 0x76afedcb, 0x54321098, 0x55f55555, 0x55555755, 0x5f, 0x17052f, 0x5, 0x0
  .long 0xc50045, 0x2b50235, 0x5580515, 0x8650595, 0xd2508e5, 0xdf50d75, 0xe850e05, 0x5df0fa5
  .long 0x76afedcb, 0x14325098, 0x55255555, 0x55555255, 0x15, 0x221205, 0x1, 0x0
  .long 0x51b050b, 0x53b052b, 0x55b054b, 0x57b056a, 0x59b058b, 0x5bb05ab, 0x5db05cb, 0x5ef05fb
  .long 0x76afedcb, 0x45321098, 0x55255555, 0x55555855, 0x45, 0x221805, 0x4, 0x0
  .long 0x51e050e, 0x53e052e, 0x55e054e, 0x57e056e, 0x59e058e, 0x5be05ae, 0x5de05ce, 0x5ff05ee
  .long 0x76afedcb, 0x24351098, 0x66166666, 0x66666566, 0x26, 0x211506, 0x2, 0x0
  .long 0x62c061c, 0x64c063c, 0x66c065c, 0x68c067c, 0x6ac069c, 0x6cc06bc, 0x6ec06dc, 0x60f06fc
  .long 0x765feacd, 0xb4321098, 0x66a66666, 0x66666b66, 0xb6, 0x2a1b06, 0xb, 0x0
  .long 0x6200600, 0x6400630, 0x6600650, 0x6800670, 0x6a00690, 0x6c006b0, 0x6e006d0, 0x61f06f0
  .long 0x76afedcb, 0x94321058, 0x66e66666, 0x66666366, 0x96, 0x2e1306, 0x9, 0x0
  .long 0x6190609, 0x6490639, 0x6690659, 0x6890679, 0x6a70699, 0x6c906b9, 0x6e906d9, 0x62f06f9
  .long 0x76afedcb, 0x4325198, 0x66166666, 0x66666466, 0x6, 0x211406, 0x0, 0x0
  .long 0x61a060a, 0x64a062a, 0x66a065a, 0x68a067a, 0x6aa069a, 0x6ca06ba, 0x6ea06da, 0x63f06fa
  .long 0x76afedcb, 0x84321095, 0x66566666, 0x66666966, 0x86, 0x251906, 0x8, 0x0
  .long 0x6180608, 0x6380628, 0x6680658, 0x6880678, 0x6a80698, 0x6c606b8, 0x6e806d8, 0x64f06f8
  .long 0x76afedcb, 0x45321098, 0x66066666, 0x66666566, 0x46, 0x201506, 0x4, 0x0
  .long 0x61e060e, 0x63e062e, 0x66e064e, 0x68e067e, 0x6ae069e, 0x6ce06be, 0x6ee06dd, 0x65f06fe
  .long 0x765fedcb, 0xa4321098, 0x66966666, 0x66666a66, 0xaa, 0x29061a, 0xa, 0x0
  .long 0x2850205, 0x3730345, 0x3f303c5, 0x4b50435, 0x5990519, 0x92506e3, 0xb5209a5, 0x66f0ed4
  .long 0x765aedfb, 0xc4321098, 0x66866666, 0x66666f66, 0xc6, 0x281f06, 0xc, 0x0
  .long 0x6110601, 0x6310621, 0x6510641, 0x6810661, 0x6a10691, 0x6c106b1, 0x6e106d1, 0x67f06f1
  .long 0x76afedcb, 0x54321098, 0x66166666, 0x66666566, 0x51, 0x150621, 0x5, 0x0
  .long 0x3cd034d, 0x63b060c, 0x91e06bb, 0xa2d099e, 0xb6d0aad, 0xbdc0b7e, 0xbfe0bed, 0x68f0e5d
  .long 0x765feacb, 0xd4321098, 0x66a66666, 0x66666b66, 0xd6, 0x2a1b06, 0xd, 0x0
  .long 0x6100602, 0x6320622, 0x6520642, 0x6720662, 0x6a20682, 0x6c206b2, 0x6e206d2, 0x69f06f2
  .long 0x96afedcb, 0x74321058, 0x66e66666, 0x66666366, 0x76, 0x2e1306, 0x7, 0x0
  .long 0x6170607, 0x6370627, 0x6570647, 0x6770667, 0x6970687, 0x6c706b7, 0x6e706d7, 0x6af06f7
  .long 0x76afedcb, 0x14325098, 0x66166666, 0x66666466, 0x16, 0x211406, 0x1, 0x0
  .long 0x61b060b, 0x63a062b, 0x65b064b, 0x67b066b, 0x69b068b, 0x6cb06ab, 0x6eb06db, 0x6bf06fb
  .long 0x78afedcb, 0x64321095, 0x66566666, 0x66666966, 0x66, 0x251906, 0x6, 0x0
  .long 0x6160606, 0x6360626, 0x6560646, 0x6760666, 0x6960686, 0x6b606a6, 0x6e606d6, 0x6cf06f6
  .long 0x76afedcb, 0x35421098, 0x66066666, 0x66666566, 0x36, 0x201506, 0x3, 0x0
  .long 0x61d060d, 0x63d062d, 0x65d064d, 0x67d066d, 0x69d068d, 0x6bd06ad, 0x6ed06cd, 0x6df06fd
  .long 0x765fadcb, 0xe4321098, 0x66966666, 0x66666a66, 0xe6, 0x291a06, 0xe, 0x0
  .long 0x6130603, 0x6330623, 0x6530643, 0x6730663, 0x6930683, 0x6b306a3, 0x6d306c3, 0x6ef06f3
  .long 0x765aedcb, 0xf4321098, 0x66866666, 0x66666f66, 0xf6, 0x281f06, 0xf, 0x0
  .long 0x6140604, 0x6340624, 0x6540644, 0x6710664, 0x6940684, 0x6b406a4, 0x6d406c4, 0x6ff06e4
  .long 0x765fadcb, 0xe4321098, 0x77d77777, 0x77777f77, 0xe7, 0x2d1f07, 0xe, 0x0
  .long 0x7230713, 0x7430733, 0x7630753, 0x7800773, 0x7a30793, 0x7c307b3, 0x7e307d3, 0x70f07f3
  .long 0x76afedcb, 0x4321598, 0x77277777, 0x77777177, 0x7, 0x221107, 0x0, 0x0
  .long 0x72a070a, 0x74a073a, 0x76a075a, 0x78a077a, 0x7aa079a, 0x7ca07ba, 0x7ea07da, 0x71f07fa
  .long 0x765fedcb, 0xa4321098, 0x77877777, 0x77777d77, 0xad, 0x28071d, 0xa, 0x0
  .long 0xc30043, 0x53202f1, 0x5b20574, 0x96307a1, 0xa0409e3, 0xa840a13, 0xf520a93, 0x72f0fd2
  .long 0x76afedcb, 0x24351098, 0x77077777, 0x77777677, 0x27, 0x201607, 0x2, 0x0
  .long 0x71c070c, 0x74c072c, 0x76c075c, 0x78c077c, 0x7ac079c, 0x7cc07bb, 0x7ec07dc, 0x73f07fc
  .long 0x56afedcb, 0x74321098, 0x77677777, 0x77777377, 0x77, 0x261307, 0x7, 0x0
  .long 0x7170707, 0x7370727, 0x7670757, 0x7870777, 0x7a70797, 0x7c607b7, 0x7e707d7, 0x74f07f7
  .long 0x76afedcb, 0x45321098, 0x77477777, 0x77777677, 0x47, 0x241607, 0x4, 0x0
  .long 0x71e070e, 0x73e072e, 0x76e074e, 0x78e077e, 0x7ae079e, 0x7ce07be, 0x7ee07dd, 0x75f07fe
  .long 0x765aefcb, 0xd4321098, 0x77e77777, 0x77777c77, 0xd7, 0x2e1c07, 0xd, 0x0
  .long 0x7120702, 0x7320722, 0x7520742, 0x7820772, 0x7a20792, 0x7c207b2, 0x7e207d2, 0x76f07f2
  .long 0x76afedcb, 0x94321058, 0x77c77777, 0x77777677, 0x97, 0x2c1607, 0x9, 0x0
  .long 0x7190709, 0x7390729, 0x7590749, 0x7890769, 0x7a90799, 0x7c907b9, 0x7e907d9, 0x77f07f8
  .long 0x765fadce, 0xb4321098, 0x77d77777, 0x77777f77, 0xb7, 0x2d1f07, 0xb, 0x0
  .long 0x7100700, 0x7300720, 0x7500740, 0x7700760, 0x7a00790, 0x7c007b0, 0x7e007d0, 0x78f07f0
  .long 0x76afedcb, 0x54321098, 0x77277777, 0x77777177, 0x52, 0x110722, 0x5, 0x0
  .long 0x24c020e, 0x28e027d, 0x56b02cc, 0x5fe05eb, 0xa3e071a, 0xc5e0abe, 0xdad0cde, 0x79f0f2a
  .long 0x765fedab, 0xc4321098, 0x77877777, 0x77777d77, 0xc7, 0x281d07, 0xc, 0x0
  .long 0x7110701, 0x7310721, 0x7510741, 0x7710761, 0x7910781, 0x7c107b1, 0x7e107d1, 0x7af07f1
  .long 0x76afedcb, 0x14352098, 0x77077777, 0x77777677, 0x17, 0x201607, 0x1, 0x0
  .long 0x71b070b, 0x73b072b, 0x75b074b, 0x77b076b, 0x79b078b, 0x7cb07ab, 0x7eb07db, 0x7bf07fb
  .long 0x57afedcb, 0x64321098, 0x77677777, 0x77777377, 0x67, 0x261307, 0x6, 0x0
  .long 0x7160706, 0x7360726, 0x7560746, 0x7760766, 0x7960786, 0x7b607a6, 0x7e607d6, 0x7cf07f6
  .long 0x76afedcb, 0x35421098, 0x77477777, 0x77777677, 0x37, 0x241607, 0x3, 0x0
  .long 0x71d070d, 0x73d072d, 0x75d074d, 0x77d076d, 0x79d078d, 0x7bd07ad, 0x7ed07cd, 0x7df07fd
  .long 0x765aedcb, 0xf4321098, 0x77e77777, 0x77777c77, 0xf7, 0x2e1c07, 0xf, 0x0
  .long 0x7140704, 0x7340724, 0x7540744, 0x7740762, 0x7940784, 0x7b407a4, 0x7d407c4, 0x7ef07f4
  .long 0x76afedcb, 0x84321059, 0x77c77777, 0x77777677, 0x87, 0x2c1607, 0x8, 0x0
  .long 0x7180708, 0x7380728, 0x7580748, 0x7780768, 0x7980788, 0x7b807a8, 0x7d807c8, 0x7ff07e8
  .long 0x765aedcb, 0xf4321098, 0x88e88888, 0x88888b88, 0xf8, 0x2e1b08, 0xf, 0x0
  .long 0x8240814, 0x8440834, 0x8640854, 0x8810874, 0x8a40894, 0x8c408b4, 0x8e408d4, 0x80f08f4
  .long 0x76afedcb, 0x14325098, 0x88388888, 0x88888488, 0x18, 0x231408, 0x1, 0x0
  .long 0x82b080b, 0x84b083b, 0x86b085b, 0x88b087b, 0x8ab089a, 0x8cb08bb, 0x8eb08db, 0x81f08fb
  .long 0x765fadcb, 0xe4321098, 0x88688888, 0x88888e88, 0xe8, 0x261e08, 0xe, 0x0
  .long 0x8130803, 0x8430833, 0x8630853, 0x8830873, 0x8a00893, 0x8c308b3, 0x8e308d3, 0x82f08f3
  .long 0x96afedcb, 0x74321058, 0x88788888, 0x88888888, 0x78, 0x271808, 0x7, 0x0
  .long 0x8170807, 0x8470827, 0x8670857, 0x8870877, 0x8a70897, 0x8c708b7, 0x8e708d7, 0x83f08f7
  .long 0x76afedcb, 0x34521098, 0x88488888, 0x88888788, 0x38, 0x241708, 0x3, 0x0
  .long 0x81d080d, 0x83d082d, 0x86d085d, 0x88d087d, 0x8ad089d, 0x8cd08bd, 0x8ed08dd, 0x84f08fd
  .long 0x76afedcb, 0x54321098, 0x88e88888, 0x88888488, 0x5e, 0x14082e, 0x5, 0x0
  .long 0x3750145, 0x62903f5, 0x76506a9, 0x80507e5, 0x8c50885, 0xa1508d6, 0xc350a95, 0x85f0cb5
  .long 0x765fedcb, 0x8432109a, 0x88f88888, 0x88888988, 0x88, 0x2f1908, 0x8, 0x0
  .long 0x8180808, 0x8380828, 0x8580848, 0x8880878, 0x8a80898, 0x8c808b8, 0x8e808d8, 0x86f08f8
  .long 0x76afedcb, 0x45321098, 0x88388888, 0x88888788, 0x48, 0x231708, 0x4, 0x0
  .long 0x81e080e, 0x83e082e, 0x85e084e, 0x88e086e, 0x8ae089e, 0x8ce08be, 0x8ee08de, 0x87f08fc
  .long 0x765aedfb, 0xc4321098, 0x88e88888, 0x88888b88, 0xc8, 0x2e1b08, 0xc, 0x0
  .long 0x8110801, 0x8310821, 0x8510841, 0x8710861, 0x8a10891, 0x8c108b1, 0x8e108d1, 0x88f08f1
  .long 0x76afedcb, 0x4325198, 0x88388888, 0x88888488, 0x8, 0x231408, 0x0, 0x0
  .long 0x81a080a, 0x83a082a, 0x85a084a, 0x87a086a, 0x8aa088a, 0x8ca08ba, 0x8ea08da, 0x89f08fa
  .long 0x765fadce, 0xb4321098, 0x88688888, 0x88888e88, 0xb8, 0x261e08, 0xb, 0x0
  .long 0x8100800, 0x8300820, 0x8500840, 0x8700860, 0x8900880, 0x8c008b0, 0x8e008d0, 0x8af08f0
  .long 0x76afedcb, 0x94321058, 0x88788888, 0x88888888, 0x98, 0x271808, 0x9, 0x0
  .long 0x8190809, 0x8370829, 0x8590849, 0x8790869, 0x8990889, 0x8c908a9, 0x8e908d9, 0x8bf08f9
  .long 0x765feacb, 0xd4321098, 0x88e88888, 0x88888f88, 0xd8, 0x2e1f08, 0xd, 0x0
  .long 0x8120802, 0x8320822, 0x8520842, 0x8720862, 0x8920882, 0x8b208a2, 0x8e208d2, 0x8cf08f2
  .long 0x75afedcb, 0x64321098, 0x88e88888, 0x88888488, 0x68, 0x2e1408, 0x6, 0x0
  .long 0x8160806, 0x8360826, 0x8560846, 0x8760866, 0x8960886, 0x8b608a6, 0x8e608c6, 0x8df08f6
  .long 0x765fedcb, 0xa4321098, 0x88f88888, 0x88888988, 0xa9, 0x2f0819, 0xa, 0x0
  .long 0x4880408, 0x6c50645, 0xa350868, 0xc550ab5, 0xcd50c75, 0xe250cf5, 0xf150ea5, 0x8ef0f95
  .long 0x76afedcb, 0x25341098, 0x88388888, 0x88888788, 0x28, 0x231708, 0x2, 0x0
  .long 0x81c080c, 0x83c082c, 0x85c084c, 0x87c086c, 0x89c088c, 0x8bc08ac, 0x8dc08cc, 0x8ff08ec
  .long 0x78afedcb, 0x64321095, 0x99799999, 0x99999099, 0x69, 0x271009, 0x6, 0x0
  .long 0x9260916, 0x9460936, 0x9660956, 0x9860976, 0x9a60996, 0x9c609b6, 0x9e609d6, 0x90f09f6
  .long 0x76afedcb, 0x45321098, 0x99199999, 0x99999899, 0x49, 0x211809, 0x4, 0x0
  .long 0x92e090e, 0x94e093e, 0x96e095e, 0x98e097e, 0x9ae099c, 0x9ce09be, 0x9ee09de, 0x91f09fe
  .long 0x76afedcb, 0x14325098, 0x99599999, 0x99999a99, 0x19, 0x251a09, 0x1, 0x0
  .long 0x91b090b, 0x94b093b, 0x96b095b, 0x98b097b, 0x9ab099b, 0x9cb09bb, 0x9eb09db, 0x92f09fb
  .long 0x76afedcb, 0x4521398, 0x99399999, 0x99999599, 0x9, 0x231509, 0x0, 0x0
  .long 0x91a090a, 0x94a092a, 0x96a095a, 0x98a097a, 0x9aa099a, 0x9ca09ba, 0x9ea09da, 0x93f09fa
  .long 0x765feacb, 0xd4321098, 0x99999999, 0x99999c99, 0xd9, 0x291c09, 0xd, 0x0
  .long 0x9120902, 0x9320922, 0x9620952, 0x9820972, 0x9a20992, 0x9c009b2, 0x9e209d2, 0x94f09f2
  .long 0x765aedcb, 0xf4321098, 0x99c99999, 0x99999b99, 0xf9, 0x2c1b09, 0xf, 0x0
  .long 0x9140904, 0x9340924, 0x9640944, 0x9840974, 0x9a40994, 0x9c409b4, 0x9e409d4, 0x95f09f4
  .long 0x765fadcb, 0xe4321098, 0x99599999, 0x99999d99, 0xe9, 0x251d09, 0xe, 0x0
  .long 0x9130903, 0x9330923, 0x9530943, 0x9830973, 0x9a30993, 0x9c309b3, 0x9e109d3, 0x96f09f3
  .long 0x76afedcb, 0x94321058, 0x99d99999, 0x99999599, 0x99, 0x2d1509, 0x9, 0x0
  .long 0x9190909, 0x9390929, 0x9590949, 0x9890969, 0x9a90999, 0x9c909b9, 0x9e909d9, 0x97f09f7
  .long 0x76afedcb, 0x84321095, 0x99799999, 0x99999099, 0x89, 0x271009, 0x8, 0x0
  .long 0x9180906, 0x9380928, 0x9580948, 0x9780968, 0x9a80998, 0x9c809b8, 0x9e809d8, 0x98f09f8
  .long 0x76afedcb, 0x25341098, 0x99199999, 0x99999899, 0x29, 0x211809, 0x2, 0x0
  .long 0x91c090c, 0x93c092c, 0x95c094c, 0x97c096c, 0x9ac098c, 0x9cc09bc, 0x9ec09dc, 0x99f09fc
  .long 0x76afedcb, 0x54321098, 0x99599999, 0x99999a99, 0x55, 0x1a0925, 0x5, 0x0
  .long 0x8e000e, 0x49d041d, 0x6c80648, 0x965092b, 0xb5509e5, 0xeb80e38, 0xf750ed5, 0x9af0ff5
  .long 0x76afedcb, 0x34521098, 0x99399999, 0x99999599, 0x39, 0x231509, 0x3, 0x0
  .long 0x91d090d, 0x93a092d, 0x95d094d, 0x97d096d, 0x99d098d, 0x9cd09ad, 0x9ed09dd, 0x9bf09fd
  .long 0x765feacd, 0xb4321098, 0x99999999, 0x99999c99, 0xb9, 0x291c09, 0xb, 0x0
  .long 0x9100900, 0x9300920, 0x9500940, 0x9700960, 0x9900980, 0x9b009a0, 0x9e009d0, 0x9cf09f0
  .long 0x765fedcb, 0xa4321098, 0x99c99999, 0x99999b99, 0xab, 0x2c091b, 0xa, 0x0
  .long 0x3b10331, 0x4c30443, 0x6920612, 0x8840804, 0xa610954, 0xd240ce2, 0xef30e73, 0x9df0fa3
  .long 0x765fadeb, 0xc4321098, 0x99599999, 0x99999d99, 0xc9, 0x251d09, 0xc, 0x0
  .long 0x9110901, 0x9310921, 0x9510941, 0x9710961, 0x9910981, 0x9b109a1, 0x9d109c1, 0x9ef09f1
  .long 0x96afedcb, 0x74321058, 0x99d99999, 0x99999599, 0x79, 0x2d1509, 0x7, 0x0
  .long 0x9170907, 0x9370927, 0x9570947, 0x9770967, 0x9970987, 0x9b709a7, 0x9d709c7, 0x9ff09e7
  .long 0x765aedcb, 0xf4321098, 0xaa6aaaaa, 0xaaaaadaa, 0xfa, 0x261d0a, 0xf, 0x0
  .long 0xa240a14, 0xa440a34, 0xa640a54, 0xa820a74, 0xaa40a94, 0xac40ab4, 0xae40ad4, 0xa0f0af4
  .long 0x765fadce, 0xb4321098, 0xaaeaaaaa, 0xaaaaadaa, 0xba, 0x2e1d0a, 0xb, 0x0
  .long 0xa200a00, 0xa400a30, 0xa600a50, 0xa800a70, 0xaa00a90, 0xac00ab0, 0xae00ad0, 0xa1f0af0
  .long 0x76afedcb, 0x34521098, 0xaa1aaaaa, 0xaaaaa7aa, 0x3a, 0x21170a, 0x3, 0x0
  .long 0xa1d0a0d, 0xa4d0a3d, 0xa6d0a5d, 0xa8d0a7d, 0xaac0a9d, 0xacd0abd, 0xaed0add, 0xa2f0afd
  .long 0x76afedcb, 0x45321098, 0xaa2aaaaa, 0xaaaaa9aa, 0x4a, 0x22190a, 0x4, 0x0
  .long 0xa1e0a0e, 0xa4e0a2e, 0xa6e0a5e, 0xa8e0a7e, 0xaae0a9e, 0xace0aba, 0xaee0ade, 0xa3f0afe
  .long 0x765fedcb, 0xa4321098, 0xaaaaaaaa, 0xaaaaa8aa, 0xa8, 0x2a0a18, 0xa, 0x0
  .long 0x1d50155, 0x5050275, 0x5f50585, 0x8b50835, 0x9950915, 0xda50ac5, 0xee50e65, 0xa4f0f25
  .long 0x86afedcb, 0x74321095, 0xaadaaaaa, 0xaaaaa2aa, 0x7a, 0x2d120a, 0x7, 0x0
  .long 0xa170a07, 0xa370a27, 0xa670a47, 0xa870a77, 0xaa70a97, 0xac70ab7, 0xae70ad7, 0xa5f0af7
  .long 0x765fedab, 0xc4321098, 0xaa6aaaaa, 0xaaaaabaa, 0xca, 0x261b0a, 0xc, 0x0
  .long 0xa110a01, 0xa310a21, 0xa510a41, 0xa810a71, 0xaa10a91, 0xac10ab1, 0xae10ad1, 0xa6f0af1
  .long 0x765fedcb, 0x943210a8, 0xaaaaaaaa, 0xaaaaa1aa, 0x9a, 0x2a110a, 0x9, 0x0
  .long 0xa190a09, 0xa390a29, 0xa590a49, 0xa890a69, 0xaa90a99, 0xac90ab9, 0xae90ad9, 0xa7f0af6
  .long 0x765aefcb, 0xd4321098, 0xaa6aaaaa, 0xaaaaadaa, 0xda, 0x261d0a, 0xd, 0x0
  .long 0xa120a02, 0xa320a22, 0xa520a42, 0xa720a62, 0xaa20a92, 0xac20ab2, 0xae20ad2, 0xa8f0af2
  .long 0x765fadcb, 0xe4321098, 0xaaeaaaaa, 0xaaaaadaa, 0xea, 0x2e1d0a, 0xe, 0x0
  .long 0xa100a03, 0xa330a23, 0xa530a43, 0xa730a63, 0xaa30a83, 0xac30ab3, 0xae30ad3, 0xa9f0af3
  .long 0x76afedcb, 0x24531098, 0xaa1aaaaa, 0xaaaaa7aa, 0x2a, 0x21170a, 0x2, 0x0
  .long 0xa1c0a0c, 0xa3c0a2c, 0xa5c0a4c, 0xa7c0a6c, 0xa9c0a8c, 0xacc0abc, 0xaec0adc, 0xaaf0afc
  .long 0x76afedcb, 0x5321498, 0xaa2aaaaa, 0xaaaaa9aa, 0xa, 0x22190a, 0x0, 0x0
  .long 0xa1a0a0a, 0xa3a0a2a, 0xa5a0a4a, 0xa7a0a6a, 0xa9a0a8a, 0xaca0aaa, 0xaea0ada, 0xabf0afa
  .long 0x76afedcb, 0x54321098, 0xaaaaaaaa, 0xaaaaa8aa, 0x5a, 0x180a2a, 0x5, 0x0
  .long 0x1a50125, 0x2e50265, 0x3b50335, 0x4850405, 0x6950615, 0xa750a45, 0xd550af5, 0xacf0dd5
  .long 0x76afedcb, 0x84321095, 0xaadaaaaa, 0xaaaaa2aa, 0x8a, 0x2d120a, 0x8, 0x0
  .long 0xa180a08, 0xa380a28, 0xa570a48, 0xa780a68, 0xa980a88, 0xab80aa8, 0xae80ac8, 0xadf0af8
  .long 0x76afedcb, 0x14325098, 0xaa0aaaaa, 0xaaaaa1aa, 0x1a, 0x20110a, 0x1, 0x0
  .long 0xa1b0a0b, 0xa3b0a2b, 0xa5b0a4b, 0xa7b0a6b, 0xa9b0a8b, 0xabb0aab, 0xadb0acb, 0xaef0afb
  .long 0x795fedcb, 0x643210a8, 0xaaaaaaaa, 0xaaaaa1aa, 0x6a, 0x2a110a, 0x6, 0x0
  .long 0xa160a06, 0xa360a26, 0xa560a46, 0xa760a66, 0xa960a86, 0xab60aa6, 0xad60ac6, 0xaff0ae6
  .long 0x765fedcb, 0xa4321098, 0xbb8bbbbb, 0xbbbbb7bb, 0xa7, 0x280b17, 0xa, 0x0
  .long 0x950015, 0x46501c5, 0x55504e5, 0x84505d5, 0x8f50875, 0xaa50a25, 0xf350b86, 0xb0f0fb5
  .long 0x765fedac, 0xb4321098, 0xbbdbbbbb, 0xbbbbbcbb, 0xbb, 0x2d1c0b, 0xb, 0x0
  .long 0xb200b00, 0xb400b30, 0xb600b50, 0xb800b70, 0xba00b90, 0xbc00bb0, 0xbe00bd0, 0xb1f0bf0
  .long 0x765fedcb, 0x943210a8, 0xbbcbbbbb, 0xbbbbb0bb, 0x9b, 0x2c100b, 0x9, 0x0
  .long 0xb190b09, 0xb490b39, 0xb690b59, 0xb890b79, 0xba70b99, 0xbc90bb9, 0xbe90bd9, 0xb2f0bf9
  .long 0x765afdcb, 0xe4321098, 0xbb6bbbbb, 0xbbbbbcbb, 0xeb, 0x261c0b, 0xe, 0x0
  .long 0xb130b03, 0xb430b23, 0xb630b53, 0xb830b73, 0xba30b93, 0xbc30bb3, 0xbe30bd3, 0xb3f0bf3
  .long 0x76afedcb, 0x84321095, 0xbb8bbbbb, 0xbbbbb6bb, 0x8b, 0x28160b, 0x8, 0x0
  .long 0xb180b08, 0xb380b28, 0xb680b58, 0xb880b78, 0xba80b98, 0xbc80bb8, 0xbe80bd8, 0xb4f0bf8
  .long 0x765feacb, 0xd4321098, 0xbb5bbbbb, 0xbbbbbabb, 0xdb, 0x251a0b, 0xd, 0x0
  .long 0xb120b02, 0xb320b22, 0xb620b42, 0xb820b72, 0xba20b92, 0xbc20bb2, 0xbe20bd2, 0xb5f0bf2
  .long 0x76afedcb, 0x34521098, 0xbb1bbbbb, 0xbbbbb4bb, 0x3b, 0x21140b, 0x3, 0x0
  .long 0xb1d0b0d, 0xb3d0b2d, 0xb5d0b4d, 0xb8d0b7d, 0xbad0b9d, 0xbcd0bbd, 0xbeb0bdd, 0xb6f0bfd
  .long 0x76afedcb, 0x5321498, 0xbb1bbbbb, 0xbbbbb2bb, 0xb, 0x21120b, 0x0, 0x0
  .long 0xb1a0b0a, 0xb3a0b2a, 0xb5a0b4a, 0xb8a0b6a, 0xbaa0b9a, 0xbca0bba, 0xbea0bda, 0xb7f0bfa
  .long 0x7a5fedcb, 0x64321098, 0xbb8bbbbb, 0xbbbbb7bb, 0x6b, 0x28170b, 0x6, 0x0
  .long 0xb160b06, 0xb360b26, 0xb560b46, 0xb760b66, 0xba60b96, 0xbc60bb6, 0xbe60bd6, 0xb8f0bf6
  .long 0x765fedab, 0xc4321098, 0xbbdbbbbb, 0xbbbbbcbb, 0xcb, 0x2d1c0b, 0xc, 0x0
  .long 0xb100b01, 0xb310b21, 0xb510b41, 0xb710b61, 0xba10b81, 0xbc10bb1, 0xbe10bd1, 0xb9f0bf1
  .long 0x965fedcb, 0x743210a8, 0xbbcbbbbb, 0xbbbbb0bb, 0x7b, 0x2c100b, 0x7, 0x0
  .long 0xb170b07, 0xb370b27, 0xb570b47, 0xb770b67, 0xb970b87, 0xbc70bb7, 0xbe70bd7, 0xbaf0bf7
  .long 0x765aedcb, 0xf4321098, 0xbb6bbbbb, 0xbbbbbcbb, 0xfb, 0x261c0b, 0xf, 0x0
  .long 0xb140b04, 0xb330b24, 0xb540b44, 0xb740b64, 0xb940b84, 0xbc40ba4, 0xbe40bd4, 0xbbf0bf4
  .long 0x76afedcb, 0x54321098, 0xbb8bbbbb, 0xbbbbb6bb, 0x58, 0x160b28, 0x5, 0x0
  .long 0xd50055, 0x1650135, 0x1e501b5, 0x6f50675, 0x7a50725, 0xb480b05, 0xc150b85, 0xbcf0c95
  .long 0x76afedcb, 0x24351098, 0xbb1bbbbb, 0xbbbbb3bb, 0x2b, 0x21130b, 0x2, 0x0
  .long 0xb1c0b0c, 0xb3c0b2c, 0xb5c0b4c, 0xb7c0b6c, 0xb9c0b8c, 0xbbc0bac, 0xbec0bcc, 0xbdf0bfc
  .long 0x76afedcb, 0x14523098, 0xbb1bbbbb, 0xbbbbb4bb, 0x1b, 0x21140b, 0x1, 0x0
  .long 0xb1b0b0b, 0xb3b0b2b, 0xb5b0b4b, 0xb7b0b6b, 0xb9b0b8b, 0xbbb0bab, 0xbdb0bcb, 0xbef0bfb
  .long 0x76afedcb, 0x45321098, 0xbb1bbbbb, 0xbbbbb2bb, 0x4b, 0x21120b, 0x4, 0x0
  .long 0xb1e0b0e, 0xb3e0b2e, 0xb5e0b4e, 0xb7a0b6e, 0xb9e0b8e, 0xbbe0bae, 0xbde0bce, 0xbff0bee
  .long 0x765fadce, 0xb4321098, 0xcccccccc, 0xcccccccc, 0xbc, 0x2c1c0c, 0xb, 0x0
  .long 0xc200c10, 0xc400c30, 0xc600c50, 0xc800c70, 0xca00c90, 0xcc00cb0, 0xce00cd0, 0xc0f0cf0
  .long 0x765aedfb, 0xc4321098, 0xcc8ccccc, 0xcccccfcc, 0xcc, 0x281f0c, 0xc, 0x0
  .long 0xc210c01, 0xc410c31, 0xc610c51, 0xc810c71, 0xca10c91, 0xcc10cb1, 0xce10cd1, 0xc1f0cf1
  .long 0x765fedcb, 0x843210a9, 0xccbccccc, 0xccccc4cc, 0x8c, 0x2b140c, 0x8, 0x0
  .long 0xc180c08, 0xc480c38, 0xc680c58, 0xc880c78, 0xca80c98, 0xcc80cb8, 0xce80cd8, 0xc2f0cf8
  .long 0x765fedcb, 0xa4321098, 0xcceccccc, 0xccccc1cc, 0xa1, 0x2e0c11, 0xa, 0x0
  .long 0x1a80128, 0x3570305, 0x3d70385, 0x7950715, 0xae50a79, 0xc450af9, 0xcb70c65, 0xc3f0cc5
  .long 0x76afedcb, 0x34521098, 0xcc0ccccc, 0xccccc1cc, 0x3c, 0x20110c, 0x3, 0x0
  .long 0xc1d0c0d, 0xc3d0c2d, 0xc6d0c5d, 0xc8d0c7d, 0xcad0c9d, 0xccb0cbd, 0xced0cdd, 0xc4f0cfd
  .long 0x76afedcb, 0x25341098, 0xcc2ccccc, 0xccccc9cc, 0x2c, 0x22190c, 0x2, 0x0
  .long 0xc1c0c0c, 0xc3c0c2c, 0xc6c0c4c, 0xc8c0c7c, 0xcac0c9c, 0xccc0cbc, 0xcec0cdc, 0xc5f0cfc
  .long 0x76afedcb, 0x4321598, 0xcc0ccccc, 0xccccc1cc, 0xc, 0x20110c, 0x0, 0x0
  .long 0xc1a0c0a, 0xc3a0c2a, 0xc5a0c4a, 0xc8a0c7a, 0xcaa0c9a, 0xcca0cba, 0xcea0cda, 0xc6f0cfa
  .long 0x76afedcb, 0x54321098, 0xcc7ccccc, 0xccccc9cc, 0x57, 0x190c27, 0x5, 0x0
  .long 0x990019, 0x2d50255, 0x4690445, 0x4e904c5, 0x5a50525, 0x8b90839, 0x9880908, 0xc7f0cf6
  .long 0x765fadcb, 0xe4321098, 0xcccccccc, 0xcccccccc, 0xec, 0x2c1c0c, 0xe, 0x0
  .long 0xc130c00, 0xc330c23, 0xc530c43, 0xc730c63, 0xca30c93, 0xcc30cb3, 0xce30cd3, 0xc8f0cf3
  .long 0x765aedcb, 0xf4321098, 0xcc8ccccc, 0xcccccfcc, 0xfc, 0x281f0c, 0xf, 0x0
  .long 0xc110c04, 0xc340c24, 0xc540c44, 0xc740c64, 0xca40c84, 0xcc40cb4, 0xce40cd4, 0xc9f0cf4
  .long 0x765fedcb, 0x943210a8, 0xccbccccc, 0xccccc4cc, 0x9c, 0x2b140c, 0x9, 0x0
  .long 0xc190c09, 0xc390c28, 0xc590c49, 0xc790c69, 0xc990c89, 0xcc90cb9, 0xce90cd9, 0xcaf0cf9
  .long 0xa65fedcb, 0x74321098, 0xcceccccc, 0xccccc1cc, 0x7c, 0x2e110c, 0x7, 0x0
  .long 0xc170c07, 0xc370c27, 0xc570c47, 0xc770c67, 0xc970c87, 0xcc70ca7, 0xce70cd7, 0xcbf0cf7
  .long 0x76afedcb, 0x14523098, 0xcc0ccccc, 0xccccc1cc, 0x1c, 0x20110c, 0x1, 0x0
  .long 0xc1b0c0b, 0xc3b0c2b, 0xc5b0c4b, 0xc7b0c6b, 0xc9b0c8b, 0xcbb0cab, 0xceb0cdb, 0xccf0cfb
  .long 0x76afedcb, 0x45321098, 0xcc2ccccc, 0xccccc9cc, 0x4c, 0x22190c, 0x4, 0x0
  .long 0xc1e0c0e, 0xc3e0c2e, 0xc5c0c4e, 0xc7e0c6e, 0xc9e0c8e, 0xcbe0cae, 0xcee0cce, 0xcdf0cfe
  .long 0x765feacb, 0xd4321098, 0xcc6ccccc, 0xcccccbcc, 0xdc, 0x261b0c, 0xd, 0x0
  .long 0xc120c02, 0xc320c22, 0xc520c42, 0xc720c62, 0xc920c82, 0xcb20ca2, 0xcd20cc2, 0xcef0cf2
  .long 0x75afedcb, 0x64321098, 0xcc7ccccc, 0xccccc9cc, 0x6c, 0x27190c, 0x6, 0x0
  .long 0xc160c06, 0xc360c26, 0xc560c46, 0xc760c66, 0xc960c86, 0xcb60ca6, 0xcd60cc6, 0xcff0ce6
  .long 0x76afedcb, 0x24351098, 0xdd0ddddd, 0xddddd6dd, 0x2d, 0x20160d, 0x2, 0x0
  .long 0xd2c0d1c, 0xd4c0d3c, 0xd6c0d5c, 0xd8b0d7c, 0xdac0d9c, 0xdcc0dbc, 0xdec0ddc, 0xd0f0dfc
  .long 0x56afedcb, 0x74321098, 0xdd6ddddd, 0xddddd3dd, 0x7d, 0x26130d, 0x7, 0x0
  .long 0xd270d07, 0xd470d37, 0xd670d57, 0xd870d77, 0xda70d97, 0xdc70db7, 0xde70dd7, 0xd1f0df7
  .long 0x765aedcb, 0xf4321098, 0xddfddddd, 0xdddddbdd, 0xfd, 0x2f1b0d, 0xf, 0x0
  .long 0xd140d04, 0xd440d34, 0xd640d54, 0xd840d74, 0xda40d94, 0xdc40db4, 0xde40dd4, 0xd2f0df4
  .long 0x76afedcb, 0x94321058, 0xdddddddd, 0xddddd3dd, 0x9d, 0x2d130d, 0x9, 0x0
  .long 0xd190d09, 0xd490d29, 0xd690d59, 0xd890d79, 0xda90d99, 0xdc90db6, 0xde90dd9, 0xd3f0df9
  .long 0x76afedcb, 0x45321098, 0xdd3ddddd, 0xddddd0dd, 0x4d, 0x23100d, 0x4, 0x0
  .long 0xd1e0d0e, 0xd3e0d2e, 0xd6e0d5e, 0xd8e0d7e, 0xdae0d9e, 0xdca0dbe, 0xdee0dde, 0xd4f0dfe
  .long 0x765feadb, 0xc4321098, 0xddaddddd, 0xdddddedd, 0xcd, 0x2a1e0d, 0xc, 0x0
  .long 0xd110d01, 0xd310d21, 0xd610d41, 0xd810d71, 0xda10d91, 0xdc10db1, 0xde10dd1, 0xd5f0df1
  .long 0x765fadce, 0xb4321098, 0xddbddddd, 0xdddddfdd, 0xbd, 0x2b1f0d, 0xb, 0x0
  .long 0xd100d00, 0xd300d20, 0xd500d40, 0xd800d70, 0xda00d90, 0xdc00db0, 0xde00dd0, 0xd6f0df0
  .long 0x765fedcb, 0xa4321098, 0xddfddddd, 0xddddd0dd, 0xa0, 0x2f0d10, 0xa, 0x0
  .long 0xe50065, 0x1950115, 0x2d90259, 0x9850905, 0xba90b29, 0xdc50d45, 0xe350df8, 0xd7f0eb5
  .long 0x76afedcb, 0x14352098, 0xdd0ddddd, 0xddddd6dd, 0x1d, 0x20160d, 0x1, 0x0
  .long 0xd1b0d0b, 0xd3b0d2b, 0xd5b0d4b, 0xd7b0d6b, 0xdab0d9b, 0xdcb0dbb, 0xdeb0ddb, 0xd8f0dfb
  .long 0x76afedcb, 0x54321098, 0xdd6ddddd, 0xddddd3dd, 0x56, 0x130d26, 0x5, 0x0
  .long 0x4750455, 0x4f504d5, 0x7c70747, 0x8a50825, 0xa650a05, 0xb350a85, 0xce50bb5, 0xd9f0d17
  .long 0x76afedcb, 0x34521098, 0xdd2ddddd, 0xddddd8dd, 0x3d, 0x22180d, 0x3, 0x0
  .long 0xd1d0d0d, 0xd3d0d2d, 0xd5d0d4d, 0xd7d0d6d, 0xd9d0d8d, 0xdcd0dbd, 0xded0ddd, 0xdaf0dfd
  .long 0x79afedcb, 0x64321058, 0xdddddddd, 0xddddd3dd, 0x6d, 0x2d130d, 0x6, 0x0
  .long 0xd160d06, 0xd360d26, 0xd560d46, 0xd760d66, 0xd960d86, 0xdc60da6, 0xde60dd6, 0xdbf0df6
  .long 0x76afedcb, 0x5321498, 0xdd3ddddd, 0xddddd0dd, 0xd, 0x23100d, 0x0, 0x0
  .long 0xd1a0d0a, 0xd3a0d2a, 0xd5a0d4a, 0xd7a0d6a, 0xd9a0d8a, 0xdba0daa, 0xdea0dda, 0xdcf0dfa
  .long 0x765feacb, 0xd4321098, 0xddaddddd, 0xdddddedd, 0xdd, 0x2a1e0d, 0xd, 0x0
  .long 0xd120d02, 0xd320d22, 0xd510d42, 0xd720d62, 0xd920d82, 0xdb20da2, 0xde20dc2, 0xddf0df2
  .long 0x765fadcb, 0xe4321098, 0xddbddddd, 0xdddddfdd, 0xed, 0x2b1f0d, 0xe, 0x0
  .long 0xd130d03, 0xd330d23, 0xd530d43, 0xd730d60, 0xd930d83, 0xdb30da3, 0xdd30dc3, 0xdef0df3
  .long 0x765fedcb, 0x8432109a, 0xddfddddd, 0xddddd0dd, 0x8d, 0x2f100d, 0x8, 0x0
  .long 0xd180d08, 0xd380d28, 0xd580d48, 0xd780d68, 0xd980d88, 0xdb80da8, 0xdd80dc8, 0xdff0de8
  .long 0x7a5fedcb, 0x64321098, 0xeefeeeee, 0xeeeee2ee, 0x6e, 0x2f120e, 0x6, 0x0
  .long 0xe260e16, 0xe460e36, 0xe660e56, 0xe860e76, 0xea60e96, 0xec60eb6, 0xee60ed6, 0xe0f0ef6
  .long 0x76afedcb, 0x4351298, 0xee4eeeee, 0xeeeee2ee, 0xe, 0x24120e, 0x0, 0x0
  .long 0xe2a0e0a, 0xe4a0e3a, 0xe6a0e5a, 0xe8a0e7a, 0xeaa0e9a, 0xeca0eba, 0xeea0eda, 0xe1f0efa
  .long 0x76afedcb, 0x45321098, 0xee4eeeee, 0xeeeee9ee, 0x4e, 0x24190e, 0x4, 0x0
  .long 0xe1e0e0e, 0xe4e0e3e, 0xe6e0e5e, 0xe8e0e7e, 0xeab0e9e, 0xece0ebe, 0xeee0ede, 0xe2f0efe
  .long 0x76afedcb, 0x84321095, 0xee5eeeee, 0xeeeee0ee, 0x8e, 0x25100e, 0x8, 0x0
  .long 0xe180e08, 0xe480e28, 0xe680e58, 0xe880e78, 0xea80e98, 0xec80eb7, 0xee80ed8, 0xe3f0ef8
  .long 0x765feadb, 0xc4321098, 0xeeceeeee, 0xeeeeeeee, 0xce, 0x2c1e0e, 0xc, 0x0
  .long 0xe110e01, 0xe310e21, 0xe610e51, 0xe810e71, 0xea10e91, 0xec10eb1, 0xee10ed1, 0xe4f0ef1
  .long 0x76afedcb, 0x34521098, 0xee1eeeee, 0xeeeee3ee, 0x3e, 0x21130e, 0x3, 0x0
  .long 0xe1d0e0d, 0xe3d0e2d, 0xe6d0e4d, 0xe8d0e7d, 0xead0e9d, 0xecd0ebd, 0xeed0edd, 0xe5f0efd
  .long 0x76afedcb, 0x54321098, 0xeedeeeee, 0xeeeee8ee, 0x5d, 0x180e2d, 0x5, 0x0
  .long 0xa50025, 0x7850705, 0x9f90979, 0xad80a58, 0xb950b15, 0xdb90d39, 0xf450ee9, 0xe6f0fc5
  .long 0x765fadce, 0xb4321098, 0xeebeeeee, 0xeeeeebee, 0xbe, 0x2b1b0e, 0xb, 0x0
  .long 0xe100e00, 0xe300e20, 0xe500e40, 0xe800e60, 0xea00e90, 0xec00eb0, 0xee00ed0, 0xe7f0ef0
  .long 0x765fedcb, 0xa4321098, 0xeefeeeee, 0xeeeee2ee, 0xa2, 0x2f0e12, 0xa, 0x0
  .long 0xb80038, 0x3a50325, 0x5e50565, 0xad50a55, 0xbf50b75, 0xe150e06, 0xf490e95, 0xe8f0fc9
  .long 0x76afedcb, 0x24351098, 0xee4eeeee, 0xeeeee2ee, 0x2e, 0x24120e, 0x2, 0x0
  .long 0xe1a0e0c, 0xe3c0e2c, 0xe5c0e4c, 0xe7c0e6c, 0xeac0e8c, 0xecc0ebc, 0xeec0edc, 0xe9f0efc
  .long 0x76afedcb, 0x15324098, 0xee4eeeee, 0xeeeee9ee, 0x1e, 0x24190e, 0x1, 0x0
  .long 0xe1b0e0b, 0xe3b0e2b, 0xe5b0e4b, 0xe7b0e6b, 0xe9b0e8b, 0xecb0ebb, 0xeeb0edb, 0xeaf0efb
  .long 0x86afedcb, 0x74321095, 0xee5eeeee, 0xeeeee0ee, 0x7e, 0x25100e, 0x7, 0x0
  .long 0xe170e07, 0xe370e27, 0xe570e47, 0xe770e67, 0xe970e87, 0xec70ea7, 0xee70ed7, 0xebf0ef7
  .long 0x765feacb, 0xd4321098, 0xeeceeeee, 0xeeeeeeee, 0xde, 0x2c1e0e, 0xd, 0x0
  .long 0xe120e02, 0xe320e22, 0xe520e41, 0xe720e62, 0xe920e82, 0xeb20ea2, 0xee20ed2, 0xecf0ef2
  .long 0x765aedcb, 0xf4321098, 0xee5eeeee, 0xeeeeeaee, 0xfe, 0x251a0e, 0xf, 0x0
  .long 0xe140e04, 0xe340e24, 0xe540e44, 0xe740e64, 0xe940e84, 0xeb40ea4, 0xee40ec4, 0xedf0ef4
  .long 0x76afedcb, 0x94321058, 0xeedeeeee, 0xeeeee8ee, 0x9e, 0x2d180e, 0x9, 0x0
  .long 0xe190e09, 0xe390e29, 0xe590e49, 0xe790e69, 0xe990e89, 0xeb90ea9, 0xed90ec9, 0xeef0ef9
  .long 0x765fadcb, 0xe4321098, 0xeebeeeee, 0xeeeeebee, 0xee, 0x2b1b0e, 0xe, 0x0
  .long 0xe130e03, 0xe330e23, 0xe530e43, 0xe700e63, 0xe930e83, 0xeb30ea3, 0xed30ec3, 0xeff0ee3
  .long 0x76afedcb, 0x34521098, 0xff3fffff, 0xfffff4ff, 0x3f, 0x23140f, 0x3, 0x0
  .long 0xf2d0f1d, 0xf4d0f3d, 0xf6d0f5d, 0xf8b0f7d, 0xfad0f9d, 0xfcd0fbd, 0xfed0fdd, 0xf0f0ffd
  .long 0x76afedcb, 0x25341098, 0xff0fffff, 0xfffff9ff, 0x2f, 0x20190f, 0x2, 0x0
  .long 0xf2c0f0c, 0xf4c0f3c, 0xf6c0f5c, 0xf8c0f7c, 0xfac0f9c, 0xfcc0fbc, 0xfec0fdc, 0xf1f0ffc
  .long 0x76afedcb, 0x4321598, 0xff2fffff, 0xfffff8ff, 0xf, 0x22180f, 0x0, 0x0
  .long 0xf1a0f0a, 0xf4a0f3a, 0xf6a0f5a, 0xf8a0f7a, 0xfaa0f9a, 0xfca0fba, 0xfea0fda, 0xf2f0ffa
  .long 0x86afedcb, 0x74321095, 0xffbfffff, 0xfffff7ff, 0x7f, 0x2b170f, 0x7, 0x0
  .long 0xf170f07, 0xf470f27, 0xf670f57, 0xf870f77, 0xfa70f97, 0xfc70fb7, 0xfe70fd7, 0xf3f0ff7
  .long 0x795fedcb, 0x643210a8, 0xffdfffff, 0xfffff2ff, 0x6f, 0x2d120f, 0x6, 0x0
  .long 0xf160f06, 0xf360f26, 0xf660f56, 0xf860f76, 0xfa60f96, 0xfc60fb6, 0xfe60fd6, 0xf4f0ff6
  .long 0x765feacb, 0xd4321098, 0xffbfffff, 0xfffffdff, 0xdf, 0x2b1d0f, 0xd, 0x0
  .long 0xf120f02, 0xf320f22, 0xf620f42, 0xf820f72, 0xfa20f92, 0xfc20fb2, 0xfe20fd1, 0xf5f0ff2
  .long 0x76afedcb, 0x54321098, 0xffcfffff, 0xfffff5ff, 0x5c, 0x150f2c, 0x5, 0x0
  .long 0x2950215, 0x5b50535, 0x7f90779, 0x9d50955, 0xba50b25, 0xc850c05, 0xec50e45, 0xf6f0fe5
  .long 0x765aedcf, 0xb4321098, 0xff5fffff, 0xfffffcff, 0xbf, 0x251c0f, 0xb, 0x0
  .long 0xf100f00, 0xf300f20, 0xf500f40, 0xf800f60, 0xfa00f90, 0xfc00fb0, 0xfe00fd0, 0xf7f0ff0
  .long 0x76afedcb, 0x14523098, 0xff3fffff, 0xfffff4ff, 0x1f, 0x23140f, 0x1, 0x0
  .long 0xf1b0f0b, 0xf3b0f2b, 0xf5b0f4b, 0xf7b0f6b, 0xfab0f9b, 0xfcb0fbb, 0xfeb0fdb, 0xf8f0ffb
  .long 0x76afedcb, 0x45321098, 0xff0fffff, 0xfffff9ff, 0x4f, 0x20190f, 0x4, 0x0
  .long 0xf1c0f0e, 0xf3e0f2e, 0xf5e0f4e, 0xf7e0f6e, 0xfae0f8e, 0xfce0fbe, 0xfee0fde, 0xf9f0ffe
  .long 0x765fadcb, 0xe4321098, 0xffffffff, 0xfffffbff, 0xef, 0x2f1b0f, 0xe, 0x0
  .long 0xf130f03, 0xf330f23, 0xf530f43, 0xf730f63, 0xf930f83, 0xfc30fb3, 0xfe30fd3, 0xfaf0ff3
  .long 0x76afedcb, 0x84321095, 0xffbfffff, 0xfffff7ff, 0x8f, 0x2b170f, 0x8, 0x0
  .long 0xf180f08, 0xf370f28, 0xf580f48, 0xf780f68, 0xf980f88, 0xfc80fa8, 0xfe80fd8, 0xfbf0ff8
  .long 0x765fedcb, 0x943210a8, 0xffdfffff, 0xfffff2ff, 0x9f, 0x2d120f, 0x9, 0x0
  .long 0xf190f09, 0xf390f29, 0xf590f46, 0xf790f69, 0xf990f89, 0xfb90fa9, 0xfe90fd9, 0xfcf0ff9
  .long 0x765feadb, 0xc4321098, 0xffbfffff, 0xfffffdff, 0xcf, 0x2b1d0f, 0xc, 0x0
  .long 0xf110f01, 0xf310f21, 0xf510f41, 0xf710f61, 0xf910f81, 0xfb10fa1, 0xfe10fc1, 0xfdf0ff1
  .long 0x765fedcb, 0xa4321098, 0xffcfffff, 0xfffff5ff, 0xa5, 0x2c0f15, 0xa, 0x0
  .long 0x2450225, 0x2c502a5, 0x4950415, 0x6550605, 0x6d50685, 0x9750935, 0x9f509b5, 0xfef0f65
  .long 0x765aedcb, 0xf4321098, 0xff5fffff, 0xfffffcff, 0xff, 0x251c0f, 0xf, 0x0
  .long 0xf140f04, 0xf340f24, 0xf540f44, 0xf700f64, 0xf940f84, 0xfb40fa4, 0xfd40fc4, 0xfff0fe4
L_order_end:
.section .rodata,"a"
.p2align 6
.amdhsa_kernel standalone__kv_cache_quant_pre_rope_vs_post_rope__sampling_kernel
  .amdhsa_next_free_vgpr 254
  .amdhsa_next_free_sgpr 102
  .amdhsa_accum_offset 256
  .amdhsa_group_segment_fixed_size 0
  .amdhsa_kernarg_size 112
  .amdhsa_user_sgpr_count 2
  .amdhsa_user_sgpr_kernarg_segment_ptr 1
  .amdhsa_system_sgpr_workgroup_id_x 1
.end_amdhsa_kernel
```

```asm
; @launch grid=(256,1,1) block=(320,1,1) lds=162304
.amdgcn_target "amdgcn-amd-amdhsa--gfx950"
.text
.globl standalone__kv_cache_quant_pre_rope_vs_post_rope__sampling_kernel
.p2align 12
.type L_pad,@object
L_pad:
.fill 832, 4, 0xbf810000
.p2align 8
.type standalone__kv_cache_quant_pre_rope_vs_post_rope__sampling_kernel,@function
standalone__kv_cache_quant_pre_rope_vs_post_rope__sampling_kernel:
  s_cmpk_ge_u32 s2, 0x100
  s_cbranch_scc1 L_end
  s_load_dwordx16 s[4:19], s[0:1], 0
  s_load_dwordx8 s[20:27], s[0:1], 64
  s_load_dwordx4 s[28:31], s[0:1], 96
  v_readfirstlane_b32 s40, v0
  s_lshr_b32 s42, s2, 4
  s_cmp_lg_u32 s40, 0
  s_cbranch_scc1 L_s0
  s_setprio 3
  s_getpc_b64 s[64:65]
L_pc0:
  s_and_b32 s44, s2, 56
  v_and_b32 v20, 63, v0
  v_lshl_add_u32 v1, v20, 6, s44
  v_lshlrev_b32_e64 v1, 4, v1
  v_min_u32 v1, L_order_end-L_pc0-1028, v1
  s_bfm_b64 exec, 50, 0
  global_load_dword v2, v1, s[64:65] offset:1024
  s_mov_b64 exec, -1
  v_min_u32 v21, 47, v20
  v_add_u32 v22, 24, v21
  v_subrev_u32_e64 v23, 24, v21
  v_min_u32 v27, v22, v23
  s_mul_i32 s44, s42, 48
  v_add_lshl_u32 v22, v21, s44, 3
  v_add_lshl_u32 v23, v27, s44, 3
  v_lshlrev_b32 v26, 3, v21
  s_and_b32 s44, s2, 7
  s_lshr_b32 s45, s2, 3
  v_and_b32 v12, 15, v21
  v_and_b32_e64 v4, 48, v21
  v_lshl_add_u32 v12, v4, 5, v12
  s_mul_i32 s68, s44, 96
  s_and_b32 s46, s45, 30
  s_add_u32 s68, s68, s46
  v_lshl_add_u32 v3, s68, 4, v12
  v_lshlrev_b32_e64 v3, 6, v3
  v_lshl_add_u32 v12, s45, 4, v12
  v_lshlrev_b32 v12, 6, v12
  s_lshr_b32 s68, s45, 2
  s_lshl_b32 s68, s68, 8
  s_add_u32 s44, s44, s68
  v_and_b32_e64 v4, 7, v20
  v_lshl_add_u32 v4, s44, 3, v4
  v_and_b32_e64 v5, 24, v20
  v_lshl_add_u32 v4, v5, 6, v4
  v_and_b32_e64 v5, 32, v20
  v_lshl_add_u32 v4, v5, 1, v4
  v_lshlrev_b32_e64 v4, 6, v4
  v_add_u32 v15, 8192, v4
  v_add_u32 v16, 16384, v4
  v_add_u32 v17, 24576, v4
  v_lshlrev_b32 v27, 3, v27
  s_waitcnt lgkmcnt(0)
  s_bitcmp1_b32 s2, 3
  s_cselect_b64 s[70:71], s[24:25], s[22:23]
  global_load_dword v5, v3, s[70:71]
  global_load_dword v6, v3, s[70:71] offset:1024
  global_load_dword v11, v12, s[4:5]
  global_load_dwordx2 v[108:109], v22, s[4:5]
  global_load_dwordx2 v[110:111], v23, s[4:5]
  global_load_dwordx2 v[104:105], v26, s[18:19]
  global_load_dwordx2 v[106:107], v26, s[20:21]
  s_add_u32 s68, s42, 16
  s_mul_i32 s44, s68, 384
  s_add_u32 s32, s4, s44
  s_addc_u32 s33, s5, 0
  global_load_dwordx2 v[112:113], v26, s[32:33]
  global_load_dwordx2 v[114:115], v27, s[32:33]
  s_add_u32 s68, s42, 32
  s_mul_i32 s44, s68, 384
  s_add_u32 s32, s4, s44
  s_addc_u32 s33, s5, 0
  global_load_dwordx2 v[116:117], v26, s[32:33]
  global_load_dwordx2 v[118:119], v27, s[32:33]
  s_bitcmp1_b32 s2, 3
  s_cselect_b64 s[70:71], s[10:11], s[8:9]
  s_cselect_b64 s[64:65], s[16:17], s[14:15]
  s_bitcmp1_b32 s2, 4
  s_cselect_b64 s[64:65], s[64:65], s[70:71]
  global_load_dword v7, v4, s[64:65]
  global_load_dword v8, v15, s[64:65]
  global_load_dword v9, v16, s[64:65]
  global_load_dword v10, v17, s[64:65]
  v_mov_b32 v14, 0
  v_cmp_gt_u32 vcc, 24, v21
  v_mov_b32 v48, 0
  v_mov_b32 v49, 0
  v_mov_b32 v50, 0
  v_mov_b32_e64 v51, 0
  ds_write_b128 v14, v[48:51] offset:0
  ds_write_b128 v14, v[48:51] offset:16
  s_waitcnt lgkmcnt(0)
  s_barrier
  s_mov_b32 s66, 0xffff0000
  s_mov_b32 s67, 0x3dd53b95
  v_cndmask_b32_e64 v30, 1.0, -1.0, vcc
  v_lshlrev_b32 v35, 4, v21
  v_mov_b32 v28, v35
  v_lshlrev_b32_e64 v29, 1, v27
  v_mov_b32 v22, 0x80008000
  v_cndmask_b32 v31, v14, v22, vcc
  v_mov_b32 v38, 1
  s_mov_b32 s43, 1
  s_waitcnt vmcnt(8)
  v_lshlrev_b32 v52, 16, v104
  v_and_b32 v53, s66, v104
  v_lshlrev_b32 v54, 16, v105
  v_and_b32 v55, s66, v105
  v_lshlrev_b32 v56, 16, v106
  v_and_b32 v57, s66, v106
  v_lshlrev_b32 v58, 16, v107
  v_and_b32 v59, s66, v107
L_hr:
  v_lshlrev_b32 v76, 16, v108
  v_and_b32 v77, s66, v108
  v_lshlrev_b32 v78, 16, v109
  v_and_b32 v79, s66, v109
  v_lshlrev_b32 v80, 16, v110
  v_and_b32 v81, s66, v110
  v_lshlrev_b32 v82, 16, v111
  v_and_b32 v83, s66, v111
  v_mul_f32 v76, v76, v52
  v_mul_f32 v77, v77, v53
  v_mul_f32 v78, v78, v54
  v_mul_f32 v79, v79, v55
  v_mul_f32 v80, v80, v56
  v_mul_f32 v81, v81, v57
  v_mul_f32 v82, v82, v58
  v_mul_f32 v83, v83, v59
  v_cvt_pk_bf16_f32 v84, v76, v80
  v_cvt_pk_bf16_f32 v85, v77, v81
  v_cvt_pk_bf16_f32 v86, v78, v82
  v_cvt_pk_bf16_f32 v87, v79, v83
  v_lshlrev_b32 v76, 16, v84
  v_and_b32 v80, s66, v84
  v_lshlrev_b32 v77, 16, v85
  v_and_b32 v81, s66, v85
  v_lshlrev_b32 v78, 16, v86
  v_and_b32 v82, s66, v86
  v_lshlrev_b32 v79, 16, v87
  v_and_b32 v83, s66, v87
  v_fma_f32 v76, v80, v30, v76
  v_fma_f32 v77, v81, v30, v77
  v_fma_f32 v78, v82, v30, v78
  v_fma_f32 v79, v83, v30, v79
  v_cvt_pk_bf16_f32 v84, v76, v77
  v_cvt_pk_bf16_f32 v85, v78, v79
  v_xor_b32 v86, v31, v84
  v_xor_b32 v87, v31, v85
  v_mov_b32_e64 v22, s43
  ds_write_b16 v28, v84 offset:512
  ds_write_b16_d16_hi v28, v84 offset:516
  ds_write_b16 v28, v85 offset:520
  ds_write_b16_d16_hi v28, v85 offset:524
  ds_write_b16 v29, v86 offset:514
  ds_write_b16_d16_hi v29, v86 offset:518
  ds_write_b16 v29, v87 offset:522
  ds_write_b16_d16_hi v29, v87 offset:526
  ds_write_b32 v14, v22 offset:16
  v_add_u32 v28, 1024, v28
  v_add_u32 v29, 1024, v29
  v_and_b32 v28, 0xfff, v28
  v_and_b32 v29, 0xfff, v29
  s_cmp_eq_u32 s43, 3
  s_cbranch_scc1 L_helper
  s_add_u32 s43, s43, 1
  s_waitcnt vmcnt(4) lgkmcnt(0)
  v_mov_b32 v108, v112
  v_mov_b32 v109, v113
  v_mov_b32 v110, v114
  v_mov_b32 v111, v115
  v_mov_b32 v112, v116
  v_mov_b32 v113, v117
  v_mov_b32_e64 v114, v118
  v_mov_b32 v115, v119
  s_branch L_hr
L_s0:
  v_subrev_u32 v0, 64, v0
  s_sub_u32 s40, s40, 64
  s_and_b32 s44, s2, 7
  s_mul_i32 s44, s44, 6
  s_bfe_u32 s41, s2, 0x10003
  s_add_u32 s44, s44, s41
  s_lshl_b32 s44, s44, 15
  s_lshr_b32 s40, s40, 6
  s_cmp_ge_u32 s40, 2
  s_cselect_b64 s[62:63], -1, 0
  s_and_b32 s45, s62, 16384
  s_sub_u32 s68, s44, s45
  s_add_u32 s44, s44, s45
  v_lshl_add_u32 v16, v0, 4, s68
  v_lshl_add_u32 v15, v0, 4, s44
  v_lshrrev_b32 v25, 4, v0
  v_and_b32 v24, 15, v0
  v_add_u32 v208, 0, v15
  v_add_u32 v209, 8192, v15
  v_add_u32 v210, 4096, v15
  s_sub_u32 s45, s41, 0
  s_mul_i32 s45, s45, 98304
  v_cmp_eq_u32 s[64:65], v25, 0
  v_add_u32_e64 v20, s45, v208
  s_nop 0
  v_cndmask_b32_e64 v208, v208, v20, s[64:65]
  v_lshl_add_u32 v22, s41, 1, v25
  v_subrev_u32 v22, s62, v22
  v_mul_u32_u24 v20, 11, v22
  v_lshrrev_b32_e64 v20, 5, v20
  v_mad_i32_i24 v20, v20, -3, v22
  v_lshlrev_b32_e64 v21, 4, v24
  v_lshl_add_u32 v248, v20, 8, v21
  v_add_u32 v20, 256, v248
  v_subrev_u32 v21, 512, v248
  v_min_u32_e64 v249, v20, v21
  v_add_u32 v20, 512, v248
  v_subrev_u32 v21, 256, v248
  v_min_u32 v250, v20, v21
  v_cmp_gt_u32 vcc, 8, v24
  v_lshlrev_b32 v23, 3, v24
  v_lshrrev_b32 v22, 1, v248
  v_add3_u32 v20, v22, v23, 64
  v_subrev_u32 v21, 384, v20
  v_min_u32 v20, v20, v21
  v_sub_u32 v20, v20, v22
  v_cndmask_b32 v242, v20, v23, vcc
  v_lshrrev_b32 v22, 1, v249
  v_add3_u32 v20, v22, v23, 64
  v_subrev_u32 v21, 384, v20
  v_min_u32 v20, v20, v21
  v_sub_u32 v20, v20, v22
  v_cndmask_b32 v243, v20, v23, vcc
  v_lshrrev_b32 v22, 1, v250
  v_add3_u32 v20, v22, v23, 64
  v_subrev_u32 v21, 384, v20
  v_min_u32_e64 v20, v20, v21
  v_sub_u32 v20, v20, v22
  v_cndmask_b32 v244, v20, v23, vcc
  s_mul_i32 s100, s40, 24576
  s_add_u32 s100, s100, 64000
  s_mul_i32 s44, s42, 1572864
  s_mov_b32 s34, 77070336
  s_mov_b32 s35, 0x20000
  s_mov_b32 s80, 25165824
  s_mov_b32 s3, 50331648
  s_mov_b32 s98, 75497472
  s_waitcnt lgkmcnt(0)
  s_add_u32 s32, s6, s44
  s_addc_u32 s33, s7, 0
  v_mov_b32 v21, s22
  v_mov_b32 v28, s24
  v_cndmask_b32 v28, v28, v21, vcc
  v_mov_b32 v21, s23
  v_mov_b32 v29, s25
  v_cndmask_b32 v29, v29, v21, vcc
  s_add_u32 m0, s100, 0
  v_lshrrev_b32 v10, 1, v208
  v_add_u32 v10, v10, v242
  v_mad_u64_u32 v[30:31], s[64:65], v10, 1, v[28:29]
  global_load_lds_dwordx4 v[30:31], off
  buffer_load_dwordx4 v[64:67], v208, s[32:35], 0 offen nt
  buffer_load_dwordx4 v[68:71], v209, s[32:35], 0 offen nt
  s_add_u32 m0, s100, 1024
  v_lshrrev_b32 v10, 1, v209
  v_add_u32 v10, v10, v244
  v_mad_u64_u32 v[30:31], s[64:65], v10, 1, v[28:29]
  global_load_lds_dwordx4 v[30:31], off
  buffer_load_dwordx4 v[72:75], v208, s[32:35], s80 offen nt
  buffer_load_dwordx4 v[76:79], v209, s[32:35], s80 offen nt
  s_add_u32 m0, s100, 2048
  v_lshrrev_b32 v10, 1, v210
  v_add_u32 v10, v10, v243
  v_mad_u64_u32 v[30:31], s[64:65], v10, 1, v[28:29]
  global_load_lds_dwordx4 v[30:31], off
  buffer_load_dwordx4 v[80:83], v208, s[32:35], s3 offen nt
  s_barrier
  s_getpc_b64 s[82:83]
L_pc1:
  s_lshl_b32 s44, s2, 6
  s_add_u32 s44, s44, L_order-L_pc1
  s_add_u32 s82, s82, s44
  s_addc_u32 s83, s83, 0
  s_load_dwordx2 s[92:93], s[82:83], 0
  s_load_dwordx2 s[96:97], s[82:83], 8
  s_mov_b32 s94, 4000000
  v_add_u32 v211, 12288, v15
  v_add_u32 v212, 16384, v16
  v_add_u32 v213, 24576, v16
  v_add_u32 v214, 20480, v16
  v_add_u32 v215, 28672, v16
  v_add_u32 v216, 65536, v15
  v_add_u32 v217, 73728, v15
  v_add_u32 v218, 69632, v15
  v_add_u32 v219, 77824, v15
  v_add_u32 v220, 81920, v16
  v_add_u32 v221, 90112, v16
  v_add_u32 v222, 86016, v16
  v_add_u32 v223, 94208, v16
  v_add_u32 v224, 131072, v15
  v_add_u32 v225, 139264, v15
  v_add_u32 v226, 135168, v15
  v_add_u32 v227, 143360, v15
  v_add_u32 v228, 147456, v16
  v_add_u32 v229, 155648, v16
  v_add_u32 v230, 151552, v16
  v_add_u32 v231, 159744, v16
  s_sub_u32 s45, s41, 0
  s_mul_i32 s45, s45, 98304
  v_cmp_eq_u32 s[64:65], v25, 15
  v_add_u32 v20, s45, v211
  s_nop 0
  v_cndmask_b32_e64 v211, v211, v20, s[64:65]
  s_sub_u32 s45, s41, 1
  s_mul_i32 s45, s45, 98304
  v_cmp_eq_u32 s[64:65], v25, 0
  v_add_u32_e64 v20, s45, v224
  s_nop 0
  v_cndmask_b32_e64 v224, v224, v20, s[64:65]
  s_sub_u32 s45, s41, 1
  s_mul_i32 s45, s45, 98304
  v_cmp_eq_u32 s[64:65], v25, 15
  v_add_u32_e64 v20, s45, v227
  s_nop 0
  v_cndmask_b32_e64 v227, v227, v20, s[64:65]
  v_cndmask_b32_e64 v251, v248, v249, s[62:63]
  v_cndmask_b32_e64 v252, v249, v250, s[62:63]
  v_cndmask_b32_e64 v253, v250, v248, s[62:63]
  v_cndmask_b32_e64 v245, v242, v243, s[62:63]
  v_cndmask_b32_e64 v246, v243, v244, s[62:63]
  v_cndmask_b32_e64 v247, v244, v242, s[62:63]
  v_lshrrev_b32_e64 v22, 6, v0
  v_bfe_u32 v23, v0, 4, 2
  v_mov_b32 v14, 0
  v_and_b32 v20, 2, v0
  v_lshl_add_u32 v21, v20, 5, v25
  v_and_b32_e64 v20, 1, v0
  v_lshl_add_u32 v21, v20, 4, v21
  v_and_b32_e64 v20, 4, v0
  v_lshl_add_u32 v21, v20, 3, v21
  s_and_b32 s44, s62, 64
  v_xor_b32 v21, s44, v21
  v_cmp_eq_u32 s[48:49], 0, v21
  v_cmp_eq_u32 vcc, 127, v21
  s_cmp_eq_u32 s41, 0
  s_cselect_b32 s44, 0, -1
  v_add_u32 v15, s44, v21
  s_cselect_b32 s44, 2, -2
  v_add_u32 v16, s44, v21
  s_cselect_b32 s44, 1, 0
  v_add_u32_e64 v17, s44, v21
  s_cselect_b64 s[50:51], 0, s[48:49]
  s_cselect_b64 s[52:53], 0, vcc
  s_cselect_b64 s[48:49], s[48:49], 0
  s_cselect_b64 vcc, vcc, 0
  v_mov_b32 v20, 254
  v_cndmask_b32_e64 v15, v15, v20, s[50:51]
  v_mov_b32 v20, 255
  v_cndmask_b32_e64 v15, v15, v20, s[52:53]
  v_mov_b32 v20, -128
  v_cndmask_b32_e64 v17, v17, v20, s[48:49]
  v_mov_b32 v20, -127
  v_cndmask_b32_e64 v17, v17, v20, vcc
  v_and_b32 v20, 8, v0
  v_mul_u32_u24 v20, 48, v20
  v_add_lshl_u32 v15, v15, v20, 2
  v_add_u32 v15, 45568, v15
  v_add_lshl_u32 v16, v16, v20, 2
  v_add_u32 v16, 46080, v16
  v_add_lshl_u32 v17, v17, v20, 2
  v_add_u32 v17, 46592, v17
  v_lshl_add_u32 v21, v24, 2, v23
  v_mul_u32_u24 v20, 192, v22
  v_add_lshl_u32 v3, v20, v21, 2
  v_add_u32 v3, 64000, v3
  v_lshlrev_b32 v6, 2, v22
  v_mov_b32 v236, 0
  v_mov_b32 v239, 0
  v_mov_b32 v237, 0
  v_mov_b32 v240, 0
  v_mov_b32 v238, 0
  v_mov_b32_e64 v241, 0
  s_mov_b32 s48, 0x11111111
  s_mov_b32 s49, s48
  s_mov_b32 s50, 0x22222222
  s_mov_b32 s51, s50
  s_mov_b32 s52, 0x44444444
  s_mov_b32 s53, s52
  s_mov_b32 s54, 0x88888888
  s_mov_b32 s55, s54
  s_mov_b32 s56, 0x05040100
  s_mov_b32 s57, 0x07060302
  s_mov_b32 s38, 1572864
  s_mov_b32 s39, 0x20000
  v_lshlrev_b32 v21, 8, v23
  v_add_u32 v21, s100, v21
  v_lshl_add_u32 v12, v24, 3, v21
  s_getreg_b32 s81, hwreg(HW_REG_HW_ID, 13, 2)
  s_getreg_b32 s79, hwreg(HW_REG_HW_ID, 8, 4)
  s_getreg_b32 s46, hwreg(HW_REG_XCC_ID, 0, 3)
  s_mul_i32 s46, s46, 4352
  s_add_u32 s46, s46, 8126464
  s_add_u32 s44, s46, 2048
  v_mov_b32 v11, s44
  s_and_b32 s45, s81, 2
  s_lshl_b32 s45, s45, 9
  s_lshl_b32 s44, s40, 8
  s_add_u32 s44, s44, s45
  s_add_u32 s44, s44, s46
  s_add_u32 s44, s44, s79
  s_and_b32 s81, s81, 1
  s_lshl_b32 s81, s81, 4
  s_add_u32 s44, s44, s81
  v_mov_b32 v7, s44
  s_xor_b32 s45, s45, 1024
  s_add_u32 s46, s46, s45
  v_and_b32 v8, 1, v0
  v_lshl_add_u32 v8, v8, 4, s46
  v_bfe_u32 v21, v0, 1, 2
  v_mad_u32_u24 v21, v21, 4, v22
  v_add_u32 v9, 0, v21
  v_and_b32 v9, 3, v9
  v_lshl_add_u32 v232, v9, 8, v8
  v_add_u32 v9, 1, v21
  v_and_b32 v9, 3, v9
  v_lshl_add_u32 v233, v9, 8, v8
  v_add_u32 v9, 2, v21
  v_and_b32 v9, 3, v9
  v_lshl_add_u32 v234, v9, 8, v8
  v_add_u32 v9, 3, v21
  v_and_b32 v9, 3, v9
  v_lshl_add_u32 v235, v9, 8, v8
  s_mov_b32 s78, 0xfefefeff
  v_mov_b32 v32, 0
  v_mov_b32 v33, 0
  v_mov_b32 v34, 0
  v_mov_b32 v35, 0
  v_mov_b32 v36, 0
  v_mov_b32 v37, 0
  v_mov_b32 v38, 0
  v_mov_b32 v39, 0
  v_mov_b32 v26, 0
  v_mov_b32 v27, 0
  v_mov_b32_e64 v8, 3
  s_getreg_b32 s58, hwreg(HW_REG_XCC_ID, 0, 1)
  s_mul_i32 s58, s58, -5
  s_add_u32 s58, s58, 3
  s_mov_b32 s91, s58
  s_mov_b32 s69, 8
  s_mov_b32 s95, 0
  buffer_load_dwordx4 v[84:87], v209, s[32:35], s3 offen nt
  s_add_u32 m0, s100, 3072
  v_lshrrev_b32 v10, 1, v211
  v_add_u32 v10, v10, v242
  v_mad_u64_u32 v[30:31], s[64:65], v10, 1, v[28:29]
  s_waitcnt vmcnt(8)
  global_load_lds_dwordx4 v[30:31], off
  s_waitcnt vmcnt(8)
  buffer_load_dwordx4 v[88:91], v210, s[32:35], 0 offen nt
  s_waitcnt vmcnt(8)
  buffer_load_dwordx4 v[92:95], v211, s[32:35], 0 offen nt
  s_mov_b32 s47, 2
  ds_read_b32 v4, v14 offset:16
L_fqz:
  s_waitcnt lgkmcnt(0)
  v_readfirstlane_b32 s46, v4
  s_cmp_ge_u32 s46, s47
  s_cbranch_scc1 L_fqz_ok
  s_cmp_eq_u32 s94, 0
  s_cbranch_scc1 L_fqz_ok
  s_sub_u32 s94, s94, 1
  ds_read_b32 v4, v14 offset:16
  s_branch L_fqz
L_fqz_ok:
  ds_read_b128 v[40:43], v248 offset:512
  ds_read_b128 v[44:47], v250 offset:512
  ds_read_b128 v[48:51], v248 offset:1536
  s_add_u32 m0, s100, 4096
  v_lshrrev_b32 v10, 1, v212
  v_add_u32 v10, v10, v246
  v_mad_u64_u32 v[30:31], s[64:65], v10, 1, v[28:29]
  s_waitcnt vmcnt(8)
  global_load_lds_dwordx4 v[30:31], off
  ds_read_b64 v[112:113], v12 offset:0
  ds_read_b64 v[114:115], v12 offset:128
  ds_read_b64 v[116:117], v12 offset:1024
  ds_read_b64 v[118:119], v12 offset:1152
  s_waitcnt vmcnt(8)
  buffer_load_dwordx4 v[96:99], v210, s[32:35], s80 offen nt
L_it0:
  s_mov_b32 s47, 3
  ds_read_b32 v4, v14 offset:16
L_fq0:
  s_waitcnt lgkmcnt(0)
  v_readfirstlane_b32 s46, v4
  s_cmp_ge_u32 s46, s47
  s_cbranch_scc1 L_fq0_ok
  s_cmp_eq_u32 s94, 0
  s_cbranch_scc1 L_fq0_ok
  s_sub_u32 s94, s94, 1
  ds_read_b32 v4, v14 offset:16
  s_branch L_fq0
L_fq0_ok:
  ds_read_b128 v[52:55], v250 offset:1536
  ds_read_b128 v[56:59], v248 offset:2560
  ds_read_b128 v[60:63], v250 offset:2560
  v_perm_b32 v13, v114, v112, s56
  v_perm_b32 v114, v114, v112, s57
  v_perm_b32 v112, v115, v113, s56
  v_perm_b32 v115, v115, v113, s57
  v_dot2_f32_bf16 v22, v13, v40, 0
  v_dot2_f32_bf16 v23, v114, v41, 0
  v_dot2_f32_bf16 v24, v112, v42, 0
  v_dot2_f32_bf16 v25, v115, v43, 0
  v_cvt_f32_i32 v64, v64
  v_cvt_f32_i32 v65, v65
  v_cvt_f32_i32 v66, v66
  v_cvt_f32_i32_e64 v67, v67
  v_pk_mul_f32 v[20:21], v[64:65], v[22:23]
  v_pk_add_f32 v[18:19], v[22:23], v[24:25]
  v_pk_fma_f32 v[20:21], v[66:67], v[24:25], v[20:21]
  v_add_f32 v18, v18, v19
  v_add_f32 v20, v20, v21
  s_add_u32 m0, s100, 5120
  v_lshrrev_b32 v10, 1, v213
  v_add_u32 v10, v10, v245
  v_mad_u64_u32 v[30:31], s[64:65], v10, 1, v[28:29]
  s_waitcnt vmcnt(8)
  global_load_lds_dwordx4 v[30:31], off
  s_waitcnt vmcnt(8)
  buffer_load_dwordx4 v[100:103], v211, s[32:35], s80 offen nt
  v_perm_b32 v113, v118, v116, s56
  v_perm_b32 v118, v118, v116, s57
  v_perm_b32 v116, v119, v117, s56
  v_perm_b32 v119, v119, v117, s57
  v_dot2_f32_bf16 v22, v113, v44, 0
  v_add_f32_dpp v239, v18, v18 row_ror:8 row_mask:0xf bank_mask:0xc
  v_add_f32_dpp v239, v20, v20 row_ror:8 row_mask:0xf bank_mask:0x3
  v_dot2_f32_bf16 v23, v118, v45, 0
  v_dot2_f32_bf16 v24, v116, v46, 0
  v_dot2_f32_bf16 v25, v119, v47, 0
  v_cvt_f32_i32 v68, v68
  v_cvt_f32_i32 v69, v69
  v_cvt_f32_i32 v70, v70
  v_cvt_f32_i32 v71, v71
  v_pk_mul_f32 v[20:21], v[68:69], v[22:23]
  v_pk_add_f32 v[18:19], v[22:23], v[24:25]
  v_pk_fma_f32 v[20:21], v[70:71], v[24:25], v[20:21]
  v_add_f32_e64 v18, v18, v19
  v_add_f32 v20, v20, v21
  s_waitcnt vmcnt(8)
  buffer_load_dwordx4 v[104:107], v210, s[32:35], s3 offen nt
  v_dot2_f32_bf16 v22, v13, v48, 0
  v_add_f32_dpp v21, v18, v18 row_ror:8 row_mask:0xf bank_mask:0xc
  v_add_f32_dpp v21, v20, v20 row_ror:8 row_mask:0xf bank_mask:0x3
  v_add_f32_dpp v20, v239, v239 row_half_mirror row_mask:0xf bank_mask:0x5
  v_dot2_f32_bf16 v23, v114, v49, 0
  v_add_f32_dpp v20, v21, v21 row_half_mirror row_mask:0xf bank_mask:0xa
  v_dot2_f32_bf16 v24, v112, v50, 0
  v_dot2_f32_bf16 v25, v115, v51, 0
  v_add_f32_dpp v20, v20, v20 quad_perm:[2,3,0,1] row_mask:0xf bank_mask:0xf
  v_cvt_f32_i32 v72, v72
  v_cvt_f32_i32 v73, v73
  v_add_f32_dpp v20, v20, v20 quad_perm:[1,0,3,2] row_mask:0xf bank_mask:0xf
  v_cndmask_b32_e64 v236, v236, v20, s[48:49]
  v_cvt_f32_i32 v74, v74
  v_cvt_f32_i32 v75, v75
  v_pk_mul_f32 v[20:21], v[72:73], v[22:23]
  v_pk_add_f32 v[18:19], v[22:23], v[24:25]
  v_pk_fma_f32 v[20:21], v[74:75], v[24:25], v[20:21]
  v_add_f32_e64 v18, v18, v19
  v_add_f32 v20, v20, v21
  s_waitcnt vmcnt(8)
  buffer_load_dwordx4 v[108:111], v211, s[32:35], s3 offen nt
L_it1:
  s_waitcnt lgkmcnt(0)
  ds_read_b128 v[40:43], v249 offset:512
  ds_read_b128 v[44:47], v248 offset:512
  ds_read_b128 v[48:51], v249 offset:1536
  v_dot2_f32_bf16 v22, v113, v52, 0
  v_add_f32_dpp v240, v18, v18 row_ror:8 row_mask:0xf bank_mask:0xc
  v_add_f32_dpp v240, v20, v20 row_ror:8 row_mask:0xf bank_mask:0x3
  v_dot2_f32_bf16 v23, v118, v53, 0
  v_dot2_f32_bf16 v24, v116, v54, 0
  v_dot2_f32_bf16 v25, v119, v55, 0
  v_cvt_f32_i32 v76, v76
  v_cvt_f32_i32 v77, v77
  v_cvt_f32_i32 v78, v78
  v_cvt_f32_i32_e64 v79, v79
  v_pk_mul_f32 v[20:21], v[76:77], v[22:23]
  v_pk_add_f32 v[18:19], v[22:23], v[24:25]
  v_pk_fma_f32 v[20:21], v[78:79], v[24:25], v[20:21]
  v_add_f32 v18, v18, v19
  v_add_f32 v20, v20, v21
  s_add_u32 m0, s100, 6144
  v_lshrrev_b32 v10, 1, v214
  v_add_u32 v10, v10, v247
  v_mad_u64_u32 v[30:31], s[64:65], v10, 1, v[28:29]
  s_waitcnt vmcnt(8)
  global_load_lds_dwordx4 v[30:31], off
  s_waitcnt vmcnt(8)
  buffer_load_dwordx4 v[64:67], v212, s[32:35], 0 offen nt
  v_dot2_f32_bf16 v22, v13, v56, 0
  v_add_f32_dpp v21, v18, v18 row_ror:8 row_mask:0xf bank_mask:0xc
  v_add_f32_dpp v21, v20, v20 row_ror:8 row_mask:0xf bank_mask:0x3
  v_add_f32_dpp v20, v240, v240 row_half_mirror row_mask:0xf bank_mask:0x5
  v_dot2_f32_bf16 v23, v114, v57, 0
  v_add_f32_dpp v20, v21, v21 row_half_mirror row_mask:0xf bank_mask:0xa
  v_dot2_f32_bf16 v24, v112, v58, 0
  v_dot2_f32_bf16 v25, v115, v59, 0
  v_add_f32_dpp v20, v20, v20 quad_perm:[2,3,0,1] row_mask:0xf bank_mask:0xf
  v_cvt_f32_i32 v80, v80
  v_cvt_f32_i32 v81, v81
  v_add_f32_dpp v20, v20, v20 quad_perm:[1,0,3,2] row_mask:0xf bank_mask:0xf
  v_cndmask_b32_e64 v237, v237, v20, s[48:49]
  v_cvt_f32_i32 v82, v82
  v_cvt_f32_i32 v83, v83
  v_pk_mul_f32 v[20:21], v[80:81], v[22:23]
  v_pk_add_f32 v[18:19], v[22:23], v[24:25]
  v_pk_fma_f32 v[20:21], v[82:83], v[24:25], v[20:21]
  v_add_f32_e64 v18, v18, v19
  v_add_f32 v20, v20, v21
  s_waitcnt vmcnt(8)
  buffer_load_dwordx4 v[68:71], v213, s[32:35], 0 offen nt
  ds_read_b64 v[120:121], v12 offset:2048
  ds_read_b64 v[122:123], v12 offset:2176
  ds_read_b64 v[124:125], v12 offset:3072
  ds_read_b64 v[126:127], v12 offset:3200
  v_dot2_f32_bf16 v22, v113, v60, 0
  v_add_f32_dpp v241, v18, v18 row_ror:8 row_mask:0xf bank_mask:0xc
  v_add_f32_dpp v241, v20, v20 row_ror:8 row_mask:0xf bank_mask:0x3
  v_dot2_f32_bf16 v23, v118, v61, 0
  v_dot2_f32_bf16 v24, v116, v62, 0
  v_dot2_f32_bf16 v25, v119, v63, 0
  v_cvt_f32_i32 v84, v84
  v_cvt_f32_i32 v85, v85
  v_cvt_f32_i32 v86, v86
  v_cvt_f32_i32 v87, v87
  v_pk_mul_f32 v[20:21], v[84:85], v[22:23]
  v_pk_add_f32 v[18:19], v[22:23], v[24:25]
  v_pk_fma_f32 v[20:21], v[86:87], v[24:25], v[20:21]
  v_add_f32_e64 v18, v18, v19
  v_add_f32 v20, v20, v21
  s_waitcnt vmcnt(7)
  buffer_load_dwordx4 v[72:75], v212, s[32:35], s80 offen nt
L_it2:
  s_waitcnt lgkmcnt(0)
  ds_read_b128 v[52:55], v248 offset:1536
  ds_read_b128 v[56:59], v249 offset:2560
  ds_read_b128 v[60:63], v248 offset:2560
  ds_read_b32 v4, v14 offset:24
  v_perm_b32 v117, v122, v120, s56
  v_perm_b32 v122, v122, v120, s57
  v_perm_b32 v120, v123, v121, s56
  v_perm_b32 v123, v123, v121, s57
  v_dot2_f32_bf16 v22, v117, v40, 0
  v_add_f32_dpp v21, v18, v18 row_ror:8 row_mask:0xf bank_mask:0xc
  v_add_f32_dpp v21, v20, v20 row_ror:8 row_mask:0xf bank_mask:0x3
  v_add_f32_dpp v20, v241, v241 row_half_mirror row_mask:0xf bank_mask:0x5
  v_dot2_f32_bf16 v23, v122, v41, 0
  v_add_f32_dpp v20, v21, v21 row_half_mirror row_mask:0xf bank_mask:0xa
  v_dot2_f32_bf16 v24, v120, v42, 0
  v_dot2_f32_bf16 v25, v123, v43, 0
  v_add_f32_dpp v20, v20, v20 quad_perm:[2,3,0,1] row_mask:0xf bank_mask:0xf
  v_cvt_f32_i32 v88, v88
  v_cvt_f32_i32_e64 v89, v89
  v_add_f32_dpp v20, v20, v20 quad_perm:[1,0,3,2] row_mask:0xf bank_mask:0xf
  v_cndmask_b32_e64 v238, v238, v20, s[48:49]
  v_cvt_f32_i32 v90, v90
  v_cvt_f32_i32 v91, v91
  v_pk_mul_f32 v[20:21], v[88:89], v[22:23]
  v_pk_add_f32 v[18:19], v[22:23], v[24:25]
  v_pk_fma_f32 v[20:21], v[90:91], v[24:25], v[20:21]
  v_add_f32 v18, v18, v19
  v_add_f32 v20, v20, v21
  s_add_u32 m0, s100, 7168
  v_lshrrev_b32 v10, 1, v215
  v_add_u32 v10, v10, v246
  v_mad_u64_u32 v[30:31], s[64:65], v10, 1, v[28:29]
  global_load_lds_dwordx4 v[30:31], off
  s_waitcnt vmcnt(7)
  buffer_load_dwordx4 v[76:79], v213, s[32:35], s80 offen nt
  v_perm_b32 v121, v126, v124, s56
  v_perm_b32 v126, v126, v124, s57
  v_perm_b32 v124, v127, v125, s56
  v_perm_b32 v127, v127, v125, s57
  v_dot2_f32_bf16 v22, v121, v44, 0
  v_add_f32_dpp v239, v18, v18 row_ror:8 row_mask:0xf bank_mask:0xc
  v_add_f32_dpp v239, v20, v20 row_ror:8 row_mask:0xf bank_mask:0x3
  v_dot2_f32_bf16 v23, v126, v45, 0
  v_dot2_f32_bf16 v24, v124, v46, 0
  v_dot2_f32_bf16 v25, v127, v47, 0
  v_cvt_f32_i32 v92, v92
  v_cvt_f32_i32 v93, v93
  v_cvt_f32_i32 v94, v94
  v_cvt_f32_i32_e64 v95, v95
  v_pk_mul_f32 v[20:21], v[92:93], v[22:23]
  v_pk_add_f32 v[18:19], v[22:23], v[24:25]
  v_pk_fma_f32 v[20:21], v[94:95], v[24:25], v[20:21]
  v_add_f32_e64 v18, v18, v19
  v_add_f32 v20, v20, v21
  s_waitcnt vmcnt(7)
  buffer_load_dwordx4 v[80:83], v212, s[32:35], s3 offen nt
  v_dot2_f32_bf16 v22, v117, v48, 0
  v_add_f32_dpp v21, v18, v18 row_ror:8 row_mask:0xf bank_mask:0xc
  v_add_f32_dpp v21, v20, v20 row_ror:8 row_mask:0xf bank_mask:0x3
  v_add_f32_dpp v20, v239, v239 row_half_mirror row_mask:0xf bank_mask:0x5
  v_dot2_f32_bf16 v23, v122, v49, 0
  v_add_f32_dpp v20, v21, v21 row_half_mirror row_mask:0xf bank_mask:0xa
  v_dot2_f32_bf16 v24, v120, v50, 0
  v_dot2_f32_bf16 v25, v123, v51, 0
  v_add_f32_dpp v20, v20, v20 quad_perm:[2,3,0,1] row_mask:0xf bank_mask:0xf
  v_cvt_f32_i32 v96, v96
  v_cvt_f32_i32 v97, v97
  v_add_f32_dpp v20, v20, v20 quad_perm:[1,0,3,2] row_mask:0xf bank_mask:0xf
  v_cndmask_b32_e64 v236, v236, v20, s[50:51]
  v_cvt_f32_i32 v98, v98
  v_cvt_f32_i32 v99, v99
  v_pk_mul_f32 v[20:21], v[96:97], v[22:23]
  v_pk_add_f32 v[18:19], v[22:23], v[24:25]
  v_pk_fma_f32 v[20:21], v[98:99], v[24:25], v[20:21]
  v_add_f32_e64 v18, v18, v19
  v_add_f32 v20, v20, v21
  s_waitcnt vmcnt(7)
  buffer_load_dwordx4 v[84:87], v213, s[32:35], s3 offen nt
L_it3:
  s_mov_b32 s47, 1
L_fc:
  s_waitcnt lgkmcnt(0)
  v_readfirstlane_b32 s46, v4
  s_cmp_ge_u32 s46, s47
  s_cbranch_scc1 L_fc_ok
  s_cmp_eq_u32 s94, 0
  s_cbranch_scc1 L_fc_ok
  s_sub_u32 s94, s94, 1
  ds_read_b32 v4, v14 offset:24
  s_branch L_fc
L_fc_ok:
  ds_read_b128 v[40:43], v252 offset:512
  ds_read_b128 v[44:47], v251 offset:512
  ds_read_b128 v[48:51], v252 offset:1536
  s_mov_b64 exec, 3
  s_add_u32 s44, s78, 0x03030303
  v_msad_u8 v9, s78, v36, 0
  v_msad_u8 v10, s44, v36, 0
  v_msad_u8 v9, s78, v37, v9
  v_msad_u8 v10, s44, v37, v10
  v_msad_u8 v9, s78, v38, v9
  v_msad_u8 v10, s44, v38, v10
  global_store_byte v7, v8, s[30:31]
  global_load_dwordx3 v[36:38], v235, s[30:31] sc1
  v_sub_u32 v9, v9, v10
  v_add_u32 v8, 1, v8
  v_readlane_b32 s66, v9, 0
  v_readlane_b32 s67, v9, 1
  s_add_u32 s78, s78, 0x01010101
  s_mov_b64 exec, -1
  s_lshl1_add_u32 s69, s91, s95
  s_add_u32 s95, s66, s67
  s_mov_b32 s69, 8
  v_dot2_f32_bf16 v22, v121, v52, 0
  v_add_f32_dpp v240, v18, v18 row_ror:8 row_mask:0xf bank_mask:0xc
  v_add_f32_dpp v240, v20, v20 row_ror:8 row_mask:0xf bank_mask:0x3
  v_dot2_f32_bf16 v23, v126, v53, 0
  v_dot2_f32_bf16 v24, v124, v54, 0
  v_dot2_f32_bf16 v25, v127, v55, 0
  v_cvt_f32_i32 v100, v100
  v_cvt_f32_i32 v101, v101
  v_cvt_f32_i32 v102, v102
  v_cvt_f32_i32 v103, v103
  v_pk_mul_f32 v[20:21], v[100:101], v[22:23]
  v_pk_add_f32 v[18:19], v[22:23], v[24:25]
  v_pk_fma_f32 v[20:21], v[102:103], v[24:25], v[20:21]
  v_add_f32 v18, v18, v19
  v_add_f32 v20, v20, v21
  s_add_u32 m0, s100, 8192
  v_lshrrev_b32 v10, 1, v216
  v_add_u32 v10, v10, v243
  v_mad_u64_u32 v[30:31], s[64:65], v10, 1, v[28:29]
  global_load_lds_dwordx4 v[30:31], off
  v_dot2_f32_bf16 v22, v117, v56, 0
  v_add_f32_dpp v21, v18, v18 row_ror:8 row_mask:0xf bank_mask:0xc
  v_add_f32_dpp v21, v20, v20 row_ror:8 row_mask:0xf bank_mask:0x3
  v_add_f32_dpp v20, v240, v240 row_half_mirror row_mask:0xf bank_mask:0x5
  v_dot2_f32_bf16 v23, v122, v57, 0
  v_add_f32_dpp v20, v21, v21 row_half_mirror row_mask:0xf bank_mask:0xa
  v_dot2_f32_bf16 v24, v120, v58, 0
  v_dot2_f32_bf16 v25, v123, v59, 0
  v_add_f32_dpp v20, v20, v20 quad_perm:[2,3,0,1] row_mask:0xf bank_mask:0xf
  v_cvt_f32_i32 v104, v104
  v_cvt_f32_i32 v105, v105
  v_add_f32_dpp v20, v20, v20 quad_perm:[1,0,3,2] row_mask:0xf bank_mask:0xf
  v_cndmask_b32_e64 v237, v237, v20, s[50:51]
  v_cvt_f32_i32 v106, v106
  v_cvt_f32_i32 v107, v107
  v_pk_mul_f32 v[20:21], v[104:105], v[22:23]
  v_pk_add_f32 v[18:19], v[22:23], v[24:25]
  v_pk_fma_f32 v[20:21], v[106:107], v[24:25], v[20:21]
  v_add_f32 v18, v18, v19
  v_add_f32 v20, v20, v21
  s_cmpk_gt_i32 s69, 0x1f
  s_cbranch_scc1 L_p2_4
  s_cmp_gt_i32 s69, L_order_end-L_order-16421
  s_cbranch_scc1 L_p2_1
  s_waitcnt vmcnt(6)
L_p2_1:
  s_waitcnt vmcnt(8)
L_p2_4:
  s_waitcnt vmcnt(9)
  buffer_load_dwordx4 v[88:91], v214, s[32:35], 0 offen nt
  ds_read_b64 v[128:129], v12 offset:4096
  ds_read_b64 v[130:131], v12 offset:4224
  ds_read_b64 v[132:133], v12 offset:5120
  ds_read_b64 v[134:135], v12 offset:5248
  v_dot2_f32_bf16 v22, v121, v60, 0
  v_add_f32_dpp v241, v18, v18 row_ror:8 row_mask:0xf bank_mask:0xc
  v_add_f32_dpp v241, v20, v20 row_ror:8 row_mask:0xf bank_mask:0x3
  v_dot2_f32_bf16 v23, v126, v61, 0
  v_dot2_f32_bf16 v24, v124, v62, 0
  v_dot2_f32_bf16 v25, v127, v63, 0
  v_cvt_f32_i32 v108, v108
  v_cvt_f32_i32 v109, v109
  v_cvt_f32_i32 v110, v110
  v_cvt_f32_i32 v111, v111
  v_pk_mul_f32 v[20:21], v[108:109], v[22:23]
  v_pk_add_f32 v[18:19], v[22:23], v[24:25]
  v_pk_fma_f32 v[20:21], v[110:111], v[24:25], v[20:21]
  v_add_f32 v18, v18, v19
  v_add_f32 v20, v20, v21
  s_cmpk_gt_i32 s69, 0x1f
  s_cbranch_scc1 L_p3_4
  s_cmp_gt_i32 s69, L_order_end-L_order-16391
  s_cbranch_scc1 L_p3_2
  s_waitcnt vmcnt(7)
L_p3_2:
  s_waitcnt vmcnt(9)
L_p3_4:
  s_waitcnt vmcnt(10)
  buffer_load_dwordx4 v[92:95], v215, s[32:35], 0 offen nt
  s_cmpk_gt_i32 s69, 0x1f
  s_cbranch_scc1 L_p4_4
  s_cmpk_gt_i32 s69, 0xb
  s_cbranch_scc1 L_p4_3
  s_cmpk_gt_i32 s69, 0xffbb
  s_cbranch_scc1 L_p4_0
  s_waitcnt vmcnt(7)
L_p4_0:
  s_waitcnt vmcnt(8)
L_p4_3:
  s_waitcnt vmcnt(10)
L_p4_4:
  s_waitcnt vmcnt(11)
  buffer_load_dwordx4 v[96:99], v214, s[32:35], s80 offen nt
L_it4:
  s_waitcnt lgkmcnt(0)
  ds_read_b128 v[52:55], v251 offset:1536
  ds_read_b128 v[56:59], v252 offset:2560
  ds_read_b128 v[60:63], v251 offset:2560
  s_mov_b64 exec, 3
  s_add_u32 s44, s78, 0x03030303
  v_msad_u8 v9, s78, v32, 0
  v_msad_u8 v10, s44, v32, 0
  v_msad_u8 v9, s78, v33, v9
  v_msad_u8 v10, s44, v33, v10
  v_msad_u8 v9, s78, v34, v9
  v_msad_u8 v10, s44, v34, v10
  global_store_byte v7, v8, s[30:31]
  global_load_dwordx3 v[32:34], v232, s[30:31] sc1
  v_sub_u32 v9, v9, v10
  v_add_u32 v8, 1, v8
  v_readlane_b32 s66, v9, 0
  v_readlane_b32 s67, v9, 1
  s_add_u32 s78, s78, 0x01010101
  s_mov_b64 exec, -1
  s_lshl1_add_u32 s69, s91, s95
  s_add_u32 s95, s66, s67
  s_mov_b32 s69, 8
  v_perm_b32 v125, v130, v128, s56
  v_perm_b32 v130, v130, v128, s57
  v_perm_b32 v128, v131, v129, s56
  v_perm_b32 v131, v131, v129, s57
  s_waitcnt vmcnt(12)
  v_dot2_f32_bf16 v22, v125, v40, 0
  v_add_f32_dpp v21, v18, v18 row_ror:8 row_mask:0xf bank_mask:0xc
  v_add_f32_dpp v21, v20, v20 row_ror:8 row_mask:0xf bank_mask:0x3
  v_add_f32_dpp v20, v241, v241 row_half_mirror row_mask:0xf bank_mask:0x5
  v_dot2_f32_bf16 v23, v130, v41, 0
  v_add_f32_dpp v20, v21, v21 row_half_mirror row_mask:0xf bank_mask:0xa
  v_dot2_f32_bf16 v24, v128, v42, 0
  v_dot2_f32_bf16 v25, v131, v43, 0
  v_add_f32_dpp v20, v20, v20 quad_perm:[2,3,0,1] row_mask:0xf bank_mask:0xf
  v_cvt_f32_i32 v64, v64
  v_cvt_f32_i32_e64 v65, v65
  v_add_f32_dpp v20, v20, v20 quad_perm:[1,0,3,2] row_mask:0xf bank_mask:0xf
  v_cndmask_b32_e64 v238, v238, v20, s[50:51]
  v_cvt_f32_i32 v66, v66
  v_cvt_f32_i32 v67, v67
  v_pk_mul_f32 v[20:21], v[64:65], v[22:23]
  v_pk_add_f32 v[18:19], v[22:23], v[24:25]
  v_pk_fma_f32 v[20:21], v[66:67], v[24:25], v[20:21]
  v_add_f32 v18, v18, v19
  v_add_f32 v20, v20, v21
  s_add_u32 m0, s100, 9216
  v_lshrrev_b32 v10, 1, v217
  v_add_u32 v10, v10, v242
  v_mad_u64_u32 v[30:31], s[64:65], v10, 1, v[28:29]
  global_load_lds_dwordx4 v[30:31], off
  v_perm_b32 v129, v134, v132, s56
  v_perm_b32 v134, v134, v132, s57
  v_perm_b32 v132, v135, v133, s56
  v_perm_b32 v135, v135, v133, s57
  s_waitcnt vmcnt(12)
  v_dot2_f32_bf16 v22, v129, v44, 0
  v_add_f32_dpp v239, v18, v18 row_ror:8 row_mask:0xf bank_mask:0xc
  v_add_f32_dpp v239, v20, v20 row_ror:8 row_mask:0xf bank_mask:0x3
  v_dot2_f32_bf16 v23, v134, v45, 0
  v_dot2_f32_bf16 v24, v132, v46, 0
  v_dot2_f32_bf16 v25, v135, v47, 0
  v_cvt_f32_i32 v68, v68
  v_cvt_f32_i32 v69, v69
  v_cvt_f32_i32 v70, v70
  v_cvt_f32_i32_e64 v71, v71
  v_pk_mul_f32 v[20:21], v[68:69], v[22:23]
  v_pk_add_f32 v[18:19], v[22:23], v[24:25]
  v_pk_fma_f32 v[20:21], v[70:71], v[24:25], v[20:21]
  v_add_f32 v18, v18, v19
  v_add_f32 v20, v20, v21
  s_cmpk_gt_i32 s69, 0x1f
  s_cbranch_scc1 L_p5_4
  s_cmp_gt_i32 s69, L_order_end-L_order-16421
  s_cbranch_scc1 L_p5_1
  s_waitcnt vmcnt(6)
L_p5_1:
  s_waitcnt vmcnt(10)
L_p5_4:
  s_waitcnt vmcnt(11)
  buffer_load_dwordx4 v[100:103], v215, s[32:35], s80 offen nt
  v_dot2_f32_bf16 v22, v125, v48, 0
  v_add_f32_dpp v21, v18, v18 row_ror:8 row_mask:0xf bank_mask:0xc
  v_add_f32_dpp v21, v20, v20 row_ror:8 row_mask:0xf bank_mask:0x3
  v_add_f32_dpp v20, v239, v239 row_half_mirror row_mask:0xf bank_mask:0x5
  v_dot2_f32_bf16 v23, v130, v49, 0
  v_add_f32_dpp v20, v21, v21 row_half_mirror row_mask:0xf bank_mask:0xa
  v_dot2_f32_bf16 v24, v128, v50, 0
  v_dot2_f32_bf16 v25, v131, v51, 0
  v_add_f32_dpp v20, v20, v20 quad_perm:[2,3,0,1] row_mask:0xf bank_mask:0xf
  v_cvt_f32_i32 v72, v72
  v_cvt_f32_i32 v73, v73
  v_add_f32_dpp v20, v20, v20 quad_perm:[1,0,3,2] row_mask:0xf bank_mask:0xf
  v_cndmask_b32_e64 v236, v236, v20, s[52:53]
  v_cvt_f32_i32 v74, v74
  v_cvt_f32_i32 v75, v75
  v_pk_mul_f32 v[20:21], v[72:73], v[22:23]
  v_pk_add_f32 v[18:19], v[22:23], v[24:25]
  v_pk_fma_f32 v[20:21], v[74:75], v[24:25], v[20:21]
  v_add_f32 v18, v18, v19
  v_add_f32 v20, v20, v21
  s_cmpk_gt_i32 s69, 0x1f
  s_cbranch_scc1 L_p6_4
  s_cmp_gt_i32 s69, L_order_end-L_order-16391
  s_cbranch_scc1 L_p6_2
  s_waitcnt vmcnt(7)
L_p6_2:
  s_waitcnt vmcnt(11)
L_p6_4:
  s_waitcnt vmcnt(12)
  buffer_load_dwordx4 v[104:107], v214, s[32:35], s3 offen nt
  s_cmpk_gt_i32 s69, 0x1f
  s_cbranch_scc1 L_p7_4
  s_cmpk_gt_i32 s69, 0xb
  s_cbranch_scc1 L_p7_3
  s_cmpk_gt_i32 s69, 0xffbb
  s_cbranch_scc1 L_p7_0
  s_waitcnt vmcnt(7)
L_p7_0:
  s_waitcnt vmcnt(8)
L_p7_3:
  s_waitcnt vmcnt(12)
L_p7_4:
  s_waitcnt vmcnt(13)
  buffer_load_dwordx4 v[108:111], v215, s[32:35], s3 offen nt
L_it5:
  s_waitcnt lgkmcnt(0)
  ds_read_b128 v[40:43], v253 offset:512
  ds_read_b128 v[44:47], v252 offset:512
  ds_read_b128 v[48:51], v253 offset:1536
  s_waitcnt vmcnt(9)
  s_mov_b64 exec, 3
  s_add_u32 s44, s78, 0x03030303
  v_msad_u8 v9, s78, v36, 0
  v_msad_u8 v10, s44, v36, 0
  v_msad_u8 v9, s78, v37, v9
  v_msad_u8 v10, s44, v37, v10
  v_msad_u8 v9, s78, v38, v9
  v_msad_u8 v10, s44, v38, v10
  global_load_dwordx2 v[26:27], v11, s[30:31] sc1
  global_store_byte v7, v8, s[30:31]
  global_load_dwordx3 v[36:38], v233, s[30:31] sc1
  v_sub_u32 v9, v9, v10
  v_add_u32_e64 v8, 1, v8
  v_readlane_b32 s66, v9, 0
  v_readlane_b32 s67, v9, 1
  s_add_u32 s78, s78, 0x01010101
  s_mov_b64 exec, -1
  s_lshl1_add_u32 s69, s91, s95
  s_add_u32 s95, s66, s67
  s_add_u32 s69, s69, s95
  v_dot2_f32_bf16 v22, v129, v52, 0
  v_add_f32_dpp v240, v18, v18 row_ror:8 row_mask:0xf bank_mask:0xc
  v_add_f32_dpp v240, v20, v20 row_ror:8 row_mask:0xf bank_mask:0x3
  v_dot2_f32_bf16 v23, v134, v53, 0
  v_dot2_f32_bf16 v24, v132, v54, 0
  v_dot2_f32_bf16 v25, v135, v55, 0
  v_cvt_f32_i32 v76, v76
  v_cvt_f32_i32 v77, v77
  v_cvt_f32_i32 v78, v78
  v_cvt_f32_i32 v79, v79
  v_pk_mul_f32 v[20:21], v[76:77], v[22:23]
  v_pk_add_f32 v[18:19], v[22:23], v[24:25]
  v_pk_fma_f32 v[20:21], v[78:79], v[24:25], v[20:21]
  v_add_f32 v18, v18, v19
  v_add_f32 v20, v20, v21
  s_add_u32 m0, s100, 10240
  v_lshrrev_b32 v10, 1, v218
  v_add_u32 v10, v10, v244
  v_mad_u64_u32 v[30:31], s[64:65], v10, 1, v[28:29]
  global_load_lds_dwordx4 v[30:31], off
  v_dot2_f32_bf16 v22, v125, v56, 0
  v_add_f32_dpp v21, v18, v18 row_ror:8 row_mask:0xf bank_mask:0xc
  v_add_f32_dpp v21, v20, v20 row_ror:8 row_mask:0xf bank_mask:0x3
  v_add_f32_dpp v20, v240, v240 row_half_mirror row_mask:0xf bank_mask:0x5
  v_dot2_f32_bf16 v23, v130, v57, 0
  v_add_f32_dpp v20, v21, v21 row_half_mirror row_mask:0xf bank_mask:0xa
  v_dot2_f32_bf16 v24, v128, v58, 0
  v_dot2_f32_bf16 v25, v131, v59, 0
  v_add_f32_dpp v20, v20, v20 quad_perm:[2,3,0,1] row_mask:0xf bank_mask:0xf
  v_cvt_f32_i32 v80, v80
  v_cvt_f32_i32 v81, v81
  v_add_f32_dpp v20, v20, v20 quad_perm:[1,0,3,2] row_mask:0xf bank_mask:0xf
  v_cndmask_b32_e64 v237, v237, v20, s[52:53]
  v_cvt_f32_i32 v82, v82
  v_cvt_f32_i32 v83, v83
  v_pk_mul_f32 v[20:21], v[80:81], v[22:23]
  v_pk_add_f32 v[18:19], v[22:23], v[24:25]
  v_pk_fma_f32 v[20:21], v[82:83], v[24:25], v[20:21]
  v_add_f32 v18, v18, v19
  v_add_f32 v20, v20, v21
  s_cmpk_gt_i32 s69, 0x1f
  s_cbranch_scc1 L_p8_4
  s_cmp_gt_i32 s69, L_order_end-L_order-16421
  s_cbranch_scc1 L_p8_1
  s_waitcnt vmcnt(7)
L_p8_1:
  s_waitcnt vmcnt(11)
L_p8_4:
  s_waitcnt vmcnt(12)
  buffer_load_dwordx4 v[64:67], v216, s[32:35], 0 offen nt
  ds_read_b64 v[136:137], v12 offset:6144
  ds_read_b64 v[138:139], v12 offset:6272
  ds_read_b64 v[140:141], v12 offset:7168
  ds_read_b64 v[142:143], v12 offset:7296
  v_dot2_f32_bf16 v22, v129, v60, 0
  v_add_f32_dpp v241, v18, v18 row_ror:8 row_mask:0xf bank_mask:0xc
  v_add_f32_dpp v241, v20, v20 row_ror:8 row_mask:0xf bank_mask:0x3
  v_dot2_f32_bf16 v23, v134, v61, 0
  v_dot2_f32_bf16 v24, v132, v62, 0
  v_dot2_f32_bf16 v25, v135, v63, 0
  v_cvt_f32_i32 v84, v84
  v_cvt_f32_i32 v85, v85
  v_cvt_f32_i32 v86, v86
  v_cvt_f32_i32 v87, v87
  v_pk_mul_f32 v[20:21], v[84:85], v[22:23]
  v_pk_add_f32 v[18:19], v[22:23], v[24:25]
  v_pk_fma_f32 v[20:21], v[86:87], v[24:25], v[20:21]
  v_add_f32 v18, v18, v19
  v_add_f32 v20, v20, v21
  s_cmpk_gt_i32 s69, 0x1f
  s_cbranch_scc1 L_p9_4
  s_cmp_gt_i32 s69, L_order_end-L_order-16391
  s_cbranch_scc1 L_p9_2
  s_waitcnt vmcnt(8)
L_p9_2:
  s_waitcnt vmcnt(12)
L_p9_4:
  s_waitcnt vmcnt(13)
  buffer_load_dwordx4 v[68:71], v217, s[32:35], 0 offen nt
  s_cmpk_gt_i32 s69, 0x1f
  s_cbranch_scc1 L_p10_4
  s_cmpk_gt_i32 s69, 0xb
  s_cbranch_scc1 L_p10_3
  s_cmpk_gt_i32 s69, 0xffbb
  s_cbranch_scc1 L_p10_0
  s_waitcnt vmcnt(8)
L_p10_0:
  s_waitcnt vmcnt(9)
L_p10_3:
  s_waitcnt vmcnt(13)
L_p10_4:
  s_waitcnt vmcnt(14)
  buffer_load_dwordx4 v[72:75], v216, s[32:35], s80 offen nt
L_it6:
  s_waitcnt lgkmcnt(0)
  ds_read_b128 v[52:55], v252 offset:1536
  ds_read_b128 v[56:59], v253 offset:2560
  ds_read_b128 v[60:63], v252 offset:2560
  s_waitcnt vmcnt(10)
  s_mov_b64 exec, 3
  s_add_u32 s44, s78, 0x03030303
  v_msad_u8 v9, s78, v32, 0
  v_msad_u8 v10, s44, v32, 0
  v_msad_u8 v9, s78, v33, v9
  v_msad_u8 v10, s44, v33, v10
  v_msad_u8 v9, s78, v34, v9
  v_msad_u8 v10, s44, v34, v10
  global_store_byte v7, v8, s[30:31]
  global_load_dwordx3 v[32:34], v234, s[30:31] sc1
  v_sub_u32 v9, v9, v10
  v_add_u32_e64 v8, 1, v8
  v_readlane_b32 s66, v9, 0
  v_readlane_b32 s67, v9, 1
  s_add_u32 s78, s78, 0x01010101
  s_mov_b64 exec, -1
  s_lshl1_add_u32 s69, s91, s95
  s_add_u32 s95, s66, s67
  s_add_u32 s69, s69, s95
  v_perm_b32 v133, v138, v136, s56
  v_perm_b32 v138, v138, v136, s57
  v_perm_b32 v136, v139, v137, s56
  v_perm_b32 v139, v139, v137, s57
  v_dot2_f32_bf16 v22, v133, v40, 0
  v_add_f32_dpp v21, v18, v18 row_ror:8 row_mask:0xf bank_mask:0xc
  v_add_f32_dpp v21, v20, v20 row_ror:8 row_mask:0xf bank_mask:0x3
  v_add_f32_dpp v20, v241, v241 row_half_mirror row_mask:0xf bank_mask:0x5
  v_dot2_f32_bf16 v23, v138, v41, 0
  v_add_f32_dpp v20, v21, v21 row_half_mirror row_mask:0xf bank_mask:0xa
  v_dot2_f32_bf16 v24, v136, v42, 0
  v_dot2_f32_bf16 v25, v139, v43, 0
  v_add_f32_dpp v20, v20, v20 quad_perm:[2,3,0,1] row_mask:0xf bank_mask:0xf
  v_cvt_f32_i32 v88, v88
  v_cvt_f32_i32 v89, v89
  v_add_f32_dpp v20, v20, v20 quad_perm:[1,0,3,2] row_mask:0xf bank_mask:0xf
  v_cndmask_b32_e64 v238, v238, v20, s[52:53]
  v_cvt_f32_i32 v90, v90
  v_cvt_f32_i32 v91, v91
  v_pk_mul_f32 v[20:21], v[88:89], v[22:23]
  v_pk_add_f32 v[18:19], v[22:23], v[24:25]
  v_pk_fma_f32 v[20:21], v[90:91], v[24:25], v[20:21]
  v_add_f32 v18, v18, v19
  v_add_f32 v20, v20, v21
  s_add_u32 m0, s100, 11264
  v_lshrrev_b32 v10, 1, v219
  v_add_u32 v10, v10, v243
  v_mad_u64_u32 v[30:31], s[64:65], v10, 1, v[28:29]
  global_load_lds_dwordx4 v[30:31], off
  v_perm_b32 v137, v142, v140, s56
  v_perm_b32 v142, v142, v140, s57
  v_perm_b32 v140, v143, v141, s56
  v_perm_b32 v143, v143, v141, s57
  v_dot2_f32_bf16 v22, v137, v44, 0
  v_add_f32_dpp v239, v18, v18 row_ror:8 row_mask:0xf bank_mask:0xc
  v_add_f32_dpp v239, v20, v20 row_ror:8 row_mask:0xf bank_mask:0x3
  v_dot2_f32_bf16 v23, v142, v45, 0
  v_dot2_f32_bf16 v24, v140, v46, 0
  v_dot2_f32_bf16 v25, v143, v47, 0
  v_cvt_f32_i32 v92, v92
  v_cvt_f32_i32 v93, v93
  v_cvt_f32_i32 v94, v94
  v_cvt_f32_i32 v95, v95
  v_pk_mul_f32 v[20:21], v[92:93], v[22:23]
  v_pk_add_f32 v[18:19], v[22:23], v[24:25]
  v_pk_fma_f32 v[20:21], v[94:95], v[24:25], v[20:21]
  v_add_f32 v18, v18, v19
  v_add_f32 v20, v20, v21
  s_cmpk_gt_i32 s69, 0x1f
  s_cbranch_scc1 L_p11_4
  s_cmp_gt_i32 s69, L_order_end-L_order-16421
  s_cbranch_scc1 L_p11_1
  s_waitcnt vmcnt(6)
L_p11_1:
  s_waitcnt vmcnt(11)
L_p11_4:
  s_waitcnt vmcnt(12)
  buffer_load_dwordx4 v[76:79], v217, s[32:35], s80 offen nt
  v_dot2_f32_bf16 v22, v133, v48, 0
  v_add_f32_dpp v21, v18, v18 row_ror:8 row_mask:0xf bank_mask:0xc
  v_add_f32_dpp v21, v20, v20 row_ror:8 row_mask:0xf bank_mask:0x3
  v_add_f32_dpp v20, v239, v239 row_half_mirror row_mask:0xf bank_mask:0x5
  v_dot2_f32_bf16 v23, v138, v49, 0
  v_add_f32_dpp v20, v21, v21 row_half_mirror row_mask:0xf bank_mask:0xa
  v_dot2_f32_bf16 v24, v136, v50, 0
  v_dot2_f32_bf16 v25, v139, v51, 0
  v_add_f32_dpp v20, v20, v20 quad_perm:[2,3,0,1] row_mask:0xf bank_mask:0xf
  v_cvt_f32_i32 v96, v96
  v_cvt_f32_i32 v97, v97
  v_add_f32_dpp v20, v20, v20 quad_perm:[1,0,3,2] row_mask:0xf bank_mask:0xf
  v_cndmask_b32_e64 v236, v236, v20, s[54:55]
  ds_write_b32 v15, v236 offset:0
  v_cvt_f32_i32 v98, v98
  v_cvt_f32_i32 v99, v99
  v_pk_mul_f32 v[20:21], v[96:97], v[22:23]
  v_pk_add_f32 v[18:19], v[22:23], v[24:25]
  v_pk_fma_f32 v[20:21], v[98:99], v[24:25], v[20:21]
  v_add_f32 v18, v18, v19
  v_add_f32 v20, v20, v21
  s_cmpk_gt_i32 s69, 0x1f
  s_cbranch_scc1 L_p12_4
  s_cmp_gt_i32 s69, L_order_end-L_order-16391
  s_cbranch_scc1 L_p12_2
  s_waitcnt vmcnt(7)
L_p12_2:
  s_waitcnt vmcnt(12)
L_p12_4:
  s_waitcnt vmcnt(13)
  buffer_load_dwordx4 v[80:83], v216, s[32:35], s3 offen nt
  s_cmpk_gt_i32 s69, 0x1f
  s_cbranch_scc1 L_p13_4
  s_cmpk_gt_i32 s69, 0xb
  s_cbranch_scc1 L_p13_3
  s_cmpk_gt_i32 s69, 0xffbb
  s_cbranch_scc1 L_p13_0
  s_waitcnt vmcnt(7)
L_p13_0:
  s_waitcnt vmcnt(8)
L_p13_3:
  s_waitcnt vmcnt(13)
L_p13_4:
  s_waitcnt vmcnt(14)
  buffer_load_dwordx4 v[84:87], v217, s[32:35], s3 offen nt
L_it7:
  s_waitcnt lgkmcnt(0)
  ds_read_b128 v[40:43], v249 offset:512
  ds_read_b128 v[44:47], v248 offset:512
  ds_read_b128 v[48:51], v249 offset:1536
  s_waitcnt vmcnt(9)
  s_mov_b64 exec, 3
  s_add_u32 s44, s78, 0x03030303
  v_msad_u8 v9, s78, v36, 0
  v_msad_u8 v10, s44, v36, 0
  v_msad_u8 v9, s78, v37, v9
  v_msad_u8 v10, s44, v37, v10
  v_msad_u8 v9, s78, v38, v9
  v_msad_u8 v10, s44, v38, v10
  global_store_byte v7, v8, s[30:31]
  global_load_dwordx3 v[36:38], v235, s[30:31] sc1
  v_sub_u32 v9, v9, v10
  v_add_u32_e64 v8, 1, v8
  v_add3_u32 v10, v26, v27, s58
  v_readlane_b32 s66, v9, 0
  v_readlane_b32 s67, v9, 1
  v_readlane_b32 s91, v10, 0
  s_add_u32 s78, s78, 0x01010101
  s_mov_b64 exec, -1
  s_lshl1_add_u32 s69, s91, s95
  s_add_u32 s95, s66, s67
  s_add_u32 s69, s69, s95
  v_dot2_f32_bf16 v22, v137, v52, 0
  v_add_f32_dpp v240, v18, v18 row_ror:8 row_mask:0xf bank_mask:0xc
  v_add_f32_dpp v240, v20, v20 row_ror:8 row_mask:0xf bank_mask:0x3
  v_dot2_f32_bf16 v23, v142, v53, 0
  v_dot2_f32_bf16 v24, v140, v54, 0
  v_dot2_f32_bf16 v25, v143, v55, 0
  v_cvt_f32_i32 v100, v100
  v_cvt_f32_i32 v101, v101
  v_cvt_f32_i32 v102, v102
  v_cvt_f32_i32 v103, v103
  v_pk_mul_f32 v[20:21], v[100:101], v[22:23]
  v_pk_add_f32 v[18:19], v[22:23], v[24:25]
  v_pk_fma_f32 v[20:21], v[102:103], v[24:25], v[20:21]
  v_add_f32 v18, v18, v19
  v_add_f32 v20, v20, v21
  s_add_u32 m0, s100, 12288
  v_lshrrev_b32 v10, 1, v220
  v_add_u32 v10, v10, v247
  v_mad_u64_u32 v[30:31], s[64:65], v10, 1, v[28:29]
  global_load_lds_dwordx4 v[30:31], off
  v_dot2_f32_bf16 v22, v133, v56, 0
  v_add_f32_dpp v21, v18, v18 row_ror:8 row_mask:0xf bank_mask:0xc
  v_add_f32_dpp v21, v20, v20 row_ror:8 row_mask:0xf bank_mask:0x3
  v_add_f32_dpp v20, v240, v240 row_half_mirror row_mask:0xf bank_mask:0x5
  v_dot2_f32_bf16 v23, v138, v57, 0
  v_add_f32_dpp v20, v21, v21 row_half_mirror row_mask:0xf bank_mask:0xa
  v_dot2_f32_bf16 v24, v136, v58, 0
  v_dot2_f32_bf16 v25, v139, v59, 0
  v_add_f32_dpp v20, v20, v20 quad_perm:[2,3,0,1] row_mask:0xf bank_mask:0xf
  v_cvt_f32_i32 v104, v104
  v_cvt_f32_i32 v105, v105
  v_add_f32_dpp v20, v20, v20 quad_perm:[1,0,3,2] row_mask:0xf bank_mask:0xf
  v_cndmask_b32_e64 v237, v237, v20, s[54:55]
  ds_write_b32 v15, v237 offset:3072
  v_cvt_f32_i32 v106, v106
  v_cvt_f32_i32 v107, v107
  v_pk_mul_f32 v[20:21], v[104:105], v[22:23]
  v_pk_add_f32 v[18:19], v[22:23], v[24:25]
  v_pk_fma_f32 v[20:21], v[106:107], v[24:25], v[20:21]
  v_add_f32 v18, v18, v19
  v_add_f32 v20, v20, v21
  s_cmpk_gt_i32 s69, 0x1f
  s_cbranch_scc1 L_p14_4
  s_cmp_gt_i32 s69, L_order_end-L_order-16421
  s_cbranch_scc1 L_p14_1
  s_waitcnt vmcnt(6)
L_p14_1:
  s_waitcnt vmcnt(10)
L_p14_4:
  s_waitcnt vmcnt(11)
  buffer_load_dwordx4 v[88:91], v218, s[32:35], 0 offen nt
  ds_read_b64 v[144:145], v12 offset:8192
  ds_read_b64 v[146:147], v12 offset:8320
  ds_read_b64 v[148:149], v12 offset:9216
  ds_read_b64 v[150:151], v12 offset:9344
  v_dot2_f32_bf16 v22, v137, v60, 0
  v_add_f32_dpp v241, v18, v18 row_ror:8 row_mask:0xf bank_mask:0xc
  v_add_f32_dpp v241, v20, v20 row_ror:8 row_mask:0xf bank_mask:0x3
  v_dot2_f32_bf16 v23, v142, v61, 0
  v_dot2_f32_bf16 v24, v140, v62, 0
  v_dot2_f32_bf16 v25, v143, v63, 0
  v_cvt_f32_i32 v108, v108
  v_cvt_f32_i32 v109, v109
  v_cvt_f32_i32 v110, v110
  v_cvt_f32_i32 v111, v111
  v_pk_mul_f32 v[20:21], v[108:109], v[22:23]
  v_pk_add_f32 v[18:19], v[22:23], v[24:25]
  v_pk_fma_f32 v[20:21], v[110:111], v[24:25], v[20:21]
  v_add_f32 v18, v18, v19
  v_add_f32 v20, v20, v21
  s_cmpk_gt_i32 s69, 0x1f
  s_cbranch_scc1 L_p15_4
  s_cmp_gt_i32 s69, L_order_end-L_order-16391
  s_cbranch_scc1 L_p15_2
  s_waitcnt vmcnt(7)
L_p15_2:
  s_waitcnt vmcnt(11)
L_p15_4:
  s_waitcnt vmcnt(12)
  buffer_load_dwordx4 v[92:95], v219, s[32:35], 0 offen nt
  s_cmpk_gt_i32 s69, 0x1f
  s_cbranch_scc1 L_p16_4
  s_cmpk_gt_i32 s69, 0xb
  s_cbranch_scc1 L_p16_3
  s_cmpk_gt_i32 s69, 0xffbb
  s_cbranch_scc1 L_p16_0
  s_waitcnt vmcnt(7)
L_p16_0:
  s_waitcnt vmcnt(8)
L_p16_3:
  s_waitcnt vmcnt(12)
L_p16_4:
  s_waitcnt vmcnt(13)
  buffer_load_dwordx4 v[96:99], v218, s[32:35], s80 offen nt
  v_mov_b32_e64 v9, 1
  ds_write_b32 v6, v9 offset:0
L_it8:
  s_waitcnt lgkmcnt(0)
  ds_read_b128 v[52:55], v248 offset:1536
  ds_read_b128 v[56:59], v249 offset:2560
  ds_read_b128 v[60:63], v248 offset:2560
  s_waitcnt vmcnt(9)
  s_mov_b64 exec, 3
  s_add_u32 s44, s78, 0x03030303
  v_msad_u8 v9, s78, v32, 0
  v_msad_u8 v10, s44, v32, 0
  v_msad_u8 v9, s78, v33, v9
  v_msad_u8 v10, s44, v33, v10
  v_msad_u8 v9, s78, v34, v9
  v_msad_u8 v10, s44, v34, v10
  global_store_byte v7, v8, s[30:31]
  global_load_dwordx3 v[32:34], v232, s[30:31] sc1
  v_sub_u32 v9, v9, v10
  v_add_u32_e64 v8, 1, v8
  v_readlane_b32 s66, v9, 0
  v_readlane_b32 s67, v9, 1
  s_add_u32 s78, s78, 0x01010101
  s_mov_b64 exec, -1
  s_lshl1_add_u32 s69, s91, s95
  s_add_u32 s95, s66, s67
  s_add_u32 s69, s69, s95
  v_perm_b32 v141, v146, v144, s56
  v_perm_b32 v146, v146, v144, s57
  v_perm_b32 v144, v147, v145, s56
  v_perm_b32 v147, v147, v145, s57
  v_dot2_f32_bf16 v22, v141, v40, 0
  v_add_f32_dpp v21, v18, v18 row_ror:8 row_mask:0xf bank_mask:0xc
  v_add_f32_dpp v21, v20, v20 row_ror:8 row_mask:0xf bank_mask:0x3
  v_add_f32_dpp v20, v241, v241 row_half_mirror row_mask:0xf bank_mask:0x5
  v_dot2_f32_bf16 v23, v146, v41, 0
  v_add_f32_dpp v20, v21, v21 row_half_mirror row_mask:0xf bank_mask:0xa
  v_dot2_f32_bf16 v24, v144, v42, 0
  v_dot2_f32_bf16 v25, v147, v43, 0
  v_add_f32_dpp v20, v20, v20 quad_perm:[2,3,0,1] row_mask:0xf bank_mask:0xf
  v_cvt_f32_i32 v64, v64
  v_cvt_f32_i32 v65, v65
  v_add_f32_dpp v20, v20, v20 quad_perm:[1,0,3,2] row_mask:0xf bank_mask:0xf
  v_cndmask_b32_e64 v238, v238, v20, s[54:55]
  ds_write_b32 v15, v238 offset:6144
  v_cvt_f32_i32 v66, v66
  v_cvt_f32_i32 v67, v67
  v_pk_mul_f32 v[20:21], v[64:65], v[22:23]
  v_pk_add_f32 v[18:19], v[22:23], v[24:25]
  v_pk_fma_f32 v[20:21], v[66:67], v[24:25], v[20:21]
  v_add_f32 v18, v18, v19
  v_add_f32 v20, v20, v21
  s_add_u32 m0, s100, 13312
  v_lshrrev_b32 v10, 1, v221
  v_add_u32 v10, v10, v246
  v_mad_u64_u32 v[30:31], s[64:65], v10, 1, v[28:29]
  global_load_lds_dwordx4 v[30:31], off
  v_perm_b32 v145, v150, v148, s56
  v_perm_b32 v150, v150, v148, s57
  v_perm_b32 v148, v151, v149, s56
  v_perm_b32 v151, v151, v149, s57
  v_dot2_f32_bf16 v22, v145, v44, 0
  v_add_f32_dpp v239, v18, v18 row_ror:8 row_mask:0xf bank_mask:0xc
  v_add_f32_dpp v239, v20, v20 row_ror:8 row_mask:0xf bank_mask:0x3
  v_dot2_f32_bf16 v23, v150, v45, 0
  v_dot2_f32_bf16 v24, v148, v46, 0
  v_dot2_f32_bf16 v25, v151, v47, 0
  v_cvt_f32_i32 v68, v68
  v_cvt_f32_i32 v69, v69
  v_cvt_f32_i32 v70, v70
  v_cvt_f32_i32 v71, v71
  v_pk_mul_f32 v[20:21], v[68:69], v[22:23]
  v_pk_add_f32 v[18:19], v[22:23], v[24:25]
  v_pk_fma_f32 v[20:21], v[70:71], v[24:25], v[20:21]
  v_add_f32 v18, v18, v19
  v_add_f32 v20, v20, v21
  s_cmpk_gt_i32 s69, 0x1f
  s_cbranch_scc1 L_p17_4
  s_cmp_gt_i32 s69, L_order_end-L_order-16421
  s_cbranch_scc1 L_p17_1
  s_waitcnt vmcnt(6)
L_p17_1:
  s_waitcnt vmcnt(10)
L_p17_4:
  s_waitcnt vmcnt(11)
  buffer_load_dwordx4 v[100:103], v219, s[32:35], s80 offen nt
  v_dot2_f32_bf16 v22, v141, v48, 0
  v_add_f32_dpp v21, v18, v18 row_ror:8 row_mask:0xf bank_mask:0xc
  v_add_f32_dpp v21, v20, v20 row_ror:8 row_mask:0xf bank_mask:0x3
  v_add_f32_dpp v20, v239, v239 row_half_mirror row_mask:0xf bank_mask:0x5
  v_dot2_f32_bf16 v23, v146, v49, 0
  v_add_f32_dpp v20, v21, v21 row_half_mirror row_mask:0xf bank_mask:0xa
  v_dot2_f32_bf16 v24, v144, v50, 0
  v_dot2_f32_bf16 v25, v147, v51, 0
  v_add_f32_dpp v20, v20, v20 quad_perm:[2,3,0,1] row_mask:0xf bank_mask:0xf
  v_cvt_f32_i32 v72, v72
  v_cvt_f32_i32 v73, v73
  v_add_f32_dpp v20, v20, v20 quad_perm:[1,0,3,2] row_mask:0xf bank_mask:0xf
  v_cndmask_b32_e64 v236, v236, v20, s[48:49]
  v_cvt_f32_i32 v74, v74
  v_cvt_f32_i32 v75, v75
  v_pk_mul_f32 v[20:21], v[72:73], v[22:23]
  v_pk_add_f32 v[18:19], v[22:23], v[24:25]
  v_pk_fma_f32 v[20:21], v[74:75], v[24:25], v[20:21]
  v_add_f32 v18, v18, v19
  v_add_f32 v20, v20, v21
  s_cmpk_gt_i32 s69, 0x1f
  s_cbranch_scc1 L_p18_4
  s_cmp_gt_i32 s69, L_order_end-L_order-16391
  s_cbranch_scc1 L_p18_2
  s_waitcnt vmcnt(7)
L_p18_2:
  s_waitcnt vmcnt(11)
L_p18_4:
  s_waitcnt vmcnt(12)
  buffer_load_dwordx4 v[104:107], v218, s[32:35], s3 offen nt
  s_cmpk_gt_i32 s69, 0x1f
  s_cbranch_scc1 L_p19_4
  s_cmpk_gt_i32 s69, 0xb
  s_cbranch_scc1 L_p19_3
  s_cmpk_gt_i32 s69, 0xffbb
  s_cbranch_scc1 L_p19_0
  s_waitcnt vmcnt(7)
L_p19_0:
  s_waitcnt vmcnt(8)
L_p19_3:
  s_waitcnt vmcnt(12)
L_p19_4:
  s_waitcnt vmcnt(13)
  buffer_load_dwordx4 v[108:111], v219, s[32:35], s3 offen nt
L_it9:
  s_waitcnt lgkmcnt(0)
  ds_read_b128 v[40:43], v250 offset:512
  ds_read_b128 v[44:47], v249 offset:512
  ds_read_b128 v[48:51], v250 offset:1536
  s_waitcnt vmcnt(9)
  s_mov_b64 exec, 3
  s_add_u32 s44, s78, 0x03030303
  v_msad_u8 v9, s78, v36, 0
  v_msad_u8 v10, s44, v36, 0
  v_msad_u8 v9, s78, v37, v9
  v_msad_u8 v10, s44, v37, v10
  v_msad_u8 v9, s78, v38, v9
  v_msad_u8 v10, s44, v38, v10
  global_store_byte v7, v8, s[30:31]
  global_load_dwordx3 v[36:38], v233, s[30:31] sc1
  v_sub_u32 v9, v9, v10
  v_add_u32_e64 v8, 1, v8
  v_readlane_b32 s66, v9, 0
  v_readlane_b32 s67, v9, 1
  s_add_u32 s78, s78, 0x01010101
  s_mov_b64 exec, -1
  s_lshl1_add_u32 s69, s91, s95
  s_add_u32 s95, s66, s67
  s_add_u32 s69, s69, s95
  v_dot2_f32_bf16 v22, v145, v52, 0
  v_add_f32_dpp v240, v18, v18 row_ror:8 row_mask:0xf bank_mask:0xc
  v_add_f32_dpp v240, v20, v20 row_ror:8 row_mask:0xf bank_mask:0x3
  v_dot2_f32_bf16 v23, v150, v53, 0
  v_dot2_f32_bf16 v24, v148, v54, 0
  v_dot2_f32_bf16 v25, v151, v55, 0
  v_cvt_f32_i32 v76, v76
  v_cvt_f32_i32 v77, v77
  v_cvt_f32_i32 v78, v78
  v_cvt_f32_i32 v79, v79
  v_pk_mul_f32 v[20:21], v[76:77], v[22:23]
  v_pk_add_f32 v[18:19], v[22:23], v[24:25]
  v_pk_fma_f32 v[20:21], v[78:79], v[24:25], v[20:21]
  v_add_f32 v18, v18, v19
  v_add_f32 v20, v20, v21
  s_add_u32 m0, s100, 14336
  v_lshrrev_b32 v10, 1, v222
  v_add_u32 v10, v10, v245
  v_mad_u64_u32 v[30:31], s[64:65], v10, 1, v[28:29]
  global_load_lds_dwordx4 v[30:31], off
  v_dot2_f32_bf16 v22, v141, v56, 0
  v_add_f32_dpp v21, v18, v18 row_ror:8 row_mask:0xf bank_mask:0xc
  v_add_f32_dpp v21, v20, v20 row_ror:8 row_mask:0xf bank_mask:0x3
  v_add_f32_dpp v20, v240, v240 row_half_mirror row_mask:0xf bank_mask:0x5
  v_dot2_f32_bf16 v23, v146, v57, 0
  v_add_f32_dpp v20, v21, v21 row_half_mirror row_mask:0xf bank_mask:0xa
  v_dot2_f32_bf16 v24, v144, v58, 0
  v_dot2_f32_bf16 v25, v147, v59, 0
  v_add_f32_dpp v20, v20, v20 quad_perm:[2,3,0,1] row_mask:0xf bank_mask:0xf
  v_cvt_f32_i32 v80, v80
  v_cvt_f32_i32 v81, v81
  v_add_f32_dpp v20, v20, v20 quad_perm:[1,0,3,2] row_mask:0xf bank_mask:0xf
  v_cndmask_b32_e64 v237, v237, v20, s[48:49]
  v_cvt_f32_i32 v82, v82
  v_cvt_f32_i32 v83, v83
  v_pk_mul_f32 v[20:21], v[80:81], v[22:23]
  v_pk_add_f32 v[18:19], v[22:23], v[24:25]
  v_pk_fma_f32 v[20:21], v[82:83], v[24:25], v[20:21]
  v_add_f32 v18, v18, v19
  v_add_f32 v20, v20, v21
  s_cmpk_gt_i32 s69, 0x1f
  s_cbranch_scc1 L_p20_4
  s_cmp_gt_i32 s69, L_order_end-L_order-16421
  s_cbranch_scc1 L_p20_1
  s_waitcnt vmcnt(6)
L_p20_1:
  s_waitcnt vmcnt(10)
L_p20_4:
  s_waitcnt vmcnt(11)
  buffer_load_dwordx4 v[64:67], v220, s[32:35], 0 offen nt
  ds_read_b64 v[152:153], v12 offset:10240
  ds_read_b64 v[154:155], v12 offset:10368
  ds_read_b64 v[156:157], v12 offset:11264
  ds_read_b64 v[158:159], v12 offset:11392
  v_dot2_f32_bf16 v22, v145, v60, 0
  v_add_f32_dpp v241, v18, v18 row_ror:8 row_mask:0xf bank_mask:0xc
  v_add_f32_dpp v241, v20, v20 row_ror:8 row_mask:0xf bank_mask:0x3
  v_dot2_f32_bf16 v23, v150, v61, 0
  v_dot2_f32_bf16 v24, v148, v62, 0
  v_dot2_f32_bf16 v25, v151, v63, 0
  v_cvt_f32_i32 v84, v84
  v_cvt_f32_i32 v85, v85
  v_cvt_f32_i32 v86, v86
  v_cvt_f32_i32 v87, v87
  v_pk_mul_f32 v[20:21], v[84:85], v[22:23]
  v_pk_add_f32 v[18:19], v[22:23], v[24:25]
  v_pk_fma_f32 v[20:21], v[86:87], v[24:25], v[20:21]
  v_add_f32 v18, v18, v19
  v_add_f32 v20, v20, v21
  s_cmpk_gt_i32 s69, 0x1f
  s_cbranch_scc1 L_p21_4
  s_cmp_gt_i32 s69, L_order_end-L_order-16391
  s_cbranch_scc1 L_p21_2
  s_waitcnt vmcnt(7)
L_p21_2:
  s_waitcnt vmcnt(11)
L_p21_4:
  s_waitcnt vmcnt(12)
  buffer_load_dwordx4 v[68:71], v221, s[32:35], 0 offen nt
  s_cmpk_gt_i32 s69, 0x1f
  s_cbranch_scc1 L_p22_4
  s_cmpk_gt_i32 s69, 0xb
  s_cbranch_scc1 L_p22_3
  s_cmpk_gt_i32 s69, 0xffbb
  s_cbranch_scc1 L_p22_0
  s_waitcnt vmcnt(7)
L_p22_0:
  s_waitcnt vmcnt(8)
L_p22_3:
  s_waitcnt vmcnt(12)
L_p22_4:
  s_waitcnt vmcnt(13)
  buffer_load_dwordx4 v[72:75], v220, s[32:35], s80 offen nt
L_it10:
  s_waitcnt lgkmcnt(0)
  ds_read_b128 v[52:55], v249 offset:1536
  ds_read_b128 v[56:59], v250 offset:2560
  ds_read_b128 v[60:63], v249 offset:2560
  s_waitcnt vmcnt(9)
  s_mov_b64 exec, 3
  s_add_u32 s44, s78, 0x03030303
  v_msad_u8 v9, s78, v32, 0
  v_msad_u8 v10, s44, v32, 0
  v_msad_u8 v9, s78, v33, v9
  v_msad_u8 v10, s44, v33, v10
  v_msad_u8 v9, s78, v34, v9
  v_msad_u8 v10, s44, v34, v10
  global_store_byte v7, v8, s[30:31]
  global_load_dwordx3 v[32:34], v234, s[30:31] sc1
  v_sub_u32 v9, v9, v10
  v_add_u32_e64 v8, 1, v8
  v_readlane_b32 s66, v9, 0
  v_readlane_b32 s67, v9, 1
  s_add_u32 s78, s78, 0x01010101
  s_mov_b64 exec, -1
  s_lshl1_add_u32 s69, s91, s95
  s_add_u32 s95, s66, s67
  s_add_u32 s69, s69, s95
  v_perm_b32 v149, v154, v152, s56
  v_perm_b32 v154, v154, v152, s57
  v_perm_b32 v152, v155, v153, s56
  v_perm_b32 v155, v155, v153, s57
  v_dot2_f32_bf16 v22, v149, v40, 0
  v_add_f32_dpp v21, v18, v18 row_ror:8 row_mask:0xf bank_mask:0xc
  v_add_f32_dpp v21, v20, v20 row_ror:8 row_mask:0xf bank_mask:0x3
  v_add_f32_dpp v20, v241, v241 row_half_mirror row_mask:0xf bank_mask:0x5
  v_dot2_f32_bf16 v23, v154, v41, 0
  v_add_f32_dpp v20, v21, v21 row_half_mirror row_mask:0xf bank_mask:0xa
  v_dot2_f32_bf16 v24, v152, v42, 0
  v_dot2_f32_bf16 v25, v155, v43, 0
  v_add_f32_dpp v20, v20, v20 quad_perm:[2,3,0,1] row_mask:0xf bank_mask:0xf
  v_cvt_f32_i32 v88, v88
  v_cvt_f32_i32 v89, v89
  v_add_f32_dpp v20, v20, v20 quad_perm:[1,0,3,2] row_mask:0xf bank_mask:0xf
  v_cndmask_b32_e64 v238, v238, v20, s[48:49]
  v_cvt_f32_i32 v90, v90
  v_cvt_f32_i32 v91, v91
  v_pk_mul_f32 v[20:21], v[88:89], v[22:23]
  v_pk_add_f32 v[18:19], v[22:23], v[24:25]
  v_pk_fma_f32 v[20:21], v[90:91], v[24:25], v[20:21]
  v_add_f32 v18, v18, v19
  v_add_f32 v20, v20, v21
  s_add_u32 m0, s100, 15360
  v_lshrrev_b32 v10, 1, v223
  v_add_u32 v10, v10, v247
  v_mad_u64_u32 v[30:31], s[64:65], v10, 1, v[28:29]
  global_load_lds_dwordx4 v[30:31], off
  v_perm_b32 v153, v158, v156, s56
  v_perm_b32 v158, v158, v156, s57
  v_perm_b32 v156, v159, v157, s56
  v_perm_b32 v159, v159, v157, s57
  v_dot2_f32_bf16 v22, v153, v44, 0
  v_add_f32_dpp v239, v18, v18 row_ror:8 row_mask:0xf bank_mask:0xc
  v_add_f32_dpp v239, v20, v20 row_ror:8 row_mask:0xf bank_mask:0x3
  v_dot2_f32_bf16 v23, v158, v45, 0
  v_dot2_f32_bf16 v24, v156, v46, 0
  v_dot2_f32_bf16 v25, v159, v47, 0
  v_cvt_f32_i32 v92, v92
  v_cvt_f32_i32 v93, v93
  v_cvt_f32_i32 v94, v94
  v_cvt_f32_i32 v95, v95
  v_pk_mul_f32 v[20:21], v[92:93], v[22:23]
  v_pk_add_f32 v[18:19], v[22:23], v[24:25]
  v_pk_fma_f32 v[20:21], v[94:95], v[24:25], v[20:21]
  v_add_f32 v18, v18, v19
  v_add_f32 v20, v20, v21
  s_cmpk_gt_i32 s69, 0x1f
  s_cbranch_scc1 L_p23_4
  s_cmp_gt_i32 s69, L_order_end-L_order-16421
  s_cbranch_scc1 L_p23_1
  s_waitcnt vmcnt(6)
L_p23_1:
  s_waitcnt vmcnt(10)
L_p23_4:
  s_waitcnt vmcnt(11)
  buffer_load_dwordx4 v[76:79], v221, s[32:35], s80 offen nt
  v_dot2_f32_bf16 v22, v149, v48, 0
  v_add_f32_dpp v21, v18, v18 row_ror:8 row_mask:0xf bank_mask:0xc
  v_add_f32_dpp v21, v20, v20 row_ror:8 row_mask:0xf bank_mask:0x3
  v_add_f32_dpp v20, v239, v239 row_half_mirror row_mask:0xf bank_mask:0x5
  v_dot2_f32_bf16 v23, v154, v49, 0
  v_add_f32_dpp v20, v21, v21 row_half_mirror row_mask:0xf bank_mask:0xa
  v_dot2_f32_bf16 v24, v152, v50, 0
  v_dot2_f32_bf16 v25, v155, v51, 0
  v_add_f32_dpp v20, v20, v20 quad_perm:[2,3,0,1] row_mask:0xf bank_mask:0xf
  v_cvt_f32_i32 v96, v96
  v_cvt_f32_i32 v97, v97
  v_add_f32_dpp v20, v20, v20 quad_perm:[1,0,3,2] row_mask:0xf bank_mask:0xf
  v_cndmask_b32_e64 v236, v236, v20, s[50:51]
  v_cvt_f32_i32 v98, v98
  v_cvt_f32_i32 v99, v99
  v_pk_mul_f32 v[20:21], v[96:97], v[22:23]
  v_pk_add_f32 v[18:19], v[22:23], v[24:25]
  v_pk_fma_f32 v[20:21], v[98:99], v[24:25], v[20:21]
  v_add_f32 v18, v18, v19
  v_add_f32 v20, v20, v21
  s_cmpk_gt_i32 s69, 0x1f
  s_cbranch_scc1 L_p24_4
  s_cmp_gt_i32 s69, L_order_end-L_order-16391
  s_cbranch_scc1 L_p24_2
  s_waitcnt vmcnt(7)
L_p24_2:
  s_waitcnt vmcnt(11)
L_p24_4:
  s_waitcnt vmcnt(12)
  buffer_load_dwordx4 v[80:83], v220, s[32:35], s3 offen nt
  s_cmpk_gt_i32 s69, 0x1f
  s_cbranch_scc1 L_p25_4
  s_cmpk_gt_i32 s69, 0xb
  s_cbranch_scc1 L_p25_3
  s_cmpk_gt_i32 s69, 0xffbb
  s_cbranch_scc1 L_p25_0
  s_waitcnt vmcnt(7)
L_p25_0:
  s_waitcnt vmcnt(8)
L_p25_3:
  s_waitcnt vmcnt(12)
L_p25_4:
  s_waitcnt vmcnt(13)
  buffer_load_dwordx4 v[84:87], v221, s[32:35], s3 offen nt
L_it11:
  s_waitcnt lgkmcnt(0)
  ds_read_b128 v[40:43], v253 offset:512
  ds_read_b128 v[44:47], v252 offset:512
  ds_read_b128 v[48:51], v253 offset:1536
  s_waitcnt vmcnt(9)
  s_mov_b64 exec, 3
  s_add_u32 s44, s78, 0x03030303
  v_msad_u8 v9, s78, v36, 0
  v_msad_u8 v10, s44, v36, 0
  v_msad_u8 v9, s78, v37, v9
  v_msad_u8 v10, s44, v37, v10
  v_msad_u8 v9, s78, v38, v9
  v_msad_u8 v10, s44, v38, v10
  global_store_byte v7, v8, s[30:31]
  global_load_dwordx3 v[36:38], v235, s[30:31] sc1
  v_sub_u32 v9, v9, v10
  v_add_u32_e64 v8, 1, v8
  v_readlane_b32 s66, v9, 0
  v_readlane_b32 s67, v9, 1
  s_add_u32 s78, s78, 0x01010101
  s_mov_b64 exec, -1
  s_lshl1_add_u32 s69, s91, s95
  s_add_u32 s95, s66, s67
  s_add_u32 s69, s69, s95
  v_dot2_f32_bf16 v22, v153, v52, 0
  v_add_f32_dpp v240, v18, v18 row_ror:8 row_mask:0xf bank_mask:0xc
  v_add_f32_dpp v240, v20, v20 row_ror:8 row_mask:0xf bank_mask:0x3
  v_dot2_f32_bf16 v23, v158, v53, 0
  v_dot2_f32_bf16 v24, v156, v54, 0
  v_dot2_f32_bf16 v25, v159, v55, 0
  v_cvt_f32_i32 v100, v100
  v_cvt_f32_i32 v101, v101
  v_cvt_f32_i32 v102, v102
  v_cvt_f32_i32 v103, v103
  v_pk_mul_f32 v[20:21], v[100:101], v[22:23]
  v_pk_add_f32 v[18:19], v[22:23], v[24:25]
  v_pk_fma_f32 v[20:21], v[102:103], v[24:25], v[20:21]
  v_add_f32 v18, v18, v19
  v_add_f32 v20, v20, v21
  s_add_u32 m0, s100, 16384
  v_lshrrev_b32 v10, 1, v224
  v_add_u32 v10, v10, v244
  v_mad_u64_u32 v[30:31], s[64:65], v10, 1, v[28:29]
  global_load_lds_dwordx4 v[30:31], off
  v_dot2_f32_bf16 v22, v149, v56, 0
  v_add_f32_dpp v21, v18, v18 row_ror:8 row_mask:0xf bank_mask:0xc
  v_add_f32_dpp v21, v20, v20 row_ror:8 row_mask:0xf bank_mask:0x3
  v_add_f32_dpp v20, v240, v240 row_half_mirror row_mask:0xf bank_mask:0x5
  v_dot2_f32_bf16 v23, v154, v57, 0
  v_add_f32_dpp v20, v21, v21 row_half_mirror row_mask:0xf bank_mask:0xa
  v_dot2_f32_bf16 v24, v152, v58, 0
  v_dot2_f32_bf16 v25, v155, v59, 0
  v_add_f32_dpp v20, v20, v20 quad_perm:[2,3,0,1] row_mask:0xf bank_mask:0xf
  v_cvt_f32_i32 v104, v104
  v_cvt_f32_i32 v105, v105
  v_add_f32_dpp v20, v20, v20 quad_perm:[1,0,3,2] row_mask:0xf bank_mask:0xf
  v_cndmask_b32_e64 v237, v237, v20, s[50:51]
  v_cvt_f32_i32 v106, v106
  v_cvt_f32_i32 v107, v107
  v_pk_mul_f32 v[20:21], v[104:105], v[22:23]
  v_pk_add_f32 v[18:19], v[22:23], v[24:25]
  v_pk_fma_f32 v[20:21], v[106:107], v[24:25], v[20:21]
  v_add_f32 v18, v18, v19
  v_add_f32 v20, v20, v21
  s_cmpk_gt_i32 s69, 0x1f
  s_cbranch_scc1 L_p26_4
  s_cmp_gt_i32 s69, L_order_end-L_order-16421
  s_cbranch_scc1 L_p26_1
  s_waitcnt vmcnt(6)
L_p26_1:
  s_waitcnt vmcnt(10)
L_p26_4:
  s_waitcnt vmcnt(11)
  buffer_load_dwordx4 v[88:91], v222, s[32:35], 0 offen nt
  ds_read_b64 v[160:161], v12 offset:12288
  ds_read_b64 v[162:163], v12 offset:12416
  ds_read_b64 v[164:165], v12 offset:13312
  ds_read_b64 v[166:167], v12 offset:13440
  v_dot2_f32_bf16 v22, v153, v60, 0
  v_add_f32_dpp v241, v18, v18 row_ror:8 row_mask:0xf bank_mask:0xc
  v_add_f32_dpp v241, v20, v20 row_ror:8 row_mask:0xf bank_mask:0x3
  v_dot2_f32_bf16 v23, v158, v61, 0
  v_dot2_f32_bf16 v24, v156, v62, 0
  v_dot2_f32_bf16 v25, v159, v63, 0
  v_cvt_f32_i32 v108, v108
  v_cvt_f32_i32 v109, v109
  v_cvt_f32_i32 v110, v110
  v_cvt_f32_i32 v111, v111
  v_pk_mul_f32 v[20:21], v[108:109], v[22:23]
  v_pk_add_f32 v[18:19], v[22:23], v[24:25]
  v_pk_fma_f32 v[20:21], v[110:111], v[24:25], v[20:21]
  v_add_f32 v18, v18, v19
  v_add_f32 v20, v20, v21
  s_cmpk_gt_i32 s69, 0x1f
  s_cbranch_scc1 L_p27_4
  s_cmp_gt_i32 s69, L_order_end-L_order-16391
  s_cbranch_scc1 L_p27_2
  s_waitcnt vmcnt(7)
L_p27_2:
  s_waitcnt vmcnt(11)
L_p27_4:
  s_waitcnt vmcnt(12)
  buffer_load_dwordx4 v[92:95], v223, s[32:35], 0 offen nt
  s_cmpk_gt_i32 s69, 0x1f
  s_cbranch_scc1 L_p28_4
  s_cmpk_gt_i32 s69, 0xb
  s_cbranch_scc1 L_p28_3
  s_cmpk_gt_i32 s69, 0xffbb
  s_cbranch_scc1 L_p28_0
  s_waitcnt vmcnt(7)
L_p28_0:
  s_waitcnt vmcnt(8)
L_p28_3:
  s_waitcnt vmcnt(12)
L_p28_4:
  s_waitcnt vmcnt(13)
  buffer_load_dwordx4 v[96:99], v222, s[32:35], s80 offen nt
L_it12:
  s_waitcnt lgkmcnt(0)
  ds_read_b128 v[52:55], v252 offset:1536
  ds_read_b128 v[56:59], v253 offset:2560
  ds_read_b128 v[60:63], v252 offset:2560
  s_waitcnt vmcnt(9)
  s_mov_b64 exec, 3
  s_add_u32 s44, s78, 0x03030303
  v_msad_u8 v9, s78, v32, 0
  v_msad_u8 v10, s44, v32, 0
  v_msad_u8 v9, s78, v33, v9
  v_msad_u8 v10, s44, v33, v10
  v_msad_u8 v9, s78, v34, v9
  v_msad_u8 v10, s44, v34, v10
  global_store_byte v7, v8, s[30:31]
  global_load_dwordx3 v[32:34], v232, s[30:31] sc1
  v_sub_u32 v9, v9, v10
  v_add_u32_e64 v8, 1, v8
  v_readlane_b32 s66, v9, 0
  v_readlane_b32 s67, v9, 1
  s_add_u32 s78, s78, 0x01010101
  s_mov_b64 exec, -1
  s_lshl1_add_u32 s69, s91, s95
  s_add_u32 s95, s66, s67
  s_add_u32 s69, s69, s95
  v_perm_b32 v157, v162, v160, s56
  v_perm_b32 v162, v162, v160, s57
  v_perm_b32 v160, v163, v161, s56
  v_perm_b32 v163, v163, v161, s57
  v_dot2_f32_bf16 v22, v157, v40, 0
  v_add_f32_dpp v21, v18, v18 row_ror:8 row_mask:0xf bank_mask:0xc
  v_add_f32_dpp v21, v20, v20 row_ror:8 row_mask:0xf bank_mask:0x3
  v_add_f32_dpp v20, v241, v241 row_half_mirror row_mask:0xf bank_mask:0x5
  v_dot2_f32_bf16 v23, v162, v41, 0
  v_add_f32_dpp v20, v21, v21 row_half_mirror row_mask:0xf bank_mask:0xa
  v_dot2_f32_bf16 v24, v160, v42, 0
  v_dot2_f32_bf16 v25, v163, v43, 0
  v_add_f32_dpp v20, v20, v20 quad_perm:[2,3,0,1] row_mask:0xf bank_mask:0xf
  v_cvt_f32_i32 v64, v64
  v_cvt_f32_i32 v65, v65
  v_add_f32_dpp v20, v20, v20 quad_perm:[1,0,3,2] row_mask:0xf bank_mask:0xf
  v_cndmask_b32_e64 v238, v238, v20, s[50:51]
  v_cvt_f32_i32 v66, v66
  v_cvt_f32_i32 v67, v67
  v_pk_mul_f32 v[20:21], v[64:65], v[22:23]
  v_pk_add_f32 v[18:19], v[22:23], v[24:25]
  v_pk_fma_f32 v[20:21], v[66:67], v[24:25], v[20:21]
  v_add_f32 v18, v18, v19
  v_add_f32 v20, v20, v21
  s_add_u32 m0, s100, 17408
  v_lshrrev_b32 v10, 1, v225
  v_add_u32 v10, v10, v243
  v_mad_u64_u32 v[30:31], s[64:65], v10, 1, v[28:29]
  global_load_lds_dwordx4 v[30:31], off
  v_perm_b32 v161, v166, v164, s56
  v_perm_b32 v166, v166, v164, s57
  v_perm_b32 v164, v167, v165, s56
  v_perm_b32 v167, v167, v165, s57
  v_dot2_f32_bf16 v22, v161, v44, 0
  v_add_f32_dpp v239, v18, v18 row_ror:8 row_mask:0xf bank_mask:0xc
  v_add_f32_dpp v239, v20, v20 row_ror:8 row_mask:0xf bank_mask:0x3
  v_dot2_f32_bf16 v23, v166, v45, 0
  v_dot2_f32_bf16 v24, v164, v46, 0
  v_dot2_f32_bf16 v25, v167, v47, 0
  v_cvt_f32_i32 v68, v68
  v_cvt_f32_i32 v69, v69
  v_cvt_f32_i32 v70, v70
  v_cvt_f32_i32 v71, v71
  v_pk_mul_f32 v[20:21], v[68:69], v[22:23]
  v_pk_add_f32 v[18:19], v[22:23], v[24:25]
  v_pk_fma_f32 v[20:21], v[70:71], v[24:25], v[20:21]
  v_add_f32 v18, v18, v19
  v_add_f32 v20, v20, v21
  s_cmpk_gt_i32 s69, 0x1f
  s_cbranch_scc1 L_p29_4
  s_cmp_gt_i32 s69, L_order_end-L_order-16421
  s_cbranch_scc1 L_p29_1
  s_waitcnt vmcnt(6)
L_p29_1:
  s_waitcnt vmcnt(10)
L_p29_4:
  s_waitcnt vmcnt(11)
  buffer_load_dwordx4 v[100:103], v223, s[32:35], s80 offen nt
  v_dot2_f32_bf16 v22, v157, v48, 0
  v_add_f32_dpp v21, v18, v18 row_ror:8 row_mask:0xf bank_mask:0xc
  v_add_f32_dpp v21, v20, v20 row_ror:8 row_mask:0xf bank_mask:0x3
  v_add_f32_dpp v20, v239, v239 row_half_mirror row_mask:0xf bank_mask:0x5
  v_dot2_f32_bf16 v23, v162, v49, 0
  v_add_f32_dpp v20, v21, v21 row_half_mirror row_mask:0xf bank_mask:0xa
  v_dot2_f32_bf16 v24, v160, v50, 0
  v_dot2_f32_bf16 v25, v163, v51, 0
  v_add_f32_dpp v20, v20, v20 quad_perm:[2,3,0,1] row_mask:0xf bank_mask:0xf
  v_cvt_f32_i32 v72, v72
  v_cvt_f32_i32 v73, v73
  v_add_f32_dpp v20, v20, v20 quad_perm:[1,0,3,2] row_mask:0xf bank_mask:0xf
  v_cndmask_b32_e64 v236, v236, v20, s[52:53]
  v_cvt_f32_i32 v74, v74
  v_cvt_f32_i32 v75, v75
  v_pk_mul_f32 v[20:21], v[72:73], v[22:23]
  v_pk_add_f32 v[18:19], v[22:23], v[24:25]
  v_pk_fma_f32 v[20:21], v[74:75], v[24:25], v[20:21]
  v_add_f32 v18, v18, v19
  v_add_f32 v20, v20, v21
  s_cmpk_gt_i32 s69, 0x1f
  s_cbranch_scc1 L_p30_4
  s_cmp_gt_i32 s69, L_order_end-L_order-16391
  s_cbranch_scc1 L_p30_2
  s_waitcnt vmcnt(7)
L_p30_2:
  s_waitcnt vmcnt(11)
L_p30_4:
  s_waitcnt vmcnt(12)
  buffer_load_dwordx4 v[104:107], v222, s[32:35], s3 offen nt
  s_cmpk_gt_i32 s69, 0x1f
  s_cbranch_scc1 L_p31_4
  s_cmpk_gt_i32 s69, 0xb
  s_cbranch_scc1 L_p31_3
  s_cmpk_gt_i32 s69, 0xffbb
  s_cbranch_scc1 L_p31_0
  s_waitcnt vmcnt(7)
L_p31_0:
  s_waitcnt vmcnt(8)
L_p31_3:
  s_waitcnt vmcnt(12)
L_p31_4:
  s_waitcnt vmcnt(13)
  buffer_load_dwordx4 v[108:111], v223, s[32:35], s3 offen nt
L_it13:
  s_waitcnt lgkmcnt(0)
  ds_read_b128 v[40:43], v251 offset:512
  ds_read_b128 v[44:47], v253 offset:512
  ds_read_b128 v[48:51], v251 offset:1536
  s_waitcnt vmcnt(9)
  s_mov_b64 exec, 3
  s_add_u32 s44, s78, 0x03030303
  v_msad_u8 v9, s78, v36, 0
  v_msad_u8 v10, s44, v36, 0
  v_msad_u8 v9, s78, v37, v9
  v_msad_u8 v10, s44, v37, v10
  v_msad_u8 v9, s78, v38, v9
  v_msad_u8 v10, s44, v38, v10
  global_load_dwordx2 v[26:27], v11, s[30:31] sc1
  global_store_byte v7, v8, s[30:31]
  global_load_dwordx3 v[36:38], v233, s[30:31] sc1
  v_sub_u32 v9, v9, v10
  v_add_u32_e64 v8, 1, v8
  v_readlane_b32 s66, v9, 0
  v_readlane_b32 s67, v9, 1
  s_add_u32 s78, s78, 0x01010101
  s_mov_b64 exec, -1
  s_lshl1_add_u32 s69, s91, s95
  s_add_u32 s95, s66, s67
  s_add_u32 s69, s69, s95
  v_dot2_f32_bf16 v22, v161, v52, 0
  v_add_f32_dpp v240, v18, v18 row_ror:8 row_mask:0xf bank_mask:0xc
  v_add_f32_dpp v240, v20, v20 row_ror:8 row_mask:0xf bank_mask:0x3
  v_dot2_f32_bf16 v23, v166, v53, 0
  v_dot2_f32_bf16 v24, v164, v54, 0
  v_dot2_f32_bf16 v25, v167, v55, 0
  v_cvt_f32_i32 v76, v76
  v_cvt_f32_i32 v77, v77
  v_cvt_f32_i32 v78, v78
  v_cvt_f32_i32 v79, v79
  v_pk_mul_f32 v[20:21], v[76:77], v[22:23]
  v_pk_add_f32 v[18:19], v[22:23], v[24:25]
  v_pk_fma_f32 v[20:21], v[78:79], v[24:25], v[20:21]
  v_add_f32 v18, v18, v19
  v_add_f32 v20, v20, v21
  s_add_u32 m0, s100, 18432
  v_lshrrev_b32 v10, 1, v226
  v_add_u32 v10, v10, v242
  v_mad_u64_u32 v[30:31], s[64:65], v10, 1, v[28:29]
  global_load_lds_dwordx4 v[30:31], off
  v_dot2_f32_bf16 v22, v157, v56, 0
  v_add_f32_dpp v21, v18, v18 row_ror:8 row_mask:0xf bank_mask:0xc
  v_add_f32_dpp v21, v20, v20 row_ror:8 row_mask:0xf bank_mask:0x3
  v_add_f32_dpp v20, v240, v240 row_half_mirror row_mask:0xf bank_mask:0x5
  v_dot2_f32_bf16 v23, v162, v57, 0
  v_add_f32_dpp v20, v21, v21 row_half_mirror row_mask:0xf bank_mask:0xa
  v_dot2_f32_bf16 v24, v160, v58, 0
  v_dot2_f32_bf16 v25, v163, v59, 0
  v_add_f32_dpp v20, v20, v20 quad_perm:[2,3,0,1] row_mask:0xf bank_mask:0xf
  v_cvt_f32_i32 v80, v80
  v_cvt_f32_i32 v81, v81
  v_add_f32_dpp v20, v20, v20 quad_perm:[1,0,3,2] row_mask:0xf bank_mask:0xf
  v_cndmask_b32_e64 v237, v237, v20, s[52:53]
  v_cvt_f32_i32 v82, v82
  v_cvt_f32_i32 v83, v83
  v_pk_mul_f32 v[20:21], v[80:81], v[22:23]
  v_pk_add_f32 v[18:19], v[22:23], v[24:25]
  v_pk_fma_f32 v[20:21], v[82:83], v[24:25], v[20:21]
  v_add_f32 v18, v18, v19
  v_add_f32 v20, v20, v21
  s_cmpk_gt_i32 s69, 0x1f
  s_cbranch_scc1 L_p32_4
  s_cmp_gt_i32 s69, L_order_end-L_order-16421
  s_cbranch_scc1 L_p32_1
  s_waitcnt vmcnt(7)
L_p32_1:
  s_waitcnt vmcnt(11)
L_p32_4:
  s_waitcnt vmcnt(12)
  buffer_load_dwordx4 v[64:67], v224, s[32:35], 0 offen nt
  ds_read_b64 v[168:169], v12 offset:14336
  ds_read_b64 v[170:171], v12 offset:14464
  ds_read_b64 v[172:173], v12 offset:15360
  ds_read_b64 v[174:175], v12 offset:15488
  v_dot2_f32_bf16 v22, v161, v60, 0
  v_add_f32_dpp v241, v18, v18 row_ror:8 row_mask:0xf bank_mask:0xc
  v_add_f32_dpp v241, v20, v20 row_ror:8 row_mask:0xf bank_mask:0x3
  v_dot2_f32_bf16 v23, v166, v61, 0
  v_dot2_f32_bf16 v24, v164, v62, 0
  v_dot2_f32_bf16 v25, v167, v63, 0
  v_cvt_f32_i32 v84, v84
  v_cvt_f32_i32 v85, v85
  v_cvt_f32_i32 v86, v86
  v_cvt_f32_i32 v87, v87
  v_pk_mul_f32 v[20:21], v[84:85], v[22:23]
  v_pk_add_f32 v[18:19], v[22:23], v[24:25]
  v_pk_fma_f32 v[20:21], v[86:87], v[24:25], v[20:21]
  v_add_f32 v18, v18, v19
  v_add_f32 v20, v20, v21
  s_cmpk_gt_i32 s69, 0x1f
  s_cbranch_scc1 L_p33_4
  s_cmp_gt_i32 s69, L_order_end-L_order-16391
  s_cbranch_scc1 L_p33_2
  s_waitcnt vmcnt(8)
L_p33_2:
  s_waitcnt vmcnt(12)
L_p33_4:
  s_waitcnt vmcnt(13)
  buffer_load_dwordx4 v[68:71], v225, s[32:35], 0 offen nt
  s_cmpk_gt_i32 s69, 0x1f
  s_cbranch_scc1 L_p34_4
  s_cmpk_gt_i32 s69, 0xb
  s_cbranch_scc1 L_p34_3
  s_cmpk_gt_i32 s69, 0xffbb
  s_cbranch_scc1 L_p34_0
  s_waitcnt vmcnt(8)
L_p34_0:
  s_waitcnt vmcnt(9)
L_p34_3:
  s_waitcnt vmcnt(13)
L_p34_4:
  s_waitcnt vmcnt(14)
  buffer_load_dwordx4 v[72:75], v224, s[32:35], s80 offen nt
L_it14:
  s_waitcnt lgkmcnt(0)
  ds_read_b128 v[52:55], v253 offset:1536
  ds_read_b128 v[56:59], v251 offset:2560
  ds_read_b128 v[60:63], v253 offset:2560
  s_waitcnt vmcnt(10)
  s_mov_b64 exec, 3
  s_add_u32 s44, s78, 0x03030303
  v_msad_u8 v9, s78, v32, 0
  v_msad_u8 v10, s44, v32, 0
  v_msad_u8 v9, s78, v33, v9
  v_msad_u8 v10, s44, v33, v10
  v_msad_u8 v9, s78, v34, v9
  v_msad_u8 v10, s44, v34, v10
  global_store_byte v7, v8, s[30:31]
  global_load_dwordx3 v[32:34], v234, s[30:31] sc1
  v_sub_u32 v9, v9, v10
  v_add_u32_e64 v8, 1, v8
  v_readlane_b32 s66, v9, 0
  v_readlane_b32 s67, v9, 1
  s_add_u32 s78, s78, 0x01010101
  s_mov_b64 exec, -1
  s_lshl1_add_u32 s69, s91, s95
  s_add_u32 s95, s66, s67
  s_add_u32 s69, s69, s95
  v_perm_b32 v165, v170, v168, s56
  v_perm_b32 v170, v170, v168, s57
  v_perm_b32 v168, v171, v169, s56
  v_perm_b32 v171, v171, v169, s57
  v_dot2_f32_bf16 v22, v165, v40, 0
  v_add_f32_dpp v21, v18, v18 row_ror:8 row_mask:0xf bank_mask:0xc
  v_add_f32_dpp v21, v20, v20 row_ror:8 row_mask:0xf bank_mask:0x3
  v_add_f32_dpp v20, v241, v241 row_half_mirror row_mask:0xf bank_mask:0x5
  v_dot2_f32_bf16 v23, v170, v41, 0
  v_add_f32_dpp v20, v21, v21 row_half_mirror row_mask:0xf bank_mask:0xa
  v_dot2_f32_bf16 v24, v168, v42, 0
  v_dot2_f32_bf16 v25, v171, v43, 0
  v_add_f32_dpp v20, v20, v20 quad_perm:[2,3,0,1] row_mask:0xf bank_mask:0xf
  v_cvt_f32_i32 v88, v88
  v_cvt_f32_i32 v89, v89
  v_add_f32_dpp v20, v20, v20 quad_perm:[1,0,3,2] row_mask:0xf bank_mask:0xf
  v_cndmask_b32_e64 v238, v238, v20, s[52:53]
  v_cvt_f32_i32 v90, v90
  v_cvt_f32_i32 v91, v91
  v_pk_mul_f32 v[20:21], v[88:89], v[22:23]
  v_pk_add_f32 v[18:19], v[22:23], v[24:25]
  v_pk_fma_f32 v[20:21], v[90:91], v[24:25], v[20:21]
  v_add_f32 v18, v18, v19
  v_add_f32 v20, v20, v21
  s_add_u32 m0, s100, 19456
  v_lshrrev_b32 v10, 1, v227
  v_add_u32 v10, v10, v244
  v_mad_u64_u32 v[30:31], s[64:65], v10, 1, v[28:29]
  global_load_lds_dwordx4 v[30:31], off
  v_perm_b32 v169, v174, v172, s56
  v_perm_b32 v174, v174, v172, s57
  v_perm_b32 v172, v175, v173, s56
  v_perm_b32 v175, v175, v173, s57
  v_dot2_f32_bf16 v22, v169, v44, 0
  v_add_f32_dpp v239, v18, v18 row_ror:8 row_mask:0xf bank_mask:0xc
  v_add_f32_dpp v239, v20, v20 row_ror:8 row_mask:0xf bank_mask:0x3
  v_dot2_f32_bf16 v23, v174, v45, 0
  v_dot2_f32_bf16 v24, v172, v46, 0
  v_dot2_f32_bf16 v25, v175, v47, 0
  v_cvt_f32_i32 v92, v92
  v_cvt_f32_i32 v93, v93
  v_cvt_f32_i32 v94, v94
  v_cvt_f32_i32 v95, v95
  v_pk_mul_f32 v[20:21], v[92:93], v[22:23]
  v_pk_add_f32 v[18:19], v[22:23], v[24:25]
  v_pk_fma_f32 v[20:21], v[94:95], v[24:25], v[20:21]
  v_add_f32 v18, v18, v19
  v_add_f32 v20, v20, v21
  s_cmpk_gt_i32 s69, 0x1f
  s_cbranch_scc1 L_p35_4
  s_cmp_gt_i32 s69, L_order_end-L_order-16421
  s_cbranch_scc1 L_p35_1
  s_waitcnt vmcnt(6)
L_p35_1:
  s_waitcnt vmcnt(11)
L_p35_4:
  s_waitcnt vmcnt(12)
  buffer_load_dwordx4 v[76:79], v225, s[32:35], s80 offen nt
  v_dot2_f32_bf16 v22, v165, v48, 0
  v_add_f32_dpp v21, v18, v18 row_ror:8 row_mask:0xf bank_mask:0xc
  v_add_f32_dpp v21, v20, v20 row_ror:8 row_mask:0xf bank_mask:0x3
  v_add_f32_dpp v20, v239, v239 row_half_mirror row_mask:0xf bank_mask:0x5
  v_dot2_f32_bf16 v23, v170, v49, 0
  v_add_f32_dpp v20, v21, v21 row_half_mirror row_mask:0xf bank_mask:0xa
  v_dot2_f32_bf16 v24, v168, v50, 0
  v_dot2_f32_bf16 v25, v171, v51, 0
  v_add_f32_dpp v20, v20, v20 quad_perm:[2,3,0,1] row_mask:0xf bank_mask:0xf
  v_cvt_f32_i32 v96, v96
  v_cvt_f32_i32 v97, v97
  v_add_f32_dpp v20, v20, v20 quad_perm:[1,0,3,2] row_mask:0xf bank_mask:0xf
  v_cndmask_b32_e64 v236, v236, v20, s[54:55]
  ds_write_b32 v16, v236 offset:0
  v_cvt_f32_i32 v98, v98
  v_cvt_f32_i32 v99, v99
  v_pk_mul_f32 v[20:21], v[96:97], v[22:23]
  v_pk_add_f32 v[18:19], v[22:23], v[24:25]
  v_pk_fma_f32 v[20:21], v[98:99], v[24:25], v[20:21]
  v_add_f32 v18, v18, v19
  v_add_f32 v20, v20, v21
  s_cmpk_gt_i32 s69, 0x1f
  s_cbranch_scc1 L_p36_4
  s_cmp_gt_i32 s69, L_order_end-L_order-16391
  s_cbranch_scc1 L_p36_2
  s_waitcnt vmcnt(7)
L_p36_2:
  s_waitcnt vmcnt(12)
L_p36_4:
  s_waitcnt vmcnt(13)
  buffer_load_dwordx4 v[80:83], v224, s[32:35], s3 offen nt
  s_cmpk_gt_i32 s69, 0x1f
  s_cbranch_scc1 L_p37_4
  s_cmpk_gt_i32 s69, 0xb
  s_cbranch_scc1 L_p37_3
  s_cmpk_gt_i32 s69, 0xffbb
  s_cbranch_scc1 L_p37_0
  s_waitcnt vmcnt(7)
L_p37_0:
  s_waitcnt vmcnt(8)
L_p37_3:
  s_waitcnt vmcnt(13)
L_p37_4:
  s_waitcnt vmcnt(14)
  buffer_load_dwordx4 v[84:87], v225, s[32:35], s3 offen nt
L_it15:
  s_waitcnt lgkmcnt(0)
  ds_read_b128 v[40:43], v250 offset:512
  ds_read_b128 v[44:47], v249 offset:512
  ds_read_b128 v[48:51], v250 offset:1536
  s_waitcnt vmcnt(9)
  s_mov_b64 exec, 3
  s_add_u32 s44, s78, 0x03030303
  v_msad_u8 v9, s78, v36, 0
  v_msad_u8 v10, s44, v36, 0
  v_msad_u8 v9, s78, v37, v9
  v_msad_u8 v10, s44, v37, v10
  v_msad_u8 v9, s78, v38, v9
  v_msad_u8 v10, s44, v38, v10
  global_store_byte v7, v8, s[30:31]
  global_load_dwordx3 v[36:38], v235, s[30:31] sc1
  v_sub_u32 v9, v9, v10
  v_add_u32_e64 v8, 1, v8
  v_add3_u32 v10, v26, v27, s58
  v_readlane_b32 s66, v9, 0
  v_readlane_b32 s67, v9, 1
  v_readlane_b32 s91, v10, 0
  s_add_u32 s78, s78, 0x01010101
  s_mov_b64 exec, -1
  s_lshl1_add_u32 s69, s91, s95
  s_add_u32 s95, s66, s67
  s_add_u32 s69, s69, s95
  v_dot2_f32_bf16 v22, v169, v52, 0
  v_add_f32_dpp v240, v18, v18 row_ror:8 row_mask:0xf bank_mask:0xc
  v_add_f32_dpp v240, v20, v20 row_ror:8 row_mask:0xf bank_mask:0x3
  v_dot2_f32_bf16 v23, v174, v53, 0
  v_dot2_f32_bf16 v24, v172, v54, 0
  v_dot2_f32_bf16 v25, v175, v55, 0
  v_cvt_f32_i32 v100, v100
  v_cvt_f32_i32 v101, v101
  v_cvt_f32_i32 v102, v102
  v_cvt_f32_i32 v103, v103
  v_pk_mul_f32 v[20:21], v[100:101], v[22:23]
  v_pk_add_f32 v[18:19], v[22:23], v[24:25]
  v_pk_fma_f32 v[20:21], v[102:103], v[24:25], v[20:21]
  v_add_f32 v18, v18, v19
  v_add_f32 v20, v20, v21
  s_add_u32 m0, s100, 20480
  v_lshrrev_b32 v10, 1, v228
  v_add_u32 v10, v10, v245
  v_mad_u64_u32 v[30:31], s[64:65], v10, 1, v[28:29]
  global_load_lds_dwordx4 v[30:31], off
  v_dot2_f32_bf16 v22, v165, v56, 0
  v_add_f32_dpp v21, v18, v18 row_ror:8 row_mask:0xf bank_mask:0xc
  v_add_f32_dpp v21, v20, v20 row_ror:8 row_mask:0xf bank_mask:0x3
  v_add_f32_dpp v20, v240, v240 row_half_mirror row_mask:0xf bank_mask:0x5
  v_dot2_f32_bf16 v23, v170, v57, 0
  v_add_f32_dpp v20, v21, v21 row_half_mirror row_mask:0xf bank_mask:0xa
  v_dot2_f32_bf16 v24, v168, v58, 0
  v_dot2_f32_bf16 v25, v171, v59, 0
  v_add_f32_dpp v20, v20, v20 quad_perm:[2,3,0,1] row_mask:0xf bank_mask:0xf
  v_cvt_f32_i32 v104, v104
  v_cvt_f32_i32 v105, v105
  v_add_f32_dpp v20, v20, v20 quad_perm:[1,0,3,2] row_mask:0xf bank_mask:0xf
  v_cndmask_b32_e64 v237, v237, v20, s[54:55]
  ds_write_b32 v16, v237 offset:3072
  v_cvt_f32_i32 v106, v106
  v_cvt_f32_i32 v107, v107
  v_pk_mul_f32 v[20:21], v[104:105], v[22:23]
  v_pk_add_f32 v[18:19], v[22:23], v[24:25]
  v_pk_fma_f32 v[20:21], v[106:107], v[24:25], v[20:21]
  v_add_f32 v18, v18, v19
  v_add_f32 v20, v20, v21
  s_cmpk_gt_i32 s69, 0x1f
  s_cbranch_scc1 L_p38_4
  s_cmp_gt_i32 s69, L_order_end-L_order-16421
  s_cbranch_scc1 L_p38_1
  s_waitcnt vmcnt(6)
L_p38_1:
  s_waitcnt vmcnt(10)
L_p38_4:
  s_waitcnt vmcnt(11)
  buffer_load_dwordx4 v[88:91], v226, s[32:35], 0 offen nt
  ds_read_b64 v[176:177], v12 offset:16384
  ds_read_b64 v[178:179], v12 offset:16512
  ds_read_b64 v[180:181], v12 offset:17408
  ds_read_b64 v[182:183], v12 offset:17536
  v_dot2_f32_bf16 v22, v169, v60, 0
  v_add_f32_dpp v241, v18, v18 row_ror:8 row_mask:0xf bank_mask:0xc
  v_add_f32_dpp v241, v20, v20 row_ror:8 row_mask:0xf bank_mask:0x3
  v_dot2_f32_bf16 v23, v174, v61, 0
  v_dot2_f32_bf16 v24, v172, v62, 0
  v_dot2_f32_bf16 v25, v175, v63, 0
  v_cvt_f32_i32 v108, v108
  v_cvt_f32_i32 v109, v109
  v_cvt_f32_i32 v110, v110
  v_cvt_f32_i32 v111, v111
  v_pk_mul_f32 v[20:21], v[108:109], v[22:23]
  v_pk_add_f32 v[18:19], v[22:23], v[24:25]
  v_pk_fma_f32 v[20:21], v[110:111], v[24:25], v[20:21]
  v_add_f32 v18, v18, v19
  v_add_f32 v20, v20, v21
  s_cmpk_gt_i32 s69, 0x1f
  s_cbranch_scc1 L_p39_4
  s_cmp_gt_i32 s69, L_order_end-L_order-16391
  s_cbranch_scc1 L_p39_2
  s_waitcnt vmcnt(7)
L_p39_2:
  s_waitcnt vmcnt(11)
L_p39_4:
  s_waitcnt vmcnt(12)
  buffer_load_dwordx4 v[92:95], v227, s[32:35], 0 offen nt
  s_cmpk_gt_i32 s69, 0x1f
  s_cbranch_scc1 L_p40_4
  s_cmpk_gt_i32 s69, 0xb
  s_cbranch_scc1 L_p40_3
  s_cmpk_gt_i32 s69, 0xffbb
  s_cbranch_scc1 L_p40_0
  s_waitcnt vmcnt(7)
L_p40_0:
  s_waitcnt vmcnt(8)
L_p40_3:
  s_waitcnt vmcnt(12)
L_p40_4:
  s_waitcnt vmcnt(13)
  buffer_load_dwordx4 v[96:99], v226, s[32:35], s80 offen nt
  v_mov_b32_e64 v9, 2
  ds_write_b32 v6, v9 offset:0
L_it16:
  s_waitcnt lgkmcnt(0)
  ds_read_b128 v[52:55], v249 offset:1536
  ds_read_b128 v[56:59], v250 offset:2560
  ds_read_b128 v[60:63], v249 offset:2560
  s_waitcnt vmcnt(9)
  s_mov_b64 exec, 3
  s_add_u32 s44, s78, 0x03030303
  v_msad_u8 v9, s78, v32, 0
  v_msad_u8 v10, s44, v32, 0
  v_msad_u8 v9, s78, v33, v9
  v_msad_u8 v10, s44, v33, v10
  v_msad_u8 v9, s78, v34, v9
  v_msad_u8 v10, s44, v34, v10
  global_store_byte v7, v8, s[30:31]
  global_load_dwordx3 v[32:34], v232, s[30:31] sc1
  v_sub_u32 v9, v9, v10
  v_add_u32_e64 v8, 1, v8
  v_readlane_b32 s66, v9, 0
  v_readlane_b32 s67, v9, 1
  s_add_u32 s78, s78, 0x01010101
  s_mov_b64 exec, -1
  s_lshl1_add_u32 s69, s91, s95
  s_add_u32 s95, s66, s67
  s_add_u32 s69, s69, s95
  v_perm_b32 v173, v178, v176, s56
  v_perm_b32 v178, v178, v176, s57
  v_perm_b32 v176, v179, v177, s56
  v_perm_b32 v179, v179, v177, s57
  v_dot2_f32_bf16 v22, v173, v40, 0
  v_add_f32_dpp v21, v18, v18 row_ror:8 row_mask:0xf bank_mask:0xc
  v_add_f32_dpp v21, v20, v20 row_ror:8 row_mask:0xf bank_mask:0x3
  v_add_f32_dpp v20, v241, v241 row_half_mirror row_mask:0xf bank_mask:0x5
  v_dot2_f32_bf16 v23, v178, v41, 0
  v_add_f32_dpp v20, v21, v21 row_half_mirror row_mask:0xf bank_mask:0xa
  v_dot2_f32_bf16 v24, v176, v42, 0
  v_dot2_f32_bf16 v25, v179, v43, 0
  v_add_f32_dpp v20, v20, v20 quad_perm:[2,3,0,1] row_mask:0xf bank_mask:0xf
  v_cvt_f32_i32 v64, v64
  v_cvt_f32_i32 v65, v65
  v_add_f32_dpp v20, v20, v20 quad_perm:[1,0,3,2] row_mask:0xf bank_mask:0xf
  v_cndmask_b32_e64 v238, v238, v20, s[54:55]
  ds_write_b32 v16, v238 offset:6144
  v_cvt_f32_i32 v66, v66
  v_cvt_f32_i32 v67, v67
  v_pk_mul_f32 v[20:21], v[64:65], v[22:23]
  v_pk_add_f32 v[18:19], v[22:23], v[24:25]
  v_pk_fma_f32 v[20:21], v[66:67], v[24:25], v[20:21]
  v_add_f32 v18, v18, v19
  v_add_f32 v20, v20, v21
  s_add_u32 m0, s100, 21504
  v_lshrrev_b32 v10, 1, v229
  v_add_u32 v10, v10, v247
  v_mad_u64_u32 v[30:31], s[64:65], v10, 1, v[28:29]
  global_load_lds_dwordx4 v[30:31], off
  v_perm_b32 v177, v182, v180, s56
  v_perm_b32 v182, v182, v180, s57
  v_perm_b32 v180, v183, v181, s56
  v_perm_b32 v183, v183, v181, s57
  v_dot2_f32_bf16 v22, v177, v44, 0
  v_add_f32_dpp v239, v18, v18 row_ror:8 row_mask:0xf bank_mask:0xc
  v_add_f32_dpp v239, v20, v20 row_ror:8 row_mask:0xf bank_mask:0x3
  v_dot2_f32_bf16 v23, v182, v45, 0
  v_dot2_f32_bf16 v24, v180, v46, 0
  v_dot2_f32_bf16 v25, v183, v47, 0
  v_cvt_f32_i32 v68, v68
  v_cvt_f32_i32 v69, v69
  v_cvt_f32_i32 v70, v70
  v_cvt_f32_i32 v71, v71
  v_pk_mul_f32 v[20:21], v[68:69], v[22:23]
  v_pk_add_f32 v[18:19], v[22:23], v[24:25]
  v_pk_fma_f32 v[20:21], v[70:71], v[24:25], v[20:21]
  v_add_f32 v18, v18, v19
  v_add_f32 v20, v20, v21
  s_cmpk_gt_i32 s69, 0x1f
  s_cbranch_scc1 L_p41_4
  s_cmp_gt_i32 s69, L_order_end-L_order-16421
  s_cbranch_scc1 L_p41_1
  s_waitcnt vmcnt(6)
L_p41_1:
  s_waitcnt vmcnt(10)
L_p41_4:
  s_waitcnt vmcnt(11)
  buffer_load_dwordx4 v[100:103], v227, s[32:35], s80 offen nt
  v_dot2_f32_bf16 v22, v173, v48, 0
  v_add_f32_dpp v21, v18, v18 row_ror:8 row_mask:0xf bank_mask:0xc
  v_add_f32_dpp v21, v20, v20 row_ror:8 row_mask:0xf bank_mask:0x3
  v_add_f32_dpp v20, v239, v239 row_half_mirror row_mask:0xf bank_mask:0x5
  v_dot2_f32_bf16 v23, v178, v49, 0
  v_add_f32_dpp v20, v21, v21 row_half_mirror row_mask:0xf bank_mask:0xa
  v_dot2_f32_bf16 v24, v176, v50, 0
  v_dot2_f32_bf16 v25, v179, v51, 0
  v_add_f32_dpp v20, v20, v20 quad_perm:[2,3,0,1] row_mask:0xf bank_mask:0xf
  v_cvt_f32_i32 v72, v72
  v_cvt_f32_i32 v73, v73
  v_add_f32_dpp v20, v20, v20 quad_perm:[1,0,3,2] row_mask:0xf bank_mask:0xf
  v_cndmask_b32_e64 v236, v236, v20, s[48:49]
  v_cvt_f32_i32 v74, v74
  v_cvt_f32_i32 v75, v75
  v_pk_mul_f32 v[20:21], v[72:73], v[22:23]
  v_pk_add_f32 v[18:19], v[22:23], v[24:25]
  v_pk_fma_f32 v[20:21], v[74:75], v[24:25], v[20:21]
  v_add_f32 v18, v18, v19
  v_add_f32 v20, v20, v21
  s_cmpk_gt_i32 s69, 0x1f
  s_cbranch_scc1 L_p42_4
  s_cmp_gt_i32 s69, L_order_end-L_order-16391
  s_cbranch_scc1 L_p42_2
  s_waitcnt vmcnt(7)
L_p42_2:
  s_waitcnt vmcnt(11)
L_p42_4:
  s_waitcnt vmcnt(12)
  buffer_load_dwordx4 v[104:107], v226, s[32:35], s3 offen nt
  s_cmpk_gt_i32 s69, 0x1f
  s_cbranch_scc1 L_p43_4
  s_cmpk_gt_i32 s69, 0xb
  s_cbranch_scc1 L_p43_3
  s_cmpk_gt_i32 s69, 0xffbb
  s_cbranch_scc1 L_p43_0
  s_waitcnt vmcnt(7)
L_p43_0:
  s_waitcnt vmcnt(8)
L_p43_3:
  s_waitcnt vmcnt(12)
L_p43_4:
  s_waitcnt vmcnt(13)
  buffer_load_dwordx4 v[108:111], v227, s[32:35], s3 offen nt
L_it17:
  s_waitcnt lgkmcnt(0)
  ds_read_b128 v[40:43], v248 offset:512
  ds_read_b128 v[44:47], v250 offset:512
  ds_read_b128 v[48:51], v248 offset:1536
  s_waitcnt vmcnt(9)
  s_mov_b64 exec, 3
  s_add_u32 s44, s78, 0x03030303
  v_msad_u8 v9, s78, v36, 0
  v_msad_u8 v10, s44, v36, 0
  v_msad_u8 v9, s78, v37, v9
  v_msad_u8 v10, s44, v37, v10
  v_msad_u8 v9, s78, v38, v9
  v_msad_u8 v10, s44, v38, v10
  global_store_byte v7, v8, s[30:31]
  global_load_dwordx3 v[36:38], v233, s[30:31] sc1
  v_sub_u32 v9, v9, v10
  v_add_u32_e64 v8, 1, v8
  v_readlane_b32 s66, v9, 0
  v_readlane_b32 s67, v9, 1
  s_add_u32 s78, s78, 0x01010101
  s_mov_b64 exec, -1
  s_lshl1_add_u32 s69, s91, s95
  s_add_u32 s95, s66, s67
  s_add_u32 s69, s69, s95
  v_dot2_f32_bf16 v22, v177, v52, 0
  v_add_f32_dpp v240, v18, v18 row_ror:8 row_mask:0xf bank_mask:0xc
  v_add_f32_dpp v240, v20, v20 row_ror:8 row_mask:0xf bank_mask:0x3
  v_dot2_f32_bf16 v23, v182, v53, 0
  v_dot2_f32_bf16 v24, v180, v54, 0
  v_dot2_f32_bf16 v25, v183, v55, 0
  v_cvt_f32_i32 v76, v76
  v_cvt_f32_i32 v77, v77
  v_cvt_f32_i32 v78, v78
  v_cvt_f32_i32 v79, v79
  v_pk_mul_f32 v[20:21], v[76:77], v[22:23]
  v_pk_add_f32 v[18:19], v[22:23], v[24:25]
  v_pk_fma_f32 v[20:21], v[78:79], v[24:25], v[20:21]
  v_add_f32 v18, v18, v19
  v_add_f32 v20, v20, v21
  s_add_u32 m0, s100, 22528
  v_lshrrev_b32 v10, 1, v230
  v_add_u32 v10, v10, v246
  v_mad_u64_u32 v[30:31], s[64:65], v10, 1, v[28:29]
  global_load_lds_dwordx4 v[30:31], off
  v_dot2_f32_bf16 v22, v173, v56, 0
  v_add_f32_dpp v21, v18, v18 row_ror:8 row_mask:0xf bank_mask:0xc
  v_add_f32_dpp v21, v20, v20 row_ror:8 row_mask:0xf bank_mask:0x3
  v_add_f32_dpp v20, v240, v240 row_half_mirror row_mask:0xf bank_mask:0x5
  v_dot2_f32_bf16 v23, v178, v57, 0
  v_add_f32_dpp v20, v21, v21 row_half_mirror row_mask:0xf bank_mask:0xa
  v_dot2_f32_bf16 v24, v176, v58, 0
  v_dot2_f32_bf16 v25, v179, v59, 0
  v_add_f32_dpp v20, v20, v20 quad_perm:[2,3,0,1] row_mask:0xf bank_mask:0xf
  v_cvt_f32_i32 v80, v80
  v_cvt_f32_i32 v81, v81
  v_add_f32_dpp v20, v20, v20 quad_perm:[1,0,3,2] row_mask:0xf bank_mask:0xf
  v_cndmask_b32_e64 v237, v237, v20, s[48:49]
  v_cvt_f32_i32 v82, v82
  v_cvt_f32_i32 v83, v83
  v_pk_mul_f32 v[20:21], v[80:81], v[22:23]
  v_pk_add_f32 v[18:19], v[22:23], v[24:25]
  v_pk_fma_f32 v[20:21], v[82:83], v[24:25], v[20:21]
  v_add_f32 v18, v18, v19
  v_add_f32 v20, v20, v21
  s_cmpk_gt_i32 s69, 0x1f
  s_cbranch_scc1 L_p44_4
  s_cmp_gt_i32 s69, L_order_end-L_order-16421
  s_cbranch_scc1 L_p44_1
  s_waitcnt vmcnt(6)
L_p44_1:
  s_waitcnt vmcnt(10)
L_p44_4:
  s_waitcnt vmcnt(11)
  buffer_load_dwordx4 v[64:67], v228, s[32:35], 0 offen nt
  ds_read_b64 v[184:185], v12 offset:18432
  ds_read_b64 v[186:187], v12 offset:18560
  ds_read_b64 v[188:189], v12 offset:19456
  ds_read_b64 v[190:191], v12 offset:19584
  v_dot2_f32_bf16 v22, v177, v60, 0
  v_add_f32_dpp v241, v18, v18 row_ror:8 row_mask:0xf bank_mask:0xc
  v_add_f32_dpp v241, v20, v20 row_ror:8 row_mask:0xf bank_mask:0x3
  v_dot2_f32_bf16 v23, v182, v61, 0
  v_dot2_f32_bf16 v24, v180, v62, 0
  v_dot2_f32_bf16 v25, v183, v63, 0
  v_cvt_f32_i32 v84, v84
  v_cvt_f32_i32 v85, v85
  v_cvt_f32_i32 v86, v86
  v_cvt_f32_i32 v87, v87
  v_pk_mul_f32 v[20:21], v[84:85], v[22:23]
  v_pk_add_f32 v[18:19], v[22:23], v[24:25]
  v_pk_fma_f32 v[20:21], v[86:87], v[24:25], v[20:21]
  v_add_f32 v18, v18, v19
  v_add_f32 v20, v20, v21
  s_cmpk_gt_i32 s69, 0x1f
  s_cbranch_scc1 L_p45_4
  s_cmp_gt_i32 s69, L_order_end-L_order-16391
  s_cbranch_scc1 L_p45_2
  s_waitcnt vmcnt(7)
L_p45_2:
  s_waitcnt vmcnt(11)
L_p45_4:
  s_waitcnt vmcnt(12)
  buffer_load_dwordx4 v[68:71], v229, s[32:35], 0 offen nt
  s_cmpk_gt_i32 s69, 0x1f
  s_cbranch_scc1 L_p46_4
  s_cmpk_gt_i32 s69, 0xb
  s_cbranch_scc1 L_p46_3
  s_cmpk_gt_i32 s69, 0xffbb
  s_cbranch_scc1 L_p46_0
  s_waitcnt vmcnt(7)
L_p46_0:
  s_waitcnt vmcnt(8)
L_p46_3:
  s_waitcnt vmcnt(12)
L_p46_4:
  s_waitcnt vmcnt(13)
  buffer_load_dwordx4 v[72:75], v228, s[32:35], s80 offen nt
L_it18:
  s_waitcnt lgkmcnt(0)
  ds_read_b128 v[52:55], v250 offset:1536
  ds_read_b128 v[56:59], v248 offset:2560
  ds_read_b128 v[60:63], v250 offset:2560
  s_waitcnt vmcnt(9)
  s_mov_b64 exec, 3
  s_add_u32 s44, s78, 0x03030303
  v_msad_u8 v9, s78, v32, 0
  v_msad_u8 v10, s44, v32, 0
  v_msad_u8 v9, s78, v33, v9
  v_msad_u8 v10, s44, v33, v10
  v_msad_u8 v9, s78, v34, v9
  v_msad_u8 v10, s44, v34, v10
  global_store_byte v7, v8, s[30:31]
  global_load_dwordx3 v[32:34], v234, s[30:31] sc1
  v_sub_u32 v9, v9, v10
  v_add_u32_e64 v8, 1, v8
  v_readlane_b32 s66, v9, 0
  v_readlane_b32 s67, v9, 1
  s_add_u32 s78, s78, 0x01010101
  s_mov_b64 exec, -1
  s_lshl1_add_u32 s69, s91, s95
  s_add_u32 s95, s66, s67
  s_add_u32 s69, s69, s95
  v_perm_b32 v181, v186, v184, s56
  v_perm_b32 v186, v186, v184, s57
  v_perm_b32 v184, v187, v185, s56
  v_perm_b32 v187, v187, v185, s57
  v_dot2_f32_bf16 v22, v181, v40, 0
  v_add_f32_dpp v21, v18, v18 row_ror:8 row_mask:0xf bank_mask:0xc
  v_add_f32_dpp v21, v20, v20 row_ror:8 row_mask:0xf bank_mask:0x3
  v_add_f32_dpp v20, v241, v241 row_half_mirror row_mask:0xf bank_mask:0x5
  v_dot2_f32_bf16 v23, v186, v41, 0
  v_add_f32_dpp v20, v21, v21 row_half_mirror row_mask:0xf bank_mask:0xa
  v_dot2_f32_bf16 v24, v184, v42, 0
  v_dot2_f32_bf16 v25, v187, v43, 0
  v_add_f32_dpp v20, v20, v20 quad_perm:[2,3,0,1] row_mask:0xf bank_mask:0xf
  v_cvt_f32_i32 v88, v88
  v_cvt_f32_i32 v89, v89
  v_add_f32_dpp v20, v20, v20 quad_perm:[1,0,3,2] row_mask:0xf bank_mask:0xf
  v_cndmask_b32_e64 v238, v238, v20, s[48:49]
  v_cvt_f32_i32 v90, v90
  v_cvt_f32_i32 v91, v91
  v_pk_mul_f32 v[20:21], v[88:89], v[22:23]
  v_pk_add_f32 v[18:19], v[22:23], v[24:25]
  v_pk_fma_f32 v[20:21], v[90:91], v[24:25], v[20:21]
  v_add_f32 v18, v18, v19
  v_add_f32 v20, v20, v21
  s_add_u32 m0, s100, 23552
  v_lshrrev_b32 v10, 1, v231
  v_add_u32 v10, v10, v245
  v_mad_u64_u32 v[30:31], s[64:65], v10, 1, v[28:29]
  global_load_lds_dwordx4 v[30:31], off
  v_perm_b32 v185, v190, v188, s56
  v_perm_b32 v190, v190, v188, s57
  v_perm_b32 v188, v191, v189, s56
  v_perm_b32 v191, v191, v189, s57
  v_dot2_f32_bf16 v22, v185, v44, 0
  v_add_f32_dpp v239, v18, v18 row_ror:8 row_mask:0xf bank_mask:0xc
  v_add_f32_dpp v239, v20, v20 row_ror:8 row_mask:0xf bank_mask:0x3
  v_dot2_f32_bf16 v23, v190, v45, 0
  v_dot2_f32_bf16 v24, v188, v46, 0
  v_dot2_f32_bf16 v25, v191, v47, 0
  v_cvt_f32_i32 v92, v92
  v_cvt_f32_i32 v93, v93
  v_cvt_f32_i32 v94, v94
  v_cvt_f32_i32 v95, v95
  v_pk_mul_f32 v[20:21], v[92:93], v[22:23]
  v_pk_add_f32 v[18:19], v[22:23], v[24:25]
  v_pk_fma_f32 v[20:21], v[94:95], v[24:25], v[20:21]
  v_add_f32 v18, v18, v19
  v_add_f32 v20, v20, v21
  s_cmpk_gt_i32 s69, 0x1f
  s_cbranch_scc1 L_p47_4
  s_cmp_gt_i32 s69, L_order_end-L_order-16421
  s_cbranch_scc1 L_p47_1
  s_waitcnt vmcnt(6)
L_p47_1:
  s_waitcnt vmcnt(10)
L_p47_4:
  s_waitcnt vmcnt(11)
  buffer_load_dwordx4 v[76:79], v229, s[32:35], s80 offen nt
  v_dot2_f32_bf16 v22, v181, v48, 0
  v_add_f32_dpp v21, v18, v18 row_ror:8 row_mask:0xf bank_mask:0xc
  v_add_f32_dpp v21, v20, v20 row_ror:8 row_mask:0xf bank_mask:0x3
  v_add_f32_dpp v20, v239, v239 row_half_mirror row_mask:0xf bank_mask:0x5
  v_dot2_f32_bf16 v23, v186, v49, 0
  v_add_f32_dpp v20, v21, v21 row_half_mirror row_mask:0xf bank_mask:0xa
  v_dot2_f32_bf16 v24, v184, v50, 0
  v_dot2_f32_bf16 v25, v187, v51, 0
  v_add_f32_dpp v20, v20, v20 quad_perm:[2,3,0,1] row_mask:0xf bank_mask:0xf
  v_cvt_f32_i32 v96, v96
  v_cvt_f32_i32 v97, v97
  v_add_f32_dpp v20, v20, v20 quad_perm:[1,0,3,2] row_mask:0xf bank_mask:0xf
  v_cndmask_b32_e64 v236, v236, v20, s[50:51]
  v_cvt_f32_i32 v98, v98
  v_cvt_f32_i32 v99, v99
  v_pk_mul_f32 v[20:21], v[96:97], v[22:23]
  v_pk_add_f32 v[18:19], v[22:23], v[24:25]
  v_pk_fma_f32 v[20:21], v[98:99], v[24:25], v[20:21]
  v_add_f32 v18, v18, v19
  v_add_f32 v20, v20, v21
  s_cmpk_gt_i32 s69, 0x1f
  s_cbranch_scc1 L_p48_4
  s_cmp_gt_i32 s69, L_order_end-L_order-16391
  s_cbranch_scc1 L_p48_2
  s_waitcnt vmcnt(7)
L_p48_2:
  s_waitcnt vmcnt(11)
L_p48_4:
  s_waitcnt vmcnt(12)
  buffer_load_dwordx4 v[80:83], v228, s[32:35], s3 offen nt
  s_cmpk_gt_i32 s69, 0x1f
  s_cbranch_scc1 L_p49_4
  s_cmpk_gt_i32 s69, 0xb
  s_cbranch_scc1 L_p49_3
  s_cmpk_gt_i32 s69, 0xffbb
  s_cbranch_scc1 L_p49_0
  s_waitcnt vmcnt(7)
L_p49_0:
  s_waitcnt vmcnt(8)
L_p49_3:
  s_waitcnt vmcnt(12)
L_p49_4:
  s_waitcnt vmcnt(13)
  buffer_load_dwordx4 v[84:87], v229, s[32:35], s3 offen nt
L_it19:
  s_waitcnt lgkmcnt(0)
  ds_read_b128 v[40:43], v251 offset:512
  ds_read_b128 v[44:47], v253 offset:512
  ds_read_b128 v[48:51], v251 offset:1536
  s_waitcnt vmcnt(9)
  s_mov_b64 exec, 3
  s_add_u32 s44, s78, 0x03030303
  v_msad_u8 v9, s78, v36, 0
  v_msad_u8 v10, s44, v36, 0
  v_msad_u8 v9, s78, v37, v9
  v_msad_u8 v10, s44, v37, v10
  v_msad_u8 v9, s78, v38, v9
  v_msad_u8 v10, s44, v38, v10
  global_store_byte v7, v8, s[30:31]
  global_load_dwordx3 v[36:38], v235, s[30:31] sc1
  v_sub_u32 v9, v9, v10
  v_add_u32_e64 v8, 1, v8
  v_readlane_b32 s66, v9, 0
  v_readlane_b32 s67, v9, 1
  s_add_u32 s78, s78, 0x01010101
  s_mov_b64 exec, -1
  s_lshl1_add_u32 s69, s91, s95
  s_add_u32 s95, s66, s67
  s_add_u32 s69, s69, s95
  v_dot2_f32_bf16 v22, v185, v52, 0
  v_add_f32_dpp v240, v18, v18 row_ror:8 row_mask:0xf bank_mask:0xc
  v_add_f32_dpp v240, v20, v20 row_ror:8 row_mask:0xf bank_mask:0x3
  v_dot2_f32_bf16 v23, v190, v53, 0
  v_dot2_f32_bf16 v24, v188, v54, 0
  v_dot2_f32_bf16 v25, v191, v55, 0
  v_cvt_f32_i32 v100, v100
  v_cvt_f32_i32 v101, v101
  v_cvt_f32_i32 v102, v102
  v_cvt_f32_i32 v103, v103
  v_pk_mul_f32 v[20:21], v[100:101], v[22:23]
  v_pk_add_f32 v[18:19], v[22:23], v[24:25]
  v_pk_fma_f32 v[20:21], v[102:103], v[24:25], v[20:21]
  v_add_f32 v18, v18, v19
  v_add_f32 v20, v20, v21
  v_dot2_f32_bf16 v22, v181, v56, 0
  v_add_f32_dpp v21, v18, v18 row_ror:8 row_mask:0xf bank_mask:0xc
  v_add_f32_dpp v21, v20, v20 row_ror:8 row_mask:0xf bank_mask:0x3
  v_add_f32_dpp v20, v240, v240 row_half_mirror row_mask:0xf bank_mask:0x5
  v_dot2_f32_bf16 v23, v186, v57, 0
  v_add_f32_dpp v20, v21, v21 row_half_mirror row_mask:0xf bank_mask:0xa
  v_dot2_f32_bf16 v24, v184, v58, 0
  v_dot2_f32_bf16 v25, v187, v59, 0
  v_add_f32_dpp v20, v20, v20 quad_perm:[2,3,0,1] row_mask:0xf bank_mask:0xf
  v_cvt_f32_i32 v104, v104
  v_cvt_f32_i32 v105, v105
  v_add_f32_dpp v20, v20, v20 quad_perm:[1,0,3,2] row_mask:0xf bank_mask:0xf
  v_cndmask_b32_e64 v237, v237, v20, s[50:51]
  v_cvt_f32_i32 v106, v106
  v_cvt_f32_i32 v107, v107
  v_pk_mul_f32 v[20:21], v[104:105], v[22:23]
  v_pk_add_f32 v[18:19], v[22:23], v[24:25]
  v_pk_fma_f32 v[20:21], v[106:107], v[24:25], v[20:21]
  v_add_f32 v18, v18, v19
  v_add_f32 v20, v20, v21
  s_cmpk_gt_i32 s69, 0x1f
  s_cbranch_scc1 L_p50_4
  s_cmp_gt_i32 s69, L_order_end-L_order-16421
  s_cbranch_scc1 L_p50_1
  s_waitcnt vmcnt(5)
L_p50_1:
  s_waitcnt vmcnt(9)
L_p50_4:
  s_waitcnt vmcnt(10)
  buffer_load_dwordx4 v[88:91], v230, s[32:35], 0 offen nt
  ds_read_b64 v[192:193], v12 offset:20480
  ds_read_b64 v[194:195], v12 offset:20608
  ds_read_b64 v[196:197], v12 offset:21504
  ds_read_b64 v[198:199], v12 offset:21632
  v_dot2_f32_bf16 v22, v185, v60, 0
  v_add_f32_dpp v241, v18, v18 row_ror:8 row_mask:0xf bank_mask:0xc
  v_add_f32_dpp v241, v20, v20 row_ror:8 row_mask:0xf bank_mask:0x3
  v_dot2_f32_bf16 v23, v190, v61, 0
  v_dot2_f32_bf16 v24, v188, v62, 0
  v_dot2_f32_bf16 v25, v191, v63, 0
  v_cvt_f32_i32 v108, v108
  v_cvt_f32_i32 v109, v109
  v_cvt_f32_i32 v110, v110
  v_cvt_f32_i32 v111, v111
  v_pk_mul_f32 v[20:21], v[108:109], v[22:23]
  v_pk_add_f32 v[18:19], v[22:23], v[24:25]
  v_pk_fma_f32 v[20:21], v[110:111], v[24:25], v[20:21]
  v_add_f32 v18, v18, v19
  v_add_f32 v20, v20, v21
  s_cmpk_gt_i32 s69, 0x1f
  s_cbranch_scc1 L_p51_4
  s_cmp_gt_i32 s69, L_order_end-L_order-16391
  s_cbranch_scc1 L_p51_2
  s_waitcnt vmcnt(6)
L_p51_2:
  s_waitcnt vmcnt(10)
L_p51_4:
  s_waitcnt vmcnt(11)
  buffer_load_dwordx4 v[92:95], v231, s[32:35], 0 offen nt
  s_cmpk_gt_i32 s69, 0x1f
  s_cbranch_scc1 L_p52_4
  s_cmpk_gt_i32 s69, 0xb
  s_cbranch_scc1 L_p52_3
  s_cmpk_gt_i32 s69, 0xffbb
  s_cbranch_scc1 L_p52_0
  s_waitcnt vmcnt(6)
L_p52_0:
  s_waitcnt vmcnt(7)
L_p52_3:
  s_waitcnt vmcnt(11)
L_p52_4:
  s_waitcnt vmcnt(12)
  buffer_load_dwordx4 v[96:99], v230, s[32:35], s80 offen nt
L_it20:
  s_waitcnt lgkmcnt(0)
  ds_read_b128 v[52:55], v253 offset:1536
  ds_read_b128 v[56:59], v251 offset:2560
  ds_read_b128 v[60:63], v253 offset:2560
  s_waitcnt vmcnt(8)
  s_mov_b64 exec, 3
  s_add_u32 s44, s78, 0x03030303
  v_msad_u8 v9, s78, v32, 0
  v_msad_u8 v10, s44, v32, 0
  v_msad_u8 v9, s78, v33, v9
  v_msad_u8 v10, s44, v33, v10
  v_msad_u8 v9, s78, v34, v9
  v_msad_u8 v10, s44, v34, v10
  global_store_byte v7, v8, s[30:31]
  global_load_dwordx3 v[32:34], v232, s[30:31] sc1
  v_sub_u32 v9, v9, v10
  v_add_u32_e64 v8, 1, v8
  v_readlane_b32 s66, v9, 0
  v_readlane_b32 s67, v9, 1
  s_add_u32 s78, s78, 0x01010101
  s_mov_b64 exec, -1
  s_lshl1_add_u32 s69, s91, s95
  s_add_u32 s95, s66, s67
  s_add_u32 s69, s69, s95
  v_perm_b32 v189, v194, v192, s56
  v_perm_b32 v194, v194, v192, s57
  v_perm_b32 v192, v195, v193, s56
  v_perm_b32 v195, v195, v193, s57
  v_dot2_f32_bf16 v22, v189, v40, 0
  v_add_f32_dpp v21, v18, v18 row_ror:8 row_mask:0xf bank_mask:0xc
  v_add_f32_dpp v21, v20, v20 row_ror:8 row_mask:0xf bank_mask:0x3
  v_add_f32_dpp v20, v241, v241 row_half_mirror row_mask:0xf bank_mask:0x5
  v_dot2_f32_bf16 v23, v194, v41, 0
  v_add_f32_dpp v20, v21, v21 row_half_mirror row_mask:0xf bank_mask:0xa
  v_dot2_f32_bf16 v24, v192, v42, 0
  v_dot2_f32_bf16 v25, v195, v43, 0
  v_add_f32_dpp v20, v20, v20 quad_perm:[2,3,0,1] row_mask:0xf bank_mask:0xf
  v_cvt_f32_i32 v64, v64
  v_cvt_f32_i32 v65, v65
  v_add_f32_dpp v20, v20, v20 quad_perm:[1,0,3,2] row_mask:0xf bank_mask:0xf
  v_cndmask_b32_e64 v238, v238, v20, s[50:51]
  v_cvt_f32_i32 v66, v66
  v_cvt_f32_i32 v67, v67
  v_pk_mul_f32 v[20:21], v[64:65], v[22:23]
  v_pk_add_f32 v[18:19], v[22:23], v[24:25]
  v_pk_fma_f32 v[20:21], v[66:67], v[24:25], v[20:21]
  v_add_f32 v18, v18, v19
  v_add_f32 v20, v20, v21
  v_perm_b32 v193, v198, v196, s56
  v_perm_b32 v198, v198, v196, s57
  v_perm_b32 v196, v199, v197, s56
  v_perm_b32 v199, v199, v197, s57
  v_dot2_f32_bf16 v22, v193, v44, 0
  v_add_f32_dpp v239, v18, v18 row_ror:8 row_mask:0xf bank_mask:0xc
  v_add_f32_dpp v239, v20, v20 row_ror:8 row_mask:0xf bank_mask:0x3
  v_dot2_f32_bf16 v23, v198, v45, 0
  v_dot2_f32_bf16 v24, v196, v46, 0
  v_dot2_f32_bf16 v25, v199, v47, 0
  v_cvt_f32_i32 v68, v68
  v_cvt_f32_i32 v69, v69
  v_cvt_f32_i32 v70, v70
  v_cvt_f32_i32 v71, v71
  v_pk_mul_f32 v[20:21], v[68:69], v[22:23]
  v_pk_add_f32 v[18:19], v[22:23], v[24:25]
  v_pk_fma_f32 v[20:21], v[70:71], v[24:25], v[20:21]
  v_add_f32 v18, v18, v19
  v_add_f32 v20, v20, v21
  s_cmpk_gt_i32 s69, 0x1f
  s_cbranch_scc1 L_p53_4
  s_cmp_gt_i32 s69, L_order_end-L_order-16421
  s_cbranch_scc1 L_p53_1
  s_waitcnt vmcnt(5)
L_p53_1:
  s_waitcnt vmcnt(8)
L_p53_4:
  s_waitcnt vmcnt(9)
  buffer_load_dwordx4 v[100:103], v231, s[32:35], s80 offen nt
  v_dot2_f32_bf16 v22, v189, v48, 0
  v_add_f32_dpp v21, v18, v18 row_ror:8 row_mask:0xf bank_mask:0xc
  v_add_f32_dpp v21, v20, v20 row_ror:8 row_mask:0xf bank_mask:0x3
  v_add_f32_dpp v20, v239, v239 row_half_mirror row_mask:0xf bank_mask:0x5
  v_dot2_f32_bf16 v23, v194, v49, 0
  v_add_f32_dpp v20, v21, v21 row_half_mirror row_mask:0xf bank_mask:0xa
  v_dot2_f32_bf16 v24, v192, v50, 0
  v_dot2_f32_bf16 v25, v195, v51, 0
  v_add_f32_dpp v20, v20, v20 quad_perm:[2,3,0,1] row_mask:0xf bank_mask:0xf
  v_cvt_f32_i32 v72, v72
  v_cvt_f32_i32 v73, v73
  v_add_f32_dpp v20, v20, v20 quad_perm:[1,0,3,2] row_mask:0xf bank_mask:0xf
  v_cndmask_b32_e64 v236, v236, v20, s[52:53]
  v_cvt_f32_i32 v74, v74
  v_cvt_f32_i32 v75, v75
  v_pk_mul_f32 v[20:21], v[72:73], v[22:23]
  v_pk_add_f32 v[18:19], v[22:23], v[24:25]
  v_pk_fma_f32 v[20:21], v[74:75], v[24:25], v[20:21]
  v_add_f32 v18, v18, v19
  v_add_f32 v20, v20, v21
  s_cmpk_gt_i32 s69, 0x1f
  s_cbranch_scc1 L_p54_4
  s_cmp_gt_i32 s69, L_order_end-L_order-16391
  s_cbranch_scc1 L_p54_2
  s_waitcnt vmcnt(6)
L_p54_2:
  s_waitcnt vmcnt(9)
L_p54_4:
  s_waitcnt vmcnt(10)
  buffer_load_dwordx4 v[104:107], v230, s[32:35], s3 offen nt
  s_cmpk_gt_i32 s69, 0x1f
  s_cbranch_scc1 L_p55_4
  s_cmpk_gt_i32 s69, 0xb
  s_cbranch_scc1 L_p55_3
  s_cmpk_gt_i32 s69, 0xffbb
  s_cbranch_scc1 L_p55_0
  s_waitcnt vmcnt(6)
L_p55_0:
  s_waitcnt vmcnt(7)
L_p55_3:
  s_waitcnt vmcnt(10)
L_p55_4:
  s_waitcnt vmcnt(11)
  buffer_load_dwordx4 v[108:111], v231, s[32:35], s3 offen nt
L_it21:
  s_waitcnt lgkmcnt(0)
  ds_read_b128 v[40:43], v252 offset:512
  ds_read_b128 v[44:47], v251 offset:512
  ds_read_b128 v[48:51], v252 offset:1536
  s_waitcnt vmcnt(7)
  s_mov_b64 exec, 3
  s_add_u32 s44, s78, 0x03030303
  v_msad_u8 v9, s78, v36, 0
  v_msad_u8 v10, s44, v36, 0
  v_msad_u8 v9, s78, v37, v9
  v_msad_u8 v10, s44, v37, v10
  v_msad_u8 v9, s78, v38, v9
  v_msad_u8 v10, s44, v38, v10
  global_load_dwordx2 v[26:27], v11, s[30:31] sc1
  global_store_byte v7, v8, s[30:31]
  global_load_dwordx3 v[36:38], v233, s[30:31] sc1
  v_sub_u32 v9, v9, v10
  v_add_u32_e64 v8, 1, v8
  v_readlane_b32 s66, v9, 0
  v_readlane_b32 s67, v9, 1
  s_add_u32 s78, s78, 0x01010101
  s_mov_b64 exec, -1
  s_lshl1_add_u32 s69, s91, s95
  s_add_u32 s95, s66, s67
  s_add_u32 s69, s69, s95
  v_dot2_f32_bf16 v22, v193, v52, 0
  v_add_f32_dpp v240, v18, v18 row_ror:8 row_mask:0xf bank_mask:0xc
  v_add_f32_dpp v240, v20, v20 row_ror:8 row_mask:0xf bank_mask:0x3
  v_dot2_f32_bf16 v23, v198, v53, 0
  v_dot2_f32_bf16 v24, v196, v54, 0
  v_dot2_f32_bf16 v25, v199, v55, 0
  v_cvt_f32_i32 v76, v76
  v_cvt_f32_i32 v77, v77
  v_cvt_f32_i32 v78, v78
  v_cvt_f32_i32 v79, v79
  v_pk_mul_f32 v[20:21], v[76:77], v[22:23]
  v_pk_add_f32 v[18:19], v[22:23], v[24:25]
  v_pk_fma_f32 v[20:21], v[78:79], v[24:25], v[20:21]
  v_add_f32 v18, v18, v19
  v_add_f32 v20, v20, v21
  v_dot2_f32_bf16 v22, v189, v56, 0
  v_add_f32_dpp v21, v18, v18 row_ror:8 row_mask:0xf bank_mask:0xc
  v_add_f32_dpp v21, v20, v20 row_ror:8 row_mask:0xf bank_mask:0x3
  v_add_f32_dpp v20, v240, v240 row_half_mirror row_mask:0xf bank_mask:0x5
  v_dot2_f32_bf16 v23, v194, v57, 0
  v_add_f32_dpp v20, v21, v21 row_half_mirror row_mask:0xf bank_mask:0xa
  v_dot2_f32_bf16 v24, v192, v58, 0
  v_dot2_f32_bf16 v25, v195, v59, 0
  v_add_f32_dpp v20, v20, v20 quad_perm:[2,3,0,1] row_mask:0xf bank_mask:0xf
  v_cvt_f32_i32 v80, v80
  v_cvt_f32_i32 v81, v81
  v_add_f32_dpp v20, v20, v20 quad_perm:[1,0,3,2] row_mask:0xf bank_mask:0xf
  v_cndmask_b32_e64 v237, v237, v20, s[52:53]
  v_cvt_f32_i32 v82, v82
  v_cvt_f32_i32 v83, v83
  v_pk_mul_f32 v[20:21], v[80:81], v[22:23]
  v_pk_add_f32 v[18:19], v[22:23], v[24:25]
  v_pk_fma_f32 v[20:21], v[82:83], v[24:25], v[20:21]
  v_add_f32 v18, v18, v19
  v_add_f32 v20, v20, v21
  s_cmpk_gt_i32 s69, 0x1f
  s_cbranch_scc1 L_p56_4
  s_cmp_gt_i32 s69, L_order_end-L_order-16421
  s_cbranch_scc1 L_p56_1
  s_waitcnt vmcnt(6)
L_p56_1:
  s_waitcnt vmcnt(9)
L_p56_4:
  s_waitcnt vmcnt(10)
  buffer_load_dwordx4 v[64:67], v208, s[32:35], s98 offen nt
  ds_read_b64 v[200:201], v12 offset:22528
  ds_read_b64 v[202:203], v12 offset:22656
  ds_read_b64 v[204:205], v12 offset:23552
  ds_read_b64 v[206:207], v12 offset:23680
  v_dot2_f32_bf16 v22, v193, v60, 0
  v_add_f32_dpp v241, v18, v18 row_ror:8 row_mask:0xf bank_mask:0xc
  v_add_f32_dpp v241, v20, v20 row_ror:8 row_mask:0xf bank_mask:0x3
  v_dot2_f32_bf16 v23, v198, v61, 0
  v_dot2_f32_bf16 v24, v196, v62, 0
  v_dot2_f32_bf16 v25, v199, v63, 0
  v_cvt_f32_i32 v84, v84
  v_cvt_f32_i32 v85, v85
  v_cvt_f32_i32 v86, v86
  v_cvt_f32_i32 v87, v87
  v_pk_mul_f32 v[20:21], v[84:85], v[22:23]
  v_pk_add_f32 v[18:19], v[22:23], v[24:25]
  v_pk_fma_f32 v[20:21], v[86:87], v[24:25], v[20:21]
  v_add_f32 v18, v18, v19
  v_add_f32 v20, v20, v21
  s_cmpk_gt_i32 s69, 0x1f
  s_cbranch_scc1 L_p57_4
  s_cmp_gt_i32 s69, L_order_end-L_order-16391
  s_cbranch_scc1 L_p57_2
  s_waitcnt vmcnt(7)
L_p57_2:
  s_waitcnt vmcnt(10)
L_p57_4:
  s_waitcnt vmcnt(11)
  buffer_load_dwordx4 v[68:71], v209, s[32:35], s98 offen nt
  s_cmpk_gt_i32 s69, 0x1f
  s_cbranch_scc1 L_p58_4
  s_cmpk_gt_i32 s69, 0xb
  s_cbranch_scc1 L_p58_3
  s_cmpk_gt_i32 s69, 0xffbb
  s_cbranch_scc1 L_p58_0
  s_waitcnt vmcnt(7)
L_p58_0:
  s_waitcnt vmcnt(8)
L_p58_3:
  s_waitcnt vmcnt(11)
L_p58_4:
  s_waitcnt vmcnt(12)
  buffer_load_dwordx4 v[72:75], v210, s[32:35], s98 offen nt
L_it22:
  s_waitcnt lgkmcnt(0)
  ds_read_b128 v[52:55], v251 offset:1536
  ds_read_b128 v[56:59], v252 offset:2560
  ds_read_b128 v[60:63], v251 offset:2560
  ds_read_b32 v4, v14 offset:16
  s_waitcnt vmcnt(8)
  s_mov_b64 exec, 3
  s_add_u32 s44, s78, 0x03030303
  v_msad_u8 v9, s78, v32, 0
  v_msad_u8 v10, s44, v32, 0
  v_msad_u8 v9, s78, v33, v9
  v_msad_u8 v10, s44, v33, v10
  v_msad_u8 v9, s78, v34, v9
  v_msad_u8 v10, s44, v34, v10
  global_store_byte v7, v8, s[30:31]
  global_load_dwordx3 v[32:34], v234, s[30:31] sc1
  v_sub_u32 v9, v9, v10
  v_add_u32_e64 v8, 1, v8
  v_readlane_b32 s66, v9, 0
  v_readlane_b32 s67, v9, 1
  s_add_u32 s78, s78, 0x01010101
  s_mov_b64 exec, -1
  s_lshl1_add_u32 s69, s91, s95
  s_add_u32 s95, s66, s67
  s_add_u32 s69, s69, s95
  v_perm_b32 v197, v202, v200, s56
  v_perm_b32 v202, v202, v200, s57
  v_perm_b32 v200, v203, v201, s56
  v_perm_b32 v203, v203, v201, s57
  v_dot2_f32_bf16 v22, v197, v40, 0
  v_add_f32_dpp v21, v18, v18 row_ror:8 row_mask:0xf bank_mask:0xc
  v_add_f32_dpp v21, v20, v20 row_ror:8 row_mask:0xf bank_mask:0x3
  v_add_f32_dpp v20, v241, v241 row_half_mirror row_mask:0xf bank_mask:0x5
  v_dot2_f32_bf16 v23, v202, v41, 0
  v_add_f32_dpp v20, v21, v21 row_half_mirror row_mask:0xf bank_mask:0xa
  v_dot2_f32_bf16 v24, v200, v42, 0
  v_dot2_f32_bf16 v25, v203, v43, 0
  v_add_f32_dpp v20, v20, v20 quad_perm:[2,3,0,1] row_mask:0xf bank_mask:0xf
  v_cvt_f32_i32 v88, v88
  v_cvt_f32_i32 v89, v89
  v_add_f32_dpp v20, v20, v20 quad_perm:[1,0,3,2] row_mask:0xf bank_mask:0xf
  v_cndmask_b32_e64 v238, v238, v20, s[52:53]
  v_cvt_f32_i32 v90, v90
  v_cvt_f32_i32 v91, v91
  v_pk_mul_f32 v[20:21], v[88:89], v[22:23]
  v_pk_add_f32 v[18:19], v[22:23], v[24:25]
  v_pk_fma_f32 v[20:21], v[90:91], v[24:25], v[20:21]
  v_add_f32 v18, v18, v19
  v_add_f32 v20, v20, v21
  v_perm_b32 v201, v206, v204, s56
  v_perm_b32 v206, v206, v204, s57
  v_perm_b32 v204, v207, v205, s56
  v_perm_b32 v207, v207, v205, s57
  v_dot2_f32_bf16 v22, v201, v44, 0
  v_add_f32_dpp v239, v18, v18 row_ror:8 row_mask:0xf bank_mask:0xc
  v_add_f32_dpp v239, v20, v20 row_ror:8 row_mask:0xf bank_mask:0x3
  v_dot2_f32_bf16 v23, v206, v45, 0
  v_dot2_f32_bf16 v24, v204, v46, 0
  v_dot2_f32_bf16 v25, v207, v47, 0
  v_cvt_f32_i32 v92, v92
  v_cvt_f32_i32 v93, v93
  v_cvt_f32_i32 v94, v94
  v_cvt_f32_i32 v95, v95
  v_pk_mul_f32 v[20:21], v[92:93], v[22:23]
  v_pk_add_f32 v[18:19], v[22:23], v[24:25]
  v_pk_fma_f32 v[20:21], v[94:95], v[24:25], v[20:21]
  v_add_f32 v18, v18, v19
  v_add_f32 v20, v20, v21
  s_cmpk_gt_i32 s69, 0x1f
  s_cbranch_scc1 L_p59_4
  s_cmp_gt_i32 s69, L_order_end-L_order-16421
  s_cbranch_scc1 L_p59_1
  s_waitcnt vmcnt(5)
L_p59_1:
  s_waitcnt vmcnt(9)
L_p59_4:
  s_waitcnt vmcnt(10)
  buffer_load_dwordx4 v[76:79], v211, s[32:35], s98 offen nt
  v_dot2_f32_bf16 v22, v197, v48, 0
  v_add_f32_dpp v21, v18, v18 row_ror:8 row_mask:0xf bank_mask:0xc
  v_add_f32_dpp v21, v20, v20 row_ror:8 row_mask:0xf bank_mask:0x3
  v_add_f32_dpp v20, v239, v239 row_half_mirror row_mask:0xf bank_mask:0x5
  v_dot2_f32_bf16 v23, v202, v49, 0
  v_add_f32_dpp v20, v21, v21 row_half_mirror row_mask:0xf bank_mask:0xa
  v_dot2_f32_bf16 v24, v200, v50, 0
  v_dot2_f32_bf16 v25, v203, v51, 0
  v_add_f32_dpp v20, v20, v20 quad_perm:[2,3,0,1] row_mask:0xf bank_mask:0xf
  v_cvt_f32_i32 v96, v96
  v_cvt_f32_i32 v97, v97
  v_add_f32_dpp v20, v20, v20 quad_perm:[1,0,3,2] row_mask:0xf bank_mask:0xf
  v_cndmask_b32_e64 v236, v236, v20, s[54:55]
  ds_write_b32 v17, v236 offset:0
  v_cvt_f32_i32 v98, v98
  v_cvt_f32_i32 v99, v99
  v_pk_mul_f32 v[20:21], v[96:97], v[22:23]
  v_pk_add_f32 v[18:19], v[22:23], v[24:25]
  v_pk_fma_f32 v[20:21], v[98:99], v[24:25], v[20:21]
  v_add_f32 v18, v18, v19
  v_add_f32 v20, v20, v21
  s_cmpk_gt_i32 s69, 0x1f
  s_cbranch_scc1 L_p60_4
  s_cmp_gt_i32 s69, L_order_end-L_order-16391
  s_cbranch_scc1 L_p60_2
  s_waitcnt vmcnt(6)
L_p60_2:
  s_waitcnt vmcnt(10)
L_p60_4:
  s_waitcnt vmcnt(11)
  buffer_load_dwordx4 v[80:83], v212, s[32:35], s98 offen nt
  s_cmpk_gt_i32 s69, 0x1f
  s_cbranch_scc1 L_p61_4
  s_cmpk_gt_i32 s69, 0xb
  s_cbranch_scc1 L_p61_3
  s_cmpk_gt_i32 s69, 0xffbb
  s_cbranch_scc1 L_p61_0
  s_waitcnt vmcnt(6)
L_p61_0:
  s_waitcnt vmcnt(7)
L_p61_3:
  s_waitcnt vmcnt(11)
L_p61_4:
  s_waitcnt vmcnt(12)
  buffer_load_dwordx4 v[84:87], v213, s[32:35], s98 offen nt
L_it23:
  s_mov_b32 s47, 4
L_fq23:
  s_waitcnt lgkmcnt(0)
  v_readfirstlane_b32 s46, v4
  s_cmp_ge_u32 s46, s47
  s_cbranch_scc1 L_fq23_ok
  s_cmp_eq_u32 s94, 0
  s_cbranch_scc1 L_fq23_ok
  s_sub_u32 s94, s94, 1
  ds_read_b32 v4, v14 offset:16
  s_branch L_fq23
L_fq23_ok:
  ds_read_b128 v[40:43], v248 offset:3584
  ds_read_b128 v[44:47], v249 offset:3584
  ds_read_b128 v[48:51], v250 offset:3584
  s_waitcnt vmcnt(7)
  s_mov_b64 exec, 3
  s_add_u32 s44, s78, 0x03030303
  v_msad_u8 v9, s78, v36, 0
  v_msad_u8 v10, s44, v36, 0
  v_msad_u8 v9, s78, v37, v9
  v_msad_u8 v10, s44, v37, v10
  v_msad_u8 v9, s78, v38, v9
  v_msad_u8 v10, s44, v38, v10
  global_store_byte v7, v8, s[30:31]
  global_load_dwordx3 v[36:38], v235, s[30:31] sc1
  v_sub_u32 v9, v9, v10
  v_add_u32_e64 v8, 1, v8
  v_add3_u32 v10, v26, v27, s58
  v_readlane_b32 s66, v9, 0
  v_readlane_b32 s67, v9, 1
  v_readlane_b32 s91, v10, 0
  s_add_u32 s78, s78, 0x01010101
  s_mov_b64 exec, -1
  s_lshl1_add_u32 s69, s91, s95
  s_add_u32 s95, s66, s67
  s_add_u32 s69, s69, s95
  v_dot2_f32_bf16 v22, v201, v52, 0
  v_add_f32_dpp v240, v18, v18 row_ror:8 row_mask:0xf bank_mask:0xc
  v_add_f32_dpp v240, v20, v20 row_ror:8 row_mask:0xf bank_mask:0x3
  v_dot2_f32_bf16 v23, v206, v53, 0
  v_dot2_f32_bf16 v24, v204, v54, 0
  v_dot2_f32_bf16 v25, v207, v55, 0
  v_cvt_f32_i32 v100, v100
  v_cvt_f32_i32 v101, v101
  v_cvt_f32_i32 v102, v102
  v_cvt_f32_i32 v103, v103
  v_pk_mul_f32 v[20:21], v[100:101], v[22:23]
  v_pk_add_f32 v[18:19], v[22:23], v[24:25]
  v_pk_fma_f32 v[20:21], v[102:103], v[24:25], v[20:21]
  v_add_f32 v18, v18, v19
  v_add_f32 v20, v20, v21
  v_dot2_f32_bf16 v22, v197, v56, 0
  v_add_f32_dpp v21, v18, v18 row_ror:8 row_mask:0xf bank_mask:0xc
  v_add_f32_dpp v21, v20, v20 row_ror:8 row_mask:0xf bank_mask:0x3
  v_add_f32_dpp v20, v240, v240 row_half_mirror row_mask:0xf bank_mask:0x5
  v_dot2_f32_bf16 v23, v202, v57, 0
  v_add_f32_dpp v20, v21, v21 row_half_mirror row_mask:0xf bank_mask:0xa
  v_dot2_f32_bf16 v24, v200, v58, 0
  v_dot2_f32_bf16 v25, v203, v59, 0
  v_add_f32_dpp v20, v20, v20 quad_perm:[2,3,0,1] row_mask:0xf bank_mask:0xf
  v_cvt_f32_i32 v104, v104
  v_cvt_f32_i32 v105, v105
  v_add_f32_dpp v20, v20, v20 quad_perm:[1,0,3,2] row_mask:0xf bank_mask:0xf
  v_cndmask_b32_e64 v237, v237, v20, s[54:55]
  ds_write_b32 v17, v237 offset:3072
  v_cvt_f32_i32 v106, v106
  v_cvt_f32_i32 v107, v107
  v_pk_mul_f32 v[20:21], v[104:105], v[22:23]
  v_pk_add_f32 v[18:19], v[22:23], v[24:25]
  v_pk_fma_f32 v[20:21], v[106:107], v[24:25], v[20:21]
  v_add_f32 v18, v18, v19
  v_add_f32 v20, v20, v21
  s_cmpk_gt_i32 s69, 0x1f
  s_cbranch_scc1 L_p62_4
  s_cmp_gt_i32 s69, L_order_end-L_order-16421
  s_cbranch_scc1 L_p62_1
  s_waitcnt vmcnt(5)
L_p62_1:
  s_waitcnt vmcnt(8)
L_p62_4:
  s_waitcnt vmcnt(9)
  buffer_load_dwordx4 v[88:91], v214, s[32:35], s98 offen nt
  v_dot2_f32_bf16 v22, v201, v60, 0
  v_add_f32_dpp v241, v18, v18 row_ror:8 row_mask:0xf bank_mask:0xc
  v_add_f32_dpp v241, v20, v20 row_ror:8 row_mask:0xf bank_mask:0x3
  v_dot2_f32_bf16 v23, v206, v61, 0
  v_dot2_f32_bf16 v24, v204, v62, 0
  v_dot2_f32_bf16 v25, v207, v63, 0
  v_cvt_f32_i32 v108, v108
  v_cvt_f32_i32 v109, v109
  v_cvt_f32_i32 v110, v110
  v_cvt_f32_i32 v111, v111
  v_pk_mul_f32 v[20:21], v[108:109], v[22:23]
  v_pk_add_f32 v[18:19], v[22:23], v[24:25]
  v_pk_fma_f32 v[20:21], v[110:111], v[24:25], v[20:21]
  v_add_f32 v18, v18, v19
  v_add_f32 v20, v20, v21
  s_cmpk_gt_i32 s69, 0x1f
  s_cbranch_scc1 L_p63_4
  s_cmp_gt_i32 s69, L_order_end-L_order-16391
  s_cbranch_scc1 L_p63_2
  s_waitcnt vmcnt(6)
L_p63_2:
  s_waitcnt vmcnt(9)
L_p63_4:
  s_waitcnt vmcnt(10)
  buffer_load_dwordx4 v[92:95], v215, s[32:35], s98 offen nt
  s_cmpk_gt_i32 s69, 0x1f
  s_cbranch_scc1 L_p64_4
  s_cmpk_gt_i32 s69, 0xb
  s_cbranch_scc1 L_p64_3
  s_cmpk_gt_i32 s69, 0xffbb
  s_cbranch_scc1 L_p64_0
  s_waitcnt vmcnt(6)
L_p64_0:
  s_waitcnt vmcnt(7)
L_p64_3:
  s_waitcnt vmcnt(10)
L_p64_4:
  s_waitcnt vmcnt(11)
  buffer_load_dwordx4 v[96:99], v216, s[32:35], s98 offen nt
  s_nop 0
  v_add_f32_dpp v21, v18, v18 row_ror:8 row_mask:0xf bank_mask:0xc
  v_add_f32_dpp v21, v20, v20 row_ror:8 row_mask:0xf bank_mask:0x3
  v_add_f32_dpp v20, v241, v241 row_half_mirror row_mask:0xf bank_mask:0x5
  s_nop 0
  v_add_f32_dpp v20, v21, v21 row_half_mirror row_mask:0xf bank_mask:0xa
  s_nop 1
  v_add_f32_dpp v20, v20, v20 quad_perm:[2,3,0,1] row_mask:0xf bank_mask:0xf
  s_nop 1
  v_add_f32_dpp v20, v20, v20 quad_perm:[1,0,3,2] row_mask:0xf bank_mask:0xf
  v_cndmask_b32_e64 v238, v238, v20, s[54:55]
  ds_write_b32 v17, v238 offset:6144
  v_mov_b32_e64 v9, 3
  ds_write_b32 v6, v9 offset:0
  ds_read_b128 v[52:55], v251 offset:3584
  ds_read_b128 v[56:59], v252 offset:3584
  ds_read_b128 v[60:63], v253 offset:3584
  s_movk_i32 s59, 3072
  s_mov_b32 s43, 3
  s_movk_i32 s101, 9216
  s_mov_b32 s34, 1572864
  s_add_u32 s32, s32, s98
  s_addc_u32 s33, s33, 0
  s_mov_b32 s68, 4
  s_lshl_b32 s44, s68, 2
  s_lshr_b64 s[64:65], s[96:97], s44
  s_and_b32 s64, s64, 15
  s_lshl4_add_u32 s68, s68, s64
  s_mul_i32 s44, s68, 1572864
  s_add_u32 s36, s6, s44
  s_addc_u32 s37, s7, 0
.p2align 6
L_k:
  s_add_u32 s44, s43, 2
  s_min_u32 s47, s44, 16
  s_addk_i32 s59, 1024
  s_cmpk_eq_u32 s59, 4096
  s_cselect_b32 s59, 0, s59
  s_waitcnt lgkmcnt(0)
  s_waitcnt vmcnt(8)
  s_mov_b64 exec, 3
  s_add_u32 s44, s78, 0x03030303
  v_msad_u8 v9, s78, v32, 0
  v_msad_u8 v10, s44, v32, 0
  v_msad_u8 v9, s78, v33, v9
  v_msad_u8 v10, s44, v33, v10
  v_msad_u8 v9, s78, v34, v9
  v_msad_u8 v10, s44, v34, v10
  global_store_byte v7, v8, s[30:31]
  global_load_dwordx3 v[32:34], v232, s[30:31] sc1
  v_sub_u32 v9, v9, v10
  v_add_u32 v8, 1, v8
  v_readlane_b32 s66, v9, 0
  v_readlane_b32 s67, v9, 1
  s_add_u32 s78, s78, 0x01010101
  s_mov_b64 exec, -1
  s_lshl1_add_u32 s69, s91, s95
  s_add_u32 s95, s66, s67
  s_add_u32 s69, s69, s95
  v_dot2_f32_bf16 v22, v13, v40, 0
  v_dot2_f32_bf16 v23, v114, v41, 0
  v_dot2_f32_bf16 v24, v112, v42, 0
  v_dot2_f32_bf16 v25, v115, v43, 0
  v_cvt_f32_i32 v64, v64
  v_cvt_f32_i32 v65, v65
  v_cvt_f32_i32 v66, v66
  v_cvt_f32_i32 v67, v67
  v_pk_mul_f32 v[20:21], v[64:65], v[22:23]
  v_pk_add_f32 v[18:19], v[22:23], v[24:25]
  v_pk_fma_f32 v[20:21], v[66:67], v[24:25], v[20:21]
  v_add_f32 v18, v18, v19
  v_add_f32 v20, v20, v21
  s_cmpk_gt_i32 s69, 0x29
  s_cbranch_scc1 L_p65_4
  s_cmp_gt_i32 s69, L_order_end-L_order-16411
  s_cbranch_scc1 L_p65_1
  s_waitcnt vmcnt(5)
L_p65_1:
  s_waitcnt vmcnt(8)
L_p65_4:
  s_waitcnt vmcnt(9)
  buffer_load_dwordx4 v[100:103], v217, s[32:35], 0 offen nt
  v_dot2_f32_bf16 v22, v113, v48, 0
  v_add_f32_dpp v239, v18, v18 row_ror:8 row_mask:0xf bank_mask:0xc
  v_add_f32_dpp v239, v20, v20 row_ror:8 row_mask:0xf bank_mask:0x3
  v_dot2_f32_bf16 v23, v118, v49, 0
  v_dot2_f32_bf16 v24, v116, v50, 0
  v_dot2_f32_bf16 v25, v119, v51, 0
  v_cvt_f32_i32 v68, v68
  v_cvt_f32_i32 v69, v69
  v_cvt_f32_i32 v70, v70
  v_cvt_f32_i32 v71, v71
  v_pk_mul_f32 v[20:21], v[68:69], v[22:23]
  v_pk_add_f32 v[18:19], v[22:23], v[24:25]
  v_pk_fma_f32 v[20:21], v[70:71], v[24:25], v[20:21]
  v_add_f32 v18, v18, v19
  v_add_f32 v20, v20, v21
  s_cmpk_gt_i32 s69, 0x29
  s_cbranch_scc1 L_p66_4
  s_cmp_gt_i32 s69, L_order_end-L_order-16381
  s_cbranch_scc1 L_p66_2
  s_waitcnt vmcnt(6)
L_p66_2:
  s_waitcnt vmcnt(9)
L_p66_4:
  s_waitcnt vmcnt(10)
  buffer_load_dwordx4 v[104:107], v218, s[32:35], 0 offen nt
  v_dot2_f32_bf16 v22, v117, v44, 0
  v_add_f32_dpp v21, v18, v18 row_ror:8 row_mask:0xf bank_mask:0xc
  v_add_f32_dpp v21, v20, v20 row_ror:8 row_mask:0xf bank_mask:0x3
  v_add_f32_dpp v20, v239, v239 row_half_mirror row_mask:0xf bank_mask:0x5
  v_dot2_f32_bf16 v23, v122, v45, 0
  v_add_f32_dpp v20, v21, v21 row_half_mirror row_mask:0xf bank_mask:0xa
  v_dot2_f32_bf16 v24, v120, v46, 0
  v_dot2_f32_bf16 v25, v123, v47, 0
  v_add_f32_dpp v20, v20, v20 quad_perm:[2,3,0,1] row_mask:0xf bank_mask:0xf
  v_cvt_f32_i32 v72, v72
  v_cvt_f32_i32 v73, v73
  v_add_f32_dpp v20, v20, v20 quad_perm:[1,0,3,2] row_mask:0xf bank_mask:0xf
  v_cndmask_b32_e64 v236, v236, v20, s[48:49]
  v_cvt_f32_i32 v74, v74
  v_cvt_f32_i32 v75, v75
  v_pk_mul_f32 v[20:21], v[72:73], v[22:23]
  v_pk_add_f32 v[18:19], v[22:23], v[24:25]
  v_pk_fma_f32 v[20:21], v[74:75], v[24:25], v[20:21]
  v_add_f32 v18, v18, v19
  v_add_f32 v20, v20, v21
  s_cmpk_gt_i32 s69, 0x29
  s_cbranch_scc1 L_p67_4
  s_cmpk_gt_i32 s69, 0x15
  s_cbranch_scc1 L_p67_3
  s_cmpk_gt_i32 s69, 0xffc5
  s_cbranch_scc1 L_p67_0
  s_waitcnt vmcnt(6)
L_p67_0:
  s_waitcnt vmcnt(7)
L_p67_3:
  s_waitcnt vmcnt(10)
L_p67_4:
  s_waitcnt vmcnt(11)
  buffer_load_dwordx4 v[108:111], v219, s[32:35], 0 offen nt
  s_waitcnt vmcnt(8)
  s_mov_b64 exec, 3
  s_add_u32 s44, s78, 0x03030303
  v_msad_u8 v9, s78, v36, 0
  v_msad_u8 v10, s44, v36, 0
  v_msad_u8 v9, s78, v37, v9
  v_msad_u8 v10, s44, v37, v10
  v_msad_u8 v9, s78, v38, v9
  v_msad_u8 v10, s44, v38, v10
  global_store_byte v7, v8, s[30:31]
  global_load_dwordx3 v[36:38], v233, s[30:31] sc1
  v_sub_u32 v9, v9, v10
  v_add_u32 v8, 1, v8
  v_readlane_b32 s66, v9, 0
  v_readlane_b32 s67, v9, 1
  s_add_u32 s78, s78, 0x01010101
  s_mov_b64 exec, -1
  s_lshl1_add_u32 s69, s91, s95
  s_add_u32 s95, s66, s67
  s_add_u32 s69, s69, s95
  v_dot2_f32_bf16 v22, v121, v40, 0
  v_add_f32_dpp v239, v18, v18 row_ror:8 row_mask:0xf bank_mask:0xc
  v_add_f32_dpp v239, v20, v20 row_ror:8 row_mask:0xf bank_mask:0x3
  v_dot2_f32_bf16 v23, v126, v41, 0
  v_dot2_f32_bf16 v24, v124, v42, 0
  v_dot2_f32_bf16 v25, v127, v43, 0
  v_cvt_f32_i32 v76, v76
  v_cvt_f32_i32 v77, v77
  v_cvt_f32_i32 v78, v78
  v_cvt_f32_i32 v79, v79
  v_pk_mul_f32 v[20:21], v[76:77], v[22:23]
  v_pk_add_f32 v[18:19], v[22:23], v[24:25]
  v_pk_fma_f32 v[20:21], v[78:79], v[24:25], v[20:21]
  v_add_f32 v18, v18, v19
  v_add_f32 v20, v20, v21
  s_cmpk_gt_i32 s69, 0x29
  s_cbranch_scc1 L_p68_4
  s_cmp_gt_i32 s69, L_order_end-L_order-16411
  s_cbranch_scc1 L_p68_1
  s_waitcnt vmcnt(5)
L_p68_1:
  s_waitcnt vmcnt(8)
L_p68_4:
  s_waitcnt vmcnt(9)
  buffer_load_dwordx4 v[64:67], v220, s[32:35], 0 offen nt
  v_dot2_f32_bf16 v22, v125, v56, 0
  v_add_f32_dpp v21, v18, v18 row_ror:8 row_mask:0xf bank_mask:0xc
  v_add_f32_dpp v21, v20, v20 row_ror:8 row_mask:0xf bank_mask:0x3
  v_add_f32_dpp v20, v239, v239 row_half_mirror row_mask:0xf bank_mask:0x5
  v_dot2_f32_bf16 v23, v130, v57, 0
  v_add_f32_dpp v20, v21, v21 row_half_mirror row_mask:0xf bank_mask:0xa
  v_dot2_f32_bf16 v24, v128, v58, 0
  v_dot2_f32_bf16 v25, v131, v59, 0
  v_add_f32_dpp v20, v20, v20 quad_perm:[2,3,0,1] row_mask:0xf bank_mask:0xf
  v_cvt_f32_i32 v80, v80
  v_cvt_f32_i32 v81, v81
  v_add_f32_dpp v20, v20, v20 quad_perm:[1,0,3,2] row_mask:0xf bank_mask:0xf
  v_cndmask_b32_e64 v236, v236, v20, s[50:51]
  v_cvt_f32_i32 v82, v82
  v_cvt_f32_i32 v83, v83
  v_pk_mul_f32 v[20:21], v[80:81], v[22:23]
  v_pk_add_f32 v[18:19], v[22:23], v[24:25]
  v_pk_fma_f32 v[20:21], v[82:83], v[24:25], v[20:21]
  v_add_f32 v18, v18, v19
  v_add_f32 v20, v20, v21
  s_cmpk_gt_i32 s69, 0x29
  s_cbranch_scc1 L_p69_4
  s_cmp_gt_i32 s69, L_order_end-L_order-16381
  s_cbranch_scc1 L_p69_2
  s_waitcnt vmcnt(6)
L_p69_2:
  s_waitcnt vmcnt(9)
L_p69_4:
  s_waitcnt vmcnt(10)
  buffer_load_dwordx4 v[68:71], v221, s[32:35], 0 offen nt
  v_dot2_f32_bf16 v22, v129, v52, 0
  v_add_f32_dpp v239, v18, v18 row_ror:8 row_mask:0xf bank_mask:0xc
  v_add_f32_dpp v239, v20, v20 row_ror:8 row_mask:0xf bank_mask:0x3
  v_dot2_f32_bf16 v23, v134, v53, 0
  v_dot2_f32_bf16 v24, v132, v54, 0
  v_dot2_f32_bf16 v25, v135, v55, 0
  v_cvt_f32_i32 v84, v84
  v_cvt_f32_i32 v85, v85
  v_cvt_f32_i32 v86, v86
  v_cvt_f32_i32 v87, v87
  v_pk_mul_f32 v[20:21], v[84:85], v[22:23]
  v_pk_add_f32 v[18:19], v[22:23], v[24:25]
  v_pk_fma_f32 v[20:21], v[86:87], v[24:25], v[20:21]
  v_add_f32 v18, v18, v19
  v_add_f32 v20, v20, v21
  s_cmpk_gt_i32 s69, 0x29
  s_cbranch_scc1 L_p70_4
  s_cmpk_gt_i32 s69, 0x15
  s_cbranch_scc1 L_p70_3
  s_cmpk_gt_i32 s69, 0xffc5
  s_cbranch_scc1 L_p70_0
  s_waitcnt vmcnt(6)
L_p70_0:
  s_waitcnt vmcnt(7)
L_p70_3:
  s_waitcnt vmcnt(10)
L_p70_4:
  s_waitcnt vmcnt(11)
  buffer_load_dwordx4 v[72:75], v222, s[32:35], 0 offen nt
  s_waitcnt vmcnt(8)
  s_mov_b64 exec, 3
  s_add_u32 s44, s78, 0x03030303
  v_msad_u8 v9, s78, v32, 0
  v_msad_u8 v10, s44, v32, 0
  v_msad_u8 v9, s78, v33, v9
  v_msad_u8 v10, s44, v33, v10
  v_msad_u8 v9, s78, v34, v9
  v_msad_u8 v10, s44, v34, v10
  global_store_byte v7, v8, s[30:31]
  global_load_dwordx3 v[32:34], v234, s[30:31] sc1
  v_sub_u32 v9, v9, v10
  v_add_u32 v8, 1, v8
  v_readlane_b32 s66, v9, 0
  v_readlane_b32 s67, v9, 1
  s_add_u32 s78, s78, 0x01010101
  s_mov_b64 exec, -1
  s_lshl1_add_u32 s69, s91, s95
  s_add_u32 s95, s66, s67
  s_add_u32 s69, s69, s95
  v_dot2_f32_bf16 v22, v133, v60, 0
  v_add_f32_dpp v21, v18, v18 row_ror:8 row_mask:0xf bank_mask:0xc
  v_add_f32_dpp v21, v20, v20 row_ror:8 row_mask:0xf bank_mask:0x3
  v_add_f32_dpp v20, v239, v239 row_half_mirror row_mask:0xf bank_mask:0x5
  v_dot2_f32_bf16 v23, v138, v61, 0
  v_add_f32_dpp v20, v21, v21 row_half_mirror row_mask:0xf bank_mask:0xa
  v_dot2_f32_bf16 v24, v136, v62, 0
  v_dot2_f32_bf16 v25, v139, v63, 0
  v_add_f32_dpp v20, v20, v20 quad_perm:[2,3,0,1] row_mask:0xf bank_mask:0xf
  v_cvt_f32_i32 v88, v88
  v_cvt_f32_i32 v89, v89
  v_add_f32_dpp v20, v20, v20 quad_perm:[1,0,3,2] row_mask:0xf bank_mask:0xf
  v_cndmask_b32_e64 v236, v236, v20, s[52:53]
  v_cvt_f32_i32 v90, v90
  v_cvt_f32_i32 v91, v91
  v_pk_mul_f32 v[20:21], v[88:89], v[22:23]
  v_pk_add_f32 v[18:19], v[22:23], v[24:25]
  v_pk_fma_f32 v[20:21], v[90:91], v[24:25], v[20:21]
  v_add_f32 v18, v18, v19
  v_add_f32 v20, v20, v21
  s_cmpk_gt_i32 s69, 0x29
  s_cbranch_scc1 L_p71_4
  s_cmp_gt_i32 s69, L_order_end-L_order-16411
  s_cbranch_scc1 L_p71_1
  s_waitcnt vmcnt(5)
L_p71_1:
  s_waitcnt vmcnt(8)
L_p71_4:
  s_waitcnt vmcnt(9)
  buffer_load_dwordx4 v[76:79], v223, s[32:35], 0 offen nt
  v_dot2_f32_bf16 v22, v137, v56, 0
  v_add_f32_dpp v239, v18, v18 row_ror:8 row_mask:0xf bank_mask:0xc
  v_add_f32_dpp v239, v20, v20 row_ror:8 row_mask:0xf bank_mask:0x3
  v_dot2_f32_bf16 v23, v142, v57, 0
  v_dot2_f32_bf16 v24, v140, v58, 0
  v_dot2_f32_bf16 v25, v143, v59, 0
  v_cvt_f32_i32 v92, v92
  v_cvt_f32_i32 v93, v93
  v_cvt_f32_i32 v94, v94
  v_cvt_f32_i32 v95, v95
  v_pk_mul_f32 v[20:21], v[92:93], v[22:23]
  v_pk_add_f32 v[18:19], v[22:23], v[24:25]
  v_pk_fma_f32 v[20:21], v[94:95], v[24:25], v[20:21]
  v_add_f32 v18, v18, v19
  v_add_f32 v20, v20, v21
  s_cmpk_gt_i32 s69, 0x29
  s_cbranch_scc1 L_p72_4
  s_cmp_gt_i32 s69, L_order_end-L_order-16381
  s_cbranch_scc1 L_p72_2
  s_waitcnt vmcnt(6)
L_p72_2:
  s_waitcnt vmcnt(9)
L_p72_4:
  s_waitcnt vmcnt(10)
  buffer_load_dwordx4 v[80:83], v224, s[32:35], 0 offen nt
  v_dot2_f32_bf16 v22, v141, v44, 0
  v_add_f32_dpp v21, v18, v18 row_ror:8 row_mask:0xf bank_mask:0xc
  v_add_f32_dpp v21, v20, v20 row_ror:8 row_mask:0xf bank_mask:0x3
  v_add_f32_dpp v20, v239, v239 row_half_mirror row_mask:0xf bank_mask:0x5
  v_dot2_f32_bf16 v23, v146, v45, 0
  v_add_f32_dpp v20, v21, v21 row_half_mirror row_mask:0xf bank_mask:0xa
  v_dot2_f32_bf16 v24, v144, v46, 0
  v_dot2_f32_bf16 v25, v147, v47, 0
  v_add_f32_dpp v20, v20, v20 quad_perm:[2,3,0,1] row_mask:0xf bank_mask:0xf
  v_cvt_f32_i32 v96, v96
  v_cvt_f32_i32 v97, v97
  v_add_f32_dpp v20, v20, v20 quad_perm:[1,0,3,2] row_mask:0xf bank_mask:0xf
  v_cndmask_b32_e64 v236, v236, v20, s[54:55]
  v_add_u32_e64 v2, s101, v15
  ds_write_b32 v2, v236
  v_cvt_f32_i32 v98, v98
  v_cvt_f32_i32 v99, v99
  v_pk_mul_f32 v[20:21], v[96:97], v[22:23]
  v_pk_add_f32 v[18:19], v[22:23], v[24:25]
  v_pk_fma_f32 v[20:21], v[98:99], v[24:25], v[20:21]
  v_add_f32 v18, v18, v19
  v_add_f32 v20, v20, v21
  s_cmpk_gt_i32 s69, 0x29
  s_cbranch_scc1 L_p73_4
  s_cmpk_gt_i32 s69, 0x15
  s_cbranch_scc1 L_p73_3
  s_cmpk_gt_i32 s69, 0xffc5
  s_cbranch_scc1 L_p73_0
  s_waitcnt vmcnt(6)
L_p73_0:
  s_waitcnt vmcnt(7)
L_p73_3:
  s_waitcnt vmcnt(10)
L_p73_4:
  s_waitcnt vmcnt(11)
  buffer_load_dwordx4 v[84:87], v225, s[32:35], 0 offen nt
  s_waitcnt vmcnt(8)
  s_mov_b64 exec, 3
  s_add_u32 s44, s78, 0x03030303
  v_msad_u8 v9, s78, v36, 0
  v_msad_u8 v10, s44, v36, 0
  v_msad_u8 v9, s78, v37, v9
  v_msad_u8 v10, s44, v37, v10
  v_msad_u8 v9, s78, v38, v9
  v_msad_u8 v10, s44, v38, v10
  global_store_byte v7, v8, s[30:31]
  global_load_dwordx3 v[36:38], v235, s[30:31] sc1
  v_sub_u32 v9, v9, v10
  v_add_u32 v8, 1, v8
  v_readlane_b32 s66, v9, 0
  v_readlane_b32 s67, v9, 1
  s_add_u32 s78, s78, 0x01010101
  s_mov_b64 exec, -1
  s_lshl1_add_u32 s69, s91, s95
  s_add_u32 s95, s66, s67
  s_add_u32 s69, s69, s95
  v_dot2_f32_bf16 v22, v145, v40, 0
  v_add_f32_dpp v239, v18, v18 row_ror:8 row_mask:0xf bank_mask:0xc
  v_add_f32_dpp v239, v20, v20 row_ror:8 row_mask:0xf bank_mask:0x3
  v_dot2_f32_bf16 v23, v150, v41, 0
  v_dot2_f32_bf16 v24, v148, v42, 0
  v_dot2_f32_bf16 v25, v151, v43, 0
  v_cvt_f32_i32 v100, v100
  v_cvt_f32_i32 v101, v101
  v_cvt_f32_i32 v102, v102
  v_cvt_f32_i32 v103, v103
  v_pk_mul_f32 v[20:21], v[100:101], v[22:23]
  v_pk_add_f32 v[18:19], v[22:23], v[24:25]
  v_pk_fma_f32 v[20:21], v[102:103], v[24:25], v[20:21]
  v_add_f32 v18, v18, v19
  v_add_f32 v20, v20, v21
  s_cmpk_gt_i32 s69, 0x29
  s_cbranch_scc1 L_p74_4
  s_cmp_gt_i32 s69, L_order_end-L_order-16411
  s_cbranch_scc1 L_p74_1
  s_waitcnt vmcnt(5)
L_p74_1:
  s_waitcnt vmcnt(8)
L_p74_4:
  s_waitcnt vmcnt(9)
  buffer_load_dwordx4 v[88:91], v226, s[32:35], 0 offen nt
  v_dot2_f32_bf16 v22, v149, v48, 0
  v_add_f32_dpp v21, v18, v18 row_ror:8 row_mask:0xf bank_mask:0xc
  v_add_f32_dpp v21, v20, v20 row_ror:8 row_mask:0xf bank_mask:0x3
  v_add_f32_dpp v20, v239, v239 row_half_mirror row_mask:0xf bank_mask:0x5
  v_dot2_f32_bf16 v23, v154, v49, 0
  v_add_f32_dpp v20, v21, v21 row_half_mirror row_mask:0xf bank_mask:0xa
  v_dot2_f32_bf16 v24, v152, v50, 0
  v_dot2_f32_bf16 v25, v155, v51, 0
  v_add_f32_dpp v20, v20, v20 quad_perm:[2,3,0,1] row_mask:0xf bank_mask:0xf
  v_cvt_f32_i32 v104, v104
  v_cvt_f32_i32 v105, v105
  v_add_f32_dpp v20, v20, v20 quad_perm:[1,0,3,2] row_mask:0xf bank_mask:0xf
  v_cndmask_b32_e64 v236, v236, v20, s[48:49]
  v_cvt_f32_i32 v106, v106
  v_cvt_f32_i32 v107, v107
  v_pk_mul_f32 v[20:21], v[104:105], v[22:23]
  v_pk_add_f32 v[18:19], v[22:23], v[24:25]
  v_pk_fma_f32 v[20:21], v[106:107], v[24:25], v[20:21]
  v_add_f32 v18, v18, v19
  v_add_f32 v20, v20, v21
  s_cmpk_gt_i32 s69, 0x29
  s_cbranch_scc1 L_p75_4
  s_cmp_gt_i32 s69, L_order_end-L_order-16381
  s_cbranch_scc1 L_p75_2
  s_waitcnt vmcnt(6)
L_p75_2:
  s_waitcnt vmcnt(9)
L_p75_4:
  s_waitcnt vmcnt(10)
  buffer_load_dwordx4 v[92:95], v227, s[32:35], 0 offen nt
  v_dot2_f32_bf16 v22, v153, v44, 0
  v_add_f32_dpp v239, v18, v18 row_ror:8 row_mask:0xf bank_mask:0xc
  v_add_f32_dpp v239, v20, v20 row_ror:8 row_mask:0xf bank_mask:0x3
  v_dot2_f32_bf16 v23, v158, v45, 0
  v_dot2_f32_bf16 v24, v156, v46, 0
  v_dot2_f32_bf16 v25, v159, v47, 0
  v_cvt_f32_i32 v108, v108
  v_cvt_f32_i32 v109, v109
  v_cvt_f32_i32 v110, v110
  v_cvt_f32_i32 v111, v111
  v_pk_mul_f32 v[20:21], v[108:109], v[22:23]
  v_pk_add_f32 v[18:19], v[22:23], v[24:25]
  v_pk_fma_f32 v[20:21], v[110:111], v[24:25], v[20:21]
  v_add_f32 v18, v18, v19
  v_add_f32 v20, v20, v21
  s_cmpk_gt_i32 s69, 0x29
  s_cbranch_scc1 L_p76_4
  s_cmpk_gt_i32 s69, 0x15
  s_cbranch_scc1 L_p76_3
  s_cmpk_gt_i32 s69, 0xffc5
  s_cbranch_scc1 L_p76_0
  s_waitcnt vmcnt(6)
L_p76_0:
  s_waitcnt vmcnt(7)
L_p76_3:
  s_waitcnt vmcnt(10)
L_p76_4:
  s_waitcnt vmcnt(11)
  buffer_load_dwordx4 v[96:99], v228, s[32:35], 0 offen nt
  s_waitcnt vmcnt(8)
  s_mov_b64 exec, 3
  s_add_u32 s44, s78, 0x03030303
  v_msad_u8 v9, s78, v32, 0
  v_msad_u8 v10, s44, v32, 0
  v_msad_u8 v9, s78, v33, v9
  v_msad_u8 v10, s44, v33, v10
  v_msad_u8 v9, s78, v34, v9
  v_msad_u8 v10, s44, v34, v10
  global_store_byte v7, v8, s[30:31]
  global_load_dwordx3 v[32:34], v232, s[30:31] sc1
  v_sub_u32 v9, v9, v10
  v_add_u32 v8, 1, v8
  v_readlane_b32 s66, v9, 0
  v_readlane_b32 s67, v9, 1
  s_add_u32 s78, s78, 0x01010101
  s_mov_b64 exec, -1
  s_lshl1_add_u32 s69, s91, s95
  s_add_u32 s95, s66, s67
  s_add_u32 s69, s69, s95
  v_dot2_f32_bf16 v22, v157, v60, 0
  v_add_f32_dpp v21, v18, v18 row_ror:8 row_mask:0xf bank_mask:0xc
  v_add_f32_dpp v21, v20, v20 row_ror:8 row_mask:0xf bank_mask:0x3
  v_add_f32_dpp v20, v239, v239 row_half_mirror row_mask:0xf bank_mask:0x5
  v_dot2_f32_bf16 v23, v162, v61, 0
  v_add_f32_dpp v20, v21, v21 row_half_mirror row_mask:0xf bank_mask:0xa
  v_dot2_f32_bf16 v24, v160, v62, 0
  v_dot2_f32_bf16 v25, v163, v63, 0
  v_add_f32_dpp v20, v20, v20 quad_perm:[2,3,0,1] row_mask:0xf bank_mask:0xf
  v_cvt_f32_i32 v64, v64
  v_cvt_f32_i32 v65, v65
  v_add_f32_dpp v20, v20, v20 quad_perm:[1,0,3,2] row_mask:0xf bank_mask:0xf
  v_cndmask_b32_e64 v236, v236, v20, s[50:51]
  v_cvt_f32_i32 v66, v66
  v_cvt_f32_i32 v67, v67
  v_pk_mul_f32 v[20:21], v[64:65], v[22:23]
  v_pk_add_f32 v[18:19], v[22:23], v[24:25]
  v_pk_fma_f32 v[20:21], v[66:67], v[24:25], v[20:21]
  v_add_f32 v18, v18, v19
  v_add_f32 v20, v20, v21
  s_cmpk_gt_i32 s69, 0x29
  s_cbranch_scc1 L_p77_4
  s_cmp_gt_i32 s69, L_order_end-L_order-16411
  s_cbranch_scc1 L_p77_1
  s_waitcnt vmcnt(5)
L_p77_1:
  s_waitcnt vmcnt(8)
L_p77_4:
  s_waitcnt vmcnt(9)
  buffer_load_dwordx4 v[100:103], v229, s[32:35], 0 offen nt
  v_dot2_f32_bf16 v22, v161, v56, 0
  v_add_f32_dpp v239, v18, v18 row_ror:8 row_mask:0xf bank_mask:0xc
  v_add_f32_dpp v239, v20, v20 row_ror:8 row_mask:0xf bank_mask:0x3
  v_dot2_f32_bf16 v23, v166, v57, 0
  v_dot2_f32_bf16 v24, v164, v58, 0
  v_dot2_f32_bf16 v25, v167, v59, 0
  v_cvt_f32_i32 v68, v68
  v_cvt_f32_i32 v69, v69
  v_cvt_f32_i32 v70, v70
  v_cvt_f32_i32 v71, v71
  v_pk_mul_f32 v[20:21], v[68:69], v[22:23]
  v_pk_add_f32 v[18:19], v[22:23], v[24:25]
  v_pk_fma_f32 v[20:21], v[70:71], v[24:25], v[20:21]
  v_add_f32 v18, v18, v19
  v_add_f32 v20, v20, v21
  s_cmpk_gt_i32 s69, 0x29
  s_cbranch_scc1 L_p78_4
  s_cmp_gt_i32 s69, L_order_end-L_order-16381
  s_cbranch_scc1 L_p78_2
  s_waitcnt vmcnt(6)
L_p78_2:
  s_waitcnt vmcnt(9)
L_p78_4:
  s_waitcnt vmcnt(10)
  buffer_load_dwordx4 v[104:107], v230, s[32:35], 0 offen nt
  v_dot2_f32_bf16 v22, v165, v52, 0
  v_add_f32_dpp v21, v18, v18 row_ror:8 row_mask:0xf bank_mask:0xc
  v_add_f32_dpp v21, v20, v20 row_ror:8 row_mask:0xf bank_mask:0x3
  v_add_f32_dpp v20, v239, v239 row_half_mirror row_mask:0xf bank_mask:0x5
  v_dot2_f32_bf16 v23, v170, v53, 0
  v_add_f32_dpp v20, v21, v21 row_half_mirror row_mask:0xf bank_mask:0xa
  v_dot2_f32_bf16 v24, v168, v54, 0
  v_dot2_f32_bf16 v25, v171, v55, 0
  v_add_f32_dpp v20, v20, v20 quad_perm:[2,3,0,1] row_mask:0xf bank_mask:0xf
  v_cvt_f32_i32 v72, v72
  v_cvt_f32_i32 v73, v73
  v_add_f32_dpp v20, v20, v20 quad_perm:[1,0,3,2] row_mask:0xf bank_mask:0xf
  v_cndmask_b32_e64 v236, v236, v20, s[52:53]
  v_cvt_f32_i32 v74, v74
  v_cvt_f32_i32 v75, v75
  v_pk_mul_f32 v[20:21], v[72:73], v[22:23]
  v_pk_add_f32 v[18:19], v[22:23], v[24:25]
  v_pk_fma_f32 v[20:21], v[74:75], v[24:25], v[20:21]
  v_add_f32 v18, v18, v19
  v_add_f32 v20, v20, v21
  s_cmpk_gt_i32 s69, 0x29
  s_cbranch_scc1 L_p79_4
  s_cmpk_gt_i32 s69, 0x15
  s_cbranch_scc1 L_p79_3
  s_cmpk_gt_i32 s69, 0xffc5
  s_cbranch_scc1 L_p79_0
  s_waitcnt vmcnt(6)
L_p79_0:
  s_waitcnt vmcnt(7)
L_p79_3:
  s_waitcnt vmcnt(10)
L_p79_4:
  s_waitcnt vmcnt(11)
  buffer_load_dwordx4 v[108:111], v231, s[32:35], 0 offen nt
  s_waitcnt vmcnt(8)
  s_mov_b64 exec, 3
  s_add_u32 s44, s78, 0x03030303
  v_msad_u8 v9, s78, v36, 0
  v_msad_u8 v10, s44, v36, 0
  v_msad_u8 v9, s78, v37, v9
  v_msad_u8 v10, s44, v37, v10
  v_msad_u8 v9, s78, v38, v9
  v_msad_u8 v10, s44, v38, v10
  global_load_dwordx2 v[26:27], v11, s[30:31] sc1
  global_store_byte v7, v8, s[30:31]
  global_load_dwordx3 v[36:38], v233, s[30:31] sc1
  v_sub_u32 v9, v9, v10
  v_add_u32 v8, 1, v8
  v_readlane_b32 s66, v9, 0
  v_readlane_b32 s67, v9, 1
  s_add_u32 s78, s78, 0x01010101
  s_mov_b64 exec, -1
  s_lshl1_add_u32 s69, s91, s95
  s_add_u32 s95, s66, s67
  s_add_u32 s69, s69, s95
  v_dot2_f32_bf16 v22, v169, v60, 0
  v_add_f32_dpp v239, v18, v18 row_ror:8 row_mask:0xf bank_mask:0xc
  v_add_f32_dpp v239, v20, v20 row_ror:8 row_mask:0xf bank_mask:0x3
  v_dot2_f32_bf16 v23, v174, v61, 0
  v_dot2_f32_bf16 v24, v172, v62, 0
  v_dot2_f32_bf16 v25, v175, v63, 0
  v_cvt_f32_i32 v76, v76
  v_cvt_f32_i32 v77, v77
  v_cvt_f32_i32 v78, v78
  v_cvt_f32_i32 v79, v79
  v_pk_mul_f32 v[20:21], v[76:77], v[22:23]
  v_pk_add_f32 v[18:19], v[22:23], v[24:25]
  v_pk_fma_f32 v[20:21], v[78:79], v[24:25], v[20:21]
  v_add_f32 v18, v18, v19
  v_add_f32 v20, v20, v21
  s_cmpk_gt_i32 s69, 0x29
  s_cbranch_scc1 L_p80_4
  s_cmp_gt_i32 s69, L_order_end-L_order-16411
  s_cbranch_scc1 L_p80_1
  s_waitcnt vmcnt(6)
L_p80_1:
  s_waitcnt vmcnt(9)
L_p80_4:
  s_waitcnt vmcnt(10)
  buffer_load_dwordx4 v[64:67], v208, s[36:39], 0 offen nt
  v_dot2_f32_bf16 v22, v173, v48, 0
  v_add_f32_dpp v21, v18, v18 row_ror:8 row_mask:0xf bank_mask:0xc
  v_add_f32_dpp v21, v20, v20 row_ror:8 row_mask:0xf bank_mask:0x3
  v_add_f32_dpp v20, v239, v239 row_half_mirror row_mask:0xf bank_mask:0x5
  v_dot2_f32_bf16 v23, v178, v49, 0
  v_add_f32_dpp v20, v21, v21 row_half_mirror row_mask:0xf bank_mask:0xa
  v_dot2_f32_bf16 v24, v176, v50, 0
  v_dot2_f32_bf16 v25, v179, v51, 0
  v_add_f32_dpp v20, v20, v20 quad_perm:[2,3,0,1] row_mask:0xf bank_mask:0xf
  v_cvt_f32_i32 v80, v80
  v_cvt_f32_i32 v81, v81
  v_add_f32_dpp v20, v20, v20 quad_perm:[1,0,3,2] row_mask:0xf bank_mask:0xf
  v_cndmask_b32_e64 v236, v236, v20, s[54:55]
  v_add_u32_e64 v2, s101, v16
  ds_write_b32 v2, v236
  v_cvt_f32_i32 v82, v82
  v_cvt_f32_i32 v83, v83
  v_pk_mul_f32 v[20:21], v[80:81], v[22:23]
  v_pk_add_f32 v[18:19], v[22:23], v[24:25]
  v_pk_fma_f32 v[20:21], v[82:83], v[24:25], v[20:21]
  v_add_f32 v18, v18, v19
  v_add_f32 v20, v20, v21
  s_cmpk_gt_i32 s69, 0x29
  s_cbranch_scc1 L_p81_4
  s_cmp_gt_i32 s69, L_order_end-L_order-16381
  s_cbranch_scc1 L_p81_2
  s_waitcnt vmcnt(7)
L_p81_2:
  s_waitcnt vmcnt(10)
L_p81_4:
  s_waitcnt vmcnt(11)
  buffer_load_dwordx4 v[68:71], v209, s[36:39], 0 offen nt
  v_dot2_f32_bf16 v22, v177, v44, 0
  v_add_f32_dpp v239, v18, v18 row_ror:8 row_mask:0xf bank_mask:0xc
  v_add_f32_dpp v239, v20, v20 row_ror:8 row_mask:0xf bank_mask:0x3
  v_dot2_f32_bf16 v23, v182, v45, 0
  v_dot2_f32_bf16 v24, v180, v46, 0
  v_dot2_f32_bf16 v25, v183, v47, 0
  v_cvt_f32_i32 v84, v84
  v_cvt_f32_i32 v85, v85
  v_cvt_f32_i32 v86, v86
  v_cvt_f32_i32 v87, v87
  v_pk_mul_f32 v[20:21], v[84:85], v[22:23]
  v_pk_add_f32 v[18:19], v[22:23], v[24:25]
  v_pk_fma_f32 v[20:21], v[86:87], v[24:25], v[20:21]
  v_add_f32 v18, v18, v19
  v_add_f32 v20, v20, v21
  s_cmpk_gt_i32 s69, 0x29
  s_cbranch_scc1 L_p82_4
  s_cmpk_gt_i32 s69, 0x15
  s_cbranch_scc1 L_p82_3
  s_cmpk_gt_i32 s69, 0xffc5
  s_cbranch_scc1 L_p82_0
  s_waitcnt vmcnt(7)
L_p82_0:
  s_waitcnt vmcnt(8)
L_p82_3:
  s_waitcnt vmcnt(11)
L_p82_4:
  s_waitcnt vmcnt(12)
  buffer_load_dwordx4 v[72:75], v210, s[36:39], 0 offen nt
  ds_read_b32 v4, v14 offset:16
  s_waitcnt vmcnt(9)
  s_mov_b64 exec, 3
  s_add_u32 s44, s78, 0x03030303
  v_msad_u8 v9, s78, v32, 0
  v_msad_u8 v10, s44, v32, 0
  v_msad_u8 v9, s78, v33, v9
  v_msad_u8 v10, s44, v33, v10
  v_msad_u8 v9, s78, v34, v9
  v_msad_u8 v10, s44, v34, v10
  global_store_byte v7, v8, s[30:31]
  global_load_dwordx3 v[32:34], v234, s[30:31] sc1
  v_sub_u32 v9, v9, v10
  v_add_u32 v8, 1, v8
  v_readlane_b32 s66, v9, 0
  v_readlane_b32 s67, v9, 1
  s_add_u32 s78, s78, 0x01010101
  s_mov_b64 exec, -1
  s_lshl1_add_u32 s69, s91, s95
  s_add_u32 s95, s66, s67
  s_add_u32 s69, s69, s95
  v_dot2_f32_bf16 v22, v181, v40, 0
  v_add_f32_dpp v21, v18, v18 row_ror:8 row_mask:0xf bank_mask:0xc
  v_add_f32_dpp v21, v20, v20 row_ror:8 row_mask:0xf bank_mask:0x3
  v_add_f32_dpp v20, v239, v239 row_half_mirror row_mask:0xf bank_mask:0x5
  v_dot2_f32_bf16 v23, v186, v41, 0
  v_add_f32_dpp v20, v21, v21 row_half_mirror row_mask:0xf bank_mask:0xa
  v_dot2_f32_bf16 v24, v184, v42, 0
  v_dot2_f32_bf16 v25, v187, v43, 0
  v_add_f32_dpp v20, v20, v20 quad_perm:[2,3,0,1] row_mask:0xf bank_mask:0xf
  v_cvt_f32_i32 v88, v88
  v_cvt_f32_i32 v89, v89
  v_add_f32_dpp v20, v20, v20 quad_perm:[1,0,3,2] row_mask:0xf bank_mask:0xf
  v_cndmask_b32_e64 v236, v236, v20, s[48:49]
  v_cvt_f32_i32 v90, v90
  v_cvt_f32_i32 v91, v91
  v_pk_mul_f32 v[20:21], v[88:89], v[22:23]
  v_pk_add_f32 v[18:19], v[22:23], v[24:25]
  v_pk_fma_f32 v[20:21], v[90:91], v[24:25], v[20:21]
  v_add_f32 v18, v18, v19
  v_add_f32 v20, v20, v21
  s_cmpk_gt_i32 s69, 0x29
  s_cbranch_scc1 L_p83_4
  s_cmp_gt_i32 s69, L_order_end-L_order-16411
  s_cbranch_scc1 L_p83_1
  s_waitcnt vmcnt(5)
L_p83_1:
  s_waitcnt vmcnt(9)
L_p83_4:
  s_waitcnt vmcnt(10)
  buffer_load_dwordx4 v[76:79], v211, s[36:39], 0 offen nt
  v_dot2_f32_bf16 v22, v185, v48, 0
  v_add_f32_dpp v239, v18, v18 row_ror:8 row_mask:0xf bank_mask:0xc
  v_add_f32_dpp v239, v20, v20 row_ror:8 row_mask:0xf bank_mask:0x3
  v_dot2_f32_bf16 v23, v190, v49, 0
  v_dot2_f32_bf16 v24, v188, v50, 0
  v_dot2_f32_bf16 v25, v191, v51, 0
  v_cvt_f32_i32 v92, v92
  v_cvt_f32_i32 v93, v93
  v_cvt_f32_i32 v94, v94
  v_cvt_f32_i32 v95, v95
  v_pk_mul_f32 v[20:21], v[92:93], v[22:23]
  v_pk_add_f32 v[18:19], v[22:23], v[24:25]
  v_pk_fma_f32 v[20:21], v[94:95], v[24:25], v[20:21]
  v_add_f32 v18, v18, v19
  v_add_f32 v20, v20, v21
  s_cmpk_gt_i32 s69, 0x29
  s_cbranch_scc1 L_p84_4
  s_cmp_gt_i32 s69, L_order_end-L_order-16381
  s_cbranch_scc1 L_p84_2
  s_waitcnt vmcnt(6)
L_p84_2:
  s_waitcnt vmcnt(10)
L_p84_4:
  s_waitcnt vmcnt(11)
  buffer_load_dwordx4 v[80:83], v212, s[36:39], 0 offen nt
  v_dot2_f32_bf16 v22, v189, v52, 0
  v_add_f32_dpp v21, v18, v18 row_ror:8 row_mask:0xf bank_mask:0xc
  v_add_f32_dpp v21, v20, v20 row_ror:8 row_mask:0xf bank_mask:0x3
  v_add_f32_dpp v20, v239, v239 row_half_mirror row_mask:0xf bank_mask:0x5
  v_dot2_f32_bf16 v23, v194, v53, 0
  v_add_f32_dpp v20, v21, v21 row_half_mirror row_mask:0xf bank_mask:0xa
  v_dot2_f32_bf16 v24, v192, v54, 0
  v_dot2_f32_bf16 v25, v195, v55, 0
  v_add_f32_dpp v20, v20, v20 quad_perm:[2,3,0,1] row_mask:0xf bank_mask:0xf
  v_cvt_f32_i32 v96, v96
  v_cvt_f32_i32 v97, v97
  v_add_f32_dpp v20, v20, v20 quad_perm:[1,0,3,2] row_mask:0xf bank_mask:0xf
  v_cndmask_b32_e64 v236, v236, v20, s[50:51]
  v_cvt_f32_i32 v98, v98
  v_cvt_f32_i32 v99, v99
  v_pk_mul_f32 v[20:21], v[96:97], v[22:23]
  v_pk_add_f32 v[18:19], v[22:23], v[24:25]
  v_pk_fma_f32 v[20:21], v[98:99], v[24:25], v[20:21]
  v_add_f32 v18, v18, v19
  v_add_f32 v20, v20, v21
  s_cmpk_gt_i32 s69, 0x29
  s_cbranch_scc1 L_p85_4
  s_cmpk_gt_i32 s69, 0x15
  s_cbranch_scc1 L_p85_3
  s_cmpk_gt_i32 s69, 0xffc5
  s_cbranch_scc1 L_p85_0
  s_waitcnt vmcnt(6)
L_p85_0:
  s_waitcnt vmcnt(7)
L_p85_3:
  s_waitcnt vmcnt(11)
L_p85_4:
  s_waitcnt vmcnt(12)
  buffer_load_dwordx4 v[84:87], v213, s[36:39], 0 offen nt
L_qn:
  s_waitcnt lgkmcnt(0)
  v_readfirstlane_b32 s46, v4
  s_cmp_ge_u32 s46, s47
  s_cbranch_scc1 L_qn_ok
  s_cmp_eq_u32 s94, 0
  s_cbranch_scc1 L_qn_ok
  s_sub_u32 s94, s94, 1
  ds_read_b32 v4, v14 offset:16
  s_branch L_qn
L_qn_ok:
  v_add_u32_e64 v10, s59, v248
  ds_read_b128 v[40:43], v10 offset:512
  v_add_u32_e64 v10, s59, v249
  ds_read_b128 v[44:47], v10 offset:512
  v_add_u32_e64 v10, s59, v250
  ds_read_b128 v[48:51], v10 offset:512
  s_waitcnt vmcnt(8)
  s_mov_b64 exec, 3
  s_add_u32 s44, s78, 0x03030303
  v_msad_u8 v9, s78, v36, 0
  v_msad_u8 v10, s44, v36, 0
  v_msad_u8 v9, s78, v37, v9
  v_msad_u8 v10, s44, v37, v10
  v_msad_u8 v9, s78, v38, v9
  v_msad_u8 v10, s44, v38, v10
  global_store_byte v7, v8, s[30:31]
  global_load_dwordx3 v[36:38], v235, s[30:31] sc1
  v_sub_u32 v9, v9, v10
  v_add_u32 v8, 1, v8
  v_add3_u32 v10, v26, v27, s58
  v_readlane_b32 s66, v9, 0
  v_readlane_b32 s67, v9, 1
  v_readlane_b32 s91, v10, 0
  s_add_u32 s78, s78, 0x01010101
  s_mov_b64 exec, -1
  s_lshl1_add_u32 s69, s91, s95
  s_add_u32 s95, s66, s67
  s_add_u32 s69, s69, s95
  v_dot2_f32_bf16 v22, v193, v60, 0
  v_add_f32_dpp v239, v18, v18 row_ror:8 row_mask:0xf bank_mask:0xc
  v_add_f32_dpp v239, v20, v20 row_ror:8 row_mask:0xf bank_mask:0x3
  v_dot2_f32_bf16 v23, v198, v61, 0
  v_dot2_f32_bf16 v24, v196, v62, 0
  v_dot2_f32_bf16 v25, v199, v63, 0
  v_cvt_f32_i32 v100, v100
  v_cvt_f32_i32 v101, v101
  v_cvt_f32_i32 v102, v102
  v_cvt_f32_i32 v103, v103
  v_add_u32_e64 v10, s59, v253
  ds_read_b128 v[60:63], v10 offset:512
  v_pk_mul_f32 v[20:21], v[100:101], v[22:23]
  v_pk_add_f32 v[18:19], v[22:23], v[24:25]
  v_pk_fma_f32 v[20:21], v[102:103], v[24:25], v[20:21]
  v_add_f32 v18, v18, v19
  v_add_f32 v20, v20, v21
  s_cmpk_gt_i32 s69, 0x29
  s_cbranch_scc1 L_p86_4
  s_cmp_gt_i32 s69, L_order_end-L_order-16411
  s_cbranch_scc1 L_p86_1
  s_waitcnt vmcnt(5)
L_p86_1:
  s_waitcnt vmcnt(8)
L_p86_4:
  s_waitcnt vmcnt(9)
  buffer_load_dwordx4 v[88:91], v214, s[36:39], 0 offen nt
  v_dot2_f32_bf16 v22, v197, v56, 0
  v_add_f32_dpp v21, v18, v18 row_ror:8 row_mask:0xf bank_mask:0xc
  v_add_f32_dpp v21, v20, v20 row_ror:8 row_mask:0xf bank_mask:0x3
  v_add_f32_dpp v20, v239, v239 row_half_mirror row_mask:0xf bank_mask:0x5
  v_dot2_f32_bf16 v23, v202, v57, 0
  v_add_f32_dpp v20, v21, v21 row_half_mirror row_mask:0xf bank_mask:0xa
  v_dot2_f32_bf16 v24, v200, v58, 0
  v_dot2_f32_bf16 v25, v203, v59, 0
  v_add_f32_dpp v20, v20, v20 quad_perm:[2,3,0,1] row_mask:0xf bank_mask:0xf
  v_cvt_f32_i32 v104, v104
  v_cvt_f32_i32 v105, v105
  v_add_f32_dpp v20, v20, v20 quad_perm:[1,0,3,2] row_mask:0xf bank_mask:0xf
  v_cndmask_b32_e64 v236, v236, v20, s[52:53]
  v_cvt_f32_i32 v106, v106
  v_cvt_f32_i32 v107, v107
  v_add_u32_e64 v10, s59, v252
  ds_read_b128 v[56:59], v10 offset:512
  v_pk_mul_f32 v[20:21], v[104:105], v[22:23]
  v_pk_add_f32 v[18:19], v[22:23], v[24:25]
  v_pk_fma_f32 v[20:21], v[106:107], v[24:25], v[20:21]
  v_add_f32 v18, v18, v19
  v_add_f32 v20, v20, v21
  s_cmpk_gt_i32 s69, 0x29
  s_cbranch_scc1 L_p87_4
  s_cmp_gt_i32 s69, L_order_end-L_order-16381
  s_cbranch_scc1 L_p87_2
  s_waitcnt vmcnt(6)
L_p87_2:
  s_waitcnt vmcnt(9)
L_p87_4:
  s_waitcnt vmcnt(10)
  buffer_load_dwordx4 v[92:95], v215, s[36:39], 0 offen nt
  v_dot2_f32_bf16 v22, v201, v52, 0
  v_add_f32_dpp v239, v18, v18 row_ror:8 row_mask:0xf bank_mask:0xc
  v_add_f32_dpp v239, v20, v20 row_ror:8 row_mask:0xf bank_mask:0x3
  v_dot2_f32_bf16 v23, v206, v53, 0
  v_dot2_f32_bf16 v24, v204, v54, 0
  v_dot2_f32_bf16 v25, v207, v55, 0
  v_cvt_f32_i32 v108, v108
  v_cvt_f32_i32 v109, v109
  v_cvt_f32_i32 v110, v110
  v_cvt_f32_i32 v111, v111
  v_add_u32_e64 v10, s59, v251
  ds_read_b128 v[52:55], v10 offset:512
  v_pk_mul_f32 v[20:21], v[108:109], v[22:23]
  v_pk_add_f32 v[18:19], v[22:23], v[24:25]
  v_pk_fma_f32 v[20:21], v[110:111], v[24:25], v[20:21]
  v_add_f32 v18, v18, v19
  v_add_f32 v20, v20, v21
  s_cmpk_gt_i32 s69, 0x29
  s_cbranch_scc1 L_p88_4
  s_cmpk_gt_i32 s69, 0x15
  s_cbranch_scc1 L_p88_3
  s_cmpk_gt_i32 s69, 0xffc5
  s_cbranch_scc1 L_p88_0
  s_waitcnt vmcnt(6)
L_p88_0:
  s_waitcnt vmcnt(7)
L_p88_3:
  s_waitcnt vmcnt(10)
L_p88_4:
  s_waitcnt vmcnt(11)
  buffer_load_dwordx4 v[96:99], v216, s[36:39], 0 offen nt
  s_nop 0
  v_add_f32_dpp v21, v18, v18 row_ror:8 row_mask:0xf bank_mask:0xc
  v_add_f32_dpp v21, v20, v20 row_ror:8 row_mask:0xf bank_mask:0x3
  v_add_f32_dpp v20, v239, v239 row_half_mirror row_mask:0xf bank_mask:0x5
  s_nop 0
  v_add_f32_dpp v20, v21, v21 row_half_mirror row_mask:0xf bank_mask:0xa
  s_nop 1
  v_add_f32_dpp v20, v20, v20 quad_perm:[2,3,0,1] row_mask:0xf bank_mask:0xf
  s_nop 1
  v_add_f32_dpp v20, v20, v20 quad_perm:[1,0,3,2] row_mask:0xf bank_mask:0xf
  v_cndmask_b32_e64 v236, v236, v20, s[54:55]
  v_add_u32_e64 v2, s101, v17
  ds_write_b32 v2, v236
  s_addk_i32 s101, 3072
  s_cmpk_eq_u32 s101, 18432
  s_cselect_b32 s101, 0, s101
  s_add_u32 s43, s43, 1
  v_mov_b32_e64 v4, s43
  ds_write_b32 v6, v4 offset:0
  s_mov_b64 s[32:33], s[36:37]
  s_add_u32 s68, s43, 1
  s_sub_u32 s45, s68, 16
  s_lshl_b32 s46, s45, 2
  s_lshr_b64 s[64:65], s[92:93], s46
  s_and_b32 s46, s64, 15
  s_cmp_lt_u32 s68, 16
  s_cselect_b32 s68, s68, s46
  s_cselect_b32 s70, s6, s12
  s_cselect_b32 s71, s7, s13
  s_lshl_b32 s44, s68, 2
  s_lshr_b64 s[64:65], s[96:97], s44
  s_and_b32 s64, s64, 15
  s_lshl4_add_u32 s68, s68, s64
  s_mul_i32 s44, s68, 1572864
  s_add_u32 s36, s70, s44
  s_addc_u32 s37, s71, 0
  s_cmp_lt_u32 s43, 16
  s_cbranch_scc1 L_k
L_vpre:
  v_subrev_u32 v116, 45568, v15
  v_mul_u32_u24 v116, 683, v116
  v_lshrrev_b32 v116, 13, v116
  v_lshlrev_b32 v116, 2, v116
  v_subrev_u32 v117, 45568, v16
  v_mul_u32_u24 v117, 683, v117
  v_lshrrev_b32 v117, 13, v117
  v_lshlrev_b32 v117, 2, v117
  v_subrev_u32 v118, 45568, v17
  v_mul_u32_u24 v118, 683, v118
  v_lshrrev_b32 v118, 13, v118
  v_lshlrev_b32 v118, 2, v118
  s_mov_b64 vcc, 0
  s_mov_b32 s43, 0
  s_lshl_b32 s68, s43, 2
  s_lshr_b64 s[64:65], s[92:93], s68
  s_and_b32 s68, s64, 15
  s_add_u32 s47, s68, 1
  ds_read_b32 v4, v14 offset:20
L_a0:
  s_waitcnt lgkmcnt(0)
  v_readfirstlane_b32 s46, v4
  s_cmp_ge_u32 s46, s47
  s_cbranch_scc1 L_a0_ok
  s_cmp_eq_u32 s94, 0
  s_cbranch_scc1 L_a0_ok
  s_sub_u32 s94, s94, 1
  ds_read_b32 v4, v14 offset:20
  s_branch L_a0
L_a0_ok:
  v_lshl_add_u32 v120, s68, 9, v116
  v_lshl_add_u32 v121, s68, 9, v117
  v_lshl_add_u32 v122, s68, 9, v118
  ds_read_b32 v112, v120 offset:37376
  ds_read_b32 v113, v121 offset:37376
  ds_read_b32 v114, v122 offset:37376
.p2align 6
L_v:
  s_cmp_eq_u32 s43, 8
  s_cselect_b32 s44, 6, 0
  s_sub_u32 s58, s58, s44
  s_add_u32 s45, s43, 1
  s_min_u32 s45, s45, 15
  s_lshl_b32 s68, s45, 2
  s_lshr_b64 s[64:65], s[92:93], s68
  s_and_b32 s68, s64, 15
  s_add_u32 s47, s68, 1
  v_lshl_add_u32 v120, s68, 9, v116
  v_lshl_add_u32 v121, s68, 9, v117
  v_lshl_add_u32 v122, s68, 9, v118
  s_waitcnt lgkmcnt(0)
  s_waitcnt vmcnt(8)
  s_mov_b64 exec, 3
  s_add_u32 s44, s78, 0x03030303
  v_msad_u8 v9, s78, v32, 0
  v_msad_u8 v10, s44, v32, 0
  v_msad_u8 v9, s78, v33, v9
  v_msad_u8 v10, s44, v33, v10
  v_msad_u8 v9, s78, v34, v9
  v_msad_u8 v10, s44, v34, v10
  global_store_byte v7, v8, s[30:31]
  global_load_dwordx3 v[32:34], v232, s[30:31] sc1
  v_sub_u32 v9, v9, v10
  v_add_u32 v8, 1, v8
  v_readlane_b32 s66, v9, 0
  v_readlane_b32 s67, v9, 1
  s_add_u32 s78, s78, 0x01010101
  s_mov_b64 exec, -1
  s_lshl1_add_u32 s69, s91, s95
  s_add_u32 s95, s66, s67
  s_add_u32 s69, s69, s95
  v_mov_b32_dpp v18, v112 row_newbcast:0 row_mask:0xf bank_mask:0xf
  v_cvt_f32_i32 v64, v64
  v_cvt_f32_i32 v65, v65
  v_cvt_f32_i32 v66, v66
  v_cvt_f32_i32 v67, v67
  v_pk_mul_f32 v[40:41], v[64:65], v[18:19] op_sel_hi:[1,0]
  v_pk_mul_f32 v[42:43], v[66:67], v[18:19] op_sel_hi:[1,0]
  s_cmpk_gt_i32 s69, 0x31
  s_cbranch_scc1 L_p89_4
  s_cmp_gt_i32 s69, L_order_end-L_order-16403
  s_cbranch_scc1 L_p89_1
  s_waitcnt vmcnt(5)
L_p89_1:
  s_waitcnt vmcnt(8)
L_p89_4:
  s_waitcnt vmcnt(9)
  buffer_load_dwordx4 v[100:103], v217, s[32:35], 0 offen nt
  v_mov_b32_dpp v18, v112 row_newbcast:4 row_mask:0xf bank_mask:0xf
  v_cvt_f32_i32 v68, v68
  v_cvt_f32_i32 v69, v69
  v_cvt_f32_i32 v70, v70
  v_cvt_f32_i32 v71, v71
  v_pk_mul_f32 v[48:49], v[68:69], v[18:19] op_sel_hi:[1,0]
  v_pk_mul_f32 v[50:51], v[70:71], v[18:19] op_sel_hi:[1,0]
  s_cmpk_gt_i32 s69, 0x31
  s_cbranch_scc1 L_p90_4
  s_cmp_gt_i32 s69, L_order_end-L_order-16373
  s_cbranch_scc1 L_p90_2
  s_waitcnt vmcnt(6)
L_p90_2:
  s_waitcnt vmcnt(9)
L_p90_4:
  s_waitcnt vmcnt(10)
  buffer_load_dwordx4 v[104:107], v218, s[32:35], 0 offen nt
  v_mov_b32_dpp v18, v112 row_newbcast:1 row_mask:0xf bank_mask:0xf
  v_cvt_f32_i32 v72, v72
  v_cvt_f32_i32 v73, v73
  v_cvt_f32_i32 v74, v74
  v_cvt_f32_i32 v75, v75
  v_pk_mul_f32 v[44:45], v[72:73], v[18:19] op_sel_hi:[1,0]
  v_pk_mul_f32 v[46:47], v[74:75], v[18:19] op_sel_hi:[1,0]
  s_cmpk_gt_i32 s69, 0x31
  s_cbranch_scc1 L_p91_4
  s_cmpk_gt_i32 s69, 0x1d
  s_cbranch_scc1 L_p91_3
  s_cmpk_gt_i32 s69, 0xffcd
  s_cbranch_scc1 L_p91_0
  s_waitcnt vmcnt(6)
L_p91_0:
  s_waitcnt vmcnt(7)
L_p91_3:
  s_waitcnt vmcnt(10)
L_p91_4:
  s_waitcnt vmcnt(11)
  buffer_load_dwordx4 v[108:111], v219, s[32:35], 0 offen nt
  s_waitcnt vmcnt(8)
  s_mov_b64 exec, 3
  s_add_u32 s44, s78, 0x03030303
  v_msad_u8 v9, s78, v36, 0
  v_msad_u8 v10, s44, v36, 0
  v_msad_u8 v9, s78, v37, v9
  v_msad_u8 v10, s44, v37, v10
  v_msad_u8 v9, s78, v38, v9
  v_msad_u8 v10, s44, v38, v10
  global_store_byte v7, v8, s[30:31]
  global_load_dwordx3 v[36:38], v233, s[30:31] sc1
  v_sub_u32 v9, v9, v10
  v_add_u32 v8, 1, v8
  v_readlane_b32 s66, v9, 0
  v_readlane_b32 s67, v9, 1
  s_add_u32 s78, s78, 0x01010101
  s_mov_b64 exec, -1
  s_lshl1_add_u32 s69, s91, s95
  s_add_u32 s95, s66, s67
  s_add_u32 s69, s69, s95
  v_mov_b32_dpp v18, v112 row_newbcast:5 row_mask:0xf bank_mask:0xf
  v_cvt_f32_i32 v76, v76
  v_cvt_f32_i32 v77, v77
  v_cvt_f32_i32 v78, v78
  v_cvt_f32_i32 v79, v79
  v_pk_fma_f32 v[40:41], v[76:77], v[18:19], v[40:41] op_sel_hi:[1,0,1]
  v_pk_fma_f32 v[42:43], v[78:79], v[18:19], v[42:43] op_sel_hi:[1,0,1]
  s_cmpk_gt_i32 s69, 0x31
  s_cbranch_scc1 L_p92_4
  s_cmp_gt_i32 s69, L_order_end-L_order-16403
  s_cbranch_scc1 L_p92_1
  s_waitcnt vmcnt(5)
L_p92_1:
  s_waitcnt vmcnt(8)
L_p92_4:
  s_waitcnt vmcnt(9)
  buffer_load_dwordx4 v[64:67], v220, s[32:35], 0 offen nt
  v_mov_b32_dpp v18, v112 row_newbcast:2 row_mask:0xf bank_mask:0xf
  v_cvt_f32_i32 v80, v80
  v_cvt_f32_i32 v81, v81
  v_cvt_f32_i32 v82, v82
  v_cvt_f32_i32 v83, v83
  v_pk_mul_f32 v[56:57], v[80:81], v[18:19] op_sel_hi:[1,0]
  v_pk_mul_f32 v[58:59], v[82:83], v[18:19] op_sel_hi:[1,0]
  s_cmpk_gt_i32 s69, 0x31
  s_cbranch_scc1 L_p93_4
  s_cmp_gt_i32 s69, L_order_end-L_order-16373
  s_cbranch_scc1 L_p93_2
  s_waitcnt vmcnt(6)
L_p93_2:
  s_waitcnt vmcnt(9)
L_p93_4:
  s_waitcnt vmcnt(10)
  buffer_load_dwordx4 v[68:71], v221, s[32:35], 0 offen nt
  v_mov_b32_dpp v18, v112 row_newbcast:6 row_mask:0xf bank_mask:0xf
  v_cvt_f32_i32 v84, v84
  v_cvt_f32_i32 v85, v85
  v_cvt_f32_i32 v86, v86
  v_cvt_f32_i32 v87, v87
  v_pk_mul_f32 v[52:53], v[84:85], v[18:19] op_sel_hi:[1,0]
  v_pk_mul_f32 v[54:55], v[86:87], v[18:19] op_sel_hi:[1,0]
  s_cmpk_gt_i32 s69, 0x31
  s_cbranch_scc1 L_p94_4
  s_cmpk_gt_i32 s69, 0x1d
  s_cbranch_scc1 L_p94_3
  s_cmpk_gt_i32 s69, 0xffcd
  s_cbranch_scc1 L_p94_0
  s_waitcnt vmcnt(6)
L_p94_0:
  s_waitcnt vmcnt(7)
L_p94_3:
  s_waitcnt vmcnt(10)
L_p94_4:
  s_waitcnt vmcnt(11)
  buffer_load_dwordx4 v[72:75], v222, s[32:35], 0 offen nt
  v_add_u32_e64 v9, s43, 16
  ds_write_b32 v14, v9 offset:28
  s_waitcnt vmcnt(8)
  s_mov_b64 exec, 3
  s_add_u32 s44, s78, 0x03030303
  v_msad_u8 v9, s78, v32, 0
  v_msad_u8 v10, s44, v32, 0
  v_msad_u8 v9, s78, v33, v9
  v_msad_u8 v10, s44, v33, v10
  v_msad_u8 v9, s78, v34, v9
  v_msad_u8 v10, s44, v34, v10
  global_store_byte v7, v8, s[30:31]
  global_load_dwordx3 v[32:34], v234, s[30:31] sc1
  v_sub_u32 v9, v9, v10
  v_add_u32 v8, 1, v8
  v_readlane_b32 s66, v9, 0
  v_readlane_b32 s67, v9, 1
  s_add_u32 s78, s78, 0x01010101
  s_mov_b64 exec, -1
  s_lshl1_add_u32 s69, s91, s95
  s_add_u32 s95, s66, s67
  s_add_u32 s69, s69, s95
  v_mov_b32_dpp v18, v112 row_newbcast:3 row_mask:0xf bank_mask:0xf
  v_cvt_f32_i32 v88, v88
  v_cvt_f32_i32 v89, v89
  v_cvt_f32_i32 v90, v90
  v_cvt_f32_i32 v91, v91
  v_pk_mul_f32 v[60:61], v[88:89], v[18:19] op_sel_hi:[1,0]
  v_pk_mul_f32 v[62:63], v[90:91], v[18:19] op_sel_hi:[1,0]
  s_cmpk_gt_i32 s69, 0x31
  s_cbranch_scc1 L_p95_4
  s_cmp_gt_i32 s69, L_order_end-L_order-16403
  s_cbranch_scc1 L_p95_1
  s_waitcnt vmcnt(5)
L_p95_1:
  s_waitcnt vmcnt(8)
L_p95_4:
  s_waitcnt vmcnt(9)
  buffer_load_dwordx4 v[76:79], v223, s[32:35], 0 offen nt
  v_mov_b32_dpp v18, v112 row_newbcast:7 row_mask:0xf bank_mask:0xf
  v_cvt_f32_i32 v92, v92
  v_cvt_f32_i32 v93, v93
  v_cvt_f32_i32 v94, v94
  v_cvt_f32_i32 v95, v95
  v_pk_fma_f32 v[56:57], v[92:93], v[18:19], v[56:57] op_sel_hi:[1,0,1]
  v_pk_fma_f32 v[58:59], v[94:95], v[18:19], v[58:59] op_sel_hi:[1,0,1]
  s_cmpk_gt_i32 s69, 0x31
  s_cbranch_scc1 L_p96_4
  s_cmp_gt_i32 s69, L_order_end-L_order-16373
  s_cbranch_scc1 L_p96_2
  s_waitcnt vmcnt(6)
L_p96_2:
  s_waitcnt vmcnt(9)
L_p96_4:
  s_waitcnt vmcnt(10)
  buffer_load_dwordx4 v[80:83], v224, s[32:35], 0 offen nt
  v_mov_b32_dpp v18, v113 row_newbcast:0 row_mask:0xf bank_mask:0xf
  v_cvt_f32_i32 v96, v96
  v_cvt_f32_i32 v97, v97
  v_cvt_f32_i32 v98, v98
  v_cvt_f32_i32 v99, v99
  v_pk_fma_f32 v[44:45], v[96:97], v[18:19], v[44:45] op_sel_hi:[1,0,1]
  v_pk_fma_f32 v[46:47], v[98:99], v[18:19], v[46:47] op_sel_hi:[1,0,1]
  s_cmpk_gt_i32 s69, 0x31
  s_cbranch_scc1 L_p97_4
  s_cmpk_gt_i32 s69, 0x1d
  s_cbranch_scc1 L_p97_3
  s_cmpk_gt_i32 s69, 0xffcd
  s_cbranch_scc1 L_p97_0
  s_waitcnt vmcnt(6)
L_p97_0:
  s_waitcnt vmcnt(7)
L_p97_3:
  s_waitcnt vmcnt(10)
L_p97_4:
  s_waitcnt vmcnt(11)
  buffer_load_dwordx4 v[84:87], v225, s[32:35], 0 offen nt
  s_waitcnt vmcnt(8)
  s_mov_b64 exec, 3
  s_add_u32 s44, s78, 0x03030303
  v_msad_u8 v9, s78, v36, 0
  v_msad_u8 v10, s44, v36, 0
  v_msad_u8 v9, s78, v37, v9
  v_msad_u8 v10, s44, v37, v10
  v_msad_u8 v9, s78, v38, v9
  v_msad_u8 v10, s44, v38, v10
  global_store_byte v7, v8, s[30:31]
  global_load_dwordx3 v[36:38], v235, s[30:31] sc1
  v_sub_u32 v9, v9, v10
  v_add_u32 v8, 1, v8
  v_readlane_b32 s66, v9, 0
  v_readlane_b32 s67, v9, 1
  s_add_u32 s78, s78, 0x01010101
  s_mov_b64 exec, -1
  s_lshl1_add_u32 s69, s91, s95
  s_add_u32 s95, s66, s67
  s_add_u32 s69, s69, s95
  v_mov_b32_dpp v18, v113 row_newbcast:4 row_mask:0xf bank_mask:0xf
  v_cvt_f32_i32 v100, v100
  v_cvt_f32_i32 v101, v101
  v_cvt_f32_i32 v102, v102
  v_cvt_f32_i32 v103, v103
  v_pk_fma_f32 v[40:41], v[100:101], v[18:19], v[40:41] op_sel_hi:[1,0,1]
  v_pk_fma_f32 v[42:43], v[102:103], v[18:19], v[42:43] op_sel_hi:[1,0,1]
  s_cmpk_gt_i32 s69, 0x31
  s_cbranch_scc1 L_p98_4
  s_cmp_gt_i32 s69, L_order_end-L_order-16403
  s_cbranch_scc1 L_p98_1
  s_waitcnt vmcnt(5)
L_p98_1:
  s_waitcnt vmcnt(8)
L_p98_4:
  s_waitcnt vmcnt(9)
  buffer_load_dwordx4 v[88:91], v226, s[32:35], 0 offen nt
  v_mov_b32_dpp v18, v113 row_newbcast:1 row_mask:0xf bank_mask:0xf
  v_cvt_f32_i32 v104, v104
  v_cvt_f32_i32 v105, v105
  v_cvt_f32_i32 v106, v106
  v_cvt_f32_i32 v107, v107
  v_pk_fma_f32 v[48:49], v[104:105], v[18:19], v[48:49] op_sel_hi:[1,0,1]
  v_pk_fma_f32 v[50:51], v[106:107], v[18:19], v[50:51] op_sel_hi:[1,0,1]
  s_cmpk_gt_i32 s69, 0x31
  s_cbranch_scc1 L_p99_4
  s_cmp_gt_i32 s69, L_order_end-L_order-16373
  s_cbranch_scc1 L_p99_2
  s_waitcnt vmcnt(6)
L_p99_2:
  s_waitcnt vmcnt(9)
L_p99_4:
  s_waitcnt vmcnt(10)
  buffer_load_dwordx4 v[92:95], v227, s[32:35], 0 offen nt
  v_mov_b32_dpp v18, v113 row_newbcast:5 row_mask:0xf bank_mask:0xf
  v_cvt_f32_i32 v108, v108
  v_cvt_f32_i32 v109, v109
  v_cvt_f32_i32 v110, v110
  v_cvt_f32_i32 v111, v111
  v_pk_fma_f32 v[44:45], v[108:109], v[18:19], v[44:45] op_sel_hi:[1,0,1]
  v_pk_fma_f32 v[46:47], v[110:111], v[18:19], v[46:47] op_sel_hi:[1,0,1]
  s_cmpk_gt_i32 s69, 0x31
  s_cbranch_scc1 L_p100_4
  s_cmpk_gt_i32 s69, 0x1d
  s_cbranch_scc1 L_p100_3
  s_cmpk_gt_i32 s69, 0xffcd
  s_cbranch_scc1 L_p100_0
  s_waitcnt vmcnt(6)
L_p100_0:
  s_waitcnt vmcnt(7)
L_p100_3:
  s_waitcnt vmcnt(10)
L_p100_4:
  s_waitcnt vmcnt(11)
  buffer_load_dwordx4 v[96:99], v228, s[32:35], 0 offen nt
  s_waitcnt vmcnt(8)
  s_mov_b64 exec, 3
  s_add_u32 s44, s78, 0x03030303
  v_msad_u8 v9, s78, v32, 0
  v_msad_u8 v10, s44, v32, 0
  v_msad_u8 v9, s78, v33, v9
  v_msad_u8 v10, s44, v33, v10
  v_msad_u8 v9, s78, v34, v9
  v_msad_u8 v10, s44, v34, v10
  global_store_byte v7, v8, s[30:31]
  global_load_dwordx3 v[32:34], v232, s[30:31] sc1
  v_sub_u32 v9, v9, v10
  v_add_u32 v8, 1, v8
  v_readlane_b32 s66, v9, 0
  v_readlane_b32 s67, v9, 1
  s_add_u32 s78, s78, 0x01010101
  s_mov_b64 exec, -1
  s_lshl1_add_u32 s69, s91, s95
  s_add_u32 s95, s66, s67
  s_add_u32 s69, s69, s95
  v_mov_b32_dpp v18, v113 row_newbcast:2 row_mask:0xf bank_mask:0xf
  v_cvt_f32_i32 v64, v64
  v_cvt_f32_i32 v65, v65
  v_cvt_f32_i32 v66, v66
  v_cvt_f32_i32 v67, v67
  v_pk_fma_f32 v[60:61], v[64:65], v[18:19], v[60:61] op_sel_hi:[1,0,1]
  v_pk_fma_f32 v[62:63], v[66:67], v[18:19], v[62:63] op_sel_hi:[1,0,1]
  s_cmpk_gt_i32 s69, 0x31
  s_cbranch_scc1 L_p101_4
  s_cmp_gt_i32 s69, L_order_end-L_order-16403
  s_cbranch_scc1 L_p101_1
  s_waitcnt vmcnt(5)
L_p101_1:
  s_waitcnt vmcnt(8)
L_p101_4:
  s_waitcnt vmcnt(9)
  buffer_load_dwordx4 v[100:103], v229, s[32:35], 0 offen nt
  v_mov_b32_dpp v18, v113 row_newbcast:6 row_mask:0xf bank_mask:0xf
  v_cvt_f32_i32 v68, v68
  v_cvt_f32_i32 v69, v69
  v_cvt_f32_i32 v70, v70
  v_cvt_f32_i32 v71, v71
  v_pk_fma_f32 v[56:57], v[68:69], v[18:19], v[56:57] op_sel_hi:[1,0,1]
  v_pk_fma_f32 v[58:59], v[70:71], v[18:19], v[58:59] op_sel_hi:[1,0,1]
  s_cmpk_gt_i32 s69, 0x31
  s_cbranch_scc1 L_p102_4
  s_cmp_gt_i32 s69, L_order_end-L_order-16373
  s_cbranch_scc1 L_p102_2
  s_waitcnt vmcnt(6)
L_p102_2:
  s_waitcnt vmcnt(9)
L_p102_4:
  s_waitcnt vmcnt(10)
  buffer_load_dwordx4 v[104:107], v230, s[32:35], 0 offen nt
  v_mov_b32_dpp v18, v113 row_newbcast:3 row_mask:0xf bank_mask:0xf
  v_cvt_f32_i32 v72, v72
  v_cvt_f32_i32 v73, v73
  v_cvt_f32_i32 v74, v74
  v_cvt_f32_i32 v75, v75
  v_pk_fma_f32 v[52:53], v[72:73], v[18:19], v[52:53] op_sel_hi:[1,0,1]
  v_pk_fma_f32 v[54:55], v[74:75], v[18:19], v[54:55] op_sel_hi:[1,0,1]
  s_cmpk_gt_i32 s69, 0x31
  s_cbranch_scc1 L_p103_4
  s_cmpk_gt_i32 s69, 0x1d
  s_cbranch_scc1 L_p103_3
  s_cmpk_gt_i32 s69, 0xffcd
  s_cbranch_scc1 L_p103_0
  s_waitcnt vmcnt(6)
L_p103_0:
  s_waitcnt vmcnt(7)
L_p103_3:
  s_waitcnt vmcnt(10)
L_p103_4:
  s_waitcnt vmcnt(11)
  buffer_load_dwordx4 v[108:111], v231, s[32:35], 0 offen nt
  s_cbranch_vccnz L_vtail
  ds_read_b32 v4, v14 offset:20
  s_waitcnt vmcnt(8)
  s_mov_b64 exec, 3
  s_add_u32 s44, s78, 0x03030303
  v_msad_u8 v9, s78, v36, 0
  v_msad_u8 v10, s44, v36, 0
  v_msad_u8 v9, s78, v37, v9
  v_msad_u8 v10, s44, v37, v10
  v_msad_u8 v9, s78, v38, v9
  v_msad_u8 v10, s44, v38, v10
  global_load_dwordx2 v[26:27], v11, s[30:31] sc1
  global_store_byte v7, v8, s[30:31]
  global_load_dwordx3 v[36:38], v233, s[30:31] sc1
  v_sub_u32 v9, v9, v10
  v_add_u32_e64 v8, 1, v8
  v_readlane_b32 s66, v9, 0
  v_readlane_b32 s67, v9, 1
  s_add_u32 s78, s78, 0x01010101
  s_mov_b64 exec, -1
  s_lshl1_add_u32 s69, s91, s95
  s_add_u32 s95, s66, s67
  s_add_u32 s69, s69, s95
  v_mov_b32_dpp v18, v113 row_newbcast:7 row_mask:0xf bank_mask:0xf
  v_cvt_f32_i32 v76, v76
  v_cvt_f32_i32 v77, v77
  v_cvt_f32_i32 v78, v78
  v_cvt_f32_i32 v79, v79
  v_pk_fma_f32 v[60:61], v[76:77], v[18:19], v[60:61] op_sel_hi:[1,0,1]
  v_pk_fma_f32 v[62:63], v[78:79], v[18:19], v[62:63] op_sel_hi:[1,0,1]
  s_cmpk_gt_i32 s69, 0x31
  s_cbranch_scc1 L_p104_4
  s_cmp_gt_i32 s69, L_order_end-L_order-16403
  s_cbranch_scc1 L_p104_1
  s_waitcnt vmcnt(6)
L_p104_1:
  s_waitcnt vmcnt(9)
L_p104_4:
  s_waitcnt vmcnt(10)
  buffer_load_dwordx4 v[64:67], v208, s[36:39], 0 offen nt
  v_mov_b32_dpp v18, v114 row_newbcast:0 row_mask:0xf bank_mask:0xf
  v_cvt_f32_i32 v80, v80
  v_cvt_f32_i32 v81, v81
  v_cvt_f32_i32 v82, v82
  v_cvt_f32_i32 v83, v83
  v_pk_fma_f32 v[48:49], v[80:81], v[18:19], v[48:49] op_sel_hi:[1,0,1]
  v_pk_fma_f32 v[50:51], v[82:83], v[18:19], v[50:51] op_sel_hi:[1,0,1]
  s_cmpk_gt_i32 s69, 0x31
  s_cbranch_scc1 L_p105_4
  s_cmp_gt_i32 s69, L_order_end-L_order-16373
  s_cbranch_scc1 L_p105_2
  s_waitcnt vmcnt(7)
L_p105_2:
  s_waitcnt vmcnt(10)
L_p105_4:
  s_waitcnt vmcnt(11)
  buffer_load_dwordx4 v[68:71], v209, s[36:39], 0 offen nt
  v_mov_b32_dpp v18, v114 row_newbcast:4 row_mask:0xf bank_mask:0xf
  v_cvt_f32_i32 v84, v84
  v_cvt_f32_i32 v85, v85
  v_cvt_f32_i32 v86, v86
  v_cvt_f32_i32 v87, v87
  v_pk_fma_f32 v[44:45], v[84:85], v[18:19], v[44:45] op_sel_hi:[1,0,1]
  v_pk_fma_f32 v[46:47], v[86:87], v[18:19], v[46:47] op_sel_hi:[1,0,1]
  s_cmpk_gt_i32 s69, 0x31
  s_cbranch_scc1 L_p106_4
  s_cmpk_gt_i32 s69, 0x1d
  s_cbranch_scc1 L_p106_3
  s_cmpk_gt_i32 s69, 0xffcd
  s_cbranch_scc1 L_p106_0
  s_waitcnt vmcnt(7)
L_p106_0:
  s_waitcnt vmcnt(8)
L_p106_3:
  s_waitcnt vmcnt(11)
L_p106_4:
  s_waitcnt vmcnt(12)
  buffer_load_dwordx4 v[72:75], v210, s[36:39], 0 offen nt
L_an:
  s_waitcnt lgkmcnt(0)
  v_readfirstlane_b32 s46, v4
  s_cmp_ge_u32 s46, s47
  s_cbranch_scc1 L_an_ok
  s_cmp_eq_u32 s94, 0
  s_cbranch_scc1 L_an_ok
  s_sub_u32 s94, s94, 1
  ds_read_b32 v4, v14 offset:20
  s_branch L_an
L_an_ok:
  ds_read_b32 v112, v120 offset:37376
  ds_read_b32 v113, v121 offset:37376
  ds_read_b32 v115, v122 offset:37376
  s_waitcnt vmcnt(9)
  s_mov_b64 exec, 3
  s_add_u32 s44, s78, 0x03030303
  v_msad_u8 v9, s78, v32, 0
  v_msad_u8 v10, s44, v32, 0
  v_msad_u8 v9, s78, v33, v9
  v_msad_u8 v10, s44, v33, v10
  v_msad_u8 v9, s78, v34, v9
  v_msad_u8 v10, s44, v34, v10
  global_store_byte v7, v8, s[30:31]
  global_load_dwordx3 v[32:34], v234, s[30:31] sc1
  v_sub_u32 v9, v9, v10
  v_add_u32 v8, 1, v8
  v_readlane_b32 s66, v9, 0
  v_readlane_b32 s67, v9, 1
  s_add_u32 s78, s78, 0x01010101
  s_mov_b64 exec, -1
  s_lshl1_add_u32 s69, s91, s95
  s_add_u32 s95, s66, s67
  s_add_u32 s69, s69, s95
  v_mov_b32_dpp v18, v114 row_newbcast:1 row_mask:0xf bank_mask:0xf
  v_cvt_f32_i32 v88, v88
  v_cvt_f32_i32 v89, v89
  v_cvt_f32_i32 v90, v90
  v_cvt_f32_i32 v91, v91
  v_pk_fma_f32 v[40:41], v[88:89], v[18:19], v[40:41] op_sel_hi:[1,0,1]
  v_pk_fma_f32 v[42:43], v[90:91], v[18:19], v[42:43] op_sel_hi:[1,0,1]
  s_cmpk_gt_i32 s69, 0x31
  s_cbranch_scc1 L_p107_4
  s_cmp_gt_i32 s69, L_order_end-L_order-16403
  s_cbranch_scc1 L_p107_1
  s_waitcnt vmcnt(5)
L_p107_1:
  s_waitcnt vmcnt(9)
L_p107_4:
  s_waitcnt vmcnt(10)
  buffer_load_dwordx4 v[76:79], v211, s[36:39], 0 offen nt
  v_mov_b32_dpp v18, v114 row_newbcast:5 row_mask:0xf bank_mask:0xf
  v_cvt_f32_i32 v92, v92
  v_cvt_f32_i32 v93, v93
  v_cvt_f32_i32 v94, v94
  v_cvt_f32_i32 v95, v95
  v_pk_fma_f32 v[48:49], v[92:93], v[18:19], v[48:49] op_sel_hi:[1,0,1]
  v_pk_fma_f32 v[50:51], v[94:95], v[18:19], v[50:51] op_sel_hi:[1,0,1]
  s_cmpk_gt_i32 s69, 0x31
  s_cbranch_scc1 L_p108_4
  s_cmp_gt_i32 s69, L_order_end-L_order-16373
  s_cbranch_scc1 L_p108_2
  s_waitcnt vmcnt(6)
L_p108_2:
  s_waitcnt vmcnt(10)
L_p108_4:
  s_waitcnt vmcnt(11)
  buffer_load_dwordx4 v[80:83], v212, s[36:39], 0 offen nt
  v_mov_b32_dpp v18, v114 row_newbcast:2 row_mask:0xf bank_mask:0xf
  v_cvt_f32_i32 v96, v96
  v_cvt_f32_i32 v97, v97
  v_cvt_f32_i32 v98, v98
  v_cvt_f32_i32 v99, v99
  v_pk_fma_f32 v[52:53], v[96:97], v[18:19], v[52:53] op_sel_hi:[1,0,1]
  v_pk_fma_f32 v[54:55], v[98:99], v[18:19], v[54:55] op_sel_hi:[1,0,1]
  s_cmpk_gt_i32 s69, 0x31
  s_cbranch_scc1 L_p109_4
  s_cmpk_gt_i32 s69, 0x1d
  s_cbranch_scc1 L_p109_3
  s_cmpk_gt_i32 s69, 0xffcd
  s_cbranch_scc1 L_p109_0
  s_waitcnt vmcnt(6)
L_p109_0:
  s_waitcnt vmcnt(7)
L_p109_3:
  s_waitcnt vmcnt(11)
L_p109_4:
  s_waitcnt vmcnt(12)
  buffer_load_dwordx4 v[84:87], v213, s[36:39], 0 offen nt
  s_cmp_eq_u32 s62, 0
  s_cbranch_scc1 L_flv
  v_pk_add_f32 v[52:53], v[52:53], v[44:45]
  v_pk_add_f32 v[54:55], v[54:55], v[46:47]
  v_pk_add_f32 v[56:57], v[56:57], v[48:49]
  v_pk_add_f32 v[58:59], v[58:59], v[50:51]
  v_pk_add_f32 v[60:61], v[60:61], v[40:41]
  v_pk_add_f32 v[62:63], v[62:63], v[42:43]
  s_branch L_fmv
.p2align 3
L_flv:
  v_pk_add_f32 v[52:53], v[52:53], v[40:41]
  v_pk_add_f32 v[54:55], v[54:55], v[42:43]
  v_pk_add_f32 v[56:57], v[56:57], v[44:45]
  v_pk_add_f32 v[58:59], v[58:59], v[46:47]
  v_pk_add_f32 v[60:61], v[60:61], v[48:49]
  v_pk_add_f32 v[62:63], v[62:63], v[50:51]
L_fmv:
  v_add_u32_e64 v9, s43, 16
  ds_write_b32 v14, v9 offset:24
  s_waitcnt vmcnt(8)
  s_mov_b64 exec, 3
  s_add_u32 s44, s78, 0x03030303
  v_msad_u8 v9, s78, v36, 0
  v_msad_u8 v10, s44, v36, 0
  v_msad_u8 v9, s78, v37, v9
  v_msad_u8 v10, s44, v37, v10
  v_msad_u8 v9, s78, v38, v9
  v_msad_u8 v10, s44, v38, v10
  global_store_byte v7, v8, s[30:31]
  global_load_dwordx3 v[36:38], v235, s[30:31] sc1
  v_sub_u32 v9, v9, v10
  v_add_u32 v8, 1, v8
  v_add3_u32 v10, v26, v27, s58
  v_readlane_b32 s66, v9, 0
  v_readlane_b32 s67, v9, 1
  v_readlane_b32 s91, v10, 0
  s_add_u32 s78, s78, 0x01010101
  s_mov_b64 exec, -1
  s_lshl1_add_u32 s69, s91, s95
  s_add_u32 s95, s66, s67
  s_add_u32 s69, s69, s95
  v_mov_b32_dpp v18, v114 row_newbcast:6 row_mask:0xf bank_mask:0xf
  v_cvt_f32_i32 v100, v100
  v_cvt_f32_i32 v101, v101
  v_cvt_f32_i32 v102, v102
  v_cvt_f32_i32 v103, v103
  v_pk_fma_f32 v[60:61], v[100:101], v[18:19], v[60:61] op_sel_hi:[1,0,1]
  v_pk_fma_f32 v[62:63], v[102:103], v[18:19], v[62:63] op_sel_hi:[1,0,1]
  s_cmpk_gt_i32 s69, 0x31
  s_cbranch_scc1 L_p110_4
  s_cmp_gt_i32 s69, L_order_end-L_order-16403
  s_cbranch_scc1 L_p110_1
  s_waitcnt vmcnt(5)
L_p110_1:
  s_waitcnt vmcnt(8)
L_p110_4:
  s_waitcnt vmcnt(9)
  buffer_load_dwordx4 v[88:91], v214, s[36:39], 0 offen nt
  v_mov_b32_dpp v18, v114 row_newbcast:3 row_mask:0xf bank_mask:0xf
  v_cvt_f32_i32 v104, v104
  v_cvt_f32_i32 v105, v105
  v_cvt_f32_i32 v106, v106
  v_cvt_f32_i32 v107, v107
  v_pk_fma_f32 v[56:57], v[104:105], v[18:19], v[56:57] op_sel_hi:[1,0,1]
  v_pk_fma_f32 v[58:59], v[106:107], v[18:19], v[58:59] op_sel_hi:[1,0,1]
  s_cmpk_gt_i32 s69, 0x31
  s_cbranch_scc1 L_p111_4
  s_cmp_gt_i32 s69, L_order_end-L_order-16373
  s_cbranch_scc1 L_p111_2
  s_waitcnt vmcnt(6)
L_p111_2:
  s_waitcnt vmcnt(9)
L_p111_4:
  s_waitcnt vmcnt(10)
  buffer_load_dwordx4 v[92:95], v215, s[36:39], 0 offen nt
  v_mov_b32_dpp v18, v114 row_newbcast:7 row_mask:0xf bank_mask:0xf
  v_cvt_f32_i32 v108, v108
  v_cvt_f32_i32 v109, v109
  v_cvt_f32_i32 v110, v110
  v_cvt_f32_i32 v111, v111
  v_pk_fma_f32 v[52:53], v[108:109], v[18:19], v[52:53] op_sel_hi:[1,0,1]
  v_pk_fma_f32 v[54:55], v[110:111], v[18:19], v[54:55] op_sel_hi:[1,0,1]
  s_cmpk_gt_i32 s69, 0x31
  s_cbranch_scc1 L_p112_4
  s_cmpk_gt_i32 s69, 0x1d
  s_cbranch_scc1 L_p112_3
  s_cmpk_gt_i32 s69, 0xffcd
  s_cbranch_scc1 L_p112_0
  s_waitcnt vmcnt(6)
L_p112_0:
  s_waitcnt vmcnt(7)
L_p112_3:
  s_waitcnt vmcnt(10)
L_p112_4:
  s_waitcnt vmcnt(11)
  buffer_load_dwordx4 v[96:99], v216, s[36:39], 0 offen nt
  s_add_u32 s43, s43, 1
  v_permlane32_swap_b32 v52, v54
  v_permlane32_swap_b32 v53, v55
  v_permlane32_swap_b32 v56, v58
  v_permlane32_swap_b32 v57, v59
  v_permlane32_swap_b32 v60, v62
  v_permlane32_swap_b32 v61, v63
  v_add_f32 v52, v52, v58
  v_add_f32 v53, v53, v59
  v_add_f32 v56, v56, v62
  v_add_f32 v57, v57, v63
  v_add_f32 v60, v60, v54
  v_add_f32 v61, v61, v55
  s_add_u32 s44, s43, 16
  s_cmp_eq_u32 s43, 15
  s_cselect_b64 vcc, -1, 0
  v_mov_b32 v4, s44
  v_permlane16_swap_b32 v52, v53
  v_permlane16_swap_b32 v56, v57
  v_permlane16_swap_b32 v60, v61
  v_add_f32 v52, v52, v61
  v_add_f32 v56, v56, v53
  v_add_f32 v60, v60, v57
  s_waitcnt lgkmcnt(0)
  ds_write_b32 v3, v52 offset:0
  ds_write_b32 v3, v56 offset:256
  ds_write_b32 v3, v60 offset:512
  ds_write_b32 v6, v4 offset:0
  v_mov_b32_e64 v114, v115
  v_add_u32 v3, 3072, v3
  s_mov_b64 s[32:33], s[36:37]
  s_add_u32 s45, s43, 1
  s_min_u32 s45, s45, 15
  s_lshl_b32 s68, s45, 2
  s_lshr_b64 s[64:65], s[92:93], s68
  s_and_b32 s68, s64, 15
  s_lshl_b32 s44, s68, 2
  s_lshr_b64 s[64:65], s[96:97], s44
  s_and_b32 s64, s64, 15
  s_lshl4_add_u32 s68, s68, s64
  s_mul_i32 s44, s68, 1572864
  s_add_u32 s36, s12, s44
  s_addc_u32 s37, s13, 0
  s_branch L_v
L_vtail:
  s_waitcnt vmcnt(10)
  v_mov_b32_dpp v18, v113 row_newbcast:7 row_mask:0xf bank_mask:0xf
  v_cvt_f32_i32 v76, v76
  v_cvt_f32_i32 v77, v77
  v_cvt_f32_i32 v78, v78
  v_cvt_f32_i32 v79, v79
  v_pk_fma_f32 v[60:61], v[76:77], v[18:19], v[60:61] op_sel_hi:[1,0,1]
  v_pk_fma_f32 v[62:63], v[78:79], v[18:19], v[62:63] op_sel_hi:[1,0,1]
  s_waitcnt vmcnt(9)
  v_mov_b32_dpp v18, v114 row_newbcast:0 row_mask:0xf bank_mask:0xf
  v_cvt_f32_i32 v80, v80
  v_cvt_f32_i32 v81, v81
  v_cvt_f32_i32 v82, v82
  v_cvt_f32_i32_e64 v83, v83
  v_pk_fma_f32 v[48:49], v[80:81], v[18:19], v[48:49] op_sel_hi:[1,0,1]
  v_pk_fma_f32 v[50:51], v[82:83], v[18:19], v[50:51] op_sel_hi:[1,0,1]
  s_waitcnt vmcnt(8)
  v_mov_b32_dpp v18, v114 row_newbcast:4 row_mask:0xf bank_mask:0xf
  v_cvt_f32_i32 v84, v84
  v_cvt_f32_i32 v85, v85
  v_cvt_f32_i32 v86, v86
  v_cvt_f32_i32_e64 v87, v87
  v_pk_fma_f32 v[44:45], v[84:85], v[18:19], v[44:45] op_sel_hi:[1,0,1]
  v_pk_fma_f32 v[46:47], v[86:87], v[18:19], v[46:47] op_sel_hi:[1,0,1]
  s_waitcnt vmcnt(6)
  v_mov_b32_dpp v18, v114 row_newbcast:1 row_mask:0xf bank_mask:0xf
  v_cvt_f32_i32 v88, v88
  v_cvt_f32_i32 v89, v89
  v_cvt_f32_i32 v90, v90
  v_cvt_f32_i32_e64 v91, v91
  v_pk_fma_f32 v[40:41], v[88:89], v[18:19], v[40:41] op_sel_hi:[1,0,1]
  v_pk_fma_f32 v[42:43], v[90:91], v[18:19], v[42:43] op_sel_hi:[1,0,1]
  s_waitcnt vmcnt(5)
  v_mov_b32_dpp v18, v114 row_newbcast:5 row_mask:0xf bank_mask:0xf
  v_cvt_f32_i32 v92, v92
  v_cvt_f32_i32 v93, v93
  v_cvt_f32_i32 v94, v94
  v_cvt_f32_i32_e64 v95, v95
  v_pk_fma_f32 v[48:49], v[92:93], v[18:19], v[48:49] op_sel_hi:[1,0,1]
  v_pk_fma_f32 v[50:51], v[94:95], v[18:19], v[50:51] op_sel_hi:[1,0,1]
  s_cmp_eq_u32 s62, 0
  s_cbranch_scc1 L_flt
  v_pk_add_f32 v[52:53], v[52:53], v[44:45]
  v_pk_add_f32 v[54:55], v[54:55], v[46:47]
  v_pk_add_f32 v[56:57], v[56:57], v[48:49]
  v_pk_add_f32 v[58:59], v[58:59], v[50:51]
  v_pk_add_f32 v[60:61], v[60:61], v[40:41]
  v_pk_add_f32 v[62:63], v[62:63], v[42:43]
  s_branch L_fmt
.p2align 3
L_flt:
  v_pk_add_f32 v[52:53], v[52:53], v[40:41]
  v_pk_add_f32 v[54:55], v[54:55], v[42:43]
  v_pk_add_f32 v[56:57], v[56:57], v[44:45]
  v_pk_add_f32 v[58:59], v[58:59], v[46:47]
  v_pk_add_f32 v[60:61], v[60:61], v[48:49]
  v_pk_add_f32 v[62:63], v[62:63], v[50:51]
L_fmt:
  s_waitcnt vmcnt(4)
  v_mov_b32_dpp v18, v114 row_newbcast:2 row_mask:0xf bank_mask:0xf
  v_cvt_f32_i32 v96, v96
  v_cvt_f32_i32 v97, v97
  v_cvt_f32_i32 v98, v98
  v_cvt_f32_i32_e64 v99, v99
  v_pk_fma_f32 v[52:53], v[96:97], v[18:19], v[52:53] op_sel_hi:[1,0,1]
  v_pk_fma_f32 v[54:55], v[98:99], v[18:19], v[54:55] op_sel_hi:[1,0,1]
  s_waitcnt vmcnt(2)
  v_mov_b32_dpp v18, v114 row_newbcast:6 row_mask:0xf bank_mask:0xf
  v_cvt_f32_i32 v100, v100
  v_cvt_f32_i32 v101, v101
  v_cvt_f32_i32 v102, v102
  v_cvt_f32_i32_e64 v103, v103
  v_pk_fma_f32 v[60:61], v[100:101], v[18:19], v[60:61] op_sel_hi:[1,0,1]
  v_pk_fma_f32 v[62:63], v[102:103], v[18:19], v[62:63] op_sel_hi:[1,0,1]
  s_waitcnt vmcnt(1)
  v_mov_b32_dpp v18, v114 row_newbcast:3 row_mask:0xf bank_mask:0xf
  v_cvt_f32_i32 v104, v104
  v_cvt_f32_i32 v105, v105
  v_cvt_f32_i32 v106, v106
  v_cvt_f32_i32_e64 v107, v107
  v_pk_fma_f32 v[56:57], v[104:105], v[18:19], v[56:57] op_sel_hi:[1,0,1]
  v_pk_fma_f32 v[58:59], v[106:107], v[18:19], v[58:59] op_sel_hi:[1,0,1]
  v_permlane32_swap_b32 v60, v62
  v_permlane32_swap_b32 v61, v63
  v_permlane32_swap_b32 v56, v58
  v_permlane32_swap_b32 v57, v59
  v_add_f32_e64 v56, v56, v62
  v_add_f32 v57, v57, v63
  s_waitcnt vmcnt(0)
  v_mov_b32_dpp v18, v114 row_newbcast:7 row_mask:0xf bank_mask:0xf
  v_cvt_f32_i32 v108, v108
  v_cvt_f32_i32 v109, v109
  v_cvt_f32_i32 v110, v110
  v_cvt_f32_i32 v111, v111
  v_pk_fma_f32 v[52:53], v[108:109], v[18:19], v[52:53] op_sel_hi:[1,0,1]
  v_pk_fma_f32 v[54:55], v[110:111], v[18:19], v[54:55] op_sel_hi:[1,0,1]
  v_permlane16_swap_b32 v56, v57
  s_nop 0
  v_permlane32_swap_b32 v52, v54
  v_permlane32_swap_b32 v53, v55
  v_add_f32 v60, v60, v54
  v_add_f32 v61, v61, v55
  v_add_f32_e64 v52, v52, v58
  v_add_f32 v53, v53, v59
  v_permlane16_swap_b32 v60, v61
  v_add_f32 v60, v60, v57
  v_permlane16_swap_b32 v52, v53
  ds_write_b32 v3, v60 offset:512
  v_add_f32 v56, v56, v53
  v_add_f32 v52, v52, v61
  ds_write_b32 v3, v56 offset:256
  ds_write_b32 v3, v52 offset:0
  s_waitcnt lgkmcnt(0)
  s_barrier
  s_endpgm
L_helper:
  s_getreg_b32 s81, hwreg(HW_REG_HW_ID, 13, 2)
  s_getreg_b32 s79, hwreg(HW_REG_HW_ID, 8, 4)
  s_getreg_b32 s46, hwreg(HW_REG_XCC_ID, 0, 3)
  s_mul_i32 s46, s46, 4352
  s_add_u32 s46, s46, 8126464
  v_lshrrev_b32_e64 v24, 1, v20
  v_lshl_add_u32 v42, v24, 8, s46
  v_and_b32_e64 v24, 1, v20
  v_lshl_add_u32 v42, v24, 4, v42
  s_mov_b64 exec, 0x3ffff
  global_store_dwordx4 v42, v[48:51], s[30:31]
  s_mov_b64 exec, -1
  s_mov_b32 s43, 2
  s_add_u32 s68, s42, 48
  s_mul_i32 s44, s68, 384
  s_add_u32 s32, s4, s44
  s_addc_u32 s33, s5, 0
  global_load_dwordx2 v[68:69], v26, s[32:33]
  global_load_dwordx2 v[70:71], v27, s[32:33]
  s_setprio 0
  s_getpc_b64 s[82:83]
L_pc113:
  s_lshl_b32 s44, s2, 6
  s_add_u32 s44, s44, L_order-L_pc113
  s_add_u32 s82, s82, s44
  s_addc_u32 s83, s83, 0
  s_load_dwordx2 s[92:93], s[82:83], 0
  s_load_dwordx2 s[96:97], s[82:83], 8
  s_mov_b32 s94, 4000000
  s_and_b32 s41, s2, 7
  s_lshl_b32 s41, s41, 1
  s_bitcmp1_b32 s2, 3
  s_addc_u32 s41, s41, 0
  s_load_dword s3, s[82:83], 24
  s_load_dwordx2 s[98:99], s[82:83], 16
  s_waitcnt vmcnt(0)
  ds_write_b32 v14, v38 offset:24
  s_waitcnt lgkmcnt(0)
  v_min_u32 v22, 2, v20
  v_lshlrev_b32 v23, 3, v22
  v_bfe_u32 v23, s99, v23, 8
  v_mul_u32_u24 v36, 4352, v23
  v_add_u32 v36, 7340032, v36
  v_and_b32 v23, 15, v23
  v_lshlrev_b32 v37, 4, v23
  v_lshl_add_u32 v22, v22, 4, s42
  v_mul_u32_u24 v45, 4352, v22
  v_add_u32 v45, 7340032, v45
  s_and_b32 s45, s81, 2
  s_lshl_b32 s44, s45, 9
  s_add_u32 s44, s44, s46
  v_add_u32 v44, s44, v20
  s_lshl_b32 s45, s45, 1
  s_add_u32 s46, s46, s45
  s_add_u32 s46, s46, 2048
  v_mov_b32_e64 v43, s46
  v_mul_u32_u24 v39, 384, v20
  v_add_u32 v39, 7864320, v39
  v_mov_b32 v40, 0
  s_mov_b32 s47, 0
  s_mov_b32 s90, 0
  s_mov_b32 s80, 0
  v_add_u32 v33, 0, v20
  s_and_b32 s44, s41, 1
  v_add_u32_e64 v23, s44, v33
  v_cmp_le_u32 vcc, 43, v23
  s_add_u32 s45, s44, 42
  v_mov_b32 v24, s45
  v_cndmask_b32 v24, 0, v24, vcc
  v_cmp_le_u32 vcc, 86, v23
  v_add_u32 v22, v33, v24
  s_sub_u32 s45, 43, s44
  v_mov_b32 v24, s45
  v_cndmask_b32 v24, 0, v24, vcc
  s_mul_i32 s44, s44, 43
  s_lshr_b32 s45, s41, 1
  s_lshl_b32 s45, s45, 8
  s_add_u32 s44, s44, s45
  v_add3_u32 v22, v22, v24, s44
  v_and_b32 v33, 255, v22
  v_lshlrev_b32 v33, 1, v33
  v_add_u32 v34, 64, v20
  s_and_b32 s44, s41, 1
  v_add_u32 v23, s44, v34
  v_cmp_le_u32 vcc, 43, v23
  s_add_u32 s45, s44, 42
  v_mov_b32 v24, s45
  v_cndmask_b32 v24, 0, v24, vcc
  v_cmp_le_u32 vcc, 86, v23
  v_add_u32 v22, v34, v24
  s_sub_u32 s45, 43, s44
  v_mov_b32 v24, s45
  v_cndmask_b32 v24, 0, v24, vcc
  s_mul_i32 s44, s44, 43
  s_lshr_b32 s45, s41, 1
  s_lshl_b32 s45, s45, 8
  s_add_u32 s44, s44, s45
  v_add3_u32 v22, v22, v24, s44
  v_and_b32 v34, 255, v22
  v_lshlrev_b32 v34, 1, v34
  v_lshlrev_b32 v46, 2, v20
  v_mul_u32_u24_e64 v199, 12, v20
  v_add_u32 v199, 45568, v199
  s_mov_b32 s101, 0
  v_mov_b32 v47, 118912
  v_mov_b32 v51, -1
  v_mov_b32 v60, 0
  v_mov_b32 v61, 0
  v_mov_b32 v62, 0
  v_mov_b32 v63, 0
  v_mov_b32 v64, 0
  v_mov_b32 v65, 0
  v_mov_b32 v66, 0
  v_mov_b32 v67, 0
  s_and_b32 s45, s2, 7
  s_lshl_b32 s45, s45, 9
  v_and_b32_e64 v22, 31, v20
  v_lshl_add_u32 v22, v22, 4, s45
  v_lshrrev_b32_e64 v23, 5, v20
  v_lshl_add_u32 v22, v23, 16, v22
  v_lshlrev_b32 v23, 2, v23
  s_lshr_b32 s44, s96, 0
  v_bfe_u32 v24, s44, v23, 4
  v_lshl_add_u32 v188, v24, 12, v22
  v_add_u32 v22, 0x20000, v22
  s_lshr_b32 s44, s96, 8
  v_bfe_u32 v24, s44, v23, 4
  v_lshl_add_u32 v189, v24, 12, v22
  v_add_u32 v22, 0x20000, v22
  s_lshr_b32 s44, s96, 16
  v_bfe_u32 v24, s44, v23, 4
  v_lshl_add_u32 v190, v24, 12, v22
  v_add_u32 v22, 0x20000, v22
  s_lshr_b32 s44, s96, 24
  v_bfe_u32 v24, s44, v23, 4
  v_lshl_add_u32 v191, v24, 12, v22
  v_add_u32 v22, 0x20000, v22
  s_lshr_b32 s44, s97, 0
  v_bfe_u32 v24, s44, v23, 4
  v_lshl_add_u32 v192, v24, 12, v22
  v_add_u32 v22, 0x20000, v22
  s_lshr_b32 s44, s97, 8
  v_bfe_u32 v24, s44, v23, 4
  v_lshl_add_u32 v193, v24, 12, v22
  v_add_u32 v22, 0x20000, v22
  s_lshr_b32 s44, s97, 16
  v_bfe_u32 v24, s44, v23, 4
  v_lshl_add_u32 v194, v24, 12, v22
  v_add_u32 v22, 0x20000, v22
  s_lshr_b32 s44, s97, 24
  v_bfe_u32 v24, s44, v23, 4
  v_lshl_add_u32 v195, v24, 12, v22
  s_mov_b32 s69, 0
  s_movk_i32 m0, 4608
  s_branch L_hq_nl
L_hk:
  s_sub_u32 s47, s43, 1
L_hsw:
  ds_read_b128 v[104:107], v14 offset:0
  s_waitcnt lgkmcnt(0)
  v_min_u32_e64 v104, v104, v105
  v_min3_u32 v104, v104, v106, v107
  s_nop 0
  v_readfirstlane_b32 s46, v104
  s_cmp_ge_u32 s46, s47
  s_cbranch_scc1 L_hsw_ok
  s_cmp_eq_u32 s94, 0
  s_cbranch_scc1 L_hsw_ok
  s_sub_u32 s94, s94, 1
  s_sleep 1
  s_branch L_hsw
L_hsw_ok:
  s_bitcmp1_b32 s80, s47
  s_cbranch_scc0 L_fas
  s_mul_i32 s44, s47, 384
  s_add_u32 s44, s44, 7864320
  s_movk_i32 s78, 1
  s_atomic_add s78, s[30:31], s44 glc
  s_mov_b64 exec, 1
  global_load_dword v41, v43, s[30:31] offset:8 sc1
  s_mov_b64 exec, -1
L_fas:
  s_cmp_lt_u32 s43, 6
  s_cbranch_scc1 L_hs_done
  s_add_u32 s68, s69, 2
  s_min_u32 s68, s68, s47
L_hs:
  ds_read_u16_d16_hi v60, v33 offset:4608
  ds_read_u16_d16_hi v61, v34 offset:4608
  ds_read_u16_d16_hi v62, v33 offset:12800
  ds_read_u16_d16_hi v63, v34 offset:12800
  ds_read_u16_d16_hi v64, v33 offset:20992
  ds_read_u16_d16_hi v65, v34 offset:20992
  ds_read_u16_d16_hi v66, v33 offset:29184
  ds_read_u16_d16_hi v67, v34 offset:29184
  v_add_u32_e64 v200, s101, v199
  v_add_u32 v201, 1536, v200
  s_addk_i32 s101, 3072
  s_cmpk_eq_u32 s101, 18432
  s_cselect_b32 s101, 0, s101
  s_add_u32 s69, s69, 1
  s_waitcnt lgkmcnt(4)
  ds_read2_b32 v[76:77], v200 offset0:0 offset1:1
  ds_read_b32 v72, v200 offset:8
  ds_read2_b32 v[78:79], v200 offset0:192 offset1:193
  ds_read_b32 v73, v200 offset:776
  ds_read2_b32 v[80:81], v201 offset0:0 offset1:1
  ds_read_b32 v74, v201 offset:8
  ds_read2_b32 v[82:83], v201 offset0:192 offset1:193
  ds_read_b32 v75, v201 offset:776
  s_waitcnt lgkmcnt(0)
  v_add_f32 v76, v76, v77
  v_add_f32 v78, v78, v79
  v_add_f32 v80, v80, v81
  v_add_f32 v82, v82, v83
  v_add_f32 v72, v72, v76
  v_add_f32 v73, v73, v78
  v_add_f32 v74, v74, v80
  v_add_f32 v75, v75, v82
  v_fma_f32 v72, -v62, v74, v72
  v_fma_f32 v73, -v63, v75, v73
  v_mul_f32 v74, s67, v60
  v_mul_f32 v75, s67, v61
  v_mul_f32 v72, v72, v74
  v_mul_f32 v73, v73, v75
  v_max_f32 v48, v72, v73
  s_nop 1
  v_max_f32_dpp v48, v48, v48 row_ror:8 row_mask:0xf bank_mask:0xf
  s_nop 1
  v_max_f32_dpp v48, v48, v48 row_ror:4 row_mask:0xf bank_mask:0xf
  s_nop 1
  v_max_f32_dpp v48, v48, v48 row_ror:2 row_mask:0xf bank_mask:0xf
  s_nop 1
  v_max_f32_dpp v48, v48, v48 row_ror:1 row_mask:0xf bank_mask:0xf
  v_mov_b32 v22, v48
  s_nop 1
  v_permlane16_swap_b32 v48, v22
  v_max_f32 v48, v48, v22
  v_mov_b32 v22, v48
  s_nop 1
  v_permlane32_swap_b32 v48, v22
  v_max_f32 v48, v48, v22
  v_sub_f32 v72, v72, v48
  v_sub_f32 v73, v73, v48
  v_exp_f32 v72, v72
  v_exp_f32 v73, v73
  s_nop 0
  v_add_f32 v49, v72, v73
  v_mul_f32 v72, v72, v64
  v_mul_f32 v73, v73, v65
  v_mul_f32 v50, v72, v66
  v_fmac_f32_e64 v50, v73, v67
  ds_write_b32 v46, v72 offset:37376
  ds_write_b32 v46, v73 offset:37632
  s_nop 1
  v_add_f32_dpp v49, v49, v49 row_ror:8 row_mask:0xf bank_mask:0xf
  s_nop 1
  v_add_f32_dpp v49, v49, v49 row_ror:4 row_mask:0xf bank_mask:0xf
  s_nop 1
  v_add_f32_dpp v49, v49, v49 row_ror:2 row_mask:0xf bank_mask:0xf
  s_nop 1
  v_add_f32_dpp v49, v49, v49 row_ror:1 row_mask:0xf bank_mask:0xf
  v_mov_b32 v22, v49
  s_nop 1
  v_permlane16_swap_b32 v49, v22
  v_add_f32 v49, v49, v22
  v_mov_b32_e64 v22, v49
  s_nop 1
  v_permlane32_swap_b32 v49, v22
  v_add_f32 v49, v49, v22
  s_nop 1
  v_add_f32_dpp v50, v50, v50 row_ror:8 row_mask:0xf bank_mask:0xf
  s_nop 1
  v_add_f32_dpp v50, v50, v50 row_ror:4 row_mask:0xf bank_mask:0xf
  s_nop 1
  v_add_f32_dpp v50, v50, v50 row_ror:2 row_mask:0xf bank_mask:0xf
  s_nop 1
  v_add_f32_dpp v50, v50, v50 row_ror:1 row_mask:0xf bank_mask:0xf
  v_mov_b32 v22, v50
  s_nop 1
  v_permlane16_swap_b32 v50, v22
  v_add_f32 v50, v50, v22
  v_mov_b32 v22, v50
  s_nop 1
  v_permlane32_swap_b32 v50, v22
  v_add_f32 v50, v50, v22
  v_mov_b32 v22, s69
  ds_write_b128 v47, v[48:51]
  ds_write_b32 v14, v22 offset:20
  v_add_u32 v46, 512, v46
  v_add_u32_e64 v47, 16, v47
  v_add_u32 v33, 512, v33
  v_add_u32 v34, 512, v34
  s_cmp_lt_u32 s69, s68
  s_cbranch_scc1 L_hs
L_hs_done:
  s_bitcmp1_b32 s80, s47
  s_cbranch_scc0 L_fbs
  s_waitcnt vmcnt(0) lgkmcnt(0)
  v_readlane_b32 s46, v40, s47
  s_sub_u32 s78, s78, s46
  s_bfe_u32 s46, s78, 0x80000
  s_min_u32 s46, s46, 15
  s_lshl_b32 s46, s46, 1
  s_sub_u32 s46, s46, 15
  v_readfirstlane_b32 s95, v41
  s_mul_i32 s45, s46, 6
  s_ashr_i32 s44, s95, 3
  s_sub_u32 s95, s95, s44
  s_cmp_lt_i32 s46, 0
  s_cselect_b32 s95, s95, 0
  s_cselect_b32 s45, -48, 0
  s_add_u32 s45, s45, s95
  v_mov_b32_e64 v41, s45
  s_lshl4_add_u32 s46, s46, s95
  s_cmp_gt_i32 s46, 0
  s_cselect_b32 s44, 3, 6
  s_mul_i32 s46, s46, s44
  s_add_u32 s46, s46, 128
  s_ashr_i32 s46, s46, 8
  v_mov_b32_e64 v42, s46
  s_mov_b64 exec, 1
  global_store_dword v43, v42, s[30:31]
  global_store_dword v43, v41, s[30:31] offset:8
  s_mov_b64 exec, -1
L_fbs:
  s_cmp_eq_u32 s47, 1
  s_cbranch_scc0 L_el
  s_bitcmp0_b32 s81, 0
  s_cbranch_scc0 L_el
  s_mov_b64 exec, 0xffff
  global_load_ubyte v42, v44, s[30:31] sc1
  s_waitcnt vmcnt(0)
  v_cmp_ne_u32 s[64:65], 0, v42
  s_lshr_b32 s44, s64, s79
  s_bcnt1_i32_b32 s44, s44
  s_sub_u32 s45, s44, 1
  s_cmp_lt_u32 s45, 7
  s_cbranch_scc0 L_el
  s_lshl_b32 s80, 0x10204081, s45
  s_and_b32 s80, s80, 0x7ffffffc
  s_mov_b32 exec_lo, s80
  global_load_dword v40, v39, s[30:31] sc1
L_el:
  s_mov_b64 exec, -1
L_hq:
  s_add_u32 s43, s43, 1
  s_sub_u32 s44, s43, 4
  s_cmp_gt_u32 s44, 12
  s_cbranch_scc1 L_hq_nl
  s_waitcnt vmcnt(0)
  v_lshlrev_b32 v76, 16, v68
  v_and_b32 v77, s66, v68
  v_lshlrev_b32 v78, 16, v69
  v_and_b32 v79, s66, v69
  v_lshlrev_b32 v80, 16, v70
  v_and_b32 v81, s66, v70
  v_lshlrev_b32 v82, 16, v71
  v_and_b32 v83, s66, v71
  v_mul_f32 v76, v76, v52
  v_mul_f32 v77, v77, v53
  v_mul_f32 v78, v78, v54
  v_mul_f32 v79, v79, v55
  v_mul_f32 v80, v80, v56
  v_mul_f32 v81, v81, v57
  v_mul_f32 v82, v82, v58
  v_mul_f32 v83, v83, v59
  v_cvt_pk_bf16_f32 v84, v76, v80
  v_cvt_pk_bf16_f32 v85, v77, v81
  v_cvt_pk_bf16_f32 v86, v78, v82
  v_cvt_pk_bf16_f32 v87, v79, v83
  v_lshlrev_b32 v76, 16, v84
  v_and_b32 v80, s66, v84
  v_lshlrev_b32 v77, 16, v85
  v_and_b32 v81, s66, v85
  v_lshlrev_b32 v78, 16, v86
  v_and_b32 v82, s66, v86
  v_lshlrev_b32 v79, 16, v87
  v_and_b32 v83, s66, v87
  v_fma_f32 v76, v80, v30, v76
  v_fma_f32 v77, v81, v30, v77
  v_fma_f32 v78, v82, v30, v78
  v_fma_f32 v79, v83, v30, v79
  v_cvt_pk_bf16_f32 v84, v76, v77
  v_cvt_pk_bf16_f32 v85, v78, v79
  v_xor_b32 v86, v31, v84
  v_xor_b32 v87, v31, v85
  v_mov_b32_e64 v22, s43
  ds_write_b16 v28, v84 offset:512
  ds_write_b16_d16_hi v28, v84 offset:516
  ds_write_b16 v28, v85 offset:520
  ds_write_b16_d16_hi v28, v85 offset:524
  ds_write_b16 v29, v86 offset:514
  ds_write_b16_d16_hi v29, v86 offset:518
  ds_write_b16 v29, v87 offset:522
  ds_write_b16_d16_hi v29, v87 offset:526
  ds_write_b32 v14, v22 offset:16
  v_add_u32 v28, 1024, v28
  v_add_u32 v29, 1024, v29
  v_and_b32 v28, 0xfff, v28
  v_and_b32 v29, 0xfff, v29
  s_cmp_eq_u32 s43, 16
  s_cbranch_scc1 L_hq_nl
  s_lshl_b32 s44, s43, 2
  s_lshr_b64 s[64:65], s[96:97], s44
  s_and_b32 s64, s64, 15
  s_lshl4_add_u32 s68, s43, s64
  s_mul_i32 s44, s68, 384
  s_add_u32 s32, s4, s44
  s_addc_u32 s33, s5, 0
  global_load_dwordx2 v[68:69], v26, s[32:33]
  global_load_dwordx2 v[70:71], v27, s[32:33]
L_hq_nl:
  s_sub_u32 s44, s43, 5
  s_cmp_lt_u32 s44, 2
  s_cbranch_scc0 L_sc_done
  global_load_lds_dwordx4 v188, s[8:9]
  s_addk_i32 m0, 1024
  s_waitcnt vmcnt(3)
  global_load_lds_dwordx4 v189, s[8:9]
  s_addk_i32 m0, 1024
  s_waitcnt vmcnt(3)
  global_load_lds_dwordx4 v190, s[8:9]
  s_addk_i32 m0, 1024
  s_waitcnt vmcnt(3)
  global_load_lds_dwordx4 v191, s[8:9]
  s_addk_i32 m0, 1024
  s_waitcnt vmcnt(3)
  global_load_lds_dwordx4 v192, s[8:9]
  s_addk_i32 m0, 1024
  s_waitcnt vmcnt(3)
  global_load_lds_dwordx4 v193, s[8:9]
  s_addk_i32 m0, 1024
  s_waitcnt vmcnt(3)
  global_load_lds_dwordx4 v194, s[8:9]
  s_addk_i32 m0, 1024
  s_waitcnt vmcnt(3)
  global_load_lds_dwordx4 v195, s[8:9]
  s_addk_i32 m0, 1024
  s_mov_b64 s[8:9], s[10:11]
  s_mov_b64 s[10:11], s[14:15]
  s_mov_b64 s[14:15], s[16:17]
  s_waitcnt vmcnt(3)
  global_load_lds_dwordx4 v188, s[8:9]
  s_addk_i32 m0, 1024
  s_waitcnt vmcnt(3)
  global_load_lds_dwordx4 v189, s[8:9]
  s_addk_i32 m0, 1024
  s_waitcnt vmcnt(3)
  global_load_lds_dwordx4 v190, s[8:9]
  s_addk_i32 m0, 1024
  s_waitcnt vmcnt(3)
  global_load_lds_dwordx4 v191, s[8:9]
  s_addk_i32 m0, 1024
  s_waitcnt vmcnt(3)
  global_load_lds_dwordx4 v192, s[8:9]
  s_addk_i32 m0, 1024
  s_waitcnt vmcnt(3)
  global_load_lds_dwordx4 v193, s[8:9]
  s_addk_i32 m0, 1024
  s_waitcnt vmcnt(3)
  global_load_lds_dwordx4 v194, s[8:9]
  s_addk_i32 m0, 1024
  s_waitcnt vmcnt(3)
  global_load_lds_dwordx4 v195, s[8:9]
  s_addk_i32 m0, 1024
  s_mov_b64 s[8:9], s[10:11]
  s_mov_b64 s[10:11], s[14:15]
  s_mov_b64 s[14:15], s[16:17]
  s_cmp_eq_u32 s43, 6
  s_cbranch_scc0 L_sc_done
  s_waitcnt vmcnt(0)
L_sc_done:
  s_cmp_eq_u32 s43, 16
  s_cbranch_scc0 L_hq_skip
  s_cmp_eq_u32 s3, 0
  s_cbranch_scc0 L_hq_skip
  s_mov_b64 exec, 7
  global_store_dword v45, v14, s[30:31] sc1
  s_waitcnt vmcnt(0)
  s_mov_b64 exec, 1
  global_store_dword v37, v38, s[28:29] sc1
  s_mov_b64 exec, -1
L_hq_skip:
  s_waitcnt lgkmcnt(0)
  s_cmp_lt_u32 s43, 18
  s_cbranch_scc1 L_hk
  v_and_b32 v24, 15, v20
  v_lshlrev_b32 v24, 1, v24
  global_load_ushort v25, v24, s[82:83] offset:32
  s_mov_b32 s43, 0
  v_min_u32 v28, 23, v20
  v_lshlrev_b32_e64 v28, 4, v28
  v_lshlrev_b32 v22, 1, v28
  s_and_b32 s44, s41, 1
  v_lshl_add_u32 v196, s44, 8, v22
  v_subrev_u32 v197, 768, v196
  v_min_u32_e64 v196, v196, v197
  v_subrev_u32 v29, 256, v196
  v_add_u32 v197, 512, v196
  v_min_u32_e64 v197, v29, v197
  v_subrev_u32 v29, 512, v196
  v_add_u32 v198, 256, v196
  v_min_u32_e64 v198, v29, v198
  v_add_u32 v196, 64000, v196
  v_add_u32 v197, 64000, v197
  v_add_u32 v198, 64000, v198
  v_add_u32 v28, 113152, v28
  v_lshlrev_b32_e64 v32, 4, v20
  v_add_u32 v30, 113152, v32
  v_cmp_gt_u32 vcc, 24, v20
  v_lshrrev_b32 v21, 1, v35
  s_mul_i32 s44, s98, 384
  s_add_u32 s26, s26, s44
  s_addc_u32 s27, s27, 0
  v_mov_b32_e64 v31, s2
  v_mul_u32_u24 v31, 6144, v31
  v_add_u32 v31, 8388608, v31
  v_add_u32 v23, 0, v32
  v_add_u32 v188, v23, v31
  v_add_u32 v23, 1024, v32
  v_add_u32_e64 v189, v23, v31
  v_add_u32 v23, 2048, v32
  v_add_u32_e64 v190, v23, v31
  v_add_u32 v23, 3072, v32
  v_add_u32_e64 v191, v23, v31
  v_add_u32 v23, 4096, v32
  v_add_u32_e64 v192, v23, v31
  v_add_u32 v23, 5120, v32
  v_add_u32_e64 v193, v23, v31
  s_mov_b32 s45, 14
  s_lshl_b32 s68, s45, 2
  s_lshr_b64 s[64:65], s[92:93], s68
  s_and_b32 s68, s64, 15
  v_lshl_add_u32 v23, s68, 4, v32
  v_cndmask_b32 v23, v23, v32, vcc
  v_add_u32 v23, 5376, v23
  v_add_u32 v168, v23, v31
  s_waitcnt vmcnt(0)
  v_lshrrev_b32 v31, 4, v25
  v_mul_u32_u24 v31, 6144, v31
  v_add_u32 v31, 8388608, v31
  v_and_b32_e64 v25, 15, v25
  v_mul_u32_u24 v25, 384, v25
  s_lshl4_add_u32 s44, s3, 5760
  v_mov_b32 v23, s44
  v_add_u32 v187, v23, v31
  v_add_u32_dpp v23, v25, v21 row_newbcast:0 row_mask:0xf bank_mask:0xf
  v_mov_b32_dpp v29, v31 row_newbcast:0 row_mask:0xf bank_mask:0xf
  v_add_u32_e64 v172, v23, v29
  v_add_u32_dpp v23, v25, v21 row_newbcast:1 row_mask:0xf bank_mask:0xf
  v_mov_b32_dpp v29, v31 row_newbcast:1 row_mask:0xf bank_mask:0xf
  v_add_u32_e64 v173, v23, v29
  v_add_u32_dpp v23, v25, v21 row_newbcast:2 row_mask:0xf bank_mask:0xf
  v_mov_b32_dpp v29, v31 row_newbcast:2 row_mask:0xf bank_mask:0xf
  v_add_u32_e64 v174, v23, v29
  v_add_u32_dpp v23, v25, v21 row_newbcast:3 row_mask:0xf bank_mask:0xf
  v_mov_b32_dpp v29, v31 row_newbcast:3 row_mask:0xf bank_mask:0xf
  v_add_u32_e64 v175, v23, v29
  v_add_u32_dpp v23, v25, v21 row_newbcast:4 row_mask:0xf bank_mask:0xf
  v_mov_b32_dpp v29, v31 row_newbcast:4 row_mask:0xf bank_mask:0xf
  v_add_u32_e64 v176, v23, v29
  v_add_u32_dpp v23, v25, v21 row_newbcast:5 row_mask:0xf bank_mask:0xf
  v_mov_b32_dpp v29, v31 row_newbcast:5 row_mask:0xf bank_mask:0xf
  v_add_u32_e64 v177, v23, v29
  v_add_u32_dpp v23, v25, v21 row_newbcast:6 row_mask:0xf bank_mask:0xf
  v_mov_b32_dpp v29, v31 row_newbcast:6 row_mask:0xf bank_mask:0xf
  v_add_u32_e64 v178, v23, v29
  v_add_u32_dpp v23, v25, v21 row_newbcast:7 row_mask:0xf bank_mask:0xf
  v_mov_b32_dpp v29, v31 row_newbcast:7 row_mask:0xf bank_mask:0xf
  v_add_u32_e64 v179, v23, v29
  v_add_u32_dpp v23, v25, v21 row_newbcast:8 row_mask:0xf bank_mask:0xf
  v_mov_b32_dpp v29, v31 row_newbcast:8 row_mask:0xf bank_mask:0xf
  v_add_u32_e64 v180, v23, v29
  v_add_u32_dpp v23, v25, v21 row_newbcast:9 row_mask:0xf bank_mask:0xf
  v_mov_b32_dpp v29, v31 row_newbcast:9 row_mask:0xf bank_mask:0xf
  v_add_u32_e64 v181, v23, v29
  v_add_u32_dpp v23, v25, v21 row_newbcast:10 row_mask:0xf bank_mask:0xf
  v_mov_b32_dpp v29, v31 row_newbcast:10 row_mask:0xf bank_mask:0xf
  v_add_u32_e64 v182, v23, v29
  v_add_u32_dpp v23, v25, v21 row_newbcast:11 row_mask:0xf bank_mask:0xf
  v_mov_b32_dpp v29, v31 row_newbcast:11 row_mask:0xf bank_mask:0xf
  v_add_u32_e64 v183, v23, v29
  v_add_u32_dpp v23, v25, v21 row_newbcast:12 row_mask:0xf bank_mask:0xf
  v_mov_b32_dpp v29, v31 row_newbcast:12 row_mask:0xf bank_mask:0xf
  v_add_u32_e64 v184, v23, v29
  v_add_u32_dpp v23, v25, v21 row_newbcast:13 row_mask:0xf bank_mask:0xf
  v_mov_b32_dpp v29, v31 row_newbcast:13 row_mask:0xf bank_mask:0xf
  v_add_u32_e64 v185, v23, v29
  v_add_u32_dpp v23, v25, v21 row_newbcast:14 row_mask:0xf bank_mask:0xf
  v_mov_b32_dpp v29, v31 row_newbcast:14 row_mask:0xf bank_mask:0xf
  v_add_u32 v186, v23, v29
  v_mov_b32 v108, -1
  v_mov_b32 v109, -1
  v_mov_b32 v110, -1
  v_mov_b32_e64 v111, -1
  s_lshl4_add_u32 s44, s3, 118912
  v_mov_b32_e64 v23, s44
  ds_write_b128 v28, v[108:111] offset:5376
  ds_write_b32 v23, v38 offset:12
L_hp:
  s_min_u32 s44, s3, 13
  s_cmp_eq_u32 s44, s43
  s_cbranch_scc0 L_hc_ok
L_hc:
  global_load_dword v104, v37, s[28:29] sc1
  s_waitcnt vmcnt(0)
  v_cmp_ne_u32 s[64:65], 1, v104
  s_cmp_eq_u64 s[64:65], 0
  s_cbranch_scc1 L_hc_ok
  s_cmp_eq_u32 s94, 0
  s_cbranch_scc1 L_hc_ok
  s_sub_u32 s94, s94, 1
  s_sleep 64
  s_branch L_hc
L_hc_ok:
  s_lshl_b32 s68, s43, 2
  s_lshr_b64 s[64:65], s[92:93], s68
  s_and_b32 s68, s64, 15
  s_lshl4_add_u32 s44, s68, 118912
  v_mov_b32_e64 v23, s44
  s_cmp_eq_u32 s43, 14
  s_cbranch_scc0 L_hp_mid
  ds_read_b128 v[144:147], v30 offset:0
  ds_read_b128 v[148:151], v30 offset:1024
  ds_read_b128 v[152:155], v30 offset:2048
  ds_read_b128 v[156:159], v30 offset:3072
  ds_read_b128 v[160:163], v30 offset:4096
  ds_read_b128 v[164:167], v30 offset:5120
L_hm:
  ds_read_b32 v104, v14 offset:24
  s_waitcnt lgkmcnt(0)
  v_readfirstlane_b32 s46, v104
  s_cmp_ge_u32 s46, 30
  s_cbranch_scc1 L_hm_ok
  s_cmp_eq_u32 s94, 0
  s_cbranch_scc1 L_hm_ok
  s_sub_u32 s94, s94, 1
  s_sleep 1
  s_branch L_hm
L_hm_ok:
  global_store_dwordx4 v188, v[144:147], s[30:31] sc1
  global_store_dwordx4 v189, v[148:151], s[30:31] sc1
  global_store_dwordx4 v190, v[152:155], s[30:31] sc1
  global_store_dwordx4 v191, v[156:159], s[30:31] sc1
  global_store_dwordx4 v192, v[160:163], s[30:31] sc1
  s_mov_b32 exec_hi, 0xffffff
  global_store_dwordx4 v193, v[164:167], s[30:31] sc1
  s_mov_b64 exec, 7
  s_waitcnt vmcnt(0)
  global_atomic_add v36, v38, s[30:31] sc1
  s_mov_b64 exec, -1
L_hp_mid:
  s_add_u32 s43, s43, 1
  s_add_u32 s47, s43, 16
L_hpw:
  ds_read_b128 v[104:107], v14 offset:0
  s_waitcnt lgkmcnt(0)
  v_min_u32 v104, v104, v105
  v_min3_u32 v104, v104, v106, v107
  s_nop 0
  v_readfirstlane_b32 s46, v104
  s_cmp_ge_u32 s46, s47
  s_cbranch_scc1 L_hpw_ok
  s_cmp_eq_u32 s94, 0
  s_cbranch_scc1 L_hpw_ok
  s_sub_u32 s94, s94, 1
  s_sleep 1
  s_branch L_hpw
L_hpw_ok:
  s_bitcmp1_b32 s80, s47
  s_cbranch_scc0 L_fap
  s_mul_i32 s44, s47, 384
  s_add_u32 s44, s44, 7864320
  s_movk_i32 s78, 1
  s_atomic_add s78, s[30:31], s44 glc
  s_mov_b64 exec, 1
  global_load_dword v41, v43, s[30:31] offset:8 sc1
  s_mov_b64 exec, -1
L_fap:
  ds_read_b128 v[72:75], v196 offset:0
  ds_read_b128 v[76:79], v196 offset:16
  ds_read_b128 v[80:83], v197 offset:768
  ds_read_b128 v[84:87], v197 offset:784
  ds_read_b128 v[88:91], v197 offset:1536
  ds_read_b128 v[92:95], v197 offset:1552
  ds_read_b128 v[96:99], v198 offset:2304
  ds_read_b128 v[100:103], v198 offset:2320
  ds_read_b128 v[48:51], v23
  s_waitcnt lgkmcnt(0)
  v_pk_add_f32 v[72:73], v[72:73], v[80:81]
  v_pk_add_f32 v[88:89], v[88:89], v[96:97]
  v_pk_add_f32 v[74:75], v[74:75], v[82:83]
  v_pk_add_f32 v[90:91], v[90:91], v[98:99]
  v_pk_add_f32 v[76:77], v[76:77], v[84:85]
  v_pk_add_f32 v[92:93], v[92:93], v[100:101]
  v_pk_add_f32 v[78:79], v[78:79], v[86:87]
  v_pk_add_f32 v[94:95], v[94:95], v[102:103]
  v_pk_add_f32 v[72:73], v[72:73], v[88:89]
  v_pk_add_f32 v[74:75], v[74:75], v[90:91]
  v_pk_add_f32 v[76:77], v[76:77], v[92:93]
  v_pk_add_f32 v[78:79], v[78:79], v[94:95]
  v_pk_add_f32 v[72:73], v[72:73], v[50:51] op_sel_hi:[1,0] neg_lo:[0,1] neg_hi:[0,1]
  v_pk_add_f32 v[74:75], v[74:75], v[50:51] op_sel_hi:[1,0] neg_lo:[0,1] neg_hi:[0,1]
  v_pk_add_f32 v[76:77], v[76:77], v[50:51] op_sel_hi:[1,0] neg_lo:[0,1] neg_hi:[0,1]
  v_pk_add_f32 v[78:79], v[78:79], v[50:51] op_sel_hi:[1,0] neg_lo:[0,1] neg_hi:[0,1]
  v_max3_f32 v25, |v72|, |v73|, |v74|
  v_max3_f32 v25, v25, |v75|, |v76|
  v_max3_f32 v25, v25, |v77|, |v78|
  v_max_f32_e64 v25, v25, |v79|
  s_nop 1
  v_max_f32_dpp v25, v25, v25 row_ror:8 row_mask:0xf bank_mask:0xf
  s_nop 1
  v_max_f32_dpp v25, v25, v25 row_ror:4 row_mask:0xf bank_mask:0xf
  s_nop 1
  v_max_f32_dpp v25, v25, v25 row_ror:2 row_mask:0xf bank_mask:0xf
  s_nop 1
  v_max_f32_dpp v25, v25, v25 row_ror:1 row_mask:0xf bank_mask:0xf
  v_mov_b32 v29, v25
  s_nop 1
  v_permlane16_swap_b32 v25, v29
  v_max_f32 v25, v25, v29
  v_mov_b32 v29, v25
  s_nop 1
  v_permlane32_swap_b32 v25, v29
  v_max_f32 v25, v25, v29
  v_frexp_exp_i32_f32 v25, v25
  v_sub_u32_e64 v29, 14, v25
  v_add_u32 v51, 242, v25
  v_ldexp_f32 v72, v72, v29
  v_ldexp_f32 v73, v73, v29
  v_ldexp_f32 v74, v74, v29
  v_ldexp_f32 v75, v75, v29
  v_ldexp_f32 v76, v76, v29
  v_ldexp_f32 v77, v77, v29
  v_ldexp_f32 v78, v78, v29
  v_ldexp_f32 v79, v79, v29
  v_cvt_pk_f16_f32 v108, v72, v73
  v_cvt_pk_f16_f32 v109, v74, v75
  v_cvt_pk_f16_f32 v110, v76, v77
  v_cvt_pk_f16_f32 v111, v78, v79
  v_min_u32 v108, -2, v108
  v_min_u32 v109, -2, v109
  v_min_u32 v110, -2, v110
  v_min_u32 v111, -2, v111
  s_cmp_eq_u32 s43, 15
  s_cbranch_scc1 L_hp_last
  ds_write_b32 v23, v51 offset:12
  v_add_u32 v196, 3072, v196
  v_add_u32 v197, 3072, v197
  v_add_u32 v198, 3072, v198
  ds_write_b128 v28, v[108:111]
  v_add_u32 v28, 384, v28
  s_bitcmp1_b32 s80, s47
  s_cbranch_scc0 L_fbp
  s_waitcnt vmcnt(0) lgkmcnt(0)
  v_readlane_b32 s46, v40, s47
  s_sub_u32 s78, s78, s46
  s_bfe_u32 s46, s78, 0x80000
  s_min_u32 s46, s46, 15
  s_lshl_b32 s46, s46, 1
  s_sub_u32 s46, s46, 15
  v_readfirstlane_b32 s95, v41
  s_mul_i32 s45, s46, 6
  s_ashr_i32 s44, s95, 3
  s_sub_u32 s95, s95, s44
  s_cmp_lt_i32 s46, 0
  s_cselect_b32 s95, s95, 0
  s_cselect_b32 s45, -48, 0
  s_add_u32 s45, s45, s95
  v_mov_b32_e64 v41, s45
  s_lshl4_add_u32 s46, s46, s95
  s_cmp_gt_i32 s46, 0
  s_cselect_b32 s44, 3, 6
  s_mul_i32 s46, s46, s44
  s_add_u32 s46, s46, 128
  s_ashr_i32 s46, s46, 8
  v_mov_b32_e64 v42, s46
  s_mov_b64 exec, 1
  global_store_dword v43, v42, s[30:31]
  global_store_dword v43, v41, s[30:31] offset:8
  s_mov_b64 exec, -1
L_fbp:
  s_branch L_hp
L_hp_last:
  v_cndmask_b32 v108, v48, v108, vcc
  v_cndmask_b32 v109, v49, v109, vcc
  v_cndmask_b32 v110, v50, v110, vcc
  v_cndmask_b32 v111, v51, v111, vcc
  s_mov_b64 exec, 0x1ffffff
  global_store_dwordx4 v168, v[108:111], s[30:31] sc1
  s_mov_b64 exec, -1
  s_and_b32 s44, s41, 1
  v_lshl_add_u32 v196, s44, 8, v35
  v_subrev_u32 v197, 768, v196
  v_min_u32_e64 v196, v196, v197
  v_subrev_u32 v29, 256, v196
  v_add_u32 v197, 512, v196
  v_min_u32_e64 v197, v29, v197
  v_subrev_u32 v29, 512, v196
  v_add_u32 v198, 256, v196
  v_min_u32_e64 v198, v29, v198
  v_add_u32 v196, 110080, v196
  v_add_u32 v197, 110080, v197
  v_add_u32 v198, 110080, v198
L_hn:
  ds_read_b32 v104, v14 offset:28
  s_waitcnt lgkmcnt(0)
  v_readfirstlane_b32 s46, v104
  s_cmp_ge_u32 s46, 31
  s_cbranch_scc1 L_hn_ok
  s_cmp_eq_u32 s94, 0
  s_cbranch_scc1 L_hn_ok
  s_sub_u32 s94, s94, 1
  s_sleep 1
  s_branch L_hn
L_hn_ok:
  s_mov_b64 exec, 1
L_hw:
  global_atomic_add v68, v36, v14, s[30:31] sc0 sc1
  s_waitcnt vmcnt(0)
  v_readfirstlane_b32 s46, v68
  s_cmp_ge_u32 s46, 16
  s_cbranch_scc1 L_hw_ok
  s_cmp_eq_u32 s94, 0
  s_cbranch_scc1 L_hw_ok
  s_sub_u32 s94, s94, 1
  s_branch L_hw
L_hw_ok:
  s_mov_b64 exec, -1
L_hg:
  global_load_dwordx4 v[52:55], v187, s[30:31] sc1
  global_load_dwordx2 v[112:113], v172, s[30:31] sc1
  global_load_dwordx2 v[114:115], v173, s[30:31] sc1
  global_load_dwordx2 v[116:117], v174, s[30:31] sc1
  global_load_dwordx2 v[118:119], v175, s[30:31] sc1
  global_load_dwordx2 v[120:121], v176, s[30:31] sc1
  global_load_dwordx2 v[122:123], v177, s[30:31] sc1
  global_load_dwordx2 v[124:125], v178, s[30:31] sc1
  global_load_dwordx2 v[126:127], v179, s[30:31] sc1
  global_load_dwordx2 v[128:129], v180, s[30:31] sc1
  global_load_dwordx2 v[130:131], v181, s[30:31] sc1
  global_load_dwordx2 v[132:133], v182, s[30:31] sc1
  global_load_dwordx2 v[134:135], v183, s[30:31] sc1
  global_load_dwordx2 v[136:137], v184, s[30:31] sc1
  global_load_dwordx2 v[138:139], v185, s[30:31] sc1
  global_load_dwordx2 v[140:141], v186, s[30:31] sc1
  s_waitcnt vmcnt(15)
  v_mov_b32_e64 v23, v55
  v_mov_b32 v24, v52
  s_nop 1
  v_max_f32_dpp v24, v24, v24 row_ror:8 row_mask:0xf bank_mask:0xf
  s_nop 1
  v_max_f32_dpp v24, v24, v24 row_ror:4 row_mask:0xf bank_mask:0xf
  s_nop 1
  v_max_f32_dpp v24, v24, v24 row_ror:2 row_mask:0xf bank_mask:0xf
  s_nop 1
  v_max_f32_dpp v24, v24, v24 row_ror:1 row_mask:0xf bank_mask:0xf
  v_sub_f32 v24, v52, v24
  v_exp_f32_e64 v24, v24
  v_subrev_u32 v55, 256, v55
  v_mul_f32 v25, v24, v53
  s_nop 1
  v_add_f32_dpp v25, v25, v25 row_ror:8 row_mask:0xf bank_mask:0xf
  s_nop 1
  v_add_f32_dpp v25, v25, v25 row_ror:4 row_mask:0xf bank_mask:0xf
  s_nop 1
  v_add_f32_dpp v25, v25, v25 row_ror:2 row_mask:0xf bank_mask:0xf
  s_nop 1
  v_add_f32_dpp v25, v25, v25 row_ror:1 row_mask:0xf bank_mask:0xf
  v_rcp_f32 v25, v25
  s_nop 0
  v_mul_f32 v24, v24, v25
  v_ldexp_f32 v25, v24, v55
  v_mul_f32_e64 v54, v24, -v54
  v_readlane_b32 s63, v24, 15
  v_readlane_b32 s44, v54, 15
  v_readlane_b32 s48, v25, 0
  v_readlane_b32 s49, v25, 1
  v_readlane_b32 s50, v25, 2
  v_readlane_b32 s51, v25, 3
  v_readlane_b32 s52, v25, 4
  v_readlane_b32 s53, v25, 5
  v_readlane_b32 s54, v25, 6
  v_readlane_b32 s55, v25, 7
  v_readlane_b32 s56, v25, 8
  v_readlane_b32 s57, v25, 9
  v_readlane_b32 s58, v25, 10
  v_readlane_b32 s59, v25, 11
  v_readlane_b32 s60, v25, 12
  v_readlane_b32 s61, v25, 13
  v_readlane_b32 s62, v25, 14
  v_mov_b32 v108, s44
  v_mov_b32 v109, s44
  v_mov_b32_e64 v110, s44
  v_mov_b32 v111, s44
  s_waitcnt vmcnt(14)
  v_max3_u32 v23, v23, v112, v113
  v_fma_mix_f32 v108, v112, s48, v108 op_sel:[0,0,0] op_sel_hi:[1,0,0]
  v_fma_mix_f32 v109, v112, s48, v109 op_sel:[1,0,0] op_sel_hi:[1,0,0]
  v_fma_mix_f32 v110, v113, s48, v110 op_sel:[0,0,0] op_sel_hi:[1,0,0]
  v_fma_mix_f32 v111, v113, s48, v111 op_sel:[1,0,0] op_sel_hi:[1,0,0]
  s_waitcnt vmcnt(13)
  v_max3_u32 v23, v23, v114, v115
  v_fma_mix_f32 v108, v114, s49, v108 op_sel:[0,0,0] op_sel_hi:[1,0,0]
  v_fma_mix_f32 v109, v114, s49, v109 op_sel:[1,0,0] op_sel_hi:[1,0,0]
  v_fma_mix_f32 v110, v115, s49, v110 op_sel:[0,0,0] op_sel_hi:[1,0,0]
  v_fma_mix_f32 v111, v115, s49, v111 op_sel:[1,0,0] op_sel_hi:[1,0,0]
  s_waitcnt vmcnt(12)
  v_max3_u32 v23, v23, v116, v117
  v_fma_mix_f32 v108, v116, s50, v108 op_sel:[0,0,0] op_sel_hi:[1,0,0]
  v_fma_mix_f32 v109, v116, s50, v109 op_sel:[1,0,0] op_sel_hi:[1,0,0]
  v_fma_mix_f32 v110, v117, s50, v110 op_sel:[0,0,0] op_sel_hi:[1,0,0]
  v_fma_mix_f32 v111, v117, s50, v111 op_sel:[1,0,0] op_sel_hi:[1,0,0]
  s_waitcnt vmcnt(11)
  v_max3_u32 v23, v23, v118, v119
  v_fma_mix_f32 v108, v118, s51, v108 op_sel:[0,0,0] op_sel_hi:[1,0,0]
  v_fma_mix_f32 v109, v118, s51, v109 op_sel:[1,0,0] op_sel_hi:[1,0,0]
  v_fma_mix_f32 v110, v119, s51, v110 op_sel:[0,0,0] op_sel_hi:[1,0,0]
  v_fma_mix_f32 v111, v119, s51, v111 op_sel:[1,0,0] op_sel_hi:[1,0,0]
  s_waitcnt vmcnt(10)
  v_max3_u32 v23, v23, v120, v121
  v_fma_mix_f32 v108, v120, s52, v108 op_sel:[0,0,0] op_sel_hi:[1,0,0]
  v_fma_mix_f32 v109, v120, s52, v109 op_sel:[1,0,0] op_sel_hi:[1,0,0]
  v_fma_mix_f32 v110, v121, s52, v110 op_sel:[0,0,0] op_sel_hi:[1,0,0]
  v_fma_mix_f32 v111, v121, s52, v111 op_sel:[1,0,0] op_sel_hi:[1,0,0]
  s_waitcnt vmcnt(9)
  v_max3_u32 v23, v23, v122, v123
  v_fma_mix_f32 v108, v122, s53, v108 op_sel:[0,0,0] op_sel_hi:[1,0,0]
  v_fma_mix_f32 v109, v122, s53, v109 op_sel:[1,0,0] op_sel_hi:[1,0,0]
  v_fma_mix_f32 v110, v123, s53, v110 op_sel:[0,0,0] op_sel_hi:[1,0,0]
  v_fma_mix_f32 v111, v123, s53, v111 op_sel:[1,0,0] op_sel_hi:[1,0,0]
  s_waitcnt vmcnt(8)
  v_max3_u32 v23, v23, v124, v125
  v_fma_mix_f32 v108, v124, s54, v108 op_sel:[0,0,0] op_sel_hi:[1,0,0]
  v_fma_mix_f32 v109, v124, s54, v109 op_sel:[1,0,0] op_sel_hi:[1,0,0]
  v_fma_mix_f32 v110, v125, s54, v110 op_sel:[0,0,0] op_sel_hi:[1,0,0]
  v_fma_mix_f32 v111, v125, s54, v111 op_sel:[1,0,0] op_sel_hi:[1,0,0]
  s_waitcnt vmcnt(7)
  v_max3_u32 v23, v23, v126, v127
  v_fma_mix_f32 v108, v126, s55, v108 op_sel:[0,0,0] op_sel_hi:[1,0,0]
  v_fma_mix_f32 v109, v126, s55, v109 op_sel:[1,0,0] op_sel_hi:[1,0,0]
  v_fma_mix_f32 v110, v127, s55, v110 op_sel:[0,0,0] op_sel_hi:[1,0,0]
  v_fma_mix_f32 v111, v127, s55, v111 op_sel:[1,0,0] op_sel_hi:[1,0,0]
  s_waitcnt vmcnt(6)
  v_max3_u32 v23, v23, v128, v129
  v_fma_mix_f32 v108, v128, s56, v108 op_sel:[0,0,0] op_sel_hi:[1,0,0]
  v_fma_mix_f32 v109, v128, s56, v109 op_sel:[1,0,0] op_sel_hi:[1,0,0]
  v_fma_mix_f32 v110, v129, s56, v110 op_sel:[0,0,0] op_sel_hi:[1,0,0]
  v_fma_mix_f32 v111, v129, s56, v111 op_sel:[1,0,0] op_sel_hi:[1,0,0]
  s_waitcnt vmcnt(5)
  v_max3_u32 v23, v23, v130, v131
  v_fma_mix_f32 v108, v130, s57, v108 op_sel:[0,0,0] op_sel_hi:[1,0,0]
  v_fma_mix_f32 v109, v130, s57, v109 op_sel:[1,0,0] op_sel_hi:[1,0,0]
  v_fma_mix_f32 v110, v131, s57, v110 op_sel:[0,0,0] op_sel_hi:[1,0,0]
  v_fma_mix_f32 v111, v131, s57, v111 op_sel:[1,0,0] op_sel_hi:[1,0,0]
  s_waitcnt vmcnt(4)
  v_max3_u32 v23, v23, v132, v133
  v_fma_mix_f32 v108, v132, s58, v108 op_sel:[0,0,0] op_sel_hi:[1,0,0]
  v_fma_mix_f32 v109, v132, s58, v109 op_sel:[1,0,0] op_sel_hi:[1,0,0]
  v_fma_mix_f32 v110, v133, s58, v110 op_sel:[0,0,0] op_sel_hi:[1,0,0]
  v_fma_mix_f32 v111, v133, s58, v111 op_sel:[1,0,0] op_sel_hi:[1,0,0]
  s_waitcnt vmcnt(3)
  v_max3_u32 v23, v23, v134, v135
  v_fma_mix_f32 v108, v134, s59, v108 op_sel:[0,0,0] op_sel_hi:[1,0,0]
  v_fma_mix_f32 v109, v134, s59, v109 op_sel:[1,0,0] op_sel_hi:[1,0,0]
  v_fma_mix_f32 v110, v135, s59, v110 op_sel:[0,0,0] op_sel_hi:[1,0,0]
  v_fma_mix_f32 v111, v135, s59, v111 op_sel:[1,0,0] op_sel_hi:[1,0,0]
  s_waitcnt vmcnt(2)
  v_max3_u32 v23, v23, v136, v137
  v_fma_mix_f32 v108, v136, s60, v108 op_sel:[0,0,0] op_sel_hi:[1,0,0]
  v_fma_mix_f32 v109, v136, s60, v109 op_sel:[1,0,0] op_sel_hi:[1,0,0]
  v_fma_mix_f32 v110, v137, s60, v110 op_sel:[0,0,0] op_sel_hi:[1,0,0]
  v_fma_mix_f32 v111, v137, s60, v111 op_sel:[1,0,0] op_sel_hi:[1,0,0]
  s_waitcnt vmcnt(1)
  v_max3_u32 v23, v23, v138, v139
  v_fma_mix_f32 v108, v138, s61, v108 op_sel:[0,0,0] op_sel_hi:[1,0,0]
  v_fma_mix_f32 v109, v138, s61, v109 op_sel:[1,0,0] op_sel_hi:[1,0,0]
  v_fma_mix_f32 v110, v139, s61, v110 op_sel:[0,0,0] op_sel_hi:[1,0,0]
  v_fma_mix_f32 v111, v139, s61, v111 op_sel:[1,0,0] op_sel_hi:[1,0,0]
  s_waitcnt vmcnt(0)
  v_max3_u32 v23, v23, v140, v141
  v_cmp_eq_u32 s[64:65], -1, v23
  v_fma_mix_f32 v108, v140, s62, v108 op_sel:[0,0,0] op_sel_hi:[1,0,0]
  v_fma_mix_f32 v109, v140, s62, v109 op_sel:[1,0,0] op_sel_hi:[1,0,0]
  v_fma_mix_f32 v110, v141, s62, v110 op_sel:[0,0,0] op_sel_hi:[1,0,0]
  v_fma_mix_f32 v111, v141, s62, v111 op_sel:[1,0,0] op_sel_hi:[1,0,0]
  s_cmp_eq_u64 s[64:65], 0
  s_cbranch_scc1 L_hg_ok
  s_cmp_eq_u32 s94, 0
  s_cbranch_scc1 L_hg_ok
  s_sub_u32 s94, s94, 1
  s_branch L_hg
L_hg_ok:
  v_mov_b32_e64 v168, s63
  s_mov_b32 exec_hi, 0xffff
  s_barrier
  ds_read_b128 v[72:75], v196 offset:0
  ds_read_b128 v[76:79], v197 offset:768
  ds_read_b128 v[80:83], v197 offset:1536
  ds_read_b128 v[84:87], v198 offset:2304
  s_waitcnt lgkmcnt(3)
  v_pk_fma_f32 v[108:109], v[72:73], v[168:169], v[108:109] op_sel_hi:[1,0,1]
  v_pk_fma_f32 v[110:111], v[74:75], v[168:169], v[110:111] op_sel_hi:[1,0,1]
  s_waitcnt lgkmcnt(2)
  v_pk_fma_f32 v[108:109], v[76:77], v[168:169], v[108:109] op_sel_hi:[1,0,1]
  v_pk_fma_f32 v[110:111], v[78:79], v[168:169], v[110:111] op_sel_hi:[1,0,1]
  s_waitcnt lgkmcnt(1)
  v_pk_fma_f32 v[108:109], v[80:81], v[168:169], v[108:109] op_sel_hi:[1,0,1]
  v_pk_fma_f32 v[110:111], v[82:83], v[168:169], v[110:111] op_sel_hi:[1,0,1]
  s_waitcnt lgkmcnt(0)
  v_pk_fma_f32 v[108:109], v[84:85], v[168:169], v[108:109] op_sel_hi:[1,0,1]
  v_pk_fma_f32 v[110:111], v[86:87], v[168:169], v[110:111] op_sel_hi:[1,0,1]
  v_cvt_pk_bf16_f32 v108, v108, v109
  v_cvt_pk_bf16_f32 v109, v110, v111
  global_store_dwordx2 v21, v[108:109], s[26:27]
L_end:
  s_endpgm
.p2align 6
.type L_order,@object
L_order:
  .long 0x76afedcb, 0x45321098, 0x500000, 0x300, 0x40, 0x251300, 0x4, 0x0
  .long 0x2e001e, 0x4e003e, 0x6e005e, 0x8d007e, 0xae009e, 0xce00be, 0xee00de, 0xf00fe
  .long 0x96afedcb, 0x74321058, 0x700000, 0x700, 0x70, 0x271700, 0x7, 0x0
  .long 0x270007, 0x470037, 0x670057, 0x870077, 0xa70097, 0xc700b7, 0xe700d7, 0x1f00f7
  .long 0x765aedfb, 0xc4321098, 0xd00000, 0xf00, 0xc0, 0x2d1f00, 0xc, 0x0
  .long 0x110001, 0x410031, 0x610051, 0x810071, 0xa10091, 0xc100b1, 0xe100d1, 0x2f00f1
  .long 0x785fedcb, 0x6432109a, 0x900000, 0x200, 0x60, 0x291200, 0x6, 0x0
  .long 0x160006, 0x460026, 0x660056, 0x860076, 0xa60096, 0xc600b6, 0xe600d6, 0x3f00f6
  .long 0x765faecb, 0xd4321098, 0xf00000, 0xd00, 0xd0, 0x2f1d00, 0xd, 0x0
  .long 0x120002, 0x320022, 0x620052, 0x820072, 0xa20092, 0xc200b2, 0xe200d2, 0x4f00f2
  .long 0x765fedca, 0xb4321098, 0x800000, 0xf00, 0xb0, 0x281f00, 0xb, 0x0
  .long 0x100000, 0x300020, 0x600040, 0x800070, 0xa00090, 0xc000b0, 0xe000d0, 0x5f00f0
  .long 0x76afedcb, 0x24351098, 0x400000, 0x0, 0x20, 0x241000, 0x2, 0x0
  .long 0x1c000c, 0x3c002c, 0x5c004c, 0x8c007c, 0xac009c, 0xcc00bc, 0xea00dc, 0x6f00fc
  .long 0x76afedcb, 0x14325098, 0x400000, 0x400, 0x10, 0x241400, 0x1, 0x0
  .long 0x1b000b, 0x3b002b, 0x5b004b, 0x8b006b, 0xab009b, 0xcb00bb, 0xeb00db, 0x7f00fb
  .long 0x76afedcb, 0x35421098, 0x500000, 0x300, 0x30, 0x251300, 0x3, 0x0
  .long 0x1d000d, 0x3d002d, 0x5d004d, 0x7d006d, 0xad009d, 0xcd00bd, 0xed00dd, 0x8f00fd
  .long 0x76afedcb, 0x94321058, 0x700000, 0x700, 0x90, 0x271700, 0x9, 0x0
  .long 0x170009, 0x390029, 0x590049, 0x790069, 0xa90089, 0xc900b9, 0xe900d9, 0x9f00f9
  .long 0x765aedcb, 0xf4321098, 0xd00000, 0xf00, 0xf0, 0x2d1f00, 0xf, 0x0
  .long 0x140004, 0x340021, 0x540044, 0x740064, 0x940084, 0xc400b4, 0xe400d4, 0xaf00f4
  .long 0x765fedcb, 0x8432109a, 0x900000, 0x200, 0x80, 0x291200, 0x8, 0x0
  .long 0x180008, 0x360028, 0x580048, 0x780068, 0x980088, 0xc800a8, 0xe800d8, 0xbf00f8
  .long 0x765fadcb, 0xe4321098, 0xf00000, 0xd00, 0xe0, 0x2f1d00, 0xe, 0x0
  .long 0x130003, 0x330023, 0x530042, 0x730063, 0x930083, 0xb300a3, 0xe300d3, 0xcf00f3
  .long 0x765fedcb, 0xa4321098, 0x800000, 0xf00, 0xaf, 0x28001f, 0xa, 0x0
  .long 0x500024, 0x14400a4, 0x2b40234, 0x6f40674, 0x7830703, 0xc1408c2, 0xd630c94, 0xdf0de3
  .long 0x76afedcb, 0x4351298, 0x400000, 0x0, 0x0, 0x241000, 0x0, 0x0
  .long 0x1a000a, 0x3a002a, 0x5a004a, 0x7a006a, 0x9a008a, 0xba00aa, 0xda00ca, 0xef00fa
  .long 0x76afedcb, 0x54321098, 0x400000, 0x400, 0x54, 0x140024, 0x5, 0x0
  .long 0x7b006c, 0x1cc00ec, 0x4be043e, 0x58d050d, 0x7de075e, 0xe1c084d, 0xe9c0e2e, 0xff0eae
  .long 0x765fadce, 0xb4321098, 0x11911111, 0x11111e11, 0xb1, 0x291e01, 0xb, 0x0
  .long 0x1200110, 0x1400130, 0x1600150, 0x1800170, 0x1a00190, 0x1c001b0, 0x1e001d0, 0x10f01f0
  .long 0x76afedcb, 0x94321058, 0x11b11111, 0x11111011, 0x91, 0x2b1001, 0x9, 0x0
  .long 0x1290109, 0x1490139, 0x1690159, 0x1890179, 0x1a90199, 0x1c901b9, 0x1e901d9, 0x11f01f9
  .long 0x765fedcb, 0x8432109a, 0x11a11111, 0x11111111, 0x81, 0x2a1101, 0x8, 0x0
  .long 0x1180108, 0x1480138, 0x1680158, 0x1880178, 0x1a70198, 0x1c801b8, 0x1e801d8, 0x12f01f8
  .long 0x765feadb, 0xc4321098, 0x11811111, 0x11111e11, 0xc1, 0x281e01, 0xc, 0x0
  .long 0x1110101, 0x1410121, 0x1610151, 0x1810171, 0x1a10191, 0x1c101b1, 0x1e101d1, 0x13f01f1
  .long 0x765aedcb, 0xf4321098, 0x11e11111, 0x11111f11, 0xf1, 0x2e1f01, 0xf, 0x0
  .long 0x1140104, 0x1340124, 0x1640154, 0x1840174, 0x1a40194, 0x1c401b4, 0x1e401d4, 0x14f01f4
  .long 0x76afedcb, 0x45321098, 0x11311111, 0x11111811, 0x41, 0x231801, 0x4, 0x0
  .long 0x11e010e, 0x13e012e, 0x16e014e, 0x18e017e, 0x1ae019e, 0x1ce01be, 0x1ee01dd, 0x15f01fe
  .long 0x7a5fedcb, 0x64321098, 0x11811111, 0x11111311, 0x61, 0x281301, 0x6, 0x0
  .long 0x1160106, 0x1360126, 0x1560146, 0x1860176, 0x1a60196, 0x1c601b6, 0x1e601d6, 0x16f01f6
  .long 0x76afedcb, 0x14325098, 0x11011111, 0x11111311, 0x11, 0x201301, 0x1, 0x0
  .long 0x11b010b, 0x13b012b, 0x15b014b, 0x18b016b, 0x1ab019b, 0x1cb01bb, 0x1eb01db, 0x17f01fa
  .long 0x765fadcb, 0xe4321098, 0x11911111, 0x11111e11, 0xe1, 0x291e01, 0xe, 0x0
  .long 0x1130100, 0x1330123, 0x1530143, 0x1730163, 0x1a30193, 0x1c301b3, 0x1e301d3, 0x18f01f3
  .long 0x76afedcb, 0x54321098, 0x11b11111, 0x11111011, 0x5b, 0x10012b, 0x5, 0x0
  .long 0x3090119, 0x5450389, 0xc2505c5, 0xd650ca5, 0xe750de5, 0xf380ef5, 0xfb80f55, 0x19f0fd5
  .long 0x865fedcb, 0x7432109a, 0x11a11111, 0x11111111, 0x71, 0x2a1101, 0x7, 0x0
  .long 0x1170107, 0x1370127, 0x1570147, 0x1770167, 0x1970187, 0x1c701b7, 0x1e701d7, 0x1af01f7
  .long 0x765feacb, 0xd4321098, 0x11811111, 0x11111e11, 0xd1, 0x281e01, 0xd, 0x0
  .long 0x1120102, 0x1310122, 0x1520142, 0x1720162, 0x1920182, 0x1c201a2, 0x1e201d2, 0x1bf01f2
  .long 0x76afedcb, 0x24351098, 0x11411111, 0x11111711, 0x21, 0x241701, 0x2, 0x0
  .long 0x11c010c, 0x13c012c, 0x15c014c, 0x17c016c, 0x19c018c, 0x1bc01ac, 0x1ec01dc, 0x1cf01fc
  .long 0x76afedcb, 0x35421098, 0x11311111, 0x11111811, 0x31, 0x231801, 0x3, 0x0
  .long 0x11d010d, 0x13d012d, 0x15d014d, 0x17d016d, 0x19d018d, 0x1bd01ad, 0x1ed01cd, 0x1df01fd
  .long 0x765fedcb, 0xa4321098, 0x11811111, 0x11111311, 0xa3, 0x280113, 0xa, 0x0
  .long 0x850005, 0x1750166, 0x62501f5, 0x74506a5, 0xbd507c5, 0xd350d15, 0xdb50d95, 0x1ef0e55
  .long 0x76afedcb, 0x4325198, 0x11011111, 0x11111311, 0x1, 0x201301, 0x0, 0x0
  .long 0x11a010a, 0x13a012a, 0x15a014a, 0x17a016a, 0x19a018a, 0x1ba01aa, 0x1da01ca, 0x1ff01ea
  .long 0x76afedcb, 0x45321098, 0x22222222, 0x22222a22, 0x42, 0x221a02, 0x4, 0x0
  .long 0x22e021e, 0x24e023e, 0x26e025e, 0x28b027e, 0x2ae029e, 0x2ce02be, 0x2ee02de, 0x20f02fe
  .long 0x7a5fedcb, 0x64321098, 0x22c22222, 0x22222622, 0x62, 0x2c1602, 0x6, 0x0
  .long 0x2260206, 0x2460236, 0x2660256, 0x2860276, 0x2a60296, 0x2c602b6, 0x2e602d6, 0x21f02f6
  .long 0x76afedcb, 0x54321098, 0x22922222, 0x22222522, 0x59, 0x150229, 0x5, 0x0
  .long 0xb50035, 0x1850105, 0x2f502a8, 0x3550315, 0x3d50395, 0x6650575, 0x94506e5, 0x22f09c5
  .long 0x765aedcb, 0xf4321098, 0x22f22222, 0x22222f22, 0xf2, 0x2f1f02, 0xf, 0x0
  .long 0x2140204, 0x2440224, 0x2640254, 0x2840274, 0x2a40294, 0x2c402b2, 0x2e402d4, 0x23f02f4
  .long 0x76afedcb, 0x24351098, 0x22222222, 0x22222522, 0x22, 0x221502, 0x2, 0x0
  .long 0x21c020c, 0x23c022c, 0x26c025c, 0x28c027c, 0x2ac029c, 0x2ca02bc, 0x2ec02dc, 0x24f02fc
  .long 0x965fedcb, 0x743210a8, 0x22722222, 0x22222022, 0x72, 0x271002, 0x7, 0x0
  .long 0x2170207, 0x2370227, 0x2670247, 0x2870277, 0x2a70297, 0x2c702b7, 0x2e702d7, 0x25f02f7
  .long 0x765fadce, 0xb4321098, 0x22a22222, 0x22222e22, 0xb2, 0x2a1e02, 0xb, 0x0
  .long 0x2100200, 0x2300220, 0x2500240, 0x2800270, 0x2a00290, 0x2c002b0, 0x2e002d0, 0x26f02f0
  .long 0x76afedcb, 0x34521098, 0x22222222, 0x22222822, 0x32, 0x221802, 0x3, 0x0
  .long 0x21d020d, 0x23d022d, 0x25d024d, 0x28d026d, 0x2ad029d, 0x2cd02bd, 0x2ed02dd, 0x27f02fd
  .long 0x76afedcb, 0x15324098, 0x22222222, 0x22222a22, 0x12, 0x221a02, 0x1, 0x0
  .long 0x21b020b, 0x23b022b, 0x25b024b, 0x27b026b, 0x2ab029b, 0x2cb02bb, 0x2eb02db, 0x28f02fb
  .long 0x765fedcb, 0xa4321098, 0x22c22222, 0x22222622, 0xa6, 0x2c0216, 0xa, 0x0
  .long 0x3650216, 0x42503e5, 0x73504a5, 0x7750755, 0x7d507b5, 0xb4507f5, 0xd050bc5, 0x29f0d85
  .long 0x76afedcb, 0x84321095, 0x22922222, 0x22222522, 0x82, 0x291502, 0x8, 0x0
  .long 0x2180208, 0x2380228, 0x2580248, 0x2780268, 0x2980288, 0x2c802b8, 0x2e802d8, 0x2af02f8
  .long 0x765aefcb, 0xd4321098, 0x22f22222, 0x22222f22, 0xd2, 0x2f1f02, 0xd, 0x0
  .long 0x2120202, 0x2320222, 0x2520242, 0x2720262, 0x2920282, 0x2c202a2, 0x2e202d2, 0x2bf02f2
  .long 0x76afedcb, 0x4351298, 0x22222222, 0x22222522, 0x2, 0x221502, 0x0, 0x0
  .long 0x21a020a, 0x23a022a, 0x25a024a, 0x27a026a, 0x29a028a, 0x2ba02aa, 0x2ea02da, 0x2cf02fa
  .long 0x765fedcb, 0x943210a8, 0x22722222, 0x22222022, 0x92, 0x271002, 0x9, 0x0
  .long 0x2190209, 0x2390229, 0x2570249, 0x2790269, 0x2990289, 0x2b902a9, 0x2e902c9, 0x2df02f9
  .long 0x765fadcb, 0xe4321098, 0x22a22222, 0x22222e22, 0xe2, 0x2a1e02, 0xe, 0x0
  .long 0x2130203, 0x2330223, 0x2530243, 0x2730260, 0x2930283, 0x2b302a3, 0x2d302c3, 0x2ef02f3
  .long 0x765fedab, 0xc4321098, 0x22922222, 0x22222d22, 0xc2, 0x291d02, 0xc, 0x0
  .long 0x2110201, 0x2310221, 0x2510241, 0x2710261, 0x2910281, 0x2b102a1, 0x2d102c1, 0x2ff02e1
  .long 0x76afedcb, 0x84321059, 0x33b33333, 0x33333133, 0x83, 0x2b1103, 0x8, 0x0
  .long 0x3280318, 0x3480338, 0x3680358, 0x3880378, 0x3a80398, 0x3c803b8, 0x3e803d8, 0x30f03f8
  .long 0x765aedcb, 0xf4321098, 0x33933333, 0x33333e33, 0xf3, 0x291e03, 0xf, 0x0
  .long 0x3240304, 0x3440334, 0x3640354, 0x3840374, 0x3a40394, 0x3c403b4, 0x3e403d4, 0x31f03f4
  .long 0x76afedcb, 0x4321598, 0x33033333, 0x33333233, 0x3, 0x201203, 0x0, 0x0
  .long 0x31a030a, 0x34a033a, 0x36a035a, 0x38a037a, 0x3aa039a, 0x3ca03ba, 0x3ea03da, 0x32f03fa
  .long 0x765fedac, 0xb4321098, 0x33a33333, 0x33333b33, 0xb3, 0x2a1b03, 0xb, 0x0
  .long 0x3100300, 0x3400320, 0x3600350, 0x3800370, 0x3a00390, 0x3c003b0, 0x3e003d0, 0x33f03f0
  .long 0x76afedcb, 0x24531098, 0x33133333, 0x33333a33, 0x23, 0x211a03, 0x2, 0x0
  .long 0x31c030c, 0x33c032c, 0x36c035c, 0x38c037c, 0x3ac039c, 0x3cc03bc, 0x3ec03dc, 0x34f03fc
  .long 0xa65fedcb, 0x74321098, 0x33933333, 0x33333133, 0x73, 0x291103, 0x7, 0x0
  .long 0x3170307, 0x3370327, 0x3670347, 0x3870377, 0x3a70397, 0x3c703b7, 0x3e703d6, 0x35f03f7
  .long 0x76afedcb, 0x15324098, 0x33333333, 0x33333633, 0x13, 0x231603, 0x1, 0x0
  .long 0x31b030b, 0x33b032b, 0x35b034b, 0x38b037b, 0x3ab039b, 0x3cb03bb, 0x3eb03db, 0x36f03fb
  .long 0x765fadcb, 0xe4321098, 0x33e33333, 0x33333a33, 0xe3, 0x2e1a03, 0xe, 0x0
  .long 0x3130303, 0x3330323, 0x3530343, 0x3830363, 0x3a30393, 0x3c303b3, 0x3e303d3, 0x37f03f2
  .long 0x76afedcb, 0x94321058, 0x33b33333, 0x33333133, 0x93, 0x2b1103, 0x9, 0x0
  .long 0x3190308, 0x3390329, 0x3590349, 0x3790369, 0x3a90399, 0x3c903b9, 0x3e903d9, 0x38f03f9
  .long 0x765fedcb, 0xa4321098, 0x33933333, 0x33333e33, 0xae, 0x29031e, 0xa, 0x0
  .long 0x1320103, 0x1b20183, 0x2e30263, 0x4740314, 0x82304f4, 0xd5208a3, 0xe420dd2, 0x39f0ec2
  .long 0x76afedcb, 0x54321098, 0x33033333, 0x33333233, 0x50, 0x120320, 0x5, 0x0
  .long 0x1fb017b, 0x65e032a, 0x73c06de, 0xaeb07bc, 0xc6a0c4d, 0xd0c0ccd, 0xf1e0d8c, 0x3af0f9e
  .long 0x765fedab, 0xc4321098, 0x33a33333, 0x33333b33, 0xc3, 0x2a1b03, 0xc, 0x0
  .long 0x3110301, 0x3300321, 0x3510341, 0x3710361, 0x3910381, 0x3c103a1, 0x3e103d1, 0x3bf03f1
  .long 0x76afedcb, 0x34521098, 0x33133333, 0x33333a33, 0x33, 0x211a03, 0x3, 0x0
  .long 0x31d030d, 0x33d032d, 0x35d034c, 0x37d036d, 0x39d038d, 0x3bd03ad, 0x3ed03dd, 0x3cf03fd
  .long 0xa75fedcb, 0x64321098, 0x33933333, 0x33333133, 0x63, 0x291103, 0x6, 0x0
  .long 0x3160306, 0x3360326, 0x3560346, 0x3760366, 0x3960386, 0x3b603a6, 0x3e603c6, 0x3df03f6
  .long 0x76afedcb, 0x45321098, 0x33333333, 0x33333633, 0x43, 0x231603, 0x4, 0x0
  .long 0x31e030e, 0x33e032e, 0x35e034e, 0x37e036b, 0x39e038e, 0x3be03ae, 0x3de03ce, 0x3ef03fe
  .long 0x765faecb, 0xd4321098, 0x33e33333, 0x33333a33, 0xd3, 0x2e1a03, 0xd, 0x0
  .long 0x3120302, 0x3320322, 0x3520342, 0x3720362, 0x3920382, 0x3b203a2, 0x3d203c2, 0x3ff03e2
  .long 0x765fedcb, 0x8432109a, 0x44a44444, 0x44444944, 0x84, 0x2a1904, 0x8, 0x0
  .long 0x4280418, 0x4480438, 0x4680458, 0x4870478, 0x4a80498, 0x4c804b8, 0x4e804d8, 0x40f04f8
  .long 0x76afedcb, 0x4521398, 0x44544444, 0x44444544, 0x4, 0x251504, 0x0, 0x0
  .long 0x42a040a, 0x44a043a, 0x46a045a, 0x48a047a, 0x4aa049a, 0x4ca04ba, 0x4ea04da, 0x41f04fa
  .long 0x76afedcb, 0x24351098, 0x44344444, 0x44444644, 0x24, 0x231604, 0x2, 0x0
  .long 0x41c040c, 0x44c043c, 0x46c045c, 0x48c047c, 0x4ac049c, 0x4cc04bc, 0x4ec04dc, 0x42f04fc
  .long 0x76afedcb, 0x45321098, 0x44444444, 0x44444a44, 0x44, 0x241a04, 0x4, 0x0
  .long 0x41e040e, 0x44e042e, 0x46e045e, 0x48e047e, 0x4ae049e, 0x4ce04bb, 0x4ee04de, 0x43f04fe
  .long 0x765fadce, 0xb4321098, 0x44744444, 0x44444b44, 0xb4, 0x271b04, 0xb, 0x0
  .long 0x4100400, 0x4300420, 0x4600450, 0x4800470, 0x4a00490, 0x4c004b0, 0x4e004d0, 0x44f04f0
  .long 0x765feacb, 0xd4321098, 0x44644444, 0x44444c44, 0xd4, 0x261c04, 0xd, 0x0
  .long 0x4120402, 0x4320422, 0x4620442, 0x4820472, 0x4a20492, 0x4c204b2, 0x4e204d2, 0x45f04f2
  .long 0x79afedcb, 0x64321058, 0x44744444, 0x44444744, 0x64, 0x271704, 0x6, 0x0
  .long 0x4160406, 0x4360426, 0x4560446, 0x4860476, 0x4a60496, 0x4c604b6, 0x4e604d6, 0x46f04f6
  .long 0x765aedcb, 0xf4321098, 0x44644444, 0x44444e44, 0xf4, 0x261e04, 0xf, 0x0
  .long 0x4140404, 0x4340424, 0x4540444, 0x4840464, 0x4a40494, 0x4c404b4, 0x4e404d4, 0x47f04f1
  .long 0x865fedcb, 0x7432109a, 0x44a44444, 0x44444944, 0x74, 0x2a1904, 0x7, 0x0
  .long 0x4170407, 0x4370427, 0x4570447, 0x4770467, 0x4a70497, 0x4c704b7, 0x4e704d7, 0x48f04f7
  .long 0x76afedcb, 0x34521098, 0x44544444, 0x44444544, 0x34, 0x251504, 0x3, 0x0
  .long 0x41a040d, 0x43d042d, 0x45d044d, 0x47d046d, 0x4ad048d, 0x4cd04bd, 0x4ed04dd, 0x49f04fd
  .long 0x76afedcb, 0x54321098, 0x44344444, 0x44444644, 0x53, 0x160423, 0x5, 0x0
  .long 0x1de015e, 0x3ee036e, 0x81b042c, 0x89b087e, 0x93d08fe, 0xd4e09bd, 0xf0d0dce, 0x4af0f8d
  .long 0x76afedcb, 0x15324098, 0x44444444, 0x44444a44, 0x14, 0x241a04, 0x1, 0x0
  .long 0x41b040b, 0x43b042b, 0x45b044b, 0x47b046b, 0x49b048b, 0x4cb04ab, 0x4eb04db, 0x4bf04fb
  .long 0x765fadcb, 0xe4321098, 0x44744444, 0x44444b44, 0xe4, 0x271b04, 0xe, 0x0
  .long 0x4130403, 0x4330423, 0x4530440, 0x4730463, 0x4930483, 0x4b304a3, 0x4e304d3, 0x4cf04f3
  .long 0x765fedcb, 0xa4321098, 0x44644444, 0x44444c44, 0xac, 0x26041c, 0xa, 0x0
  .long 0x5230452, 0x76405a3, 0x94207e4, 0xb1109c2, 0xb910b34, 0xc030bb4, 0xf740c83, 0x4df0ff4
  .long 0x76afedcb, 0x94321058, 0x44744444, 0x44444744, 0x94, 0x271704, 0x9, 0x0
  .long 0x4190409, 0x4390429, 0x4590449, 0x4790466, 0x4990489, 0x4b904a9, 0x4d904c9, 0x4ef04f9
  .long 0x765aedfb, 0xc4321098, 0x44644444, 0x44444e44, 0xc4, 0x261e04, 0xc, 0x0
  .long 0x4110401, 0x4310421, 0x4510441, 0x4710461, 0x4910481, 0x4b104a1, 0x4d104c1, 0x4ff04e1
  .long 0x76afedcb, 0x34521098, 0x55455555, 0x55555855, 0x35, 0x241805, 0x3, 0x0
  .long 0x52d051d, 0x54d053d, 0x56d055d, 0x58c057d, 0x5ad059d, 0x5cd05bd, 0x5ed05dd, 0x50f05fd
  .long 0x765fedcb, 0x943210a8, 0x55f55555, 0x55555a55, 0x95, 0x2f1a05, 0x9, 0x0
  .long 0x5290509, 0x5490539, 0x5690559, 0x5890579, 0x5a90596, 0x5c905b9, 0x5e905d9, 0x51f05f9
  .long 0x765fadeb, 0xc4321098, 0x55755555, 0x55555c55, 0xc5, 0x271c05, 0xc, 0x0
  .long 0x5110501, 0x5410531, 0x5610551, 0x5810571, 0x5a10591, 0x5c105b1, 0x5e105d1, 0x52f05f1
  .long 0x765feacd, 0xb4321098, 0x55c55555, 0x55555d55, 0xb5, 0x2c1d05, 0xb, 0x0
  .long 0x5100500, 0x5400520, 0x5600550, 0x5800570, 0x5a00590, 0x5c005b0, 0x5e005d0, 0x53f05f0
  .long 0xa65fedcb, 0x74321098, 0x55b55555, 0x55555455, 0x75, 0x2b1405, 0x7, 0x0
  .long 0x5170507, 0x5370527, 0x5670557, 0x5870577, 0x5a70597, 0x5c705b7, 0x5e705d7, 0x54f05f7
  .long 0x76afedcb, 0x84321095, 0x55f55555, 0x55555755, 0x85, 0x2f1705, 0x8, 0x0
  .long 0x5180508, 0x5380528, 0x5680548, 0x5880578, 0x5a80598, 0x5c805b8, 0x5e805d8, 0x55f05f8
  .long 0x76afedcb, 0x4325198, 0x55255555, 0x55555255, 0x5, 0x221205, 0x0, 0x0
  .long 0x51a050a, 0x53a052a, 0x55a054a, 0x58a057a, 0x5aa059a, 0x5ca05ba, 0x5ea05da, 0x56f05fa
  .long 0x765aedcb, 0xf4321098, 0x55955555, 0x55555d55, 0xf5, 0x291d05, 0xf, 0x0
  .long 0x5140504, 0x5340524, 0x5540544, 0x5840564, 0x5a40594, 0x5c405b4, 0x5e405d4, 0x57f05f4
  .long 0x76afedcb, 0x24531098, 0x55455555, 0x55555855, 0x25, 0x241805, 0x2, 0x0
  .long 0x51c050c, 0x53c052c, 0x55c054c, 0x57c056c, 0x5ac059c, 0x5cc05bc, 0x5ec05dc, 0x58f05fc
  .long 0x795fedcb, 0x643210a8, 0x55f55555, 0x55555a55, 0x65, 0x2f1a05, 0x6, 0x0
  .long 0x5160506, 0x5360526, 0x5560546, 0x5760566, 0x5a60586, 0x5c605b6, 0x5e605d6, 0x59f05f6
  .long 0x765fadcb, 0xe4321098, 0x55755555, 0x55555c55, 0xe5, 0x271c05, 0xe, 0x0
  .long 0x5130503, 0x5330521, 0x5530543, 0x5730563, 0x5930583, 0x5c305b3, 0x5e305d3, 0x5af05f3
  .long 0x765feacb, 0xd4321098, 0x55c55555, 0x55555d55, 0xd5, 0x2c1d05, 0xd, 0x0
  .long 0x5120502, 0x5300522, 0x5520542, 0x5720562, 0x5920582, 0x5c205a2, 0x5e205d2, 0x5bf05f2
  .long 0x765fedcb, 0xa4321098, 0x55b55555, 0x55555455, 0xa4, 0x2b0514, 0xa, 0x0
  .long 0xf50075, 0x6350547, 0x81506b5, 0x8950855, 0xb6508d5, 0xc290be5, 0xf050ca9, 0x5cf0f85
  .long 0x76afedcb, 0x54321098, 0x55f55555, 0x55555755, 0x5f, 0x17052f, 0x5, 0x0
  .long 0xc50045, 0x2b50235, 0x5580515, 0x8650595, 0xd2508e5, 0xdf50d75, 0xe850e05, 0x5df0fa5
  .long 0x76afedcb, 0x14325098, 0x55255555, 0x55555255, 0x15, 0x221205, 0x1, 0x0
  .long 0x51b050b, 0x53b052b, 0x55b054b, 0x57b056a, 0x59b058b, 0x5bb05ab, 0x5db05cb, 0x5ef05fb
  .long 0x76afedcb, 0x45321098, 0x55255555, 0x55555855, 0x45, 0x221805, 0x4, 0x0
  .long 0x51e050e, 0x53e052e, 0x55e054e, 0x57e056e, 0x59e058e, 0x5be05ae, 0x5de05ce, 0x5ff05ee
  .long 0x76afedcb, 0x24351098, 0x66166666, 0x66666566, 0x26, 0x211506, 0x2, 0x0
  .long 0x62c061c, 0x64c063c, 0x66c065c, 0x68c067c, 0x6ac069c, 0x6cc06bc, 0x6ec06dc, 0x60f06fc
  .long 0x765feacd, 0xb4321098, 0x66a66666, 0x66666b66, 0xb6, 0x2a1b06, 0xb, 0x0
  .long 0x6200600, 0x6400630, 0x6600650, 0x6800670, 0x6a00690, 0x6c006b0, 0x6e006d0, 0x61f06f0
  .long 0x76afedcb, 0x94321058, 0x66e66666, 0x66666366, 0x96, 0x2e1306, 0x9, 0x0
  .long 0x6190609, 0x6490639, 0x6690659, 0x6890679, 0x6a70699, 0x6c906b9, 0x6e906d9, 0x62f06f9
  .long 0x76afedcb, 0x4325198, 0x66166666, 0x66666466, 0x6, 0x211406, 0x0, 0x0
  .long 0x61a060a, 0x64a062a, 0x66a065a, 0x68a067a, 0x6aa069a, 0x6ca06ba, 0x6ea06da, 0x63f06fa
  .long 0x76afedcb, 0x84321095, 0x66566666, 0x66666966, 0x86, 0x251906, 0x8, 0x0
  .long 0x6180608, 0x6380628, 0x6680658, 0x6880678, 0x6a80698, 0x6c606b8, 0x6e806d8, 0x64f06f8
  .long 0x76afedcb, 0x45321098, 0x66066666, 0x66666566, 0x46, 0x201506, 0x4, 0x0
  .long 0x61e060e, 0x63e062e, 0x66e064e, 0x68e067e, 0x6ae069e, 0x6ce06be, 0x6ee06dd, 0x65f06fe
  .long 0x765fedcb, 0xa4321098, 0x66966666, 0x66666a66, 0xaa, 0x29061a, 0xa, 0x0
  .long 0x2850205, 0x3730345, 0x3f303c5, 0x4b50435, 0x5990519, 0x92506e3, 0xb5209a5, 0x66f0ed4
  .long 0x765aedfb, 0xc4321098, 0x66866666, 0x66666f66, 0xc6, 0x281f06, 0xc, 0x0
  .long 0x6110601, 0x6310621, 0x6510641, 0x6810661, 0x6a10691, 0x6c106b1, 0x6e106d1, 0x67f06f1
  .long 0x76afedcb, 0x54321098, 0x66166666, 0x66666566, 0x51, 0x150621, 0x5, 0x0
  .long 0x3cd034d, 0x63b060c, 0x91e06bb, 0xa2d099e, 0xb6d0aad, 0xbdc0b7e, 0xbfe0bed, 0x68f0e5d
  .long 0x765feacb, 0xd4321098, 0x66a66666, 0x66666b66, 0xd6, 0x2a1b06, 0xd, 0x0
  .long 0x6100602, 0x6320622, 0x6520642, 0x6720662, 0x6a20682, 0x6c206b2, 0x6e206d2, 0x69f06f2
  .long 0x96afedcb, 0x74321058, 0x66e66666, 0x66666366, 0x76, 0x2e1306, 0x7, 0x0
  .long 0x6170607, 0x6370627, 0x6570647, 0x6770667, 0x6970687, 0x6c706b7, 0x6e706d7, 0x6af06f7
  .long 0x76afedcb, 0x14325098, 0x66166666, 0x66666466, 0x16, 0x211406, 0x1, 0x0
  .long 0x61b060b, 0x63a062b, 0x65b064b, 0x67b066b, 0x69b068b, 0x6cb06ab, 0x6eb06db, 0x6bf06fb
  .long 0x78afedcb, 0x64321095, 0x66566666, 0x66666966, 0x66, 0x251906, 0x6, 0x0
  .long 0x6160606, 0x6360626, 0x6560646, 0x6760666, 0x6960686, 0x6b606a6, 0x6e606d6, 0x6cf06f6
  .long 0x76afedcb, 0x35421098, 0x66066666, 0x66666566, 0x36, 0x201506, 0x3, 0x0
  .long 0x61d060d, 0x63d062d, 0x65d064d, 0x67d066d, 0x69d068d, 0x6bd06ad, 0x6ed06cd, 0x6df06fd
  .long 0x765fadcb, 0xe4321098, 0x66966666, 0x66666a66, 0xe6, 0x291a06, 0xe, 0x0
  .long 0x6130603, 0x6330623, 0x6530643, 0x6730663, 0x6930683, 0x6b306a3, 0x6d306c3, 0x6ef06f3
  .long 0x765aedcb, 0xf4321098, 0x66866666, 0x66666f66, 0xf6, 0x281f06, 0xf, 0x0
  .long 0x6140604, 0x6340624, 0x6540644, 0x6710664, 0x6940684, 0x6b406a4, 0x6d406c4, 0x6ff06e4
  .long 0x765fadcb, 0xe4321098, 0x77d77777, 0x77777f77, 0xe7, 0x2d1f07, 0xe, 0x0
  .long 0x7230713, 0x7430733, 0x7630753, 0x7800773, 0x7a30793, 0x7c307b3, 0x7e307d3, 0x70f07f3
  .long 0x76afedcb, 0x4321598, 0x77277777, 0x77777177, 0x7, 0x221107, 0x0, 0x0
  .long 0x72a070a, 0x74a073a, 0x76a075a, 0x78a077a, 0x7aa079a, 0x7ca07ba, 0x7ea07da, 0x71f07fa
  .long 0x765fedcb, 0xa4321098, 0x77877777, 0x77777d77, 0xad, 0x28071d, 0xa, 0x0
  .long 0xc30043, 0x53202f1, 0x5b20574, 0x96307a1, 0xa0409e3, 0xa840a13, 0xf520a93, 0x72f0fd2
  .long 0x76afedcb, 0x24351098, 0x77077777, 0x77777677, 0x27, 0x201607, 0x2, 0x0
  .long 0x71c070c, 0x74c072c, 0x76c075c, 0x78c077c, 0x7ac079c, 0x7cc07bb, 0x7ec07dc, 0x73f07fc
  .long 0x56afedcb, 0x74321098, 0x77677777, 0x77777377, 0x77, 0x261307, 0x7, 0x0
  .long 0x7170707, 0x7370727, 0x7670757, 0x7870777, 0x7a70797, 0x7c607b7, 0x7e707d7, 0x74f07f7
  .long 0x76afedcb, 0x45321098, 0x77477777, 0x77777677, 0x47, 0x241607, 0x4, 0x0
  .long 0x71e070e, 0x73e072e, 0x76e074e, 0x78e077e, 0x7ae079e, 0x7ce07be, 0x7ee07dd, 0x75f07fe
  .long 0x765aefcb, 0xd4321098, 0x77e77777, 0x77777c77, 0xd7, 0x2e1c07, 0xd, 0x0
  .long 0x7120702, 0x7320722, 0x7520742, 0x7820772, 0x7a20792, 0x7c207b2, 0x7e207d2, 0x76f07f2
  .long 0x76afedcb, 0x94321058, 0x77c77777, 0x77777677, 0x97, 0x2c1607, 0x9, 0x0
  .long 0x7190709, 0x7390729, 0x7590749, 0x7890769, 0x7a90799, 0x7c907b9, 0x7e907d9, 0x77f07f8
  .long 0x765fadce, 0xb4321098, 0x77d77777, 0x77777f77, 0xb7, 0x2d1f07, 0xb, 0x0
  .long 0x7100700, 0x7300720, 0x7500740, 0x7700760, 0x7a00790, 0x7c007b0, 0x7e007d0, 0x78f07f0
  .long 0x76afedcb, 0x54321098, 0x77277777, 0x77777177, 0x52, 0x110722, 0x5, 0x0
  .long 0x24c020e, 0x28e027d, 0x56b02cc, 0x5fe05eb, 0xa3e071a, 0xc5e0abe, 0xdad0cde, 0x79f0f2a
  .long 0x765fedab, 0xc4321098, 0x77877777, 0x77777d77, 0xc7, 0x281d07, 0xc, 0x0
  .long 0x7110701, 0x7310721, 0x7510741, 0x7710761, 0x7910781, 0x7c107b1, 0x7e107d1, 0x7af07f1
  .long 0x76afedcb, 0x14352098, 0x77077777, 0x77777677, 0x17, 0x201607, 0x1, 0x0
  .long 0x71b070b, 0x73b072b, 0x75b074b, 0x77b076b, 0x79b078b, 0x7cb07ab, 0x7eb07db, 0x7bf07fb
  .long 0x57afedcb, 0x64321098, 0x77677777, 0x77777377, 0x67, 0x261307, 0x6, 0x0
  .long 0x7160706, 0x7360726, 0x7560746, 0x7760766, 0x7960786, 0x7b607a6, 0x7e607d6, 0x7cf07f6
  .long 0x76afedcb, 0x35421098, 0x77477777, 0x77777677, 0x37, 0x241607, 0x3, 0x0
  .long 0x71d070d, 0x73d072d, 0x75d074d, 0x77d076d, 0x79d078d, 0x7bd07ad, 0x7ed07cd, 0x7df07fd
  .long 0x765aedcb, 0xf4321098, 0x77e77777, 0x77777c77, 0xf7, 0x2e1c07, 0xf, 0x0
  .long 0x7140704, 0x7340724, 0x7540744, 0x7740762, 0x7940784, 0x7b407a4, 0x7d407c4, 0x7ef07f4
  .long 0x76afedcb, 0x84321059, 0x77c77777, 0x77777677, 0x87, 0x2c1607, 0x8, 0x0
  .long 0x7180708, 0x7380728, 0x7580748, 0x7780768, 0x7980788, 0x7b807a8, 0x7d807c8, 0x7ff07e8
  .long 0x765aedcb, 0xf4321098, 0x88e88888, 0x88888b88, 0xf8, 0x2e1b08, 0xf, 0x0
  .long 0x8240814, 0x8440834, 0x8640854, 0x8810874, 0x8a40894, 0x8c408b4, 0x8e408d4, 0x80f08f4
  .long 0x76afedcb, 0x14325098, 0x88388888, 0x88888488, 0x18, 0x231408, 0x1, 0x0
  .long 0x82b080b, 0x84b083b, 0x86b085b, 0x88b087b, 0x8ab089a, 0x8cb08bb, 0x8eb08db, 0x81f08fb
  .long 0x765fadcb, 0xe4321098, 0x88688888, 0x88888e88, 0xe8, 0x261e08, 0xe, 0x0
  .long 0x8130803, 0x8430833, 0x8630853, 0x8830873, 0x8a00893, 0x8c308b3, 0x8e308d3, 0x82f08f3
  .long 0x96afedcb, 0x74321058, 0x88788888, 0x88888888, 0x78, 0x271808, 0x7, 0x0
  .long 0x8170807, 0x8470827, 0x8670857, 0x8870877, 0x8a70897, 0x8c708b7, 0x8e708d7, 0x83f08f7
  .long 0x76afedcb, 0x34521098, 0x88488888, 0x88888788, 0x38, 0x241708, 0x3, 0x0
  .long 0x81d080d, 0x83d082d, 0x86d085d, 0x88d087d, 0x8ad089d, 0x8cd08bd, 0x8ed08dd, 0x84f08fd
  .long 0x76afedcb, 0x54321098, 0x88e88888, 0x88888488, 0x5e, 0x14082e, 0x5, 0x0
  .long 0x3750145, 0x62903f5, 0x76506a9, 0x80507e5, 0x8c50885, 0xa1508d6, 0xc350a95, 0x85f0cb5
  .long 0x765fedcb, 0x8432109a, 0x88f88888, 0x88888988, 0x88, 0x2f1908, 0x8, 0x0
  .long 0x8180808, 0x8380828, 0x8580848, 0x8880878, 0x8a80898, 0x8c808b8, 0x8e808d8, 0x86f08f8
  .long 0x76afedcb, 0x45321098, 0x88388888, 0x88888788, 0x48, 0x231708, 0x4, 0x0
  .long 0x81e080e, 0x83e082e, 0x85e084e, 0x88e086e, 0x8ae089e, 0x8ce08be, 0x8ee08de, 0x87f08fc
  .long 0x765aedfb, 0xc4321098, 0x88e88888, 0x88888b88, 0xc8, 0x2e1b08, 0xc, 0x0
  .long 0x8110801, 0x8310821, 0x8510841, 0x8710861, 0x8a10891, 0x8c108b1, 0x8e108d1, 0x88f08f1
  .long 0x76afedcb, 0x4325198, 0x88388888, 0x88888488, 0x8, 0x231408, 0x0, 0x0
  .long 0x81a080a, 0x83a082a, 0x85a084a, 0x87a086a, 0x8aa088a, 0x8ca08ba, 0x8ea08da, 0x89f08fa
  .long 0x765fadce, 0xb4321098, 0x88688888, 0x88888e88, 0xb8, 0x261e08, 0xb, 0x0
  .long 0x8100800, 0x8300820, 0x8500840, 0x8700860, 0x8900880, 0x8c008b0, 0x8e008d0, 0x8af08f0
  .long 0x76afedcb, 0x94321058, 0x88788888, 0x88888888, 0x98, 0x271808, 0x9, 0x0
  .long 0x8190809, 0x8370829, 0x8590849, 0x8790869, 0x8990889, 0x8c908a9, 0x8e908d9, 0x8bf08f9
  .long 0x765feacb, 0xd4321098, 0x88e88888, 0x88888f88, 0xd8, 0x2e1f08, 0xd, 0x0
  .long 0x8120802, 0x8320822, 0x8520842, 0x8720862, 0x8920882, 0x8b208a2, 0x8e208d2, 0x8cf08f2
  .long 0x75afedcb, 0x64321098, 0x88e88888, 0x88888488, 0x68, 0x2e1408, 0x6, 0x0
  .long 0x8160806, 0x8360826, 0x8560846, 0x8760866, 0x8960886, 0x8b608a6, 0x8e608c6, 0x8df08f6
  .long 0x765fedcb, 0xa4321098, 0x88f88888, 0x88888988, 0xa9, 0x2f0819, 0xa, 0x0
  .long 0x4880408, 0x6c50645, 0xa350868, 0xc550ab5, 0xcd50c75, 0xe250cf5, 0xf150ea5, 0x8ef0f95
  .long 0x76afedcb, 0x25341098, 0x88388888, 0x88888788, 0x28, 0x231708, 0x2, 0x0
  .long 0x81c080c, 0x83c082c, 0x85c084c, 0x87c086c, 0x89c088c, 0x8bc08ac, 0x8dc08cc, 0x8ff08ec
  .long 0x78afedcb, 0x64321095, 0x99799999, 0x99999099, 0x69, 0x271009, 0x6, 0x0
  .long 0x9260916, 0x9460936, 0x9660956, 0x9860976, 0x9a60996, 0x9c609b6, 0x9e609d6, 0x90f09f6
  .long 0x76afedcb, 0x45321098, 0x99199999, 0x99999899, 0x49, 0x211809, 0x4, 0x0
  .long 0x92e090e, 0x94e093e, 0x96e095e, 0x98e097e, 0x9ae099c, 0x9ce09be, 0x9ee09de, 0x91f09fe
  .long 0x76afedcb, 0x14325098, 0x99599999, 0x99999a99, 0x19, 0x251a09, 0x1, 0x0
  .long 0x91b090b, 0x94b093b, 0x96b095b, 0x98b097b, 0x9ab099b, 0x9cb09bb, 0x9eb09db, 0x92f09fb
  .long 0x76afedcb, 0x4521398, 0x99399999, 0x99999599, 0x9, 0x231509, 0x0, 0x0
  .long 0x91a090a, 0x94a092a, 0x96a095a, 0x98a097a, 0x9aa099a, 0x9ca09ba, 0x9ea09da, 0x93f09fa
  .long 0x765feacb, 0xd4321098, 0x99999999, 0x99999c99, 0xd9, 0x291c09, 0xd, 0x0
  .long 0x9120902, 0x9320922, 0x9620952, 0x9820972, 0x9a20992, 0x9c009b2, 0x9e209d2, 0x94f09f2
  .long 0x765aedcb, 0xf4321098, 0x99c99999, 0x99999b99, 0xf9, 0x2c1b09, 0xf, 0x0
  .long 0x9140904, 0x9340924, 0x9640944, 0x9840974, 0x9a40994, 0x9c409b4, 0x9e409d4, 0x95f09f4
  .long 0x765fadcb, 0xe4321098, 0x99599999, 0x99999d99, 0xe9, 0x251d09, 0xe, 0x0
  .long 0x9130903, 0x9330923, 0x9530943, 0x9830973, 0x9a30993, 0x9c309b3, 0x9e109d3, 0x96f09f3
  .long 0x76afedcb, 0x94321058, 0x99d99999, 0x99999599, 0x99, 0x2d1509, 0x9, 0x0
  .long 0x9190909, 0x9390929, 0x9590949, 0x9890969, 0x9a90999, 0x9c909b9, 0x9e909d9, 0x97f09f7
  .long 0x76afedcb, 0x84321095, 0x99799999, 0x99999099, 0x89, 0x271009, 0x8, 0x0
  .long 0x9180906, 0x9380928, 0x9580948, 0x9780968, 0x9a80998, 0x9c809b8, 0x9e809d8, 0x98f09f8
  .long 0x76afedcb, 0x25341098, 0x99199999, 0x99999899, 0x29, 0x211809, 0x2, 0x0
  .long 0x91c090c, 0x93c092c, 0x95c094c, 0x97c096c, 0x9ac098c, 0x9cc09bc, 0x9ec09dc, 0x99f09fc
  .long 0x76afedcb, 0x54321098, 0x99599999, 0x99999a99, 0x55, 0x1a0925, 0x5, 0x0
  .long 0x8e000e, 0x49d041d, 0x6c80648, 0x965092b, 0xb5509e5, 0xeb80e38, 0xf750ed5, 0x9af0ff5
  .long 0x76afedcb, 0x34521098, 0x99399999, 0x99999599, 0x39, 0x231509, 0x3, 0x0
  .long 0x91d090d, 0x93a092d, 0x95d094d, 0x97d096d, 0x99d098d, 0x9cd09ad, 0x9ed09dd, 0x9bf09fd
  .long 0x765feacd, 0xb4321098, 0x99999999, 0x99999c99, 0xb9, 0x291c09, 0xb, 0x0
  .long 0x9100900, 0x9300920, 0x9500940, 0x9700960, 0x9900980, 0x9b009a0, 0x9e009d0, 0x9cf09f0
  .long 0x765fedcb, 0xa4321098, 0x99c99999, 0x99999b99, 0xab, 0x2c091b, 0xa, 0x0
  .long 0x3b10331, 0x4c30443, 0x6920612, 0x8840804, 0xa610954, 0xd240ce2, 0xef30e73, 0x9df0fa3
  .long 0x765fadeb, 0xc4321098, 0x99599999, 0x99999d99, 0xc9, 0x251d09, 0xc, 0x0
  .long 0x9110901, 0x9310921, 0x9510941, 0x9710961, 0x9910981, 0x9b109a1, 0x9d109c1, 0x9ef09f1
  .long 0x96afedcb, 0x74321058, 0x99d99999, 0x99999599, 0x79, 0x2d1509, 0x7, 0x0
  .long 0x9170907, 0x9370927, 0x9570947, 0x9770967, 0x9970987, 0x9b709a7, 0x9d709c7, 0x9ff09e7
  .long 0x765aedcb, 0xf4321098, 0xaa6aaaaa, 0xaaaaadaa, 0xfa, 0x261d0a, 0xf, 0x0
  .long 0xa240a14, 0xa440a34, 0xa640a54, 0xa820a74, 0xaa40a94, 0xac40ab4, 0xae40ad4, 0xa0f0af4
  .long 0x765fadce, 0xb4321098, 0xaaeaaaaa, 0xaaaaadaa, 0xba, 0x2e1d0a, 0xb, 0x0
  .long 0xa200a00, 0xa400a30, 0xa600a50, 0xa800a70, 0xaa00a90, 0xac00ab0, 0xae00ad0, 0xa1f0af0
  .long 0x76afedcb, 0x34521098, 0xaa1aaaaa, 0xaaaaa7aa, 0x3a, 0x21170a, 0x3, 0x0
  .long 0xa1d0a0d, 0xa4d0a3d, 0xa6d0a5d, 0xa8d0a7d, 0xaac0a9d, 0xacd0abd, 0xaed0add, 0xa2f0afd
  .long 0x76afedcb, 0x45321098, 0xaa2aaaaa, 0xaaaaa9aa, 0x4a, 0x22190a, 0x4, 0x0
  .long 0xa1e0a0e, 0xa4e0a2e, 0xa6e0a5e, 0xa8e0a7e, 0xaae0a9e, 0xace0aba, 0xaee0ade, 0xa3f0afe
  .long 0x765fedcb, 0xa4321098, 0xaaaaaaaa, 0xaaaaa8aa, 0xa8, 0x2a0a18, 0xa, 0x0
  .long 0x1d50155, 0x5050275, 0x5f50585, 0x8b50835, 0x9950915, 0xda50ac5, 0xee50e65, 0xa4f0f25
  .long 0x86afedcb, 0x74321095, 0xaadaaaaa, 0xaaaaa2aa, 0x7a, 0x2d120a, 0x7, 0x0
  .long 0xa170a07, 0xa370a27, 0xa670a47, 0xa870a77, 0xaa70a97, 0xac70ab7, 0xae70ad7, 0xa5f0af7
  .long 0x765fedab, 0xc4321098, 0xaa6aaaaa, 0xaaaaabaa, 0xca, 0x261b0a, 0xc, 0x0
  .long 0xa110a01, 0xa310a21, 0xa510a41, 0xa810a71, 0xaa10a91, 0xac10ab1, 0xae10ad1, 0xa6f0af1
  .long 0x765fedcb, 0x943210a8, 0xaaaaaaaa, 0xaaaaa1aa, 0x9a, 0x2a110a, 0x9, 0x0
  .long 0xa190a09, 0xa390a29, 0xa590a49, 0xa890a69, 0xaa90a99, 0xac90ab9, 0xae90ad9, 0xa7f0af6
  .long 0x765aefcb, 0xd4321098, 0xaa6aaaaa, 0xaaaaadaa, 0xda, 0x261d0a, 0xd, 0x0
  .long 0xa120a02, 0xa320a22, 0xa520a42, 0xa720a62, 0xaa20a92, 0xac20ab2, 0xae20ad2, 0xa8f0af2
  .long 0x765fadcb, 0xe4321098, 0xaaeaaaaa, 0xaaaaadaa, 0xea, 0x2e1d0a, 0xe, 0x0
  .long 0xa100a03, 0xa330a23, 0xa530a43, 0xa730a63, 0xaa30a83, 0xac30ab3, 0xae30ad3, 0xa9f0af3
  .long 0x76afedcb, 0x24531098, 0xaa1aaaaa, 0xaaaaa7aa, 0x2a, 0x21170a, 0x2, 0x0
  .long 0xa1c0a0c, 0xa3c0a2c, 0xa5c0a4c, 0xa7c0a6c, 0xa9c0a8c, 0xacc0abc, 0xaec0adc, 0xaaf0afc
  .long 0x76afedcb, 0x5321498, 0xaa2aaaaa, 0xaaaaa9aa, 0xa, 0x22190a, 0x0, 0x0
  .long 0xa1a0a0a, 0xa3a0a2a, 0xa5a0a4a, 0xa7a0a6a, 0xa9a0a8a, 0xaca0aaa, 0xaea0ada, 0xabf0afa
  .long 0x76afedcb, 0x54321098, 0xaaaaaaaa, 0xaaaaa8aa, 0x5a, 0x180a2a, 0x5, 0x0
  .long 0x1a50125, 0x2e50265, 0x3b50335, 0x4850405, 0x6950615, 0xa750a45, 0xd550af5, 0xacf0dd5
  .long 0x76afedcb, 0x84321095, 0xaadaaaaa, 0xaaaaa2aa, 0x8a, 0x2d120a, 0x8, 0x0
  .long 0xa180a08, 0xa380a28, 0xa570a48, 0xa780a68, 0xa980a88, 0xab80aa8, 0xae80ac8, 0xadf0af8
  .long 0x76afedcb, 0x14325098, 0xaa0aaaaa, 0xaaaaa1aa, 0x1a, 0x20110a, 0x1, 0x0
  .long 0xa1b0a0b, 0xa3b0a2b, 0xa5b0a4b, 0xa7b0a6b, 0xa9b0a8b, 0xabb0aab, 0xadb0acb, 0xaef0afb
  .long 0x795fedcb, 0x643210a8, 0xaaaaaaaa, 0xaaaaa1aa, 0x6a, 0x2a110a, 0x6, 0x0
  .long 0xa160a06, 0xa360a26, 0xa560a46, 0xa760a66, 0xa960a86, 0xab60aa6, 0xad60ac6, 0xaff0ae6
  .long 0x765fedcb, 0xa4321098, 0xbb8bbbbb, 0xbbbbb7bb, 0xa7, 0x280b17, 0xa, 0x0
  .long 0x950015, 0x46501c5, 0x55504e5, 0x84505d5, 0x8f50875, 0xaa50a25, 0xf350b86, 0xb0f0fb5
  .long 0x765fedac, 0xb4321098, 0xbbdbbbbb, 0xbbbbbcbb, 0xbb, 0x2d1c0b, 0xb, 0x0
  .long 0xb200b00, 0xb400b30, 0xb600b50, 0xb800b70, 0xba00b90, 0xbc00bb0, 0xbe00bd0, 0xb1f0bf0
  .long 0x765fedcb, 0x943210a8, 0xbbcbbbbb, 0xbbbbb0bb, 0x9b, 0x2c100b, 0x9, 0x0
  .long 0xb190b09, 0xb490b39, 0xb690b59, 0xb890b79, 0xba70b99, 0xbc90bb9, 0xbe90bd9, 0xb2f0bf9
  .long 0x765afdcb, 0xe4321098, 0xbb6bbbbb, 0xbbbbbcbb, 0xeb, 0x261c0b, 0xe, 0x0
  .long 0xb130b03, 0xb430b23, 0xb630b53, 0xb830b73, 0xba30b93, 0xbc30bb3, 0xbe30bd3, 0xb3f0bf3
  .long 0x76afedcb, 0x84321095, 0xbb8bbbbb, 0xbbbbb6bb, 0x8b, 0x28160b, 0x8, 0x0
  .long 0xb180b08, 0xb380b28, 0xb680b58, 0xb880b78, 0xba80b98, 0xbc80bb8, 0xbe80bd8, 0xb4f0bf8
  .long 0x765feacb, 0xd4321098, 0xbb5bbbbb, 0xbbbbbabb, 0xdb, 0x251a0b, 0xd, 0x0
  .long 0xb120b02, 0xb320b22, 0xb620b42, 0xb820b72, 0xba20b92, 0xbc20bb2, 0xbe20bd2, 0xb5f0bf2
  .long 0x76afedcb, 0x34521098, 0xbb1bbbbb, 0xbbbbb4bb, 0x3b, 0x21140b, 0x3, 0x0
  .long 0xb1d0b0d, 0xb3d0b2d, 0xb5d0b4d, 0xb8d0b7d, 0xbad0b9d, 0xbcd0bbd, 0xbeb0bdd, 0xb6f0bfd
  .long 0x76afedcb, 0x5321498, 0xbb1bbbbb, 0xbbbbb2bb, 0xb, 0x21120b, 0x0, 0x0
  .long 0xb1a0b0a, 0xb3a0b2a, 0xb5a0b4a, 0xb8a0b6a, 0xbaa0b9a, 0xbca0bba, 0xbea0bda, 0xb7f0bfa
  .long 0x7a5fedcb, 0x64321098, 0xbb8bbbbb, 0xbbbbb7bb, 0x6b, 0x28170b, 0x6, 0x0
  .long 0xb160b06, 0xb360b26, 0xb560b46, 0xb760b66, 0xba60b96, 0xbc60bb6, 0xbe60bd6, 0xb8f0bf6
  .long 0x765fedab, 0xc4321098, 0xbbdbbbbb, 0xbbbbbcbb, 0xcb, 0x2d1c0b, 0xc, 0x0
  .long 0xb100b01, 0xb310b21, 0xb510b41, 0xb710b61, 0xba10b81, 0xbc10bb1, 0xbe10bd1, 0xb9f0bf1
  .long 0x965fedcb, 0x743210a8, 0xbbcbbbbb, 0xbbbbb0bb, 0x7b, 0x2c100b, 0x7, 0x0
  .long 0xb170b07, 0xb370b27, 0xb570b47, 0xb770b67, 0xb970b87, 0xbc70bb7, 0xbe70bd7, 0xbaf0bf7
  .long 0x765aedcb, 0xf4321098, 0xbb6bbbbb, 0xbbbbbcbb, 0xfb, 0x261c0b, 0xf, 0x0
  .long 0xb140b04, 0xb330b24, 0xb540b44, 0xb740b64, 0xb940b84, 0xbc40ba4, 0xbe40bd4, 0xbbf0bf4
  .long 0x76afedcb, 0x54321098, 0xbb8bbbbb, 0xbbbbb6bb, 0x58, 0x160b28, 0x5, 0x0
  .long 0xd50055, 0x1650135, 0x1e501b5, 0x6f50675, 0x7a50725, 0xb480b05, 0xc150b85, 0xbcf0c95
  .long 0x76afedcb, 0x24351098, 0xbb1bbbbb, 0xbbbbb3bb, 0x2b, 0x21130b, 0x2, 0x0
  .long 0xb1c0b0c, 0xb3c0b2c, 0xb5c0b4c, 0xb7c0b6c, 0xb9c0b8c, 0xbbc0bac, 0xbec0bcc, 0xbdf0bfc
  .long 0x76afedcb, 0x14523098, 0xbb1bbbbb, 0xbbbbb4bb, 0x1b, 0x21140b, 0x1, 0x0
  .long 0xb1b0b0b, 0xb3b0b2b, 0xb5b0b4b, 0xb7b0b6b, 0xb9b0b8b, 0xbbb0bab, 0xbdb0bcb, 0xbef0bfb
  .long 0x76afedcb, 0x45321098, 0xbb1bbbbb, 0xbbbbb2bb, 0x4b, 0x21120b, 0x4, 0x0
  .long 0xb1e0b0e, 0xb3e0b2e, 0xb5e0b4e, 0xb7a0b6e, 0xb9e0b8e, 0xbbe0bae, 0xbde0bce, 0xbff0bee
  .long 0x765fadce, 0xb4321098, 0xcccccccc, 0xcccccccc, 0xbc, 0x2c1c0c, 0xb, 0x0
  .long 0xc200c10, 0xc400c30, 0xc600c50, 0xc800c70, 0xca00c90, 0xcc00cb0, 0xce00cd0, 0xc0f0cf0
  .long 0x765aedfb, 0xc4321098, 0xcc8ccccc, 0xcccccfcc, 0xcc, 0x281f0c, 0xc, 0x0
  .long 0xc210c01, 0xc410c31, 0xc610c51, 0xc810c71, 0xca10c91, 0xcc10cb1, 0xce10cd1, 0xc1f0cf1
  .long 0x765fedcb, 0x843210a9, 0xccbccccc, 0xccccc4cc, 0x8c, 0x2b140c, 0x8, 0x0
  .long 0xc180c08, 0xc480c38, 0xc680c58, 0xc880c78, 0xca80c98, 0xcc80cb8, 0xce80cd8, 0xc2f0cf8
  .long 0x765fedcb, 0xa4321098, 0xcceccccc, 0xccccc1cc, 0xa1, 0x2e0c11, 0xa, 0x0
  .long 0x1a80128, 0x3570305, 0x3d70385, 0x7950715, 0xae50a79, 0xc450af9, 0xcb70c65, 0xc3f0cc5
  .long 0x76afedcb, 0x34521098, 0xcc0ccccc, 0xccccc1cc, 0x3c, 0x20110c, 0x3, 0x0
  .long 0xc1d0c0d, 0xc3d0c2d, 0xc6d0c5d, 0xc8d0c7d, 0xcad0c9d, 0xccb0cbd, 0xced0cdd, 0xc4f0cfd
  .long 0x76afedcb, 0x25341098, 0xcc2ccccc, 0xccccc9cc, 0x2c, 0x22190c, 0x2, 0x0
  .long 0xc1c0c0c, 0xc3c0c2c, 0xc6c0c4c, 0xc8c0c7c, 0xcac0c9c, 0xccc0cbc, 0xcec0cdc, 0xc5f0cfc
  .long 0x76afedcb, 0x4321598, 0xcc0ccccc, 0xccccc1cc, 0xc, 0x20110c, 0x0, 0x0
  .long 0xc1a0c0a, 0xc3a0c2a, 0xc5a0c4a, 0xc8a0c7a, 0xcaa0c9a, 0xcca0cba, 0xcea0cda, 0xc6f0cfa
  .long 0x76afedcb, 0x54321098, 0xcc7ccccc, 0xccccc9cc, 0x57, 0x190c27, 0x5, 0x0
  .long 0x990019, 0x2d50255, 0x4690445, 0x4e904c5, 0x5a50525, 0x8b90839, 0x9880908, 0xc7f0cf6
  .long 0x765fadcb, 0xe4321098, 0xcccccccc, 0xcccccccc, 0xec, 0x2c1c0c, 0xe, 0x0
  .long 0xc130c00, 0xc330c23, 0xc530c43, 0xc730c63, 0xca30c93, 0xcc30cb3, 0xce30cd3, 0xc8f0cf3
  .long 0x765aedcb, 0xf4321098, 0xcc8ccccc, 0xcccccfcc, 0xfc, 0x281f0c, 0xf, 0x0
  .long 0xc110c04, 0xc340c24, 0xc540c44, 0xc740c64, 0xca40c84, 0xcc40cb4, 0xce40cd4, 0xc9f0cf4
  .long 0x765fedcb, 0x943210a8, 0xccbccccc, 0xccccc4cc, 0x9c, 0x2b140c, 0x9, 0x0
  .long 0xc190c09, 0xc390c28, 0xc590c49, 0xc790c69, 0xc990c89, 0xcc90cb9, 0xce90cd9, 0xcaf0cf9
  .long 0xa65fedcb, 0x74321098, 0xcceccccc, 0xccccc1cc, 0x7c, 0x2e110c, 0x7, 0x0
  .long 0xc170c07, 0xc370c27, 0xc570c47, 0xc770c67, 0xc970c87, 0xcc70ca7, 0xce70cd7, 0xcbf0cf7
  .long 0x76afedcb, 0x14523098, 0xcc0ccccc, 0xccccc1cc, 0x1c, 0x20110c, 0x1, 0x0
  .long 0xc1b0c0b, 0xc3b0c2b, 0xc5b0c4b, 0xc7b0c6b, 0xc9b0c8b, 0xcbb0cab, 0xceb0cdb, 0xccf0cfb
  .long 0x76afedcb, 0x45321098, 0xcc2ccccc, 0xccccc9cc, 0x4c, 0x22190c, 0x4, 0x0
  .long 0xc1e0c0e, 0xc3e0c2e, 0xc5c0c4e, 0xc7e0c6e, 0xc9e0c8e, 0xcbe0cae, 0xcee0cce, 0xcdf0cfe
  .long 0x765feacb, 0xd4321098, 0xcc6ccccc, 0xcccccbcc, 0xdc, 0x261b0c, 0xd, 0x0
  .long 0xc120c02, 0xc320c22, 0xc520c42, 0xc720c62, 0xc920c82, 0xcb20ca2, 0xcd20cc2, 0xcef0cf2
  .long 0x75afedcb, 0x64321098, 0xcc7ccccc, 0xccccc9cc, 0x6c, 0x27190c, 0x6, 0x0
  .long 0xc160c06, 0xc360c26, 0xc560c46, 0xc760c66, 0xc960c86, 0xcb60ca6, 0xcd60cc6, 0xcff0ce6
  .long 0x76afedcb, 0x24351098, 0xdd0ddddd, 0xddddd6dd, 0x2d, 0x20160d, 0x2, 0x0
  .long 0xd2c0d1c, 0xd4c0d3c, 0xd6c0d5c, 0xd8b0d7c, 0xdac0d9c, 0xdcc0dbc, 0xdec0ddc, 0xd0f0dfc
  .long 0x56afedcb, 0x74321098, 0xdd6ddddd, 0xddddd3dd, 0x7d, 0x26130d, 0x7, 0x0
  .long 0xd270d07, 0xd470d37, 0xd670d57, 0xd870d77, 0xda70d97, 0xdc70db7, 0xde70dd7, 0xd1f0df7
  .long 0x765aedcb, 0xf4321098, 0xddfddddd, 0xdddddbdd, 0xfd, 0x2f1b0d, 0xf, 0x0
  .long 0xd140d04, 0xd440d34, 0xd640d54, 0xd840d74, 0xda40d94, 0xdc40db4, 0xde40dd4, 0xd2f0df4
  .long 0x76afedcb, 0x94321058, 0xdddddddd, 0xddddd3dd, 0x9d, 0x2d130d, 0x9, 0x0
  .long 0xd190d09, 0xd490d29, 0xd690d59, 0xd890d79, 0xda90d99, 0xdc90db6, 0xde90dd9, 0xd3f0df9
  .long 0x76afedcb, 0x45321098, 0xdd3ddddd, 0xddddd0dd, 0x4d, 0x23100d, 0x4, 0x0
  .long 0xd1e0d0e, 0xd3e0d2e, 0xd6e0d5e, 0xd8e0d7e, 0xdae0d9e, 0xdca0dbe, 0xdee0dde, 0xd4f0dfe
  .long 0x765feadb, 0xc4321098, 0xddaddddd, 0xdddddedd, 0xcd, 0x2a1e0d, 0xc, 0x0
  .long 0xd110d01, 0xd310d21, 0xd610d41, 0xd810d71, 0xda10d91, 0xdc10db1, 0xde10dd1, 0xd5f0df1
  .long 0x765fadce, 0xb4321098, 0xddbddddd, 0xdddddfdd, 0xbd, 0x2b1f0d, 0xb, 0x0
  .long 0xd100d00, 0xd300d20, 0xd500d40, 0xd800d70, 0xda00d90, 0xdc00db0, 0xde00dd0, 0xd6f0df0
  .long 0x765fedcb, 0xa4321098, 0xddfddddd, 0xddddd0dd, 0xa0, 0x2f0d10, 0xa, 0x0
  .long 0xe50065, 0x1950115, 0x2d90259, 0x9850905, 0xba90b29, 0xdc50d45, 0xe350df8, 0xd7f0eb5
  .long 0x76afedcb, 0x14352098, 0xdd0ddddd, 0xddddd6dd, 0x1d, 0x20160d, 0x1, 0x0
  .long 0xd1b0d0b, 0xd3b0d2b, 0xd5b0d4b, 0xd7b0d6b, 0xdab0d9b, 0xdcb0dbb, 0xdeb0ddb, 0xd8f0dfb
  .long 0x76afedcb, 0x54321098, 0xdd6ddddd, 0xddddd3dd, 0x56, 0x130d26, 0x5, 0x0
  .long 0x4750455, 0x4f504d5, 0x7c70747, 0x8a50825, 0xa650a05, 0xb350a85, 0xce50bb5, 0xd9f0d17
  .long 0x76afedcb, 0x34521098, 0xdd2ddddd, 0xddddd8dd, 0x3d, 0x22180d, 0x3, 0x0
  .long 0xd1d0d0d, 0xd3d0d2d, 0xd5d0d4d, 0xd7d0d6d, 0xd9d0d8d, 0xdcd0dbd, 0xded0ddd, 0xdaf0dfd
  .long 0x79afedcb, 0x64321058, 0xdddddddd, 0xddddd3dd, 0x6d, 0x2d130d, 0x6, 0x0
  .long 0xd160d06, 0xd360d26, 0xd560d46, 0xd760d66, 0xd960d86, 0xdc60da6, 0xde60dd6, 0xdbf0df6
  .long 0x76afedcb, 0x5321498, 0xdd3ddddd, 0xddddd0dd, 0xd, 0x23100d, 0x0, 0x0
  .long 0xd1a0d0a, 0xd3a0d2a, 0xd5a0d4a, 0xd7a0d6a, 0xd9a0d8a, 0xdba0daa, 0xdea0dda, 0xdcf0dfa
  .long 0x765feacb, 0xd4321098, 0xddaddddd, 0xdddddedd, 0xdd, 0x2a1e0d, 0xd, 0x0
  .long 0xd120d02, 0xd320d22, 0xd510d42, 0xd720d62, 0xd920d82, 0xdb20da2, 0xde20dc2, 0xddf0df2
  .long 0x765fadcb, 0xe4321098, 0xddbddddd, 0xdddddfdd, 0xed, 0x2b1f0d, 0xe, 0x0
  .long 0xd130d03, 0xd330d23, 0xd530d43, 0xd730d60, 0xd930d83, 0xdb30da3, 0xdd30dc3, 0xdef0df3
  .long 0x765fedcb, 0x8432109a, 0xddfddddd, 0xddddd0dd, 0x8d, 0x2f100d, 0x8, 0x0
  .long 0xd180d08, 0xd380d28, 0xd580d48, 0xd780d68, 0xd980d88, 0xdb80da8, 0xdd80dc8, 0xdff0de8
  .long 0x7a5fedcb, 0x64321098, 0xeefeeeee, 0xeeeee2ee, 0x6e, 0x2f120e, 0x6, 0x0
  .long 0xe260e16, 0xe460e36, 0xe660e56, 0xe860e76, 0xea60e96, 0xec60eb6, 0xee60ed6, 0xe0f0ef6
  .long 0x76afedcb, 0x4351298, 0xee4eeeee, 0xeeeee2ee, 0xe, 0x24120e, 0x0, 0x0
  .long 0xe2a0e0a, 0xe4a0e3a, 0xe6a0e5a, 0xe8a0e7a, 0xeaa0e9a, 0xeca0eba, 0xeea0eda, 0xe1f0efa
  .long 0x76afedcb, 0x45321098, 0xee4eeeee, 0xeeeee9ee, 0x4e, 0x24190e, 0x4, 0x0
  .long 0xe1e0e0e, 0xe4e0e3e, 0xe6e0e5e, 0xe8e0e7e, 0xeab0e9e, 0xece0ebe, 0xeee0ede, 0xe2f0efe
  .long 0x76afedcb, 0x84321095, 0xee5eeeee, 0xeeeee0ee, 0x8e, 0x25100e, 0x8, 0x0
  .long 0xe180e08, 0xe480e28, 0xe680e58, 0xe880e78, 0xea80e98, 0xec80eb7, 0xee80ed8, 0xe3f0ef8
  .long 0x765feadb, 0xc4321098, 0xeeceeeee, 0xeeeeeeee, 0xce, 0x2c1e0e, 0xc, 0x0
  .long 0xe110e01, 0xe310e21, 0xe610e51, 0xe810e71, 0xea10e91, 0xec10eb1, 0xee10ed1, 0xe4f0ef1
  .long 0x76afedcb, 0x34521098, 0xee1eeeee, 0xeeeee3ee, 0x3e, 0x21130e, 0x3, 0x0
  .long 0xe1d0e0d, 0xe3d0e2d, 0xe6d0e4d, 0xe8d0e7d, 0xead0e9d, 0xecd0ebd, 0xeed0edd, 0xe5f0efd
  .long 0x76afedcb, 0x54321098, 0xeedeeeee, 0xeeeee8ee, 0x5d, 0x180e2d, 0x5, 0x0
  .long 0xa50025, 0x7850705, 0x9f90979, 0xad80a58, 0xb950b15, 0xdb90d39, 0xf450ee9, 0xe6f0fc5
  .long 0x765fadce, 0xb4321098, 0xeebeeeee, 0xeeeeebee, 0xbe, 0x2b1b0e, 0xb, 0x0
  .long 0xe100e00, 0xe300e20, 0xe500e40, 0xe800e60, 0xea00e90, 0xec00eb0, 0xee00ed0, 0xe7f0ef0
  .long 0x765fedcb, 0xa4321098, 0xeefeeeee, 0xeeeee2ee, 0xa2, 0x2f0e12, 0xa, 0x0
  .long 0xb80038, 0x3a50325, 0x5e50565, 0xad50a55, 0xbf50b75, 0xe150e06, 0xf490e95, 0xe8f0fc9
  .long 0x76afedcb, 0x24351098, 0xee4eeeee, 0xeeeee2ee, 0x2e, 0x24120e, 0x2, 0x0
  .long 0xe1a0e0c, 0xe3c0e2c, 0xe5c0e4c, 0xe7c0e6c, 0xeac0e8c, 0xecc0ebc, 0xeec0edc, 0xe9f0efc
  .long 0x76afedcb, 0x15324098, 0xee4eeeee, 0xeeeee9ee, 0x1e, 0x24190e, 0x1, 0x0
  .long 0xe1b0e0b, 0xe3b0e2b, 0xe5b0e4b, 0xe7b0e6b, 0xe9b0e8b, 0xecb0ebb, 0xeeb0edb, 0xeaf0efb
  .long 0x86afedcb, 0x74321095, 0xee5eeeee, 0xeeeee0ee, 0x7e, 0x25100e, 0x7, 0x0
  .long 0xe170e07, 0xe370e27, 0xe570e47, 0xe770e67, 0xe970e87, 0xec70ea7, 0xee70ed7, 0xebf0ef7
  .long 0x765feacb, 0xd4321098, 0xeeceeeee, 0xeeeeeeee, 0xde, 0x2c1e0e, 0xd, 0x0
  .long 0xe120e02, 0xe320e22, 0xe520e41, 0xe720e62, 0xe920e82, 0xeb20ea2, 0xee20ed2, 0xecf0ef2
  .long 0x765aedcb, 0xf4321098, 0xee5eeeee, 0xeeeeeaee, 0xfe, 0x251a0e, 0xf, 0x0
  .long 0xe140e04, 0xe340e24, 0xe540e44, 0xe740e64, 0xe940e84, 0xeb40ea4, 0xee40ec4, 0xedf0ef4
  .long 0x76afedcb, 0x94321058, 0xeedeeeee, 0xeeeee8ee, 0x9e, 0x2d180e, 0x9, 0x0
  .long 0xe190e09, 0xe390e29, 0xe590e49, 0xe790e69, 0xe990e89, 0xeb90ea9, 0xed90ec9, 0xeef0ef9
  .long 0x765fadcb, 0xe4321098, 0xeebeeeee, 0xeeeeebee, 0xee, 0x2b1b0e, 0xe, 0x0
  .long 0xe130e03, 0xe330e23, 0xe530e43, 0xe700e63, 0xe930e83, 0xeb30ea3, 0xed30ec3, 0xeff0ee3
  .long 0x76afedcb, 0x34521098, 0xff3fffff, 0xfffff4ff, 0x3f, 0x23140f, 0x3, 0x0
  .long 0xf2d0f1d, 0xf4d0f3d, 0xf6d0f5d, 0xf8b0f7d, 0xfad0f9d, 0xfcd0fbd, 0xfed0fdd, 0xf0f0ffd
  .long 0x76afedcb, 0x25341098, 0xff0fffff, 0xfffff9ff, 0x2f, 0x20190f, 0x2, 0x0
  .long 0xf2c0f0c, 0xf4c0f3c, 0xf6c0f5c, 0xf8c0f7c, 0xfac0f9c, 0xfcc0fbc, 0xfec0fdc, 0xf1f0ffc
  .long 0x76afedcb, 0x4321598, 0xff2fffff, 0xfffff8ff, 0xf, 0x22180f, 0x0, 0x0
  .long 0xf1a0f0a, 0xf4a0f3a, 0xf6a0f5a, 0xf8a0f7a, 0xfaa0f9a, 0xfca0fba, 0xfea0fda, 0xf2f0ffa
  .long 0x86afedcb, 0x74321095, 0xffbfffff, 0xfffff7ff, 0x7f, 0x2b170f, 0x7, 0x0
  .long 0xf170f07, 0xf470f27, 0xf670f57, 0xf870f77, 0xfa70f97, 0xfc70fb7, 0xfe70fd7, 0xf3f0ff7
  .long 0x795fedcb, 0x643210a8, 0xffdfffff, 0xfffff2ff, 0x6f, 0x2d120f, 0x6, 0x0
  .long 0xf160f06, 0xf360f26, 0xf660f56, 0xf860f76, 0xfa60f96, 0xfc60fb6, 0xfe60fd6, 0xf4f0ff6
  .long 0x765feacb, 0xd4321098, 0xffbfffff, 0xfffffdff, 0xdf, 0x2b1d0f, 0xd, 0x0
  .long 0xf120f02, 0xf320f22, 0xf620f42, 0xf820f72, 0xfa20f92, 0xfc20fb2, 0xfe20fd1, 0xf5f0ff2
  .long 0x76afedcb, 0x54321098, 0xffcfffff, 0xfffff5ff, 0x5c, 0x150f2c, 0x5, 0x0
  .long 0x2950215, 0x5b50535, 0x7f90779, 0x9d50955, 0xba50b25, 0xc850c05, 0xec50e45, 0xf6f0fe5
  .long 0x765aedcf, 0xb4321098, 0xff5fffff, 0xfffffcff, 0xbf, 0x251c0f, 0xb, 0x0
  .long 0xf100f00, 0xf300f20, 0xf500f40, 0xf800f60, 0xfa00f90, 0xfc00fb0, 0xfe00fd0, 0xf7f0ff0
  .long 0x76afedcb, 0x14523098, 0xff3fffff, 0xfffff4ff, 0x1f, 0x23140f, 0x1, 0x0
  .long 0xf1b0f0b, 0xf3b0f2b, 0xf5b0f4b, 0xf7b0f6b, 0xfab0f9b, 0xfcb0fbb, 0xfeb0fdb, 0xf8f0ffb
  .long 0x76afedcb, 0x45321098, 0xff0fffff, 0xfffff9ff, 0x4f, 0x20190f, 0x4, 0x0
  .long 0xf1c0f0e, 0xf3e0f2e, 0xf5e0f4e, 0xf7e0f6e, 0xfae0f8e, 0xfce0fbe, 0xfee0fde, 0xf9f0ffe
  .long 0x765fadcb, 0xe4321098, 0xffffffff, 0xfffffbff, 0xef, 0x2f1b0f, 0xe, 0x0
  .long 0xf130f03, 0xf330f23, 0xf530f43, 0xf730f63, 0xf930f83, 0xfc30fb3, 0xfe30fd3, 0xfaf0ff3
  .long 0x76afedcb, 0x84321095, 0xffbfffff, 0xfffff7ff, 0x8f, 0x2b170f, 0x8, 0x0
  .long 0xf180f08, 0xf370f28, 0xf580f48, 0xf780f68, 0xf980f88, 0xfc80fa8, 0xfe80fd8, 0xfbf0ff8
  .long 0x765fedcb, 0x943210a8, 0xffdfffff, 0xfffff2ff, 0x9f, 0x2d120f, 0x9, 0x0
  .long 0xf190f09, 0xf390f29, 0xf590f46, 0xf790f69, 0xf990f89, 0xfb90fa9, 0xfe90fd9, 0xfcf0ff9
  .long 0x765feadb, 0xc4321098, 0xffbfffff, 0xfffffdff, 0xcf, 0x2b1d0f, 0xc, 0x0
  .long 0xf110f01, 0xf310f21, 0xf510f41, 0xf710f61, 0xf910f81, 0xfb10fa1, 0xfe10fc1, 0xfdf0ff1
  .long 0x765fedcb, 0xa4321098, 0xffcfffff, 0xfffff5ff, 0xa5, 0x2c0f15, 0xa, 0x0
  .long 0x2450225, 0x2c502a5, 0x4950415, 0x6550605, 0x6d50685, 0x9750935, 0x9f509b5, 0xfef0f65
  .long 0x765aedcb, 0xf4321098, 0xff5fffff, 0xfffffcff, 0xff, 0x251c0f, 0xf, 0x0
  .long 0xf140f04, 0xf340f24, 0xf540f44, 0xf700f64, 0xf940f84, 0xfb40fa4, 0xfd40fc4, 0xfff0fe4
L_order_end:
.section .rodata,"a"
.p2align 6
.amdhsa_kernel standalone__kv_cache_quant_pre_rope_vs_post_rope__sampling_kernel
  .amdhsa_next_free_vgpr 254
  .amdhsa_next_free_sgpr 102
  .amdhsa_accum_offset 256
  .amdhsa_group_segment_fixed_size 0
  .amdhsa_kernarg_size 112
  .amdhsa_user_sgpr_count 2
  .amdhsa_user_sgpr_kernarg_segment_ptr 1
  .amdhsa_system_sgpr_workgroup_id_x 1
.end_amdhsa_kernel
```

```asm
; @launch grid=(256,1,1) block=(320,1,1) lds=162304
.amdgcn_target "amdgcn-amd-amdhsa--gfx950"
.text
.globl standalone__kv_cache_quant_pre_rope_vs_post_rope__sampling_kernel
.p2align 12
.type L_pad,@object
L_pad:
.fill 832, 4, 0xbf810000
.p2align 8
.type standalone__kv_cache_quant_pre_rope_vs_post_rope__sampling_kernel,@function
standalone__kv_cache_quant_pre_rope_vs_post_rope__sampling_kernel:
  s_cmpk_ge_u32 s2, 0x100
  s_cbranch_scc1 L_end
  s_load_dwordx16 s[4:19], s[0:1], 0
  s_load_dwordx8 s[20:27], s[0:1], 64
  s_load_dwordx4 s[28:31], s[0:1], 96
  v_readfirstlane_b32 s40, v0
  s_lshr_b32 s42, s2, 4
  s_cmp_lg_u32 s40, 0
  s_cbranch_scc1 L_s0
  s_setprio 3
  s_getpc_b64 s[64:65]
L_pc0:
  s_and_b32 s44, s2, 56
  v_and_b32 v20, 63, v0
  v_lshl_add_u32 v1, v20, 6, s44
  v_lshlrev_b32_e64 v1, 4, v1
  v_min_u32 v1, L_order_end-L_pc0-1028, v1
  s_bfm_b64 exec, 50, 0
  global_load_dword v2, v1, s[64:65] offset:1024
  s_mov_b64 exec, -1
  v_min_u32 v21, 47, v20
  v_add_u32 v22, 24, v21
  v_subrev_u32_e64 v23, 24, v21
  v_min_u32 v27, v22, v23
  s_mul_i32 s44, s42, 48
  v_add_lshl_u32 v22, v21, s44, 3
  v_add_lshl_u32 v23, v27, s44, 3
  v_lshlrev_b32 v26, 3, v21
  s_and_b32 s44, s2, 7
  s_lshr_b32 s45, s2, 3
  v_and_b32 v12, 15, v21
  v_and_b32_e64 v4, 48, v21
  v_lshl_add_u32 v12, v4, 5, v12
  s_mul_i32 s68, s44, 96
  s_and_b32 s46, s45, 30
  s_add_u32 s68, s68, s46
  v_lshl_add_u32 v3, s68, 4, v12
  v_lshlrev_b32_e64 v3, 6, v3
  v_lshl_add_u32 v12, s45, 4, v12
  v_lshlrev_b32 v12, 6, v12
  s_lshr_b32 s68, s45, 2
  s_lshl_b32 s68, s68, 8
  s_add_u32 s44, s44, s68
  v_and_b32_e64 v4, 7, v20
  v_lshl_add_u32 v4, s44, 3, v4
  v_and_b32_e64 v5, 24, v20
  v_lshl_add_u32 v4, v5, 6, v4
  v_and_b32_e64 v5, 32, v20
  v_lshl_add_u32 v4, v5, 1, v4
  v_lshlrev_b32_e64 v4, 6, v4
  v_add_u32 v15, 8192, v4
  v_add_u32 v16, 16384, v4
  v_add_u32 v17, 24576, v4
  v_lshlrev_b32 v27, 3, v27
  s_waitcnt lgkmcnt(0)
  s_bitcmp1_b32 s2, 3
  s_cselect_b64 s[70:71], s[24:25], s[22:23]
  global_load_dword v5, v3, s[70:71]
  global_load_dword v6, v3, s[70:71] offset:1024
  global_load_dword v11, v12, s[4:5]
  global_load_dwordx2 v[108:109], v22, s[4:5]
  global_load_dwordx2 v[110:111], v23, s[4:5]
  global_load_dwordx2 v[104:105], v26, s[18:19]
  global_load_dwordx2 v[106:107], v26, s[20:21]
  s_add_u32 s68, s42, 16
  s_mul_i32 s44, s68, 384
  s_add_u32 s32, s4, s44
  s_addc_u32 s33, s5, 0
  global_load_dwordx2 v[112:113], v26, s[32:33]
  global_load_dwordx2 v[114:115], v27, s[32:33]
  s_add_u32 s68, s42, 32
  s_mul_i32 s44, s68, 384
  s_add_u32 s32, s4, s44
  s_addc_u32 s33, s5, 0
  global_load_dwordx2 v[116:117], v26, s[32:33]
  global_load_dwordx2 v[118:119], v27, s[32:33]
  s_bitcmp1_b32 s2, 3
  s_cselect_b64 s[70:71], s[10:11], s[8:9]
  s_cselect_b64 s[64:65], s[16:17], s[14:15]
  s_bitcmp1_b32 s2, 4
  s_cselect_b64 s[64:65], s[64:65], s[70:71]
  global_load_dword v7, v4, s[64:65]
  global_load_dword v8, v15, s[64:65]
  global_load_dword v9, v16, s[64:65]
  global_load_dword v10, v17, s[64:65]
  v_mov_b32 v14, 0
  v_cmp_gt_u32 vcc, 24, v21
  v_mov_b32 v48, 0
  v_mov_b32 v49, 0
  v_mov_b32 v50, 0
  v_mov_b32_e64 v51, 0
  ds_write_b128 v14, v[48:51] offset:0
  ds_write_b128 v14, v[48:51] offset:16
  s_waitcnt lgkmcnt(0)
  s_barrier
  s_mov_b32 s66, 0xffff0000
  s_mov_b32 s67, 0x3dd53b95
  v_cndmask_b32_e64 v30, 1.0, -1.0, vcc
  v_lshlrev_b32 v35, 4, v21
  v_mov_b32 v28, v35
  v_lshlrev_b32_e64 v29, 1, v27
  v_mov_b32 v22, 0x80008000
  v_cndmask_b32 v31, v14, v22, vcc
  v_mov_b32 v38, 1
  s_mov_b32 s43, 1
  s_waitcnt vmcnt(8)
  v_lshlrev_b32 v52, 16, v104
  v_and_b32 v53, s66, v104
  v_lshlrev_b32 v54, 16, v105
  v_and_b32 v55, s66, v105
  v_lshlrev_b32 v56, 16, v106
  v_and_b32 v57, s66, v106
  v_lshlrev_b32 v58, 16, v107
  v_and_b32 v59, s66, v107
L_hr:
  v_lshlrev_b32 v76, 16, v108
  v_and_b32 v77, s66, v108
  v_lshlrev_b32 v78, 16, v109
  v_and_b32 v79, s66, v109
  v_lshlrev_b32 v80, 16, v110
  v_and_b32 v81, s66, v110
  v_lshlrev_b32 v82, 16, v111
  v_and_b32 v83, s66, v111
  v_mul_f32 v76, v76, v52
  v_mul_f32 v77, v77, v53
  v_mul_f32 v78, v78, v54
  v_mul_f32 v79, v79, v55
  v_mul_f32 v80, v80, v56
  v_mul_f32 v81, v81, v57
  v_mul_f32 v82, v82, v58
  v_mul_f32 v83, v83, v59
  v_cvt_pk_bf16_f32 v84, v76, v80
  v_cvt_pk_bf16_f32 v85, v77, v81
  v_cvt_pk_bf16_f32 v86, v78, v82
  v_cvt_pk_bf16_f32 v87, v79, v83
  v_lshlrev_b32 v76, 16, v84
  v_and_b32 v80, s66, v84
  v_lshlrev_b32 v77, 16, v85
  v_and_b32 v81, s66, v85
  v_lshlrev_b32 v78, 16, v86
  v_and_b32 v82, s66, v86
  v_lshlrev_b32 v79, 16, v87
  v_and_b32 v83, s66, v87
  v_fma_f32 v76, v80, v30, v76
  v_fma_f32 v77, v81, v30, v77
  v_fma_f32 v78, v82, v30, v78
  v_fma_f32 v79, v83, v30, v79
  v_cvt_pk_bf16_f32 v84, v76, v77
  v_cvt_pk_bf16_f32 v85, v78, v79
  v_xor_b32 v86, v31, v84
  v_xor_b32 v87, v31, v85
  v_mov_b32_e64 v22, s43
  ds_write_b16 v28, v84 offset:512
  ds_write_b16_d16_hi v28, v84 offset:516
  ds_write_b16 v28, v85 offset:520
  ds_write_b16_d16_hi v28, v85 offset:524
  ds_write_b16 v29, v86 offset:514
  ds_write_b16_d16_hi v29, v86 offset:518
  ds_write_b16 v29, v87 offset:522
  ds_write_b16_d16_hi v29, v87 offset:526
  ds_write_b32 v14, v22 offset:16
  v_add_u32 v28, 1024, v28
  v_add_u32 v29, 1024, v29
  v_and_b32 v28, 0xfff, v28
  v_and_b32 v29, 0xfff, v29
  s_cmp_eq_u32 s43, 3
  s_cbranch_scc1 L_helper
  s_add_u32 s43, s43, 1
  s_waitcnt vmcnt(4) lgkmcnt(0)
  v_mov_b32 v108, v112
  v_mov_b32 v109, v113
  v_mov_b32 v110, v114
  v_mov_b32 v111, v115
  v_mov_b32 v112, v116
  v_mov_b32 v113, v117
  v_mov_b32_e64 v114, v118
  v_mov_b32 v115, v119
  s_branch L_hr
L_s0:
  v_subrev_u32 v0, 64, v0
  s_sub_u32 s40, s40, 64
  s_and_b32 s44, s2, 7
  s_mul_i32 s44, s44, 6
  s_bfe_u32 s41, s2, 0x10003
  s_add_u32 s44, s44, s41
  s_lshl_b32 s44, s44, 15
  s_lshr_b32 s40, s40, 6
  s_cmp_ge_u32 s40, 2
  s_cselect_b64 s[62:63], -1, 0
  s_and_b32 s45, s62, 16384
  s_sub_u32 s68, s44, s45
  s_add_u32 s44, s44, s45
  v_lshl_add_u32 v16, v0, 4, s68
  v_lshl_add_u32 v15, v0, 4, s44
  v_lshrrev_b32 v25, 4, v0
  v_and_b32 v24, 15, v0
  v_add_u32 v208, 0, v15
  v_add_u32 v209, 8192, v15
  v_add_u32 v210, 4096, v15
  s_sub_u32 s45, s41, 0
  s_mul_i32 s45, s45, 98304
  v_cmp_eq_u32 s[64:65], v25, 0
  v_add_u32_e64 v20, s45, v208
  s_nop 0
  v_cndmask_b32_e64 v208, v208, v20, s[64:65]
  v_lshl_add_u32 v22, s41, 1, v25
  v_subrev_u32 v22, s62, v22
  v_mul_u32_u24 v20, 11, v22
  v_lshrrev_b32_e64 v20, 5, v20
  v_mad_i32_i24 v20, v20, -3, v22
  v_lshlrev_b32_e64 v21, 4, v24
  v_lshl_add_u32 v248, v20, 8, v21
  v_add_u32 v20, 256, v248
  v_subrev_u32 v21, 512, v248
  v_min_u32_e64 v249, v20, v21
  v_add_u32 v20, 512, v248
  v_subrev_u32 v21, 256, v248
  v_min_u32 v250, v20, v21
  v_cmp_gt_u32 vcc, 8, v24
  v_lshlrev_b32 v23, 3, v24
  v_lshrrev_b32 v22, 1, v248
  v_add3_u32 v20, v22, v23, 64
  v_subrev_u32 v21, 384, v20
  v_min_u32 v20, v20, v21
  v_sub_u32 v20, v20, v22
  v_cndmask_b32 v242, v20, v23, vcc
  v_lshrrev_b32 v22, 1, v249
  v_add3_u32 v20, v22, v23, 64
  v_subrev_u32 v21, 384, v20
  v_min_u32 v20, v20, v21
  v_sub_u32 v20, v20, v22
  v_cndmask_b32 v243, v20, v23, vcc
  v_lshrrev_b32 v22, 1, v250
  v_add3_u32 v20, v22, v23, 64
  v_subrev_u32 v21, 384, v20
  v_min_u32_e64 v20, v20, v21
  v_sub_u32 v20, v20, v22
  v_cndmask_b32 v244, v20, v23, vcc
  s_mul_i32 s100, s40, 24576
  s_add_u32 s100, s100, 64000
  s_mul_i32 s44, s42, 1572864
  s_mov_b32 s34, 77070336
  s_mov_b32 s35, 0x20000
  s_mov_b32 s80, 25165824
  s_mov_b32 s3, 50331648
  s_mov_b32 s98, 75497472
  s_waitcnt lgkmcnt(0)
  s_add_u32 s32, s6, s44
  s_addc_u32 s33, s7, 0
  v_mov_b32 v21, s22
  v_mov_b32 v28, s24
  v_cndmask_b32 v28, v28, v21, vcc
  v_mov_b32 v21, s23
  v_mov_b32 v29, s25
  v_cndmask_b32 v29, v29, v21, vcc
  s_add_u32 m0, s100, 0
  v_lshrrev_b32 v10, 1, v208
  v_add_u32 v10, v10, v242
  v_mad_u64_u32 v[30:31], s[64:65], v10, 1, v[28:29]
  global_load_lds_dwordx4 v[30:31], off
  buffer_load_dwordx4 v[64:67], v208, s[32:35], 0 offen nt
  buffer_load_dwordx4 v[68:71], v209, s[32:35], 0 offen nt
  s_add_u32 m0, s100, 1024
  v_lshrrev_b32 v10, 1, v209
  v_add_u32 v10, v10, v244
  v_mad_u64_u32 v[30:31], s[64:65], v10, 1, v[28:29]
  global_load_lds_dwordx4 v[30:31], off
  buffer_load_dwordx4 v[72:75], v208, s[32:35], s80 offen nt
  buffer_load_dwordx4 v[76:79], v209, s[32:35], s80 offen nt
  s_add_u32 m0, s100, 2048
  v_lshrrev_b32 v10, 1, v210
  v_add_u32 v10, v10, v243
  v_mad_u64_u32 v[30:31], s[64:65], v10, 1, v[28:29]
  global_load_lds_dwordx4 v[30:31], off
  buffer_load_dwordx4 v[80:83], v208, s[32:35], s3 offen nt
  s_barrier
  s_getpc_b64 s[82:83]
L_pc1:
  s_lshl_b32 s44, s2, 6
  s_add_u32 s44, s44, L_order-L_pc1
  s_add_u32 s82, s82, s44
  s_addc_u32 s83, s83, 0
  s_load_dwordx2 s[92:93], s[82:83], 0
  s_load_dwordx2 s[96:97], s[82:83], 8
  s_mov_b32 s94, 4000000
  v_add_u32 v211, 12288, v15
  v_add_u32 v212, 16384, v16
  v_add_u32 v213, 24576, v16
  v_add_u32 v214, 20480, v16
  v_add_u32 v215, 28672, v16
  v_add_u32 v216, 65536, v15
  v_add_u32 v217, 73728, v15
  v_add_u32 v218, 69632, v15
  v_add_u32 v219, 77824, v15
  v_add_u32 v220, 81920, v16
  v_add_u32 v221, 90112, v16
  v_add_u32 v222, 86016, v16
  v_add_u32 v223, 94208, v16
  v_add_u32 v224, 131072, v15
  v_add_u32 v225, 139264, v15
  v_add_u32 v226, 135168, v15
  v_add_u32 v227, 143360, v15
  v_add_u32 v228, 147456, v16
  v_add_u32 v229, 155648, v16
  v_add_u32 v230, 151552, v16
  v_add_u32 v231, 159744, v16
  s_sub_u32 s45, s41, 0
  s_mul_i32 s45, s45, 98304
  v_cmp_eq_u32 s[64:65], v25, 15
  v_add_u32 v20, s45, v211
  s_nop 0
  v_cndmask_b32_e64 v211, v211, v20, s[64:65]
  s_sub_u32 s45, s41, 1
  s_mul_i32 s45, s45, 98304
  v_cmp_eq_u32 s[64:65], v25, 0
  v_add_u32_e64 v20, s45, v224
  s_nop 0
  v_cndmask_b32_e64 v224, v224, v20, s[64:65]
  s_sub_u32 s45, s41, 1
  s_mul_i32 s45, s45, 98304
  v_cmp_eq_u32 s[64:65], v25, 15
  v_add_u32_e64 v20, s45, v227
  s_nop 0
  v_cndmask_b32_e64 v227, v227, v20, s[64:65]
  v_cndmask_b32_e64 v251, v248, v249, s[62:63]
  v_cndmask_b32_e64 v252, v249, v250, s[62:63]
  v_cndmask_b32_e64 v253, v250, v248, s[62:63]
  v_cndmask_b32_e64 v245, v242, v243, s[62:63]
  v_cndmask_b32_e64 v246, v243, v244, s[62:63]
  v_cndmask_b32_e64 v247, v244, v242, s[62:63]
  v_lshrrev_b32_e64 v22, 6, v0
  v_bfe_u32 v23, v0, 4, 2
  v_mov_b32 v14, 0
  v_and_b32 v20, 2, v0
  v_lshl_add_u32 v21, v20, 5, v25
  v_and_b32_e64 v20, 1, v0
  v_lshl_add_u32 v21, v20, 4, v21
  v_and_b32_e64 v20, 4, v0
  v_lshl_add_u32 v21, v20, 3, v21
  s_and_b32 s44, s62, 64
  v_xor_b32 v21, s44, v21
  v_cmp_eq_u32 s[48:49], 0, v21
  v_cmp_eq_u32 vcc, 127, v21
  s_cmp_eq_u32 s41, 0
  s_cselect_b32 s44, 0, -1
  v_add_u32 v15, s44, v21
  s_cselect_b32 s44, 2, -2
  v_add_u32 v16, s44, v21
  s_cselect_b32 s44, 1, 0
  v_add_u32_e64 v17, s44, v21
  s_cselect_b64 s[50:51], 0, s[48:49]
  s_cselect_b64 s[52:53], 0, vcc
  s_cselect_b64 s[48:49], s[48:49], 0
  s_cselect_b64 vcc, vcc, 0
  v_mov_b32 v20, 254
  v_cndmask_b32_e64 v15, v15, v20, s[50:51]
  v_mov_b32 v20, 255
  v_cndmask_b32_e64 v15, v15, v20, s[52:53]
  v_mov_b32 v20, -128
  v_cndmask_b32_e64 v17, v17, v20, s[48:49]
  v_mov_b32 v20, -127
  v_cndmask_b32_e64 v17, v17, v20, vcc
  v_and_b32 v20, 8, v0
  v_mul_u32_u24 v20, 48, v20
  v_add_lshl_u32 v15, v15, v20, 2
  v_add_u32 v15, 45568, v15
  v_add_lshl_u32 v16, v16, v20, 2
  v_add_u32 v16, 46080, v16
  v_add_lshl_u32 v17, v17, v20, 2
  v_add_u32 v17, 46592, v17
  v_lshl_add_u32 v21, v24, 2, v23
  v_mul_u32_u24 v20, 192, v22
  v_add_lshl_u32 v3, v20, v21, 2
  v_add_u32 v3, 64000, v3
  v_lshlrev_b32 v6, 2, v22
  v_mov_b32 v236, 0
  v_mov_b32 v239, 0
  v_mov_b32 v237, 0
  v_mov_b32 v240, 0
  v_mov_b32 v238, 0
  v_mov_b32_e64 v241, 0
  s_mov_b32 s48, 0x11111111
  s_mov_b32 s49, s48
  s_mov_b32 s50, 0x22222222
  s_mov_b32 s51, s50
  s_mov_b32 s52, 0x44444444
  s_mov_b32 s53, s52
  s_mov_b32 s54, 0x88888888
  s_mov_b32 s55, s54
  s_mov_b32 s56, 0x05040100
  s_mov_b32 s57, 0x07060302
  s_mov_b32 s38, 1572864
  s_mov_b32 s39, 0x20000
  v_lshlrev_b32 v21, 8, v23
  v_add_u32 v21, s100, v21
  v_lshl_add_u32 v12, v24, 3, v21
  s_getreg_b32 s81, hwreg(HW_REG_HW_ID, 13, 2)
  s_getreg_b32 s79, hwreg(HW_REG_HW_ID, 8, 4)
  s_getreg_b32 s46, hwreg(HW_REG_XCC_ID, 0, 3)
  s_mul_i32 s46, s46, 4352
  s_add_u32 s46, s46, 8126464
  s_add_u32 s44, s46, 2048
  v_mov_b32 v11, s44
  s_and_b32 s45, s81, 2
  s_lshl_b32 s45, s45, 9
  s_lshl_b32 s44, s40, 8
  s_add_u32 s44, s44, s45
  s_add_u32 s44, s44, s46
  s_add_u32 s44, s44, s79
  s_and_b32 s81, s81, 1
  s_lshl_b32 s81, s81, 4
  s_add_u32 s44, s44, s81
  v_mov_b32 v7, s44
  s_xor_b32 s45, s45, 1024
  s_add_u32 s46, s46, s45
  v_and_b32 v8, 1, v0
  v_lshl_add_u32 v8, v8, 4, s46
  v_bfe_u32 v21, v0, 1, 2
  v_mad_u32_u24 v21, v21, 4, v22
  v_add_u32 v9, 0, v21
  v_and_b32 v9, 3, v9
  v_lshl_add_u32 v232, v9, 8, v8
  v_add_u32 v9, 1, v21
  v_and_b32 v9, 3, v9
  v_lshl_add_u32 v233, v9, 8, v8
  v_add_u32 v9, 2, v21
  v_and_b32 v9, 3, v9
  v_lshl_add_u32 v234, v9, 8, v8
  v_add_u32 v9, 3, v21
  v_and_b32 v9, 3, v9
  v_lshl_add_u32 v235, v9, 8, v8
  s_mov_b32 s78, 0xfefefeff
  v_mov_b32 v32, 0
  v_mov_b32 v33, 0
  v_mov_b32 v34, 0
  v_mov_b32 v35, 0
  v_mov_b32 v36, 0
  v_mov_b32 v37, 0
  v_mov_b32 v38, 0
  v_mov_b32 v39, 0
  v_mov_b32 v26, 0
  v_mov_b32 v27, 0
  v_mov_b32_e64 v8, 3
  s_getreg_b32 s58, hwreg(HW_REG_XCC_ID, 0, 1)
  s_mul_i32 s58, s58, -5
  s_add_u32 s58, s58, 3
  s_mov_b32 s91, s58
  s_mov_b32 s69, 8
  s_mov_b32 s95, 0
  buffer_load_dwordx4 v[84:87], v209, s[32:35], s3 offen nt
  s_add_u32 m0, s100, 3072
  v_lshrrev_b32 v10, 1, v211
  v_add_u32 v10, v10, v242
  v_mad_u64_u32 v[30:31], s[64:65], v10, 1, v[28:29]
  s_waitcnt vmcnt(8)
  global_load_lds_dwordx4 v[30:31], off
  s_waitcnt vmcnt(8)
  buffer_load_dwordx4 v[88:91], v210, s[32:35], 0 offen nt
  s_waitcnt vmcnt(8)
  buffer_load_dwordx4 v[92:95], v211, s[32:35], 0 offen nt
  s_mov_b32 s47, 2
  ds_read_b32 v4, v14 offset:16
L_fqz:
  s_waitcnt lgkmcnt(0)
  v_readfirstlane_b32 s46, v4
  s_cmp_ge_u32 s46, s47
  s_cbranch_scc1 L_fqz_ok
  s_cmp_eq_u32 s94, 0
  s_cbranch_scc1 L_fqz_ok
  s_sub_u32 s94, s94, 1
  ds_read_b32 v4, v14 offset:16
  s_branch L_fqz
L_fqz_ok:
  ds_read_b128 v[40:43], v248 offset:512
  ds_read_b128 v[44:47], v250 offset:512
  ds_read_b128 v[48:51], v248 offset:1536
  s_add_u32 m0, s100, 4096
  v_lshrrev_b32 v10, 1, v212
  v_add_u32 v10, v10, v246
  v_mad_u64_u32 v[30:31], s[64:65], v10, 1, v[28:29]
  s_waitcnt vmcnt(8)
  global_load_lds_dwordx4 v[30:31], off
  ds_read_b64 v[112:113], v12 offset:0
  ds_read_b64 v[114:115], v12 offset:128
  ds_read_b64 v[116:117], v12 offset:1024
  ds_read_b64 v[118:119], v12 offset:1152
  s_waitcnt vmcnt(8)
  buffer_load_dwordx4 v[96:99], v210, s[32:35], s80 offen nt
L_it0:
  s_mov_b32 s47, 3
  ds_read_b32 v4, v14 offset:16
L_fq0:
  s_waitcnt lgkmcnt(0)
  v_readfirstlane_b32 s46, v4
  s_cmp_ge_u32 s46, s47
  s_cbranch_scc1 L_fq0_ok
  s_cmp_eq_u32 s94, 0
  s_cbranch_scc1 L_fq0_ok
  s_sub_u32 s94, s94, 1
  ds_read_b32 v4, v14 offset:16
  s_branch L_fq0
L_fq0_ok:
  ds_read_b128 v[52:55], v250 offset:1536
  ds_read_b128 v[56:59], v248 offset:2560
  ds_read_b128 v[60:63], v250 offset:2560
  v_perm_b32 v13, v114, v112, s56
  v_perm_b32 v114, v114, v112, s57
  v_perm_b32 v112, v115, v113, s56
  v_perm_b32 v115, v115, v113, s57
  v_dot2_f32_bf16 v22, v13, v40, 0
  v_dot2_f32_bf16 v23, v114, v41, 0
  v_dot2_f32_bf16 v24, v112, v42, 0
  v_dot2_f32_bf16 v25, v115, v43, 0
  v_cvt_f32_i32 v64, v64
  v_cvt_f32_i32 v65, v65
  v_cvt_f32_i32 v66, v66
  v_cvt_f32_i32_e64 v67, v67
  v_pk_mul_f32 v[20:21], v[64:65], v[22:23]
  v_pk_add_f32 v[18:19], v[22:23], v[24:25]
  v_pk_fma_f32 v[20:21], v[66:67], v[24:25], v[20:21]
  v_add_f32 v18, v18, v19
  v_add_f32 v20, v20, v21
  s_add_u32 m0, s100, 5120
  v_lshrrev_b32 v10, 1, v213
  v_add_u32 v10, v10, v245
  v_mad_u64_u32 v[30:31], s[64:65], v10, 1, v[28:29]
  s_waitcnt vmcnt(8)
  global_load_lds_dwordx4 v[30:31], off
  s_waitcnt vmcnt(8)
  buffer_load_dwordx4 v[100:103], v211, s[32:35], s80 offen nt
  v_perm_b32 v113, v118, v116, s56
  v_perm_b32 v118, v118, v116, s57
  v_perm_b32 v116, v119, v117, s56
  v_perm_b32 v119, v119, v117, s57
  v_dot2_f32_bf16 v22, v113, v44, 0
  v_add_f32_dpp v239, v18, v18 row_ror:8 row_mask:0xf bank_mask:0xc
  v_add_f32_dpp v239, v20, v20 row_ror:8 row_mask:0xf bank_mask:0x3
  v_dot2_f32_bf16 v23, v118, v45, 0
  v_dot2_f32_bf16 v24, v116, v46, 0
  v_dot2_f32_bf16 v25, v119, v47, 0
  v_cvt_f32_i32 v68, v68
  v_cvt_f32_i32 v69, v69
  v_cvt_f32_i32 v70, v70
  v_cvt_f32_i32 v71, v71
  v_pk_mul_f32 v[20:21], v[68:69], v[22:23]
  v_pk_add_f32 v[18:19], v[22:23], v[24:25]
  v_pk_fma_f32 v[20:21], v[70:71], v[24:25], v[20:21]
  v_add_f32_e64 v18, v18, v19
  v_add_f32 v20, v20, v21
  s_waitcnt vmcnt(8)
  buffer_load_dwordx4 v[104:107], v210, s[32:35], s3 offen nt
  v_dot2_f32_bf16 v22, v13, v48, 0
  v_add_f32_dpp v21, v18, v18 row_ror:8 row_mask:0xf bank_mask:0xc
  v_add_f32_dpp v21, v20, v20 row_ror:8 row_mask:0xf bank_mask:0x3
  v_add_f32_dpp v20, v239, v239 row_half_mirror row_mask:0xf bank_mask:0x5
  v_dot2_f32_bf16 v23, v114, v49, 0
  v_add_f32_dpp v20, v21, v21 row_half_mirror row_mask:0xf bank_mask:0xa
  v_dot2_f32_bf16 v24, v112, v50, 0
  v_dot2_f32_bf16 v25, v115, v51, 0
  v_add_f32_dpp v20, v20, v20 quad_perm:[2,3,0,1] row_mask:0xf bank_mask:0xf
  v_cvt_f32_i32 v72, v72
  v_cvt_f32_i32 v73, v73
  v_add_f32_dpp v20, v20, v20 quad_perm:[1,0,3,2] row_mask:0xf bank_mask:0xf
  v_cndmask_b32_e64 v236, v236, v20, s[48:49]
  v_cvt_f32_i32 v74, v74
  v_cvt_f32_i32 v75, v75
  v_pk_mul_f32 v[20:21], v[72:73], v[22:23]
  v_pk_add_f32 v[18:19], v[22:23], v[24:25]
  v_pk_fma_f32 v[20:21], v[74:75], v[24:25], v[20:21]
  v_add_f32_e64 v18, v18, v19
  v_add_f32 v20, v20, v21
  s_waitcnt vmcnt(8)
  buffer_load_dwordx4 v[108:111], v211, s[32:35], s3 offen nt
L_it1:
  s_waitcnt lgkmcnt(0)
  ds_read_b128 v[40:43], v249 offset:512
  ds_read_b128 v[44:47], v248 offset:512
  ds_read_b128 v[48:51], v249 offset:1536
  v_dot2_f32_bf16 v22, v113, v52, 0
  v_add_f32_dpp v240, v18, v18 row_ror:8 row_mask:0xf bank_mask:0xc
  v_add_f32_dpp v240, v20, v20 row_ror:8 row_mask:0xf bank_mask:0x3
  v_dot2_f32_bf16 v23, v118, v53, 0
  v_dot2_f32_bf16 v24, v116, v54, 0
  v_dot2_f32_bf16 v25, v119, v55, 0
  v_cvt_f32_i32 v76, v76
  v_cvt_f32_i32 v77, v77
  v_cvt_f32_i32 v78, v78
  v_cvt_f32_i32_e64 v79, v79
  v_pk_mul_f32 v[20:21], v[76:77], v[22:23]
  v_pk_add_f32 v[18:19], v[22:23], v[24:25]
  v_pk_fma_f32 v[20:21], v[78:79], v[24:25], v[20:21]
  v_add_f32 v18, v18, v19
  v_add_f32 v20, v20, v21
  s_add_u32 m0, s100, 6144
  v_lshrrev_b32 v10, 1, v214
  v_add_u32 v10, v10, v247
  v_mad_u64_u32 v[30:31], s[64:65], v10, 1, v[28:29]
  s_waitcnt vmcnt(8)
  global_load_lds_dwordx4 v[30:31], off
  s_waitcnt vmcnt(8)
  buffer_load_dwordx4 v[64:67], v212, s[32:35], 0 offen nt
  v_dot2_f32_bf16 v22, v13, v56, 0
  v_add_f32_dpp v21, v18, v18 row_ror:8 row_mask:0xf bank_mask:0xc
  v_add_f32_dpp v21, v20, v20 row_ror:8 row_mask:0xf bank_mask:0x3
  v_add_f32_dpp v20, v240, v240 row_half_mirror row_mask:0xf bank_mask:0x5
  v_dot2_f32_bf16 v23, v114, v57, 0
  v_add_f32_dpp v20, v21, v21 row_half_mirror row_mask:0xf bank_mask:0xa
  v_dot2_f32_bf16 v24, v112, v58, 0
  v_dot2_f32_bf16 v25, v115, v59, 0
  v_add_f32_dpp v20, v20, v20 quad_perm:[2,3,0,1] row_mask:0xf bank_mask:0xf
  v_cvt_f32_i32 v80, v80
  v_cvt_f32_i32 v81, v81
  v_add_f32_dpp v20, v20, v20 quad_perm:[1,0,3,2] row_mask:0xf bank_mask:0xf
  v_cndmask_b32_e64 v237, v237, v20, s[48:49]
  v_cvt_f32_i32 v82, v82
  v_cvt_f32_i32 v83, v83
  v_pk_mul_f32 v[20:21], v[80:81], v[22:23]
  v_pk_add_f32 v[18:19], v[22:23], v[24:25]
  v_pk_fma_f32 v[20:21], v[82:83], v[24:25], v[20:21]
  v_add_f32_e64 v18, v18, v19
  v_add_f32 v20, v20, v21
  s_waitcnt vmcnt(8)
  buffer_load_dwordx4 v[68:71], v213, s[32:35], 0 offen nt
  ds_read_b64 v[120:121], v12 offset:2048
  ds_read_b64 v[122:123], v12 offset:2176
  ds_read_b64 v[124:125], v12 offset:3072
  ds_read_b64 v[126:127], v12 offset:3200
  v_dot2_f32_bf16 v22, v113, v60, 0
  v_add_f32_dpp v241, v18, v18 row_ror:8 row_mask:0xf bank_mask:0xc
  v_add_f32_dpp v241, v20, v20 row_ror:8 row_mask:0xf bank_mask:0x3
  v_dot2_f32_bf16 v23, v118, v61, 0
  v_dot2_f32_bf16 v24, v116, v62, 0
  v_dot2_f32_bf16 v25, v119, v63, 0
  v_cvt_f32_i32 v84, v84
  v_cvt_f32_i32 v85, v85
  v_cvt_f32_i32 v86, v86
  v_cvt_f32_i32 v87, v87
  v_pk_mul_f32 v[20:21], v[84:85], v[22:23]
  v_pk_add_f32 v[18:19], v[22:23], v[24:25]
  v_pk_fma_f32 v[20:21], v[86:87], v[24:25], v[20:21]
  v_add_f32_e64 v18, v18, v19
  v_add_f32 v20, v20, v21
  s_waitcnt vmcnt(7)
  buffer_load_dwordx4 v[72:75], v212, s[32:35], s80 offen nt
L_it2:
  s_waitcnt lgkmcnt(0)
  ds_read_b128 v[52:55], v248 offset:1536
  ds_read_b128 v[56:59], v249 offset:2560
  ds_read_b128 v[60:63], v248 offset:2560
  ds_read_b32 v4, v14 offset:24
  v_perm_b32 v117, v122, v120, s56
  v_perm_b32 v122, v122, v120, s57
  v_perm_b32 v120, v123, v121, s56
  v_perm_b32 v123, v123, v121, s57
  v_dot2_f32_bf16 v22, v117, v40, 0
  v_add_f32_dpp v21, v18, v18 row_ror:8 row_mask:0xf bank_mask:0xc
  v_add_f32_dpp v21, v20, v20 row_ror:8 row_mask:0xf bank_mask:0x3
  v_add_f32_dpp v20, v241, v241 row_half_mirror row_mask:0xf bank_mask:0x5
  v_dot2_f32_bf16 v23, v122, v41, 0
  v_add_f32_dpp v20, v21, v21 row_half_mirror row_mask:0xf bank_mask:0xa
  v_dot2_f32_bf16 v24, v120, v42, 0
  v_dot2_f32_bf16 v25, v123, v43, 0
  v_add_f32_dpp v20, v20, v20 quad_perm:[2,3,0,1] row_mask:0xf bank_mask:0xf
  v_cvt_f32_i32 v88, v88
  v_cvt_f32_i32_e64 v89, v89
  v_add_f32_dpp v20, v20, v20 quad_perm:[1,0,3,2] row_mask:0xf bank_mask:0xf
  v_cndmask_b32_e64 v238, v238, v20, s[48:49]
  v_cvt_f32_i32 v90, v90
  v_cvt_f32_i32 v91, v91
  v_pk_mul_f32 v[20:21], v[88:89], v[22:23]
  v_pk_add_f32 v[18:19], v[22:23], v[24:25]
  v_pk_fma_f32 v[20:21], v[90:91], v[24:25], v[20:21]
  v_add_f32 v18, v18, v19
  v_add_f32 v20, v20, v21
  s_add_u32 m0, s100, 7168
  v_lshrrev_b32 v10, 1, v215
  v_add_u32 v10, v10, v246
  v_mad_u64_u32 v[30:31], s[64:65], v10, 1, v[28:29]
  global_load_lds_dwordx4 v[30:31], off
  s_waitcnt vmcnt(7)
  buffer_load_dwordx4 v[76:79], v213, s[32:35], s80 offen nt
  v_perm_b32 v121, v126, v124, s56
  v_perm_b32 v126, v126, v124, s57
  v_perm_b32 v124, v127, v125, s56
  v_perm_b32 v127, v127, v125, s57
  v_dot2_f32_bf16 v22, v121, v44, 0
  v_add_f32_dpp v239, v18, v18 row_ror:8 row_mask:0xf bank_mask:0xc
  v_add_f32_dpp v239, v20, v20 row_ror:8 row_mask:0xf bank_mask:0x3
  v_dot2_f32_bf16 v23, v126, v45, 0
  v_dot2_f32_bf16 v24, v124, v46, 0
  v_dot2_f32_bf16 v25, v127, v47, 0
  v_cvt_f32_i32 v92, v92
  v_cvt_f32_i32 v93, v93
  v_cvt_f32_i32 v94, v94
  v_cvt_f32_i32_e64 v95, v95
  v_pk_mul_f32 v[20:21], v[92:93], v[22:23]
  v_pk_add_f32 v[18:19], v[22:23], v[24:25]
  v_pk_fma_f32 v[20:21], v[94:95], v[24:25], v[20:21]
  v_add_f32_e64 v18, v18, v19
  v_add_f32 v20, v20, v21
  s_waitcnt vmcnt(7)
  buffer_load_dwordx4 v[80:83], v212, s[32:35], s3 offen nt
  v_dot2_f32_bf16 v22, v117, v48, 0
  v_add_f32_dpp v21, v18, v18 row_ror:8 row_mask:0xf bank_mask:0xc
  v_add_f32_dpp v21, v20, v20 row_ror:8 row_mask:0xf bank_mask:0x3
  v_add_f32_dpp v20, v239, v239 row_half_mirror row_mask:0xf bank_mask:0x5
  v_dot2_f32_bf16 v23, v122, v49, 0
  v_add_f32_dpp v20, v21, v21 row_half_mirror row_mask:0xf bank_mask:0xa
  v_dot2_f32_bf16 v24, v120, v50, 0
  v_dot2_f32_bf16 v25, v123, v51, 0
  v_add_f32_dpp v20, v20, v20 quad_perm:[2,3,0,1] row_mask:0xf bank_mask:0xf
  v_cvt_f32_i32 v96, v96
  v_cvt_f32_i32 v97, v97
  v_add_f32_dpp v20, v20, v20 quad_perm:[1,0,3,2] row_mask:0xf bank_mask:0xf
  v_cndmask_b32_e64 v236, v236, v20, s[50:51]
  v_cvt_f32_i32 v98, v98
  v_cvt_f32_i32 v99, v99
  v_pk_mul_f32 v[20:21], v[96:97], v[22:23]
  v_pk_add_f32 v[18:19], v[22:23], v[24:25]
  v_pk_fma_f32 v[20:21], v[98:99], v[24:25], v[20:21]
  v_add_f32_e64 v18, v18, v19
  v_add_f32 v20, v20, v21
  s_waitcnt vmcnt(7)
  buffer_load_dwordx4 v[84:87], v213, s[32:35], s3 offen nt
L_it3:
  s_mov_b32 s47, 1
L_fc:
  s_waitcnt lgkmcnt(0)
  v_readfirstlane_b32 s46, v4
  s_cmp_ge_u32 s46, s47
  s_cbranch_scc1 L_fc_ok
  s_cmp_eq_u32 s94, 0
  s_cbranch_scc1 L_fc_ok
  s_sub_u32 s94, s94, 1
  ds_read_b32 v4, v14 offset:24
  s_branch L_fc
L_fc_ok:
  ds_read_b128 v[40:43], v252 offset:512
  ds_read_b128 v[44:47], v251 offset:512
  ds_read_b128 v[48:51], v252 offset:1536
  s_mov_b64 exec, 3
  s_add_u32 s44, s78, 0x03030303
  v_msad_u8 v9, s78, v36, 0
  v_msad_u8 v10, s44, v36, 0
  v_msad_u8 v9, s78, v37, v9
  v_msad_u8 v10, s44, v37, v10
  v_msad_u8 v9, s78, v38, v9
  v_msad_u8 v10, s44, v38, v10
  global_store_byte v7, v8, s[30:31]
  global_load_dwordx3 v[36:38], v235, s[30:31] sc1
  v_sub_u32 v9, v9, v10
  v_add_u32 v8, 1, v8
  v_readlane_b32 s66, v9, 0
  v_readlane_b32 s67, v9, 1
  s_add_u32 s78, s78, 0x01010101
  s_mov_b64 exec, -1
  s_lshl1_add_u32 s69, s91, s95
  s_add_u32 s95, s66, s67
  s_mov_b32 s69, 8
  v_dot2_f32_bf16 v22, v121, v52, 0
  v_add_f32_dpp v240, v18, v18 row_ror:8 row_mask:0xf bank_mask:0xc
  v_add_f32_dpp v240, v20, v20 row_ror:8 row_mask:0xf bank_mask:0x3
  v_dot2_f32_bf16 v23, v126, v53, 0
  v_dot2_f32_bf16 v24, v124, v54, 0
  v_dot2_f32_bf16 v25, v127, v55, 0
  v_cvt_f32_i32 v100, v100
  v_cvt_f32_i32 v101, v101
  v_cvt_f32_i32 v102, v102
  v_cvt_f32_i32 v103, v103
  v_pk_mul_f32 v[20:21], v[100:101], v[22:23]
  v_pk_add_f32 v[18:19], v[22:23], v[24:25]
  v_pk_fma_f32 v[20:21], v[102:103], v[24:25], v[20:21]
  v_add_f32 v18, v18, v19
  v_add_f32 v20, v20, v21
  s_add_u32 m0, s100, 8192
  v_lshrrev_b32 v10, 1, v216
  v_add_u32 v10, v10, v243
  v_mad_u64_u32 v[30:31], s[64:65], v10, 1, v[28:29]
  global_load_lds_dwordx4 v[30:31], off
  v_dot2_f32_bf16 v22, v117, v56, 0
  v_add_f32_dpp v21, v18, v18 row_ror:8 row_mask:0xf bank_mask:0xc
  v_add_f32_dpp v21, v20, v20 row_ror:8 row_mask:0xf bank_mask:0x3
  v_add_f32_dpp v20, v240, v240 row_half_mirror row_mask:0xf bank_mask:0x5
  v_dot2_f32_bf16 v23, v122, v57, 0
  v_add_f32_dpp v20, v21, v21 row_half_mirror row_mask:0xf bank_mask:0xa
  v_dot2_f32_bf16 v24, v120, v58, 0
  v_dot2_f32_bf16 v25, v123, v59, 0
  v_add_f32_dpp v20, v20, v20 quad_perm:[2,3,0,1] row_mask:0xf bank_mask:0xf
  v_cvt_f32_i32 v104, v104
  v_cvt_f32_i32 v105, v105
  v_add_f32_dpp v20, v20, v20 quad_perm:[1,0,3,2] row_mask:0xf bank_mask:0xf
  v_cndmask_b32_e64 v237, v237, v20, s[50:51]
  v_cvt_f32_i32 v106, v106
  v_cvt_f32_i32 v107, v107
  v_pk_mul_f32 v[20:21], v[104:105], v[22:23]
  v_pk_add_f32 v[18:19], v[22:23], v[24:25]
  v_pk_fma_f32 v[20:21], v[106:107], v[24:25], v[20:21]
  v_add_f32 v18, v18, v19
  v_add_f32 v20, v20, v21
  s_cmpk_gt_i32 s69, 0x13
  s_cbranch_scc1 L_p2_3
  s_cmp_gt_i32 s69, L_order_end-L_order-16421
  s_cbranch_scc1 L_p2_1
  s_waitcnt vmcnt(6)
L_p2_1:
  s_waitcnt vmcnt(8)
L_p2_3:
  s_waitcnt vmcnt(9)
  buffer_load_dwordx4 v[88:91], v214, s[32:35], 0 offen nt
  ds_read_b64 v[128:129], v12 offset:4096
  ds_read_b64 v[130:131], v12 offset:4224
  ds_read_b64 v[132:133], v12 offset:5120
  ds_read_b64 v[134:135], v12 offset:5248
  v_dot2_f32_bf16 v22, v121, v60, 0
  v_add_f32_dpp v241, v18, v18 row_ror:8 row_mask:0xf bank_mask:0xc
  v_add_f32_dpp v241, v20, v20 row_ror:8 row_mask:0xf bank_mask:0x3
  v_dot2_f32_bf16 v23, v126, v61, 0
  v_dot2_f32_bf16 v24, v124, v62, 0
  v_dot2_f32_bf16 v25, v127, v63, 0
  v_cvt_f32_i32 v108, v108
  v_cvt_f32_i32 v109, v109
  v_cvt_f32_i32 v110, v110
  v_cvt_f32_i32 v111, v111
  v_pk_mul_f32 v[20:21], v[108:109], v[22:23]
  v_pk_add_f32 v[18:19], v[22:23], v[24:25]
  v_pk_fma_f32 v[20:21], v[110:111], v[24:25], v[20:21]
  v_add_f32 v18, v18, v19
  v_add_f32 v20, v20, v21
  s_cmpk_gt_i32 s69, 0x13
  s_cbranch_scc1 L_p3_3
  s_cmp_gt_i32 s69, L_order_end-L_order-16391
  s_cbranch_scc1 L_p3_2
  s_waitcnt vmcnt(7)
L_p3_2:
  s_waitcnt vmcnt(9)
L_p3_3:
  s_waitcnt vmcnt(10)
  buffer_load_dwordx4 v[92:95], v215, s[32:35], 0 offen nt
  s_cmpk_gt_i32 s69, 0x13
  s_cbranch_scc1 L_p4_3
  s_cmp_gt_i32 s69, L_order_end-L_order-16445
  s_cbranch_scc1 L_p4_0
  s_waitcnt vmcnt(7)
L_p4_0:
  s_waitcnt vmcnt(8)
L_p4_3:
  s_waitcnt vmcnt(10)
  buffer_load_dwordx4 v[96:99], v214, s[32:35], s80 offen nt
L_it4:
  s_waitcnt lgkmcnt(0)
  ds_read_b128 v[52:55], v251 offset:1536
  ds_read_b128 v[56:59], v252 offset:2560
  ds_read_b128 v[60:63], v251 offset:2560
  s_mov_b64 exec, 3
  s_add_u32 s44, s78, 0x03030303
  v_msad_u8 v9, s78, v32, 0
  v_msad_u8 v10, s44, v32, 0
  v_msad_u8 v9, s78, v33, v9
  v_msad_u8 v10, s44, v33, v10
  v_msad_u8 v9, s78, v34, v9
  v_msad_u8 v10, s44, v34, v10
  global_store_byte v7, v8, s[30:31]
  global_load_dwordx3 v[32:34], v232, s[30:31] sc1
  v_sub_u32 v9, v9, v10
  v_add_u32 v8, 1, v8
  v_readlane_b32 s66, v9, 0
  v_readlane_b32 s67, v9, 1
  s_add_u32 s78, s78, 0x01010101
  s_mov_b64 exec, -1
  s_lshl1_add_u32 s69, s91, s95
  s_add_u32 s95, s66, s67
  s_mov_b32 s69, 8
  v_perm_b32 v125, v130, v128, s56
  v_perm_b32 v130, v130, v128, s57
  v_perm_b32 v128, v131, v129, s56
  v_perm_b32 v131, v131, v129, s57
  v_dot2_f32_bf16 v22, v125, v40, 0
  v_add_f32_dpp v21, v18, v18 row_ror:8 row_mask:0xf bank_mask:0xc
  v_add_f32_dpp v21, v20, v20 row_ror:8 row_mask:0xf bank_mask:0x3
  v_add_f32_dpp v20, v241, v241 row_half_mirror row_mask:0xf bank_mask:0x5
  v_dot2_f32_bf16 v23, v130, v41, 0
  v_add_f32_dpp v20, v21, v21 row_half_mirror row_mask:0xf bank_mask:0xa
  v_dot2_f32_bf16 v24, v128, v42, 0
  v_dot2_f32_bf16 v25, v131, v43, 0
  v_add_f32_dpp v20, v20, v20 quad_perm:[2,3,0,1] row_mask:0xf bank_mask:0xf
  v_cvt_f32_i32 v64, v64
  v_cvt_f32_i32 v65, v65
  v_add_f32_dpp v20, v20, v20 quad_perm:[1,0,3,2] row_mask:0xf bank_mask:0xf
  v_cndmask_b32_e64 v238, v238, v20, s[50:51]
  v_cvt_f32_i32 v66, v66
  v_cvt_f32_i32 v67, v67
  v_pk_mul_f32 v[20:21], v[64:65], v[22:23]
  v_pk_add_f32 v[18:19], v[22:23], v[24:25]
  v_pk_fma_f32 v[20:21], v[66:67], v[24:25], v[20:21]
  v_add_f32 v18, v18, v19
  v_add_f32 v20, v20, v21
  s_add_u32 m0, s100, 9216
  v_lshrrev_b32 v10, 1, v217
  v_add_u32 v10, v10, v242
  v_mad_u64_u32 v[30:31], s[64:65], v10, 1, v[28:29]
  global_load_lds_dwordx4 v[30:31], off
  v_perm_b32 v129, v134, v132, s56
  v_perm_b32 v134, v134, v132, s57
  v_perm_b32 v132, v135, v133, s56
  v_perm_b32 v135, v135, v133, s57
  s_waitcnt vmcnt(12)
  v_dot2_f32_bf16 v22, v129, v44, 0
  v_add_f32_dpp v239, v18, v18 row_ror:8 row_mask:0xf bank_mask:0xc
  v_add_f32_dpp v239, v20, v20 row_ror:8 row_mask:0xf bank_mask:0x3
  v_dot2_f32_bf16 v23, v134, v45, 0
  v_dot2_f32_bf16 v24, v132, v46, 0
  v_dot2_f32_bf16 v25, v135, v47, 0
  v_cvt_f32_i32 v68, v68
  v_cvt_f32_i32 v69, v69
  v_cvt_f32_i32 v70, v70
  v_cvt_f32_i32_e64 v71, v71
  v_pk_mul_f32 v[20:21], v[68:69], v[22:23]
  v_pk_add_f32 v[18:19], v[22:23], v[24:25]
  v_pk_fma_f32 v[20:21], v[70:71], v[24:25], v[20:21]
  v_add_f32 v18, v18, v19
  v_add_f32 v20, v20, v21
  s_cmpk_gt_i32 s69, 0x13
  s_cbranch_scc1 L_p5_3
  s_cmp_gt_i32 s69, L_order_end-L_order-16421
  s_cbranch_scc1 L_p5_1
  s_waitcnt vmcnt(6)
L_p5_1:
  s_waitcnt vmcnt(10)
L_p5_3:
  s_waitcnt vmcnt(11)
  buffer_load_dwordx4 v[100:103], v215, s[32:35], s80 offen nt
  v_dot2_f32_bf16 v22, v125, v48, 0
  v_add_f32_dpp v21, v18, v18 row_ror:8 row_mask:0xf bank_mask:0xc
  v_add_f32_dpp v21, v20, v20 row_ror:8 row_mask:0xf bank_mask:0x3
  v_add_f32_dpp v20, v239, v239 row_half_mirror row_mask:0xf bank_mask:0x5
  v_dot2_f32_bf16 v23, v130, v49, 0
  v_add_f32_dpp v20, v21, v21 row_half_mirror row_mask:0xf bank_mask:0xa
  v_dot2_f32_bf16 v24, v128, v50, 0
  v_dot2_f32_bf16 v25, v131, v51, 0
  v_add_f32_dpp v20, v20, v20 quad_perm:[2,3,0,1] row_mask:0xf bank_mask:0xf
  v_cvt_f32_i32 v72, v72
  v_cvt_f32_i32 v73, v73
  v_add_f32_dpp v20, v20, v20 quad_perm:[1,0,3,2] row_mask:0xf bank_mask:0xf
  v_cndmask_b32_e64 v236, v236, v20, s[52:53]
  v_cvt_f32_i32 v74, v74
  v_cvt_f32_i32 v75, v75
  v_pk_mul_f32 v[20:21], v[72:73], v[22:23]
  v_pk_add_f32 v[18:19], v[22:23], v[24:25]
  v_pk_fma_f32 v[20:21], v[74:75], v[24:25], v[20:21]
  v_add_f32 v18, v18, v19
  v_add_f32 v20, v20, v21
  s_cmpk_gt_i32 s69, 0x13
  s_cbranch_scc1 L_p6_3
  s_cmp_gt_i32 s69, L_order_end-L_order-16391
  s_cbranch_scc1 L_p6_2
  s_waitcnt vmcnt(7)
L_p6_2:
  s_waitcnt vmcnt(11)
L_p6_3:
  s_waitcnt vmcnt(12)
  buffer_load_dwordx4 v[104:107], v214, s[32:35], s3 offen nt
  s_cmpk_gt_i32 s69, 0x13
  s_cbranch_scc1 L_p7_3
  s_cmp_gt_i32 s69, L_order_end-L_order-16445
  s_cbranch_scc1 L_p7_0
  s_waitcnt vmcnt(7)
L_p7_0:
  s_waitcnt vmcnt(8)
L_p7_3:
  s_waitcnt vmcnt(12)
  buffer_load_dwordx4 v[108:111], v215, s[32:35], s3 offen nt
L_it5:
  s_waitcnt lgkmcnt(0)
  ds_read_b128 v[40:43], v253 offset:512
  ds_read_b128 v[44:47], v252 offset:512
  ds_read_b128 v[48:51], v253 offset:1536
  s_waitcnt vmcnt(9)
  s_mov_b64 exec, 3
  s_add_u32 s44, s78, 0x03030303
  v_msad_u8 v9, s78, v36, 0
  v_msad_u8 v10, s44, v36, 0
  v_msad_u8 v9, s78, v37, v9
  v_msad_u8 v10, s44, v37, v10
  v_msad_u8 v9, s78, v38, v9
  v_msad_u8 v10, s44, v38, v10
  global_load_dwordx2 v[26:27], v11, s[30:31] sc1
  global_store_byte v7, v8, s[30:31]
  global_load_dwordx3 v[36:38], v233, s[30:31] sc1
  v_sub_u32 v9, v9, v10
  v_add_u32_e64 v8, 1, v8
  v_readlane_b32 s66, v9, 0
  v_readlane_b32 s67, v9, 1
  s_add_u32 s78, s78, 0x01010101
  s_mov_b64 exec, -1
  s_lshl1_add_u32 s69, s91, s95
  s_add_u32 s95, s66, s67
  s_add_u32 s69, s69, s95
  v_dot2_f32_bf16 v22, v129, v52, 0
  v_add_f32_dpp v240, v18, v18 row_ror:8 row_mask:0xf bank_mask:0xc
  v_add_f32_dpp v240, v20, v20 row_ror:8 row_mask:0xf bank_mask:0x3
  v_dot2_f32_bf16 v23, v134, v53, 0
  v_dot2_f32_bf16 v24, v132, v54, 0
  v_dot2_f32_bf16 v25, v135, v55, 0
  v_cvt_f32_i32 v76, v76
  v_cvt_f32_i32 v77, v77
  v_cvt_f32_i32 v78, v78
  v_cvt_f32_i32 v79, v79
  v_pk_mul_f32 v[20:21], v[76:77], v[22:23]
  v_pk_add_f32 v[18:19], v[22:23], v[24:25]
  v_pk_fma_f32 v[20:21], v[78:79], v[24:25], v[20:21]
  v_add_f32 v18, v18, v19
  v_add_f32 v20, v20, v21
  s_add_u32 m0, s100, 10240
  v_lshrrev_b32 v10, 1, v218
  v_add_u32 v10, v10, v244
  v_mad_u64_u32 v[30:31], s[64:65], v10, 1, v[28:29]
  global_load_lds_dwordx4 v[30:31], off
  v_dot2_f32_bf16 v22, v125, v56, 0
  v_add_f32_dpp v21, v18, v18 row_ror:8 row_mask:0xf bank_mask:0xc
  v_add_f32_dpp v21, v20, v20 row_ror:8 row_mask:0xf bank_mask:0x3
  v_add_f32_dpp v20, v240, v240 row_half_mirror row_mask:0xf bank_mask:0x5
  v_dot2_f32_bf16 v23, v130, v57, 0
  v_add_f32_dpp v20, v21, v21 row_half_mirror row_mask:0xf bank_mask:0xa
  v_dot2_f32_bf16 v24, v128, v58, 0
  v_dot2_f32_bf16 v25, v131, v59, 0
  v_add_f32_dpp v20, v20, v20 quad_perm:[2,3,0,1] row_mask:0xf bank_mask:0xf
  v_cvt_f32_i32 v80, v80
  v_cvt_f32_i32 v81, v81
  v_add_f32_dpp v20, v20, v20 quad_perm:[1,0,3,2] row_mask:0xf bank_mask:0xf
  v_cndmask_b32_e64 v237, v237, v20, s[52:53]
  v_cvt_f32_i32 v82, v82
  v_cvt_f32_i32 v83, v83
  v_pk_mul_f32 v[20:21], v[80:81], v[22:23]
  v_pk_add_f32 v[18:19], v[22:23], v[24:25]
  v_pk_fma_f32 v[20:21], v[82:83], v[24:25], v[20:21]
  v_add_f32 v18, v18, v19
  v_add_f32 v20, v20, v21
  s_cmpk_gt_i32 s69, 0x13
  s_cbranch_scc1 L_p8_3
  s_cmp_gt_i32 s69, L_order_end-L_order-16421
  s_cbranch_scc1 L_p8_1
  s_waitcnt vmcnt(7)
L_p8_1:
  s_waitcnt vmcnt(11)
L_p8_3:
  s_waitcnt vmcnt(12)
  buffer_load_dwordx4 v[64:67], v216, s[32:35], 0 offen nt
  ds_read_b64 v[136:137], v12 offset:6144
  ds_read_b64 v[138:139], v12 offset:6272
  ds_read_b64 v[140:141], v12 offset:7168
  ds_read_b64 v[142:143], v12 offset:7296
  v_dot2_f32_bf16 v22, v129, v60, 0
  v_add_f32_dpp v241, v18, v18 row_ror:8 row_mask:0xf bank_mask:0xc
  v_add_f32_dpp v241, v20, v20 row_ror:8 row_mask:0xf bank_mask:0x3
  v_dot2_f32_bf16 v23, v134, v61, 0
  v_dot2_f32_bf16 v24, v132, v62, 0
  v_dot2_f32_bf16 v25, v135, v63, 0
  v_cvt_f32_i32 v84, v84
  v_cvt_f32_i32 v85, v85
  v_cvt_f32_i32 v86, v86
  v_cvt_f32_i32 v87, v87
  v_pk_mul_f32 v[20:21], v[84:85], v[22:23]
  v_pk_add_f32 v[18:19], v[22:23], v[24:25]
  v_pk_fma_f32 v[20:21], v[86:87], v[24:25], v[20:21]
  v_add_f32 v18, v18, v19
  v_add_f32 v20, v20, v21
  s_cmpk_gt_i32 s69, 0x13
  s_cbranch_scc1 L_p9_3
  s_cmp_gt_i32 s69, L_order_end-L_order-16391
  s_cbranch_scc1 L_p9_2
  s_waitcnt vmcnt(8)
L_p9_2:
  s_waitcnt vmcnt(12)
L_p9_3:
  s_waitcnt vmcnt(13)
  buffer_load_dwordx4 v[68:71], v217, s[32:35], 0 offen nt
  s_cmpk_gt_i32 s69, 0x13
  s_cbranch_scc1 L_p10_3
  s_cmp_gt_i32 s69, L_order_end-L_order-16445
  s_cbranch_scc1 L_p10_0
  s_waitcnt vmcnt(8)
L_p10_0:
  s_waitcnt vmcnt(9)
L_p10_3:
  s_waitcnt vmcnt(13)
  buffer_load_dwordx4 v[72:75], v216, s[32:35], s80 offen nt
L_it6:
  s_waitcnt lgkmcnt(0)
  ds_read_b128 v[52:55], v252 offset:1536
  ds_read_b128 v[56:59], v253 offset:2560
  ds_read_b128 v[60:63], v252 offset:2560
  s_waitcnt vmcnt(10)
  s_mov_b64 exec, 3
  s_add_u32 s44, s78, 0x03030303
  v_msad_u8 v9, s78, v32, 0
  v_msad_u8 v10, s44, v32, 0
  v_msad_u8 v9, s78, v33, v9
  v_msad_u8 v10, s44, v33, v10
  v_msad_u8 v9, s78, v34, v9
  v_msad_u8 v10, s44, v34, v10
  global_store_byte v7, v8, s[30:31]
  global_load_dwordx3 v[32:34], v234, s[30:31] sc1
  v_sub_u32 v9, v9, v10
  v_add_u32_e64 v8, 1, v8
  v_readlane_b32 s66, v9, 0
  v_readlane_b32 s67, v9, 1
  s_add_u32 s78, s78, 0x01010101
  s_mov_b64 exec, -1
  s_lshl1_add_u32 s69, s91, s95
  s_add_u32 s95, s66, s67
  s_add_u32 s69, s69, s95
  v_perm_b32 v133, v138, v136, s56
  v_perm_b32 v138, v138, v136, s57
  v_perm_b32 v136, v139, v137, s56
  v_perm_b32 v139, v139, v137, s57
  v_dot2_f32_bf16 v22, v133, v40, 0
  v_add_f32_dpp v21, v18, v18 row_ror:8 row_mask:0xf bank_mask:0xc
  v_add_f32_dpp v21, v20, v20 row_ror:8 row_mask:0xf bank_mask:0x3
  v_add_f32_dpp v20, v241, v241 row_half_mirror row_mask:0xf bank_mask:0x5
  v_dot2_f32_bf16 v23, v138, v41, 0
  v_add_f32_dpp v20, v21, v21 row_half_mirror row_mask:0xf bank_mask:0xa
  v_dot2_f32_bf16 v24, v136, v42, 0
  v_dot2_f32_bf16 v25, v139, v43, 0
  v_add_f32_dpp v20, v20, v20 quad_perm:[2,3,0,1] row_mask:0xf bank_mask:0xf
  v_cvt_f32_i32 v88, v88
  v_cvt_f32_i32 v89, v89
  v_add_f32_dpp v20, v20, v20 quad_perm:[1,0,3,2] row_mask:0xf bank_mask:0xf
  v_cndmask_b32_e64 v238, v238, v20, s[52:53]
  v_cvt_f32_i32 v90, v90
  v_cvt_f32_i32 v91, v91
  v_pk_mul_f32 v[20:21], v[88:89], v[22:23]
  v_pk_add_f32 v[18:19], v[22:23], v[24:25]
  v_pk_fma_f32 v[20:21], v[90:91], v[24:25], v[20:21]
  v_add_f32 v18, v18, v19
  v_add_f32 v20, v20, v21
  s_add_u32 m0, s100, 11264
  v_lshrrev_b32 v10, 1, v219
  v_add_u32 v10, v10, v243
  v_mad_u64_u32 v[30:31], s[64:65], v10, 1, v[28:29]
  global_load_lds_dwordx4 v[30:31], off
  v_perm_b32 v137, v142, v140, s56
  v_perm_b32 v142, v142, v140, s57
  v_perm_b32 v140, v143, v141, s56
  v_perm_b32 v143, v143, v141, s57
  v_dot2_f32_bf16 v22, v137, v44, 0
  v_add_f32_dpp v239, v18, v18 row_ror:8 row_mask:0xf bank_mask:0xc
  v_add_f32_dpp v239, v20, v20 row_ror:8 row_mask:0xf bank_mask:0x3
  v_dot2_f32_bf16 v23, v142, v45, 0
  v_dot2_f32_bf16 v24, v140, v46, 0
  v_dot2_f32_bf16 v25, v143, v47, 0
  v_cvt_f32_i32 v92, v92
  v_cvt_f32_i32 v93, v93
  v_cvt_f32_i32 v94, v94
  v_cvt_f32_i32 v95, v95
  v_pk_mul_f32 v[20:21], v[92:93], v[22:23]
  v_pk_add_f32 v[18:19], v[22:23], v[24:25]
  v_pk_fma_f32 v[20:21], v[94:95], v[24:25], v[20:21]
  v_add_f32 v18, v18, v19
  v_add_f32 v20, v20, v21
  s_cmpk_gt_i32 s69, 0x13
  s_cbranch_scc1 L_p11_3
  s_cmp_gt_i32 s69, L_order_end-L_order-16421
  s_cbranch_scc1 L_p11_1
  s_waitcnt vmcnt(6)
L_p11_1:
  s_waitcnt vmcnt(11)
L_p11_3:
  s_waitcnt vmcnt(12)
  buffer_load_dwordx4 v[76:79], v217, s[32:35], s80 offen nt
  v_dot2_f32_bf16 v22, v133, v48, 0
  v_add_f32_dpp v21, v18, v18 row_ror:8 row_mask:0xf bank_mask:0xc
  v_add_f32_dpp v21, v20, v20 row_ror:8 row_mask:0xf bank_mask:0x3
  v_add_f32_dpp v20, v239, v239 row_half_mirror row_mask:0xf bank_mask:0x5
  v_dot2_f32_bf16 v23, v138, v49, 0
  v_add_f32_dpp v20, v21, v21 row_half_mirror row_mask:0xf bank_mask:0xa
  v_dot2_f32_bf16 v24, v136, v50, 0
  v_dot2_f32_bf16 v25, v139, v51, 0
  v_add_f32_dpp v20, v20, v20 quad_perm:[2,3,0,1] row_mask:0xf bank_mask:0xf
  v_cvt_f32_i32 v96, v96
  v_cvt_f32_i32 v97, v97
  v_add_f32_dpp v20, v20, v20 quad_perm:[1,0,3,2] row_mask:0xf bank_mask:0xf
  v_cndmask_b32_e64 v236, v236, v20, s[54:55]
  ds_write_b32 v15, v236 offset:0
  v_cvt_f32_i32 v98, v98
  v_cvt_f32_i32 v99, v99
  v_pk_mul_f32 v[20:21], v[96:97], v[22:23]
  v_pk_add_f32 v[18:19], v[22:23], v[24:25]
  v_pk_fma_f32 v[20:21], v[98:99], v[24:25], v[20:21]
  v_add_f32 v18, v18, v19
  v_add_f32 v20, v20, v21
  s_cmpk_gt_i32 s69, 0x13
  s_cbranch_scc1 L_p12_3
  s_cmp_gt_i32 s69, L_order_end-L_order-16391
  s_cbranch_scc1 L_p12_2
  s_waitcnt vmcnt(7)
L_p12_2:
  s_waitcnt vmcnt(12)
L_p12_3:
  s_waitcnt vmcnt(13)
  buffer_load_dwordx4 v[80:83], v216, s[32:35], s3 offen nt
  s_cmpk_gt_i32 s69, 0x13
  s_cbranch_scc1 L_p13_3
  s_cmp_gt_i32 s69, L_order_end-L_order-16445
  s_cbranch_scc1 L_p13_0
  s_waitcnt vmcnt(7)
L_p13_0:
  s_waitcnt vmcnt(8)
L_p13_3:
  s_waitcnt vmcnt(13)
  buffer_load_dwordx4 v[84:87], v217, s[32:35], s3 offen nt
L_it7:
  s_waitcnt lgkmcnt(0)
  ds_read_b128 v[40:43], v249 offset:512
  ds_read_b128 v[44:47], v248 offset:512
  ds_read_b128 v[48:51], v249 offset:1536
  s_waitcnt vmcnt(9)
  s_mov_b64 exec, 3
  s_add_u32 s44, s78, 0x03030303
  v_msad_u8 v9, s78, v36, 0
  v_msad_u8 v10, s44, v36, 0
  v_msad_u8 v9, s78, v37, v9
  v_msad_u8 v10, s44, v37, v10
  v_msad_u8 v9, s78, v38, v9
  v_msad_u8 v10, s44, v38, v10
  global_store_byte v7, v8, s[30:31]
  global_load_dwordx3 v[36:38], v235, s[30:31] sc1
  v_sub_u32 v9, v9, v10
  v_add_u32_e64 v8, 1, v8
  v_add3_u32 v10, v26, v27, s58
  v_readlane_b32 s66, v9, 0
  v_readlane_b32 s67, v9, 1
  v_readlane_b32 s91, v10, 0
  s_add_u32 s78, s78, 0x01010101
  s_mov_b64 exec, -1
  s_lshl1_add_u32 s69, s91, s95
  s_add_u32 s95, s66, s67
  s_add_u32 s69, s69, s95
  v_dot2_f32_bf16 v22, v137, v52, 0
  v_add_f32_dpp v240, v18, v18 row_ror:8 row_mask:0xf bank_mask:0xc
  v_add_f32_dpp v240, v20, v20 row_ror:8 row_mask:0xf bank_mask:0x3
  v_dot2_f32_bf16 v23, v142, v53, 0
  v_dot2_f32_bf16 v24, v140, v54, 0
  v_dot2_f32_bf16 v25, v143, v55, 0
  v_cvt_f32_i32 v100, v100
  v_cvt_f32_i32 v101, v101
  v_cvt_f32_i32 v102, v102
  v_cvt_f32_i32 v103, v103
  v_pk_mul_f32 v[20:21], v[100:101], v[22:23]
  v_pk_add_f32 v[18:19], v[22:23], v[24:25]
  v_pk_fma_f32 v[20:21], v[102:103], v[24:25], v[20:21]
  v_add_f32 v18, v18, v19
  v_add_f32 v20, v20, v21
  s_add_u32 m0, s100, 12288
  v_lshrrev_b32 v10, 1, v220
  v_add_u32 v10, v10, v247
  v_mad_u64_u32 v[30:31], s[64:65], v10, 1, v[28:29]
  global_load_lds_dwordx4 v[30:31], off
  v_dot2_f32_bf16 v22, v133, v56, 0
  v_add_f32_dpp v21, v18, v18 row_ror:8 row_mask:0xf bank_mask:0xc
  v_add_f32_dpp v21, v20, v20 row_ror:8 row_mask:0xf bank_mask:0x3
  v_add_f32_dpp v20, v240, v240 row_half_mirror row_mask:0xf bank_mask:0x5
  v_dot2_f32_bf16 v23, v138, v57, 0
  v_add_f32_dpp v20, v21, v21 row_half_mirror row_mask:0xf bank_mask:0xa
  v_dot2_f32_bf16 v24, v136, v58, 0
  v_dot2_f32_bf16 v25, v139, v59, 0
  v_add_f32_dpp v20, v20, v20 quad_perm:[2,3,0,1] row_mask:0xf bank_mask:0xf
  v_cvt_f32_i32 v104, v104
  v_cvt_f32_i32 v105, v105
  v_add_f32_dpp v20, v20, v20 quad_perm:[1,0,3,2] row_mask:0xf bank_mask:0xf
  v_cndmask_b32_e64 v237, v237, v20, s[54:55]
  ds_write_b32 v15, v237 offset:3072
  v_cvt_f32_i32 v106, v106
  v_cvt_f32_i32 v107, v107
  v_pk_mul_f32 v[20:21], v[104:105], v[22:23]
  v_pk_add_f32 v[18:19], v[22:23], v[24:25]
  v_pk_fma_f32 v[20:21], v[106:107], v[24:25], v[20:21]
  v_add_f32 v18, v18, v19
  v_add_f32 v20, v20, v21
  s_cmpk_gt_i32 s69, 0x13
  s_cbranch_scc1 L_p14_3
  s_cmp_gt_i32 s69, L_order_end-L_order-16421
  s_cbranch_scc1 L_p14_1
  s_waitcnt vmcnt(6)
L_p14_1:
  s_waitcnt vmcnt(10)
L_p14_3:
  s_waitcnt vmcnt(11)
  buffer_load_dwordx4 v[88:91], v218, s[32:35], 0 offen nt
  ds_read_b64 v[144:145], v12 offset:8192
  ds_read_b64 v[146:147], v12 offset:8320
  ds_read_b64 v[148:149], v12 offset:9216
  ds_read_b64 v[150:151], v12 offset:9344
  v_dot2_f32_bf16 v22, v137, v60, 0
  v_add_f32_dpp v241, v18, v18 row_ror:8 row_mask:0xf bank_mask:0xc
  v_add_f32_dpp v241, v20, v20 row_ror:8 row_mask:0xf bank_mask:0x3
  v_dot2_f32_bf16 v23, v142, v61, 0
  v_dot2_f32_bf16 v24, v140, v62, 0
  v_dot2_f32_bf16 v25, v143, v63, 0
  v_cvt_f32_i32 v108, v108
  v_cvt_f32_i32 v109, v109
  v_cvt_f32_i32 v110, v110
  v_cvt_f32_i32 v111, v111
  v_pk_mul_f32 v[20:21], v[108:109], v[22:23]
  v_pk_add_f32 v[18:19], v[22:23], v[24:25]
  v_pk_fma_f32 v[20:21], v[110:111], v[24:25], v[20:21]
  v_add_f32 v18, v18, v19
  v_add_f32 v20, v20, v21
  s_cmpk_gt_i32 s69, 0x13
  s_cbranch_scc1 L_p15_3
  s_cmp_gt_i32 s69, L_order_end-L_order-16391
  s_cbranch_scc1 L_p15_2
  s_waitcnt vmcnt(7)
L_p15_2:
  s_waitcnt vmcnt(11)
L_p15_3:
  s_waitcnt vmcnt(12)
  buffer_load_dwordx4 v[92:95], v219, s[32:35], 0 offen nt
  s_cmpk_gt_i32 s69, 0x13
  s_cbranch_scc1 L_p16_3
  s_cmp_gt_i32 s69, L_order_end-L_order-16445
  s_cbranch_scc1 L_p16_0
  s_waitcnt vmcnt(7)
L_p16_0:
  s_waitcnt vmcnt(8)
L_p16_3:
  s_waitcnt vmcnt(12)
  buffer_load_dwordx4 v[96:99], v218, s[32:35], s80 offen nt
  v_mov_b32_e64 v9, 1
  ds_write_b32 v6, v9 offset:0
L_it8:
  s_waitcnt lgkmcnt(0)
  ds_read_b128 v[52:55], v248 offset:1536
  ds_read_b128 v[56:59], v249 offset:2560
  ds_read_b128 v[60:63], v248 offset:2560
  s_waitcnt vmcnt(9)
  s_mov_b64 exec, 3
  s_add_u32 s44, s78, 0x03030303
  v_msad_u8 v9, s78, v32, 0
  v_msad_u8 v10, s44, v32, 0
  v_msad_u8 v9, s78, v33, v9
  v_msad_u8 v10, s44, v33, v10
  v_msad_u8 v9, s78, v34, v9
  v_msad_u8 v10, s44, v34, v10
  global_store_byte v7, v8, s[30:31]
  global_load_dwordx3 v[32:34], v232, s[30:31] sc1
  v_sub_u32 v9, v9, v10
  v_add_u32_e64 v8, 1, v8
  v_readlane_b32 s66, v9, 0
  v_readlane_b32 s67, v9, 1
  s_add_u32 s78, s78, 0x01010101
  s_mov_b64 exec, -1
  s_lshl1_add_u32 s69, s91, s95
  s_add_u32 s95, s66, s67
  s_add_u32 s69, s69, s95
  v_perm_b32 v141, v146, v144, s56
  v_perm_b32 v146, v146, v144, s57
  v_perm_b32 v144, v147, v145, s56
  v_perm_b32 v147, v147, v145, s57
  v_dot2_f32_bf16 v22, v141, v40, 0
  v_add_f32_dpp v21, v18, v18 row_ror:8 row_mask:0xf bank_mask:0xc
  v_add_f32_dpp v21, v20, v20 row_ror:8 row_mask:0xf bank_mask:0x3
  v_add_f32_dpp v20, v241, v241 row_half_mirror row_mask:0xf bank_mask:0x5
  v_dot2_f32_bf16 v23, v146, v41, 0
  v_add_f32_dpp v20, v21, v21 row_half_mirror row_mask:0xf bank_mask:0xa
  v_dot2_f32_bf16 v24, v144, v42, 0
  v_dot2_f32_bf16 v25, v147, v43, 0
  v_add_f32_dpp v20, v20, v20 quad_perm:[2,3,0,1] row_mask:0xf bank_mask:0xf
  v_cvt_f32_i32 v64, v64
  v_cvt_f32_i32 v65, v65
  v_add_f32_dpp v20, v20, v20 quad_perm:[1,0,3,2] row_mask:0xf bank_mask:0xf
  v_cndmask_b32_e64 v238, v238, v20, s[54:55]
  ds_write_b32 v15, v238 offset:6144
  v_cvt_f32_i32 v66, v66
  v_cvt_f32_i32 v67, v67
  v_pk_mul_f32 v[20:21], v[64:65], v[22:23]
  v_pk_add_f32 v[18:19], v[22:23], v[24:25]
  v_pk_fma_f32 v[20:21], v[66:67], v[24:25], v[20:21]
  v_add_f32 v18, v18, v19
  v_add_f32 v20, v20, v21
  s_add_u32 m0, s100, 13312
  v_lshrrev_b32 v10, 1, v221
  v_add_u32 v10, v10, v246
  v_mad_u64_u32 v[30:31], s[64:65], v10, 1, v[28:29]
  global_load_lds_dwordx4 v[30:31], off
  v_perm_b32 v145, v150, v148, s56
  v_perm_b32 v150, v150, v148, s57
  v_perm_b32 v148, v151, v149, s56
  v_perm_b32 v151, v151, v149, s57
  v_dot2_f32_bf16 v22, v145, v44, 0
  v_add_f32_dpp v239, v18, v18 row_ror:8 row_mask:0xf bank_mask:0xc
  v_add_f32_dpp v239, v20, v20 row_ror:8 row_mask:0xf bank_mask:0x3
  v_dot2_f32_bf16 v23, v150, v45, 0
  v_dot2_f32_bf16 v24, v148, v46, 0
  v_dot2_f32_bf16 v25, v151, v47, 0
  v_cvt_f32_i32 v68, v68
  v_cvt_f32_i32 v69, v69
  v_cvt_f32_i32 v70, v70
  v_cvt_f32_i32 v71, v71
  v_pk_mul_f32 v[20:21], v[68:69], v[22:23]
  v_pk_add_f32 v[18:19], v[22:23], v[24:25]
  v_pk_fma_f32 v[20:21], v[70:71], v[24:25], v[20:21]
  v_add_f32 v18, v18, v19
  v_add_f32 v20, v20, v21
  s_cmpk_gt_i32 s69, 0x13
  s_cbranch_scc1 L_p17_3
  s_cmp_gt_i32 s69, L_order_end-L_order-16421
  s_cbranch_scc1 L_p17_1
  s_waitcnt vmcnt(6)
L_p17_1:
  s_waitcnt vmcnt(10)
L_p17_3:
  s_waitcnt vmcnt(11)
  buffer_load_dwordx4 v[100:103], v219, s[32:35], s80 offen nt
  v_dot2_f32_bf16 v22, v141, v48, 0
  v_add_f32_dpp v21, v18, v18 row_ror:8 row_mask:0xf bank_mask:0xc
  v_add_f32_dpp v21, v20, v20 row_ror:8 row_mask:0xf bank_mask:0x3
  v_add_f32_dpp v20, v239, v239 row_half_mirror row_mask:0xf bank_mask:0x5
  v_dot2_f32_bf16 v23, v146, v49, 0
  v_add_f32_dpp v20, v21, v21 row_half_mirror row_mask:0xf bank_mask:0xa
  v_dot2_f32_bf16 v24, v144, v50, 0
  v_dot2_f32_bf16 v25, v147, v51, 0
  v_add_f32_dpp v20, v20, v20 quad_perm:[2,3,0,1] row_mask:0xf bank_mask:0xf
  v_cvt_f32_i32 v72, v72
  v_cvt_f32_i32 v73, v73
  v_add_f32_dpp v20, v20, v20 quad_perm:[1,0,3,2] row_mask:0xf bank_mask:0xf
  v_cndmask_b32_e64 v236, v236, v20, s[48:49]
  v_cvt_f32_i32 v74, v74
  v_cvt_f32_i32 v75, v75
  v_pk_mul_f32 v[20:21], v[72:73], v[22:23]
  v_pk_add_f32 v[18:19], v[22:23], v[24:25]
  v_pk_fma_f32 v[20:21], v[74:75], v[24:25], v[20:21]
  v_add_f32 v18, v18, v19
  v_add_f32 v20, v20, v21
  s_cmpk_gt_i32 s69, 0x13
  s_cbranch_scc1 L_p18_3
  s_cmp_gt_i32 s69, L_order_end-L_order-16391
  s_cbranch_scc1 L_p18_2
  s_waitcnt vmcnt(7)
L_p18_2:
  s_waitcnt vmcnt(11)
L_p18_3:
  s_waitcnt vmcnt(12)
  buffer_load_dwordx4 v[104:107], v218, s[32:35], s3 offen nt
  s_cmpk_gt_i32 s69, 0x13
  s_cbranch_scc1 L_p19_3
  s_cmp_gt_i32 s69, L_order_end-L_order-16445
  s_cbranch_scc1 L_p19_0
  s_waitcnt vmcnt(7)
L_p19_0:
  s_waitcnt vmcnt(8)
L_p19_3:
  s_waitcnt vmcnt(12)
  buffer_load_dwordx4 v[108:111], v219, s[32:35], s3 offen nt
L_it9:
  s_waitcnt lgkmcnt(0)
  ds_read_b128 v[40:43], v250 offset:512
  ds_read_b128 v[44:47], v249 offset:512
  ds_read_b128 v[48:51], v250 offset:1536
  s_waitcnt vmcnt(9)
  s_mov_b64 exec, 3
  s_add_u32 s44, s78, 0x03030303
  v_msad_u8 v9, s78, v36, 0
  v_msad_u8 v10, s44, v36, 0
  v_msad_u8 v9, s78, v37, v9
  v_msad_u8 v10, s44, v37, v10
  v_msad_u8 v9, s78, v38, v9
  v_msad_u8 v10, s44, v38, v10
  global_store_byte v7, v8, s[30:31]
  global_load_dwordx3 v[36:38], v233, s[30:31] sc1
  v_sub_u32 v9, v9, v10
  v_add_u32_e64 v8, 1, v8
  v_readlane_b32 s66, v9, 0
  v_readlane_b32 s67, v9, 1
  s_add_u32 s78, s78, 0x01010101
  s_mov_b64 exec, -1
  s_lshl1_add_u32 s69, s91, s95
  s_add_u32 s95, s66, s67
  s_add_u32 s69, s69, s95
  v_dot2_f32_bf16 v22, v145, v52, 0
  v_add_f32_dpp v240, v18, v18 row_ror:8 row_mask:0xf bank_mask:0xc
  v_add_f32_dpp v240, v20, v20 row_ror:8 row_mask:0xf bank_mask:0x3
  v_dot2_f32_bf16 v23, v150, v53, 0
  v_dot2_f32_bf16 v24, v148, v54, 0
  v_dot2_f32_bf16 v25, v151, v55, 0
  v_cvt_f32_i32 v76, v76
  v_cvt_f32_i32 v77, v77
  v_cvt_f32_i32 v78, v78
  v_cvt_f32_i32 v79, v79
  v_pk_mul_f32 v[20:21], v[76:77], v[22:23]
  v_pk_add_f32 v[18:19], v[22:23], v[24:25]
  v_pk_fma_f32 v[20:21], v[78:79], v[24:25], v[20:21]
  v_add_f32 v18, v18, v19
  v_add_f32 v20, v20, v21
  s_add_u32 m0, s100, 14336
  v_lshrrev_b32 v10, 1, v222
  v_add_u32 v10, v10, v245
  v_mad_u64_u32 v[30:31], s[64:65], v10, 1, v[28:29]
  global_load_lds_dwordx4 v[30:31], off
  v_dot2_f32_bf16 v22, v141, v56, 0
  v_add_f32_dpp v21, v18, v18 row_ror:8 row_mask:0xf bank_mask:0xc
  v_add_f32_dpp v21, v20, v20 row_ror:8 row_mask:0xf bank_mask:0x3
  v_add_f32_dpp v20, v240, v240 row_half_mirror row_mask:0xf bank_mask:0x5
  v_dot2_f32_bf16 v23, v146, v57, 0
  v_add_f32_dpp v20, v21, v21 row_half_mirror row_mask:0xf bank_mask:0xa
  v_dot2_f32_bf16 v24, v144, v58, 0
  v_dot2_f32_bf16 v25, v147, v59, 0
  v_add_f32_dpp v20, v20, v20 quad_perm:[2,3,0,1] row_mask:0xf bank_mask:0xf
  v_cvt_f32_i32 v80, v80
  v_cvt_f32_i32 v81, v81
  v_add_f32_dpp v20, v20, v20 quad_perm:[1,0,3,2] row_mask:0xf bank_mask:0xf
  v_cndmask_b32_e64 v237, v237, v20, s[48:49]
  v_cvt_f32_i32 v82, v82
  v_cvt_f32_i32 v83, v83
  v_pk_mul_f32 v[20:21], v[80:81], v[22:23]
  v_pk_add_f32 v[18:19], v[22:23], v[24:25]
  v_pk_fma_f32 v[20:21], v[82:83], v[24:25], v[20:21]
  v_add_f32 v18, v18, v19
  v_add_f32 v20, v20, v21
  s_cmpk_gt_i32 s69, 0x13
  s_cbranch_scc1 L_p20_3
  s_cmp_gt_i32 s69, L_order_end-L_order-16421
  s_cbranch_scc1 L_p20_1
  s_waitcnt vmcnt(6)
L_p20_1:
  s_waitcnt vmcnt(10)
L_p20_3:
  s_waitcnt vmcnt(11)
  buffer_load_dwordx4 v[64:67], v220, s[32:35], 0 offen nt
  ds_read_b64 v[152:153], v12 offset:10240
  ds_read_b64 v[154:155], v12 offset:10368
  ds_read_b64 v[156:157], v12 offset:11264
  ds_read_b64 v[158:159], v12 offset:11392
  v_dot2_f32_bf16 v22, v145, v60, 0
  v_add_f32_dpp v241, v18, v18 row_ror:8 row_mask:0xf bank_mask:0xc
  v_add_f32_dpp v241, v20, v20 row_ror:8 row_mask:0xf bank_mask:0x3
  v_dot2_f32_bf16 v23, v150, v61, 0
  v_dot2_f32_bf16 v24, v148, v62, 0
  v_dot2_f32_bf16 v25, v151, v63, 0
  v_cvt_f32_i32 v84, v84
  v_cvt_f32_i32 v85, v85
  v_cvt_f32_i32 v86, v86
  v_cvt_f32_i32 v87, v87
  v_pk_mul_f32 v[20:21], v[84:85], v[22:23]
  v_pk_add_f32 v[18:19], v[22:23], v[24:25]
  v_pk_fma_f32 v[20:21], v[86:87], v[24:25], v[20:21]
  v_add_f32 v18, v18, v19
  v_add_f32 v20, v20, v21
  s_cmpk_gt_i32 s69, 0x13
  s_cbranch_scc1 L_p21_3
  s_cmp_gt_i32 s69, L_order_end-L_order-16391
  s_cbranch_scc1 L_p21_2
  s_waitcnt vmcnt(7)
L_p21_2:
  s_waitcnt vmcnt(11)
L_p21_3:
  s_waitcnt vmcnt(12)
  buffer_load_dwordx4 v[68:71], v221, s[32:35], 0 offen nt
  s_cmpk_gt_i32 s69, 0x13
  s_cbranch_scc1 L_p22_3
  s_cmp_gt_i32 s69, L_order_end-L_order-16445
  s_cbranch_scc1 L_p22_0
  s_waitcnt vmcnt(7)
L_p22_0:
  s_waitcnt vmcnt(8)
L_p22_3:
  s_waitcnt vmcnt(12)
  buffer_load_dwordx4 v[72:75], v220, s[32:35], s80 offen nt
L_it10:
  s_waitcnt lgkmcnt(0)
  ds_read_b128 v[52:55], v249 offset:1536
  ds_read_b128 v[56:59], v250 offset:2560
  ds_read_b128 v[60:63], v249 offset:2560
  s_waitcnt vmcnt(9)
  s_mov_b64 exec, 3
  s_add_u32 s44, s78, 0x03030303
  v_msad_u8 v9, s78, v32, 0
  v_msad_u8 v10, s44, v32, 0
  v_msad_u8 v9, s78, v33, v9
  v_msad_u8 v10, s44, v33, v10
  v_msad_u8 v9, s78, v34, v9
  v_msad_u8 v10, s44, v34, v10
  global_store_byte v7, v8, s[30:31]
  global_load_dwordx3 v[32:34], v234, s[30:31] sc1
  v_sub_u32 v9, v9, v10
  v_add_u32_e64 v8, 1, v8
  v_readlane_b32 s66, v9, 0
  v_readlane_b32 s67, v9, 1
  s_add_u32 s78, s78, 0x01010101
  s_mov_b64 exec, -1
  s_lshl1_add_u32 s69, s91, s95
  s_add_u32 s95, s66, s67
  s_add_u32 s69, s69, s95
  v_perm_b32 v149, v154, v152, s56
  v_perm_b32 v154, v154, v152, s57
  v_perm_b32 v152, v155, v153, s56
  v_perm_b32 v155, v155, v153, s57
  v_dot2_f32_bf16 v22, v149, v40, 0
  v_add_f32_dpp v21, v18, v18 row_ror:8 row_mask:0xf bank_mask:0xc
  v_add_f32_dpp v21, v20, v20 row_ror:8 row_mask:0xf bank_mask:0x3
  v_add_f32_dpp v20, v241, v241 row_half_mirror row_mask:0xf bank_mask:0x5
  v_dot2_f32_bf16 v23, v154, v41, 0
  v_add_f32_dpp v20, v21, v21 row_half_mirror row_mask:0xf bank_mask:0xa
  v_dot2_f32_bf16 v24, v152, v42, 0
  v_dot2_f32_bf16 v25, v155, v43, 0
  v_add_f32_dpp v20, v20, v20 quad_perm:[2,3,0,1] row_mask:0xf bank_mask:0xf
  v_cvt_f32_i32 v88, v88
  v_cvt_f32_i32 v89, v89
  v_add_f32_dpp v20, v20, v20 quad_perm:[1,0,3,2] row_mask:0xf bank_mask:0xf
  v_cndmask_b32_e64 v238, v238, v20, s[48:49]
  v_cvt_f32_i32 v90, v90
  v_cvt_f32_i32 v91, v91
  v_pk_mul_f32 v[20:21], v[88:89], v[22:23]
  v_pk_add_f32 v[18:19], v[22:23], v[24:25]
  v_pk_fma_f32 v[20:21], v[90:91], v[24:25], v[20:21]
  v_add_f32 v18, v18, v19
  v_add_f32 v20, v20, v21
  s_add_u32 m0, s100, 15360
  v_lshrrev_b32 v10, 1, v223
  v_add_u32 v10, v10, v247
  v_mad_u64_u32 v[30:31], s[64:65], v10, 1, v[28:29]
  global_load_lds_dwordx4 v[30:31], off
  v_perm_b32 v153, v158, v156, s56
  v_perm_b32 v158, v158, v156, s57
  v_perm_b32 v156, v159, v157, s56
  v_perm_b32 v159, v159, v157, s57
  v_dot2_f32_bf16 v22, v153, v44, 0
  v_add_f32_dpp v239, v18, v18 row_ror:8 row_mask:0xf bank_mask:0xc
  v_add_f32_dpp v239, v20, v20 row_ror:8 row_mask:0xf bank_mask:0x3
  v_dot2_f32_bf16 v23, v158, v45, 0
  v_dot2_f32_bf16 v24, v156, v46, 0
  v_dot2_f32_bf16 v25, v159, v47, 0
  v_cvt_f32_i32 v92, v92
  v_cvt_f32_i32 v93, v93
  v_cvt_f32_i32 v94, v94
  v_cvt_f32_i32 v95, v95
  v_pk_mul_f32 v[20:21], v[92:93], v[22:23]
  v_pk_add_f32 v[18:19], v[22:23], v[24:25]
  v_pk_fma_f32 v[20:21], v[94:95], v[24:25], v[20:21]
  v_add_f32 v18, v18, v19
  v_add_f32 v20, v20, v21
  s_cmpk_gt_i32 s69, 0x13
  s_cbranch_scc1 L_p23_3
  s_cmp_gt_i32 s69, L_order_end-L_order-16421
  s_cbranch_scc1 L_p23_1
  s_waitcnt vmcnt(6)
L_p23_1:
  s_waitcnt vmcnt(10)
L_p23_3:
  s_waitcnt vmcnt(11)
  buffer_load_dwordx4 v[76:79], v221, s[32:35], s80 offen nt
  v_dot2_f32_bf16 v22, v149, v48, 0
  v_add_f32_dpp v21, v18, v18 row_ror:8 row_mask:0xf bank_mask:0xc
  v_add_f32_dpp v21, v20, v20 row_ror:8 row_mask:0xf bank_mask:0x3
  v_add_f32_dpp v20, v239, v239 row_half_mirror row_mask:0xf bank_mask:0x5
  v_dot2_f32_bf16 v23, v154, v49, 0
  v_add_f32_dpp v20, v21, v21 row_half_mirror row_mask:0xf bank_mask:0xa
  v_dot2_f32_bf16 v24, v152, v50, 0
  v_dot2_f32_bf16 v25, v155, v51, 0
  v_add_f32_dpp v20, v20, v20 quad_perm:[2,3,0,1] row_mask:0xf bank_mask:0xf
  v_cvt_f32_i32 v96, v96
  v_cvt_f32_i32 v97, v97
  v_add_f32_dpp v20, v20, v20 quad_perm:[1,0,3,2] row_mask:0xf bank_mask:0xf
  v_cndmask_b32_e64 v236, v236, v20, s[50:51]
  v_cvt_f32_i32 v98, v98
  v_cvt_f32_i32 v99, v99
  v_pk_mul_f32 v[20:21], v[96:97], v[22:23]
  v_pk_add_f32 v[18:19], v[22:23], v[24:25]
  v_pk_fma_f32 v[20:21], v[98:99], v[24:25], v[20:21]
  v_add_f32 v18, v18, v19
  v_add_f32 v20, v20, v21
  s_cmpk_gt_i32 s69, 0x13
  s_cbranch_scc1 L_p24_3
  s_cmp_gt_i32 s69, L_order_end-L_order-16391
  s_cbranch_scc1 L_p24_2
  s_waitcnt vmcnt(7)
L_p24_2:
  s_waitcnt vmcnt(11)
L_p24_3:
  s_waitcnt vmcnt(12)
  buffer_load_dwordx4 v[80:83], v220, s[32:35], s3 offen nt
  s_cmpk_gt_i32 s69, 0x13
  s_cbranch_scc1 L_p25_3
  s_cmp_gt_i32 s69, L_order_end-L_order-16445
  s_cbranch_scc1 L_p25_0
  s_waitcnt vmcnt(7)
L_p25_0:
  s_waitcnt vmcnt(8)
L_p25_3:
  s_waitcnt vmcnt(12)
  buffer_load_dwordx4 v[84:87], v221, s[32:35], s3 offen nt
L_it11:
  s_waitcnt lgkmcnt(0)
  ds_read_b128 v[40:43], v253 offset:512
  ds_read_b128 v[44:47], v252 offset:512
  ds_read_b128 v[48:51], v253 offset:1536
  s_waitcnt vmcnt(9)
  s_mov_b64 exec, 3
  s_add_u32 s44, s78, 0x03030303
  v_msad_u8 v9, s78, v36, 0
  v_msad_u8 v10, s44, v36, 0
  v_msad_u8 v9, s78, v37, v9
  v_msad_u8 v10, s44, v37, v10
  v_msad_u8 v9, s78, v38, v9
  v_msad_u8 v10, s44, v38, v10
  global_store_byte v7, v8, s[30:31]
  global_load_dwordx3 v[36:38], v235, s[30:31] sc1
  v_sub_u32 v9, v9, v10
  v_add_u32_e64 v8, 1, v8
  v_readlane_b32 s66, v9, 0
  v_readlane_b32 s67, v9, 1
  s_add_u32 s78, s78, 0x01010101
  s_mov_b64 exec, -1
  s_lshl1_add_u32 s69, s91, s95
  s_add_u32 s95, s66, s67
  s_add_u32 s69, s69, s95
  v_dot2_f32_bf16 v22, v153, v52, 0
  v_add_f32_dpp v240, v18, v18 row_ror:8 row_mask:0xf bank_mask:0xc
  v_add_f32_dpp v240, v20, v20 row_ror:8 row_mask:0xf bank_mask:0x3
  v_dot2_f32_bf16 v23, v158, v53, 0
  v_dot2_f32_bf16 v24, v156, v54, 0
  v_dot2_f32_bf16 v25, v159, v55, 0
  v_cvt_f32_i32 v100, v100
  v_cvt_f32_i32 v101, v101
  v_cvt_f32_i32 v102, v102
  v_cvt_f32_i32 v103, v103
  v_pk_mul_f32 v[20:21], v[100:101], v[22:23]
  v_pk_add_f32 v[18:19], v[22:23], v[24:25]
  v_pk_fma_f32 v[20:21], v[102:103], v[24:25], v[20:21]
  v_add_f32 v18, v18, v19
  v_add_f32 v20, v20, v21
  s_add_u32 m0, s100, 16384
  v_lshrrev_b32 v10, 1, v224
  v_add_u32 v10, v10, v244
  v_mad_u64_u32 v[30:31], s[64:65], v10, 1, v[28:29]
  global_load_lds_dwordx4 v[30:31], off
  v_dot2_f32_bf16 v22, v149, v56, 0
  v_add_f32_dpp v21, v18, v18 row_ror:8 row_mask:0xf bank_mask:0xc
  v_add_f32_dpp v21, v20, v20 row_ror:8 row_mask:0xf bank_mask:0x3
  v_add_f32_dpp v20, v240, v240 row_half_mirror row_mask:0xf bank_mask:0x5
  v_dot2_f32_bf16 v23, v154, v57, 0
  v_add_f32_dpp v20, v21, v21 row_half_mirror row_mask:0xf bank_mask:0xa
  v_dot2_f32_bf16 v24, v152, v58, 0
  v_dot2_f32_bf16 v25, v155, v59, 0
  v_add_f32_dpp v20, v20, v20 quad_perm:[2,3,0,1] row_mask:0xf bank_mask:0xf
  v_cvt_f32_i32 v104, v104
  v_cvt_f32_i32 v105, v105
  v_add_f32_dpp v20, v20, v20 quad_perm:[1,0,3,2] row_mask:0xf bank_mask:0xf
  v_cndmask_b32_e64 v237, v237, v20, s[50:51]
  v_cvt_f32_i32 v106, v106
  v_cvt_f32_i32 v107, v107
  v_pk_mul_f32 v[20:21], v[104:105], v[22:23]
  v_pk_add_f32 v[18:19], v[22:23], v[24:25]
  v_pk_fma_f32 v[20:21], v[106:107], v[24:25], v[20:21]
  v_add_f32 v18, v18, v19
  v_add_f32 v20, v20, v21
  s_cmpk_gt_i32 s69, 0x13
  s_cbranch_scc1 L_p26_3
  s_cmp_gt_i32 s69, L_order_end-L_order-16421
  s_cbranch_scc1 L_p26_1
  s_waitcnt vmcnt(6)
L_p26_1:
  s_waitcnt vmcnt(10)
L_p26_3:
  s_waitcnt vmcnt(11)
  buffer_load_dwordx4 v[88:91], v222, s[32:35], 0 offen nt
  ds_read_b64 v[160:161], v12 offset:12288
  ds_read_b64 v[162:163], v12 offset:12416
  ds_read_b64 v[164:165], v12 offset:13312
  ds_read_b64 v[166:167], v12 offset:13440
  v_dot2_f32_bf16 v22, v153, v60, 0
  v_add_f32_dpp v241, v18, v18 row_ror:8 row_mask:0xf bank_mask:0xc
  v_add_f32_dpp v241, v20, v20 row_ror:8 row_mask:0xf bank_mask:0x3
  v_dot2_f32_bf16 v23, v158, v61, 0
  v_dot2_f32_bf16 v24, v156, v62, 0
  v_dot2_f32_bf16 v25, v159, v63, 0
  v_cvt_f32_i32 v108, v108
  v_cvt_f32_i32 v109, v109
  v_cvt_f32_i32 v110, v110
  v_cvt_f32_i32 v111, v111
  v_pk_mul_f32 v[20:21], v[108:109], v[22:23]
  v_pk_add_f32 v[18:19], v[22:23], v[24:25]
  v_pk_fma_f32 v[20:21], v[110:111], v[24:25], v[20:21]
  v_add_f32 v18, v18, v19
  v_add_f32 v20, v20, v21
  s_cmpk_gt_i32 s69, 0x13
  s_cbranch_scc1 L_p27_3
  s_cmp_gt_i32 s69, L_order_end-L_order-16391
  s_cbranch_scc1 L_p27_2
  s_waitcnt vmcnt(7)
L_p27_2:
  s_waitcnt vmcnt(11)
L_p27_3:
  s_waitcnt vmcnt(12)
  buffer_load_dwordx4 v[92:95], v223, s[32:35], 0 offen nt
  s_cmpk_gt_i32 s69, 0x13
  s_cbranch_scc1 L_p28_3
  s_cmp_gt_i32 s69, L_order_end-L_order-16445
  s_cbranch_scc1 L_p28_0
  s_waitcnt vmcnt(7)
L_p28_0:
  s_waitcnt vmcnt(8)
L_p28_3:
  s_waitcnt vmcnt(12)
  buffer_load_dwordx4 v[96:99], v222, s[32:35], s80 offen nt
L_it12:
  s_waitcnt lgkmcnt(0)
  ds_read_b128 v[52:55], v252 offset:1536
  ds_read_b128 v[56:59], v253 offset:2560
  ds_read_b128 v[60:63], v252 offset:2560
  s_waitcnt vmcnt(9)
  s_mov_b64 exec, 3
  s_add_u32 s44, s78, 0x03030303
  v_msad_u8 v9, s78, v32, 0
  v_msad_u8 v10, s44, v32, 0
  v_msad_u8 v9, s78, v33, v9
  v_msad_u8 v10, s44, v33, v10
  v_msad_u8 v9, s78, v34, v9
  v_msad_u8 v10, s44, v34, v10
  global_store_byte v7, v8, s[30:31]
  global_load_dwordx3 v[32:34], v232, s[30:31] sc1
  v_sub_u32 v9, v9, v10
  v_add_u32_e64 v8, 1, v8
  v_readlane_b32 s66, v9, 0
  v_readlane_b32 s67, v9, 1
  s_add_u32 s78, s78, 0x01010101
  s_mov_b64 exec, -1
  s_lshl1_add_u32 s69, s91, s95
  s_add_u32 s95, s66, s67
  s_add_u32 s69, s69, s95
  v_perm_b32 v157, v162, v160, s56
  v_perm_b32 v162, v162, v160, s57
  v_perm_b32 v160, v163, v161, s56
  v_perm_b32 v163, v163, v161, s57
  v_dot2_f32_bf16 v22, v157, v40, 0
  v_add_f32_dpp v21, v18, v18 row_ror:8 row_mask:0xf bank_mask:0xc
  v_add_f32_dpp v21, v20, v20 row_ror:8 row_mask:0xf bank_mask:0x3
  v_add_f32_dpp v20, v241, v241 row_half_mirror row_mask:0xf bank_mask:0x5
  v_dot2_f32_bf16 v23, v162, v41, 0
  v_add_f32_dpp v20, v21, v21 row_half_mirror row_mask:0xf bank_mask:0xa
  v_dot2_f32_bf16 v24, v160, v42, 0
  v_dot2_f32_bf16 v25, v163, v43, 0
  v_add_f32_dpp v20, v20, v20 quad_perm:[2,3,0,1] row_mask:0xf bank_mask:0xf
  v_cvt_f32_i32 v64, v64
  v_cvt_f32_i32 v65, v65
  v_add_f32_dpp v20, v20, v20 quad_perm:[1,0,3,2] row_mask:0xf bank_mask:0xf
  v_cndmask_b32_e64 v238, v238, v20, s[50:51]
  v_cvt_f32_i32 v66, v66
  v_cvt_f32_i32 v67, v67
  v_pk_mul_f32 v[20:21], v[64:65], v[22:23]
  v_pk_add_f32 v[18:19], v[22:23], v[24:25]
  v_pk_fma_f32 v[20:21], v[66:67], v[24:25], v[20:21]
  v_add_f32 v18, v18, v19
  v_add_f32 v20, v20, v21
  s_add_u32 m0, s100, 17408
  v_lshrrev_b32 v10, 1, v225
  v_add_u32 v10, v10, v243
  v_mad_u64_u32 v[30:31], s[64:65], v10, 1, v[28:29]
  global_load_lds_dwordx4 v[30:31], off
  v_perm_b32 v161, v166, v164, s56
  v_perm_b32 v166, v166, v164, s57
  v_perm_b32 v164, v167, v165, s56
  v_perm_b32 v167, v167, v165, s57
  v_dot2_f32_bf16 v22, v161, v44, 0
  v_add_f32_dpp v239, v18, v18 row_ror:8 row_mask:0xf bank_mask:0xc
  v_add_f32_dpp v239, v20, v20 row_ror:8 row_mask:0xf bank_mask:0x3
  v_dot2_f32_bf16 v23, v166, v45, 0
  v_dot2_f32_bf16 v24, v164, v46, 0
  v_dot2_f32_bf16 v25, v167, v47, 0
  v_cvt_f32_i32 v68, v68
  v_cvt_f32_i32 v69, v69
  v_cvt_f32_i32 v70, v70
  v_cvt_f32_i32 v71, v71
  v_pk_mul_f32 v[20:21], v[68:69], v[22:23]
  v_pk_add_f32 v[18:19], v[22:23], v[24:25]
  v_pk_fma_f32 v[20:21], v[70:71], v[24:25], v[20:21]
  v_add_f32 v18, v18, v19
  v_add_f32 v20, v20, v21
  s_cmpk_gt_i32 s69, 0x13
  s_cbranch_scc1 L_p29_3
  s_cmp_gt_i32 s69, L_order_end-L_order-16421
  s_cbranch_scc1 L_p29_1
  s_waitcnt vmcnt(6)
L_p29_1:
  s_waitcnt vmcnt(10)
L_p29_3:
  s_waitcnt vmcnt(11)
  buffer_load_dwordx4 v[100:103], v223, s[32:35], s80 offen nt
  v_dot2_f32_bf16 v22, v157, v48, 0
  v_add_f32_dpp v21, v18, v18 row_ror:8 row_mask:0xf bank_mask:0xc
  v_add_f32_dpp v21, v20, v20 row_ror:8 row_mask:0xf bank_mask:0x3
  v_add_f32_dpp v20, v239, v239 row_half_mirror row_mask:0xf bank_mask:0x5
  v_dot2_f32_bf16 v23, v162, v49, 0
  v_add_f32_dpp v20, v21, v21 row_half_mirror row_mask:0xf bank_mask:0xa
  v_dot2_f32_bf16 v24, v160, v50, 0
  v_dot2_f32_bf16 v25, v163, v51, 0
  v_add_f32_dpp v20, v20, v20 quad_perm:[2,3,0,1] row_mask:0xf bank_mask:0xf
  v_cvt_f32_i32 v72, v72
  v_cvt_f32_i32 v73, v73
  v_add_f32_dpp v20, v20, v20 quad_perm:[1,0,3,2] row_mask:0xf bank_mask:0xf
  v_cndmask_b32_e64 v236, v236, v20, s[52:53]
  v_cvt_f32_i32 v74, v74
  v_cvt_f32_i32 v75, v75
  v_pk_mul_f32 v[20:21], v[72:73], v[22:23]
  v_pk_add_f32 v[18:19], v[22:23], v[24:25]
  v_pk_fma_f32 v[20:21], v[74:75], v[24:25], v[20:21]
  v_add_f32 v18, v18, v19
  v_add_f32 v20, v20, v21
  s_cmpk_gt_i32 s69, 0x13
  s_cbranch_scc1 L_p30_3
  s_cmp_gt_i32 s69, L_order_end-L_order-16391
  s_cbranch_scc1 L_p30_2
  s_waitcnt vmcnt(7)
L_p30_2:
  s_waitcnt vmcnt(11)
L_p30_3:
  s_waitcnt vmcnt(12)
  buffer_load_dwordx4 v[104:107], v222, s[32:35], s3 offen nt
  s_cmpk_gt_i32 s69, 0x13
  s_cbranch_scc1 L_p31_3
  s_cmp_gt_i32 s69, L_order_end-L_order-16445
  s_cbranch_scc1 L_p31_0
  s_waitcnt vmcnt(7)
L_p31_0:
  s_waitcnt vmcnt(8)
L_p31_3:
  s_waitcnt vmcnt(12)
  buffer_load_dwordx4 v[108:111], v223, s[32:35], s3 offen nt
L_it13:
  s_waitcnt lgkmcnt(0)
  ds_read_b128 v[40:43], v251 offset:512
  ds_read_b128 v[44:47], v253 offset:512
  ds_read_b128 v[48:51], v251 offset:1536
  s_waitcnt vmcnt(9)
  s_mov_b64 exec, 3
  s_add_u32 s44, s78, 0x03030303
  v_msad_u8 v9, s78, v36, 0
  v_msad_u8 v10, s44, v36, 0
  v_msad_u8 v9, s78, v37, v9
  v_msad_u8 v10, s44, v37, v10
  v_msad_u8 v9, s78, v38, v9
  v_msad_u8 v10, s44, v38, v10
  global_load_dwordx2 v[26:27], v11, s[30:31] sc1
  global_store_byte v7, v8, s[30:31]
  global_load_dwordx3 v[36:38], v233, s[30:31] sc1
  v_sub_u32 v9, v9, v10
  v_add_u32_e64 v8, 1, v8
  v_readlane_b32 s66, v9, 0
  v_readlane_b32 s67, v9, 1
  s_add_u32 s78, s78, 0x01010101
  s_mov_b64 exec, -1
  s_lshl1_add_u32 s69, s91, s95
  s_add_u32 s95, s66, s67
  s_add_u32 s69, s69, s95
  v_dot2_f32_bf16 v22, v161, v52, 0
  v_add_f32_dpp v240, v18, v18 row_ror:8 row_mask:0xf bank_mask:0xc
  v_add_f32_dpp v240, v20, v20 row_ror:8 row_mask:0xf bank_mask:0x3
  v_dot2_f32_bf16 v23, v166, v53, 0
  v_dot2_f32_bf16 v24, v164, v54, 0
  v_dot2_f32_bf16 v25, v167, v55, 0
  v_cvt_f32_i32 v76, v76
  v_cvt_f32_i32 v77, v77
  v_cvt_f32_i32 v78, v78
  v_cvt_f32_i32 v79, v79
  v_pk_mul_f32 v[20:21], v[76:77], v[22:23]
  v_pk_add_f32 v[18:19], v[22:23], v[24:25]
  v_pk_fma_f32 v[20:21], v[78:79], v[24:25], v[20:21]
  v_add_f32 v18, v18, v19
  v_add_f32 v20, v20, v21
  s_add_u32 m0, s100, 18432
  v_lshrrev_b32 v10, 1, v226
  v_add_u32 v10, v10, v242
  v_mad_u64_u32 v[30:31], s[64:65], v10, 1, v[28:29]
  global_load_lds_dwordx4 v[30:31], off
  v_dot2_f32_bf16 v22, v157, v56, 0
  v_add_f32_dpp v21, v18, v18 row_ror:8 row_mask:0xf bank_mask:0xc
  v_add_f32_dpp v21, v20, v20 row_ror:8 row_mask:0xf bank_mask:0x3
  v_add_f32_dpp v20, v240, v240 row_half_mirror row_mask:0xf bank_mask:0x5
  v_dot2_f32_bf16 v23, v162, v57, 0
  v_add_f32_dpp v20, v21, v21 row_half_mirror row_mask:0xf bank_mask:0xa
  v_dot2_f32_bf16 v24, v160, v58, 0
  v_dot2_f32_bf16 v25, v163, v59, 0
  v_add_f32_dpp v20, v20, v20 quad_perm:[2,3,0,1] row_mask:0xf bank_mask:0xf
  v_cvt_f32_i32 v80, v80
  v_cvt_f32_i32 v81, v81
  v_add_f32_dpp v20, v20, v20 quad_perm:[1,0,3,2] row_mask:0xf bank_mask:0xf
  v_cndmask_b32_e64 v237, v237, v20, s[52:53]
  v_cvt_f32_i32 v82, v82
  v_cvt_f32_i32 v83, v83
  v_pk_mul_f32 v[20:21], v[80:81], v[22:23]
  v_pk_add_f32 v[18:19], v[22:23], v[24:25]
  v_pk_fma_f32 v[20:21], v[82:83], v[24:25], v[20:21]
  v_add_f32 v18, v18, v19
  v_add_f32 v20, v20, v21
  s_cmpk_gt_i32 s69, 0x13
  s_cbranch_scc1 L_p32_3
  s_cmp_gt_i32 s69, L_order_end-L_order-16421
  s_cbranch_scc1 L_p32_1
  s_waitcnt vmcnt(7)
L_p32_1:
  s_waitcnt vmcnt(11)
L_p32_3:
  s_waitcnt vmcnt(12)
  buffer_load_dwordx4 v[64:67], v224, s[32:35], 0 offen nt
  ds_read_b64 v[168:169], v12 offset:14336
  ds_read_b64 v[170:171], v12 offset:14464
  ds_read_b64 v[172:173], v12 offset:15360
  ds_read_b64 v[174:175], v12 offset:15488
  v_dot2_f32_bf16 v22, v161, v60, 0
  v_add_f32_dpp v241, v18, v18 row_ror:8 row_mask:0xf bank_mask:0xc
  v_add_f32_dpp v241, v20, v20 row_ror:8 row_mask:0xf bank_mask:0x3
  v_dot2_f32_bf16 v23, v166, v61, 0
  v_dot2_f32_bf16 v24, v164, v62, 0
  v_dot2_f32_bf16 v25, v167, v63, 0
  v_cvt_f32_i32 v84, v84
  v_cvt_f32_i32 v85, v85
  v_cvt_f32_i32 v86, v86
  v_cvt_f32_i32 v87, v87
  v_pk_mul_f32 v[20:21], v[84:85], v[22:23]
  v_pk_add_f32 v[18:19], v[22:23], v[24:25]
  v_pk_fma_f32 v[20:21], v[86:87], v[24:25], v[20:21]
  v_add_f32 v18, v18, v19
  v_add_f32 v20, v20, v21
  s_cmpk_gt_i32 s69, 0x13
  s_cbranch_scc1 L_p33_3
  s_cmp_gt_i32 s69, L_order_end-L_order-16391
  s_cbranch_scc1 L_p33_2
  s_waitcnt vmcnt(8)
L_p33_2:
  s_waitcnt vmcnt(12)
L_p33_3:
  s_waitcnt vmcnt(13)
  buffer_load_dwordx4 v[68:71], v225, s[32:35], 0 offen nt
  s_cmpk_gt_i32 s69, 0x13
  s_cbranch_scc1 L_p34_3
  s_cmp_gt_i32 s69, L_order_end-L_order-16445
  s_cbranch_scc1 L_p34_0
  s_waitcnt vmcnt(8)
L_p34_0:
  s_waitcnt vmcnt(9)
L_p34_3:
  s_waitcnt vmcnt(13)
  buffer_load_dwordx4 v[72:75], v224, s[32:35], s80 offen nt
L_it14:
  s_waitcnt lgkmcnt(0)
  ds_read_b128 v[52:55], v253 offset:1536
  ds_read_b128 v[56:59], v251 offset:2560
  ds_read_b128 v[60:63], v253 offset:2560
  s_waitcnt vmcnt(10)
  s_mov_b64 exec, 3
  s_add_u32 s44, s78, 0x03030303
  v_msad_u8 v9, s78, v32, 0
  v_msad_u8 v10, s44, v32, 0
  v_msad_u8 v9, s78, v33, v9
  v_msad_u8 v10, s44, v33, v10
  v_msad_u8 v9, s78, v34, v9
  v_msad_u8 v10, s44, v34, v10
  global_store_byte v7, v8, s[30:31]
  global_load_dwordx3 v[32:34], v234, s[30:31] sc1
  v_sub_u32 v9, v9, v10
  v_add_u32_e64 v8, 1, v8
  v_readlane_b32 s66, v9, 0
  v_readlane_b32 s67, v9, 1
  s_add_u32 s78, s78, 0x01010101
  s_mov_b64 exec, -1
  s_lshl1_add_u32 s69, s91, s95
  s_add_u32 s95, s66, s67
  s_add_u32 s69, s69, s95
  v_perm_b32 v165, v170, v168, s56
  v_perm_b32 v170, v170, v168, s57
  v_perm_b32 v168, v171, v169, s56
  v_perm_b32 v171, v171, v169, s57
  v_dot2_f32_bf16 v22, v165, v40, 0
  v_add_f32_dpp v21, v18, v18 row_ror:8 row_mask:0xf bank_mask:0xc
  v_add_f32_dpp v21, v20, v20 row_ror:8 row_mask:0xf bank_mask:0x3
  v_add_f32_dpp v20, v241, v241 row_half_mirror row_mask:0xf bank_mask:0x5
  v_dot2_f32_bf16 v23, v170, v41, 0
  v_add_f32_dpp v20, v21, v21 row_half_mirror row_mask:0xf bank_mask:0xa
  v_dot2_f32_bf16 v24, v168, v42, 0
  v_dot2_f32_bf16 v25, v171, v43, 0
  v_add_f32_dpp v20, v20, v20 quad_perm:[2,3,0,1] row_mask:0xf bank_mask:0xf
  v_cvt_f32_i32 v88, v88
  v_cvt_f32_i32 v89, v89
  v_add_f32_dpp v20, v20, v20 quad_perm:[1,0,3,2] row_mask:0xf bank_mask:0xf
  v_cndmask_b32_e64 v238, v238, v20, s[52:53]
  v_cvt_f32_i32 v90, v90
  v_cvt_f32_i32 v91, v91
  v_pk_mul_f32 v[20:21], v[88:89], v[22:23]
  v_pk_add_f32 v[18:19], v[22:23], v[24:25]
  v_pk_fma_f32 v[20:21], v[90:91], v[24:25], v[20:21]
  v_add_f32 v18, v18, v19
  v_add_f32 v20, v20, v21
  s_add_u32 m0, s100, 19456
  v_lshrrev_b32 v10, 1, v227
  v_add_u32 v10, v10, v244
  v_mad_u64_u32 v[30:31], s[64:65], v10, 1, v[28:29]
  global_load_lds_dwordx4 v[30:31], off
  v_perm_b32 v169, v174, v172, s56
  v_perm_b32 v174, v174, v172, s57
  v_perm_b32 v172, v175, v173, s56
  v_perm_b32 v175, v175, v173, s57
  v_dot2_f32_bf16 v22, v169, v44, 0
  v_add_f32_dpp v239, v18, v18 row_ror:8 row_mask:0xf bank_mask:0xc
  v_add_f32_dpp v239, v20, v20 row_ror:8 row_mask:0xf bank_mask:0x3
  v_dot2_f32_bf16 v23, v174, v45, 0
  v_dot2_f32_bf16 v24, v172, v46, 0
  v_dot2_f32_bf16 v25, v175, v47, 0
  v_cvt_f32_i32 v92, v92
  v_cvt_f32_i32 v93, v93
  v_cvt_f32_i32 v94, v94
  v_cvt_f32_i32 v95, v95
  v_pk_mul_f32 v[20:21], v[92:93], v[22:23]
  v_pk_add_f32 v[18:19], v[22:23], v[24:25]
  v_pk_fma_f32 v[20:21], v[94:95], v[24:25], v[20:21]
  v_add_f32 v18, v18, v19
  v_add_f32 v20, v20, v21
  s_cmpk_gt_i32 s69, 0x13
  s_cbranch_scc1 L_p35_3
  s_cmp_gt_i32 s69, L_order_end-L_order-16421
  s_cbranch_scc1 L_p35_1
  s_waitcnt vmcnt(6)
L_p35_1:
  s_waitcnt vmcnt(11)
L_p35_3:
  s_waitcnt vmcnt(12)
  buffer_load_dwordx4 v[76:79], v225, s[32:35], s80 offen nt
  v_dot2_f32_bf16 v22, v165, v48, 0
  v_add_f32_dpp v21, v18, v18 row_ror:8 row_mask:0xf bank_mask:0xc
  v_add_f32_dpp v21, v20, v20 row_ror:8 row_mask:0xf bank_mask:0x3
  v_add_f32_dpp v20, v239, v239 row_half_mirror row_mask:0xf bank_mask:0x5
  v_dot2_f32_bf16 v23, v170, v49, 0
  v_add_f32_dpp v20, v21, v21 row_half_mirror row_mask:0xf bank_mask:0xa
  v_dot2_f32_bf16 v24, v168, v50, 0
  v_dot2_f32_bf16 v25, v171, v51, 0
  v_add_f32_dpp v20, v20, v20 quad_perm:[2,3,0,1] row_mask:0xf bank_mask:0xf
  v_cvt_f32_i32 v96, v96
  v_cvt_f32_i32 v97, v97
  v_add_f32_dpp v20, v20, v20 quad_perm:[1,0,3,2] row_mask:0xf bank_mask:0xf
  v_cndmask_b32_e64 v236, v236, v20, s[54:55]
  ds_write_b32 v16, v236 offset:0
  v_cvt_f32_i32 v98, v98
  v_cvt_f32_i32 v99, v99
  v_pk_mul_f32 v[20:21], v[96:97], v[22:23]
  v_pk_add_f32 v[18:19], v[22:23], v[24:25]
  v_pk_fma_f32 v[20:21], v[98:99], v[24:25], v[20:21]
  v_add_f32 v18, v18, v19
  v_add_f32 v20, v20, v21
  s_cmpk_gt_i32 s69, 0x13
  s_cbranch_scc1 L_p36_3
  s_cmp_gt_i32 s69, L_order_end-L_order-16391
  s_cbranch_scc1 L_p36_2
  s_waitcnt vmcnt(7)
L_p36_2:
  s_waitcnt vmcnt(12)
L_p36_3:
  s_waitcnt vmcnt(13)
  buffer_load_dwordx4 v[80:83], v224, s[32:35], s3 offen nt
  s_cmpk_gt_i32 s69, 0x13
  s_cbranch_scc1 L_p37_3
  s_cmp_gt_i32 s69, L_order_end-L_order-16445
  s_cbranch_scc1 L_p37_0
  s_waitcnt vmcnt(7)
L_p37_0:
  s_waitcnt vmcnt(8)
L_p37_3:
  s_waitcnt vmcnt(13)
  buffer_load_dwordx4 v[84:87], v225, s[32:35], s3 offen nt
L_it15:
  s_waitcnt lgkmcnt(0)
  ds_read_b128 v[40:43], v250 offset:512
  ds_read_b128 v[44:47], v249 offset:512
  ds_read_b128 v[48:51], v250 offset:1536
  s_waitcnt vmcnt(9)
  s_mov_b64 exec, 3
  s_add_u32 s44, s78, 0x03030303
  v_msad_u8 v9, s78, v36, 0
  v_msad_u8 v10, s44, v36, 0
  v_msad_u8 v9, s78, v37, v9
  v_msad_u8 v10, s44, v37, v10
  v_msad_u8 v9, s78, v38, v9
  v_msad_u8 v10, s44, v38, v10
  global_store_byte v7, v8, s[30:31]
  global_load_dwordx3 v[36:38], v235, s[30:31] sc1
  v_sub_u32 v9, v9, v10
  v_add_u32_e64 v8, 1, v8
  v_add3_u32 v10, v26, v27, s58
  v_readlane_b32 s66, v9, 0
  v_readlane_b32 s67, v9, 1
  v_readlane_b32 s91, v10, 0
  s_add_u32 s78, s78, 0x01010101
  s_mov_b64 exec, -1
  s_lshl1_add_u32 s69, s91, s95
  s_add_u32 s95, s66, s67
  s_add_u32 s69, s69, s95
  v_dot2_f32_bf16 v22, v169, v52, 0
  v_add_f32_dpp v240, v18, v18 row_ror:8 row_mask:0xf bank_mask:0xc
  v_add_f32_dpp v240, v20, v20 row_ror:8 row_mask:0xf bank_mask:0x3
  v_dot2_f32_bf16 v23, v174, v53, 0
  v_dot2_f32_bf16 v24, v172, v54, 0
  v_dot2_f32_bf16 v25, v175, v55, 0
  v_cvt_f32_i32 v100, v100
  v_cvt_f32_i32 v101, v101
  v_cvt_f32_i32 v102, v102
  v_cvt_f32_i32 v103, v103
  v_pk_mul_f32 v[20:21], v[100:101], v[22:23]
  v_pk_add_f32 v[18:19], v[22:23], v[24:25]
  v_pk_fma_f32 v[20:21], v[102:103], v[24:25], v[20:21]
  v_add_f32 v18, v18, v19
  v_add_f32 v20, v20, v21
  s_add_u32 m0, s100, 20480
  v_lshrrev_b32 v10, 1, v228
  v_add_u32 v10, v10, v245
  v_mad_u64_u32 v[30:31], s[64:65], v10, 1, v[28:29]
  global_load_lds_dwordx4 v[30:31], off
  v_dot2_f32_bf16 v22, v165, v56, 0
  v_add_f32_dpp v21, v18, v18 row_ror:8 row_mask:0xf bank_mask:0xc
  v_add_f32_dpp v21, v20, v20 row_ror:8 row_mask:0xf bank_mask:0x3
  v_add_f32_dpp v20, v240, v240 row_half_mirror row_mask:0xf bank_mask:0x5
  v_dot2_f32_bf16 v23, v170, v57, 0
  v_add_f32_dpp v20, v21, v21 row_half_mirror row_mask:0xf bank_mask:0xa
  v_dot2_f32_bf16 v24, v168, v58, 0
  v_dot2_f32_bf16 v25, v171, v59, 0
  v_add_f32_dpp v20, v20, v20 quad_perm:[2,3,0,1] row_mask:0xf bank_mask:0xf
  v_cvt_f32_i32 v104, v104
  v_cvt_f32_i32 v105, v105
  v_add_f32_dpp v20, v20, v20 quad_perm:[1,0,3,2] row_mask:0xf bank_mask:0xf
  v_cndmask_b32_e64 v237, v237, v20, s[54:55]
  ds_write_b32 v16, v237 offset:3072
  v_cvt_f32_i32 v106, v106
  v_cvt_f32_i32 v107, v107
  v_pk_mul_f32 v[20:21], v[104:105], v[22:23]
  v_pk_add_f32 v[18:19], v[22:23], v[24:25]
  v_pk_fma_f32 v[20:21], v[106:107], v[24:25], v[20:21]
  v_add_f32 v18, v18, v19
  v_add_f32 v20, v20, v21
  s_cmpk_gt_i32 s69, 0x13
  s_cbranch_scc1 L_p38_3
  s_cmp_gt_i32 s69, L_order_end-L_order-16421
  s_cbranch_scc1 L_p38_1
  s_waitcnt vmcnt(6)
L_p38_1:
  s_waitcnt vmcnt(10)
L_p38_3:
  s_waitcnt vmcnt(11)
  buffer_load_dwordx4 v[88:91], v226, s[32:35], 0 offen nt
  ds_read_b64 v[176:177], v12 offset:16384
  ds_read_b64 v[178:179], v12 offset:16512
  ds_read_b64 v[180:181], v12 offset:17408
  ds_read_b64 v[182:183], v12 offset:17536
  v_dot2_f32_bf16 v22, v169, v60, 0
  v_add_f32_dpp v241, v18, v18 row_ror:8 row_mask:0xf bank_mask:0xc
  v_add_f32_dpp v241, v20, v20 row_ror:8 row_mask:0xf bank_mask:0x3
  v_dot2_f32_bf16 v23, v174, v61, 0
  v_dot2_f32_bf16 v24, v172, v62, 0
  v_dot2_f32_bf16 v25, v175, v63, 0
  v_cvt_f32_i32 v108, v108
  v_cvt_f32_i32 v109, v109
  v_cvt_f32_i32 v110, v110
  v_cvt_f32_i32 v111, v111
  v_pk_mul_f32 v[20:21], v[108:109], v[22:23]
  v_pk_add_f32 v[18:19], v[22:23], v[24:25]
  v_pk_fma_f32 v[20:21], v[110:111], v[24:25], v[20:21]
  v_add_f32 v18, v18, v19
  v_add_f32 v20, v20, v21
  s_cmpk_gt_i32 s69, 0x13
  s_cbranch_scc1 L_p39_3
  s_cmp_gt_i32 s69, L_order_end-L_order-16391
  s_cbranch_scc1 L_p39_2
  s_waitcnt vmcnt(7)
L_p39_2:
  s_waitcnt vmcnt(11)
L_p39_3:
  s_waitcnt vmcnt(12)
  buffer_load_dwordx4 v[92:95], v227, s[32:35], 0 offen nt
  s_cmpk_gt_i32 s69, 0x13
  s_cbranch_scc1 L_p40_3
  s_cmp_gt_i32 s69, L_order_end-L_order-16445
  s_cbranch_scc1 L_p40_0
  s_waitcnt vmcnt(7)
L_p40_0:
  s_waitcnt vmcnt(8)
L_p40_3:
  s_waitcnt vmcnt(12)
  buffer_load_dwordx4 v[96:99], v226, s[32:35], s80 offen nt
  v_mov_b32_e64 v9, 2
  ds_write_b32 v6, v9 offset:0
L_it16:
  s_waitcnt lgkmcnt(0)
  ds_read_b128 v[52:55], v249 offset:1536
  ds_read_b128 v[56:59], v250 offset:2560
  ds_read_b128 v[60:63], v249 offset:2560
  s_waitcnt vmcnt(9)
  s_mov_b64 exec, 3
  s_add_u32 s44, s78, 0x03030303
  v_msad_u8 v9, s78, v32, 0
  v_msad_u8 v10, s44, v32, 0
  v_msad_u8 v9, s78, v33, v9
  v_msad_u8 v10, s44, v33, v10
  v_msad_u8 v9, s78, v34, v9
  v_msad_u8 v10, s44, v34, v10
  global_store_byte v7, v8, s[30:31]
  global_load_dwordx3 v[32:34], v232, s[30:31] sc1
  v_sub_u32 v9, v9, v10
  v_add_u32_e64 v8, 1, v8
  v_readlane_b32 s66, v9, 0
  v_readlane_b32 s67, v9, 1
  s_add_u32 s78, s78, 0x01010101
  s_mov_b64 exec, -1
  s_lshl1_add_u32 s69, s91, s95
  s_add_u32 s95, s66, s67
  s_add_u32 s69, s69, s95
  v_perm_b32 v173, v178, v176, s56
  v_perm_b32 v178, v178, v176, s57
  v_perm_b32 v176, v179, v177, s56
  v_perm_b32 v179, v179, v177, s57
  v_dot2_f32_bf16 v22, v173, v40, 0
  v_add_f32_dpp v21, v18, v18 row_ror:8 row_mask:0xf bank_mask:0xc
  v_add_f32_dpp v21, v20, v20 row_ror:8 row_mask:0xf bank_mask:0x3
  v_add_f32_dpp v20, v241, v241 row_half_mirror row_mask:0xf bank_mask:0x5
  v_dot2_f32_bf16 v23, v178, v41, 0
  v_add_f32_dpp v20, v21, v21 row_half_mirror row_mask:0xf bank_mask:0xa
  v_dot2_f32_bf16 v24, v176, v42, 0
  v_dot2_f32_bf16 v25, v179, v43, 0
  v_add_f32_dpp v20, v20, v20 quad_perm:[2,3,0,1] row_mask:0xf bank_mask:0xf
  v_cvt_f32_i32 v64, v64
  v_cvt_f32_i32 v65, v65
  v_add_f32_dpp v20, v20, v20 quad_perm:[1,0,3,2] row_mask:0xf bank_mask:0xf
  v_cndmask_b32_e64 v238, v238, v20, s[54:55]
  ds_write_b32 v16, v238 offset:6144
  v_cvt_f32_i32 v66, v66
  v_cvt_f32_i32 v67, v67
  v_pk_mul_f32 v[20:21], v[64:65], v[22:23]
  v_pk_add_f32 v[18:19], v[22:23], v[24:25]
  v_pk_fma_f32 v[20:21], v[66:67], v[24:25], v[20:21]
  v_add_f32 v18, v18, v19
  v_add_f32 v20, v20, v21
  s_add_u32 m0, s100, 21504
  v_lshrrev_b32 v10, 1, v229
  v_add_u32 v10, v10, v247
  v_mad_u64_u32 v[30:31], s[64:65], v10, 1, v[28:29]
  global_load_lds_dwordx4 v[30:31], off
  v_perm_b32 v177, v182, v180, s56
  v_perm_b32 v182, v182, v180, s57
  v_perm_b32 v180, v183, v181, s56
  v_perm_b32 v183, v183, v181, s57
  v_dot2_f32_bf16 v22, v177, v44, 0
  v_add_f32_dpp v239, v18, v18 row_ror:8 row_mask:0xf bank_mask:0xc
  v_add_f32_dpp v239, v20, v20 row_ror:8 row_mask:0xf bank_mask:0x3
  v_dot2_f32_bf16 v23, v182, v45, 0
  v_dot2_f32_bf16 v24, v180, v46, 0
  v_dot2_f32_bf16 v25, v183, v47, 0
  v_cvt_f32_i32 v68, v68
  v_cvt_f32_i32 v69, v69
  v_cvt_f32_i32 v70, v70
  v_cvt_f32_i32 v71, v71
  v_pk_mul_f32 v[20:21], v[68:69], v[22:23]
  v_pk_add_f32 v[18:19], v[22:23], v[24:25]
  v_pk_fma_f32 v[20:21], v[70:71], v[24:25], v[20:21]
  v_add_f32 v18, v18, v19
  v_add_f32 v20, v20, v21
  s_cmpk_gt_i32 s69, 0x13
  s_cbranch_scc1 L_p41_3
  s_cmp_gt_i32 s69, L_order_end-L_order-16421
  s_cbranch_scc1 L_p41_1
  s_waitcnt vmcnt(6)
L_p41_1:
  s_waitcnt vmcnt(10)
L_p41_3:
  s_waitcnt vmcnt(11)
  buffer_load_dwordx4 v[100:103], v227, s[32:35], s80 offen nt
  v_dot2_f32_bf16 v22, v173, v48, 0
  v_add_f32_dpp v21, v18, v18 row_ror:8 row_mask:0xf bank_mask:0xc
  v_add_f32_dpp v21, v20, v20 row_ror:8 row_mask:0xf bank_mask:0x3
  v_add_f32_dpp v20, v239, v239 row_half_mirror row_mask:0xf bank_mask:0x5
  v_dot2_f32_bf16 v23, v178, v49, 0
  v_add_f32_dpp v20, v21, v21 row_half_mirror row_mask:0xf bank_mask:0xa
  v_dot2_f32_bf16 v24, v176, v50, 0
  v_dot2_f32_bf16 v25, v179, v51, 0
  v_add_f32_dpp v20, v20, v20 quad_perm:[2,3,0,1] row_mask:0xf bank_mask:0xf
  v_cvt_f32_i32 v72, v72
  v_cvt_f32_i32 v73, v73
  v_add_f32_dpp v20, v20, v20 quad_perm:[1,0,3,2] row_mask:0xf bank_mask:0xf
  v_cndmask_b32_e64 v236, v236, v20, s[48:49]
  v_cvt_f32_i32 v74, v74
  v_cvt_f32_i32 v75, v75
  v_pk_mul_f32 v[20:21], v[72:73], v[22:23]
  v_pk_add_f32 v[18:19], v[22:23], v[24:25]
  v_pk_fma_f32 v[20:21], v[74:75], v[24:25], v[20:21]
  v_add_f32 v18, v18, v19
  v_add_f32 v20, v20, v21
  s_cmpk_gt_i32 s69, 0x13
  s_cbranch_scc1 L_p42_3
  s_cmp_gt_i32 s69, L_order_end-L_order-16391
  s_cbranch_scc1 L_p42_2
  s_waitcnt vmcnt(7)
L_p42_2:
  s_waitcnt vmcnt(11)
L_p42_3:
  s_waitcnt vmcnt(12)
  buffer_load_dwordx4 v[104:107], v226, s[32:35], s3 offen nt
  s_cmpk_gt_i32 s69, 0x13
  s_cbranch_scc1 L_p43_3
  s_cmp_gt_i32 s69, L_order_end-L_order-16445
  s_cbranch_scc1 L_p43_0
  s_waitcnt vmcnt(7)
L_p43_0:
  s_waitcnt vmcnt(8)
L_p43_3:
  s_waitcnt vmcnt(12)
  buffer_load_dwordx4 v[108:111], v227, s[32:35], s3 offen nt
L_it17:
  s_waitcnt lgkmcnt(0)
  ds_read_b128 v[40:43], v248 offset:512
  ds_read_b128 v[44:47], v250 offset:512
  ds_read_b128 v[48:51], v248 offset:1536
  s_waitcnt vmcnt(9)
  s_mov_b64 exec, 3
  s_add_u32 s44, s78, 0x03030303
  v_msad_u8 v9, s78, v36, 0
  v_msad_u8 v10, s44, v36, 0
  v_msad_u8 v9, s78, v37, v9
  v_msad_u8 v10, s44, v37, v10
  v_msad_u8 v9, s78, v38, v9
  v_msad_u8 v10, s44, v38, v10
  global_store_byte v7, v8, s[30:31]
  global_load_dwordx3 v[36:38], v233, s[30:31] sc1
  v_sub_u32 v9, v9, v10
  v_add_u32_e64 v8, 1, v8
  v_readlane_b32 s66, v9, 0
  v_readlane_b32 s67, v9, 1
  s_add_u32 s78, s78, 0x01010101
  s_mov_b64 exec, -1
  s_lshl1_add_u32 s69, s91, s95
  s_add_u32 s95, s66, s67
  s_add_u32 s69, s69, s95
  v_dot2_f32_bf16 v22, v177, v52, 0
  v_add_f32_dpp v240, v18, v18 row_ror:8 row_mask:0xf bank_mask:0xc
  v_add_f32_dpp v240, v20, v20 row_ror:8 row_mask:0xf bank_mask:0x3
  v_dot2_f32_bf16 v23, v182, v53, 0
  v_dot2_f32_bf16 v24, v180, v54, 0
  v_dot2_f32_bf16 v25, v183, v55, 0
  v_cvt_f32_i32 v76, v76
  v_cvt_f32_i32 v77, v77
  v_cvt_f32_i32 v78, v78
  v_cvt_f32_i32 v79, v79
  v_pk_mul_f32 v[20:21], v[76:77], v[22:23]
  v_pk_add_f32 v[18:19], v[22:23], v[24:25]
  v_pk_fma_f32 v[20:21], v[78:79], v[24:25], v[20:21]
  v_add_f32 v18, v18, v19
  v_add_f32 v20, v20, v21
  s_add_u32 m0, s100, 22528
  v_lshrrev_b32 v10, 1, v230
  v_add_u32 v10, v10, v246
  v_mad_u64_u32 v[30:31], s[64:65], v10, 1, v[28:29]
  global_load_lds_dwordx4 v[30:31], off
  v_dot2_f32_bf16 v22, v173, v56, 0
  v_add_f32_dpp v21, v18, v18 row_ror:8 row_mask:0xf bank_mask:0xc
  v_add_f32_dpp v21, v20, v20 row_ror:8 row_mask:0xf bank_mask:0x3
  v_add_f32_dpp v20, v240, v240 row_half_mirror row_mask:0xf bank_mask:0x5
  v_dot2_f32_bf16 v23, v178, v57, 0
  v_add_f32_dpp v20, v21, v21 row_half_mirror row_mask:0xf bank_mask:0xa
  v_dot2_f32_bf16 v24, v176, v58, 0
  v_dot2_f32_bf16 v25, v179, v59, 0
  v_add_f32_dpp v20, v20, v20 quad_perm:[2,3,0,1] row_mask:0xf bank_mask:0xf
  v_cvt_f32_i32 v80, v80
  v_cvt_f32_i32 v81, v81
  v_add_f32_dpp v20, v20, v20 quad_perm:[1,0,3,2] row_mask:0xf bank_mask:0xf
  v_cndmask_b32_e64 v237, v237, v20, s[48:49]
  v_cvt_f32_i32 v82, v82
  v_cvt_f32_i32 v83, v83
  v_pk_mul_f32 v[20:21], v[80:81], v[22:23]
  v_pk_add_f32 v[18:19], v[22:23], v[24:25]
  v_pk_fma_f32 v[20:21], v[82:83], v[24:25], v[20:21]
  v_add_f32 v18, v18, v19
  v_add_f32 v20, v20, v21
  s_cmpk_gt_i32 s69, 0x13
  s_cbranch_scc1 L_p44_3
  s_cmp_gt_i32 s69, L_order_end-L_order-16421
  s_cbranch_scc1 L_p44_1
  s_waitcnt vmcnt(6)
L_p44_1:
  s_waitcnt vmcnt(10)
L_p44_3:
  s_waitcnt vmcnt(11)
  buffer_load_dwordx4 v[64:67], v228, s[32:35], 0 offen nt
  ds_read_b64 v[184:185], v12 offset:18432
  ds_read_b64 v[186:187], v12 offset:18560
  ds_read_b64 v[188:189], v12 offset:19456
  ds_read_b64 v[190:191], v12 offset:19584
  v_dot2_f32_bf16 v22, v177, v60, 0
  v_add_f32_dpp v241, v18, v18 row_ror:8 row_mask:0xf bank_mask:0xc
  v_add_f32_dpp v241, v20, v20 row_ror:8 row_mask:0xf bank_mask:0x3
  v_dot2_f32_bf16 v23, v182, v61, 0
  v_dot2_f32_bf16 v24, v180, v62, 0
  v_dot2_f32_bf16 v25, v183, v63, 0
  v_cvt_f32_i32 v84, v84
  v_cvt_f32_i32 v85, v85
  v_cvt_f32_i32 v86, v86
  v_cvt_f32_i32 v87, v87
  v_pk_mul_f32 v[20:21], v[84:85], v[22:23]
  v_pk_add_f32 v[18:19], v[22:23], v[24:25]
  v_pk_fma_f32 v[20:21], v[86:87], v[24:25], v[20:21]
  v_add_f32 v18, v18, v19
  v_add_f32 v20, v20, v21
  s_cmpk_gt_i32 s69, 0x13
  s_cbranch_scc1 L_p45_3
  s_cmp_gt_i32 s69, L_order_end-L_order-16391
  s_cbranch_scc1 L_p45_2
  s_waitcnt vmcnt(7)
L_p45_2:
  s_waitcnt vmcnt(11)
L_p45_3:
  s_waitcnt vmcnt(12)
  buffer_load_dwordx4 v[68:71], v229, s[32:35], 0 offen nt
  s_cmpk_gt_i32 s69, 0x13
  s_cbranch_scc1 L_p46_3
  s_cmp_gt_i32 s69, L_order_end-L_order-16445
  s_cbranch_scc1 L_p46_0
  s_waitcnt vmcnt(7)
L_p46_0:
  s_waitcnt vmcnt(8)
L_p46_3:
  s_waitcnt vmcnt(12)
  buffer_load_dwordx4 v[72:75], v228, s[32:35], s80 offen nt
L_it18:
  s_waitcnt lgkmcnt(0)
  ds_read_b128 v[52:55], v250 offset:1536
  ds_read_b128 v[56:59], v248 offset:2560
  ds_read_b128 v[60:63], v250 offset:2560
  s_waitcnt vmcnt(9)
  s_mov_b64 exec, 3
  s_add_u32 s44, s78, 0x03030303
  v_msad_u8 v9, s78, v32, 0
  v_msad_u8 v10, s44, v32, 0
  v_msad_u8 v9, s78, v33, v9
  v_msad_u8 v10, s44, v33, v10
  v_msad_u8 v9, s78, v34, v9
  v_msad_u8 v10, s44, v34, v10
  global_store_byte v7, v8, s[30:31]
  global_load_dwordx3 v[32:34], v234, s[30:31] sc1
  v_sub_u32 v9, v9, v10
  v_add_u32_e64 v8, 1, v8
  v_readlane_b32 s66, v9, 0
  v_readlane_b32 s67, v9, 1
  s_add_u32 s78, s78, 0x01010101
  s_mov_b64 exec, -1
  s_lshl1_add_u32 s69, s91, s95
  s_add_u32 s95, s66, s67
  s_add_u32 s69, s69, s95
  v_perm_b32 v181, v186, v184, s56
  v_perm_b32 v186, v186, v184, s57
  v_perm_b32 v184, v187, v185, s56
  v_perm_b32 v187, v187, v185, s57
  v_dot2_f32_bf16 v22, v181, v40, 0
  v_add_f32_dpp v21, v18, v18 row_ror:8 row_mask:0xf bank_mask:0xc
  v_add_f32_dpp v21, v20, v20 row_ror:8 row_mask:0xf bank_mask:0x3
  v_add_f32_dpp v20, v241, v241 row_half_mirror row_mask:0xf bank_mask:0x5
  v_dot2_f32_bf16 v23, v186, v41, 0
  v_add_f32_dpp v20, v21, v21 row_half_mirror row_mask:0xf bank_mask:0xa
  v_dot2_f32_bf16 v24, v184, v42, 0
  v_dot2_f32_bf16 v25, v187, v43, 0
  v_add_f32_dpp v20, v20, v20 quad_perm:[2,3,0,1] row_mask:0xf bank_mask:0xf
  v_cvt_f32_i32 v88, v88
  v_cvt_f32_i32 v89, v89
  v_add_f32_dpp v20, v20, v20 quad_perm:[1,0,3,2] row_mask:0xf bank_mask:0xf
  v_cndmask_b32_e64 v238, v238, v20, s[48:49]
  v_cvt_f32_i32 v90, v90
  v_cvt_f32_i32 v91, v91
  v_pk_mul_f32 v[20:21], v[88:89], v[22:23]
  v_pk_add_f32 v[18:19], v[22:23], v[24:25]
  v_pk_fma_f32 v[20:21], v[90:91], v[24:25], v[20:21]
  v_add_f32 v18, v18, v19
  v_add_f32 v20, v20, v21
  s_add_u32 m0, s100, 23552
  v_lshrrev_b32 v10, 1, v231
  v_add_u32 v10, v10, v245
  v_mad_u64_u32 v[30:31], s[64:65], v10, 1, v[28:29]
  global_load_lds_dwordx4 v[30:31], off
  v_perm_b32 v185, v190, v188, s56
  v_perm_b32 v190, v190, v188, s57
  v_perm_b32 v188, v191, v189, s56
  v_perm_b32 v191, v191, v189, s57
  v_dot2_f32_bf16 v22, v185, v44, 0
  v_add_f32_dpp v239, v18, v18 row_ror:8 row_mask:0xf bank_mask:0xc
  v_add_f32_dpp v239, v20, v20 row_ror:8 row_mask:0xf bank_mask:0x3
  v_dot2_f32_bf16 v23, v190, v45, 0
  v_dot2_f32_bf16 v24, v188, v46, 0
  v_dot2_f32_bf16 v25, v191, v47, 0
  v_cvt_f32_i32 v92, v92
  v_cvt_f32_i32 v93, v93
  v_cvt_f32_i32 v94, v94
  v_cvt_f32_i32 v95, v95
  v_pk_mul_f32 v[20:21], v[92:93], v[22:23]
  v_pk_add_f32 v[18:19], v[22:23], v[24:25]
  v_pk_fma_f32 v[20:21], v[94:95], v[24:25], v[20:21]
  v_add_f32 v18, v18, v19
  v_add_f32 v20, v20, v21
  s_cmpk_gt_i32 s69, 0x13
  s_cbranch_scc1 L_p47_3
  s_cmp_gt_i32 s69, L_order_end-L_order-16421
  s_cbranch_scc1 L_p47_1
  s_waitcnt vmcnt(6)
L_p47_1:
  s_waitcnt vmcnt(10)
L_p47_3:
  s_waitcnt vmcnt(11)
  buffer_load_dwordx4 v[76:79], v229, s[32:35], s80 offen nt
  v_dot2_f32_bf16 v22, v181, v48, 0
  v_add_f32_dpp v21, v18, v18 row_ror:8 row_mask:0xf bank_mask:0xc
  v_add_f32_dpp v21, v20, v20 row_ror:8 row_mask:0xf bank_mask:0x3
  v_add_f32_dpp v20, v239, v239 row_half_mirror row_mask:0xf bank_mask:0x5
  v_dot2_f32_bf16 v23, v186, v49, 0
  v_add_f32_dpp v20, v21, v21 row_half_mirror row_mask:0xf bank_mask:0xa
  v_dot2_f32_bf16 v24, v184, v50, 0
  v_dot2_f32_bf16 v25, v187, v51, 0
  v_add_f32_dpp v20, v20, v20 quad_perm:[2,3,0,1] row_mask:0xf bank_mask:0xf
  v_cvt_f32_i32 v96, v96
  v_cvt_f32_i32 v97, v97
  v_add_f32_dpp v20, v20, v20 quad_perm:[1,0,3,2] row_mask:0xf bank_mask:0xf
  v_cndmask_b32_e64 v236, v236, v20, s[50:51]
  v_cvt_f32_i32 v98, v98
  v_cvt_f32_i32 v99, v99
  v_pk_mul_f32 v[20:21], v[96:97], v[22:23]
  v_pk_add_f32 v[18:19], v[22:23], v[24:25]
  v_pk_fma_f32 v[20:21], v[98:99], v[24:25], v[20:21]
  v_add_f32 v18, v18, v19
  v_add_f32 v20, v20, v21
  s_cmpk_gt_i32 s69, 0x13
  s_cbranch_scc1 L_p48_3
  s_cmp_gt_i32 s69, L_order_end-L_order-16391
  s_cbranch_scc1 L_p48_2
  s_waitcnt vmcnt(7)
L_p48_2:
  s_waitcnt vmcnt(11)
L_p48_3:
  s_waitcnt vmcnt(12)
  buffer_load_dwordx4 v[80:83], v228, s[32:35], s3 offen nt
  s_cmpk_gt_i32 s69, 0x13
  s_cbranch_scc1 L_p49_3
  s_cmp_gt_i32 s69, L_order_end-L_order-16445
  s_cbranch_scc1 L_p49_0
  s_waitcnt vmcnt(7)
L_p49_0:
  s_waitcnt vmcnt(8)
L_p49_3:
  s_waitcnt vmcnt(12)
  buffer_load_dwordx4 v[84:87], v229, s[32:35], s3 offen nt
L_it19:
  s_waitcnt lgkmcnt(0)
  ds_read_b128 v[40:43], v251 offset:512
  ds_read_b128 v[44:47], v253 offset:512
  ds_read_b128 v[48:51], v251 offset:1536
  s_waitcnt vmcnt(9)
  s_mov_b64 exec, 3
  s_add_u32 s44, s78, 0x03030303
  v_msad_u8 v9, s78, v36, 0
  v_msad_u8 v10, s44, v36, 0
  v_msad_u8 v9, s78, v37, v9
  v_msad_u8 v10, s44, v37, v10
  v_msad_u8 v9, s78, v38, v9
  v_msad_u8 v10, s44, v38, v10
  global_store_byte v7, v8, s[30:31]
  global_load_dwordx3 v[36:38], v235, s[30:31] sc1
  v_sub_u32 v9, v9, v10
  v_add_u32_e64 v8, 1, v8
  v_readlane_b32 s66, v9, 0
  v_readlane_b32 s67, v9, 1
  s_add_u32 s78, s78, 0x01010101
  s_mov_b64 exec, -1
  s_lshl1_add_u32 s69, s91, s95
  s_add_u32 s95, s66, s67
  s_add_u32 s69, s69, s95
  v_dot2_f32_bf16 v22, v185, v52, 0
  v_add_f32_dpp v240, v18, v18 row_ror:8 row_mask:0xf bank_mask:0xc
  v_add_f32_dpp v240, v20, v20 row_ror:8 row_mask:0xf bank_mask:0x3
  v_dot2_f32_bf16 v23, v190, v53, 0
  v_dot2_f32_bf16 v24, v188, v54, 0
  v_dot2_f32_bf16 v25, v191, v55, 0
  v_cvt_f32_i32 v100, v100
  v_cvt_f32_i32 v101, v101
  v_cvt_f32_i32 v102, v102
  v_cvt_f32_i32 v103, v103
  v_pk_mul_f32 v[20:21], v[100:101], v[22:23]
  v_pk_add_f32 v[18:19], v[22:23], v[24:25]
  v_pk_fma_f32 v[20:21], v[102:103], v[24:25], v[20:21]
  v_add_f32 v18, v18, v19
  v_add_f32 v20, v20, v21
  v_dot2_f32_bf16 v22, v181, v56, 0
  v_add_f32_dpp v21, v18, v18 row_ror:8 row_mask:0xf bank_mask:0xc
  v_add_f32_dpp v21, v20, v20 row_ror:8 row_mask:0xf bank_mask:0x3
  v_add_f32_dpp v20, v240, v240 row_half_mirror row_mask:0xf bank_mask:0x5
  v_dot2_f32_bf16 v23, v186, v57, 0
  v_add_f32_dpp v20, v21, v21 row_half_mirror row_mask:0xf bank_mask:0xa
  v_dot2_f32_bf16 v24, v184, v58, 0
  v_dot2_f32_bf16 v25, v187, v59, 0
  v_add_f32_dpp v20, v20, v20 quad_perm:[2,3,0,1] row_mask:0xf bank_mask:0xf
  v_cvt_f32_i32 v104, v104
  v_cvt_f32_i32 v105, v105
  v_add_f32_dpp v20, v20, v20 quad_perm:[1,0,3,2] row_mask:0xf bank_mask:0xf
  v_cndmask_b32_e64 v237, v237, v20, s[50:51]
  v_cvt_f32_i32 v106, v106
  v_cvt_f32_i32 v107, v107
  v_pk_mul_f32 v[20:21], v[104:105], v[22:23]
  v_pk_add_f32 v[18:19], v[22:23], v[24:25]
  v_pk_fma_f32 v[20:21], v[106:107], v[24:25], v[20:21]
  v_add_f32 v18, v18, v19
  v_add_f32 v20, v20, v21
  s_cmpk_gt_i32 s69, 0x13
  s_cbranch_scc1 L_p50_3
  s_cmp_gt_i32 s69, L_order_end-L_order-16421
  s_cbranch_scc1 L_p50_1
  s_waitcnt vmcnt(5)
L_p50_1:
  s_waitcnt vmcnt(9)
L_p50_3:
  s_waitcnt vmcnt(10)
  buffer_load_dwordx4 v[88:91], v230, s[32:35], 0 offen nt
  ds_read_b64 v[192:193], v12 offset:20480
  ds_read_b64 v[194:195], v12 offset:20608
  ds_read_b64 v[196:197], v12 offset:21504
  ds_read_b64 v[198:199], v12 offset:21632
  v_dot2_f32_bf16 v22, v185, v60, 0
  v_add_f32_dpp v241, v18, v18 row_ror:8 row_mask:0xf bank_mask:0xc
  v_add_f32_dpp v241, v20, v20 row_ror:8 row_mask:0xf bank_mask:0x3
  v_dot2_f32_bf16 v23, v190, v61, 0
  v_dot2_f32_bf16 v24, v188, v62, 0
  v_dot2_f32_bf16 v25, v191, v63, 0
  v_cvt_f32_i32 v108, v108
  v_cvt_f32_i32 v109, v109
  v_cvt_f32_i32 v110, v110
  v_cvt_f32_i32 v111, v111
  v_pk_mul_f32 v[20:21], v[108:109], v[22:23]
  v_pk_add_f32 v[18:19], v[22:23], v[24:25]
  v_pk_fma_f32 v[20:21], v[110:111], v[24:25], v[20:21]
  v_add_f32 v18, v18, v19
  v_add_f32 v20, v20, v21
  s_cmpk_gt_i32 s69, 0x13
  s_cbranch_scc1 L_p51_3
  s_cmp_gt_i32 s69, L_order_end-L_order-16391
  s_cbranch_scc1 L_p51_2
  s_waitcnt vmcnt(6)
L_p51_2:
  s_waitcnt vmcnt(10)
L_p51_3:
  s_waitcnt vmcnt(11)
  buffer_load_dwordx4 v[92:95], v231, s[32:35], 0 offen nt
  s_cmpk_gt_i32 s69, 0x13
  s_cbranch_scc1 L_p52_3
  s_cmp_gt_i32 s69, L_order_end-L_order-16445
  s_cbranch_scc1 L_p52_0
  s_waitcnt vmcnt(6)
L_p52_0:
  s_waitcnt vmcnt(7)
L_p52_3:
  s_waitcnt vmcnt(11)
  buffer_load_dwordx4 v[96:99], v230, s[32:35], s80 offen nt
L_it20:
  s_waitcnt lgkmcnt(0)
  ds_read_b128 v[52:55], v253 offset:1536
  ds_read_b128 v[56:59], v251 offset:2560
  ds_read_b128 v[60:63], v253 offset:2560
  s_waitcnt vmcnt(8)
  s_mov_b64 exec, 3
  s_add_u32 s44, s78, 0x03030303
  v_msad_u8 v9, s78, v32, 0
  v_msad_u8 v10, s44, v32, 0
  v_msad_u8 v9, s78, v33, v9
  v_msad_u8 v10, s44, v33, v10
  v_msad_u8 v9, s78, v34, v9
  v_msad_u8 v10, s44, v34, v10
  global_store_byte v7, v8, s[30:31]
  global_load_dwordx3 v[32:34], v232, s[30:31] sc1
  v_sub_u32 v9, v9, v10
  v_add_u32_e64 v8, 1, v8
  v_readlane_b32 s66, v9, 0
  v_readlane_b32 s67, v9, 1
  s_add_u32 s78, s78, 0x01010101
  s_mov_b64 exec, -1
  s_lshl1_add_u32 s69, s91, s95
  s_add_u32 s95, s66, s67
  s_add_u32 s69, s69, s95
  v_perm_b32 v189, v194, v192, s56
  v_perm_b32 v194, v194, v192, s57
  v_perm_b32 v192, v195, v193, s56
  v_perm_b32 v195, v195, v193, s57
  v_dot2_f32_bf16 v22, v189, v40, 0
  v_add_f32_dpp v21, v18, v18 row_ror:8 row_mask:0xf bank_mask:0xc
  v_add_f32_dpp v21, v20, v20 row_ror:8 row_mask:0xf bank_mask:0x3
  v_add_f32_dpp v20, v241, v241 row_half_mirror row_mask:0xf bank_mask:0x5
  v_dot2_f32_bf16 v23, v194, v41, 0
  v_add_f32_dpp v20, v21, v21 row_half_mirror row_mask:0xf bank_mask:0xa
  v_dot2_f32_bf16 v24, v192, v42, 0
  v_dot2_f32_bf16 v25, v195, v43, 0
  v_add_f32_dpp v20, v20, v20 quad_perm:[2,3,0,1] row_mask:0xf bank_mask:0xf
  v_cvt_f32_i32 v64, v64
  v_cvt_f32_i32 v65, v65
  v_add_f32_dpp v20, v20, v20 quad_perm:[1,0,3,2] row_mask:0xf bank_mask:0xf
  v_cndmask_b32_e64 v238, v238, v20, s[50:51]
  v_cvt_f32_i32 v66, v66
  v_cvt_f32_i32 v67, v67
  v_pk_mul_f32 v[20:21], v[64:65], v[22:23]
  v_pk_add_f32 v[18:19], v[22:23], v[24:25]
  v_pk_fma_f32 v[20:21], v[66:67], v[24:25], v[20:21]
  v_add_f32 v18, v18, v19
  v_add_f32 v20, v20, v21
  v_perm_b32 v193, v198, v196, s56
  v_perm_b32 v198, v198, v196, s57
  v_perm_b32 v196, v199, v197, s56
  v_perm_b32 v199, v199, v197, s57
  v_dot2_f32_bf16 v22, v193, v44, 0
  v_add_f32_dpp v239, v18, v18 row_ror:8 row_mask:0xf bank_mask:0xc
  v_add_f32_dpp v239, v20, v20 row_ror:8 row_mask:0xf bank_mask:0x3
  v_dot2_f32_bf16 v23, v198, v45, 0
  v_dot2_f32_bf16 v24, v196, v46, 0
  v_dot2_f32_bf16 v25, v199, v47, 0
  v_cvt_f32_i32 v68, v68
  v_cvt_f32_i32 v69, v69
  v_cvt_f32_i32 v70, v70
  v_cvt_f32_i32 v71, v71
  v_pk_mul_f32 v[20:21], v[68:69], v[22:23]
  v_pk_add_f32 v[18:19], v[22:23], v[24:25]
  v_pk_fma_f32 v[20:21], v[70:71], v[24:25], v[20:21]
  v_add_f32 v18, v18, v19
  v_add_f32 v20, v20, v21
  s_cmpk_gt_i32 s69, 0x13
  s_cbranch_scc1 L_p53_3
  s_cmp_gt_i32 s69, L_order_end-L_order-16421
  s_cbranch_scc1 L_p53_1
  s_waitcnt vmcnt(5)
L_p53_1:
  s_waitcnt vmcnt(8)
L_p53_3:
  s_waitcnt vmcnt(9)
  buffer_load_dwordx4 v[100:103], v231, s[32:35], s80 offen nt
  v_dot2_f32_bf16 v22, v189, v48, 0
  v_add_f32_dpp v21, v18, v18 row_ror:8 row_mask:0xf bank_mask:0xc
  v_add_f32_dpp v21, v20, v20 row_ror:8 row_mask:0xf bank_mask:0x3
  v_add_f32_dpp v20, v239, v239 row_half_mirror row_mask:0xf bank_mask:0x5
  v_dot2_f32_bf16 v23, v194, v49, 0
  v_add_f32_dpp v20, v21, v21 row_half_mirror row_mask:0xf bank_mask:0xa
  v_dot2_f32_bf16 v24, v192, v50, 0
  v_dot2_f32_bf16 v25, v195, v51, 0
  v_add_f32_dpp v20, v20, v20 quad_perm:[2,3,0,1] row_mask:0xf bank_mask:0xf
  v_cvt_f32_i32 v72, v72
  v_cvt_f32_i32 v73, v73
  v_add_f32_dpp v20, v20, v20 quad_perm:[1,0,3,2] row_mask:0xf bank_mask:0xf
  v_cndmask_b32_e64 v236, v236, v20, s[52:53]
  v_cvt_f32_i32 v74, v74
  v_cvt_f32_i32 v75, v75
  v_pk_mul_f32 v[20:21], v[72:73], v[22:23]
  v_pk_add_f32 v[18:19], v[22:23], v[24:25]
  v_pk_fma_f32 v[20:21], v[74:75], v[24:25], v[20:21]
  v_add_f32 v18, v18, v19
  v_add_f32 v20, v20, v21
  s_cmpk_gt_i32 s69, 0x13
  s_cbranch_scc1 L_p54_3
  s_cmp_gt_i32 s69, L_order_end-L_order-16391
  s_cbranch_scc1 L_p54_2
  s_waitcnt vmcnt(6)
L_p54_2:
  s_waitcnt vmcnt(9)
L_p54_3:
  s_waitcnt vmcnt(10)
  buffer_load_dwordx4 v[104:107], v230, s[32:35], s3 offen nt
  s_cmpk_gt_i32 s69, 0x13
  s_cbranch_scc1 L_p55_3
  s_cmp_gt_i32 s69, L_order_end-L_order-16445
  s_cbranch_scc1 L_p55_0
  s_waitcnt vmcnt(6)
L_p55_0:
  s_waitcnt vmcnt(7)
L_p55_3:
  s_waitcnt vmcnt(10)
  buffer_load_dwordx4 v[108:111], v231, s[32:35], s3 offen nt
L_it21:
  s_waitcnt lgkmcnt(0)
  ds_read_b128 v[40:43], v252 offset:512
  ds_read_b128 v[44:47], v251 offset:512
  ds_read_b128 v[48:51], v252 offset:1536
  s_waitcnt vmcnt(7)
  s_mov_b64 exec, 3
  s_add_u32 s44, s78, 0x03030303
  v_msad_u8 v9, s78, v36, 0
  v_msad_u8 v10, s44, v36, 0
  v_msad_u8 v9, s78, v37, v9
  v_msad_u8 v10, s44, v37, v10
  v_msad_u8 v9, s78, v38, v9
  v_msad_u8 v10, s44, v38, v10
  global_load_dwordx2 v[26:27], v11, s[30:31] sc1
  global_store_byte v7, v8, s[30:31]
  global_load_dwordx3 v[36:38], v233, s[30:31] sc1
  v_sub_u32 v9, v9, v10
  v_add_u32_e64 v8, 1, v8
  v_readlane_b32 s66, v9, 0
  v_readlane_b32 s67, v9, 1
  s_add_u32 s78, s78, 0x01010101
  s_mov_b64 exec, -1
  s_lshl1_add_u32 s69, s91, s95
  s_add_u32 s95, s66, s67
  s_add_u32 s69, s69, s95
  v_dot2_f32_bf16 v22, v193, v52, 0
  v_add_f32_dpp v240, v18, v18 row_ror:8 row_mask:0xf bank_mask:0xc
  v_add_f32_dpp v240, v20, v20 row_ror:8 row_mask:0xf bank_mask:0x3
  v_dot2_f32_bf16 v23, v198, v53, 0
  v_dot2_f32_bf16 v24, v196, v54, 0
  v_dot2_f32_bf16 v25, v199, v55, 0
  v_cvt_f32_i32 v76, v76
  v_cvt_f32_i32 v77, v77
  v_cvt_f32_i32 v78, v78
  v_cvt_f32_i32 v79, v79
  v_pk_mul_f32 v[20:21], v[76:77], v[22:23]
  v_pk_add_f32 v[18:19], v[22:23], v[24:25]
  v_pk_fma_f32 v[20:21], v[78:79], v[24:25], v[20:21]
  v_add_f32 v18, v18, v19
  v_add_f32 v20, v20, v21
  v_dot2_f32_bf16 v22, v189, v56, 0
  v_add_f32_dpp v21, v18, v18 row_ror:8 row_mask:0xf bank_mask:0xc
  v_add_f32_dpp v21, v20, v20 row_ror:8 row_mask:0xf bank_mask:0x3
  v_add_f32_dpp v20, v240, v240 row_half_mirror row_mask:0xf bank_mask:0x5
  v_dot2_f32_bf16 v23, v194, v57, 0
  v_add_f32_dpp v20, v21, v21 row_half_mirror row_mask:0xf bank_mask:0xa
  v_dot2_f32_bf16 v24, v192, v58, 0
  v_dot2_f32_bf16 v25, v195, v59, 0
  v_add_f32_dpp v20, v20, v20 quad_perm:[2,3,0,1] row_mask:0xf bank_mask:0xf
  v_cvt_f32_i32 v80, v80
  v_cvt_f32_i32 v81, v81
  v_add_f32_dpp v20, v20, v20 quad_perm:[1,0,3,2] row_mask:0xf bank_mask:0xf
  v_cndmask_b32_e64 v237, v237, v20, s[52:53]
  v_cvt_f32_i32 v82, v82
  v_cvt_f32_i32 v83, v83
  v_pk_mul_f32 v[20:21], v[80:81], v[22:23]
  v_pk_add_f32 v[18:19], v[22:23], v[24:25]
  v_pk_fma_f32 v[20:21], v[82:83], v[24:25], v[20:21]
  v_add_f32 v18, v18, v19
  v_add_f32 v20, v20, v21
  s_cmpk_gt_i32 s69, 0x13
  s_cbranch_scc1 L_p56_3
  s_cmp_gt_i32 s69, L_order_end-L_order-16421
  s_cbranch_scc1 L_p56_1
  s_waitcnt vmcnt(6)
L_p56_1:
  s_waitcnt vmcnt(9)
L_p56_3:
  s_waitcnt vmcnt(10)
  buffer_load_dwordx4 v[64:67], v208, s[32:35], s98 offen nt
  ds_read_b64 v[200:201], v12 offset:22528
  ds_read_b64 v[202:203], v12 offset:22656
  ds_read_b64 v[204:205], v12 offset:23552
  ds_read_b64 v[206:207], v12 offset:23680
  v_dot2_f32_bf16 v22, v193, v60, 0
  v_add_f32_dpp v241, v18, v18 row_ror:8 row_mask:0xf bank_mask:0xc
  v_add_f32_dpp v241, v20, v20 row_ror:8 row_mask:0xf bank_mask:0x3
  v_dot2_f32_bf16 v23, v198, v61, 0
  v_dot2_f32_bf16 v24, v196, v62, 0
  v_dot2_f32_bf16 v25, v199, v63, 0
  v_cvt_f32_i32 v84, v84
  v_cvt_f32_i32 v85, v85
  v_cvt_f32_i32 v86, v86
  v_cvt_f32_i32 v87, v87
  v_pk_mul_f32 v[20:21], v[84:85], v[22:23]
  v_pk_add_f32 v[18:19], v[22:23], v[24:25]
  v_pk_fma_f32 v[20:21], v[86:87], v[24:25], v[20:21]
  v_add_f32 v18, v18, v19
  v_add_f32 v20, v20, v21
  s_cmpk_gt_i32 s69, 0x13
  s_cbranch_scc1 L_p57_3
  s_cmp_gt_i32 s69, L_order_end-L_order-16391
  s_cbranch_scc1 L_p57_2
  s_waitcnt vmcnt(7)
L_p57_2:
  s_waitcnt vmcnt(10)
L_p57_3:
  s_waitcnt vmcnt(11)
  buffer_load_dwordx4 v[68:71], v209, s[32:35], s98 offen nt
  s_cmpk_gt_i32 s69, 0x13
  s_cbranch_scc1 L_p58_3
  s_cmp_gt_i32 s69, L_order_end-L_order-16445
  s_cbranch_scc1 L_p58_0
  s_waitcnt vmcnt(7)
L_p58_0:
  s_waitcnt vmcnt(8)
L_p58_3:
  s_waitcnt vmcnt(11)
  buffer_load_dwordx4 v[72:75], v210, s[32:35], s98 offen nt
L_it22:
  s_waitcnt lgkmcnt(0)
  ds_read_b128 v[52:55], v251 offset:1536
  ds_read_b128 v[56:59], v252 offset:2560
  ds_read_b128 v[60:63], v251 offset:2560
  ds_read_b32 v4, v14 offset:16
  s_waitcnt vmcnt(8)
  s_mov_b64 exec, 3
  s_add_u32 s44, s78, 0x03030303
  v_msad_u8 v9, s78, v32, 0
  v_msad_u8 v10, s44, v32, 0
  v_msad_u8 v9, s78, v33, v9
  v_msad_u8 v10, s44, v33, v10
  v_msad_u8 v9, s78, v34, v9
  v_msad_u8 v10, s44, v34, v10
  global_store_byte v7, v8, s[30:31]
  global_load_dwordx3 v[32:34], v234, s[30:31] sc1
  v_sub_u32 v9, v9, v10
  v_add_u32_e64 v8, 1, v8
  v_readlane_b32 s66, v9, 0
  v_readlane_b32 s67, v9, 1
  s_add_u32 s78, s78, 0x01010101
  s_mov_b64 exec, -1
  s_lshl1_add_u32 s69, s91, s95
  s_add_u32 s95, s66, s67
  s_add_u32 s69, s69, s95
  v_perm_b32 v197, v202, v200, s56
  v_perm_b32 v202, v202, v200, s57
  v_perm_b32 v200, v203, v201, s56
  v_perm_b32 v203, v203, v201, s57
  v_dot2_f32_bf16 v22, v197, v40, 0
  v_add_f32_dpp v21, v18, v18 row_ror:8 row_mask:0xf bank_mask:0xc
  v_add_f32_dpp v21, v20, v20 row_ror:8 row_mask:0xf bank_mask:0x3
  v_add_f32_dpp v20, v241, v241 row_half_mirror row_mask:0xf bank_mask:0x5
  v_dot2_f32_bf16 v23, v202, v41, 0
  v_add_f32_dpp v20, v21, v21 row_half_mirror row_mask:0xf bank_mask:0xa
  v_dot2_f32_bf16 v24, v200, v42, 0
  v_dot2_f32_bf16 v25, v203, v43, 0
  v_add_f32_dpp v20, v20, v20 quad_perm:[2,3,0,1] row_mask:0xf bank_mask:0xf
  v_cvt_f32_i32 v88, v88
  v_cvt_f32_i32 v89, v89
  v_add_f32_dpp v20, v20, v20 quad_perm:[1,0,3,2] row_mask:0xf bank_mask:0xf
  v_cndmask_b32_e64 v238, v238, v20, s[52:53]
  v_cvt_f32_i32 v90, v90
  v_cvt_f32_i32 v91, v91
  v_pk_mul_f32 v[20:21], v[88:89], v[22:23]
  v_pk_add_f32 v[18:19], v[22:23], v[24:25]
  v_pk_fma_f32 v[20:21], v[90:91], v[24:25], v[20:21]
  v_add_f32 v18, v18, v19
  v_add_f32 v20, v20, v21
  v_perm_b32 v201, v206, v204, s56
  v_perm_b32 v206, v206, v204, s57
  v_perm_b32 v204, v207, v205, s56
  v_perm_b32 v207, v207, v205, s57
  v_dot2_f32_bf16 v22, v201, v44, 0
  v_add_f32_dpp v239, v18, v18 row_ror:8 row_mask:0xf bank_mask:0xc
  v_add_f32_dpp v239, v20, v20 row_ror:8 row_mask:0xf bank_mask:0x3
  v_dot2_f32_bf16 v23, v206, v45, 0
  v_dot2_f32_bf16 v24, v204, v46, 0
  v_dot2_f32_bf16 v25, v207, v47, 0
  v_cvt_f32_i32 v92, v92
  v_cvt_f32_i32 v93, v93
  v_cvt_f32_i32 v94, v94
  v_cvt_f32_i32 v95, v95
  v_pk_mul_f32 v[20:21], v[92:93], v[22:23]
  v_pk_add_f32 v[18:19], v[22:23], v[24:25]
  v_pk_fma_f32 v[20:21], v[94:95], v[24:25], v[20:21]
  v_add_f32 v18, v18, v19
  v_add_f32 v20, v20, v21
  s_cmpk_gt_i32 s69, 0x13
  s_cbranch_scc1 L_p59_3
  s_cmp_gt_i32 s69, L_order_end-L_order-16421
  s_cbranch_scc1 L_p59_1
  s_waitcnt vmcnt(5)
L_p59_1:
  s_waitcnt vmcnt(9)
L_p59_3:
  s_waitcnt vmcnt(10)
  buffer_load_dwordx4 v[76:79], v211, s[32:35], s98 offen nt
  v_dot2_f32_bf16 v22, v197, v48, 0
  v_add_f32_dpp v21, v18, v18 row_ror:8 row_mask:0xf bank_mask:0xc
  v_add_f32_dpp v21, v20, v20 row_ror:8 row_mask:0xf bank_mask:0x3
  v_add_f32_dpp v20, v239, v239 row_half_mirror row_mask:0xf bank_mask:0x5
  v_dot2_f32_bf16 v23, v202, v49, 0
  v_add_f32_dpp v20, v21, v21 row_half_mirror row_mask:0xf bank_mask:0xa
  v_dot2_f32_bf16 v24, v200, v50, 0
  v_dot2_f32_bf16 v25, v203, v51, 0
  v_add_f32_dpp v20, v20, v20 quad_perm:[2,3,0,1] row_mask:0xf bank_mask:0xf
  v_cvt_f32_i32 v96, v96
  v_cvt_f32_i32 v97, v97
  v_add_f32_dpp v20, v20, v20 quad_perm:[1,0,3,2] row_mask:0xf bank_mask:0xf
  v_cndmask_b32_e64 v236, v236, v20, s[54:55]
  ds_write_b32 v17, v236 offset:0
  v_cvt_f32_i32 v98, v98
  v_cvt_f32_i32 v99, v99
  v_pk_mul_f32 v[20:21], v[96:97], v[22:23]
  v_pk_add_f32 v[18:19], v[22:23], v[24:25]
  v_pk_fma_f32 v[20:21], v[98:99], v[24:25], v[20:21]
  v_add_f32 v18, v18, v19
  v_add_f32 v20, v20, v21
  s_cmpk_gt_i32 s69, 0x13
  s_cbranch_scc1 L_p60_3
  s_cmp_gt_i32 s69, L_order_end-L_order-16391
  s_cbranch_scc1 L_p60_2
  s_waitcnt vmcnt(6)
L_p60_2:
  s_waitcnt vmcnt(10)
L_p60_3:
  s_waitcnt vmcnt(11)
  buffer_load_dwordx4 v[80:83], v212, s[32:35], s98 offen nt
  s_cmpk_gt_i32 s69, 0x13
  s_cbranch_scc1 L_p61_3
  s_cmp_gt_i32 s69, L_order_end-L_order-16445
  s_cbranch_scc1 L_p61_0
  s_waitcnt vmcnt(6)
L_p61_0:
  s_waitcnt vmcnt(7)
L_p61_3:
  s_waitcnt vmcnt(11)
  buffer_load_dwordx4 v[84:87], v213, s[32:35], s98 offen nt
L_it23:
  s_mov_b32 s47, 4
L_fq23:
  s_waitcnt lgkmcnt(0)
  v_readfirstlane_b32 s46, v4
  s_cmp_ge_u32 s46, s47
  s_cbranch_scc1 L_fq23_ok
  s_cmp_eq_u32 s94, 0
  s_cbranch_scc1 L_fq23_ok
  s_sub_u32 s94, s94, 1
  ds_read_b32 v4, v14 offset:16
  s_branch L_fq23
L_fq23_ok:
  ds_read_b128 v[40:43], v248 offset:3584
  ds_read_b128 v[44:47], v249 offset:3584
  ds_read_b128 v[48:51], v250 offset:3584
  s_waitcnt vmcnt(7)
  s_mov_b64 exec, 3
  s_add_u32 s44, s78, 0x03030303
  v_msad_u8 v9, s78, v36, 0
  v_msad_u8 v10, s44, v36, 0
  v_msad_u8 v9, s78, v37, v9
  v_msad_u8 v10, s44, v37, v10
  v_msad_u8 v9, s78, v38, v9
  v_msad_u8 v10, s44, v38, v10
  global_store_byte v7, v8, s[30:31]
  global_load_dwordx3 v[36:38], v235, s[30:31] sc1
  v_sub_u32 v9, v9, v10
  v_add_u32_e64 v8, 1, v8
  v_add3_u32 v10, v26, v27, s58
  v_readlane_b32 s66, v9, 0
  v_readlane_b32 s67, v9, 1
  v_readlane_b32 s91, v10, 0
  s_add_u32 s78, s78, 0x01010101
  s_mov_b64 exec, -1
  s_lshl1_add_u32 s69, s91, s95
  s_add_u32 s95, s66, s67
  s_add_u32 s69, s69, s95
  v_dot2_f32_bf16 v22, v201, v52, 0
  v_add_f32_dpp v240, v18, v18 row_ror:8 row_mask:0xf bank_mask:0xc
  v_add_f32_dpp v240, v20, v20 row_ror:8 row_mask:0xf bank_mask:0x3
  v_dot2_f32_bf16 v23, v206, v53, 0
  v_dot2_f32_bf16 v24, v204, v54, 0
  v_dot2_f32_bf16 v25, v207, v55, 0
  v_cvt_f32_i32 v100, v100
  v_cvt_f32_i32 v101, v101
  v_cvt_f32_i32 v102, v102
  v_cvt_f32_i32 v103, v103
  v_pk_mul_f32 v[20:21], v[100:101], v[22:23]
  v_pk_add_f32 v[18:19], v[22:23], v[24:25]
  v_pk_fma_f32 v[20:21], v[102:103], v[24:25], v[20:21]
  v_add_f32 v18, v18, v19
  v_add_f32 v20, v20, v21
  v_dot2_f32_bf16 v22, v197, v56, 0
  v_add_f32_dpp v21, v18, v18 row_ror:8 row_mask:0xf bank_mask:0xc
  v_add_f32_dpp v21, v20, v20 row_ror:8 row_mask:0xf bank_mask:0x3
  v_add_f32_dpp v20, v240, v240 row_half_mirror row_mask:0xf bank_mask:0x5
  v_dot2_f32_bf16 v23, v202, v57, 0
  v_add_f32_dpp v20, v21, v21 row_half_mirror row_mask:0xf bank_mask:0xa
  v_dot2_f32_bf16 v24, v200, v58, 0
  v_dot2_f32_bf16 v25, v203, v59, 0
  v_add_f32_dpp v20, v20, v20 quad_perm:[2,3,0,1] row_mask:0xf bank_mask:0xf
  v_cvt_f32_i32 v104, v104
  v_cvt_f32_i32 v105, v105
  v_add_f32_dpp v20, v20, v20 quad_perm:[1,0,3,2] row_mask:0xf bank_mask:0xf
  v_cndmask_b32_e64 v237, v237, v20, s[54:55]
  ds_write_b32 v17, v237 offset:3072
  v_cvt_f32_i32 v106, v106
  v_cvt_f32_i32 v107, v107
  v_pk_mul_f32 v[20:21], v[104:105], v[22:23]
  v_pk_add_f32 v[18:19], v[22:23], v[24:25]
  v_pk_fma_f32 v[20:21], v[106:107], v[24:25], v[20:21]
  v_add_f32 v18, v18, v19
  v_add_f32 v20, v20, v21
  s_cmpk_gt_i32 s69, 0x13
  s_cbranch_scc1 L_p62_3
  s_cmp_gt_i32 s69, L_order_end-L_order-16421
  s_cbranch_scc1 L_p62_1
  s_waitcnt vmcnt(5)
L_p62_1:
  s_waitcnt vmcnt(8)
L_p62_3:
  s_waitcnt vmcnt(9)
  buffer_load_dwordx4 v[88:91], v214, s[32:35], s98 offen nt
  v_dot2_f32_bf16 v22, v201, v60, 0
  v_add_f32_dpp v241, v18, v18 row_ror:8 row_mask:0xf bank_mask:0xc
  v_add_f32_dpp v241, v20, v20 row_ror:8 row_mask:0xf bank_mask:0x3
  v_dot2_f32_bf16 v23, v206, v61, 0
  v_dot2_f32_bf16 v24, v204, v62, 0
  v_dot2_f32_bf16 v25, v207, v63, 0
  v_cvt_f32_i32 v108, v108
  v_cvt_f32_i32 v109, v109
  v_cvt_f32_i32 v110, v110
  v_cvt_f32_i32 v111, v111
  v_pk_mul_f32 v[20:21], v[108:109], v[22:23]
  v_pk_add_f32 v[18:19], v[22:23], v[24:25]
  v_pk_fma_f32 v[20:21], v[110:111], v[24:25], v[20:21]
  v_add_f32 v18, v18, v19
  v_add_f32 v20, v20, v21
  s_cmpk_gt_i32 s69, 0x13
  s_cbranch_scc1 L_p63_3
  s_cmp_gt_i32 s69, L_order_end-L_order-16391
  s_cbranch_scc1 L_p63_2
  s_waitcnt vmcnt(6)
L_p63_2:
  s_waitcnt vmcnt(9)
L_p63_3:
  s_waitcnt vmcnt(10)
  buffer_load_dwordx4 v[92:95], v215, s[32:35], s98 offen nt
  s_cmpk_gt_i32 s69, 0x13
  s_cbranch_scc1 L_p64_3
  s_cmp_gt_i32 s69, L_order_end-L_order-16445
  s_cbranch_scc1 L_p64_0
  s_waitcnt vmcnt(6)
L_p64_0:
  s_waitcnt vmcnt(7)
L_p64_3:
  s_waitcnt vmcnt(10)
  buffer_load_dwordx4 v[96:99], v216, s[32:35], s98 offen nt
  s_nop 0
  v_add_f32_dpp v21, v18, v18 row_ror:8 row_mask:0xf bank_mask:0xc
  v_add_f32_dpp v21, v20, v20 row_ror:8 row_mask:0xf bank_mask:0x3
  v_add_f32_dpp v20, v241, v241 row_half_mirror row_mask:0xf bank_mask:0x5
  s_nop 0
  v_add_f32_dpp v20, v21, v21 row_half_mirror row_mask:0xf bank_mask:0xa
  s_nop 1
  v_add_f32_dpp v20, v20, v20 quad_perm:[2,3,0,1] row_mask:0xf bank_mask:0xf
  s_nop 1
  v_add_f32_dpp v20, v20, v20 quad_perm:[1,0,3,2] row_mask:0xf bank_mask:0xf
  v_cndmask_b32_e64 v238, v238, v20, s[54:55]
  ds_write_b32 v17, v238 offset:6144
  v_mov_b32_e64 v9, 3
  ds_write_b32 v6, v9 offset:0
  ds_read_b128 v[52:55], v251 offset:3584
  ds_read_b128 v[56:59], v252 offset:3584
  ds_read_b128 v[60:63], v253 offset:3584
  s_movk_i32 s59, 3072
  s_mov_b32 s43, 3
  s_movk_i32 s101, 9216
  s_mov_b32 s34, 1572864
  s_add_u32 s32, s32, s98
  s_addc_u32 s33, s33, 0
  s_mov_b32 s68, 4
  s_lshl_b32 s44, s68, 2
  s_lshr_b64 s[64:65], s[96:97], s44
  s_and_b32 s64, s64, 15
  s_lshl4_add_u32 s68, s68, s64
  s_mul_i32 s44, s68, 1572864
  s_add_u32 s36, s6, s44
  s_addc_u32 s37, s7, 0
.p2align 6
L_k:
  s_add_u32 s44, s43, 2
  s_min_u32 s47, s44, 16
  s_addk_i32 s59, 1024
  s_cmpk_eq_u32 s59, 4096
  s_cselect_b32 s59, 0, s59
  s_waitcnt lgkmcnt(0)
  s_waitcnt vmcnt(8)
  s_mov_b64 exec, 3
  s_add_u32 s44, s78, 0x03030303
  v_msad_u8 v9, s78, v32, 0
  v_msad_u8 v10, s44, v32, 0
  v_msad_u8 v9, s78, v33, v9
  v_msad_u8 v10, s44, v33, v10
  v_msad_u8 v9, s78, v34, v9
  v_msad_u8 v10, s44, v34, v10
  global_store_byte v7, v8, s[30:31]
  global_load_dwordx3 v[32:34], v232, s[30:31] sc1
  v_sub_u32 v9, v9, v10
  v_add_u32 v8, 1, v8
  v_readlane_b32 s66, v9, 0
  v_readlane_b32 s67, v9, 1
  s_add_u32 s78, s78, 0x01010101
  s_mov_b64 exec, -1
  s_lshl1_add_u32 s69, s91, s95
  s_add_u32 s95, s66, s67
  s_add_u32 s69, s69, s95
  v_dot2_f32_bf16 v22, v13, v40, 0
  v_dot2_f32_bf16 v23, v114, v41, 0
  v_dot2_f32_bf16 v24, v112, v42, 0
  v_dot2_f32_bf16 v25, v115, v43, 0
  v_cvt_f32_i32 v64, v64
  v_cvt_f32_i32 v65, v65
  v_cvt_f32_i32 v66, v66
  v_cvt_f32_i32 v67, v67
  v_pk_mul_f32 v[20:21], v[64:65], v[22:23]
  v_pk_add_f32 v[18:19], v[22:23], v[24:25]
  v_pk_fma_f32 v[20:21], v[66:67], v[24:25], v[20:21]
  v_add_f32 v18, v18, v19
  v_add_f32 v20, v20, v21
  s_cmpk_gt_i32 s69, 0x1d
  s_cbranch_scc1 L_p65_3
  s_cmp_gt_i32 s69, L_order_end-L_order-16411
  s_cbranch_scc1 L_p65_1
  s_waitcnt vmcnt(5)
L_p65_1:
  s_waitcnt vmcnt(8)
L_p65_3:
  s_waitcnt vmcnt(9)
  buffer_load_dwordx4 v[100:103], v217, s[32:35], 0 offen nt
  v_dot2_f32_bf16 v22, v113, v48, 0
  v_add_f32_dpp v239, v18, v18 row_ror:8 row_mask:0xf bank_mask:0xc
  v_add_f32_dpp v239, v20, v20 row_ror:8 row_mask:0xf bank_mask:0x3
  v_dot2_f32_bf16 v23, v118, v49, 0
  v_dot2_f32_bf16 v24, v116, v50, 0
  v_dot2_f32_bf16 v25, v119, v51, 0
  v_cvt_f32_i32 v68, v68
  v_cvt_f32_i32 v69, v69
  v_cvt_f32_i32 v70, v70
  v_cvt_f32_i32 v71, v71
  v_pk_mul_f32 v[20:21], v[68:69], v[22:23]
  v_pk_add_f32 v[18:19], v[22:23], v[24:25]
  v_pk_fma_f32 v[20:21], v[70:71], v[24:25], v[20:21]
  v_add_f32 v18, v18, v19
  v_add_f32 v20, v20, v21
  s_cmpk_gt_i32 s69, 0x1d
  s_cbranch_scc1 L_p66_3
  s_cmp_gt_i32 s69, L_order_end-L_order-16381
  s_cbranch_scc1 L_p66_2
  s_waitcnt vmcnt(6)
L_p66_2:
  s_waitcnt vmcnt(9)
L_p66_3:
  s_waitcnt vmcnt(10)
  buffer_load_dwordx4 v[104:107], v218, s[32:35], 0 offen nt
  v_dot2_f32_bf16 v22, v117, v44, 0
  v_add_f32_dpp v21, v18, v18 row_ror:8 row_mask:0xf bank_mask:0xc
  v_add_f32_dpp v21, v20, v20 row_ror:8 row_mask:0xf bank_mask:0x3
  v_add_f32_dpp v20, v239, v239 row_half_mirror row_mask:0xf bank_mask:0x5
  v_dot2_f32_bf16 v23, v122, v45, 0
  v_add_f32_dpp v20, v21, v21 row_half_mirror row_mask:0xf bank_mask:0xa
  v_dot2_f32_bf16 v24, v120, v46, 0
  v_dot2_f32_bf16 v25, v123, v47, 0
  v_add_f32_dpp v20, v20, v20 quad_perm:[2,3,0,1] row_mask:0xf bank_mask:0xf
  v_cvt_f32_i32 v72, v72
  v_cvt_f32_i32 v73, v73
  v_add_f32_dpp v20, v20, v20 quad_perm:[1,0,3,2] row_mask:0xf bank_mask:0xf
  v_cndmask_b32_e64 v236, v236, v20, s[48:49]
  v_cvt_f32_i32 v74, v74
  v_cvt_f32_i32 v75, v75
  v_pk_mul_f32 v[20:21], v[72:73], v[22:23]
  v_pk_add_f32 v[18:19], v[22:23], v[24:25]
  v_pk_fma_f32 v[20:21], v[74:75], v[24:25], v[20:21]
  v_add_f32 v18, v18, v19
  v_add_f32 v20, v20, v21
  s_cmpk_gt_i32 s69, 0x1d
  s_cbranch_scc1 L_p67_3
  s_cmp_gt_i32 s69, L_order_end-L_order-16435
  s_cbranch_scc1 L_p67_0
  s_waitcnt vmcnt(6)
L_p67_0:
  s_waitcnt vmcnt(7)
L_p67_3:
  s_waitcnt vmcnt(10)
  buffer_load_dwordx4 v[108:111], v219, s[32:35], 0 offen nt
  s_waitcnt vmcnt(8)
  s_mov_b64 exec, 3
  s_add_u32 s44, s78, 0x03030303
  v_msad_u8 v9, s78, v36, 0
  v_msad_u8 v10, s44, v36, 0
  v_msad_u8 v9, s78, v37, v9
  v_msad_u8 v10, s44, v37, v10
  v_msad_u8 v9, s78, v38, v9
  v_msad_u8 v10, s44, v38, v10
  global_store_byte v7, v8, s[30:31]
  global_load_dwordx3 v[36:38], v233, s[30:31] sc1
  v_sub_u32 v9, v9, v10
  v_add_u32 v8, 1, v8
  v_readlane_b32 s66, v9, 0
  v_readlane_b32 s67, v9, 1
  s_add_u32 s78, s78, 0x01010101
  s_mov_b64 exec, -1
  s_lshl1_add_u32 s69, s91, s95
  s_add_u32 s95, s66, s67
  s_add_u32 s69, s69, s95
  v_dot2_f32_bf16 v22, v121, v40, 0
  v_add_f32_dpp v239, v18, v18 row_ror:8 row_mask:0xf bank_mask:0xc
  v_add_f32_dpp v239, v20, v20 row_ror:8 row_mask:0xf bank_mask:0x3
  v_dot2_f32_bf16 v23, v126, v41, 0
  v_dot2_f32_bf16 v24, v124, v42, 0
  v_dot2_f32_bf16 v25, v127, v43, 0
  v_cvt_f32_i32 v76, v76
  v_cvt_f32_i32 v77, v77
  v_cvt_f32_i32 v78, v78
  v_cvt_f32_i32 v79, v79
  v_pk_mul_f32 v[20:21], v[76:77], v[22:23]
  v_pk_add_f32 v[18:19], v[22:23], v[24:25]
  v_pk_fma_f32 v[20:21], v[78:79], v[24:25], v[20:21]
  v_add_f32 v18, v18, v19
  v_add_f32 v20, v20, v21
  s_cmpk_gt_i32 s69, 0x1d
  s_cbranch_scc1 L_p68_3
  s_cmp_gt_i32 s69, L_order_end-L_order-16411
  s_cbranch_scc1 L_p68_1
  s_waitcnt vmcnt(5)
L_p68_1:
  s_waitcnt vmcnt(8)
L_p68_3:
  s_waitcnt vmcnt(9)
  buffer_load_dwordx4 v[64:67], v220, s[32:35], 0 offen nt
  v_dot2_f32_bf16 v22, v125, v56, 0
  v_add_f32_dpp v21, v18, v18 row_ror:8 row_mask:0xf bank_mask:0xc
  v_add_f32_dpp v21, v20, v20 row_ror:8 row_mask:0xf bank_mask:0x3
  v_add_f32_dpp v20, v239, v239 row_half_mirror row_mask:0xf bank_mask:0x5
  v_dot2_f32_bf16 v23, v130, v57, 0
  v_add_f32_dpp v20, v21, v21 row_half_mirror row_mask:0xf bank_mask:0xa
  v_dot2_f32_bf16 v24, v128, v58, 0
  v_dot2_f32_bf16 v25, v131, v59, 0
  v_add_f32_dpp v20, v20, v20 quad_perm:[2,3,0,1] row_mask:0xf bank_mask:0xf
  v_cvt_f32_i32 v80, v80
  v_cvt_f32_i32 v81, v81
  v_add_f32_dpp v20, v20, v20 quad_perm:[1,0,3,2] row_mask:0xf bank_mask:0xf
  v_cndmask_b32_e64 v236, v236, v20, s[50:51]
  v_cvt_f32_i32 v82, v82
  v_cvt_f32_i32 v83, v83
  v_pk_mul_f32 v[20:21], v[80:81], v[22:23]
  v_pk_add_f32 v[18:19], v[22:23], v[24:25]
  v_pk_fma_f32 v[20:21], v[82:83], v[24:25], v[20:21]
  v_add_f32 v18, v18, v19
  v_add_f32 v20, v20, v21
  s_cmpk_gt_i32 s69, 0x1d
  s_cbranch_scc1 L_p69_3
  s_cmp_gt_i32 s69, L_order_end-L_order-16381
  s_cbranch_scc1 L_p69_2
  s_waitcnt vmcnt(6)
L_p69_2:
  s_waitcnt vmcnt(9)
L_p69_3:
  s_waitcnt vmcnt(10)
  buffer_load_dwordx4 v[68:71], v221, s[32:35], 0 offen nt
  v_dot2_f32_bf16 v22, v129, v52, 0
  v_add_f32_dpp v239, v18, v18 row_ror:8 row_mask:0xf bank_mask:0xc
  v_add_f32_dpp v239, v20, v20 row_ror:8 row_mask:0xf bank_mask:0x3
  v_dot2_f32_bf16 v23, v134, v53, 0
  v_dot2_f32_bf16 v24, v132, v54, 0
  v_dot2_f32_bf16 v25, v135, v55, 0
  v_cvt_f32_i32 v84, v84
  v_cvt_f32_i32 v85, v85
  v_cvt_f32_i32 v86, v86
  v_cvt_f32_i32 v87, v87
  v_pk_mul_f32 v[20:21], v[84:85], v[22:23]
  v_pk_add_f32 v[18:19], v[22:23], v[24:25]
  v_pk_fma_f32 v[20:21], v[86:87], v[24:25], v[20:21]
  v_add_f32 v18, v18, v19
  v_add_f32 v20, v20, v21
  s_cmpk_gt_i32 s69, 0x1d
  s_cbranch_scc1 L_p70_3
  s_cmp_gt_i32 s69, L_order_end-L_order-16435
  s_cbranch_scc1 L_p70_0
  s_waitcnt vmcnt(6)
L_p70_0:
  s_waitcnt vmcnt(7)
L_p70_3:
  s_waitcnt vmcnt(10)
  buffer_load_dwordx4 v[72:75], v222, s[32:35], 0 offen nt
  s_waitcnt vmcnt(8)
  s_mov_b64 exec, 3
  s_add_u32 s44, s78, 0x03030303
  v_msad_u8 v9, s78, v32, 0
  v_msad_u8 v10, s44, v32, 0
  v_msad_u8 v9, s78, v33, v9
  v_msad_u8 v10, s44, v33, v10
  v_msad_u8 v9, s78, v34, v9
  v_msad_u8 v10, s44, v34, v10
  global_store_byte v7, v8, s[30:31]
  global_load_dwordx3 v[32:34], v234, s[30:31] sc1
  v_sub_u32 v9, v9, v10
  v_add_u32 v8, 1, v8
  v_readlane_b32 s66, v9, 0
  v_readlane_b32 s67, v9, 1
  s_add_u32 s78, s78, 0x01010101
  s_mov_b64 exec, -1
  s_lshl1_add_u32 s69, s91, s95
  s_add_u32 s95, s66, s67
  s_add_u32 s69, s69, s95
  v_dot2_f32_bf16 v22, v133, v60, 0
  v_add_f32_dpp v21, v18, v18 row_ror:8 row_mask:0xf bank_mask:0xc
  v_add_f32_dpp v21, v20, v20 row_ror:8 row_mask:0xf bank_mask:0x3
  v_add_f32_dpp v20, v239, v239 row_half_mirror row_mask:0xf bank_mask:0x5
  v_dot2_f32_bf16 v23, v138, v61, 0
  v_add_f32_dpp v20, v21, v21 row_half_mirror row_mask:0xf bank_mask:0xa
  v_dot2_f32_bf16 v24, v136, v62, 0
  v_dot2_f32_bf16 v25, v139, v63, 0
  v_add_f32_dpp v20, v20, v20 quad_perm:[2,3,0,1] row_mask:0xf bank_mask:0xf
  v_cvt_f32_i32 v88, v88
  v_cvt_f32_i32 v89, v89
  v_add_f32_dpp v20, v20, v20 quad_perm:[1,0,3,2] row_mask:0xf bank_mask:0xf
  v_cndmask_b32_e64 v236, v236, v20, s[52:53]
  v_cvt_f32_i32 v90, v90
  v_cvt_f32_i32 v91, v91
  v_pk_mul_f32 v[20:21], v[88:89], v[22:23]
  v_pk_add_f32 v[18:19], v[22:23], v[24:25]
  v_pk_fma_f32 v[20:21], v[90:91], v[24:25], v[20:21]
  v_add_f32 v18, v18, v19
  v_add_f32 v20, v20, v21
  s_cmpk_gt_i32 s69, 0x1d
  s_cbranch_scc1 L_p71_3
  s_cmp_gt_i32 s69, L_order_end-L_order-16411
  s_cbranch_scc1 L_p71_1
  s_waitcnt vmcnt(5)
L_p71_1:
  s_waitcnt vmcnt(8)
L_p71_3:
  s_waitcnt vmcnt(9)
  buffer_load_dwordx4 v[76:79], v223, s[32:35], 0 offen nt
  v_dot2_f32_bf16 v22, v137, v56, 0
  v_add_f32_dpp v239, v18, v18 row_ror:8 row_mask:0xf bank_mask:0xc
  v_add_f32_dpp v239, v20, v20 row_ror:8 row_mask:0xf bank_mask:0x3
  v_dot2_f32_bf16 v23, v142, v57, 0
  v_dot2_f32_bf16 v24, v140, v58, 0
  v_dot2_f32_bf16 v25, v143, v59, 0
  v_cvt_f32_i32 v92, v92
  v_cvt_f32_i32 v93, v93
  v_cvt_f32_i32 v94, v94
  v_cvt_f32_i32 v95, v95
  v_pk_mul_f32 v[20:21], v[92:93], v[22:23]
  v_pk_add_f32 v[18:19], v[22:23], v[24:25]
  v_pk_fma_f32 v[20:21], v[94:95], v[24:25], v[20:21]
  v_add_f32 v18, v18, v19
  v_add_f32 v20, v20, v21
  s_cmpk_gt_i32 s69, 0x1d
  s_cbranch_scc1 L_p72_3
  s_cmp_gt_i32 s69, L_order_end-L_order-16381
  s_cbranch_scc1 L_p72_2
  s_waitcnt vmcnt(6)
L_p72_2:
  s_waitcnt vmcnt(9)
L_p72_3:
  s_waitcnt vmcnt(10)
  buffer_load_dwordx4 v[80:83], v224, s[32:35], 0 offen nt
  v_dot2_f32_bf16 v22, v141, v44, 0
  v_add_f32_dpp v21, v18, v18 row_ror:8 row_mask:0xf bank_mask:0xc
  v_add_f32_dpp v21, v20, v20 row_ror:8 row_mask:0xf bank_mask:0x3
  v_add_f32_dpp v20, v239, v239 row_half_mirror row_mask:0xf bank_mask:0x5
  v_dot2_f32_bf16 v23, v146, v45, 0
  v_add_f32_dpp v20, v21, v21 row_half_mirror row_mask:0xf bank_mask:0xa
  v_dot2_f32_bf16 v24, v144, v46, 0
  v_dot2_f32_bf16 v25, v147, v47, 0
  v_add_f32_dpp v20, v20, v20 quad_perm:[2,3,0,1] row_mask:0xf bank_mask:0xf
  v_cvt_f32_i32 v96, v96
  v_cvt_f32_i32 v97, v97
  v_add_f32_dpp v20, v20, v20 quad_perm:[1,0,3,2] row_mask:0xf bank_mask:0xf
  v_cndmask_b32_e64 v236, v236, v20, s[54:55]
  v_add_u32_e64 v2, s101, v15
  ds_write_b32 v2, v236
  v_cvt_f32_i32 v98, v98
  v_cvt_f32_i32 v99, v99
  v_pk_mul_f32 v[20:21], v[96:97], v[22:23]
  v_pk_add_f32 v[18:19], v[22:23], v[24:25]
  v_pk_fma_f32 v[20:21], v[98:99], v[24:25], v[20:21]
  v_add_f32 v18, v18, v19
  v_add_f32 v20, v20, v21
  s_cmpk_gt_i32 s69, 0x1d
  s_cbranch_scc1 L_p73_3
  s_cmp_gt_i32 s69, L_order_end-L_order-16435
  s_cbranch_scc1 L_p73_0
  s_waitcnt vmcnt(6)
L_p73_0:
  s_waitcnt vmcnt(7)
L_p73_3:
  s_waitcnt vmcnt(10)
  buffer_load_dwordx4 v[84:87], v225, s[32:35], 0 offen nt
  s_waitcnt vmcnt(8)
  s_mov_b64 exec, 3
  s_add_u32 s44, s78, 0x03030303
  v_msad_u8 v9, s78, v36, 0
  v_msad_u8 v10, s44, v36, 0
  v_msad_u8 v9, s78, v37, v9
  v_msad_u8 v10, s44, v37, v10
  v_msad_u8 v9, s78, v38, v9
  v_msad_u8 v10, s44, v38, v10
  global_store_byte v7, v8, s[30:31]
  global_load_dwordx3 v[36:38], v235, s[30:31] sc1
  v_sub_u32 v9, v9, v10
  v_add_u32 v8, 1, v8
  v_readlane_b32 s66, v9, 0
  v_readlane_b32 s67, v9, 1
  s_add_u32 s78, s78, 0x01010101
  s_mov_b64 exec, -1
  s_lshl1_add_u32 s69, s91, s95
  s_add_u32 s95, s66, s67
  s_add_u32 s69, s69, s95
  v_dot2_f32_bf16 v22, v145, v40, 0
  v_add_f32_dpp v239, v18, v18 row_ror:8 row_mask:0xf bank_mask:0xc
  v_add_f32_dpp v239, v20, v20 row_ror:8 row_mask:0xf bank_mask:0x3
  v_dot2_f32_bf16 v23, v150, v41, 0
  v_dot2_f32_bf16 v24, v148, v42, 0
  v_dot2_f32_bf16 v25, v151, v43, 0
  v_cvt_f32_i32 v100, v100
  v_cvt_f32_i32 v101, v101
  v_cvt_f32_i32 v102, v102
  v_cvt_f32_i32 v103, v103
  v_pk_mul_f32 v[20:21], v[100:101], v[22:23]
  v_pk_add_f32 v[18:19], v[22:23], v[24:25]
  v_pk_fma_f32 v[20:21], v[102:103], v[24:25], v[20:21]
  v_add_f32 v18, v18, v19
  v_add_f32 v20, v20, v21
  s_cmpk_gt_i32 s69, 0x1d
  s_cbranch_scc1 L_p74_3
  s_cmp_gt_i32 s69, L_order_end-L_order-16411
  s_cbranch_scc1 L_p74_1
  s_waitcnt vmcnt(5)
L_p74_1:
  s_waitcnt vmcnt(8)
L_p74_3:
  s_waitcnt vmcnt(9)
  buffer_load_dwordx4 v[88:91], v226, s[32:35], 0 offen nt
  v_dot2_f32_bf16 v22, v149, v48, 0
  v_add_f32_dpp v21, v18, v18 row_ror:8 row_mask:0xf bank_mask:0xc
  v_add_f32_dpp v21, v20, v20 row_ror:8 row_mask:0xf bank_mask:0x3
  v_add_f32_dpp v20, v239, v239 row_half_mirror row_mask:0xf bank_mask:0x5
  v_dot2_f32_bf16 v23, v154, v49, 0
  v_add_f32_dpp v20, v21, v21 row_half_mirror row_mask:0xf bank_mask:0xa
  v_dot2_f32_bf16 v24, v152, v50, 0
  v_dot2_f32_bf16 v25, v155, v51, 0
  v_add_f32_dpp v20, v20, v20 quad_perm:[2,3,0,1] row_mask:0xf bank_mask:0xf
  v_cvt_f32_i32 v104, v104
  v_cvt_f32_i32 v105, v105
  v_add_f32_dpp v20, v20, v20 quad_perm:[1,0,3,2] row_mask:0xf bank_mask:0xf
  v_cndmask_b32_e64 v236, v236, v20, s[48:49]
  v_cvt_f32_i32 v106, v106
  v_cvt_f32_i32 v107, v107
  v_pk_mul_f32 v[20:21], v[104:105], v[22:23]
  v_pk_add_f32 v[18:19], v[22:23], v[24:25]
  v_pk_fma_f32 v[20:21], v[106:107], v[24:25], v[20:21]
  v_add_f32 v18, v18, v19
  v_add_f32 v20, v20, v21
  s_cmpk_gt_i32 s69, 0x1d
  s_cbranch_scc1 L_p75_3
  s_cmp_gt_i32 s69, L_order_end-L_order-16381
  s_cbranch_scc1 L_p75_2
  s_waitcnt vmcnt(6)
L_p75_2:
  s_waitcnt vmcnt(9)
L_p75_3:
  s_waitcnt vmcnt(10)
  buffer_load_dwordx4 v[92:95], v227, s[32:35], 0 offen nt
  v_dot2_f32_bf16 v22, v153, v44, 0
  v_add_f32_dpp v239, v18, v18 row_ror:8 row_mask:0xf bank_mask:0xc
  v_add_f32_dpp v239, v20, v20 row_ror:8 row_mask:0xf bank_mask:0x3
  v_dot2_f32_bf16 v23, v158, v45, 0
  v_dot2_f32_bf16 v24, v156, v46, 0
  v_dot2_f32_bf16 v25, v159, v47, 0
  v_cvt_f32_i32 v108, v108
  v_cvt_f32_i32 v109, v109
  v_cvt_f32_i32 v110, v110
  v_cvt_f32_i32 v111, v111
  v_pk_mul_f32 v[20:21], v[108:109], v[22:23]
  v_pk_add_f32 v[18:19], v[22:23], v[24:25]
  v_pk_fma_f32 v[20:21], v[110:111], v[24:25], v[20:21]
  v_add_f32 v18, v18, v19
  v_add_f32 v20, v20, v21
  s_cmpk_gt_i32 s69, 0x1d
  s_cbranch_scc1 L_p76_3
  s_cmp_gt_i32 s69, L_order_end-L_order-16435
  s_cbranch_scc1 L_p76_0
  s_waitcnt vmcnt(6)
L_p76_0:
  s_waitcnt vmcnt(7)
L_p76_3:
  s_waitcnt vmcnt(10)
  buffer_load_dwordx4 v[96:99], v228, s[32:35], 0 offen nt
  s_waitcnt vmcnt(8)
  s_mov_b64 exec, 3
  s_add_u32 s44, s78, 0x03030303
  v_msad_u8 v9, s78, v32, 0
  v_msad_u8 v10, s44, v32, 0
  v_msad_u8 v9, s78, v33, v9
  v_msad_u8 v10, s44, v33, v10
  v_msad_u8 v9, s78, v34, v9
  v_msad_u8 v10, s44, v34, v10
  global_store_byte v7, v8, s[30:31]
  global_load_dwordx3 v[32:34], v232, s[30:31] sc1
  v_sub_u32 v9, v9, v10
  v_add_u32 v8, 1, v8
  v_readlane_b32 s66, v9, 0
  v_readlane_b32 s67, v9, 1
  s_add_u32 s78, s78, 0x01010101
  s_mov_b64 exec, -1
  s_lshl1_add_u32 s69, s91, s95
  s_add_u32 s95, s66, s67
  s_add_u32 s69, s69, s95
  v_dot2_f32_bf16 v22, v157, v60, 0
  v_add_f32_dpp v21, v18, v18 row_ror:8 row_mask:0xf bank_mask:0xc
  v_add_f32_dpp v21, v20, v20 row_ror:8 row_mask:0xf bank_mask:0x3
  v_add_f32_dpp v20, v239, v239 row_half_mirror row_mask:0xf bank_mask:0x5
  v_dot2_f32_bf16 v23, v162, v61, 0
  v_add_f32_dpp v20, v21, v21 row_half_mirror row_mask:0xf bank_mask:0xa
  v_dot2_f32_bf16 v24, v160, v62, 0
  v_dot2_f32_bf16 v25, v163, v63, 0
  v_add_f32_dpp v20, v20, v20 quad_perm:[2,3,0,1] row_mask:0xf bank_mask:0xf
  v_cvt_f32_i32 v64, v64
  v_cvt_f32_i32 v65, v65
  v_add_f32_dpp v20, v20, v20 quad_perm:[1,0,3,2] row_mask:0xf bank_mask:0xf
  v_cndmask_b32_e64 v236, v236, v20, s[50:51]
  v_cvt_f32_i32 v66, v66
  v_cvt_f32_i32 v67, v67
  v_pk_mul_f32 v[20:21], v[64:65], v[22:23]
  v_pk_add_f32 v[18:19], v[22:23], v[24:25]
  v_pk_fma_f32 v[20:21], v[66:67], v[24:25], v[20:21]
  v_add_f32 v18, v18, v19
  v_add_f32 v20, v20, v21
  s_cmpk_gt_i32 s69, 0x1d
  s_cbranch_scc1 L_p77_3
  s_cmp_gt_i32 s69, L_order_end-L_order-16411
  s_cbranch_scc1 L_p77_1
  s_waitcnt vmcnt(5)
L_p77_1:
  s_waitcnt vmcnt(8)
L_p77_3:
  s_waitcnt vmcnt(9)
  buffer_load_dwordx4 v[100:103], v229, s[32:35], 0 offen nt
  v_dot2_f32_bf16 v22, v161, v56, 0
  v_add_f32_dpp v239, v18, v18 row_ror:8 row_mask:0xf bank_mask:0xc
  v_add_f32_dpp v239, v20, v20 row_ror:8 row_mask:0xf bank_mask:0x3
  v_dot2_f32_bf16 v23, v166, v57, 0
  v_dot2_f32_bf16 v24, v164, v58, 0
  v_dot2_f32_bf16 v25, v167, v59, 0
  v_cvt_f32_i32 v68, v68
  v_cvt_f32_i32 v69, v69
  v_cvt_f32_i32 v70, v70
  v_cvt_f32_i32 v71, v71
  v_pk_mul_f32 v[20:21], v[68:69], v[22:23]
  v_pk_add_f32 v[18:19], v[22:23], v[24:25]
  v_pk_fma_f32 v[20:21], v[70:71], v[24:25], v[20:21]
  v_add_f32 v18, v18, v19
  v_add_f32 v20, v20, v21
  s_cmpk_gt_i32 s69, 0x1d
  s_cbranch_scc1 L_p78_3
  s_cmp_gt_i32 s69, L_order_end-L_order-16381
  s_cbranch_scc1 L_p78_2
  s_waitcnt vmcnt(6)
L_p78_2:
  s_waitcnt vmcnt(9)
L_p78_3:
  s_waitcnt vmcnt(10)
  buffer_load_dwordx4 v[104:107], v230, s[32:35], 0 offen nt
  v_dot2_f32_bf16 v22, v165, v52, 0
  v_add_f32_dpp v21, v18, v18 row_ror:8 row_mask:0xf bank_mask:0xc
  v_add_f32_dpp v21, v20, v20 row_ror:8 row_mask:0xf bank_mask:0x3
  v_add_f32_dpp v20, v239, v239 row_half_mirror row_mask:0xf bank_mask:0x5
  v_dot2_f32_bf16 v23, v170, v53, 0
  v_add_f32_dpp v20, v21, v21 row_half_mirror row_mask:0xf bank_mask:0xa
  v_dot2_f32_bf16 v24, v168, v54, 0
  v_dot2_f32_bf16 v25, v171, v55, 0
  v_add_f32_dpp v20, v20, v20 quad_perm:[2,3,0,1] row_mask:0xf bank_mask:0xf
  v_cvt_f32_i32 v72, v72
  v_cvt_f32_i32 v73, v73
  v_add_f32_dpp v20, v20, v20 quad_perm:[1,0,3,2] row_mask:0xf bank_mask:0xf
  v_cndmask_b32_e64 v236, v236, v20, s[52:53]
  v_cvt_f32_i32 v74, v74
  v_cvt_f32_i32 v75, v75
  v_pk_mul_f32 v[20:21], v[72:73], v[22:23]
  v_pk_add_f32 v[18:19], v[22:23], v[24:25]
  v_pk_fma_f32 v[20:21], v[74:75], v[24:25], v[20:21]
  v_add_f32 v18, v18, v19
  v_add_f32 v20, v20, v21
  s_cmpk_gt_i32 s69, 0x1d
  s_cbranch_scc1 L_p79_3
  s_cmp_gt_i32 s69, L_order_end-L_order-16435
  s_cbranch_scc1 L_p79_0
  s_waitcnt vmcnt(6)
L_p79_0:
  s_waitcnt vmcnt(7)
L_p79_3:
  s_waitcnt vmcnt(10)
  buffer_load_dwordx4 v[108:111], v231, s[32:35], 0 offen nt
  s_waitcnt vmcnt(8)
  s_mov_b64 exec, 3
  s_add_u32 s44, s78, 0x03030303
  v_msad_u8 v9, s78, v36, 0
  v_msad_u8 v10, s44, v36, 0
  v_msad_u8 v9, s78, v37, v9
  v_msad_u8 v10, s44, v37, v10
  v_msad_u8 v9, s78, v38, v9
  v_msad_u8 v10, s44, v38, v10
  global_load_dwordx2 v[26:27], v11, s[30:31] sc1
  global_store_byte v7, v8, s[30:31]
  global_load_dwordx3 v[36:38], v233, s[30:31] sc1
  v_sub_u32 v9, v9, v10
  v_add_u32 v8, 1, v8
  v_readlane_b32 s66, v9, 0
  v_readlane_b32 s67, v9, 1
  s_add_u32 s78, s78, 0x01010101
  s_mov_b64 exec, -1
  s_lshl1_add_u32 s69, s91, s95
  s_add_u32 s95, s66, s67
  s_add_u32 s69, s69, s95
  v_dot2_f32_bf16 v22, v169, v60, 0
  v_add_f32_dpp v239, v18, v18 row_ror:8 row_mask:0xf bank_mask:0xc
  v_add_f32_dpp v239, v20, v20 row_ror:8 row_mask:0xf bank_mask:0x3
  v_dot2_f32_bf16 v23, v174, v61, 0
  v_dot2_f32_bf16 v24, v172, v62, 0
  v_dot2_f32_bf16 v25, v175, v63, 0
  v_cvt_f32_i32 v76, v76
  v_cvt_f32_i32 v77, v77
  v_cvt_f32_i32 v78, v78
  v_cvt_f32_i32 v79, v79
  v_pk_mul_f32 v[20:21], v[76:77], v[22:23]
  v_pk_add_f32 v[18:19], v[22:23], v[24:25]
  v_pk_fma_f32 v[20:21], v[78:79], v[24:25], v[20:21]
  v_add_f32 v18, v18, v19
  v_add_f32 v20, v20, v21
  s_cmpk_gt_i32 s69, 0x1d
  s_cbranch_scc1 L_p80_3
  s_cmp_gt_i32 s69, L_order_end-L_order-16411
  s_cbranch_scc1 L_p80_1
  s_waitcnt vmcnt(6)
L_p80_1:
  s_waitcnt vmcnt(9)
L_p80_3:
  s_waitcnt vmcnt(10)
  buffer_load_dwordx4 v[64:67], v208, s[36:39], 0 offen nt
  v_dot2_f32_bf16 v22, v173, v48, 0
  v_add_f32_dpp v21, v18, v18 row_ror:8 row_mask:0xf bank_mask:0xc
  v_add_f32_dpp v21, v20, v20 row_ror:8 row_mask:0xf bank_mask:0x3
  v_add_f32_dpp v20, v239, v239 row_half_mirror row_mask:0xf bank_mask:0x5
  v_dot2_f32_bf16 v23, v178, v49, 0
  v_add_f32_dpp v20, v21, v21 row_half_mirror row_mask:0xf bank_mask:0xa
  v_dot2_f32_bf16 v24, v176, v50, 0
  v_dot2_f32_bf16 v25, v179, v51, 0
  v_add_f32_dpp v20, v20, v20 quad_perm:[2,3,0,1] row_mask:0xf bank_mask:0xf
  v_cvt_f32_i32 v80, v80
  v_cvt_f32_i32 v81, v81
  v_add_f32_dpp v20, v20, v20 quad_perm:[1,0,3,2] row_mask:0xf bank_mask:0xf
  v_cndmask_b32_e64 v236, v236, v20, s[54:55]
  v_add_u32_e64 v2, s101, v16
  ds_write_b32 v2, v236
  v_cvt_f32_i32 v82, v82
  v_cvt_f32_i32 v83, v83
  v_pk_mul_f32 v[20:21], v[80:81], v[22:23]
  v_pk_add_f32 v[18:19], v[22:23], v[24:25]
  v_pk_fma_f32 v[20:21], v[82:83], v[24:25], v[20:21]
  v_add_f32 v18, v18, v19
  v_add_f32 v20, v20, v21
  s_cmpk_gt_i32 s69, 0x1d
  s_cbranch_scc1 L_p81_3
  s_cmp_gt_i32 s69, L_order_end-L_order-16381
  s_cbranch_scc1 L_p81_2
  s_waitcnt vmcnt(7)
L_p81_2:
  s_waitcnt vmcnt(10)
L_p81_3:
  s_waitcnt vmcnt(11)
  buffer_load_dwordx4 v[68:71], v209, s[36:39], 0 offen nt
  v_dot2_f32_bf16 v22, v177, v44, 0
  v_add_f32_dpp v239, v18, v18 row_ror:8 row_mask:0xf bank_mask:0xc
  v_add_f32_dpp v239, v20, v20 row_ror:8 row_mask:0xf bank_mask:0x3
  v_dot2_f32_bf16 v23, v182, v45, 0
  v_dot2_f32_bf16 v24, v180, v46, 0
  v_dot2_f32_bf16 v25, v183, v47, 0
  v_cvt_f32_i32 v84, v84
  v_cvt_f32_i32 v85, v85
  v_cvt_f32_i32 v86, v86
  v_cvt_f32_i32 v87, v87
  v_pk_mul_f32 v[20:21], v[84:85], v[22:23]
  v_pk_add_f32 v[18:19], v[22:23], v[24:25]
  v_pk_fma_f32 v[20:21], v[86:87], v[24:25], v[20:21]
  v_add_f32 v18, v18, v19
  v_add_f32 v20, v20, v21
  s_cmpk_gt_i32 s69, 0x1d
  s_cbranch_scc1 L_p82_3
  s_cmp_gt_i32 s69, L_order_end-L_order-16435
  s_cbranch_scc1 L_p82_0
  s_waitcnt vmcnt(7)
L_p82_0:
  s_waitcnt vmcnt(8)
L_p82_3:
  s_waitcnt vmcnt(11)
  buffer_load_dwordx4 v[72:75], v210, s[36:39], 0 offen nt
  ds_read_b32 v4, v14 offset:16
  s_waitcnt vmcnt(9)
  s_mov_b64 exec, 3
  s_add_u32 s44, s78, 0x03030303
  v_msad_u8 v9, s78, v32, 0
  v_msad_u8 v10, s44, v32, 0
  v_msad_u8 v9, s78, v33, v9
  v_msad_u8 v10, s44, v33, v10
  v_msad_u8 v9, s78, v34, v9
  v_msad_u8 v10, s44, v34, v10
  global_store_byte v7, v8, s[30:31]
  global_load_dwordx3 v[32:34], v234, s[30:31] sc1
  v_sub_u32 v9, v9, v10
  v_add_u32 v8, 1, v8
  v_readlane_b32 s66, v9, 0
  v_readlane_b32 s67, v9, 1
  s_add_u32 s78, s78, 0x01010101
  s_mov_b64 exec, -1
  s_lshl1_add_u32 s69, s91, s95
  s_add_u32 s95, s66, s67
  s_add_u32 s69, s69, s95
  v_dot2_f32_bf16 v22, v181, v40, 0
  v_add_f32_dpp v21, v18, v18 row_ror:8 row_mask:0xf bank_mask:0xc
  v_add_f32_dpp v21, v20, v20 row_ror:8 row_mask:0xf bank_mask:0x3
  v_add_f32_dpp v20, v239, v239 row_half_mirror row_mask:0xf bank_mask:0x5
  v_dot2_f32_bf16 v23, v186, v41, 0
  v_add_f32_dpp v20, v21, v21 row_half_mirror row_mask:0xf bank_mask:0xa
  v_dot2_f32_bf16 v24, v184, v42, 0
  v_dot2_f32_bf16 v25, v187, v43, 0
  v_add_f32_dpp v20, v20, v20 quad_perm:[2,3,0,1] row_mask:0xf bank_mask:0xf
  v_cvt_f32_i32 v88, v88
  v_cvt_f32_i32 v89, v89
  v_add_f32_dpp v20, v20, v20 quad_perm:[1,0,3,2] row_mask:0xf bank_mask:0xf
  v_cndmask_b32_e64 v236, v236, v20, s[48:49]
  v_cvt_f32_i32 v90, v90
  v_cvt_f32_i32 v91, v91
  v_pk_mul_f32 v[20:21], v[88:89], v[22:23]
  v_pk_add_f32 v[18:19], v[22:23], v[24:25]
  v_pk_fma_f32 v[20:21], v[90:91], v[24:25], v[20:21]
  v_add_f32 v18, v18, v19
  v_add_f32 v20, v20, v21
  s_cmpk_gt_i32 s69, 0x1d
  s_cbranch_scc1 L_p83_3
  s_cmp_gt_i32 s69, L_order_end-L_order-16411
  s_cbranch_scc1 L_p83_1
  s_waitcnt vmcnt(5)
L_p83_1:
  s_waitcnt vmcnt(9)
L_p83_3:
  s_waitcnt vmcnt(10)
  buffer_load_dwordx4 v[76:79], v211, s[36:39], 0 offen nt
  v_dot2_f32_bf16 v22, v185, v48, 0
  v_add_f32_dpp v239, v18, v18 row_ror:8 row_mask:0xf bank_mask:0xc
  v_add_f32_dpp v239, v20, v20 row_ror:8 row_mask:0xf bank_mask:0x3
  v_dot2_f32_bf16 v23, v190, v49, 0
  v_dot2_f32_bf16 v24, v188, v50, 0
  v_dot2_f32_bf16 v25, v191, v51, 0
  v_cvt_f32_i32 v92, v92
  v_cvt_f32_i32 v93, v93
  v_cvt_f32_i32 v94, v94
  v_cvt_f32_i32 v95, v95
  v_pk_mul_f32 v[20:21], v[92:93], v[22:23]
  v_pk_add_f32 v[18:19], v[22:23], v[24:25]
  v_pk_fma_f32 v[20:21], v[94:95], v[24:25], v[20:21]
  v_add_f32 v18, v18, v19
  v_add_f32 v20, v20, v21
  s_cmpk_gt_i32 s69, 0x1d
  s_cbranch_scc1 L_p84_3
  s_cmp_gt_i32 s69, L_order_end-L_order-16381
  s_cbranch_scc1 L_p84_2
  s_waitcnt vmcnt(6)
L_p84_2:
  s_waitcnt vmcnt(10)
L_p84_3:
  s_waitcnt vmcnt(11)
  buffer_load_dwordx4 v[80:83], v212, s[36:39], 0 offen nt
  v_dot2_f32_bf16 v22, v189, v52, 0
  v_add_f32_dpp v21, v18, v18 row_ror:8 row_mask:0xf bank_mask:0xc
  v_add_f32_dpp v21, v20, v20 row_ror:8 row_mask:0xf bank_mask:0x3
  v_add_f32_dpp v20, v239, v239 row_half_mirror row_mask:0xf bank_mask:0x5
  v_dot2_f32_bf16 v23, v194, v53, 0
  v_add_f32_dpp v20, v21, v21 row_half_mirror row_mask:0xf bank_mask:0xa
  v_dot2_f32_bf16 v24, v192, v54, 0
  v_dot2_f32_bf16 v25, v195, v55, 0
  v_add_f32_dpp v20, v20, v20 quad_perm:[2,3,0,1] row_mask:0xf bank_mask:0xf
  v_cvt_f32_i32 v96, v96
  v_cvt_f32_i32 v97, v97
  v_add_f32_dpp v20, v20, v20 quad_perm:[1,0,3,2] row_mask:0xf bank_mask:0xf
  v_cndmask_b32_e64 v236, v236, v20, s[50:51]
  v_cvt_f32_i32 v98, v98
  v_cvt_f32_i32 v99, v99
  v_pk_mul_f32 v[20:21], v[96:97], v[22:23]
  v_pk_add_f32 v[18:19], v[22:23], v[24:25]
  v_pk_fma_f32 v[20:21], v[98:99], v[24:25], v[20:21]
  v_add_f32 v18, v18, v19
  v_add_f32 v20, v20, v21
  s_cmpk_gt_i32 s69, 0x1d
  s_cbranch_scc1 L_p85_3
  s_cmp_gt_i32 s69, L_order_end-L_order-16435
  s_cbranch_scc1 L_p85_0
  s_waitcnt vmcnt(6)
L_p85_0:
  s_waitcnt vmcnt(7)
L_p85_3:
  s_waitcnt vmcnt(11)
  buffer_load_dwordx4 v[84:87], v213, s[36:39], 0 offen nt
L_qn:
  s_waitcnt lgkmcnt(0)
  v_readfirstlane_b32 s46, v4
  s_cmp_ge_u32 s46, s47
  s_cbranch_scc1 L_qn_ok
  s_cmp_eq_u32 s94, 0
  s_cbranch_scc1 L_qn_ok
  s_sub_u32 s94, s94, 1
  ds_read_b32 v4, v14 offset:16
  s_branch L_qn
L_qn_ok:
  v_add_u32_e64 v10, s59, v248
  ds_read_b128 v[40:43], v10 offset:512
  v_add_u32_e64 v10, s59, v249
  ds_read_b128 v[44:47], v10 offset:512
  v_add_u32_e64 v10, s59, v250
  ds_read_b128 v[48:51], v10 offset:512
  s_waitcnt vmcnt(8)
  s_mov_b64 exec, 3
  s_add_u32 s44, s78, 0x03030303
  v_msad_u8 v9, s78, v36, 0
  v_msad_u8 v10, s44, v36, 0
  v_msad_u8 v9, s78, v37, v9
  v_msad_u8 v10, s44, v37, v10
  v_msad_u8 v9, s78, v38, v9
  v_msad_u8 v10, s44, v38, v10
  global_store_byte v7, v8, s[30:31]
  global_load_dwordx3 v[36:38], v235, s[30:31] sc1
  v_sub_u32 v9, v9, v10
  v_add_u32 v8, 1, v8
  v_add3_u32 v10, v26, v27, s58
  v_readlane_b32 s66, v9, 0
  v_readlane_b32 s67, v9, 1
  v_readlane_b32 s91, v10, 0
  s_add_u32 s78, s78, 0x01010101
  s_mov_b64 exec, -1
  s_lshl1_add_u32 s69, s91, s95
  s_add_u32 s95, s66, s67
  s_add_u32 s69, s69, s95
  v_dot2_f32_bf16 v22, v193, v60, 0
  v_add_f32_dpp v239, v18, v18 row_ror:8 row_mask:0xf bank_mask:0xc
  v_add_f32_dpp v239, v20, v20 row_ror:8 row_mask:0xf bank_mask:0x3
  v_dot2_f32_bf16 v23, v198, v61, 0
  v_dot2_f32_bf16 v24, v196, v62, 0
  v_dot2_f32_bf16 v25, v199, v63, 0
  v_cvt_f32_i32 v100, v100
  v_cvt_f32_i32 v101, v101
  v_cvt_f32_i32 v102, v102
  v_cvt_f32_i32 v103, v103
  v_add_u32_e64 v10, s59, v253
  ds_read_b128 v[60:63], v10 offset:512
  v_pk_mul_f32 v[20:21], v[100:101], v[22:23]
  v_pk_add_f32 v[18:19], v[22:23], v[24:25]
  v_pk_fma_f32 v[20:21], v[102:103], v[24:25], v[20:21]
  v_add_f32 v18, v18, v19
  v_add_f32 v20, v20, v21
  s_cmpk_gt_i32 s69, 0x1d
  s_cbranch_scc1 L_p86_3
  s_cmp_gt_i32 s69, L_order_end-L_order-16411
  s_cbranch_scc1 L_p86_1
  s_waitcnt vmcnt(5)
L_p86_1:
  s_waitcnt vmcnt(8)
L_p86_3:
  s_waitcnt vmcnt(9)
  buffer_load_dwordx4 v[88:91], v214, s[36:39], 0 offen nt
  v_dot2_f32_bf16 v22, v197, v56, 0
  v_add_f32_dpp v21, v18, v18 row_ror:8 row_mask:0xf bank_mask:0xc
  v_add_f32_dpp v21, v20, v20 row_ror:8 row_mask:0xf bank_mask:0x3
  v_add_f32_dpp v20, v239, v239 row_half_mirror row_mask:0xf bank_mask:0x5
  v_dot2_f32_bf16 v23, v202, v57, 0
  v_add_f32_dpp v20, v21, v21 row_half_mirror row_mask:0xf bank_mask:0xa
  v_dot2_f32_bf16 v24, v200, v58, 0
  v_dot2_f32_bf16 v25, v203, v59, 0
  v_add_f32_dpp v20, v20, v20 quad_perm:[2,3,0,1] row_mask:0xf bank_mask:0xf
  v_cvt_f32_i32 v104, v104
  v_cvt_f32_i32 v105, v105
  v_add_f32_dpp v20, v20, v20 quad_perm:[1,0,3,2] row_mask:0xf bank_mask:0xf
  v_cndmask_b32_e64 v236, v236, v20, s[52:53]
  v_cvt_f32_i32 v106, v106
  v_cvt_f32_i32 v107, v107
  v_add_u32_e64 v10, s59, v252
  ds_read_b128 v[56:59], v10 offset:512
  v_pk_mul_f32 v[20:21], v[104:105], v[22:23]
  v_pk_add_f32 v[18:19], v[22:23], v[24:25]
  v_pk_fma_f32 v[20:21], v[106:107], v[24:25], v[20:21]
  v_add_f32 v18, v18, v19
  v_add_f32 v20, v20, v21
  s_cmpk_gt_i32 s69, 0x1d
  s_cbranch_scc1 L_p87_3
  s_cmp_gt_i32 s69, L_order_end-L_order-16381
  s_cbranch_scc1 L_p87_2
  s_waitcnt vmcnt(6)
L_p87_2:
  s_waitcnt vmcnt(9)
L_p87_3:
  s_waitcnt vmcnt(10)
  buffer_load_dwordx4 v[92:95], v215, s[36:39], 0 offen nt
  v_dot2_f32_bf16 v22, v201, v52, 0
  v_add_f32_dpp v239, v18, v18 row_ror:8 row_mask:0xf bank_mask:0xc
  v_add_f32_dpp v239, v20, v20 row_ror:8 row_mask:0xf bank_mask:0x3
  v_dot2_f32_bf16 v23, v206, v53, 0
  v_dot2_f32_bf16 v24, v204, v54, 0
  v_dot2_f32_bf16 v25, v207, v55, 0
  v_cvt_f32_i32 v108, v108
  v_cvt_f32_i32 v109, v109
  v_cvt_f32_i32 v110, v110
  v_cvt_f32_i32 v111, v111
  v_add_u32_e64 v10, s59, v251
  ds_read_b128 v[52:55], v10 offset:512
  v_pk_mul_f32 v[20:21], v[108:109], v[22:23]
  v_pk_add_f32 v[18:19], v[22:23], v[24:25]
  v_pk_fma_f32 v[20:21], v[110:111], v[24:25], v[20:21]
  v_add_f32 v18, v18, v19
  v_add_f32 v20, v20, v21
  s_cmpk_gt_i32 s69, 0x1d
  s_cbranch_scc1 L_p88_3
  s_cmp_gt_i32 s69, L_order_end-L_order-16435
  s_cbranch_scc1 L_p88_0
  s_waitcnt vmcnt(6)
L_p88_0:
  s_waitcnt vmcnt(7)
L_p88_3:
  s_waitcnt vmcnt(10)
  buffer_load_dwordx4 v[96:99], v216, s[36:39], 0 offen nt
  s_nop 0
  v_add_f32_dpp v21, v18, v18 row_ror:8 row_mask:0xf bank_mask:0xc
  v_add_f32_dpp v21, v20, v20 row_ror:8 row_mask:0xf bank_mask:0x3
  v_add_f32_dpp v20, v239, v239 row_half_mirror row_mask:0xf bank_mask:0x5
  s_nop 0
  v_add_f32_dpp v20, v21, v21 row_half_mirror row_mask:0xf bank_mask:0xa
  s_nop 1
  v_add_f32_dpp v20, v20, v20 quad_perm:[2,3,0,1] row_mask:0xf bank_mask:0xf
  s_nop 1
  v_add_f32_dpp v20, v20, v20 quad_perm:[1,0,3,2] row_mask:0xf bank_mask:0xf
  v_cndmask_b32_e64 v236, v236, v20, s[54:55]
  v_add_u32_e64 v2, s101, v17
  ds_write_b32 v2, v236
  s_addk_i32 s101, 3072
  s_cmpk_eq_u32 s101, 18432
  s_cselect_b32 s101, 0, s101
  s_add_u32 s43, s43, 1
  v_mov_b32_e64 v4, s43
  ds_write_b32 v6, v4 offset:0
  s_mov_b64 s[32:33], s[36:37]
  s_add_u32 s68, s43, 1
  s_sub_u32 s45, s68, 16
  s_lshl_b32 s46, s45, 2
  s_lshr_b64 s[64:65], s[92:93], s46
  s_and_b32 s46, s64, 15
  s_cmp_lt_u32 s68, 16
  s_cselect_b32 s68, s68, s46
  s_cselect_b32 s70, s6, s12
  s_cselect_b32 s71, s7, s13
  s_lshl_b32 s44, s68, 2
  s_lshr_b64 s[64:65], s[96:97], s44
  s_and_b32 s64, s64, 15
  s_lshl4_add_u32 s68, s68, s64
  s_mul_i32 s44, s68, 1572864
  s_add_u32 s36, s70, s44
  s_addc_u32 s37, s71, 0
  s_cmp_lt_u32 s43, 16
  s_cbranch_scc1 L_k
L_vpre:
  v_subrev_u32 v116, 45568, v15
  v_mul_u32_u24 v116, 683, v116
  v_lshrrev_b32 v116, 13, v116
  v_lshlrev_b32 v116, 2, v116
  v_subrev_u32 v117, 45568, v16
  v_mul_u32_u24 v117, 683, v117
  v_lshrrev_b32 v117, 13, v117
  v_lshlrev_b32 v117, 2, v117
  v_subrev_u32 v118, 45568, v17
  v_mul_u32_u24 v118, 683, v118
  v_lshrrev_b32 v118, 13, v118
  v_lshlrev_b32 v118, 2, v118
  s_mov_b64 vcc, 0
  s_mov_b32 s43, 0
  s_lshl_b32 s68, s43, 2
  s_lshr_b64 s[64:65], s[92:93], s68
  s_and_b32 s68, s64, 15
  s_add_u32 s47, s68, 1
  ds_read_b32 v4, v14 offset:20
L_a0:
  s_waitcnt lgkmcnt(0)
  v_readfirstlane_b32 s46, v4
  s_cmp_ge_u32 s46, s47
  s_cbranch_scc1 L_a0_ok
  s_cmp_eq_u32 s94, 0
  s_cbranch_scc1 L_a0_ok
  s_sub_u32 s94, s94, 1
  ds_read_b32 v4, v14 offset:20
  s_branch L_a0
L_a0_ok:
  v_lshl_add_u32 v120, s68, 9, v116
  v_lshl_add_u32 v121, s68, 9, v117
  v_lshl_add_u32 v122, s68, 9, v118
  ds_read_b32 v112, v120 offset:37376
  ds_read_b32 v113, v121 offset:37376
  ds_read_b32 v114, v122 offset:37376
.p2align 6
L_v:
  s_cmp_eq_u32 s43, 8
  s_cselect_b32 s44, 6, 0
  s_sub_u32 s58, s58, s44
  s_add_u32 s45, s43, 1
  s_min_u32 s45, s45, 15
  s_lshl_b32 s68, s45, 2
  s_lshr_b64 s[64:65], s[92:93], s68
  s_and_b32 s68, s64, 15
  s_add_u32 s47, s68, 1
  v_lshl_add_u32 v120, s68, 9, v116
  v_lshl_add_u32 v121, s68, 9, v117
  v_lshl_add_u32 v122, s68, 9, v118
  s_waitcnt lgkmcnt(0)
  s_waitcnt vmcnt(8)
  s_mov_b64 exec, 3
  s_add_u32 s44, s78, 0x03030303
  v_msad_u8 v9, s78, v32, 0
  v_msad_u8 v10, s44, v32, 0
  v_msad_u8 v9, s78, v33, v9
  v_msad_u8 v10, s44, v33, v10
  v_msad_u8 v9, s78, v34, v9
  v_msad_u8 v10, s44, v34, v10
  global_store_byte v7, v8, s[30:31]
  global_load_dwordx3 v[32:34], v232, s[30:31] sc1
  v_sub_u32 v9, v9, v10
  v_add_u32 v8, 1, v8
  v_readlane_b32 s66, v9, 0
  v_readlane_b32 s67, v9, 1
  s_add_u32 s78, s78, 0x01010101
  s_mov_b64 exec, -1
  s_lshl1_add_u32 s69, s91, s95
  s_add_u32 s95, s66, s67
  s_add_u32 s69, s69, s95
  v_mov_b32_dpp v18, v112 row_newbcast:0 row_mask:0xf bank_mask:0xf
  v_cvt_f32_i32 v64, v64
  v_cvt_f32_i32 v65, v65
  v_cvt_f32_i32 v66, v66
  v_cvt_f32_i32 v67, v67
  v_pk_mul_f32 v[40:41], v[64:65], v[18:19] op_sel_hi:[1,0]
  v_pk_mul_f32 v[42:43], v[66:67], v[18:19] op_sel_hi:[1,0]
  s_cmpk_gt_i32 s69, 0x25
  s_cbranch_scc1 L_p89_3
  s_cmp_gt_i32 s69, L_order_end-L_order-16403
  s_cbranch_scc1 L_p89_1
  s_waitcnt vmcnt(5)
L_p89_1:
  s_waitcnt vmcnt(8)
L_p89_3:
  s_waitcnt vmcnt(9)
  buffer_load_dwordx4 v[100:103], v217, s[32:35], 0 offen nt
  v_mov_b32_dpp v18, v112 row_newbcast:4 row_mask:0xf bank_mask:0xf
  v_cvt_f32_i32 v68, v68
  v_cvt_f32_i32 v69, v69
  v_cvt_f32_i32 v70, v70
  v_cvt_f32_i32 v71, v71
  v_pk_mul_f32 v[48:49], v[68:69], v[18:19] op_sel_hi:[1,0]
  v_pk_mul_f32 v[50:51], v[70:71], v[18:19] op_sel_hi:[1,0]
  s_cmpk_gt_i32 s69, 0x25
  s_cbranch_scc1 L_p90_3
  s_cmp_gt_i32 s69, L_order_end-L_order-16373
  s_cbranch_scc1 L_p90_2
  s_waitcnt vmcnt(6)
L_p90_2:
  s_waitcnt vmcnt(9)
L_p90_3:
  s_waitcnt vmcnt(10)
  buffer_load_dwordx4 v[104:107], v218, s[32:35], 0 offen nt
  v_mov_b32_dpp v18, v112 row_newbcast:1 row_mask:0xf bank_mask:0xf
  v_cvt_f32_i32 v72, v72
  v_cvt_f32_i32 v73, v73
  v_cvt_f32_i32 v74, v74
  v_cvt_f32_i32 v75, v75
  v_pk_mul_f32 v[44:45], v[72:73], v[18:19] op_sel_hi:[1,0]
  v_pk_mul_f32 v[46:47], v[74:75], v[18:19] op_sel_hi:[1,0]
  s_cmpk_gt_i32 s69, 0x25
  s_cbranch_scc1 L_p91_3
  s_cmp_gt_i32 s69, L_order_end-L_order-16427
  s_cbranch_scc1 L_p91_0
  s_waitcnt vmcnt(6)
L_p91_0:
  s_waitcnt vmcnt(7)
L_p91_3:
  s_waitcnt vmcnt(10)
  buffer_load_dwordx4 v[108:111], v219, s[32:35], 0 offen nt
  s_waitcnt vmcnt(8)
  s_mov_b64 exec, 3
  s_add_u32 s44, s78, 0x03030303
  v_msad_u8 v9, s78, v36, 0
  v_msad_u8 v10, s44, v36, 0
  v_msad_u8 v9, s78, v37, v9
  v_msad_u8 v10, s44, v37, v10
  v_msad_u8 v9, s78, v38, v9
  v_msad_u8 v10, s44, v38, v10
  global_store_byte v7, v8, s[30:31]
  global_load_dwordx3 v[36:38], v233, s[30:31] sc1
  v_sub_u32 v9, v9, v10
  v_add_u32 v8, 1, v8
  v_readlane_b32 s66, v9, 0
  v_readlane_b32 s67, v9, 1
  s_add_u32 s78, s78, 0x01010101
  s_mov_b64 exec, -1
  s_lshl1_add_u32 s69, s91, s95
  s_add_u32 s95, s66, s67
  s_add_u32 s69, s69, s95
  v_mov_b32_dpp v18, v112 row_newbcast:5 row_mask:0xf bank_mask:0xf
  v_cvt_f32_i32 v76, v76
  v_cvt_f32_i32 v77, v77
  v_cvt_f32_i32 v78, v78
  v_cvt_f32_i32 v79, v79
  v_pk_fma_f32 v[40:41], v[76:77], v[18:19], v[40:41] op_sel_hi:[1,0,1]
  v_pk_fma_f32 v[42:43], v[78:79], v[18:19], v[42:43] op_sel_hi:[1,0,1]
  s_cmpk_gt_i32 s69, 0x25
  s_cbranch_scc1 L_p92_3
  s_cmp_gt_i32 s69, L_order_end-L_order-16403
  s_cbranch_scc1 L_p92_1
  s_waitcnt vmcnt(5)
L_p92_1:
  s_waitcnt vmcnt(8)
L_p92_3:
  s_waitcnt vmcnt(9)
  buffer_load_dwordx4 v[64:67], v220, s[32:35], 0 offen nt
  v_mov_b32_dpp v18, v112 row_newbcast:2 row_mask:0xf bank_mask:0xf
  v_cvt_f32_i32 v80, v80
  v_cvt_f32_i32 v81, v81
  v_cvt_f32_i32 v82, v82
  v_cvt_f32_i32 v83, v83
  v_pk_mul_f32 v[56:57], v[80:81], v[18:19] op_sel_hi:[1,0]
  v_pk_mul_f32 v[58:59], v[82:83], v[18:19] op_sel_hi:[1,0]
  s_cmpk_gt_i32 s69, 0x25
  s_cbranch_scc1 L_p93_3
  s_cmp_gt_i32 s69, L_order_end-L_order-16373
  s_cbranch_scc1 L_p93_2
  s_waitcnt vmcnt(6)
L_p93_2:
  s_waitcnt vmcnt(9)
L_p93_3:
  s_waitcnt vmcnt(10)
  buffer_load_dwordx4 v[68:71], v221, s[32:35], 0 offen nt
  v_mov_b32_dpp v18, v112 row_newbcast:6 row_mask:0xf bank_mask:0xf
  v_cvt_f32_i32 v84, v84
  v_cvt_f32_i32 v85, v85
  v_cvt_f32_i32 v86, v86
  v_cvt_f32_i32 v87, v87
  v_pk_mul_f32 v[52:53], v[84:85], v[18:19] op_sel_hi:[1,0]
  v_pk_mul_f32 v[54:55], v[86:87], v[18:19] op_sel_hi:[1,0]
  s_cmpk_gt_i32 s69, 0x25
  s_cbranch_scc1 L_p94_3
  s_cmp_gt_i32 s69, L_order_end-L_order-16427
  s_cbranch_scc1 L_p94_0
  s_waitcnt vmcnt(6)
L_p94_0:
  s_waitcnt vmcnt(7)
L_p94_3:
  s_waitcnt vmcnt(10)
  buffer_load_dwordx4 v[72:75], v222, s[32:35], 0 offen nt
  v_add_u32_e64 v9, s43, 16
  ds_write_b32 v14, v9 offset:28
  s_waitcnt vmcnt(8)
  s_mov_b64 exec, 3
  s_add_u32 s44, s78, 0x03030303
  v_msad_u8 v9, s78, v32, 0
  v_msad_u8 v10, s44, v32, 0
  v_msad_u8 v9, s78, v33, v9
  v_msad_u8 v10, s44, v33, v10
  v_msad_u8 v9, s78, v34, v9
  v_msad_u8 v10, s44, v34, v10
  global_store_byte v7, v8, s[30:31]
  global_load_dwordx3 v[32:34], v234, s[30:31] sc1
  v_sub_u32 v9, v9, v10
  v_add_u32 v8, 1, v8
  v_readlane_b32 s66, v9, 0
  v_readlane_b32 s67, v9, 1
  s_add_u32 s78, s78, 0x01010101
  s_mov_b64 exec, -1
  s_lshl1_add_u32 s69, s91, s95
  s_add_u32 s95, s66, s67
  s_add_u32 s69, s69, s95
  v_mov_b32_dpp v18, v112 row_newbcast:3 row_mask:0xf bank_mask:0xf
  v_cvt_f32_i32 v88, v88
  v_cvt_f32_i32 v89, v89
  v_cvt_f32_i32 v90, v90
  v_cvt_f32_i32 v91, v91
  v_pk_mul_f32 v[60:61], v[88:89], v[18:19] op_sel_hi:[1,0]
  v_pk_mul_f32 v[62:63], v[90:91], v[18:19] op_sel_hi:[1,0]
  s_cmpk_gt_i32 s69, 0x25
  s_cbranch_scc1 L_p95_3
  s_cmp_gt_i32 s69, L_order_end-L_order-16403
  s_cbranch_scc1 L_p95_1
  s_waitcnt vmcnt(5)
L_p95_1:
  s_waitcnt vmcnt(8)
L_p95_3:
  s_waitcnt vmcnt(9)
  buffer_load_dwordx4 v[76:79], v223, s[32:35], 0 offen nt
  v_mov_b32_dpp v18, v112 row_newbcast:7 row_mask:0xf bank_mask:0xf
  v_cvt_f32_i32 v92, v92
  v_cvt_f32_i32 v93, v93
  v_cvt_f32_i32 v94, v94
  v_cvt_f32_i32 v95, v95
  v_pk_fma_f32 v[56:57], v[92:93], v[18:19], v[56:57] op_sel_hi:[1,0,1]
  v_pk_fma_f32 v[58:59], v[94:95], v[18:19], v[58:59] op_sel_hi:[1,0,1]
  s_cmpk_gt_i32 s69, 0x25
  s_cbranch_scc1 L_p96_3
  s_cmp_gt_i32 s69, L_order_end-L_order-16373
  s_cbranch_scc1 L_p96_2
  s_waitcnt vmcnt(6)
L_p96_2:
  s_waitcnt vmcnt(9)
L_p96_3:
  s_waitcnt vmcnt(10)
  buffer_load_dwordx4 v[80:83], v224, s[32:35], 0 offen nt
  v_mov_b32_dpp v18, v113 row_newbcast:0 row_mask:0xf bank_mask:0xf
  v_cvt_f32_i32 v96, v96
  v_cvt_f32_i32 v97, v97
  v_cvt_f32_i32 v98, v98
  v_cvt_f32_i32 v99, v99
  v_pk_fma_f32 v[44:45], v[96:97], v[18:19], v[44:45] op_sel_hi:[1,0,1]
  v_pk_fma_f32 v[46:47], v[98:99], v[18:19], v[46:47] op_sel_hi:[1,0,1]
  s_cmpk_gt_i32 s69, 0x25
  s_cbranch_scc1 L_p97_3
  s_cmp_gt_i32 s69, L_order_end-L_order-16427
  s_cbranch_scc1 L_p97_0
  s_waitcnt vmcnt(6)
L_p97_0:
  s_waitcnt vmcnt(7)
L_p97_3:
  s_waitcnt vmcnt(10)
  buffer_load_dwordx4 v[84:87], v225, s[32:35], 0 offen nt
  s_waitcnt vmcnt(8)
  s_mov_b64 exec, 3
  s_add_u32 s44, s78, 0x03030303
  v_msad_u8 v9, s78, v36, 0
  v_msad_u8 v10, s44, v36, 0
  v_msad_u8 v9, s78, v37, v9
  v_msad_u8 v10, s44, v37, v10
  v_msad_u8 v9, s78, v38, v9
  v_msad_u8 v10, s44, v38, v10
  global_store_byte v7, v8, s[30:31]
  global_load_dwordx3 v[36:38], v235, s[30:31] sc1
  v_sub_u32 v9, v9, v10
  v_add_u32 v8, 1, v8
  v_readlane_b32 s66, v9, 0
  v_readlane_b32 s67, v9, 1
  s_add_u32 s78, s78, 0x01010101
  s_mov_b64 exec, -1
  s_lshl1_add_u32 s69, s91, s95
  s_add_u32 s95, s66, s67
  s_add_u32 s69, s69, s95
  v_mov_b32_dpp v18, v113 row_newbcast:4 row_mask:0xf bank_mask:0xf
  v_cvt_f32_i32 v100, v100
  v_cvt_f32_i32 v101, v101
  v_cvt_f32_i32 v102, v102
  v_cvt_f32_i32 v103, v103
  v_pk_fma_f32 v[40:41], v[100:101], v[18:19], v[40:41] op_sel_hi:[1,0,1]
  v_pk_fma_f32 v[42:43], v[102:103], v[18:19], v[42:43] op_sel_hi:[1,0,1]
  s_cmpk_gt_i32 s69, 0x25
  s_cbranch_scc1 L_p98_3
  s_cmp_gt_i32 s69, L_order_end-L_order-16403
  s_cbranch_scc1 L_p98_1
  s_waitcnt vmcnt(5)
L_p98_1:
  s_waitcnt vmcnt(8)
L_p98_3:
  s_waitcnt vmcnt(9)
  buffer_load_dwordx4 v[88:91], v226, s[32:35], 0 offen nt
  v_mov_b32_dpp v18, v113 row_newbcast:1 row_mask:0xf bank_mask:0xf
  v_cvt_f32_i32 v104, v104
  v_cvt_f32_i32 v105, v105
  v_cvt_f32_i32 v106, v106
  v_cvt_f32_i32 v107, v107
  v_pk_fma_f32 v[48:49], v[104:105], v[18:19], v[48:49] op_sel_hi:[1,0,1]
  v_pk_fma_f32 v[50:51], v[106:107], v[18:19], v[50:51] op_sel_hi:[1,0,1]
  s_cmpk_gt_i32 s69, 0x25
  s_cbranch_scc1 L_p99_3
  s_cmp_gt_i32 s69, L_order_end-L_order-16373
  s_cbranch_scc1 L_p99_2
  s_waitcnt vmcnt(6)
L_p99_2:
  s_waitcnt vmcnt(9)
L_p99_3:
  s_waitcnt vmcnt(10)
  buffer_load_dwordx4 v[92:95], v227, s[32:35], 0 offen nt
  v_mov_b32_dpp v18, v113 row_newbcast:5 row_mask:0xf bank_mask:0xf
  v_cvt_f32_i32 v108, v108
  v_cvt_f32_i32 v109, v109
  v_cvt_f32_i32 v110, v110
  v_cvt_f32_i32 v111, v111
  v_pk_fma_f32 v[44:45], v[108:109], v[18:19], v[44:45] op_sel_hi:[1,0,1]
  v_pk_fma_f32 v[46:47], v[110:111], v[18:19], v[46:47] op_sel_hi:[1,0,1]
  s_cmpk_gt_i32 s69, 0x25
  s_cbranch_scc1 L_p100_3
  s_cmp_gt_i32 s69, L_order_end-L_order-16427
  s_cbranch_scc1 L_p100_0
  s_waitcnt vmcnt(6)
L_p100_0:
  s_waitcnt vmcnt(7)
L_p100_3:
  s_waitcnt vmcnt(10)
  buffer_load_dwordx4 v[96:99], v228, s[32:35], 0 offen nt
  s_waitcnt vmcnt(8)
  s_mov_b64 exec, 3
  s_add_u32 s44, s78, 0x03030303
  v_msad_u8 v9, s78, v32, 0
  v_msad_u8 v10, s44, v32, 0
  v_msad_u8 v9, s78, v33, v9
  v_msad_u8 v10, s44, v33, v10
  v_msad_u8 v9, s78, v34, v9
  v_msad_u8 v10, s44, v34, v10
  global_store_byte v7, v8, s[30:31]
  global_load_dwordx3 v[32:34], v232, s[30:31] sc1
  v_sub_u32 v9, v9, v10
  v_add_u32 v8, 1, v8
  v_readlane_b32 s66, v9, 0
  v_readlane_b32 s67, v9, 1
  s_add_u32 s78, s78, 0x01010101
  s_mov_b64 exec, -1
  s_lshl1_add_u32 s69, s91, s95
  s_add_u32 s95, s66, s67
  s_add_u32 s69, s69, s95
  v_mov_b32_dpp v18, v113 row_newbcast:2 row_mask:0xf bank_mask:0xf
  v_cvt_f32_i32 v64, v64
  v_cvt_f32_i32 v65, v65
  v_cvt_f32_i32 v66, v66
  v_cvt_f32_i32 v67, v67
  v_pk_fma_f32 v[60:61], v[64:65], v[18:19], v[60:61] op_sel_hi:[1,0,1]
  v_pk_fma_f32 v[62:63], v[66:67], v[18:19], v[62:63] op_sel_hi:[1,0,1]
  s_cmpk_gt_i32 s69, 0x25
  s_cbranch_scc1 L_p101_3
  s_cmp_gt_i32 s69, L_order_end-L_order-16403
  s_cbranch_scc1 L_p101_1
  s_waitcnt vmcnt(5)
L_p101_1:
  s_waitcnt vmcnt(8)
L_p101_3:
  s_waitcnt vmcnt(9)
  buffer_load_dwordx4 v[100:103], v229, s[32:35], 0 offen nt
  v_mov_b32_dpp v18, v113 row_newbcast:6 row_mask:0xf bank_mask:0xf
  v_cvt_f32_i32 v68, v68
  v_cvt_f32_i32 v69, v69
  v_cvt_f32_i32 v70, v70
  v_cvt_f32_i32 v71, v71
  v_pk_fma_f32 v[56:57], v[68:69], v[18:19], v[56:57] op_sel_hi:[1,0,1]
  v_pk_fma_f32 v[58:59], v[70:71], v[18:19], v[58:59] op_sel_hi:[1,0,1]
  s_cmpk_gt_i32 s69, 0x25
  s_cbranch_scc1 L_p102_3
  s_cmp_gt_i32 s69, L_order_end-L_order-16373
  s_cbranch_scc1 L_p102_2
  s_waitcnt vmcnt(6)
L_p102_2:
  s_waitcnt vmcnt(9)
L_p102_3:
  s_waitcnt vmcnt(10)
  buffer_load_dwordx4 v[104:107], v230, s[32:35], 0 offen nt
  v_mov_b32_dpp v18, v113 row_newbcast:3 row_mask:0xf bank_mask:0xf
  v_cvt_f32_i32 v72, v72
  v_cvt_f32_i32 v73, v73
  v_cvt_f32_i32 v74, v74
  v_cvt_f32_i32 v75, v75
  v_pk_fma_f32 v[52:53], v[72:73], v[18:19], v[52:53] op_sel_hi:[1,0,1]
  v_pk_fma_f32 v[54:55], v[74:75], v[18:19], v[54:55] op_sel_hi:[1,0,1]
  s_cmpk_gt_i32 s69, 0x25
  s_cbranch_scc1 L_p103_3
  s_cmp_gt_i32 s69, L_order_end-L_order-16427
  s_cbranch_scc1 L_p103_0
  s_waitcnt vmcnt(6)
L_p103_0:
  s_waitcnt vmcnt(7)
L_p103_3:
  s_waitcnt vmcnt(10)
  buffer_load_dwordx4 v[108:111], v231, s[32:35], 0 offen nt
  s_cbranch_vccnz L_vtail
  ds_read_b32 v4, v14 offset:20
  s_waitcnt vmcnt(8)
  s_mov_b64 exec, 3
  s_add_u32 s44, s78, 0x03030303
  v_msad_u8 v9, s78, v36, 0
  v_msad_u8 v10, s44, v36, 0
  v_msad_u8 v9, s78, v37, v9
  v_msad_u8 v10, s44, v37, v10
  v_msad_u8 v9, s78, v38, v9
  v_msad_u8 v10, s44, v38, v10
  global_load_dwordx2 v[26:27], v11, s[30:31] sc1
  global_store_byte v7, v8, s[30:31]
  global_load_dwordx3 v[36:38], v233, s[30:31] sc1
  v_sub_u32 v9, v9, v10
  v_add_u32_e64 v8, 1, v8
  v_readlane_b32 s66, v9, 0
  v_readlane_b32 s67, v9, 1
  s_add_u32 s78, s78, 0x01010101
  s_mov_b64 exec, -1
  s_lshl1_add_u32 s69, s91, s95
  s_add_u32 s95, s66, s67
  s_add_u32 s69, s69, s95
  v_mov_b32_dpp v18, v113 row_newbcast:7 row_mask:0xf bank_mask:0xf
  v_cvt_f32_i32 v76, v76
  v_cvt_f32_i32 v77, v77
  v_cvt_f32_i32 v78, v78
  v_cvt_f32_i32 v79, v79
  v_pk_fma_f32 v[60:61], v[76:77], v[18:19], v[60:61] op_sel_hi:[1,0,1]
  v_pk_fma_f32 v[62:63], v[78:79], v[18:19], v[62:63] op_sel_hi:[1,0,1]
  s_cmpk_gt_i32 s69, 0x25
  s_cbranch_scc1 L_p104_3
  s_cmp_gt_i32 s69, L_order_end-L_order-16403
  s_cbranch_scc1 L_p104_1
  s_waitcnt vmcnt(6)
L_p104_1:
  s_waitcnt vmcnt(9)
L_p104_3:
  s_waitcnt vmcnt(10)
  buffer_load_dwordx4 v[64:67], v208, s[36:39], 0 offen nt
  v_mov_b32_dpp v18, v114 row_newbcast:0 row_mask:0xf bank_mask:0xf
  v_cvt_f32_i32 v80, v80
  v_cvt_f32_i32 v81, v81
  v_cvt_f32_i32 v82, v82
  v_cvt_f32_i32 v83, v83
  v_pk_fma_f32 v[48:49], v[80:81], v[18:19], v[48:49] op_sel_hi:[1,0,1]
  v_pk_fma_f32 v[50:51], v[82:83], v[18:19], v[50:51] op_sel_hi:[1,0,1]
  s_cmpk_gt_i32 s69, 0x25
  s_cbranch_scc1 L_p105_3
  s_cmp_gt_i32 s69, L_order_end-L_order-16373
  s_cbranch_scc1 L_p105_2
  s_waitcnt vmcnt(7)
L_p105_2:
  s_waitcnt vmcnt(10)
L_p105_3:
  s_waitcnt vmcnt(11)
  buffer_load_dwordx4 v[68:71], v209, s[36:39], 0 offen nt
  v_mov_b32_dpp v18, v114 row_newbcast:4 row_mask:0xf bank_mask:0xf
  v_cvt_f32_i32 v84, v84
  v_cvt_f32_i32 v85, v85
  v_cvt_f32_i32 v86, v86
  v_cvt_f32_i32 v87, v87
  v_pk_fma_f32 v[44:45], v[84:85], v[18:19], v[44:45] op_sel_hi:[1,0,1]
  v_pk_fma_f32 v[46:47], v[86:87], v[18:19], v[46:47] op_sel_hi:[1,0,1]
  s_cmpk_gt_i32 s69, 0x25
  s_cbranch_scc1 L_p106_3
  s_cmp_gt_i32 s69, L_order_end-L_order-16427
  s_cbranch_scc1 L_p106_0
  s_waitcnt vmcnt(7)
L_p106_0:
  s_waitcnt vmcnt(8)
L_p106_3:
  s_waitcnt vmcnt(11)
  buffer_load_dwordx4 v[72:75], v210, s[36:39], 0 offen nt
L_an:
  s_waitcnt lgkmcnt(0)
  v_readfirstlane_b32 s46, v4
  s_cmp_ge_u32 s46, s47
  s_cbranch_scc1 L_an_ok
  s_cmp_eq_u32 s94, 0
  s_cbranch_scc1 L_an_ok
  s_sub_u32 s94, s94, 1
  ds_read_b32 v4, v14 offset:20
  s_branch L_an
L_an_ok:
  ds_read_b32 v112, v120 offset:37376
  ds_read_b32 v113, v121 offset:37376
  ds_read_b32 v115, v122 offset:37376
  s_waitcnt vmcnt(9)
  s_mov_b64 exec, 3
  s_add_u32 s44, s78, 0x03030303
  v_msad_u8 v9, s78, v32, 0
  v_msad_u8 v10, s44, v32, 0
  v_msad_u8 v9, s78, v33, v9
  v_msad_u8 v10, s44, v33, v10
  v_msad_u8 v9, s78, v34, v9
  v_msad_u8 v10, s44, v34, v10
  global_store_byte v7, v8, s[30:31]
  global_load_dwordx3 v[32:34], v234, s[30:31] sc1
  v_sub_u32 v9, v9, v10
  v_add_u32 v8, 1, v8
  v_readlane_b32 s66, v9, 0
  v_readlane_b32 s67, v9, 1
  s_add_u32 s78, s78, 0x01010101
  s_mov_b64 exec, -1
  s_lshl1_add_u32 s69, s91, s95
  s_add_u32 s95, s66, s67
  s_add_u32 s69, s69, s95
  v_mov_b32_dpp v18, v114 row_newbcast:1 row_mask:0xf bank_mask:0xf
  v_cvt_f32_i32 v88, v88
  v_cvt_f32_i32 v89, v89
  v_cvt_f32_i32 v90, v90
  v_cvt_f32_i32 v91, v91
  v_pk_fma_f32 v[40:41], v[88:89], v[18:19], v[40:41] op_sel_hi:[1,0,1]
  v_pk_fma_f32 v[42:43], v[90:91], v[18:19], v[42:43] op_sel_hi:[1,0,1]
  s_cmpk_gt_i32 s69, 0x25
  s_cbranch_scc1 L_p107_3
  s_cmp_gt_i32 s69, L_order_end-L_order-16403
  s_cbranch_scc1 L_p107_1
  s_waitcnt vmcnt(5)
L_p107_1:
  s_waitcnt vmcnt(9)
L_p107_3:
  s_waitcnt vmcnt(10)
  buffer_load_dwordx4 v[76:79], v211, s[36:39], 0 offen nt
  v_mov_b32_dpp v18, v114 row_newbcast:5 row_mask:0xf bank_mask:0xf
  v_cvt_f32_i32 v92, v92
  v_cvt_f32_i32 v93, v93
  v_cvt_f32_i32 v94, v94
  v_cvt_f32_i32 v95, v95
  v_pk_fma_f32 v[48:49], v[92:93], v[18:19], v[48:49] op_sel_hi:[1,0,1]
  v_pk_fma_f32 v[50:51], v[94:95], v[18:19], v[50:51] op_sel_hi:[1,0,1]
  s_cmpk_gt_i32 s69, 0x25
  s_cbranch_scc1 L_p108_3
  s_cmp_gt_i32 s69, L_order_end-L_order-16373
  s_cbranch_scc1 L_p108_2
  s_waitcnt vmcnt(6)
L_p108_2:
  s_waitcnt vmcnt(10)
L_p108_3:
  s_waitcnt vmcnt(11)
  buffer_load_dwordx4 v[80:83], v212, s[36:39], 0 offen nt
  v_mov_b32_dpp v18, v114 row_newbcast:2 row_mask:0xf bank_mask:0xf
  v_cvt_f32_i32 v96, v96
  v_cvt_f32_i32 v97, v97
  v_cvt_f32_i32 v98, v98
  v_cvt_f32_i32 v99, v99
  v_pk_fma_f32 v[52:53], v[96:97], v[18:19], v[52:53] op_sel_hi:[1,0,1]
  v_pk_fma_f32 v[54:55], v[98:99], v[18:19], v[54:55] op_sel_hi:[1,0,1]
  s_cmpk_gt_i32 s69, 0x25
  s_cbranch_scc1 L_p109_3
  s_cmp_gt_i32 s69, L_order_end-L_order-16427
  s_cbranch_scc1 L_p109_0
  s_waitcnt vmcnt(6)
L_p109_0:
  s_waitcnt vmcnt(7)
L_p109_3:
  s_waitcnt vmcnt(11)
  buffer_load_dwordx4 v[84:87], v213, s[36:39], 0 offen nt
  s_cmp_eq_u32 s62, 0
  s_cbranch_scc1 L_flv
  v_pk_add_f32 v[52:53], v[52:53], v[44:45]
  v_pk_add_f32 v[54:55], v[54:55], v[46:47]
  v_pk_add_f32 v[56:57], v[56:57], v[48:49]
  v_pk_add_f32 v[58:59], v[58:59], v[50:51]
  v_pk_add_f32 v[60:61], v[60:61], v[40:41]
  v_pk_add_f32 v[62:63], v[62:63], v[42:43]
  s_branch L_fmv
.p2align 3
L_flv:
  v_pk_add_f32 v[52:53], v[52:53], v[40:41]
  v_pk_add_f32 v[54:55], v[54:55], v[42:43]
  v_pk_add_f32 v[56:57], v[56:57], v[44:45]
  v_pk_add_f32 v[58:59], v[58:59], v[46:47]
  v_pk_add_f32 v[60:61], v[60:61], v[48:49]
  v_pk_add_f32 v[62:63], v[62:63], v[50:51]
L_fmv:
  v_add_u32_e64 v9, s43, 16
  ds_write_b32 v14, v9 offset:24
  s_waitcnt vmcnt(8)
  s_mov_b64 exec, 3
  s_add_u32 s44, s78, 0x03030303
  v_msad_u8 v9, s78, v36, 0
  v_msad_u8 v10, s44, v36, 0
  v_msad_u8 v9, s78, v37, v9
  v_msad_u8 v10, s44, v37, v10
  v_msad_u8 v9, s78, v38, v9
  v_msad_u8 v10, s44, v38, v10
  global_store_byte v7, v8, s[30:31]
  global_load_dwordx3 v[36:38], v235, s[30:31] sc1
  v_sub_u32 v9, v9, v10
  v_add_u32 v8, 1, v8
  v_add3_u32 v10, v26, v27, s58
  v_readlane_b32 s66, v9, 0
  v_readlane_b32 s67, v9, 1
  v_readlane_b32 s91, v10, 0
  s_add_u32 s78, s78, 0x01010101
  s_mov_b64 exec, -1
  s_lshl1_add_u32 s69, s91, s95
  s_add_u32 s95, s66, s67
  s_add_u32 s69, s69, s95
  v_mov_b32_dpp v18, v114 row_newbcast:6 row_mask:0xf bank_mask:0xf
  v_cvt_f32_i32 v100, v100
  v_cvt_f32_i32 v101, v101
  v_cvt_f32_i32 v102, v102
  v_cvt_f32_i32 v103, v103
  v_pk_fma_f32 v[60:61], v[100:101], v[18:19], v[60:61] op_sel_hi:[1,0,1]
  v_pk_fma_f32 v[62:63], v[102:103], v[18:19], v[62:63] op_sel_hi:[1,0,1]
  s_cmpk_gt_i32 s69, 0x25
  s_cbranch_scc1 L_p110_3
  s_cmp_gt_i32 s69, L_order_end-L_order-16403
  s_cbranch_scc1 L_p110_1
  s_waitcnt vmcnt(5)
L_p110_1:
  s_waitcnt vmcnt(8)
L_p110_3:
  s_waitcnt vmcnt(9)
  buffer_load_dwordx4 v[88:91], v214, s[36:39], 0 offen nt
  v_mov_b32_dpp v18, v114 row_newbcast:3 row_mask:0xf bank_mask:0xf
  v_cvt_f32_i32 v104, v104
  v_cvt_f32_i32 v105, v105
  v_cvt_f32_i32 v106, v106
  v_cvt_f32_i32 v107, v107
  v_pk_fma_f32 v[56:57], v[104:105], v[18:19], v[56:57] op_sel_hi:[1,0,1]
  v_pk_fma_f32 v[58:59], v[106:107], v[18:19], v[58:59] op_sel_hi:[1,0,1]
  s_cmpk_gt_i32 s69, 0x25
  s_cbranch_scc1 L_p111_3
  s_cmp_gt_i32 s69, L_order_end-L_order-16373
  s_cbranch_scc1 L_p111_2
  s_waitcnt vmcnt(6)
L_p111_2:
  s_waitcnt vmcnt(9)
L_p111_3:
  s_waitcnt vmcnt(10)
  buffer_load_dwordx4 v[92:95], v215, s[36:39], 0 offen nt
  v_mov_b32_dpp v18, v114 row_newbcast:7 row_mask:0xf bank_mask:0xf
  v_cvt_f32_i32 v108, v108
  v_cvt_f32_i32 v109, v109
  v_cvt_f32_i32 v110, v110
  v_cvt_f32_i32 v111, v111
  v_pk_fma_f32 v[52:53], v[108:109], v[18:19], v[52:53] op_sel_hi:[1,0,1]
  v_pk_fma_f32 v[54:55], v[110:111], v[18:19], v[54:55] op_sel_hi:[1,0,1]
  s_cmpk_gt_i32 s69, 0x25
  s_cbranch_scc1 L_p112_3
  s_cmp_gt_i32 s69, L_order_end-L_order-16427
  s_cbranch_scc1 L_p112_0
  s_waitcnt vmcnt(6)
L_p112_0:
  s_waitcnt vmcnt(7)
L_p112_3:
  s_waitcnt vmcnt(10)
  buffer_load_dwordx4 v[96:99], v216, s[36:39], 0 offen nt
  s_add_u32 s43, s43, 1
  v_permlane32_swap_b32 v52, v54
  v_permlane32_swap_b32 v53, v55
  v_permlane32_swap_b32 v56, v58
  v_permlane32_swap_b32 v57, v59
  v_permlane32_swap_b32 v60, v62
  v_permlane32_swap_b32 v61, v63
  v_add_f32 v52, v52, v58
  v_add_f32 v53, v53, v59
  v_add_f32 v56, v56, v62
  v_add_f32 v57, v57, v63
  v_add_f32 v60, v60, v54
  v_add_f32 v61, v61, v55
  s_add_u32 s44, s43, 16
  s_cmp_eq_u32 s43, 15
  s_cselect_b64 vcc, -1, 0
  v_mov_b32 v4, s44
  v_permlane16_swap_b32 v52, v53
  v_permlane16_swap_b32 v56, v57
  v_permlane16_swap_b32 v60, v61
  v_add_f32 v52, v52, v61
  v_add_f32 v56, v56, v53
  v_add_f32 v60, v60, v57
  s_waitcnt lgkmcnt(0)
  ds_write_b32 v3, v52 offset:0
  ds_write_b32 v3, v56 offset:256
  ds_write_b32 v3, v60 offset:512
  ds_write_b32 v6, v4 offset:0
  v_mov_b32_e64 v114, v115
  v_add_u32 v3, 3072, v3
  s_mov_b64 s[32:33], s[36:37]
  s_add_u32 s45, s43, 1
  s_min_u32 s45, s45, 15
  s_lshl_b32 s68, s45, 2
  s_lshr_b64 s[64:65], s[92:93], s68
  s_and_b32 s68, s64, 15
  s_lshl_b32 s44, s68, 2
  s_lshr_b64 s[64:65], s[96:97], s44
  s_and_b32 s64, s64, 15
  s_lshl4_add_u32 s68, s68, s64
  s_mul_i32 s44, s68, 1572864
  s_add_u32 s36, s12, s44
  s_addc_u32 s37, s13, 0
  s_branch L_v
L_vtail:
  s_waitcnt vmcnt(10)
  v_mov_b32_dpp v18, v113 row_newbcast:7 row_mask:0xf bank_mask:0xf
  v_cvt_f32_i32 v76, v76
  v_cvt_f32_i32 v77, v77
  v_cvt_f32_i32 v78, v78
  v_cvt_f32_i32 v79, v79
  v_pk_fma_f32 v[60:61], v[76:77], v[18:19], v[60:61] op_sel_hi:[1,0,1]
  v_pk_fma_f32 v[62:63], v[78:79], v[18:19], v[62:63] op_sel_hi:[1,0,1]
  s_waitcnt vmcnt(9)
  v_mov_b32_dpp v18, v114 row_newbcast:0 row_mask:0xf bank_mask:0xf
  v_cvt_f32_i32 v80, v80
  v_cvt_f32_i32 v81, v81
  v_cvt_f32_i32 v82, v82
  v_cvt_f32_i32_e64 v83, v83
  v_pk_fma_f32 v[48:49], v[80:81], v[18:19], v[48:49] op_sel_hi:[1,0,1]
  v_pk_fma_f32 v[50:51], v[82:83], v[18:19], v[50:51] op_sel_hi:[1,0,1]
  s_waitcnt vmcnt(8)
  v_mov_b32_dpp v18, v114 row_newbcast:4 row_mask:0xf bank_mask:0xf
  v_cvt_f32_i32 v84, v84
  v_cvt_f32_i32 v85, v85
  v_cvt_f32_i32 v86, v86
  v_cvt_f32_i32_e64 v87, v87
  v_pk_fma_f32 v[44:45], v[84:85], v[18:19], v[44:45] op_sel_hi:[1,0,1]
  v_pk_fma_f32 v[46:47], v[86:87], v[18:19], v[46:47] op_sel_hi:[1,0,1]
  s_waitcnt vmcnt(6)
  v_mov_b32_dpp v18, v114 row_newbcast:1 row_mask:0xf bank_mask:0xf
  v_cvt_f32_i32 v88, v88
  v_cvt_f32_i32 v89, v89
  v_cvt_f32_i32 v90, v90
  v_cvt_f32_i32_e64 v91, v91
  v_pk_fma_f32 v[40:41], v[88:89], v[18:19], v[40:41] op_sel_hi:[1,0,1]
  v_pk_fma_f32 v[42:43], v[90:91], v[18:19], v[42:43] op_sel_hi:[1,0,1]
  s_waitcnt vmcnt(5)
  v_mov_b32_dpp v18, v114 row_newbcast:5 row_mask:0xf bank_mask:0xf
  v_cvt_f32_i32 v92, v92
  v_cvt_f32_i32 v93, v93
  v_cvt_f32_i32 v94, v94
  v_cvt_f32_i32_e64 v95, v95
  v_pk_fma_f32 v[48:49], v[92:93], v[18:19], v[48:49] op_sel_hi:[1,0,1]
  v_pk_fma_f32 v[50:51], v[94:95], v[18:19], v[50:51] op_sel_hi:[1,0,1]
  s_cmp_eq_u32 s62, 0
  s_cbranch_scc1 L_flt
  v_pk_add_f32 v[52:53], v[52:53], v[44:45]
  v_pk_add_f32 v[54:55], v[54:55], v[46:47]
  v_pk_add_f32 v[56:57], v[56:57], v[48:49]
  v_pk_add_f32 v[58:59], v[58:59], v[50:51]
  v_pk_add_f32 v[60:61], v[60:61], v[40:41]
  v_pk_add_f32 v[62:63], v[62:63], v[42:43]
  s_branch L_fmt
.p2align 3
L_flt:
  v_pk_add_f32 v[52:53], v[52:53], v[40:41]
  v_pk_add_f32 v[54:55], v[54:55], v[42:43]
  v_pk_add_f32 v[56:57], v[56:57], v[44:45]
  v_pk_add_f32 v[58:59], v[58:59], v[46:47]
  v_pk_add_f32 v[60:61], v[60:61], v[48:49]
  v_pk_add_f32 v[62:63], v[62:63], v[50:51]
L_fmt:
  s_waitcnt vmcnt(4)
  v_mov_b32_dpp v18, v114 row_newbcast:2 row_mask:0xf bank_mask:0xf
  v_cvt_f32_i32 v96, v96
  v_cvt_f32_i32 v97, v97
  v_cvt_f32_i32 v98, v98
  v_cvt_f32_i32_e64 v99, v99
  v_pk_fma_f32 v[52:53], v[96:97], v[18:19], v[52:53] op_sel_hi:[1,0,1]
  v_pk_fma_f32 v[54:55], v[98:99], v[18:19], v[54:55] op_sel_hi:[1,0,1]
  s_waitcnt vmcnt(2)
  v_mov_b32_dpp v18, v114 row_newbcast:6 row_mask:0xf bank_mask:0xf
  v_cvt_f32_i32 v100, v100
  v_cvt_f32_i32 v101, v101
  v_cvt_f32_i32 v102, v102
  v_cvt_f32_i32_e64 v103, v103
  v_pk_fma_f32 v[60:61], v[100:101], v[18:19], v[60:61] op_sel_hi:[1,0,1]
  v_pk_fma_f32 v[62:63], v[102:103], v[18:19], v[62:63] op_sel_hi:[1,0,1]
  s_waitcnt vmcnt(1)
  v_mov_b32_dpp v18, v114 row_newbcast:3 row_mask:0xf bank_mask:0xf
  v_cvt_f32_i32 v104, v104
  v_cvt_f32_i32 v105, v105
  v_cvt_f32_i32 v106, v106
  v_cvt_f32_i32_e64 v107, v107
  v_pk_fma_f32 v[56:57], v[104:105], v[18:19], v[56:57] op_sel_hi:[1,0,1]
  v_pk_fma_f32 v[58:59], v[106:107], v[18:19], v[58:59] op_sel_hi:[1,0,1]
  v_permlane32_swap_b32 v60, v62
  v_permlane32_swap_b32 v61, v63
  v_permlane32_swap_b32 v56, v58
  v_permlane32_swap_b32 v57, v59
  v_add_f32_e64 v56, v56, v62
  v_add_f32 v57, v57, v63
  s_waitcnt vmcnt(0)
  v_mov_b32_dpp v18, v114 row_newbcast:7 row_mask:0xf bank_mask:0xf
  v_cvt_f32_i32 v108, v108
  v_cvt_f32_i32 v109, v109
  v_cvt_f32_i32 v110, v110
  v_cvt_f32_i32 v111, v111
  v_pk_fma_f32 v[52:53], v[108:109], v[18:19], v[52:53] op_sel_hi:[1,0,1]
  v_pk_fma_f32 v[54:55], v[110:111], v[18:19], v[54:55] op_sel_hi:[1,0,1]
  v_permlane16_swap_b32 v56, v57
  s_nop 0
  v_permlane32_swap_b32 v52, v54
  v_permlane32_swap_b32 v53, v55
  v_add_f32 v60, v60, v54
  v_add_f32 v61, v61, v55
  v_add_f32_e64 v52, v52, v58
  v_add_f32 v53, v53, v59
  v_permlane16_swap_b32 v60, v61
  v_add_f32 v60, v60, v57
  v_permlane16_swap_b32 v52, v53
  ds_write_b32 v3, v60 offset:512
  v_add_f32 v56, v56, v53
  v_add_f32 v52, v52, v61
  ds_write_b32 v3, v56 offset:256
  ds_write_b32 v3, v52 offset:0
  s_waitcnt lgkmcnt(0)
  s_barrier
  s_endpgm
L_helper:
  s_getreg_b32 s81, hwreg(HW_REG_HW_ID, 13, 2)
  s_getreg_b32 s79, hwreg(HW_REG_HW_ID, 8, 4)
  s_getreg_b32 s46, hwreg(HW_REG_XCC_ID, 0, 3)
  s_mul_i32 s46, s46, 4352
  s_add_u32 s46, s46, 8126464
  v_lshrrev_b32_e64 v24, 1, v20
  v_lshl_add_u32 v42, v24, 8, s46
  v_and_b32_e64 v24, 1, v20
  v_lshl_add_u32 v42, v24, 4, v42
  s_mov_b64 exec, 0x3ffff
  global_store_dwordx4 v42, v[48:51], s[30:31]
  s_mov_b64 exec, -1
  s_mov_b32 s43, 2
  s_add_u32 s68, s42, 48
  s_mul_i32 s44, s68, 384
  s_add_u32 s32, s4, s44
  s_addc_u32 s33, s5, 0
  global_load_dwordx2 v[68:69], v26, s[32:33]
  global_load_dwordx2 v[70:71], v27, s[32:33]
  s_setprio 0
  s_getpc_b64 s[82:83]
L_pc113:
  s_lshl_b32 s44, s2, 6
  s_add_u32 s44, s44, L_order-L_pc113
  s_add_u32 s82, s82, s44
  s_addc_u32 s83, s83, 0
  s_load_dwordx2 s[92:93], s[82:83], 0
  s_load_dwordx2 s[96:97], s[82:83], 8
  s_mov_b32 s94, 4000000
  s_and_b32 s41, s2, 7
  s_lshl_b32 s41, s41, 1
  s_bitcmp1_b32 s2, 3
  s_addc_u32 s41, s41, 0
  s_load_dword s3, s[82:83], 24
  s_load_dwordx2 s[98:99], s[82:83], 16
  s_waitcnt vmcnt(0)
  ds_write_b32 v14, v38 offset:24
  s_waitcnt lgkmcnt(0)
  v_min_u32 v22, 2, v20
  v_lshlrev_b32 v23, 3, v22
  v_bfe_u32 v23, s99, v23, 8
  v_mul_u32_u24 v36, 4352, v23
  v_add_u32 v36, 7340032, v36
  v_and_b32 v23, 15, v23
  v_lshlrev_b32 v37, 4, v23
  v_lshl_add_u32 v22, v22, 4, s42
  v_mul_u32_u24 v45, 4352, v22
  v_add_u32 v45, 7340032, v45
  s_and_b32 s45, s81, 2
  s_lshl_b32 s44, s45, 9
  s_add_u32 s44, s44, s46
  v_add_u32 v44, s44, v20
  s_lshl_b32 s45, s45, 1
  s_add_u32 s46, s46, s45
  s_add_u32 s46, s46, 2048
  v_mov_b32_e64 v43, s46
  v_mul_u32_u24 v39, 384, v20
  v_add_u32 v39, 7864320, v39
  v_mov_b32 v40, 0
  s_mov_b32 s47, 0
  s_mov_b32 s90, 0
  s_mov_b32 s80, 0
  v_add_u32 v33, 0, v20
  s_and_b32 s44, s41, 1
  v_add_u32_e64 v23, s44, v33
  v_cmp_le_u32 vcc, 43, v23
  s_add_u32 s45, s44, 42
  v_mov_b32 v24, s45
  v_cndmask_b32 v24, 0, v24, vcc
  v_cmp_le_u32 vcc, 86, v23
  v_add_u32 v22, v33, v24
  s_sub_u32 s45, 43, s44
  v_mov_b32 v24, s45
  v_cndmask_b32 v24, 0, v24, vcc
  s_mul_i32 s44, s44, 43
  s_lshr_b32 s45, s41, 1
  s_lshl_b32 s45, s45, 8
  s_add_u32 s44, s44, s45
  v_add3_u32 v22, v22, v24, s44
  v_and_b32 v33, 255, v22
  v_lshlrev_b32 v33, 1, v33
  v_add_u32 v34, 64, v20
  s_and_b32 s44, s41, 1
  v_add_u32 v23, s44, v34
  v_cmp_le_u32 vcc, 43, v23
  s_add_u32 s45, s44, 42
  v_mov_b32 v24, s45
  v_cndmask_b32 v24, 0, v24, vcc
  v_cmp_le_u32 vcc, 86, v23
  v_add_u32 v22, v34, v24
  s_sub_u32 s45, 43, s44
  v_mov_b32 v24, s45
  v_cndmask_b32 v24, 0, v24, vcc
  s_mul_i32 s44, s44, 43
  s_lshr_b32 s45, s41, 1
  s_lshl_b32 s45, s45, 8
  s_add_u32 s44, s44, s45
  v_add3_u32 v22, v22, v24, s44
  v_and_b32 v34, 255, v22
  v_lshlrev_b32 v34, 1, v34
  v_lshlrev_b32 v46, 2, v20
  v_mul_u32_u24_e64 v199, 12, v20
  v_add_u32 v199, 45568, v199
  s_mov_b32 s101, 0
  v_mov_b32 v47, 118912
  v_mov_b32 v51, -1
  v_mov_b32 v60, 0
  v_mov_b32 v61, 0
  v_mov_b32 v62, 0
  v_mov_b32 v63, 0
  v_mov_b32 v64, 0
  v_mov_b32 v65, 0
  v_mov_b32 v66, 0
  v_mov_b32 v67, 0
  s_and_b32 s45, s2, 7
  s_lshl_b32 s45, s45, 9
  v_and_b32_e64 v22, 31, v20
  v_lshl_add_u32 v22, v22, 4, s45
  v_lshrrev_b32_e64 v23, 5, v20
  v_lshl_add_u32 v22, v23, 16, v22
  v_lshlrev_b32 v23, 2, v23
  s_lshr_b32 s44, s96, 0
  v_bfe_u32 v24, s44, v23, 4
  v_lshl_add_u32 v188, v24, 12, v22
  v_add_u32 v22, 0x20000, v22
  s_lshr_b32 s44, s96, 8
  v_bfe_u32 v24, s44, v23, 4
  v_lshl_add_u32 v189, v24, 12, v22
  v_add_u32 v22, 0x20000, v22
  s_lshr_b32 s44, s96, 16
  v_bfe_u32 v24, s44, v23, 4
  v_lshl_add_u32 v190, v24, 12, v22
  v_add_u32 v22, 0x20000, v22
  s_lshr_b32 s44, s96, 24
  v_bfe_u32 v24, s44, v23, 4
  v_lshl_add_u32 v191, v24, 12, v22
  v_add_u32 v22, 0x20000, v22
  s_lshr_b32 s44, s97, 0
  v_bfe_u32 v24, s44, v23, 4
  v_lshl_add_u32 v192, v24, 12, v22
  v_add_u32 v22, 0x20000, v22
  s_lshr_b32 s44, s97, 8
  v_bfe_u32 v24, s44, v23, 4
  v_lshl_add_u32 v193, v24, 12, v22
  v_add_u32 v22, 0x20000, v22
  s_lshr_b32 s44, s97, 16
  v_bfe_u32 v24, s44, v23, 4
  v_lshl_add_u32 v194, v24, 12, v22
  v_add_u32 v22, 0x20000, v22
  s_lshr_b32 s44, s97, 24
  v_bfe_u32 v24, s44, v23, 4
  v_lshl_add_u32 v195, v24, 12, v22
  s_mov_b32 s69, 0
  s_movk_i32 m0, 4608
  s_branch L_hq_nl
L_hk:
  s_sub_u32 s47, s43, 1
L_hsw:
  ds_read_b128 v[104:107], v14 offset:0
  s_waitcnt lgkmcnt(0)
  v_min_u32_e64 v104, v104, v105
  v_min3_u32 v104, v104, v106, v107
  s_nop 0
  v_readfirstlane_b32 s46, v104
  s_cmp_ge_u32 s46, s47
  s_cbranch_scc1 L_hsw_ok
  s_cmp_eq_u32 s94, 0
  s_cbranch_scc1 L_hsw_ok
  s_sub_u32 s94, s94, 1
  s_sleep 1
  s_branch L_hsw
L_hsw_ok:
  s_bitcmp1_b32 s80, s47
  s_cbranch_scc0 L_fas
  s_mul_i32 s44, s47, 384
  s_add_u32 s44, s44, 7864320
  s_movk_i32 s78, 1
  s_atomic_add s78, s[30:31], s44 glc
  s_mov_b64 exec, 1
  global_load_dword v41, v43, s[30:31] offset:8 sc1
  s_mov_b64 exec, -1
L_fas:
  s_cmp_lt_u32 s43, 6
  s_cbranch_scc1 L_hs_done
  s_add_u32 s68, s69, 2
  s_min_u32 s68, s68, s47
L_hs:
  ds_read_u16_d16_hi v60, v33 offset:4608
  ds_read_u16_d16_hi v61, v34 offset:4608
  ds_read_u16_d16_hi v62, v33 offset:12800
  ds_read_u16_d16_hi v63, v34 offset:12800
  ds_read_u16_d16_hi v64, v33 offset:20992
  ds_read_u16_d16_hi v65, v34 offset:20992
  ds_read_u16_d16_hi v66, v33 offset:29184
  ds_read_u16_d16_hi v67, v34 offset:29184
  v_add_u32_e64 v200, s101, v199
  v_add_u32 v201, 1536, v200
  s_addk_i32 s101, 3072
  s_cmpk_eq_u32 s101, 18432
  s_cselect_b32 s101, 0, s101
  s_add_u32 s69, s69, 1
  s_waitcnt lgkmcnt(4)
  ds_read2_b32 v[76:77], v200 offset0:0 offset1:1
  ds_read_b32 v72, v200 offset:8
  ds_read2_b32 v[78:79], v200 offset0:192 offset1:193
  ds_read_b32 v73, v200 offset:776
  ds_read2_b32 v[80:81], v201 offset0:0 offset1:1
  ds_read_b32 v74, v201 offset:8
  ds_read2_b32 v[82:83], v201 offset0:192 offset1:193
  ds_read_b32 v75, v201 offset:776
  s_waitcnt lgkmcnt(0)
  v_add_f32 v76, v76, v77
  v_add_f32 v78, v78, v79
  v_add_f32 v80, v80, v81
  v_add_f32 v82, v82, v83
  v_add_f32 v72, v72, v76
  v_add_f32 v73, v73, v78
  v_add_f32 v74, v74, v80
  v_add_f32 v75, v75, v82
  v_fma_f32 v72, -v62, v74, v72
  v_fma_f32 v73, -v63, v75, v73
  v_mul_f32 v74, s67, v60
  v_mul_f32 v75, s67, v61
  v_mul_f32 v72, v72, v74
  v_mul_f32 v73, v73, v75
  v_max_f32 v48, v72, v73
  s_nop 1
  v_max_f32_dpp v48, v48, v48 row_ror:8 row_mask:0xf bank_mask:0xf
  s_nop 1
  v_max_f32_dpp v48, v48, v48 row_ror:4 row_mask:0xf bank_mask:0xf
  s_nop 1
  v_max_f32_dpp v48, v48, v48 row_ror:2 row_mask:0xf bank_mask:0xf
  s_nop 1
  v_max_f32_dpp v48, v48, v48 row_ror:1 row_mask:0xf bank_mask:0xf
  v_mov_b32 v22, v48
  s_nop 1
  v_permlane16_swap_b32 v48, v22
  v_max_f32 v48, v48, v22
  v_mov_b32 v22, v48
  s_nop 1
  v_permlane32_swap_b32 v48, v22
  v_max_f32 v48, v48, v22
  v_sub_f32 v72, v72, v48
  v_sub_f32 v73, v73, v48
  v_exp_f32 v72, v72
  v_exp_f32 v73, v73
  s_nop 0
  v_add_f32 v49, v72, v73
  v_mul_f32 v72, v72, v64
  v_mul_f32 v73, v73, v65
  v_mul_f32 v50, v72, v66
  v_fmac_f32_e64 v50, v73, v67
  ds_write_b32 v46, v72 offset:37376
  ds_write_b32 v46, v73 offset:37632
  s_nop 1
  v_add_f32_dpp v49, v49, v49 row_ror:8 row_mask:0xf bank_mask:0xf
  s_nop 1
  v_add_f32_dpp v49, v49, v49 row_ror:4 row_mask:0xf bank_mask:0xf
  s_nop 1
  v_add_f32_dpp v49, v49, v49 row_ror:2 row_mask:0xf bank_mask:0xf
  s_nop 1
  v_add_f32_dpp v49, v49, v49 row_ror:1 row_mask:0xf bank_mask:0xf
  v_mov_b32 v22, v49
  s_nop 1
  v_permlane16_swap_b32 v49, v22
  v_add_f32 v49, v49, v22
  v_mov_b32_e64 v22, v49
  s_nop 1
  v_permlane32_swap_b32 v49, v22
  v_add_f32 v49, v49, v22
  s_nop 1
  v_add_f32_dpp v50, v50, v50 row_ror:8 row_mask:0xf bank_mask:0xf
  s_nop 1
  v_add_f32_dpp v50, v50, v50 row_ror:4 row_mask:0xf bank_mask:0xf
  s_nop 1
  v_add_f32_dpp v50, v50, v50 row_ror:2 row_mask:0xf bank_mask:0xf
  s_nop 1
  v_add_f32_dpp v50, v50, v50 row_ror:1 row_mask:0xf bank_mask:0xf
  v_mov_b32 v22, v50
  s_nop 1
  v_permlane16_swap_b32 v50, v22
  v_add_f32 v50, v50, v22
  v_mov_b32 v22, v50
  s_nop 1
  v_permlane32_swap_b32 v50, v22
  v_add_f32 v50, v50, v22
  v_mov_b32 v22, s69
  ds_write_b128 v47, v[48:51]
  ds_write_b32 v14, v22 offset:20
  v_add_u32 v46, 512, v46
  v_add_u32_e64 v47, 16, v47
  v_add_u32 v33, 512, v33
  v_add_u32 v34, 512, v34
  s_cmp_lt_u32 s69, s68
  s_cbranch_scc1 L_hs
L_hs_done:
  s_bitcmp1_b32 s80, s47
  s_cbranch_scc0 L_fbs
  s_waitcnt vmcnt(0) lgkmcnt(0)
  v_readlane_b32 s46, v40, s47
  s_sub_u32 s78, s78, s46
  s_bfe_u32 s46, s78, 0x80000
  s_min_u32 s46, s46, 15
  s_lshl_b32 s46, s46, 1
  s_sub_u32 s46, s46, 15
  v_readfirstlane_b32 s95, v41
  s_mul_i32 s45, s46, 6
  s_ashr_i32 s44, s95, 3
  s_sub_u32 s95, s95, s44
  s_cmp_lt_i32 s46, 0
  s_cselect_b32 s95, s95, 0
  s_cselect_b32 s45, -48, 0
  s_add_u32 s45, s45, s95
  v_mov_b32_e64 v41, s45
  s_lshl4_add_u32 s46, s46, s95
  s_cmp_gt_i32 s46, 0
  s_cselect_b32 s44, 3, 6
  s_mul_i32 s46, s46, s44
  s_add_u32 s46, s46, 128
  s_ashr_i32 s46, s46, 8
  v_mov_b32_e64 v42, s46
  s_mov_b64 exec, 1
  global_store_dword v43, v42, s[30:31]
  global_store_dword v43, v41, s[30:31] offset:8
  s_mov_b64 exec, -1
L_fbs:
  s_cmp_eq_u32 s47, 1
  s_cbranch_scc0 L_el
  s_bitcmp0_b32 s81, 0
  s_cbranch_scc0 L_el
  s_mov_b64 exec, 0xffff
  global_load_ubyte v42, v44, s[30:31] sc1
  s_waitcnt vmcnt(0)
  v_cmp_ne_u32 s[64:65], 0, v42
  s_lshr_b32 s44, s64, s79
  s_bcnt1_i32_b32 s44, s44
  s_sub_u32 s45, s44, 1
  s_cmp_lt_u32 s45, 7
  s_cbranch_scc0 L_el
  s_lshl_b32 s80, 0x10204081, s45
  s_and_b32 s80, s80, 0x7ffffffc
  s_mov_b32 exec_lo, s80
  global_load_dword v40, v39, s[30:31] sc1
L_el:
  s_mov_b64 exec, -1
L_hq:
  s_add_u32 s43, s43, 1
  s_sub_u32 s44, s43, 4
  s_cmp_gt_u32 s44, 12
  s_cbranch_scc1 L_hq_nl
  s_waitcnt vmcnt(0)
  v_lshlrev_b32 v76, 16, v68
  v_and_b32 v77, s66, v68
  v_lshlrev_b32 v78, 16, v69
  v_and_b32 v79, s66, v69
  v_lshlrev_b32 v80, 16, v70
  v_and_b32 v81, s66, v70
  v_lshlrev_b32 v82, 16, v71
  v_and_b32 v83, s66, v71
  v_mul_f32 v76, v76, v52
  v_mul_f32 v77, v77, v53
  v_mul_f32 v78, v78, v54
  v_mul_f32 v79, v79, v55
  v_mul_f32 v80, v80, v56
  v_mul_f32 v81, v81, v57
  v_mul_f32 v82, v82, v58
  v_mul_f32 v83, v83, v59
  v_cvt_pk_bf16_f32 v84, v76, v80
  v_cvt_pk_bf16_f32 v85, v77, v81
  v_cvt_pk_bf16_f32 v86, v78, v82
  v_cvt_pk_bf16_f32 v87, v79, v83
  v_lshlrev_b32 v76, 16, v84
  v_and_b32 v80, s66, v84
  v_lshlrev_b32 v77, 16, v85
  v_and_b32 v81, s66, v85
  v_lshlrev_b32 v78, 16, v86
  v_and_b32 v82, s66, v86
  v_lshlrev_b32 v79, 16, v87
  v_and_b32 v83, s66, v87
  v_fma_f32 v76, v80, v30, v76
  v_fma_f32 v77, v81, v30, v77
  v_fma_f32 v78, v82, v30, v78
  v_fma_f32 v79, v83, v30, v79
  v_cvt_pk_bf16_f32 v84, v76, v77
  v_cvt_pk_bf16_f32 v85, v78, v79
  v_xor_b32 v86, v31, v84
  v_xor_b32 v87, v31, v85
  v_mov_b32_e64 v22, s43
  ds_write_b16 v28, v84 offset:512
  ds_write_b16_d16_hi v28, v84 offset:516
  ds_write_b16 v28, v85 offset:520
  ds_write_b16_d16_hi v28, v85 offset:524
  ds_write_b16 v29, v86 offset:514
  ds_write_b16_d16_hi v29, v86 offset:518
  ds_write_b16 v29, v87 offset:522
  ds_write_b16_d16_hi v29, v87 offset:526
  ds_write_b32 v14, v22 offset:16
  v_add_u32 v28, 1024, v28
  v_add_u32 v29, 1024, v29
  v_and_b32 v28, 0xfff, v28
  v_and_b32 v29, 0xfff, v29
  s_cmp_eq_u32 s43, 16
  s_cbranch_scc1 L_hq_nl
  s_lshl_b32 s44, s43, 2
  s_lshr_b64 s[64:65], s[96:97], s44
  s_and_b32 s64, s64, 15
  s_lshl4_add_u32 s68, s43, s64
  s_mul_i32 s44, s68, 384
  s_add_u32 s32, s4, s44
  s_addc_u32 s33, s5, 0
  global_load_dwordx2 v[68:69], v26, s[32:33]
  global_load_dwordx2 v[70:71], v27, s[32:33]
L_hq_nl:
  s_sub_u32 s44, s43, 5
  s_cmp_lt_u32 s44, 2
  s_cbranch_scc0 L_sc_done
  global_load_lds_dwordx4 v188, s[8:9]
  s_addk_i32 m0, 1024
  s_waitcnt vmcnt(3)
  global_load_lds_dwordx4 v189, s[8:9]
  s_addk_i32 m0, 1024
  s_waitcnt vmcnt(3)
  global_load_lds_dwordx4 v190, s[8:9]
  s_addk_i32 m0, 1024
  s_waitcnt vmcnt(3)
  global_load_lds_dwordx4 v191, s[8:9]
  s_addk_i32 m0, 1024
  s_waitcnt vmcnt(3)
  global_load_lds_dwordx4 v192, s[8:9]
  s_addk_i32 m0, 1024
  s_waitcnt vmcnt(3)
  global_load_lds_dwordx4 v193, s[8:9]
  s_addk_i32 m0, 1024
  s_waitcnt vmcnt(3)
  global_load_lds_dwordx4 v194, s[8:9]
  s_addk_i32 m0, 1024
  s_waitcnt vmcnt(3)
  global_load_lds_dwordx4 v195, s[8:9]
  s_addk_i32 m0, 1024
  s_mov_b64 s[8:9], s[10:11]
  s_mov_b64 s[10:11], s[14:15]
  s_mov_b64 s[14:15], s[16:17]
  s_waitcnt vmcnt(3)
  global_load_lds_dwordx4 v188, s[8:9]
  s_addk_i32 m0, 1024
  s_waitcnt vmcnt(3)
  global_load_lds_dwordx4 v189, s[8:9]
  s_addk_i32 m0, 1024
  s_waitcnt vmcnt(3)
  global_load_lds_dwordx4 v190, s[8:9]
  s_addk_i32 m0, 1024
  s_waitcnt vmcnt(3)
  global_load_lds_dwordx4 v191, s[8:9]
  s_addk_i32 m0, 1024
  s_waitcnt vmcnt(3)
  global_load_lds_dwordx4 v192, s[8:9]
  s_addk_i32 m0, 1024
  s_waitcnt vmcnt(3)
  global_load_lds_dwordx4 v193, s[8:9]
  s_addk_i32 m0, 1024
  s_waitcnt vmcnt(3)
  global_load_lds_dwordx4 v194, s[8:9]
  s_addk_i32 m0, 1024
  s_waitcnt vmcnt(3)
  global_load_lds_dwordx4 v195, s[8:9]
  s_addk_i32 m0, 1024
  s_mov_b64 s[8:9], s[10:11]
  s_mov_b64 s[10:11], s[14:15]
  s_mov_b64 s[14:15], s[16:17]
  s_cmp_eq_u32 s43, 6
  s_cbranch_scc0 L_sc_done
  s_waitcnt vmcnt(0)
L_sc_done:
  s_cmp_eq_u32 s43, 16
  s_cbranch_scc0 L_hq_skip
  s_cmp_eq_u32 s3, 0
  s_cbranch_scc0 L_hq_skip
  s_mov_b64 exec, 7
  global_store_dword v45, v14, s[30:31] sc1
  s_waitcnt vmcnt(0)
  s_mov_b64 exec, 1
  global_store_dword v37, v38, s[28:29] sc1
  s_mov_b64 exec, -1
L_hq_skip:
  s_waitcnt lgkmcnt(0)
  s_cmp_lt_u32 s43, 18
  s_cbranch_scc1 L_hk
  v_and_b32 v24, 15, v20
  v_lshlrev_b32 v24, 1, v24
  global_load_ushort v25, v24, s[82:83] offset:32
  s_mov_b32 s43, 0
  v_min_u32 v28, 23, v20
  v_lshlrev_b32_e64 v28, 4, v28
  v_lshlrev_b32 v22, 1, v28
  s_and_b32 s44, s41, 1
  v_lshl_add_u32 v196, s44, 8, v22
  v_subrev_u32 v197, 768, v196
  v_min_u32_e64 v196, v196, v197
  v_subrev_u32 v29, 256, v196
  v_add_u32 v197, 512, v196
  v_min_u32_e64 v197, v29, v197
  v_subrev_u32 v29, 512, v196
  v_add_u32 v198, 256, v196
  v_min_u32_e64 v198, v29, v198
  v_add_u32 v196, 64000, v196
  v_add_u32 v197, 64000, v197
  v_add_u32 v198, 64000, v198
  v_add_u32 v28, 113152, v28
  v_lshlrev_b32_e64 v32, 4, v20
  v_add_u32 v30, 113152, v32
  v_cmp_gt_u32 vcc, 24, v20
  v_lshrrev_b32 v21, 1, v35
  s_mul_i32 s44, s98, 384
  s_add_u32 s26, s26, s44
  s_addc_u32 s27, s27, 0
  v_mov_b32_e64 v31, s2
  v_mul_u32_u24 v31, 6144, v31
  v_add_u32 v31, 8388608, v31
  v_add_u32 v23, 0, v32
  v_add_u32 v188, v23, v31
  v_add_u32 v23, 1024, v32
  v_add_u32_e64 v189, v23, v31
  v_add_u32 v23, 2048, v32
  v_add_u32_e64 v190, v23, v31
  v_add_u32 v23, 3072, v32
  v_add_u32_e64 v191, v23, v31
  v_add_u32 v23, 4096, v32
  v_add_u32_e64 v192, v23, v31
  v_add_u32 v23, 5120, v32
  v_add_u32_e64 v193, v23, v31
  s_mov_b32 s45, 14
  s_lshl_b32 s68, s45, 2
  s_lshr_b64 s[64:65], s[92:93], s68
  s_and_b32 s68, s64, 15
  v_lshl_add_u32 v23, s68, 4, v32
  v_cndmask_b32 v23, v23, v32, vcc
  v_add_u32 v23, 5376, v23
  v_add_u32 v168, v23, v31
  s_waitcnt vmcnt(0)
  v_lshrrev_b32 v31, 4, v25
  v_mul_u32_u24 v31, 6144, v31
  v_add_u32 v31, 8388608, v31
  v_and_b32_e64 v25, 15, v25
  v_mul_u32_u24 v25, 384, v25
  s_lshl4_add_u32 s44, s3, 5760
  v_mov_b32 v23, s44
  v_add_u32 v187, v23, v31
  v_add_u32_dpp v23, v25, v21 row_newbcast:0 row_mask:0xf bank_mask:0xf
  v_mov_b32_dpp v29, v31 row_newbcast:0 row_mask:0xf bank_mask:0xf
  v_add_u32_e64 v172, v23, v29
  v_add_u32_dpp v23, v25, v21 row_newbcast:1 row_mask:0xf bank_mask:0xf
  v_mov_b32_dpp v29, v31 row_newbcast:1 row_mask:0xf bank_mask:0xf
  v_add_u32_e64 v173, v23, v29
  v_add_u32_dpp v23, v25, v21 row_newbcast:2 row_mask:0xf bank_mask:0xf
  v_mov_b32_dpp v29, v31 row_newbcast:2 row_mask:0xf bank_mask:0xf
  v_add_u32_e64 v174, v23, v29
  v_add_u32_dpp v23, v25, v21 row_newbcast:3 row_mask:0xf bank_mask:0xf
  v_mov_b32_dpp v29, v31 row_newbcast:3 row_mask:0xf bank_mask:0xf
  v_add_u32_e64 v175, v23, v29
  v_add_u32_dpp v23, v25, v21 row_newbcast:4 row_mask:0xf bank_mask:0xf
  v_mov_b32_dpp v29, v31 row_newbcast:4 row_mask:0xf bank_mask:0xf
  v_add_u32_e64 v176, v23, v29
  v_add_u32_dpp v23, v25, v21 row_newbcast:5 row_mask:0xf bank_mask:0xf
  v_mov_b32_dpp v29, v31 row_newbcast:5 row_mask:0xf bank_mask:0xf
  v_add_u32_e64 v177, v23, v29
  v_add_u32_dpp v23, v25, v21 row_newbcast:6 row_mask:0xf bank_mask:0xf
  v_mov_b32_dpp v29, v31 row_newbcast:6 row_mask:0xf bank_mask:0xf
  v_add_u32_e64 v178, v23, v29
  v_add_u32_dpp v23, v25, v21 row_newbcast:7 row_mask:0xf bank_mask:0xf
  v_mov_b32_dpp v29, v31 row_newbcast:7 row_mask:0xf bank_mask:0xf
  v_add_u32_e64 v179, v23, v29
  v_add_u32_dpp v23, v25, v21 row_newbcast:8 row_mask:0xf bank_mask:0xf
  v_mov_b32_dpp v29, v31 row_newbcast:8 row_mask:0xf bank_mask:0xf
  v_add_u32_e64 v180, v23, v29
  v_add_u32_dpp v23, v25, v21 row_newbcast:9 row_mask:0xf bank_mask:0xf
  v_mov_b32_dpp v29, v31 row_newbcast:9 row_mask:0xf bank_mask:0xf
  v_add_u32_e64 v181, v23, v29
  v_add_u32_dpp v23, v25, v21 row_newbcast:10 row_mask:0xf bank_mask:0xf
  v_mov_b32_dpp v29, v31 row_newbcast:10 row_mask:0xf bank_mask:0xf
  v_add_u32_e64 v182, v23, v29
  v_add_u32_dpp v23, v25, v21 row_newbcast:11 row_mask:0xf bank_mask:0xf
  v_mov_b32_dpp v29, v31 row_newbcast:11 row_mask:0xf bank_mask:0xf
  v_add_u32_e64 v183, v23, v29
  v_add_u32_dpp v23, v25, v21 row_newbcast:12 row_mask:0xf bank_mask:0xf
  v_mov_b32_dpp v29, v31 row_newbcast:12 row_mask:0xf bank_mask:0xf
  v_add_u32_e64 v184, v23, v29
  v_add_u32_dpp v23, v25, v21 row_newbcast:13 row_mask:0xf bank_mask:0xf
  v_mov_b32_dpp v29, v31 row_newbcast:13 row_mask:0xf bank_mask:0xf
  v_add_u32_e64 v185, v23, v29
  v_add_u32_dpp v23, v25, v21 row_newbcast:14 row_mask:0xf bank_mask:0xf
  v_mov_b32_dpp v29, v31 row_newbcast:14 row_mask:0xf bank_mask:0xf
  v_add_u32 v186, v23, v29
  v_mov_b32 v108, -1
  v_mov_b32 v109, -1
  v_mov_b32 v110, -1
  v_mov_b32_e64 v111, -1
  s_lshl4_add_u32 s44, s3, 118912
  v_mov_b32_e64 v23, s44
  ds_write_b128 v28, v[108:111] offset:5376
  ds_write_b32 v23, v38 offset:12
L_hp:
  s_min_u32 s44, s3, 13
  s_cmp_eq_u32 s44, s43
  s_cbranch_scc0 L_hc_ok
L_hc:
  global_load_dword v104, v37, s[28:29] sc1
  s_waitcnt vmcnt(0)
  v_cmp_ne_u32 s[64:65], 1, v104
  s_cmp_eq_u64 s[64:65], 0
  s_cbranch_scc1 L_hc_ok
  s_cmp_eq_u32 s94, 0
  s_cbranch_scc1 L_hc_ok
  s_sub_u32 s94, s94, 1
  s_sleep 64
  s_branch L_hc
L_hc_ok:
  s_lshl_b32 s68, s43, 2
  s_lshr_b64 s[64:65], s[92:93], s68
  s_and_b32 s68, s64, 15
  s_lshl4_add_u32 s44, s68, 118912
  v_mov_b32_e64 v23, s44
  s_cmp_eq_u32 s43, 14
  s_cbranch_scc0 L_hp_mid
  ds_read_b128 v[144:147], v30 offset:0
  ds_read_b128 v[148:151], v30 offset:1024
  ds_read_b128 v[152:155], v30 offset:2048
  ds_read_b128 v[156:159], v30 offset:3072
  ds_read_b128 v[160:163], v30 offset:4096
  ds_read_b128 v[164:167], v30 offset:5120
L_hm:
  ds_read_b32 v104, v14 offset:24
  s_waitcnt lgkmcnt(0)
  v_readfirstlane_b32 s46, v104
  s_cmp_ge_u32 s46, 30
  s_cbranch_scc1 L_hm_ok
  s_cmp_eq_u32 s94, 0
  s_cbranch_scc1 L_hm_ok
  s_sub_u32 s94, s94, 1
  s_sleep 1
  s_branch L_hm
L_hm_ok:
  global_store_dwordx4 v188, v[144:147], s[30:31] sc1
  global_store_dwordx4 v189, v[148:151], s[30:31] sc1
  global_store_dwordx4 v190, v[152:155], s[30:31] sc1
  global_store_dwordx4 v191, v[156:159], s[30:31] sc1
  global_store_dwordx4 v192, v[160:163], s[30:31] sc1
  s_mov_b32 exec_hi, 0xffffff
  global_store_dwordx4 v193, v[164:167], s[30:31] sc1
  s_mov_b64 exec, 7
  s_waitcnt vmcnt(0)
  global_atomic_add v36, v38, s[30:31] sc1
  s_mov_b64 exec, -1
L_hp_mid:
  s_add_u32 s43, s43, 1
  s_add_u32 s47, s43, 16
L_hpw:
  ds_read_b128 v[104:107], v14 offset:0
  s_waitcnt lgkmcnt(0)
  v_min_u32 v104, v104, v105
  v_min3_u32 v104, v104, v106, v107
  s_nop 0
  v_readfirstlane_b32 s46, v104
  s_cmp_ge_u32 s46, s47
  s_cbranch_scc1 L_hpw_ok
  s_cmp_eq_u32 s94, 0
  s_cbranch_scc1 L_hpw_ok
  s_sub_u32 s94, s94, 1
  s_sleep 1
  s_branch L_hpw
L_hpw_ok:
  s_bitcmp1_b32 s80, s47
  s_cbranch_scc0 L_fap
  s_mul_i32 s44, s47, 384
  s_add_u32 s44, s44, 7864320
  s_movk_i32 s78, 1
  s_atomic_add s78, s[30:31], s44 glc
  s_mov_b64 exec, 1
  global_load_dword v41, v43, s[30:31] offset:8 sc1
  s_mov_b64 exec, -1
L_fap:
  ds_read_b128 v[72:75], v196 offset:0
  ds_read_b128 v[76:79], v196 offset:16
  ds_read_b128 v[80:83], v197 offset:768
  ds_read_b128 v[84:87], v197 offset:784
  ds_read_b128 v[88:91], v197 offset:1536
  ds_read_b128 v[92:95], v197 offset:1552
  ds_read_b128 v[96:99], v198 offset:2304
  ds_read_b128 v[100:103], v198 offset:2320
  ds_read_b128 v[48:51], v23
  s_waitcnt lgkmcnt(0)
  v_pk_add_f32 v[72:73], v[72:73], v[80:81]
  v_pk_add_f32 v[88:89], v[88:89], v[96:97]
  v_pk_add_f32 v[74:75], v[74:75], v[82:83]
  v_pk_add_f32 v[90:91], v[90:91], v[98:99]
  v_pk_add_f32 v[76:77], v[76:77], v[84:85]
  v_pk_add_f32 v[92:93], v[92:93], v[100:101]
  v_pk_add_f32 v[78:79], v[78:79], v[86:87]
  v_pk_add_f32 v[94:95], v[94:95], v[102:103]
  v_pk_add_f32 v[72:73], v[72:73], v[88:89]
  v_pk_add_f32 v[74:75], v[74:75], v[90:91]
  v_pk_add_f32 v[76:77], v[76:77], v[92:93]
  v_pk_add_f32 v[78:79], v[78:79], v[94:95]
  v_pk_add_f32 v[72:73], v[72:73], v[50:51] op_sel_hi:[1,0] neg_lo:[0,1] neg_hi:[0,1]
  v_pk_add_f32 v[74:75], v[74:75], v[50:51] op_sel_hi:[1,0] neg_lo:[0,1] neg_hi:[0,1]
  v_pk_add_f32 v[76:77], v[76:77], v[50:51] op_sel_hi:[1,0] neg_lo:[0,1] neg_hi:[0,1]
  v_pk_add_f32 v[78:79], v[78:79], v[50:51] op_sel_hi:[1,0] neg_lo:[0,1] neg_hi:[0,1]
  v_max3_f32 v25, |v72|, |v73|, |v74|
  v_max3_f32 v25, v25, |v75|, |v76|
  v_max3_f32 v25, v25, |v77|, |v78|
  v_max_f32_e64 v25, v25, |v79|
  s_nop 1
  v_max_f32_dpp v25, v25, v25 row_ror:8 row_mask:0xf bank_mask:0xf
  s_nop 1
  v_max_f32_dpp v25, v25, v25 row_ror:4 row_mask:0xf bank_mask:0xf
  s_nop 1
  v_max_f32_dpp v25, v25, v25 row_ror:2 row_mask:0xf bank_mask:0xf
  s_nop 1
  v_max_f32_dpp v25, v25, v25 row_ror:1 row_mask:0xf bank_mask:0xf
  v_mov_b32 v29, v25
  s_nop 1
  v_permlane16_swap_b32 v25, v29
  v_max_f32 v25, v25, v29
  v_mov_b32 v29, v25
  s_nop 1
  v_permlane32_swap_b32 v25, v29
  v_max_f32 v25, v25, v29
  v_frexp_exp_i32_f32 v25, v25
  v_sub_u32_e64 v29, 14, v25
  v_add_u32 v51, 242, v25
  v_ldexp_f32 v72, v72, v29
  v_ldexp_f32 v73, v73, v29
  v_ldexp_f32 v74, v74, v29
  v_ldexp_f32 v75, v75, v29
  v_ldexp_f32 v76, v76, v29
  v_ldexp_f32 v77, v77, v29
  v_ldexp_f32 v78, v78, v29
  v_ldexp_f32 v79, v79, v29
  v_cvt_pk_f16_f32 v108, v72, v73
  v_cvt_pk_f16_f32 v109, v74, v75
  v_cvt_pk_f16_f32 v110, v76, v77
  v_cvt_pk_f16_f32 v111, v78, v79
  v_min_u32 v108, -2, v108
  v_min_u32 v109, -2, v109
  v_min_u32 v110, -2, v110
  v_min_u32 v111, -2, v111
  s_cmp_eq_u32 s43, 15
  s_cbranch_scc1 L_hp_last
  ds_write_b32 v23, v51 offset:12
  v_add_u32 v196, 3072, v196
  v_add_u32 v197, 3072, v197
  v_add_u32 v198, 3072, v198
  ds_write_b128 v28, v[108:111]
  v_add_u32 v28, 384, v28
  s_bitcmp1_b32 s80, s47
  s_cbranch_scc0 L_fbp
  s_waitcnt vmcnt(0) lgkmcnt(0)
  v_readlane_b32 s46, v40, s47
  s_sub_u32 s78, s78, s46
  s_bfe_u32 s46, s78, 0x80000
  s_min_u32 s46, s46, 15
  s_lshl_b32 s46, s46, 1
  s_sub_u32 s46, s46, 15
  v_readfirstlane_b32 s95, v41
  s_mul_i32 s45, s46, 6
  s_ashr_i32 s44, s95, 3
  s_sub_u32 s95, s95, s44
  s_cmp_lt_i32 s46, 0
  s_cselect_b32 s95, s95, 0
  s_cselect_b32 s45, -48, 0
  s_add_u32 s45, s45, s95
  v_mov_b32_e64 v41, s45
  s_lshl4_add_u32 s46, s46, s95
  s_cmp_gt_i32 s46, 0
  s_cselect_b32 s44, 3, 6
  s_mul_i32 s46, s46, s44
  s_add_u32 s46, s46, 128
  s_ashr_i32 s46, s46, 8
  v_mov_b32_e64 v42, s46
  s_mov_b64 exec, 1
  global_store_dword v43, v42, s[30:31]
  global_store_dword v43, v41, s[30:31] offset:8
  s_mov_b64 exec, -1
L_fbp:
  s_branch L_hp
L_hp_last:
  v_cndmask_b32 v108, v48, v108, vcc
  v_cndmask_b32 v109, v49, v109, vcc
  v_cndmask_b32 v110, v50, v110, vcc
  v_cndmask_b32 v111, v51, v111, vcc
  s_mov_b64 exec, 0x1ffffff
  global_store_dwordx4 v168, v[108:111], s[30:31] sc1
  s_mov_b64 exec, -1
  s_and_b32 s44, s41, 1
  v_lshl_add_u32 v196, s44, 8, v35
  v_subrev_u32 v197, 768, v196
  v_min_u32_e64 v196, v196, v197
  v_subrev_u32 v29, 256, v196
  v_add_u32 v197, 512, v196
  v_min_u32_e64 v197, v29, v197
  v_subrev_u32 v29, 512, v196
  v_add_u32 v198, 256, v196
  v_min_u32_e64 v198, v29, v198
  v_add_u32 v196, 110080, v196
  v_add_u32 v197, 110080, v197
  v_add_u32 v198, 110080, v198
L_hn:
  ds_read_b32 v104, v14 offset:28
  s_waitcnt lgkmcnt(0)
  v_readfirstlane_b32 s46, v104
  s_cmp_ge_u32 s46, 31
  s_cbranch_scc1 L_hn_ok
  s_cmp_eq_u32 s94, 0
  s_cbranch_scc1 L_hn_ok
  s_sub_u32 s94, s94, 1
  s_sleep 1
  s_branch L_hn
L_hn_ok:
  s_mov_b64 exec, 1
L_hw:
  global_atomic_add v68, v36, v14, s[30:31] sc0 sc1
  s_waitcnt vmcnt(0)
  v_readfirstlane_b32 s46, v68
  s_cmp_ge_u32 s46, 16
  s_cbranch_scc1 L_hw_ok
  s_cmp_eq_u32 s94, 0
  s_cbranch_scc1 L_hw_ok
  s_sub_u32 s94, s94, 1
  s_branch L_hw
L_hw_ok:
  s_mov_b64 exec, -1
L_hg:
  global_load_dwordx4 v[52:55], v187, s[30:31] sc1
  global_load_dwordx2 v[112:113], v172, s[30:31] sc1
  global_load_dwordx2 v[114:115], v173, s[30:31] sc1
  global_load_dwordx2 v[116:117], v174, s[30:31] sc1
  global_load_dwordx2 v[118:119], v175, s[30:31] sc1
  global_load_dwordx2 v[120:121], v176, s[30:31] sc1
  global_load_dwordx2 v[122:123], v177, s[30:31] sc1
  global_load_dwordx2 v[124:125], v178, s[30:31] sc1
  global_load_dwordx2 v[126:127], v179, s[30:31] sc1
  global_load_dwordx2 v[128:129], v180, s[30:31] sc1
  global_load_dwordx2 v[130:131], v181, s[30:31] sc1
  global_load_dwordx2 v[132:133], v182, s[30:31] sc1
  global_load_dwordx2 v[134:135], v183, s[30:31] sc1
  global_load_dwordx2 v[136:137], v184, s[30:31] sc1
  global_load_dwordx2 v[138:139], v185, s[30:31] sc1
  global_load_dwordx2 v[140:141], v186, s[30:31] sc1
  s_waitcnt vmcnt(15)
  v_mov_b32_e64 v23, v55
  v_mov_b32 v24, v52
  s_nop 1
  v_max_f32_dpp v24, v24, v24 row_ror:8 row_mask:0xf bank_mask:0xf
  s_nop 1
  v_max_f32_dpp v24, v24, v24 row_ror:4 row_mask:0xf bank_mask:0xf
  s_nop 1
  v_max_f32_dpp v24, v24, v24 row_ror:2 row_mask:0xf bank_mask:0xf
  s_nop 1
  v_max_f32_dpp v24, v24, v24 row_ror:1 row_mask:0xf bank_mask:0xf
  v_sub_f32 v24, v52, v24
  v_exp_f32_e64 v24, v24
  v_subrev_u32 v55, 256, v55
  v_mul_f32 v25, v24, v53
  s_nop 1
  v_add_f32_dpp v25, v25, v25 row_ror:8 row_mask:0xf bank_mask:0xf
  s_nop 1
  v_add_f32_dpp v25, v25, v25 row_ror:4 row_mask:0xf bank_mask:0xf
  s_nop 1
  v_add_f32_dpp v25, v25, v25 row_ror:2 row_mask:0xf bank_mask:0xf
  s_nop 1
  v_add_f32_dpp v25, v25, v25 row_ror:1 row_mask:0xf bank_mask:0xf
  v_rcp_f32 v25, v25
  s_nop 0
  v_mul_f32 v24, v24, v25
  v_ldexp_f32 v25, v24, v55
  v_mul_f32_e64 v54, v24, -v54
  v_readlane_b32 s63, v24, 15
  v_readlane_b32 s44, v54, 15
  v_readlane_b32 s48, v25, 0
  v_readlane_b32 s49, v25, 1
  v_readlane_b32 s50, v25, 2
  v_readlane_b32 s51, v25, 3
  v_readlane_b32 s52, v25, 4
  v_readlane_b32 s53, v25, 5
  v_readlane_b32 s54, v25, 6
  v_readlane_b32 s55, v25, 7
  v_readlane_b32 s56, v25, 8
  v_readlane_b32 s57, v25, 9
  v_readlane_b32 s58, v25, 10
  v_readlane_b32 s59, v25, 11
  v_readlane_b32 s60, v25, 12
  v_readlane_b32 s61, v25, 13
  v_readlane_b32 s62, v25, 14
  v_mov_b32 v108, s44
  v_mov_b32 v109, s44
  v_mov_b32_e64 v110, s44
  v_mov_b32 v111, s44
  s_waitcnt vmcnt(14)
  v_max3_u32 v23, v23, v112, v113
  v_fma_mix_f32 v108, v112, s48, v108 op_sel:[0,0,0] op_sel_hi:[1,0,0]
  v_fma_mix_f32 v109, v112, s48, v109 op_sel:[1,0,0] op_sel_hi:[1,0,0]
  v_fma_mix_f32 v110, v113, s48, v110 op_sel:[0,0,0] op_sel_hi:[1,0,0]
  v_fma_mix_f32 v111, v113, s48, v111 op_sel:[1,0,0] op_sel_hi:[1,0,0]
  s_waitcnt vmcnt(13)
  v_max3_u32 v23, v23, v114, v115
  v_fma_mix_f32 v108, v114, s49, v108 op_sel:[0,0,0] op_sel_hi:[1,0,0]
  v_fma_mix_f32 v109, v114, s49, v109 op_sel:[1,0,0] op_sel_hi:[1,0,0]
  v_fma_mix_f32 v110, v115, s49, v110 op_sel:[0,0,0] op_sel_hi:[1,0,0]
  v_fma_mix_f32 v111, v115, s49, v111 op_sel:[1,0,0] op_sel_hi:[1,0,0]
  s_waitcnt vmcnt(12)
  v_max3_u32 v23, v23, v116, v117
  v_fma_mix_f32 v108, v116, s50, v108 op_sel:[0,0,0] op_sel_hi:[1,0,0]
  v_fma_mix_f32 v109, v116, s50, v109 op_sel:[1,0,0] op_sel_hi:[1,0,0]
  v_fma_mix_f32 v110, v117, s50, v110 op_sel:[0,0,0] op_sel_hi:[1,0,0]
  v_fma_mix_f32 v111, v117, s50, v111 op_sel:[1,0,0] op_sel_hi:[1,0,0]
  s_waitcnt vmcnt(11)
  v_max3_u32 v23, v23, v118, v119
  v_fma_mix_f32 v108, v118, s51, v108 op_sel:[0,0,0] op_sel_hi:[1,0,0]
  v_fma_mix_f32 v109, v118, s51, v109 op_sel:[1,0,0] op_sel_hi:[1,0,0]
  v_fma_mix_f32 v110, v119, s51, v110 op_sel:[0,0,0] op_sel_hi:[1,0,0]
  v_fma_mix_f32 v111, v119, s51, v111 op_sel:[1,0,0] op_sel_hi:[1,0,0]
  s_waitcnt vmcnt(10)
  v_max3_u32 v23, v23, v120, v121
  v_fma_mix_f32 v108, v120, s52, v108 op_sel:[0,0,0] op_sel_hi:[1,0,0]
  v_fma_mix_f32 v109, v120, s52, v109 op_sel:[1,0,0] op_sel_hi:[1,0,0]
  v_fma_mix_f32 v110, v121, s52, v110 op_sel:[0,0,0] op_sel_hi:[1,0,0]
  v_fma_mix_f32 v111, v121, s52, v111 op_sel:[1,0,0] op_sel_hi:[1,0,0]
  s_waitcnt vmcnt(9)
  v_max3_u32 v23, v23, v122, v123
  v_fma_mix_f32 v108, v122, s53, v108 op_sel:[0,0,0] op_sel_hi:[1,0,0]
  v_fma_mix_f32 v109, v122, s53, v109 op_sel:[1,0,0] op_sel_hi:[1,0,0]
  v_fma_mix_f32 v110, v123, s53, v110 op_sel:[0,0,0] op_sel_hi:[1,0,0]
  v_fma_mix_f32 v111, v123, s53, v111 op_sel:[1,0,0] op_sel_hi:[1,0,0]
  s_waitcnt vmcnt(8)
  v_max3_u32 v23, v23, v124, v125
  v_fma_mix_f32 v108, v124, s54, v108 op_sel:[0,0,0] op_sel_hi:[1,0,0]
  v_fma_mix_f32 v109, v124, s54, v109 op_sel:[1,0,0] op_sel_hi:[1,0,0]
  v_fma_mix_f32 v110, v125, s54, v110 op_sel:[0,0,0] op_sel_hi:[1,0,0]
  v_fma_mix_f32 v111, v125, s54, v111 op_sel:[1,0,0] op_sel_hi:[1,0,0]
  s_waitcnt vmcnt(7)
  v_max3_u32 v23, v23, v126, v127
  v_fma_mix_f32 v108, v126, s55, v108 op_sel:[0,0,0] op_sel_hi:[1,0,0]
  v_fma_mix_f32 v109, v126, s55, v109 op_sel:[1,0,0] op_sel_hi:[1,0,0]
  v_fma_mix_f32 v110, v127, s55, v110 op_sel:[0,0,0] op_sel_hi:[1,0,0]
  v_fma_mix_f32 v111, v127, s55, v111 op_sel:[1,0,0] op_sel_hi:[1,0,0]
  s_waitcnt vmcnt(6)
  v_max3_u32 v23, v23, v128, v129
  v_fma_mix_f32 v108, v128, s56, v108 op_sel:[0,0,0] op_sel_hi:[1,0,0]
  v_fma_mix_f32 v109, v128, s56, v109 op_sel:[1,0,0] op_sel_hi:[1,0,0]
  v_fma_mix_f32 v110, v129, s56, v110 op_sel:[0,0,0] op_sel_hi:[1,0,0]
  v_fma_mix_f32 v111, v129, s56, v111 op_sel:[1,0,0] op_sel_hi:[1,0,0]
  s_waitcnt vmcnt(5)
  v_max3_u32 v23, v23, v130, v131
  v_fma_mix_f32 v108, v130, s57, v108 op_sel:[0,0,0] op_sel_hi:[1,0,0]
  v_fma_mix_f32 v109, v130, s57, v109 op_sel:[1,0,0] op_sel_hi:[1,0,0]
  v_fma_mix_f32 v110, v131, s57, v110 op_sel:[0,0,0] op_sel_hi:[1,0,0]
  v_fma_mix_f32 v111, v131, s57, v111 op_sel:[1,0,0] op_sel_hi:[1,0,0]
  s_waitcnt vmcnt(4)
  v_max3_u32 v23, v23, v132, v133
  v_fma_mix_f32 v108, v132, s58, v108 op_sel:[0,0,0] op_sel_hi:[1,0,0]
  v_fma_mix_f32 v109, v132, s58, v109 op_sel:[1,0,0] op_sel_hi:[1,0,0]
  v_fma_mix_f32 v110, v133, s58, v110 op_sel:[0,0,0] op_sel_hi:[1,0,0]
  v_fma_mix_f32 v111, v133, s58, v111 op_sel:[1,0,0] op_sel_hi:[1,0,0]
  s_waitcnt vmcnt(3)
  v_max3_u32 v23, v23, v134, v135
  v_fma_mix_f32 v108, v134, s59, v108 op_sel:[0,0,0] op_sel_hi:[1,0,0]
  v_fma_mix_f32 v109, v134, s59, v109 op_sel:[1,0,0] op_sel_hi:[1,0,0]
  v_fma_mix_f32 v110, v135, s59, v110 op_sel:[0,0,0] op_sel_hi:[1,0,0]
  v_fma_mix_f32 v111, v135, s59, v111 op_sel:[1,0,0] op_sel_hi:[1,0,0]
  s_waitcnt vmcnt(2)
  v_max3_u32 v23, v23, v136, v137
  v_fma_mix_f32 v108, v136, s60, v108 op_sel:[0,0,0] op_sel_hi:[1,0,0]
  v_fma_mix_f32 v109, v136, s60, v109 op_sel:[1,0,0] op_sel_hi:[1,0,0]
  v_fma_mix_f32 v110, v137, s60, v110 op_sel:[0,0,0] op_sel_hi:[1,0,0]
  v_fma_mix_f32 v111, v137, s60, v111 op_sel:[1,0,0] op_sel_hi:[1,0,0]
  s_waitcnt vmcnt(1)
  v_max3_u32 v23, v23, v138, v139
  v_fma_mix_f32 v108, v138, s61, v108 op_sel:[0,0,0] op_sel_hi:[1,0,0]
  v_fma_mix_f32 v109, v138, s61, v109 op_sel:[1,0,0] op_sel_hi:[1,0,0]
  v_fma_mix_f32 v110, v139, s61, v110 op_sel:[0,0,0] op_sel_hi:[1,0,0]
  v_fma_mix_f32 v111, v139, s61, v111 op_sel:[1,0,0] op_sel_hi:[1,0,0]
  s_waitcnt vmcnt(0)
  v_max3_u32 v23, v23, v140, v141
  v_cmp_eq_u32 s[64:65], -1, v23
  v_fma_mix_f32 v108, v140, s62, v108 op_sel:[0,0,0] op_sel_hi:[1,0,0]
  v_fma_mix_f32 v109, v140, s62, v109 op_sel:[1,0,0] op_sel_hi:[1,0,0]
  v_fma_mix_f32 v110, v141, s62, v110 op_sel:[0,0,0] op_sel_hi:[1,0,0]
  v_fma_mix_f32 v111, v141, s62, v111 op_sel:[1,0,0] op_sel_hi:[1,0,0]
  s_cmp_eq_u64 s[64:65], 0
  s_cbranch_scc1 L_hg_ok
  s_cmp_eq_u32 s94, 0
  s_cbranch_scc1 L_hg_ok
  s_sub_u32 s94, s94, 1
  s_branch L_hg
L_hg_ok:
  v_mov_b32_e64 v168, s63
  s_mov_b32 exec_hi, 0xffff
  s_barrier
  ds_read_b128 v[72:75], v196 offset:0
  ds_read_b128 v[76:79], v197 offset:768
  ds_read_b128 v[80:83], v197 offset:1536
  ds_read_b128 v[84:87], v198 offset:2304
  s_waitcnt lgkmcnt(3)
  v_pk_fma_f32 v[108:109], v[72:73], v[168:169], v[108:109] op_sel_hi:[1,0,1]
  v_pk_fma_f32 v[110:111], v[74:75], v[168:169], v[110:111] op_sel_hi:[1,0,1]
  s_waitcnt lgkmcnt(2)
  v_pk_fma_f32 v[108:109], v[76:77], v[168:169], v[108:109] op_sel_hi:[1,0,1]
  v_pk_fma_f32 v[110:111], v[78:79], v[168:169], v[110:111] op_sel_hi:[1,0,1]
  s_waitcnt lgkmcnt(1)
  v_pk_fma_f32 v[108:109], v[80:81], v[168:169], v[108:109] op_sel_hi:[1,0,1]
  v_pk_fma_f32 v[110:111], v[82:83], v[168:169], v[110:111] op_sel_hi:[1,0,1]
  s_waitcnt lgkmcnt(0)
  v_pk_fma_f32 v[108:109], v[84:85], v[168:169], v[108:109] op_sel_hi:[1,0,1]
  v_pk_fma_f32 v[110:111], v[86:87], v[168:169], v[110:111] op_sel_hi:[1,0,1]
  v_cvt_pk_bf16_f32 v108, v108, v109
  v_cvt_pk_bf16_f32 v109, v110, v111
  global_store_dwordx2 v21, v[108:109], s[26:27]
L_end:
  s_endpgm
.p2align 6
.type L_order,@object
L_order:
  .long 0x76afedcb, 0x45321098, 0x500000, 0x300, 0x40, 0x251300, 0x4, 0x0
  .long 0x2e001e, 0x4e003e, 0x6e005e, 0x8d007e, 0xae009e, 0xce00be, 0xee00de, 0xf00fe
  .long 0x96afedcb, 0x74321058, 0x700000, 0x700, 0x70, 0x271700, 0x7, 0x0
  .long 0x270007, 0x470037, 0x670057, 0x870077, 0xa70097, 0xc700b7, 0xe700d7, 0x1f00f7
  .long 0x765aedfb, 0xc4321098, 0xd00000, 0xf00, 0xc0, 0x2d1f00, 0xc, 0x0
  .long 0x110001, 0x410031, 0x610051, 0x810071, 0xa10091, 0xc100b1, 0xe100d1, 0x2f00f1
  .long 0x785fedcb, 0x6432109a, 0x900000, 0x200, 0x60, 0x291200, 0x6, 0x0
  .long 0x160006, 0x460026, 0x660056, 0x860076, 0xa60096, 0xc600b6, 0xe600d6, 0x3f00f6
  .long 0x765faecb, 0xd4321098, 0xf00000, 0xd00, 0xd0, 0x2f1d00, 0xd, 0x0
  .long 0x120002, 0x320022, 0x620052, 0x820072, 0xa20092, 0xc200b2, 0xe200d2, 0x4f00f2
  .long 0x765fedca, 0xb4321098, 0x800000, 0xf00, 0xb0, 0x281f00, 0xb, 0x0
  .long 0x100000, 0x300020, 0x600040, 0x800070, 0xa00090, 0xc000b0, 0xe000d0, 0x5f00f0
  .long 0x76afedcb, 0x24351098, 0x400000, 0x0, 0x20, 0x241000, 0x2, 0x0
  .long 0x1c000c, 0x3c002c, 0x5c004c, 0x8c007c, 0xac009c, 0xcc00bc, 0xea00dc, 0x6f00fc
  .long 0x76afedcb, 0x14325098, 0x400000, 0x400, 0x10, 0x241400, 0x1, 0x0
  .long 0x1b000b, 0x3b002b, 0x5b004b, 0x8b006b, 0xab009b, 0xcb00bb, 0xeb00db, 0x7f00fb
  .long 0x76afedcb, 0x35421098, 0x500000, 0x300, 0x30, 0x251300, 0x3, 0x0
  .long 0x1d000d, 0x3d002d, 0x5d004d, 0x7d006d, 0xad009d, 0xcd00bd, 0xed00dd, 0x8f00fd
  .long 0x76afedcb, 0x94321058, 0x700000, 0x700, 0x90, 0x271700, 0x9, 0x0
  .long 0x170009, 0x390029, 0x590049, 0x790069, 0xa90089, 0xc900b9, 0xe900d9, 0x9f00f9
  .long 0x765aedcb, 0xf4321098, 0xd00000, 0xf00, 0xf0, 0x2d1f00, 0xf, 0x0
  .long 0x140004, 0x340021, 0x540044, 0x740064, 0x940084, 0xc400b4, 0xe400d4, 0xaf00f4
  .long 0x765fedcb, 0x8432109a, 0x900000, 0x200, 0x80, 0x291200, 0x8, 0x0
  .long 0x180008, 0x360028, 0x580048, 0x780068, 0x980088, 0xc800a8, 0xe800d8, 0xbf00f8
  .long 0x765fadcb, 0xe4321098, 0xf00000, 0xd00, 0xe0, 0x2f1d00, 0xe, 0x0
  .long 0x130003, 0x330023, 0x530042, 0x730063, 0x930083, 0xb300a3, 0xe300d3, 0xcf00f3
  .long 0x765fedcb, 0xa4321098, 0x800000, 0xf00, 0xaf, 0x28001f, 0xa, 0x0
  .long 0x500024, 0x14400a4, 0x2b40234, 0x6f40674, 0x7830703, 0xc1408c2, 0xd630c94, 0xdf0de3
  .long 0x76afedcb, 0x4351298, 0x400000, 0x0, 0x0, 0x241000, 0x0, 0x0
  .long 0x1a000a, 0x3a002a, 0x5a004a, 0x7a006a, 0x9a008a, 0xba00aa, 0xda00ca, 0xef00fa
  .long 0x76afedcb, 0x54321098, 0x400000, 0x400, 0x54, 0x140024, 0x5, 0x0
  .long 0x7b006c, 0x1cc00ec, 0x4be043e, 0x58d050d, 0x7de075e, 0xe1c084d, 0xe9c0e2e, 0xff0eae
  .long 0x765fadce, 0xb4321098, 0x11911111, 0x11111e11, 0xb1, 0x291e01, 0xb, 0x0
  .long 0x1200110, 0x1400130, 0x1600150, 0x1800170, 0x1a00190, 0x1c001b0, 0x1e001d0, 0x10f01f0
  .long 0x76afedcb, 0x94321058, 0x11b11111, 0x11111011, 0x91, 0x2b1001, 0x9, 0x0
  .long 0x1290109, 0x1490139, 0x1690159, 0x1890179, 0x1a90199, 0x1c901b9, 0x1e901d9, 0x11f01f9
  .long 0x765fedcb, 0x8432109a, 0x11a11111, 0x11111111, 0x81, 0x2a1101, 0x8, 0x0
  .long 0x1180108, 0x1480138, 0x1680158, 0x1880178, 0x1a70198, 0x1c801b8, 0x1e801d8, 0x12f01f8
  .long 0x765feadb, 0xc4321098, 0x11811111, 0x11111e11, 0xc1, 0x281e01, 0xc, 0x0
  .long 0x1110101, 0x1410121, 0x1610151, 0x1810171, 0x1a10191, 0x1c101b1, 0x1e101d1, 0x13f01f1
  .long 0x765aedcb, 0xf4321098, 0x11e11111, 0x11111f11, 0xf1, 0x2e1f01, 0xf, 0x0
  .long 0x1140104, 0x1340124, 0x1640154, 0x1840174, 0x1a40194, 0x1c401b4, 0x1e401d4, 0x14f01f4
  .long 0x76afedcb, 0x45321098, 0x11311111, 0x11111811, 0x41, 0x231801, 0x4, 0x0
  .long 0x11e010e, 0x13e012e, 0x16e014e, 0x18e017e, 0x1ae019e, 0x1ce01be, 0x1ee01dd, 0x15f01fe
  .long 0x7a5fedcb, 0x64321098, 0x11811111, 0x11111311, 0x61, 0x281301, 0x6, 0x0
  .long 0x1160106, 0x1360126, 0x1560146, 0x1860176, 0x1a60196, 0x1c601b6, 0x1e601d6, 0x16f01f6
  .long 0x76afedcb, 0x14325098, 0x11011111, 0x11111311, 0x11, 0x201301, 0x1, 0x0
  .long 0x11b010b, 0x13b012b, 0x15b014b, 0x18b016b, 0x1ab019b, 0x1cb01bb, 0x1eb01db, 0x17f01fa
  .long 0x765fadcb, 0xe4321098, 0x11911111, 0x11111e11, 0xe1, 0x291e01, 0xe, 0x0
  .long 0x1130100, 0x1330123, 0x1530143, 0x1730163, 0x1a30193, 0x1c301b3, 0x1e301d3, 0x18f01f3
  .long 0x76afedcb, 0x54321098, 0x11b11111, 0x11111011, 0x5b, 0x10012b, 0x5, 0x0
  .long 0x3090119, 0x5450389, 0xc2505c5, 0xd650ca5, 0xe750de5, 0xf380ef5, 0xfb80f55, 0x19f0fd5
  .long 0x865fedcb, 0x7432109a, 0x11a11111, 0x11111111, 0x71, 0x2a1101, 0x7, 0x0
  .long 0x1170107, 0x1370127, 0x1570147, 0x1770167, 0x1970187, 0x1c701b7, 0x1e701d7, 0x1af01f7
  .long 0x765feacb, 0xd4321098, 0x11811111, 0x11111e11, 0xd1, 0x281e01, 0xd, 0x0
  .long 0x1120102, 0x1310122, 0x1520142, 0x1720162, 0x1920182, 0x1c201a2, 0x1e201d2, 0x1bf01f2
  .long 0x76afedcb, 0x24351098, 0x11411111, 0x11111711, 0x21, 0x241701, 0x2, 0x0
  .long 0x11c010c, 0x13c012c, 0x15c014c, 0x17c016c, 0x19c018c, 0x1bc01ac, 0x1ec01dc, 0x1cf01fc
  .long 0x76afedcb, 0x35421098, 0x11311111, 0x11111811, 0x31, 0x231801, 0x3, 0x0
  .long 0x11d010d, 0x13d012d, 0x15d014d, 0x17d016d, 0x19d018d, 0x1bd01ad, 0x1ed01cd, 0x1df01fd
  .long 0x765fedcb, 0xa4321098, 0x11811111, 0x11111311, 0xa3, 0x280113, 0xa, 0x0
  .long 0x850005, 0x1750166, 0x62501f5, 0x74506a5, 0xbd507c5, 0xd350d15, 0xdb50d95, 0x1ef0e55
  .long 0x76afedcb, 0x4325198, 0x11011111, 0x11111311, 0x1, 0x201301, 0x0, 0x0
  .long 0x11a010a, 0x13a012a, 0x15a014a, 0x17a016a, 0x19a018a, 0x1ba01aa, 0x1da01ca, 0x1ff01ea
  .long 0x76afedcb, 0x45321098, 0x22222222, 0x22222a22, 0x42, 0x221a02, 0x4, 0x0
  .long 0x22e021e, 0x24e023e, 0x26e025e, 0x28b027e, 0x2ae029e, 0x2ce02be, 0x2ee02de, 0x20f02fe
  .long 0x7a5fedcb, 0x64321098, 0x22c22222, 0x22222622, 0x62, 0x2c1602, 0x6, 0x0
  .long 0x2260206, 0x2460236, 0x2660256, 0x2860276, 0x2a60296, 0x2c602b6, 0x2e602d6, 0x21f02f6
  .long 0x76afedcb, 0x54321098, 0x22922222, 0x22222522, 0x59, 0x150229, 0x5, 0x0
  .long 0xb50035, 0x1850105, 0x2f502a8, 0x3550315, 0x3d50395, 0x6650575, 0x94506e5, 0x22f09c5
  .long 0x765aedcb, 0xf4321098, 0x22f22222, 0x22222f22, 0xf2, 0x2f1f02, 0xf, 0x0
  .long 0x2140204, 0x2440224, 0x2640254, 0x2840274, 0x2a40294, 0x2c402b2, 0x2e402d4, 0x23f02f4
  .long 0x76afedcb, 0x24351098, 0x22222222, 0x22222522, 0x22, 0x221502, 0x2, 0x0
  .long 0x21c020c, 0x23c022c, 0x26c025c, 0x28c027c, 0x2ac029c, 0x2ca02bc, 0x2ec02dc, 0x24f02fc
  .long 0x965fedcb, 0x743210a8, 0x22722222, 0x22222022, 0x72, 0x271002, 0x7, 0x0
  .long 0x2170207, 0x2370227, 0x2670247, 0x2870277, 0x2a70297, 0x2c702b7, 0x2e702d7, 0x25f02f7
  .long 0x765fadce, 0xb4321098, 0x22a22222, 0x22222e22, 0xb2, 0x2a1e02, 0xb, 0x0
  .long 0x2100200, 0x2300220, 0x2500240, 0x2800270, 0x2a00290, 0x2c002b0, 0x2e002d0, 0x26f02f0
  .long 0x76afedcb, 0x34521098, 0x22222222, 0x22222822, 0x32, 0x221802, 0x3, 0x0
  .long 0x21d020d, 0x23d022d, 0x25d024d, 0x28d026d, 0x2ad029d, 0x2cd02bd, 0x2ed02dd, 0x27f02fd
  .long 0x76afedcb, 0x15324098, 0x22222222, 0x22222a22, 0x12, 0x221a02, 0x1, 0x0
  .long 0x21b020b, 0x23b022b, 0x25b024b, 0x27b026b, 0x2ab029b, 0x2cb02bb, 0x2eb02db, 0x28f02fb
  .long 0x765fedcb, 0xa4321098, 0x22c22222, 0x22222622, 0xa6, 0x2c0216, 0xa, 0x0
  .long 0x3650216, 0x42503e5, 0x73504a5, 0x7750755, 0x7d507b5, 0xb4507f5, 0xd050bc5, 0x29f0d85
  .long 0x76afedcb, 0x84321095, 0x22922222, 0x22222522, 0x82, 0x291502, 0x8, 0x0
  .long 0x2180208, 0x2380228, 0x2580248, 0x2780268, 0x2980288, 0x2c802b8, 0x2e802d8, 0x2af02f8
  .long 0x765aefcb, 0xd4321098, 0x22f22222, 0x22222f22, 0xd2, 0x2f1f02, 0xd, 0x0
  .long 0x2120202, 0x2320222, 0x2520242, 0x2720262, 0x2920282, 0x2c202a2, 0x2e202d2, 0x2bf02f2
  .long 0x76afedcb, 0x4351298, 0x22222222, 0x22222522, 0x2, 0x221502, 0x0, 0x0
  .long 0x21a020a, 0x23a022a, 0x25a024a, 0x27a026a, 0x29a028a, 0x2ba02aa, 0x2ea02da, 0x2cf02fa
  .long 0x765fedcb, 0x943210a8, 0x22722222, 0x22222022, 0x92, 0x271002, 0x9, 0x0
  .long 0x2190209, 0x2390229, 0x2570249, 0x2790269, 0x2990289, 0x2b902a9, 0x2e902c9, 0x2df02f9
  .long 0x765fadcb, 0xe4321098, 0x22a22222, 0x22222e22, 0xe2, 0x2a1e02, 0xe, 0x0
  .long 0x2130203, 0x2330223, 0x2530243, 0x2730260, 0x2930283, 0x2b302a3, 0x2d302c3, 0x2ef02f3
  .long 0x765fedab, 0xc4321098, 0x22922222, 0x22222d22, 0xc2, 0x291d02, 0xc, 0x0
  .long 0x2110201, 0x2310221, 0x2510241, 0x2710261, 0x2910281, 0x2b102a1, 0x2d102c1, 0x2ff02e1
  .long 0x76afedcb, 0x84321059, 0x33b33333, 0x33333133, 0x83, 0x2b1103, 0x8, 0x0
  .long 0x3280318, 0x3480338, 0x3680358, 0x3880378, 0x3a80398, 0x3c803b8, 0x3e803d8, 0x30f03f8
  .long 0x765aedcb, 0xf4321098, 0x33933333, 0x33333e33, 0xf3, 0x291e03, 0xf, 0x0
  .long 0x3240304, 0x3440334, 0x3640354, 0x3840374, 0x3a40394, 0x3c403b4, 0x3e403d4, 0x31f03f4
  .long 0x76afedcb, 0x4321598, 0x33033333, 0x33333233, 0x3, 0x201203, 0x0, 0x0
  .long 0x31a030a, 0x34a033a, 0x36a035a, 0x38a037a, 0x3aa039a, 0x3ca03ba, 0x3ea03da, 0x32f03fa
  .long 0x765fedac, 0xb4321098, 0x33a33333, 0x33333b33, 0xb3, 0x2a1b03, 0xb, 0x0
  .long 0x3100300, 0x3400320, 0x3600350, 0x3800370, 0x3a00390, 0x3c003b0, 0x3e003d0, 0x33f03f0
  .long 0x76afedcb, 0x24531098, 0x33133333, 0x33333a33, 0x23, 0x211a03, 0x2, 0x0
  .long 0x31c030c, 0x33c032c, 0x36c035c, 0x38c037c, 0x3ac039c, 0x3cc03bc, 0x3ec03dc, 0x34f03fc
  .long 0xa65fedcb, 0x74321098, 0x33933333, 0x33333133, 0x73, 0x291103, 0x7, 0x0
  .long 0x3170307, 0x3370327, 0x3670347, 0x3870377, 0x3a70397, 0x3c703b7, 0x3e703d6, 0x35f03f7
  .long 0x76afedcb, 0x15324098, 0x33333333, 0x33333633, 0x13, 0x231603, 0x1, 0x0
  .long 0x31b030b, 0x33b032b, 0x35b034b, 0x38b037b, 0x3ab039b, 0x3cb03bb, 0x3eb03db, 0x36f03fb
  .long 0x765fadcb, 0xe4321098, 0x33e33333, 0x33333a33, 0xe3, 0x2e1a03, 0xe, 0x0
  .long 0x3130303, 0x3330323, 0x3530343, 0x3830363, 0x3a30393, 0x3c303b3, 0x3e303d3, 0x37f03f2
  .long 0x76afedcb, 0x94321058, 0x33b33333, 0x33333133, 0x93, 0x2b1103, 0x9, 0x0
  .long 0x3190308, 0x3390329, 0x3590349, 0x3790369, 0x3a90399, 0x3c903b9, 0x3e903d9, 0x38f03f9
  .long 0x765fedcb, 0xa4321098, 0x33933333, 0x33333e33, 0xae, 0x29031e, 0xa, 0x0
  .long 0x1320103, 0x1b20183, 0x2e30263, 0x4740314, 0x82304f4, 0xd5208a3, 0xe420dd2, 0x39f0ec2
  .long 0x76afedcb, 0x54321098, 0x33033333, 0x33333233, 0x50, 0x120320, 0x5, 0x0
  .long 0x1fb017b, 0x65e032a, 0x73c06de, 0xaeb07bc, 0xc6a0c4d, 0xd0c0ccd, 0xf1e0d8c, 0x3af0f9e
  .long 0x765fedab, 0xc4321098, 0x33a33333, 0x33333b33, 0xc3, 0x2a1b03, 0xc, 0x0
  .long 0x3110301, 0x3300321, 0x3510341, 0x3710361, 0x3910381, 0x3c103a1, 0x3e103d1, 0x3bf03f1
  .long 0x76afedcb, 0x34521098, 0x33133333, 0x33333a33, 0x33, 0x211a03, 0x3, 0x0
  .long 0x31d030d, 0x33d032d, 0x35d034c, 0x37d036d, 0x39d038d, 0x3bd03ad, 0x3ed03dd, 0x3cf03fd
  .long 0xa75fedcb, 0x64321098, 0x33933333, 0x33333133, 0x63, 0x291103, 0x6, 0x0
  .long 0x3160306, 0x3360326, 0x3560346, 0x3760366, 0x3960386, 0x3b603a6, 0x3e603c6, 0x3df03f6
  .long 0x76afedcb, 0x45321098, 0x33333333, 0x33333633, 0x43, 0x231603, 0x4, 0x0
  .long 0x31e030e, 0x33e032e, 0x35e034e, 0x37e036b, 0x39e038e, 0x3be03ae, 0x3de03ce, 0x3ef03fe
  .long 0x765faecb, 0xd4321098, 0x33e33333, 0x33333a33, 0xd3, 0x2e1a03, 0xd, 0x0
  .long 0x3120302, 0x3320322, 0x3520342, 0x3720362, 0x3920382, 0x3b203a2, 0x3d203c2, 0x3ff03e2
  .long 0x765fedcb, 0x8432109a, 0x44a44444, 0x44444944, 0x84, 0x2a1904, 0x8, 0x0
  .long 0x4280418, 0x4480438, 0x4680458, 0x4870478, 0x4a80498, 0x4c804b8, 0x4e804d8, 0x40f04f8
  .long 0x76afedcb, 0x4521398, 0x44544444, 0x44444544, 0x4, 0x251504, 0x0, 0x0
  .long 0x42a040a, 0x44a043a, 0x46a045a, 0x48a047a, 0x4aa049a, 0x4ca04ba, 0x4ea04da, 0x41f04fa
  .long 0x76afedcb, 0x24351098, 0x44344444, 0x44444644, 0x24, 0x231604, 0x2, 0x0
  .long 0x41c040c, 0x44c043c, 0x46c045c, 0x48c047c, 0x4ac049c, 0x4cc04bc, 0x4ec04dc, 0x42f04fc
  .long 0x76afedcb, 0x45321098, 0x44444444, 0x44444a44, 0x44, 0x241a04, 0x4, 0x0
  .long 0x41e040e, 0x44e042e, 0x46e045e, 0x48e047e, 0x4ae049e, 0x4ce04bb, 0x4ee04de, 0x43f04fe
  .long 0x765fadce, 0xb4321098, 0x44744444, 0x44444b44, 0xb4, 0x271b04, 0xb, 0x0
  .long 0x4100400, 0x4300420, 0x4600450, 0x4800470, 0x4a00490, 0x4c004b0, 0x4e004d0, 0x44f04f0
  .long 0x765feacb, 0xd4321098, 0x44644444, 0x44444c44, 0xd4, 0x261c04, 0xd, 0x0
  .long 0x4120402, 0x4320422, 0x4620442, 0x4820472, 0x4a20492, 0x4c204b2, 0x4e204d2, 0x45f04f2
  .long 0x79afedcb, 0x64321058, 0x44744444, 0x44444744, 0x64, 0x271704, 0x6, 0x0
  .long 0x4160406, 0x4360426, 0x4560446, 0x4860476, 0x4a60496, 0x4c604b6, 0x4e604d6, 0x46f04f6
  .long 0x765aedcb, 0xf4321098, 0x44644444, 0x44444e44, 0xf4, 0x261e04, 0xf, 0x0
  .long 0x4140404, 0x4340424, 0x4540444, 0x4840464, 0x4a40494, 0x4c404b4, 0x4e404d4, 0x47f04f1
  .long 0x865fedcb, 0x7432109a, 0x44a44444, 0x44444944, 0x74, 0x2a1904, 0x7, 0x0
  .long 0x4170407, 0x4370427, 0x4570447, 0x4770467, 0x4a70497, 0x4c704b7, 0x4e704d7, 0x48f04f7
  .long 0x76afedcb, 0x34521098, 0x44544444, 0x44444544, 0x34, 0x251504, 0x3, 0x0
  .long 0x41a040d, 0x43d042d, 0x45d044d, 0x47d046d, 0x4ad048d, 0x4cd04bd, 0x4ed04dd, 0x49f04fd
  .long 0x76afedcb, 0x54321098, 0x44344444, 0x44444644, 0x53, 0x160423, 0x5, 0x0
  .long 0x1de015e, 0x3ee036e, 0x81b042c, 0x89b087e, 0x93d08fe, 0xd4e09bd, 0xf0d0dce, 0x4af0f8d
  .long 0x76afedcb, 0x15324098, 0x44444444, 0x44444a44, 0x14, 0x241a04, 0x1, 0x0
  .long 0x41b040b, 0x43b042b, 0x45b044b, 0x47b046b, 0x49b048b, 0x4cb04ab, 0x4eb04db, 0x4bf04fb
  .long 0x765fadcb, 0xe4321098, 0x44744444, 0x44444b44, 0xe4, 0x271b04, 0xe, 0x0
  .long 0x4130403, 0x4330423, 0x4530440, 0x4730463, 0x4930483, 0x4b304a3, 0x4e304d3, 0x4cf04f3
  .long 0x765fedcb, 0xa4321098, 0x44644444, 0x44444c44, 0xac, 0x26041c, 0xa, 0x0
  .long 0x5230452, 0x76405a3, 0x94207e4, 0xb1109c2, 0xb910b34, 0xc030bb4, 0xf740c83, 0x4df0ff4
  .long 0x76afedcb, 0x94321058, 0x44744444, 0x44444744, 0x94, 0x271704, 0x9, 0x0
  .long 0x4190409, 0x4390429, 0x4590449, 0x4790466, 0x4990489, 0x4b904a9, 0x4d904c9, 0x4ef04f9
  .long 0x765aedfb, 0xc4321098, 0x44644444, 0x44444e44, 0xc4, 0x261e04, 0xc, 0x0
  .long 0x4110401, 0x4310421, 0x4510441, 0x4710461, 0x4910481, 0x4b104a1, 0x4d104c1, 0x4ff04e1
  .long 0x76afedcb, 0x34521098, 0x55455555, 0x55555855, 0x35, 0x241805, 0x3, 0x0
  .long 0x52d051d, 0x54d053d, 0x56d055d, 0x58c057d, 0x5ad059d, 0x5cd05bd, 0x5ed05dd, 0x50f05fd
  .long 0x765fedcb, 0x943210a8, 0x55f55555, 0x55555a55, 0x95, 0x2f1a05, 0x9, 0x0
  .long 0x5290509, 0x5490539, 0x5690559, 0x5890579, 0x5a90596, 0x5c905b9, 0x5e905d9, 0x51f05f9
  .long 0x765fadeb, 0xc4321098, 0x55755555, 0x55555c55, 0xc5, 0x271c05, 0xc, 0x0
  .long 0x5110501, 0x5410531, 0x5610551, 0x5810571, 0x5a10591, 0x5c105b1, 0x5e105d1, 0x52f05f1
  .long 0x765feacd, 0xb4321098, 0x55c55555, 0x55555d55, 0xb5, 0x2c1d05, 0xb, 0x0
  .long 0x5100500, 0x5400520, 0x5600550, 0x5800570, 0x5a00590, 0x5c005b0, 0x5e005d0, 0x53f05f0
  .long 0xa65fedcb, 0x74321098, 0x55b55555, 0x55555455, 0x75, 0x2b1405, 0x7, 0x0
  .long 0x5170507, 0x5370527, 0x5670557, 0x5870577, 0x5a70597, 0x5c705b7, 0x5e705d7, 0x54f05f7
  .long 0x76afedcb, 0x84321095, 0x55f55555, 0x55555755, 0x85, 0x2f1705, 0x8, 0x0
  .long 0x5180508, 0x5380528, 0x5680548, 0x5880578, 0x5a80598, 0x5c805b8, 0x5e805d8, 0x55f05f8
  .long 0x76afedcb, 0x4325198, 0x55255555, 0x55555255, 0x5, 0x221205, 0x0, 0x0
  .long 0x51a050a, 0x53a052a, 0x55a054a, 0x58a057a, 0x5aa059a, 0x5ca05ba, 0x5ea05da, 0x56f05fa
  .long 0x765aedcb, 0xf4321098, 0x55955555, 0x55555d55, 0xf5, 0x291d05, 0xf, 0x0
  .long 0x5140504, 0x5340524, 0x5540544, 0x5840564, 0x5a40594, 0x5c405b4, 0x5e405d4, 0x57f05f4
  .long 0x76afedcb, 0x24531098, 0x55455555, 0x55555855, 0x25, 0x241805, 0x2, 0x0
  .long 0x51c050c, 0x53c052c, 0x55c054c, 0x57c056c, 0x5ac059c, 0x5cc05bc, 0x5ec05dc, 0x58f05fc
  .long 0x795fedcb, 0x643210a8, 0x55f55555, 0x55555a55, 0x65, 0x2f1a05, 0x6, 0x0
  .long 0x5160506, 0x5360526, 0x5560546, 0x5760566, 0x5a60586, 0x5c605b6, 0x5e605d6, 0x59f05f6
  .long 0x765fadcb, 0xe4321098, 0x55755555, 0x55555c55, 0xe5, 0x271c05, 0xe, 0x0
  .long 0x5130503, 0x5330521, 0x5530543, 0x5730563, 0x5930583, 0x5c305b3, 0x5e305d3, 0x5af05f3
  .long 0x765feacb, 0xd4321098, 0x55c55555, 0x55555d55, 0xd5, 0x2c1d05, 0xd, 0x0
  .long 0x5120502, 0x5300522, 0x5520542, 0x5720562, 0x5920582, 0x5c205a2, 0x5e205d2, 0x5bf05f2
  .long 0x765fedcb, 0xa4321098, 0x55b55555, 0x55555455, 0xa4, 0x2b0514, 0xa, 0x0
  .long 0xf50075, 0x6350547, 0x81506b5, 0x8950855, 0xb6508d5, 0xc290be5, 0xf050ca9, 0x5cf0f85
  .long 0x76afedcb, 0x54321098, 0x55f55555, 0x55555755, 0x5f, 0x17052f, 0x5, 0x0
  .long 0xc50045, 0x2b50235, 0x5580515, 0x8650595, 0xd2508e5, 0xdf50d75, 0xe850e05, 0x5df0fa5
  .long 0x76afedcb, 0x14325098, 0x55255555, 0x55555255, 0x15, 0x221205, 0x1, 0x0
  .long 0x51b050b, 0x53b052b, 0x55b054b, 0x57b056a, 0x59b058b, 0x5bb05ab, 0x5db05cb, 0x5ef05fb
  .long 0x76afedcb, 0x45321098, 0x55255555, 0x55555855, 0x45, 0x221805, 0x4, 0x0
  .long 0x51e050e, 0x53e052e, 0x55e054e, 0x57e056e, 0x59e058e, 0x5be05ae, 0x5de05ce, 0x5ff05ee
  .long 0x76afedcb, 0x24351098, 0x66166666, 0x66666566, 0x26, 0x211506, 0x2, 0x0
  .long 0x62c061c, 0x64c063c, 0x66c065c, 0x68c067c, 0x6ac069c, 0x6cc06bc, 0x6ec06dc, 0x60f06fc
  .long 0x765feacd, 0xb4321098, 0x66a66666, 0x66666b66, 0xb6, 0x2a1b06, 0xb, 0x0
  .long 0x6200600, 0x6400630, 0x6600650, 0x6800670, 0x6a00690, 0x6c006b0, 0x6e006d0, 0x61f06f0
  .long 0x76afedcb, 0x94321058, 0x66e66666, 0x66666366, 0x96, 0x2e1306, 0x9, 0x0
  .long 0x6190609, 0x6490639, 0x6690659, 0x6890679, 0x6a70699, 0x6c906b9, 0x6e906d9, 0x62f06f9
  .long 0x76afedcb, 0x4325198, 0x66166666, 0x66666466, 0x6, 0x211406, 0x0, 0x0
  .long 0x61a060a, 0x64a062a, 0x66a065a, 0x68a067a, 0x6aa069a, 0x6ca06ba, 0x6ea06da, 0x63f06fa
  .long 0x76afedcb, 0x84321095, 0x66566666, 0x66666966, 0x86, 0x251906, 0x8, 0x0
  .long 0x6180608, 0x6380628, 0x6680658, 0x6880678, 0x6a80698, 0x6c606b8, 0x6e806d8, 0x64f06f8
  .long 0x76afedcb, 0x45321098, 0x66066666, 0x66666566, 0x46, 0x201506, 0x4, 0x0
  .long 0x61e060e, 0x63e062e, 0x66e064e, 0x68e067e, 0x6ae069e, 0x6ce06be, 0x6ee06dd, 0x65f06fe
  .long 0x765fedcb, 0xa4321098, 0x66966666, 0x66666a66, 0xaa, 0x29061a, 0xa, 0x0
  .long 0x2850205, 0x3730345, 0x3f303c5, 0x4b50435, 0x5990519, 0x92506e3, 0xb5209a5, 0x66f0ed4
  .long 0x765aedfb, 0xc4321098, 0x66866666, 0x66666f66, 0xc6, 0x281f06, 0xc, 0x0
  .long 0x6110601, 0x6310621, 0x6510641, 0x6810661, 0x6a10691, 0x6c106b1, 0x6e106d1, 0x67f06f1
  .long 0x76afedcb, 0x54321098, 0x66166666, 0x66666566, 0x51, 0x150621, 0x5, 0x0
  .long 0x3cd034d, 0x63b060c, 0x91e06bb, 0xa2d099e, 0xb6d0aad, 0xbdc0b7e, 0xbfe0bed, 0x68f0e5d
  .long 0x765feacb, 0xd4321098, 0x66a66666, 0x66666b66, 0xd6, 0x2a1b06, 0xd, 0x0
  .long 0x6100602, 0x6320622, 0x6520642, 0x6720662, 0x6a20682, 0x6c206b2, 0x6e206d2, 0x69f06f2
  .long 0x96afedcb, 0x74321058, 0x66e66666, 0x66666366, 0x76, 0x2e1306, 0x7, 0x0
  .long 0x6170607, 0x6370627, 0x6570647, 0x6770667, 0x6970687, 0x6c706b7, 0x6e706d7, 0x6af06f7
  .long 0x76afedcb, 0x14325098, 0x66166666, 0x66666466, 0x16, 0x211406, 0x1, 0x0
  .long 0x61b060b, 0x63a062b, 0x65b064b, 0x67b066b, 0x69b068b, 0x6cb06ab, 0x6eb06db, 0x6bf06fb
  .long 0x78afedcb, 0x64321095, 0x66566666, 0x66666966, 0x66, 0x251906, 0x6, 0x0
  .long 0x6160606, 0x6360626, 0x6560646, 0x6760666, 0x6960686, 0x6b606a6, 0x6e606d6, 0x6cf06f6
  .long 0x76afedcb, 0x35421098, 0x66066666, 0x66666566, 0x36, 0x201506, 0x3, 0x0
  .long 0x61d060d, 0x63d062d, 0x65d064d, 0x67d066d, 0x69d068d, 0x6bd06ad, 0x6ed06cd, 0x6df06fd
  .long 0x765fadcb, 0xe4321098, 0x66966666, 0x66666a66, 0xe6, 0x291a06, 0xe, 0x0
  .long 0x6130603, 0x6330623, 0x6530643, 0x6730663, 0x6930683, 0x6b306a3, 0x6d306c3, 0x6ef06f3
  .long 0x765aedcb, 0xf4321098, 0x66866666, 0x66666f66, 0xf6, 0x281f06, 0xf, 0x0
  .long 0x6140604, 0x6340624, 0x6540644, 0x6710664, 0x6940684, 0x6b406a4, 0x6d406c4, 0x6ff06e4
  .long 0x765fadcb, 0xe4321098, 0x77d77777, 0x77777f77, 0xe7, 0x2d1f07, 0xe, 0x0
  .long 0x7230713, 0x7430733, 0x7630753, 0x7800773, 0x7a30793, 0x7c307b3, 0x7e307d3, 0x70f07f3
  .long 0x76afedcb, 0x4321598, 0x77277777, 0x77777177, 0x7, 0x221107, 0x0, 0x0
  .long 0x72a070a, 0x74a073a, 0x76a075a, 0x78a077a, 0x7aa079a, 0x7ca07ba, 0x7ea07da, 0x71f07fa
  .long 0x765fedcb, 0xa4321098, 0x77877777, 0x77777d77, 0xad, 0x28071d, 0xa, 0x0
  .long 0xc30043, 0x53202f1, 0x5b20574, 0x96307a1, 0xa0409e3, 0xa840a13, 0xf520a93, 0x72f0fd2
  .long 0x76afedcb, 0x24351098, 0x77077777, 0x77777677, 0x27, 0x201607, 0x2, 0x0
  .long 0x71c070c, 0x74c072c, 0x76c075c, 0x78c077c, 0x7ac079c, 0x7cc07bb, 0x7ec07dc, 0x73f07fc
  .long 0x56afedcb, 0x74321098, 0x77677777, 0x77777377, 0x77, 0x261307, 0x7, 0x0
  .long 0x7170707, 0x7370727, 0x7670757, 0x7870777, 0x7a70797, 0x7c607b7, 0x7e707d7, 0x74f07f7
  .long 0x76afedcb, 0x45321098, 0x77477777, 0x77777677, 0x47, 0x241607, 0x4, 0x0
  .long 0x71e070e, 0x73e072e, 0x76e074e, 0x78e077e, 0x7ae079e, 0x7ce07be, 0x7ee07dd, 0x75f07fe
  .long 0x765aefcb, 0xd4321098, 0x77e77777, 0x77777c77, 0xd7, 0x2e1c07, 0xd, 0x0
  .long 0x7120702, 0x7320722, 0x7520742, 0x7820772, 0x7a20792, 0x7c207b2, 0x7e207d2, 0x76f07f2
  .long 0x76afedcb, 0x94321058, 0x77c77777, 0x77777677, 0x97, 0x2c1607, 0x9, 0x0
  .long 0x7190709, 0x7390729, 0x7590749, 0x7890769, 0x7a90799, 0x7c907b9, 0x7e907d9, 0x77f07f8
  .long 0x765fadce, 0xb4321098, 0x77d77777, 0x77777f77, 0xb7, 0x2d1f07, 0xb, 0x0
  .long 0x7100700, 0x7300720, 0x7500740, 0x7700760, 0x7a00790, 0x7c007b0, 0x7e007d0, 0x78f07f0
  .long 0x76afedcb, 0x54321098, 0x77277777, 0x77777177, 0x52, 0x110722, 0x5, 0x0
  .long 0x24c020e, 0x28e027d, 0x56b02cc, 0x5fe05eb, 0xa3e071a, 0xc5e0abe, 0xdad0cde, 0x79f0f2a
  .long 0x765fedab, 0xc4321098, 0x77877777, 0x77777d77, 0xc7, 0x281d07, 0xc, 0x0
  .long 0x7110701, 0x7310721, 0x7510741, 0x7710761, 0x7910781, 0x7c107b1, 0x7e107d1, 0x7af07f1
  .long 0x76afedcb, 0x14352098, 0x77077777, 0x77777677, 0x17, 0x201607, 0x1, 0x0
  .long 0x71b070b, 0x73b072b, 0x75b074b, 0x77b076b, 0x79b078b, 0x7cb07ab, 0x7eb07db, 0x7bf07fb
  .long 0x57afedcb, 0x64321098, 0x77677777, 0x77777377, 0x67, 0x261307, 0x6, 0x0
  .long 0x7160706, 0x7360726, 0x7560746, 0x7760766, 0x7960786, 0x7b607a6, 0x7e607d6, 0x7cf07f6
  .long 0x76afedcb, 0x35421098, 0x77477777, 0x77777677, 0x37, 0x241607, 0x3, 0x0
  .long 0x71d070d, 0x73d072d, 0x75d074d, 0x77d076d, 0x79d078d, 0x7bd07ad, 0x7ed07cd, 0x7df07fd
  .long 0x765aedcb, 0xf4321098, 0x77e77777, 0x77777c77, 0xf7, 0x2e1c07, 0xf, 0x0
  .long 0x7140704, 0x7340724, 0x7540744, 0x7740762, 0x7940784, 0x7b407a4, 0x7d407c4, 0x7ef07f4
  .long 0x76afedcb, 0x84321059, 0x77c77777, 0x77777677, 0x87, 0x2c1607, 0x8, 0x0
  .long 0x7180708, 0x7380728, 0x7580748, 0x7780768, 0x7980788, 0x7b807a8, 0x7d807c8, 0x7ff07e8
  .long 0x765aedcb, 0xf4321098, 0x88e88888, 0x88888b88, 0xf8, 0x2e1b08, 0xf, 0x0
  .long 0x8240814, 0x8440834, 0x8640854, 0x8810874, 0x8a40894, 0x8c408b4, 0x8e408d4, 0x80f08f4
  .long 0x76afedcb, 0x14325098, 0x88388888, 0x88888488, 0x18, 0x231408, 0x1, 0x0
  .long 0x82b080b, 0x84b083b, 0x86b085b, 0x88b087b, 0x8ab089a, 0x8cb08bb, 0x8eb08db, 0x81f08fb
  .long 0x765fadcb, 0xe4321098, 0x88688888, 0x88888e88, 0xe8, 0x261e08, 0xe, 0x0
  .long 0x8130803, 0x8430833, 0x8630853, 0x8830873, 0x8a00893, 0x8c308b3, 0x8e308d3, 0x82f08f3
  .long 0x96afedcb, 0x74321058, 0x88788888, 0x88888888, 0x78, 0x271808, 0x7, 0x0
  .long 0x8170807, 0x8470827, 0x8670857, 0x8870877, 0x8a70897, 0x8c708b7, 0x8e708d7, 0x83f08f7
  .long 0x76afedcb, 0x34521098, 0x88488888, 0x88888788, 0x38, 0x241708, 0x3, 0x0
  .long 0x81d080d, 0x83d082d, 0x86d085d, 0x88d087d, 0x8ad089d, 0x8cd08bd, 0x8ed08dd, 0x84f08fd
  .long 0x76afedcb, 0x54321098, 0x88e88888, 0x88888488, 0x5e, 0x14082e, 0x5, 0x0
  .long 0x3750145, 0x62903f5, 0x76506a9, 0x80507e5, 0x8c50885, 0xa1508d6, 0xc350a95, 0x85f0cb5
  .long 0x765fedcb, 0x8432109a, 0x88f88888, 0x88888988, 0x88, 0x2f1908, 0x8, 0x0
  .long 0x8180808, 0x8380828, 0x8580848, 0x8880878, 0x8a80898, 0x8c808b8, 0x8e808d8, 0x86f08f8
  .long 0x76afedcb, 0x45321098, 0x88388888, 0x88888788, 0x48, 0x231708, 0x4, 0x0
  .long 0x81e080e, 0x83e082e, 0x85e084e, 0x88e086e, 0x8ae089e, 0x8ce08be, 0x8ee08de, 0x87f08fc
  .long 0x765aedfb, 0xc4321098, 0x88e88888, 0x88888b88, 0xc8, 0x2e1b08, 0xc, 0x0
  .long 0x8110801, 0x8310821, 0x8510841, 0x8710861, 0x8a10891, 0x8c108b1, 0x8e108d1, 0x88f08f1
  .long 0x76afedcb, 0x4325198, 0x88388888, 0x88888488, 0x8, 0x231408, 0x0, 0x0
  .long 0x81a080a, 0x83a082a, 0x85a084a, 0x87a086a, 0x8aa088a, 0x8ca08ba, 0x8ea08da, 0x89f08fa
  .long 0x765fadce, 0xb4321098, 0x88688888, 0x88888e88, 0xb8, 0x261e08, 0xb, 0x0
  .long 0x8100800, 0x8300820, 0x8500840, 0x8700860, 0x8900880, 0x8c008b0, 0x8e008d0, 0x8af08f0
  .long 0x76afedcb, 0x94321058, 0x88788888, 0x88888888, 0x98, 0x271808, 0x9, 0x0
  .long 0x8190809, 0x8370829, 0x8590849, 0x8790869, 0x8990889, 0x8c908a9, 0x8e908d9, 0x8bf08f9
  .long 0x765feacb, 0xd4321098, 0x88e88888, 0x88888f88, 0xd8, 0x2e1f08, 0xd, 0x0
  .long 0x8120802, 0x8320822, 0x8520842, 0x8720862, 0x8920882, 0x8b208a2, 0x8e208d2, 0x8cf08f2
  .long 0x75afedcb, 0x64321098, 0x88e88888, 0x88888488, 0x68, 0x2e1408, 0x6, 0x0
  .long 0x8160806, 0x8360826, 0x8560846, 0x8760866, 0x8960886, 0x8b608a6, 0x8e608c6, 0x8df08f6
  .long 0x765fedcb, 0xa4321098, 0x88f88888, 0x88888988, 0xa9, 0x2f0819, 0xa, 0x0
  .long 0x4880408, 0x6c50645, 0xa350868, 0xc550ab5, 0xcd50c75, 0xe250cf5, 0xf150ea5, 0x8ef0f95
  .long 0x76afedcb, 0x25341098, 0x88388888, 0x88888788, 0x28, 0x231708, 0x2, 0x0
  .long 0x81c080c, 0x83c082c, 0x85c084c, 0x87c086c, 0x89c088c, 0x8bc08ac, 0x8dc08cc, 0x8ff08ec
  .long 0x78afedcb, 0x64321095, 0x99799999, 0x99999099, 0x69, 0x271009, 0x6, 0x0
  .long 0x9260916, 0x9460936, 0x9660956, 0x9860976, 0x9a60996, 0x9c609b6, 0x9e609d6, 0x90f09f6
  .long 0x76afedcb, 0x45321098, 0x99199999, 0x99999899, 0x49, 0x211809, 0x4, 0x0
  .long 0x92e090e, 0x94e093e, 0x96e095e, 0x98e097e, 0x9ae099c, 0x9ce09be, 0x9ee09de, 0x91f09fe
  .long 0x76afedcb, 0x14325098, 0x99599999, 0x99999a99, 0x19, 0x251a09, 0x1, 0x0
  .long 0x91b090b, 0x94b093b, 0x96b095b, 0x98b097b, 0x9ab099b, 0x9cb09bb, 0x9eb09db, 0x92f09fb
  .long 0x76afedcb, 0x4521398, 0x99399999, 0x99999599, 0x9, 0x231509, 0x0, 0x0
  .long 0x91a090a, 0x94a092a, 0x96a095a, 0x98a097a, 0x9aa099a, 0x9ca09ba, 0x9ea09da, 0x93f09fa
  .long 0x765feacb, 0xd4321098, 0x99999999, 0x99999c99, 0xd9, 0x291c09, 0xd, 0x0
  .long 0x9120902, 0x9320922, 0x9620952, 0x9820972, 0x9a20992, 0x9c009b2, 0x9e209d2, 0x94f09f2
  .long 0x765aedcb, 0xf4321098, 0x99c99999, 0x99999b99, 0xf9, 0x2c1b09, 0xf, 0x0
  .long 0x9140904, 0x9340924, 0x9640944, 0x9840974, 0x9a40994, 0x9c409b4, 0x9e409d4, 0x95f09f4
  .long 0x765fadcb, 0xe4321098, 0x99599999, 0x99999d99, 0xe9, 0x251d09, 0xe, 0x0
  .long 0x9130903, 0x9330923, 0x9530943, 0x9830973, 0x9a30993, 0x9c309b3, 0x9e109d3, 0x96f09f3
  .long 0x76afedcb, 0x94321058, 0x99d99999, 0x99999599, 0x99, 0x2d1509, 0x9, 0x0
  .long 0x9190909, 0x9390929, 0x9590949, 0x9890969, 0x9a90999, 0x9c909b9, 0x9e909d9, 0x97f09f7
  .long 0x76afedcb, 0x84321095, 0x99799999, 0x99999099, 0x89, 0x271009, 0x8, 0x0
  .long 0x9180906, 0x9380928, 0x9580948, 0x9780968, 0x9a80998, 0x9c809b8, 0x9e809d8, 0x98f09f8
  .long 0x76afedcb, 0x25341098, 0x99199999, 0x99999899, 0x29, 0x211809, 0x2, 0x0
  .long 0x91c090c, 0x93c092c, 0x95c094c, 0x97c096c, 0x9ac098c, 0x9cc09bc, 0x9ec09dc, 0x99f09fc
  .long 0x76afedcb, 0x54321098, 0x99599999, 0x99999a99, 0x55, 0x1a0925, 0x5, 0x0
  .long 0x8e000e, 0x49d041d, 0x6c80648, 0x965092b, 0xb5509e5, 0xeb80e38, 0xf750ed5, 0x9af0ff5
  .long 0x76afedcb, 0x34521098, 0x99399999, 0x99999599, 0x39, 0x231509, 0x3, 0x0
  .long 0x91d090d, 0x93a092d, 0x95d094d, 0x97d096d, 0x99d098d, 0x9cd09ad, 0x9ed09dd, 0x9bf09fd
  .long 0x765feacd, 0xb4321098, 0x99999999, 0x99999c99, 0xb9, 0x291c09, 0xb, 0x0
  .long 0x9100900, 0x9300920, 0x9500940, 0x9700960, 0x9900980, 0x9b009a0, 0x9e009d0, 0x9cf09f0
  .long 0x765fedcb, 0xa4321098, 0x99c99999, 0x99999b99, 0xab, 0x2c091b, 0xa, 0x0
  .long 0x3b10331, 0x4c30443, 0x6920612, 0x8840804, 0xa610954, 0xd240ce2, 0xef30e73, 0x9df0fa3
  .long 0x765fadeb, 0xc4321098, 0x99599999, 0x99999d99, 0xc9, 0x251d09, 0xc, 0x0
  .long 0x9110901, 0x9310921, 0x9510941, 0x9710961, 0x9910981, 0x9b109a1, 0x9d109c1, 0x9ef09f1
  .long 0x96afedcb, 0x74321058, 0x99d99999, 0x99999599, 0x79, 0x2d1509, 0x7, 0x0
  .long 0x9170907, 0x9370927, 0x9570947, 0x9770967, 0x9970987, 0x9b709a7, 0x9d709c7, 0x9ff09e7
  .long 0x765aedcb, 0xf4321098, 0xaa6aaaaa, 0xaaaaadaa, 0xfa, 0x261d0a, 0xf, 0x0
  .long 0xa240a14, 0xa440a34, 0xa640a54, 0xa820a74, 0xaa40a94, 0xac40ab4, 0xae40ad4, 0xa0f0af4
  .long 0x765fadce, 0xb4321098, 0xaaeaaaaa, 0xaaaaadaa, 0xba, 0x2e1d0a, 0xb, 0x0
  .long 0xa200a00, 0xa400a30, 0xa600a50, 0xa800a70, 0xaa00a90, 0xac00ab0, 0xae00ad0, 0xa1f0af0
  .long 0x76afedcb, 0x34521098, 0xaa1aaaaa, 0xaaaaa7aa, 0x3a, 0x21170a, 0x3, 0x0
  .long 0xa1d0a0d, 0xa4d0a3d, 0xa6d0a5d, 0xa8d0a7d, 0xaac0a9d, 0xacd0abd, 0xaed0add, 0xa2f0afd
  .long 0x76afedcb, 0x45321098, 0xaa2aaaaa, 0xaaaaa9aa, 0x4a, 0x22190a, 0x4, 0x0
  .long 0xa1e0a0e, 0xa4e0a2e, 0xa6e0a5e, 0xa8e0a7e, 0xaae0a9e, 0xace0aba, 0xaee0ade, 0xa3f0afe
  .long 0x765fedcb, 0xa4321098, 0xaaaaaaaa, 0xaaaaa8aa, 0xa8, 0x2a0a18, 0xa, 0x0
  .long 0x1d50155, 0x5050275, 0x5f50585, 0x8b50835, 0x9950915, 0xda50ac5, 0xee50e65, 0xa4f0f25
  .long 0x86afedcb, 0x74321095, 0xaadaaaaa, 0xaaaaa2aa, 0x7a, 0x2d120a, 0x7, 0x0
  .long 0xa170a07, 0xa370a27, 0xa670a47, 0xa870a77, 0xaa70a97, 0xac70ab7, 0xae70ad7, 0xa5f0af7
  .long 0x765fedab, 0xc4321098, 0xaa6aaaaa, 0xaaaaabaa, 0xca, 0x261b0a, 0xc, 0x0
  .long 0xa110a01, 0xa310a21, 0xa510a41, 0xa810a71, 0xaa10a91, 0xac10ab1, 0xae10ad1, 0xa6f0af1
  .long 0x765fedcb, 0x943210a8, 0xaaaaaaaa, 0xaaaaa1aa, 0x9a, 0x2a110a, 0x9, 0x0
  .long 0xa190a09, 0xa390a29, 0xa590a49, 0xa890a69, 0xaa90a99, 0xac90ab9, 0xae90ad9, 0xa7f0af6
  .long 0x765aefcb, 0xd4321098, 0xaa6aaaaa, 0xaaaaadaa, 0xda, 0x261d0a, 0xd, 0x0
  .long 0xa120a02, 0xa320a22, 0xa520a42, 0xa720a62, 0xaa20a92, 0xac20ab2, 0xae20ad2, 0xa8f0af2
  .long 0x765fadcb, 0xe4321098, 0xaaeaaaaa, 0xaaaaadaa, 0xea, 0x2e1d0a, 0xe, 0x0
  .long 0xa100a03, 0xa330a23, 0xa530a43, 0xa730a63, 0xaa30a83, 0xac30ab3, 0xae30ad3, 0xa9f0af3
  .long 0x76afedcb, 0x24531098, 0xaa1aaaaa, 0xaaaaa7aa, 0x2a, 0x21170a, 0x2, 0x0
  .long 0xa1c0a0c, 0xa3c0a2c, 0xa5c0a4c, 0xa7c0a6c, 0xa9c0a8c, 0xacc0abc, 0xaec0adc, 0xaaf0afc
  .long 0x76afedcb, 0x5321498, 0xaa2aaaaa, 0xaaaaa9aa, 0xa, 0x22190a, 0x0, 0x0
  .long 0xa1a0a0a, 0xa3a0a2a, 0xa5a0a4a, 0xa7a0a6a, 0xa9a0a8a, 0xaca0aaa, 0xaea0ada, 0xabf0afa
  .long 0x76afedcb, 0x54321098, 0xaaaaaaaa, 0xaaaaa8aa, 0x5a, 0x180a2a, 0x5, 0x0
  .long 0x1a50125, 0x2e50265, 0x3b50335, 0x4850405, 0x6950615, 0xa750a45, 0xd550af5, 0xacf0dd5
  .long 0x76afedcb, 0x84321095, 0xaadaaaaa, 0xaaaaa2aa, 0x8a, 0x2d120a, 0x8, 0x0
  .long 0xa180a08, 0xa380a28, 0xa570a48, 0xa780a68, 0xa980a88, 0xab80aa8, 0xae80ac8, 0xadf0af8
  .long 0x76afedcb, 0x14325098, 0xaa0aaaaa, 0xaaaaa1aa, 0x1a, 0x20110a, 0x1, 0x0
  .long 0xa1b0a0b, 0xa3b0a2b, 0xa5b0a4b, 0xa7b0a6b, 0xa9b0a8b, 0xabb0aab, 0xadb0acb, 0xaef0afb
  .long 0x795fedcb, 0x643210a8, 0xaaaaaaaa, 0xaaaaa1aa, 0x6a, 0x2a110a, 0x6, 0x0
  .long 0xa160a06, 0xa360a26, 0xa560a46, 0xa760a66, 0xa960a86, 0xab60aa6, 0xad60ac6, 0xaff0ae6
  .long 0x765fedcb, 0xa4321098, 0xbb8bbbbb, 0xbbbbb7bb, 0xa7, 0x280b17, 0xa, 0x0
  .long 0x950015, 0x46501c5, 0x55504e5, 0x84505d5, 0x8f50875, 0xaa50a25, 0xf350b86, 0xb0f0fb5
  .long 0x765fedac, 0xb4321098, 0xbbdbbbbb, 0xbbbbbcbb, 0xbb, 0x2d1c0b, 0xb, 0x0
  .long 0xb200b00, 0xb400b30, 0xb600b50, 0xb800b70, 0xba00b90, 0xbc00bb0, 0xbe00bd0, 0xb1f0bf0
  .long 0x765fedcb, 0x943210a8, 0xbbcbbbbb, 0xbbbbb0bb, 0x9b, 0x2c100b, 0x9, 0x0
  .long 0xb190b09, 0xb490b39, 0xb690b59, 0xb890b79, 0xba70b99, 0xbc90bb9, 0xbe90bd9, 0xb2f0bf9
  .long 0x765afdcb, 0xe4321098, 0xbb6bbbbb, 0xbbbbbcbb, 0xeb, 0x261c0b, 0xe, 0x0
  .long 0xb130b03, 0xb430b23, 0xb630b53, 0xb830b73, 0xba30b93, 0xbc30bb3, 0xbe30bd3, 0xb3f0bf3
  .long 0x76afedcb, 0x84321095, 0xbb8bbbbb, 0xbbbbb6bb, 0x8b, 0x28160b, 0x8, 0x0
  .long 0xb180b08, 0xb380b28, 0xb680b58, 0xb880b78, 0xba80b98, 0xbc80bb8, 0xbe80bd8, 0xb4f0bf8
  .long 0x765feacb, 0xd4321098, 0xbb5bbbbb, 0xbbbbbabb, 0xdb, 0x251a0b, 0xd, 0x0
  .long 0xb120b02, 0xb320b22, 0xb620b42, 0xb820b72, 0xba20b92, 0xbc20bb2, 0xbe20bd2, 0xb5f0bf2
  .long 0x76afedcb, 0x34521098, 0xbb1bbbbb, 0xbbbbb4bb, 0x3b, 0x21140b, 0x3, 0x0
  .long 0xb1d0b0d, 0xb3d0b2d, 0xb5d0b4d, 0xb8d0b7d, 0xbad0b9d, 0xbcd0bbd, 0xbeb0bdd, 0xb6f0bfd
  .long 0x76afedcb, 0x5321498, 0xbb1bbbbb, 0xbbbbb2bb, 0xb, 0x21120b, 0x0, 0x0
  .long 0xb1a0b0a, 0xb3a0b2a, 0xb5a0b4a, 0xb8a0b6a, 0xbaa0b9a, 0xbca0bba, 0xbea0bda, 0xb7f0bfa
  .long 0x7a5fedcb, 0x64321098, 0xbb8bbbbb, 0xbbbbb7bb, 0x6b, 0x28170b, 0x6, 0x0
  .long 0xb160b06, 0xb360b26, 0xb560b46, 0xb760b66, 0xba60b96, 0xbc60bb6, 0xbe60bd6, 0xb8f0bf6
  .long 0x765fedab, 0xc4321098, 0xbbdbbbbb, 0xbbbbbcbb, 0xcb, 0x2d1c0b, 0xc, 0x0
  .long 0xb100b01, 0xb310b21, 0xb510b41, 0xb710b61, 0xba10b81, 0xbc10bb1, 0xbe10bd1, 0xb9f0bf1
  .long 0x965fedcb, 0x743210a8, 0xbbcbbbbb, 0xbbbbb0bb, 0x7b, 0x2c100b, 0x7, 0x0
  .long 0xb170b07, 0xb370b27, 0xb570b47, 0xb770b67, 0xb970b87, 0xbc70bb7, 0xbe70bd7, 0xbaf0bf7
  .long 0x765aedcb, 0xf4321098, 0xbb6bbbbb, 0xbbbbbcbb, 0xfb, 0x261c0b, 0xf, 0x0
  .long 0xb140b04, 0xb330b24, 0xb540b44, 0xb740b64, 0xb940b84, 0xbc40ba4, 0xbe40bd4, 0xbbf0bf4
  .long 0x76afedcb, 0x54321098, 0xbb8bbbbb, 0xbbbbb6bb, 0x58, 0x160b28, 0x5, 0x0
  .long 0xd50055, 0x1650135, 0x1e501b5, 0x6f50675, 0x7a50725, 0xb480b05, 0xc150b85, 0xbcf0c95
  .long 0x76afedcb, 0x24351098, 0xbb1bbbbb, 0xbbbbb3bb, 0x2b, 0x21130b, 0x2, 0x0
  .long 0xb1c0b0c, 0xb3c0b2c, 0xb5c0b4c, 0xb7c0b6c, 0xb9c0b8c, 0xbbc0bac, 0xbec0bcc, 0xbdf0bfc
  .long 0x76afedcb, 0x14523098, 0xbb1bbbbb, 0xbbbbb4bb, 0x1b, 0x21140b, 0x1, 0x0
  .long 0xb1b0b0b, 0xb3b0b2b, 0xb5b0b4b, 0xb7b0b6b, 0xb9b0b8b, 0xbbb0bab, 0xbdb0bcb, 0xbef0bfb
  .long 0x76afedcb, 0x45321098, 0xbb1bbbbb, 0xbbbbb2bb, 0x4b, 0x21120b, 0x4, 0x0
  .long 0xb1e0b0e, 0xb3e0b2e, 0xb5e0b4e, 0xb7a0b6e, 0xb9e0b8e, 0xbbe0bae, 0xbde0bce, 0xbff0bee
  .long 0x765fadce, 0xb4321098, 0xcccccccc, 0xcccccccc, 0xbc, 0x2c1c0c, 0xb, 0x0
  .long 0xc200c10, 0xc400c30, 0xc600c50, 0xc800c70, 0xca00c90, 0xcc00cb0, 0xce00cd0, 0xc0f0cf0
  .long 0x765aedfb, 0xc4321098, 0xcc8ccccc, 0xcccccfcc, 0xcc, 0x281f0c, 0xc, 0x0
  .long 0xc210c01, 0xc410c31, 0xc610c51, 0xc810c71, 0xca10c91, 0xcc10cb1, 0xce10cd1, 0xc1f0cf1
  .long 0x765fedcb, 0x843210a9, 0xccbccccc, 0xccccc4cc, 0x8c, 0x2b140c, 0x8, 0x0
  .long 0xc180c08, 0xc480c38, 0xc680c58, 0xc880c78, 0xca80c98, 0xcc80cb8, 0xce80cd8, 0xc2f0cf8
  .long 0x765fedcb, 0xa4321098, 0xcceccccc, 0xccccc1cc, 0xa1, 0x2e0c11, 0xa, 0x0
  .long 0x1a80128, 0x3570305, 0x3d70385, 0x7950715, 0xae50a79, 0xc450af9, 0xcb70c65, 0xc3f0cc5
  .long 0x76afedcb, 0x34521098, 0xcc0ccccc, 0xccccc1cc, 0x3c, 0x20110c, 0x3, 0x0
  .long 0xc1d0c0d, 0xc3d0c2d, 0xc6d0c5d, 0xc8d0c7d, 0xcad0c9d, 0xccb0cbd, 0xced0cdd, 0xc4f0cfd
  .long 0x76afedcb, 0x25341098, 0xcc2ccccc, 0xccccc9cc, 0x2c, 0x22190c, 0x2, 0x0
  .long 0xc1c0c0c, 0xc3c0c2c, 0xc6c0c4c, 0xc8c0c7c, 0xcac0c9c, 0xccc0cbc, 0xcec0cdc, 0xc5f0cfc
  .long 0x76afedcb, 0x4321598, 0xcc0ccccc, 0xccccc1cc, 0xc, 0x20110c, 0x0, 0x0
  .long 0xc1a0c0a, 0xc3a0c2a, 0xc5a0c4a, 0xc8a0c7a, 0xcaa0c9a, 0xcca0cba, 0xcea0cda, 0xc6f0cfa
  .long 0x76afedcb, 0x54321098, 0xcc7ccccc, 0xccccc9cc, 0x57, 0x190c27, 0x5, 0x0
  .long 0x990019, 0x2d50255, 0x4690445, 0x4e904c5, 0x5a50525, 0x8b90839, 0x9880908, 0xc7f0cf6
  .long 0x765fadcb, 0xe4321098, 0xcccccccc, 0xcccccccc, 0xec, 0x2c1c0c, 0xe, 0x0
  .long 0xc130c00, 0xc330c23, 0xc530c43, 0xc730c63, 0xca30c93, 0xcc30cb3, 0xce30cd3, 0xc8f0cf3
  .long 0x765aedcb, 0xf4321098, 0xcc8ccccc, 0xcccccfcc, 0xfc, 0x281f0c, 0xf, 0x0
  .long 0xc110c04, 0xc340c24, 0xc540c44, 0xc740c64, 0xca40c84, 0xcc40cb4, 0xce40cd4, 0xc9f0cf4
  .long 0x765fedcb, 0x943210a8, 0xccbccccc, 0xccccc4cc, 0x9c, 0x2b140c, 0x9, 0x0
  .long 0xc190c09, 0xc390c28, 0xc590c49, 0xc790c69, 0xc990c89, 0xcc90cb9, 0xce90cd9, 0xcaf0cf9
  .long 0xa65fedcb, 0x74321098, 0xcceccccc, 0xccccc1cc, 0x7c, 0x2e110c, 0x7, 0x0
  .long 0xc170c07, 0xc370c27, 0xc570c47, 0xc770c67, 0xc970c87, 0xcc70ca7, 0xce70cd7, 0xcbf0cf7
  .long 0x76afedcb, 0x14523098, 0xcc0ccccc, 0xccccc1cc, 0x1c, 0x20110c, 0x1, 0x0
  .long 0xc1b0c0b, 0xc3b0c2b, 0xc5b0c4b, 0xc7b0c6b, 0xc9b0c8b, 0xcbb0cab, 0xceb0cdb, 0xccf0cfb
  .long 0x76afedcb, 0x45321098, 0xcc2ccccc, 0xccccc9cc, 0x4c, 0x22190c, 0x4, 0x0
  .long 0xc1e0c0e, 0xc3e0c2e, 0xc5c0c4e, 0xc7e0c6e, 0xc9e0c8e, 0xcbe0cae, 0xcee0cce, 0xcdf0cfe
  .long 0x765feacb, 0xd4321098, 0xcc6ccccc, 0xcccccbcc, 0xdc, 0x261b0c, 0xd, 0x0
  .long 0xc120c02, 0xc320c22, 0xc520c42, 0xc720c62, 0xc920c82, 0xcb20ca2, 0xcd20cc2, 0xcef0cf2
  .long 0x75afedcb, 0x64321098, 0xcc7ccccc, 0xccccc9cc, 0x6c, 0x27190c, 0x6, 0x0
  .long 0xc160c06, 0xc360c26, 0xc560c46, 0xc760c66, 0xc960c86, 0xcb60ca6, 0xcd60cc6, 0xcff0ce6
  .long 0x76afedcb, 0x24351098, 0xdd0ddddd, 0xddddd6dd, 0x2d, 0x20160d, 0x2, 0x0
  .long 0xd2c0d1c, 0xd4c0d3c, 0xd6c0d5c, 0xd8b0d7c, 0xdac0d9c, 0xdcc0dbc, 0xdec0ddc, 0xd0f0dfc
  .long 0x56afedcb, 0x74321098, 0xdd6ddddd, 0xddddd3dd, 0x7d, 0x26130d, 0x7, 0x0
  .long 0xd270d07, 0xd470d37, 0xd670d57, 0xd870d77, 0xda70d97, 0xdc70db7, 0xde70dd7, 0xd1f0df7
  .long 0x765aedcb, 0xf4321098, 0xddfddddd, 0xdddddbdd, 0xfd, 0x2f1b0d, 0xf, 0x0
  .long 0xd140d04, 0xd440d34, 0xd640d54, 0xd840d74, 0xda40d94, 0xdc40db4, 0xde40dd4, 0xd2f0df4
  .long 0x76afedcb, 0x94321058, 0xdddddddd, 0xddddd3dd, 0x9d, 0x2d130d, 0x9, 0x0
  .long 0xd190d09, 0xd490d29, 0xd690d59, 0xd890d79, 0xda90d99, 0xdc90db6, 0xde90dd9, 0xd3f0df9
  .long 0x76afedcb, 0x45321098, 0xdd3ddddd, 0xddddd0dd, 0x4d, 0x23100d, 0x4, 0x0
  .long 0xd1e0d0e, 0xd3e0d2e, 0xd6e0d5e, 0xd8e0d7e, 0xdae0d9e, 0xdca0dbe, 0xdee0dde, 0xd4f0dfe
  .long 0x765feadb, 0xc4321098, 0xddaddddd, 0xdddddedd, 0xcd, 0x2a1e0d, 0xc, 0x0
  .long 0xd110d01, 0xd310d21, 0xd610d41, 0xd810d71, 0xda10d91, 0xdc10db1, 0xde10dd1, 0xd5f0df1
  .long 0x765fadce, 0xb4321098, 0xddbddddd, 0xdddddfdd, 0xbd, 0x2b1f0d, 0xb, 0x0
  .long 0xd100d00, 0xd300d20, 0xd500d40, 0xd800d70, 0xda00d90, 0xdc00db0, 0xde00dd0, 0xd6f0df0
  .long 0x765fedcb, 0xa4321098, 0xddfddddd, 0xddddd0dd, 0xa0, 0x2f0d10, 0xa, 0x0
  .long 0xe50065, 0x1950115, 0x2d90259, 0x9850905, 0xba90b29, 0xdc50d45, 0xe350df8, 0xd7f0eb5
  .long 0x76afedcb, 0x14352098, 0xdd0ddddd, 0xddddd6dd, 0x1d, 0x20160d, 0x1, 0x0
  .long 0xd1b0d0b, 0xd3b0d2b, 0xd5b0d4b, 0xd7b0d6b, 0xdab0d9b, 0xdcb0dbb, 0xdeb0ddb, 0xd8f0dfb
  .long 0x76afedcb, 0x54321098, 0xdd6ddddd, 0xddddd3dd, 0x56, 0x130d26, 0x5, 0x0
  .long 0x4750455, 0x4f504d5, 0x7c70747, 0x8a50825, 0xa650a05, 0xb350a85, 0xce50bb5, 0xd9f0d17
  .long 0x76afedcb, 0x34521098, 0xdd2ddddd, 0xddddd8dd, 0x3d, 0x22180d, 0x3, 0x0
  .long 0xd1d0d0d, 0xd3d0d2d, 0xd5d0d4d, 0xd7d0d6d, 0xd9d0d8d, 0xdcd0dbd, 0xded0ddd, 0xdaf0dfd
  .long 0x79afedcb, 0x64321058, 0xdddddddd, 0xddddd3dd, 0x6d, 0x2d130d, 0x6, 0x0
  .long 0xd160d06, 0xd360d26, 0xd560d46, 0xd760d66, 0xd960d86, 0xdc60da6, 0xde60dd6, 0xdbf0df6
  .long 0x76afedcb, 0x5321498, 0xdd3ddddd, 0xddddd0dd, 0xd, 0x23100d, 0x0, 0x0
  .long 0xd1a0d0a, 0xd3a0d2a, 0xd5a0d4a, 0xd7a0d6a, 0xd9a0d8a, 0xdba0daa, 0xdea0dda, 0xdcf0dfa
  .long 0x765feacb, 0xd4321098, 0xddaddddd, 0xdddddedd, 0xdd, 0x2a1e0d, 0xd, 0x0
  .long 0xd120d02, 0xd320d22, 0xd510d42, 0xd720d62, 0xd920d82, 0xdb20da2, 0xde20dc2, 0xddf0df2
  .long 0x765fadcb, 0xe4321098, 0xddbddddd, 0xdddddfdd, 0xed, 0x2b1f0d, 0xe, 0x0
  .long 0xd130d03, 0xd330d23, 0xd530d43, 0xd730d60, 0xd930d83, 0xdb30da3, 0xdd30dc3, 0xdef0df3
  .long 0x765fedcb, 0x8432109a, 0xddfddddd, 0xddddd0dd, 0x8d, 0x2f100d, 0x8, 0x0
  .long 0xd180d08, 0xd380d28, 0xd580d48, 0xd780d68, 0xd980d88, 0xdb80da8, 0xdd80dc8, 0xdff0de8
  .long 0x7a5fedcb, 0x64321098, 0xeefeeeee, 0xeeeee2ee, 0x6e, 0x2f120e, 0x6, 0x0
  .long 0xe260e16, 0xe460e36, 0xe660e56, 0xe860e76, 0xea60e96, 0xec60eb6, 0xee60ed6, 0xe0f0ef6
  .long 0x76afedcb, 0x4351298, 0xee4eeeee, 0xeeeee2ee, 0xe, 0x24120e, 0x0, 0x0
  .long 0xe2a0e0a, 0xe4a0e3a, 0xe6a0e5a, 0xe8a0e7a, 0xeaa0e9a, 0xeca0eba, 0xeea0eda, 0xe1f0efa
  .long 0x76afedcb, 0x45321098, 0xee4eeeee, 0xeeeee9ee, 0x4e, 0x24190e, 0x4, 0x0
  .long 0xe1e0e0e, 0xe4e0e3e, 0xe6e0e5e, 0xe8e0e7e, 0xeab0e9e, 0xece0ebe, 0xeee0ede, 0xe2f0efe
  .long 0x76afedcb, 0x84321095, 0xee5eeeee, 0xeeeee0ee, 0x8e, 0x25100e, 0x8, 0x0
  .long 0xe180e08, 0xe480e28, 0xe680e58, 0xe880e78, 0xea80e98, 0xec80eb7, 0xee80ed8, 0xe3f0ef8
  .long 0x765feadb, 0xc4321098, 0xeeceeeee, 0xeeeeeeee, 0xce, 0x2c1e0e, 0xc, 0x0
  .long 0xe110e01, 0xe310e21, 0xe610e51, 0xe810e71, 0xea10e91, 0xec10eb1, 0xee10ed1, 0xe4f0ef1
  .long 0x76afedcb, 0x34521098, 0xee1eeeee, 0xeeeee3ee, 0x3e, 0x21130e, 0x3, 0x0
  .long 0xe1d0e0d, 0xe3d0e2d, 0xe6d0e4d, 0xe8d0e7d, 0xead0e9d, 0xecd0ebd, 0xeed0edd, 0xe5f0efd
  .long 0x76afedcb, 0x54321098, 0xeedeeeee, 0xeeeee8ee, 0x5d, 0x180e2d, 0x5, 0x0
  .long 0xa50025, 0x7850705, 0x9f90979, 0xad80a58, 0xb950b15, 0xdb90d39, 0xf450ee9, 0xe6f0fc5
  .long 0x765fadce, 0xb4321098, 0xeebeeeee, 0xeeeeebee, 0xbe, 0x2b1b0e, 0xb, 0x0
  .long 0xe100e00, 0xe300e20, 0xe500e40, 0xe800e60, 0xea00e90, 0xec00eb0, 0xee00ed0, 0xe7f0ef0
  .long 0x765fedcb, 0xa4321098, 0xeefeeeee, 0xeeeee2ee, 0xa2, 0x2f0e12, 0xa, 0x0
  .long 0xb80038, 0x3a50325, 0x5e50565, 0xad50a55, 0xbf50b75, 0xe150e06, 0xf490e95, 0xe8f0fc9
  .long 0x76afedcb, 0x24351098, 0xee4eeeee, 0xeeeee2ee, 0x2e, 0x24120e, 0x2, 0x0
  .long 0xe1a0e0c, 0xe3c0e2c, 0xe5c0e4c, 0xe7c0e6c, 0xeac0e8c, 0xecc0ebc, 0xeec0edc, 0xe9f0efc
  .long 0x76afedcb, 0x15324098, 0xee4eeeee, 0xeeeee9ee, 0x1e, 0x24190e, 0x1, 0x0
  .long 0xe1b0e0b, 0xe3b0e2b, 0xe5b0e4b, 0xe7b0e6b, 0xe9b0e8b, 0xecb0ebb, 0xeeb0edb, 0xeaf0efb
  .long 0x86afedcb, 0x74321095, 0xee5eeeee, 0xeeeee0ee, 0x7e, 0x25100e, 0x7, 0x0
  .long 0xe170e07, 0xe370e27, 0xe570e47, 0xe770e67, 0xe970e87, 0xec70ea7, 0xee70ed7, 0xebf0ef7
  .long 0x765feacb, 0xd4321098, 0xeeceeeee, 0xeeeeeeee, 0xde, 0x2c1e0e, 0xd, 0x0
  .long 0xe120e02, 0xe320e22, 0xe520e41, 0xe720e62, 0xe920e82, 0xeb20ea2, 0xee20ed2, 0xecf0ef2
  .long 0x765aedcb, 0xf4321098, 0xee5eeeee, 0xeeeeeaee, 0xfe, 0x251a0e, 0xf, 0x0
  .long 0xe140e04, 0xe340e24, 0xe540e44, 0xe740e64, 0xe940e84, 0xeb40ea4, 0xee40ec4, 0xedf0ef4
  .long 0x76afedcb, 0x94321058, 0xeedeeeee, 0xeeeee8ee, 0x9e, 0x2d180e, 0x9, 0x0
  .long 0xe190e09, 0xe390e29, 0xe590e49, 0xe790e69, 0xe990e89, 0xeb90ea9, 0xed90ec9, 0xeef0ef9
  .long 0x765fadcb, 0xe4321098, 0xeebeeeee, 0xeeeeebee, 0xee, 0x2b1b0e, 0xe, 0x0
  .long 0xe130e03, 0xe330e23, 0xe530e43, 0xe700e63, 0xe930e83, 0xeb30ea3, 0xed30ec3, 0xeff0ee3
  .long 0x76afedcb, 0x34521098, 0xff3fffff, 0xfffff4ff, 0x3f, 0x23140f, 0x3, 0x0
  .long 0xf2d0f1d, 0xf4d0f3d, 0xf6d0f5d, 0xf8b0f7d, 0xfad0f9d, 0xfcd0fbd, 0xfed0fdd, 0xf0f0ffd
  .long 0x76afedcb, 0x25341098, 0xff0fffff, 0xfffff9ff, 0x2f, 0x20190f, 0x2, 0x0
  .long 0xf2c0f0c, 0xf4c0f3c, 0xf6c0f5c, 0xf8c0f7c, 0xfac0f9c, 0xfcc0fbc, 0xfec0fdc, 0xf1f0ffc
  .long 0x76afedcb, 0x4321598, 0xff2fffff, 0xfffff8ff, 0xf, 0x22180f, 0x0, 0x0
  .long 0xf1a0f0a, 0xf4a0f3a, 0xf6a0f5a, 0xf8a0f7a, 0xfaa0f9a, 0xfca0fba, 0xfea0fda, 0xf2f0ffa
  .long 0x86afedcb, 0x74321095, 0xffbfffff, 0xfffff7ff, 0x7f, 0x2b170f, 0x7, 0x0
  .long 0xf170f07, 0xf470f27, 0xf670f57, 0xf870f77, 0xfa70f97, 0xfc70fb7, 0xfe70fd7, 0xf3f0ff7
  .long 0x795fedcb, 0x643210a8, 0xffdfffff, 0xfffff2ff, 0x6f, 0x2d120f, 0x6, 0x0
  .long 0xf160f06, 0xf360f26, 0xf660f56, 0xf860f76, 0xfa60f96, 0xfc60fb6, 0xfe60fd6, 0xf4f0ff6
  .long 0x765feacb, 0xd4321098, 0xffbfffff, 0xfffffdff, 0xdf, 0x2b1d0f, 0xd, 0x0
  .long 0xf120f02, 0xf320f22, 0xf620f42, 0xf820f72, 0xfa20f92, 0xfc20fb2, 0xfe20fd1, 0xf5f0ff2
  .long 0x76afedcb, 0x54321098, 0xffcfffff, 0xfffff5ff, 0x5c, 0x150f2c, 0x5, 0x0
  .long 0x2950215, 0x5b50535, 0x7f90779, 0x9d50955, 0xba50b25, 0xc850c05, 0xec50e45, 0xf6f0fe5
  .long 0x765aedcf, 0xb4321098, 0xff5fffff, 0xfffffcff, 0xbf, 0x251c0f, 0xb, 0x0
  .long 0xf100f00, 0xf300f20, 0xf500f40, 0xf800f60, 0xfa00f90, 0xfc00fb0, 0xfe00fd0, 0xf7f0ff0
  .long 0x76afedcb, 0x14523098, 0xff3fffff, 0xfffff4ff, 0x1f, 0x23140f, 0x1, 0x0
  .long 0xf1b0f0b, 0xf3b0f2b, 0xf5b0f4b, 0xf7b0f6b, 0xfab0f9b, 0xfcb0fbb, 0xfeb0fdb, 0xf8f0ffb
  .long 0x76afedcb, 0x45321098, 0xff0fffff, 0xfffff9ff, 0x4f, 0x20190f, 0x4, 0x0
  .long 0xf1c0f0e, 0xf3e0f2e, 0xf5e0f4e, 0xf7e0f6e, 0xfae0f8e, 0xfce0fbe, 0xfee0fde, 0xf9f0ffe
  .long 0x765fadcb, 0xe4321098, 0xffffffff, 0xfffffbff, 0xef, 0x2f1b0f, 0xe, 0x0
  .long 0xf130f03, 0xf330f23, 0xf530f43, 0xf730f63, 0xf930f83, 0xfc30fb3, 0xfe30fd3, 0xfaf0ff3
  .long 0x76afedcb, 0x84321095, 0xffbfffff, 0xfffff7ff, 0x8f, 0x2b170f, 0x8, 0x0
  .long 0xf180f08, 0xf370f28, 0xf580f48, 0xf780f68, 0xf980f88, 0xfc80fa8, 0xfe80fd8, 0xfbf0ff8
  .long 0x765fedcb, 0x943210a8, 0xffdfffff, 0xfffff2ff, 0x9f, 0x2d120f, 0x9, 0x0
  .long 0xf190f09, 0xf390f29, 0xf590f46, 0xf790f69, 0xf990f89, 0xfb90fa9, 0xfe90fd9, 0xfcf0ff9
  .long 0x765feadb, 0xc4321098, 0xffbfffff, 0xfffffdff, 0xcf, 0x2b1d0f, 0xc, 0x0
  .long 0xf110f01, 0xf310f21, 0xf510f41, 0xf710f61, 0xf910f81, 0xfb10fa1, 0xfe10fc1, 0xfdf0ff1
  .long 0x765fedcb, 0xa4321098, 0xffcfffff, 0xfffff5ff, 0xa5, 0x2c0f15, 0xa, 0x0
  .long 0x2450225, 0x2c502a5, 0x4950415, 0x6550605, 0x6d50685, 0x9750935, 0x9f509b5, 0xfef0f65
  .long 0x765aedcb, 0xf4321098, 0xff5fffff, 0xfffffcff, 0xff, 0x251c0f, 0xf, 0x0
  .long 0xf140f04, 0xf340f24, 0xf540f44, 0xf700f64, 0xf940f84, 0xfb40fa4, 0xfd40fc4, 0xfff0fe4
L_order_end:
.section .rodata,"a"
.p2align 6
.amdhsa_kernel standalone__kv_cache_quant_pre_rope_vs_post_rope__sampling_kernel
  .amdhsa_next_free_vgpr 254
  .amdhsa_next_free_sgpr 102
  .amdhsa_accum_offset 256
  .amdhsa_group_segment_fixed_size 0
  .amdhsa_kernarg_size 112
  .amdhsa_user_sgpr_count 2
  .amdhsa_user_sgpr_kernarg_segment_ptr 1
  .amdhsa_system_sgpr_workgroup_id_x 1
.end_amdhsa_kernel
```

```asm
; @launch grid=(256,1,1) block=(320,1,1) lds=162304
.amdgcn_target "amdgcn-amd-amdhsa--gfx950"
.text
.globl standalone__kv_cache_quant_pre_rope_vs_post_rope__sampling_kernel
.p2align 12
.type L_pad,@object
L_pad:
.fill 832, 4, 0xbf810000
.p2align 8
.type standalone__kv_cache_quant_pre_rope_vs_post_rope__sampling_kernel,@function
standalone__kv_cache_quant_pre_rope_vs_post_rope__sampling_kernel:
  s_cmpk_ge_u32 s2, 0x100
  s_cbranch_scc1 L_end
  s_load_dwordx16 s[4:19], s[0:1], 0
  s_load_dwordx8 s[20:27], s[0:1], 64
  s_load_dwordx4 s[28:31], s[0:1], 96
  v_readfirstlane_b32 s40, v0
  s_lshr_b32 s42, s2, 4
  s_cmp_lg_u32 s40, 0
  s_cbranch_scc1 L_s0
  s_setprio 3
  s_getpc_b64 s[64:65]
L_pc0:
  s_and_b32 s44, s2, 56
  v_and_b32 v20, 63, v0
  v_lshl_add_u32 v1, v20, 6, s44
  v_lshlrev_b32_e64 v1, 4, v1
  v_min_u32 v1, L_order_end-L_pc0-1028, v1
  s_bfm_b64 exec, 50, 0
  global_load_dword v2, v1, s[64:65] offset:1024
  s_mov_b64 exec, -1
  v_min_u32 v21, 47, v20
  v_add_u32 v22, 24, v21
  v_subrev_u32_e64 v23, 24, v21
  v_min_u32 v27, v22, v23
  s_mul_i32 s44, s42, 48
  v_add_lshl_u32 v22, v21, s44, 3
  v_add_lshl_u32 v23, v27, s44, 3
  v_lshlrev_b32 v26, 3, v21
  s_and_b32 s44, s2, 7
  s_lshr_b32 s45, s2, 3
  v_and_b32 v12, 15, v21
  v_and_b32_e64 v4, 48, v21
  v_lshl_add_u32 v12, v4, 5, v12
  s_mul_i32 s68, s44, 96
  s_and_b32 s46, s45, 30
  s_add_u32 s68, s68, s46
  v_lshl_add_u32 v3, s68, 4, v12
  v_lshlrev_b32_e64 v3, 6, v3
  v_lshl_add_u32 v12, s45, 4, v12
  v_lshlrev_b32 v12, 6, v12
  s_lshr_b32 s68, s45, 2
  s_lshl_b32 s68, s68, 8
  s_add_u32 s44, s44, s68
  v_and_b32_e64 v4, 7, v20
  v_lshl_add_u32 v4, s44, 3, v4
  v_and_b32_e64 v5, 24, v20
  v_lshl_add_u32 v4, v5, 6, v4
  v_and_b32_e64 v5, 32, v20
  v_lshl_add_u32 v4, v5, 1, v4
  v_lshlrev_b32_e64 v4, 6, v4
  v_add_u32 v15, 8192, v4
  v_add_u32 v16, 16384, v4
  v_add_u32 v17, 24576, v4
  v_lshlrev_b32 v27, 3, v27
  s_waitcnt lgkmcnt(0)
  s_bitcmp1_b32 s2, 3
  s_cselect_b64 s[70:71], s[24:25], s[22:23]
  global_load_dword v5, v3, s[70:71]
  global_load_dword v6, v3, s[70:71] offset:1024
  global_load_dword v11, v12, s[4:5]
  global_load_dwordx2 v[108:109], v22, s[4:5]
  global_load_dwordx2 v[110:111], v23, s[4:5]
  global_load_dwordx2 v[104:105], v26, s[18:19]
  global_load_dwordx2 v[106:107], v26, s[20:21]
  s_add_u32 s68, s42, 16
  s_mul_i32 s44, s68, 384
  s_add_u32 s32, s4, s44
  s_addc_u32 s33, s5, 0
  global_load_dwordx2 v[112:113], v26, s[32:33]
  global_load_dwordx2 v[114:115], v27, s[32:33]
  s_add_u32 s68, s42, 32
  s_mul_i32 s44, s68, 384
  s_add_u32 s32, s4, s44
  s_addc_u32 s33, s5, 0
  global_load_dwordx2 v[116:117], v26, s[32:33]
  global_load_dwordx2 v[118:119], v27, s[32:33]
  s_bitcmp1_b32 s2, 3
  s_cselect_b64 s[70:71], s[10:11], s[8:9]
  s_cselect_b64 s[64:65], s[16:17], s[14:15]
  s_bitcmp1_b32 s2, 4
  s_cselect_b64 s[64:65], s[64:65], s[70:71]
  global_load_dword v7, v4, s[64:65]
  global_load_dword v8, v15, s[64:65]
  global_load_dword v9, v16, s[64:65]
  global_load_dword v10, v17, s[64:65]
  v_mov_b32 v14, 0
  v_cmp_gt_u32 vcc, 24, v21
  v_mov_b32 v48, 0
  v_mov_b32 v49, 0
  v_mov_b32 v50, 0
  v_mov_b32_e64 v51, 0
  ds_write_b128 v14, v[48:51] offset:0
  ds_write_b128 v14, v[48:51] offset:16
  s_waitcnt lgkmcnt(0)
  s_barrier
  s_mov_b32 s66, 0xffff0000
  s_mov_b32 s67, 0x3dd53b95
  v_cndmask_b32_e64 v30, 1.0, -1.0, vcc
  v_lshlrev_b32 v35, 4, v21
  v_mov_b32 v28, v35
  v_lshlrev_b32_e64 v29, 1, v27
  v_mov_b32 v22, 0x80008000
  v_cndmask_b32 v31, v14, v22, vcc
  v_mov_b32 v38, 1
  s_mov_b32 s43, 1
  s_waitcnt vmcnt(8)
  v_lshlrev_b32 v52, 16, v104
  v_and_b32 v53, s66, v104
  v_lshlrev_b32 v54, 16, v105
  v_and_b32 v55, s66, v105
  v_lshlrev_b32 v56, 16, v106
  v_and_b32 v57, s66, v106
  v_lshlrev_b32 v58, 16, v107
  v_and_b32 v59, s66, v107
L_hr:
  v_lshlrev_b32 v76, 16, v108
  v_and_b32 v77, s66, v108
  v_lshlrev_b32 v78, 16, v109
  v_and_b32 v79, s66, v109
  v_lshlrev_b32 v80, 16, v110
  v_and_b32 v81, s66, v110
  v_lshlrev_b32 v82, 16, v111
  v_and_b32 v83, s66, v111
  v_mul_f32 v76, v76, v52
  v_mul_f32 v77, v77, v53
  v_mul_f32 v78, v78, v54
  v_mul_f32 v79, v79, v55
  v_mul_f32 v80, v80, v56
  v_mul_f32 v81, v81, v57
  v_mul_f32 v82, v82, v58
  v_mul_f32 v83, v83, v59
  v_cvt_pk_bf16_f32 v84, v76, v80
  v_cvt_pk_bf16_f32 v85, v77, v81
  v_cvt_pk_bf16_f32 v86, v78, v82
  v_cvt_pk_bf16_f32 v87, v79, v83
  v_lshlrev_b32 v76, 16, v84
  v_and_b32 v80, s66, v84
  v_lshlrev_b32 v77, 16, v85
  v_and_b32 v81, s66, v85
  v_lshlrev_b32 v78, 16, v86
  v_and_b32 v82, s66, v86
  v_lshlrev_b32 v79, 16, v87
  v_and_b32 v83, s66, v87
  v_fma_f32 v76, v80, v30, v76
  v_fma_f32 v77, v81, v30, v77
  v_fma_f32 v78, v82, v30, v78
  v_fma_f32 v79, v83, v30, v79
  v_cvt_pk_bf16_f32 v84, v76, v77
  v_cvt_pk_bf16_f32 v85, v78, v79
  v_xor_b32 v86, v31, v84
  v_xor_b32 v87, v31, v85
  v_mov_b32_e64 v22, s43
  ds_write_b16 v28, v84 offset:512
  ds_write_b16_d16_hi v28, v84 offset:516
  ds_write_b16 v28, v85 offset:520
  ds_write_b16_d16_hi v28, v85 offset:524
  ds_write_b16 v29, v86 offset:514
  ds_write_b16_d16_hi v29, v86 offset:518
  ds_write_b16 v29, v87 offset:522
  ds_write_b16_d16_hi v29, v87 offset:526
  ds_write_b32 v14, v22 offset:16
  v_add_u32 v28, 1024, v28
  v_add_u32 v29, 1024, v29
  v_and_b32 v28, 0xfff, v28
  v_and_b32 v29, 0xfff, v29
  s_cmp_eq_u32 s43, 3
  s_cbranch_scc1 L_helper
  s_add_u32 s43, s43, 1
  s_waitcnt vmcnt(4) lgkmcnt(0)
  v_mov_b32 v108, v112
  v_mov_b32 v109, v113
  v_mov_b32 v110, v114
  v_mov_b32 v111, v115
  v_mov_b32 v112, v116
  v_mov_b32 v113, v117
  v_mov_b32_e64 v114, v118
  v_mov_b32 v115, v119
  s_branch L_hr
L_s0:
  v_subrev_u32 v0, 64, v0
  s_sub_u32 s40, s40, 64
  s_and_b32 s44, s2, 7
  s_mul_i32 s44, s44, 6
  s_bfe_u32 s41, s2, 0x10003
  s_add_u32 s44, s44, s41
  s_lshl_b32 s44, s44, 15
  s_lshr_b32 s40, s40, 6
  s_cmp_ge_u32 s40, 2
  s_cselect_b64 s[62:63], -1, 0
  s_and_b32 s45, s62, 16384
  s_sub_u32 s68, s44, s45
  s_add_u32 s44, s44, s45
  v_lshl_add_u32 v16, v0, 4, s68
  v_lshl_add_u32 v15, v0, 4, s44
  v_lshrrev_b32 v25, 4, v0
  v_and_b32 v24, 15, v0
  v_add_u32 v208, 0, v15
  v_add_u32 v209, 8192, v15
  v_add_u32 v210, 4096, v15
  s_sub_u32 s45, s41, 0
  s_mul_i32 s45, s45, 98304
  v_cmp_eq_u32 s[64:65], v25, 0
  v_add_u32_e64 v20, s45, v208
  s_nop 0
  v_cndmask_b32_e64 v208, v208, v20, s[64:65]
  v_lshl_add_u32 v22, s41, 1, v25
  v_subrev_u32 v22, s62, v22
  v_mul_u32_u24 v20, 11, v22
  v_lshrrev_b32_e64 v20, 5, v20
  v_mad_i32_i24 v20, v20, -3, v22
  v_lshlrev_b32_e64 v21, 4, v24
  v_lshl_add_u32 v248, v20, 8, v21
  v_add_u32 v20, 256, v248
  v_subrev_u32 v21, 512, v248
  v_min_u32_e64 v249, v20, v21
  v_add_u32 v20, 512, v248
  v_subrev_u32 v21, 256, v248
  v_min_u32 v250, v20, v21
  v_cmp_gt_u32 vcc, 8, v24
  v_lshlrev_b32 v23, 3, v24
  v_lshrrev_b32 v22, 1, v248
  v_add3_u32 v20, v22, v23, 64
  v_subrev_u32 v21, 384, v20
  v_min_u32 v20, v20, v21
  v_sub_u32 v20, v20, v22
  v_cndmask_b32 v242, v20, v23, vcc
  v_lshrrev_b32 v22, 1, v249
  v_add3_u32 v20, v22, v23, 64
  v_subrev_u32 v21, 384, v20
  v_min_u32 v20, v20, v21
  v_sub_u32 v20, v20, v22
  v_cndmask_b32 v243, v20, v23, vcc
  v_lshrrev_b32 v22, 1, v250
  v_add3_u32 v20, v22, v23, 64
  v_subrev_u32 v21, 384, v20
  v_min_u32_e64 v20, v20, v21
  v_sub_u32 v20, v20, v22
  v_cndmask_b32 v244, v20, v23, vcc
  s_mul_i32 s100, s40, 24576
  s_add_u32 s100, s100, 64000
  s_mul_i32 s44, s42, 1572864
  s_mov_b32 s34, 77070336
  s_mov_b32 s35, 0x20000
  s_mov_b32 s80, 25165824
  s_mov_b32 s3, 50331648
  s_mov_b32 s98, 75497472
  s_waitcnt lgkmcnt(0)
  s_add_u32 s32, s6, s44
  s_addc_u32 s33, s7, 0
  v_mov_b32 v21, s22
  v_mov_b32 v28, s24
  v_cndmask_b32 v28, v28, v21, vcc
  v_mov_b32 v21, s23
  v_mov_b32 v29, s25
  v_cndmask_b32 v29, v29, v21, vcc
  s_add_u32 m0, s100, 0
  v_lshrrev_b32 v10, 1, v208
  v_add_u32 v10, v10, v242
  v_mad_u64_u32 v[30:31], s[64:65], v10, 1, v[28:29]
  global_load_lds_dwordx4 v[30:31], off
  buffer_load_dwordx4 v[64:67], v208, s[32:35], 0 offen nt
  buffer_load_dwordx4 v[68:71], v209, s[32:35], 0 offen nt
  s_add_u32 m0, s100, 1024
  v_lshrrev_b32 v10, 1, v209
  v_add_u32 v10, v10, v244
  v_mad_u64_u32 v[30:31], s[64:65], v10, 1, v[28:29]
  global_load_lds_dwordx4 v[30:31], off
  buffer_load_dwordx4 v[72:75], v208, s[32:35], s80 offen nt
  buffer_load_dwordx4 v[76:79], v209, s[32:35], s80 offen nt
  s_add_u32 m0, s100, 2048
  v_lshrrev_b32 v10, 1, v210
  v_add_u32 v10, v10, v243
  v_mad_u64_u32 v[30:31], s[64:65], v10, 1, v[28:29]
  global_load_lds_dwordx4 v[30:31], off
  buffer_load_dwordx4 v[80:83], v208, s[32:35], s3 offen nt
  s_barrier
  s_getpc_b64 s[82:83]
L_pc1:
  s_lshl_b32 s44, s2, 6
  s_add_u32 s44, s44, L_order-L_pc1
  s_add_u32 s82, s82, s44
  s_addc_u32 s83, s83, 0
  s_load_dwordx2 s[92:93], s[82:83], 0
  s_load_dwordx2 s[96:97], s[82:83], 8
  s_mov_b32 s94, 4000000
  v_add_u32 v211, 12288, v15
  v_add_u32 v212, 16384, v16
  v_add_u32 v213, 24576, v16
  v_add_u32 v214, 20480, v16
  v_add_u32 v215, 28672, v16
  v_add_u32 v216, 65536, v15
  v_add_u32 v217, 73728, v15
  v_add_u32 v218, 69632, v15
  v_add_u32 v219, 77824, v15
  v_add_u32 v220, 81920, v16
  v_add_u32 v221, 90112, v16
  v_add_u32 v222, 86016, v16
  v_add_u32 v223, 94208, v16
  v_add_u32 v224, 131072, v15
  v_add_u32 v225, 139264, v15
  v_add_u32 v226, 135168, v15
  v_add_u32 v227, 143360, v15
  v_add_u32 v228, 147456, v16
  v_add_u32 v229, 155648, v16
  v_add_u32 v230, 151552, v16
  v_add_u32 v231, 159744, v16
  s_sub_u32 s45, s41, 0
  s_mul_i32 s45, s45, 98304
  v_cmp_eq_u32 s[64:65], v25, 15
  v_add_u32 v20, s45, v211
  s_nop 0
  v_cndmask_b32_e64 v211, v211, v20, s[64:65]
  s_sub_u32 s45, s41, 1
  s_mul_i32 s45, s45, 98304
  v_cmp_eq_u32 s[64:65], v25, 0
  v_add_u32_e64 v20, s45, v224
  s_nop 0
  v_cndmask_b32_e64 v224, v224, v20, s[64:65]
  s_sub_u32 s45, s41, 1
  s_mul_i32 s45, s45, 98304
  v_cmp_eq_u32 s[64:65], v25, 15
  v_add_u32_e64 v20, s45, v227
  s_nop 0
  v_cndmask_b32_e64 v227, v227, v20, s[64:65]
  v_cndmask_b32_e64 v251, v248, v249, s[62:63]
  v_cndmask_b32_e64 v252, v249, v250, s[62:63]
  v_cndmask_b32_e64 v253, v250, v248, s[62:63]
  v_cndmask_b32_e64 v245, v242, v243, s[62:63]
  v_cndmask_b32_e64 v246, v243, v244, s[62:63]
  v_cndmask_b32_e64 v247, v244, v242, s[62:63]
  v_lshrrev_b32_e64 v22, 6, v0
  v_bfe_u32 v23, v0, 4, 2
  v_mov_b32 v14, 0
  v_and_b32 v20, 2, v0
  v_lshl_add_u32 v21, v20, 5, v25
  v_and_b32_e64 v20, 1, v0
  v_lshl_add_u32 v21, v20, 4, v21
  v_and_b32_e64 v20, 4, v0
  v_lshl_add_u32 v21, v20, 3, v21
  s_and_b32 s44, s62, 64
  v_xor_b32 v21, s44, v21
  v_cmp_eq_u32 s[48:49], 0, v21
  v_cmp_eq_u32 vcc, 127, v21
  s_cmp_eq_u32 s41, 0
  s_cselect_b32 s44, 0, -1
  v_add_u32 v15, s44, v21
  s_cselect_b32 s44, 2, -2
  v_add_u32 v16, s44, v21
  s_cselect_b32 s44, 1, 0
  v_add_u32_e64 v17, s44, v21
  s_cselect_b64 s[50:51], 0, s[48:49]
  s_cselect_b64 s[52:53], 0, vcc
  s_cselect_b64 s[48:49], s[48:49], 0
  s_cselect_b64 vcc, vcc, 0
  v_mov_b32 v20, 254
  v_cndmask_b32_e64 v15, v15, v20, s[50:51]
  v_mov_b32 v20, 255
  v_cndmask_b32_e64 v15, v15, v20, s[52:53]
  v_mov_b32 v20, -128
  v_cndmask_b32_e64 v17, v17, v20, s[48:49]
  v_mov_b32 v20, -127
  v_cndmask_b32_e64 v17, v17, v20, vcc
  v_and_b32 v20, 8, v0
  v_mul_u32_u24 v20, 48, v20
  v_add_lshl_u32 v15, v15, v20, 2
  v_add_u32 v15, 45568, v15
  v_add_lshl_u32 v16, v16, v20, 2
  v_add_u32 v16, 46080, v16
  v_add_lshl_u32 v17, v17, v20, 2
  v_add_u32 v17, 46592, v17
  v_lshl_add_u32 v21, v24, 2, v23
  v_mul_u32_u24 v20, 192, v22
  v_add_lshl_u32 v3, v20, v21, 2
  v_add_u32 v3, 64000, v3
  v_lshlrev_b32 v6, 2, v22
  v_mov_b32 v236, 0
  v_mov_b32 v239, 0
  v_mov_b32 v237, 0
  v_mov_b32 v240, 0
  v_mov_b32 v238, 0
  v_mov_b32_e64 v241, 0
  s_mov_b32 s48, 0x11111111
  s_mov_b32 s49, s48
  s_mov_b32 s50, 0x22222222
  s_mov_b32 s51, s50
  s_mov_b32 s52, 0x44444444
  s_mov_b32 s53, s52
  s_mov_b32 s54, 0x88888888
  s_mov_b32 s55, s54
  s_mov_b32 s56, 0x05040100
  s_mov_b32 s57, 0x07060302
  s_mov_b32 s38, 1572864
  s_mov_b32 s39, 0x20000
  v_lshlrev_b32 v21, 8, v23
  v_add_u32 v21, s100, v21
  v_lshl_add_u32 v12, v24, 3, v21
  s_getreg_b32 s81, hwreg(HW_REG_HW_ID, 13, 2)
  s_getreg_b32 s79, hwreg(HW_REG_HW_ID, 8, 4)
  s_getreg_b32 s46, hwreg(HW_REG_XCC_ID, 0, 3)
  s_mul_i32 s46, s46, 4352
  s_add_u32 s46, s46, 8126464
  s_add_u32 s44, s46, 2048
  v_mov_b32 v11, s44
  s_and_b32 s45, s81, 2
  s_lshl_b32 s45, s45, 9
  s_lshl_b32 s44, s40, 8
  s_add_u32 s44, s44, s45
  s_add_u32 s44, s44, s46
  s_add_u32 s44, s44, s79
  s_and_b32 s81, s81, 1
  s_lshl_b32 s81, s81, 4
  s_add_u32 s44, s44, s81
  v_mov_b32 v7, s44
  s_xor_b32 s45, s45, 1024
  s_add_u32 s46, s46, s45
  v_and_b32 v8, 1, v0
  v_lshl_add_u32 v8, v8, 4, s46
  v_bfe_u32 v21, v0, 1, 2
  v_mad_u32_u24 v21, v21, 4, v22
  v_add_u32 v9, 0, v21
  v_and_b32 v9, 3, v9
  v_lshl_add_u32 v232, v9, 8, v8
  v_add_u32 v9, 1, v21
  v_and_b32 v9, 3, v9
  v_lshl_add_u32 v233, v9, 8, v8
  v_add_u32 v9, 2, v21
  v_and_b32 v9, 3, v9
  v_lshl_add_u32 v234, v9, 8, v8
  v_add_u32 v9, 3, v21
  v_and_b32 v9, 3, v9
  v_lshl_add_u32 v235, v9, 8, v8
  s_mov_b32 s78, 0xfefefeff
  v_mov_b32 v32, 0
  v_mov_b32 v33, 0
  v_mov_b32 v34, 0
  v_mov_b32 v35, 0
  v_mov_b32 v36, 0
  v_mov_b32 v37, 0
  v_mov_b32 v38, 0
  v_mov_b32 v39, 0
  v_mov_b32 v26, 0
  v_mov_b32 v27, 0
  v_mov_b32_e64 v8, 3
  s_getreg_b32 s58, hwreg(HW_REG_XCC_ID, 0, 1)
  s_mul_i32 s58, s58, -5
  s_add_u32 s58, s58, 3
  s_mov_b32 s91, s58
  s_mov_b32 s69, 8
  s_mov_b32 s95, 0
  buffer_load_dwordx4 v[84:87], v209, s[32:35], s3 offen nt
  s_add_u32 m0, s100, 3072
  v_lshrrev_b32 v10, 1, v211
  v_add_u32 v10, v10, v242
  v_mad_u64_u32 v[30:31], s[64:65], v10, 1, v[28:29]
  s_waitcnt vmcnt(8)
  global_load_lds_dwordx4 v[30:31], off
  s_waitcnt vmcnt(8)
  buffer_load_dwordx4 v[88:91], v210, s[32:35], 0 offen nt
  s_waitcnt vmcnt(8)
  buffer_load_dwordx4 v[92:95], v211, s[32:35], 0 offen nt
  s_mov_b32 s47, 2
  ds_read_b32 v4, v14 offset:16
L_fqz:
  s_waitcnt lgkmcnt(0)
  v_readfirstlane_b32 s46, v4
  s_cmp_ge_u32 s46, s47
  s_cbranch_scc1 L_fqz_ok
  s_cmp_eq_u32 s94, 0
  s_cbranch_scc1 L_fqz_ok
  s_sub_u32 s94, s94, 1
  ds_read_b32 v4, v14 offset:16
  s_branch L_fqz
L_fqz_ok:
  ds_read_b128 v[40:43], v248 offset:512
  ds_read_b128 v[44:47], v250 offset:512
  ds_read_b128 v[48:51], v248 offset:1536
  s_add_u32 m0, s100, 4096
  v_lshrrev_b32 v10, 1, v212
  v_add_u32 v10, v10, v246
  v_mad_u64_u32 v[30:31], s[64:65], v10, 1, v[28:29]
  s_waitcnt vmcnt(8)
  global_load_lds_dwordx4 v[30:31], off
  ds_read_b64 v[112:113], v12 offset:0
  ds_read_b64 v[114:115], v12 offset:128
  ds_read_b64 v[116:117], v12 offset:1024
  ds_read_b64 v[118:119], v12 offset:1152
  s_waitcnt vmcnt(8)
  buffer_load_dwordx4 v[96:99], v210, s[32:35], s80 offen nt
L_it0:
  s_mov_b32 s47, 3
  ds_read_b32 v4, v14 offset:16
L_fq0:
  s_waitcnt lgkmcnt(0)
  v_readfirstlane_b32 s46, v4
  s_cmp_ge_u32 s46, s47
  s_cbranch_scc1 L_fq0_ok
  s_cmp_eq_u32 s94, 0
  s_cbranch_scc1 L_fq0_ok
  s_sub_u32 s94, s94, 1
  ds_read_b32 v4, v14 offset:16
  s_branch L_fq0
L_fq0_ok:
  ds_read_b128 v[52:55], v250 offset:1536
  ds_read_b128 v[56:59], v248 offset:2560
  ds_read_b128 v[60:63], v250 offset:2560
  v_perm_b32 v13, v114, v112, s56
  v_perm_b32 v114, v114, v112, s57
  v_perm_b32 v112, v115, v113, s56
  v_perm_b32 v115, v115, v113, s57
  v_dot2_f32_bf16 v22, v13, v40, 0
  v_dot2_f32_bf16 v23, v114, v41, 0
  v_dot2_f32_bf16 v24, v112, v42, 0
  v_dot2_f32_bf16 v25, v115, v43, 0
  v_cvt_f32_i32 v64, v64
  v_cvt_f32_i32 v65, v65
  v_cvt_f32_i32 v66, v66
  v_cvt_f32_i32_e64 v67, v67
  v_pk_mul_f32 v[20:21], v[64:65], v[22:23]
  v_pk_add_f32 v[18:19], v[22:23], v[24:25]
  v_pk_fma_f32 v[20:21], v[66:67], v[24:25], v[20:21]
  v_add_f32 v18, v18, v19
  v_add_f32 v20, v20, v21
  s_add_u32 m0, s100, 5120
  v_lshrrev_b32 v10, 1, v213
  v_add_u32 v10, v10, v245
  v_mad_u64_u32 v[30:31], s[64:65], v10, 1, v[28:29]
  s_waitcnt vmcnt(8)
  global_load_lds_dwordx4 v[30:31], off
  s_waitcnt vmcnt(8)
  buffer_load_dwordx4 v[100:103], v211, s[32:35], s80 offen nt
  v_perm_b32 v113, v118, v116, s56
  v_perm_b32 v118, v118, v116, s57
  v_perm_b32 v116, v119, v117, s56
  v_perm_b32 v119, v119, v117, s57
  v_dot2_f32_bf16 v22, v113, v44, 0
  v_add_f32_dpp v239, v18, v18 row_ror:8 row_mask:0xf bank_mask:0xc
  v_add_f32_dpp v239, v20, v20 row_ror:8 row_mask:0xf bank_mask:0x3
  v_dot2_f32_bf16 v23, v118, v45, 0
  v_dot2_f32_bf16 v24, v116, v46, 0
  v_dot2_f32_bf16 v25, v119, v47, 0
  v_cvt_f32_i32 v68, v68
  v_cvt_f32_i32 v69, v69
  v_cvt_f32_i32 v70, v70
  v_cvt_f32_i32 v71, v71
  v_pk_mul_f32 v[20:21], v[68:69], v[22:23]
  v_pk_add_f32 v[18:19], v[22:23], v[24:25]
  v_pk_fma_f32 v[20:21], v[70:71], v[24:25], v[20:21]
  v_add_f32_e64 v18, v18, v19
  v_add_f32 v20, v20, v21
  s_waitcnt vmcnt(8)
  buffer_load_dwordx4 v[104:107], v210, s[32:35], s3 offen nt
  v_dot2_f32_bf16 v22, v13, v48, 0
  v_add_f32_dpp v21, v18, v18 row_ror:8 row_mask:0xf bank_mask:0xc
  v_add_f32_dpp v21, v20, v20 row_ror:8 row_mask:0xf bank_mask:0x3
  v_add_f32_dpp v20, v239, v239 row_half_mirror row_mask:0xf bank_mask:0x5
  v_dot2_f32_bf16 v23, v114, v49, 0
  v_add_f32_dpp v20, v21, v21 row_half_mirror row_mask:0xf bank_mask:0xa
  v_dot2_f32_bf16 v24, v112, v50, 0
  v_dot2_f32_bf16 v25, v115, v51, 0
  v_add_f32_dpp v20, v20, v20 quad_perm:[2,3,0,1] row_mask:0xf bank_mask:0xf
  v_cvt_f32_i32 v72, v72
  v_cvt_f32_i32 v73, v73
  v_add_f32_dpp v20, v20, v20 quad_perm:[1,0,3,2] row_mask:0xf bank_mask:0xf
  v_cndmask_b32_e64 v236, v236, v20, s[48:49]
  v_cvt_f32_i32 v74, v74
  v_cvt_f32_i32 v75, v75
  v_pk_mul_f32 v[20:21], v[72:73], v[22:23]
  v_pk_add_f32 v[18:19], v[22:23], v[24:25]
  v_pk_fma_f32 v[20:21], v[74:75], v[24:25], v[20:21]
  v_add_f32_e64 v18, v18, v19
  v_add_f32 v20, v20, v21
  s_waitcnt vmcnt(8)
  buffer_load_dwordx4 v[108:111], v211, s[32:35], s3 offen nt
L_it1:
  s_waitcnt lgkmcnt(0)
  ds_read_b128 v[40:43], v249 offset:512
  ds_read_b128 v[44:47], v248 offset:512
  ds_read_b128 v[48:51], v249 offset:1536
  v_dot2_f32_bf16 v22, v113, v52, 0
  v_add_f32_dpp v240, v18, v18 row_ror:8 row_mask:0xf bank_mask:0xc
  v_add_f32_dpp v240, v20, v20 row_ror:8 row_mask:0xf bank_mask:0x3
  v_dot2_f32_bf16 v23, v118, v53, 0
  v_dot2_f32_bf16 v24, v116, v54, 0
  v_dot2_f32_bf16 v25, v119, v55, 0
  v_cvt_f32_i32 v76, v76
  v_cvt_f32_i32 v77, v77
  v_cvt_f32_i32 v78, v78
  v_cvt_f32_i32_e64 v79, v79
  v_pk_mul_f32 v[20:21], v[76:77], v[22:23]
  v_pk_add_f32 v[18:19], v[22:23], v[24:25]
  v_pk_fma_f32 v[20:21], v[78:79], v[24:25], v[20:21]
  v_add_f32 v18, v18, v19
  v_add_f32 v20, v20, v21
  s_add_u32 m0, s100, 6144
  v_lshrrev_b32 v10, 1, v214
  v_add_u32 v10, v10, v247
  v_mad_u64_u32 v[30:31], s[64:65], v10, 1, v[28:29]
  s_waitcnt vmcnt(8)
  global_load_lds_dwordx4 v[30:31], off
  s_waitcnt vmcnt(8)
  buffer_load_dwordx4 v[64:67], v212, s[32:35], 0 offen nt
  v_dot2_f32_bf16 v22, v13, v56, 0
  v_add_f32_dpp v21, v18, v18 row_ror:8 row_mask:0xf bank_mask:0xc
  v_add_f32_dpp v21, v20, v20 row_ror:8 row_mask:0xf bank_mask:0x3
  v_add_f32_dpp v20, v240, v240 row_half_mirror row_mask:0xf bank_mask:0x5
  v_dot2_f32_bf16 v23, v114, v57, 0
  v_add_f32_dpp v20, v21, v21 row_half_mirror row_mask:0xf bank_mask:0xa
  v_dot2_f32_bf16 v24, v112, v58, 0
  v_dot2_f32_bf16 v25, v115, v59, 0
  v_add_f32_dpp v20, v20, v20 quad_perm:[2,3,0,1] row_mask:0xf bank_mask:0xf
  v_cvt_f32_i32 v80, v80
  v_cvt_f32_i32 v81, v81
  v_add_f32_dpp v20, v20, v20 quad_perm:[1,0,3,2] row_mask:0xf bank_mask:0xf
  v_cndmask_b32_e64 v237, v237, v20, s[48:49]
  v_cvt_f32_i32 v82, v82
  v_cvt_f32_i32 v83, v83
  v_pk_mul_f32 v[20:21], v[80:81], v[22:23]
  v_pk_add_f32 v[18:19], v[22:23], v[24:25]
  v_pk_fma_f32 v[20:21], v[82:83], v[24:25], v[20:21]
  v_add_f32_e64 v18, v18, v19
  v_add_f32 v20, v20, v21
  s_waitcnt vmcnt(8)
  buffer_load_dwordx4 v[68:71], v213, s[32:35], 0 offen nt
  ds_read_b64 v[120:121], v12 offset:2048
  ds_read_b64 v[122:123], v12 offset:2176
  ds_read_b64 v[124:125], v12 offset:3072
  ds_read_b64 v[126:127], v12 offset:3200
  v_dot2_f32_bf16 v22, v113, v60, 0
  v_add_f32_dpp v241, v18, v18 row_ror:8 row_mask:0xf bank_mask:0xc
  v_add_f32_dpp v241, v20, v20 row_ror:8 row_mask:0xf bank_mask:0x3
  v_dot2_f32_bf16 v23, v118, v61, 0
  v_dot2_f32_bf16 v24, v116, v62, 0
  v_dot2_f32_bf16 v25, v119, v63, 0
  v_cvt_f32_i32 v84, v84
  v_cvt_f32_i32 v85, v85
  v_cvt_f32_i32 v86, v86
  v_cvt_f32_i32 v87, v87
  v_pk_mul_f32 v[20:21], v[84:85], v[22:23]
  v_pk_add_f32 v[18:19], v[22:23], v[24:25]
  v_pk_fma_f32 v[20:21], v[86:87], v[24:25], v[20:21]
  v_add_f32_e64 v18, v18, v19
  v_add_f32 v20, v20, v21
  s_waitcnt vmcnt(7)
  buffer_load_dwordx4 v[72:75], v212, s[32:35], s80 offen nt
L_it2:
  s_waitcnt lgkmcnt(0)
  ds_read_b128 v[52:55], v248 offset:1536
  ds_read_b128 v[56:59], v249 offset:2560
  ds_read_b128 v[60:63], v248 offset:2560
  ds_read_b32 v4, v14 offset:24
  v_perm_b32 v117, v122, v120, s56
  v_perm_b32 v122, v122, v120, s57
  v_perm_b32 v120, v123, v121, s56
  v_perm_b32 v123, v123, v121, s57
  v_dot2_f32_bf16 v22, v117, v40, 0
  v_add_f32_dpp v21, v18, v18 row_ror:8 row_mask:0xf bank_mask:0xc
  v_add_f32_dpp v21, v20, v20 row_ror:8 row_mask:0xf bank_mask:0x3
  v_add_f32_dpp v20, v241, v241 row_half_mirror row_mask:0xf bank_mask:0x5
  v_dot2_f32_bf16 v23, v122, v41, 0
  v_add_f32_dpp v20, v21, v21 row_half_mirror row_mask:0xf bank_mask:0xa
  v_dot2_f32_bf16 v24, v120, v42, 0
  v_dot2_f32_bf16 v25, v123, v43, 0
  v_add_f32_dpp v20, v20, v20 quad_perm:[2,3,0,1] row_mask:0xf bank_mask:0xf
  v_cvt_f32_i32 v88, v88
  v_cvt_f32_i32_e64 v89, v89
  v_add_f32_dpp v20, v20, v20 quad_perm:[1,0,3,2] row_mask:0xf bank_mask:0xf
  v_cndmask_b32_e64 v238, v238, v20, s[48:49]
  v_cvt_f32_i32 v90, v90
  v_cvt_f32_i32 v91, v91
  v_pk_mul_f32 v[20:21], v[88:89], v[22:23]
  v_pk_add_f32 v[18:19], v[22:23], v[24:25]
  v_pk_fma_f32 v[20:21], v[90:91], v[24:25], v[20:21]
  v_add_f32 v18, v18, v19
  v_add_f32 v20, v20, v21
  s_add_u32 m0, s100, 7168
  v_lshrrev_b32 v10, 1, v215
  v_add_u32 v10, v10, v246
  v_mad_u64_u32 v[30:31], s[64:65], v10, 1, v[28:29]
  global_load_lds_dwordx4 v[30:31], off
  s_waitcnt vmcnt(7)
  buffer_load_dwordx4 v[76:79], v213, s[32:35], s80 offen nt
  v_perm_b32 v121, v126, v124, s56
  v_perm_b32 v126, v126, v124, s57
  v_perm_b32 v124, v127, v125, s56
  v_perm_b32 v127, v127, v125, s57
  v_dot2_f32_bf16 v22, v121, v44, 0
  v_add_f32_dpp v239, v18, v18 row_ror:8 row_mask:0xf bank_mask:0xc
  v_add_f32_dpp v239, v20, v20 row_ror:8 row_mask:0xf bank_mask:0x3
  v_dot2_f32_bf16 v23, v126, v45, 0
  v_dot2_f32_bf16 v24, v124, v46, 0
  v_dot2_f32_bf16 v25, v127, v47, 0
  v_cvt_f32_i32 v92, v92
  v_cvt_f32_i32 v93, v93
  v_cvt_f32_i32 v94, v94
  v_cvt_f32_i32_e64 v95, v95
  v_pk_mul_f32 v[20:21], v[92:93], v[22:23]
  v_pk_add_f32 v[18:19], v[22:23], v[24:25]
  v_pk_fma_f32 v[20:21], v[94:95], v[24:25], v[20:21]
  v_add_f32_e64 v18, v18, v19
  v_add_f32 v20, v20, v21
  s_waitcnt vmcnt(7)
  buffer_load_dwordx4 v[80:83], v212, s[32:35], s3 offen nt
  v_dot2_f32_bf16 v22, v117, v48, 0
  v_add_f32_dpp v21, v18, v18 row_ror:8 row_mask:0xf bank_mask:0xc
  v_add_f32_dpp v21, v20, v20 row_ror:8 row_mask:0xf bank_mask:0x3
  v_add_f32_dpp v20, v239, v239 row_half_mirror row_mask:0xf bank_mask:0x5
  v_dot2_f32_bf16 v23, v122, v49, 0
  v_add_f32_dpp v20, v21, v21 row_half_mirror row_mask:0xf bank_mask:0xa
  v_dot2_f32_bf16 v24, v120, v50, 0
  v_dot2_f32_bf16 v25, v123, v51, 0
  v_add_f32_dpp v20, v20, v20 quad_perm:[2,3,0,1] row_mask:0xf bank_mask:0xf
  v_cvt_f32_i32 v96, v96
  v_cvt_f32_i32 v97, v97
  v_add_f32_dpp v20, v20, v20 quad_perm:[1,0,3,2] row_mask:0xf bank_mask:0xf
  v_cndmask_b32_e64 v236, v236, v20, s[50:51]
  v_cvt_f32_i32 v98, v98
  v_cvt_f32_i32 v99, v99
  v_pk_mul_f32 v[20:21], v[96:97], v[22:23]
  v_pk_add_f32 v[18:19], v[22:23], v[24:25]
  v_pk_fma_f32 v[20:21], v[98:99], v[24:25], v[20:21]
  v_add_f32_e64 v18, v18, v19
  v_add_f32 v20, v20, v21
  s_waitcnt vmcnt(7)
  buffer_load_dwordx4 v[84:87], v213, s[32:35], s3 offen nt
L_it3:
  s_mov_b32 s47, 1
L_fc:
  s_waitcnt lgkmcnt(0)
  v_readfirstlane_b32 s46, v4
  s_cmp_ge_u32 s46, s47
  s_cbranch_scc1 L_fc_ok
  s_cmp_eq_u32 s94, 0
  s_cbranch_scc1 L_fc_ok
  s_sub_u32 s94, s94, 1
  ds_read_b32 v4, v14 offset:24
  s_branch L_fc
L_fc_ok:
  ds_read_b128 v[40:43], v252 offset:512
  ds_read_b128 v[44:47], v251 offset:512
  ds_read_b128 v[48:51], v252 offset:1536
  s_mov_b64 exec, 3
  s_add_u32 s44, s78, 0x03030303
  v_msad_u8 v9, s78, v36, 0
  v_msad_u8 v10, s44, v36, 0
  v_msad_u8 v9, s78, v37, v9
  v_msad_u8 v10, s44, v37, v10
  v_msad_u8 v9, s78, v38, v9
  v_msad_u8 v10, s44, v38, v10
  global_store_byte v7, v8, s[30:31]
  global_load_dwordx3 v[36:38], v235, s[30:31] sc1
  v_sub_u32 v9, v9, v10
  v_add_u32 v8, 1, v8
  v_readlane_b32 s66, v9, 0
  v_readlane_b32 s67, v9, 1
  s_add_u32 s78, s78, 0x01010101
  s_mov_b64 exec, -1
  s_lshl1_add_u32 s69, s91, s95
  s_add_u32 s95, s66, s67
  s_mov_b32 s69, 8
  v_dot2_f32_bf16 v22, v121, v52, 0
  v_add_f32_dpp v240, v18, v18 row_ror:8 row_mask:0xf bank_mask:0xc
  v_add_f32_dpp v240, v20, v20 row_ror:8 row_mask:0xf bank_mask:0x3
  v_dot2_f32_bf16 v23, v126, v53, 0
  v_dot2_f32_bf16 v24, v124, v54, 0
  v_dot2_f32_bf16 v25, v127, v55, 0
  v_cvt_f32_i32 v100, v100
  v_cvt_f32_i32 v101, v101
  v_cvt_f32_i32 v102, v102
  v_cvt_f32_i32 v103, v103
  v_pk_mul_f32 v[20:21], v[100:101], v[22:23]
  v_pk_add_f32 v[18:19], v[22:23], v[24:25]
  v_pk_fma_f32 v[20:21], v[102:103], v[24:25], v[20:21]
  v_add_f32 v18, v18, v19
  v_add_f32 v20, v20, v21
  s_add_u32 m0, s100, 8192
  v_lshrrev_b32 v10, 1, v216
  v_add_u32 v10, v10, v243
  v_mad_u64_u32 v[30:31], s[64:65], v10, 1, v[28:29]
  global_load_lds_dwordx4 v[30:31], off
  v_dot2_f32_bf16 v22, v117, v56, 0
  v_add_f32_dpp v21, v18, v18 row_ror:8 row_mask:0xf bank_mask:0xc
  v_add_f32_dpp v21, v20, v20 row_ror:8 row_mask:0xf bank_mask:0x3
  v_add_f32_dpp v20, v240, v240 row_half_mirror row_mask:0xf bank_mask:0x5
  v_dot2_f32_bf16 v23, v122, v57, 0
  v_add_f32_dpp v20, v21, v21 row_half_mirror row_mask:0xf bank_mask:0xa
  v_dot2_f32_bf16 v24, v120, v58, 0
  v_dot2_f32_bf16 v25, v123, v59, 0
  v_add_f32_dpp v20, v20, v20 quad_perm:[2,3,0,1] row_mask:0xf bank_mask:0xf
  v_cvt_f32_i32 v104, v104
  v_cvt_f32_i32 v105, v105
  v_add_f32_dpp v20, v20, v20 quad_perm:[1,0,3,2] row_mask:0xf bank_mask:0xf
  v_cndmask_b32_e64 v237, v237, v20, s[50:51]
  v_cvt_f32_i32 v106, v106
  v_cvt_f32_i32 v107, v107
  v_pk_mul_f32 v[20:21], v[104:105], v[22:23]
  v_pk_add_f32 v[18:19], v[22:23], v[24:25]
  v_pk_fma_f32 v[20:21], v[106:107], v[24:25], v[20:21]
  v_add_f32 v18, v18, v19
  v_add_f32 v20, v20, v21
  s_cmpk_gt_i32 s69, 0x13
  s_cbranch_scc1 L_p2_3
  s_cmp_gt_i32 s69, L_order_end-L_order-16421
  s_cbranch_scc1 L_p2_1
  s_waitcnt vmcnt(6)
L_p2_1:
  s_waitcnt vmcnt(8)
L_p2_3:
  s_waitcnt vmcnt(9)
  buffer_load_dwordx4 v[88:91], v214, s[32:35], 0 offen nt
  ds_read_b64 v[128:129], v12 offset:4096
  ds_read_b64 v[130:131], v12 offset:4224
  ds_read_b64 v[132:133], v12 offset:5120
  ds_read_b64 v[134:135], v12 offset:5248
  v_dot2_f32_bf16 v22, v121, v60, 0
  v_add_f32_dpp v241, v18, v18 row_ror:8 row_mask:0xf bank_mask:0xc
  v_add_f32_dpp v241, v20, v20 row_ror:8 row_mask:0xf bank_mask:0x3
  v_dot2_f32_bf16 v23, v126, v61, 0
  v_dot2_f32_bf16 v24, v124, v62, 0
  v_dot2_f32_bf16 v25, v127, v63, 0
  v_cvt_f32_i32 v108, v108
  v_cvt_f32_i32 v109, v109
  v_cvt_f32_i32 v110, v110
  v_cvt_f32_i32 v111, v111
  v_pk_mul_f32 v[20:21], v[108:109], v[22:23]
  v_pk_add_f32 v[18:19], v[22:23], v[24:25]
  v_pk_fma_f32 v[20:21], v[110:111], v[24:25], v[20:21]
  v_add_f32 v18, v18, v19
  v_add_f32 v20, v20, v21
  s_cmpk_gt_i32 s69, 0x13
  s_cbranch_scc1 L_p3_3
  s_cmp_gt_i32 s69, L_order_end-L_order-16391
  s_cbranch_scc1 L_p3_2
  s_waitcnt vmcnt(7)
L_p3_2:
  s_waitcnt vmcnt(9)
L_p3_3:
  s_waitcnt vmcnt(10)
  buffer_load_dwordx4 v[92:95], v215, s[32:35], 0 offen nt
  s_cmpk_gt_i32 s69, 0x13
  s_cbranch_scc1 L_p4_3
  s_cmp_gt_i32 s69, L_order_end-L_order-16445
  s_cbranch_scc1 L_p4_0
  s_waitcnt vmcnt(7)
L_p4_0:
  s_waitcnt vmcnt(8)
L_p4_3:
  s_waitcnt vmcnt(10)
  buffer_load_dwordx4 v[96:99], v214, s[32:35], s80 offen nt
L_it4:
  s_waitcnt lgkmcnt(0)
  ds_read_b128 v[52:55], v251 offset:1536
  ds_read_b128 v[56:59], v252 offset:2560
  ds_read_b128 v[60:63], v251 offset:2560
  s_mov_b64 exec, 3
  s_add_u32 s44, s78, 0x03030303
  v_msad_u8 v9, s78, v32, 0
  v_msad_u8 v10, s44, v32, 0
  v_msad_u8 v9, s78, v33, v9
  v_msad_u8 v10, s44, v33, v10
  v_msad_u8 v9, s78, v34, v9
  v_msad_u8 v10, s44, v34, v10
  global_store_byte v7, v8, s[30:31]
  global_load_dwordx3 v[32:34], v232, s[30:31] sc1
  v_sub_u32 v9, v9, v10
  v_add_u32 v8, 1, v8
  v_readlane_b32 s66, v9, 0
  v_readlane_b32 s67, v9, 1
  s_add_u32 s78, s78, 0x01010101
  s_mov_b64 exec, -1
  s_lshl1_add_u32 s69, s91, s95
  s_add_u32 s95, s66, s67
  s_mov_b32 s69, 8
  v_perm_b32 v125, v130, v128, s56
  v_perm_b32 v130, v130, v128, s57
  v_perm_b32 v128, v131, v129, s56
  v_perm_b32 v131, v131, v129, s57
  v_dot2_f32_bf16 v22, v125, v40, 0
  v_add_f32_dpp v21, v18, v18 row_ror:8 row_mask:0xf bank_mask:0xc
  v_add_f32_dpp v21, v20, v20 row_ror:8 row_mask:0xf bank_mask:0x3
  v_add_f32_dpp v20, v241, v241 row_half_mirror row_mask:0xf bank_mask:0x5
  v_dot2_f32_bf16 v23, v130, v41, 0
  v_add_f32_dpp v20, v21, v21 row_half_mirror row_mask:0xf bank_mask:0xa
  v_dot2_f32_bf16 v24, v128, v42, 0
  v_dot2_f32_bf16 v25, v131, v43, 0
  v_add_f32_dpp v20, v20, v20 quad_perm:[2,3,0,1] row_mask:0xf bank_mask:0xf
  v_cvt_f32_i32 v64, v64
  v_cvt_f32_i32 v65, v65
  v_add_f32_dpp v20, v20, v20 quad_perm:[1,0,3,2] row_mask:0xf bank_mask:0xf
  v_cndmask_b32_e64 v238, v238, v20, s[50:51]
  v_cvt_f32_i32 v66, v66
  v_cvt_f32_i32 v67, v67
  v_pk_mul_f32 v[20:21], v[64:65], v[22:23]
  v_pk_add_f32 v[18:19], v[22:23], v[24:25]
  v_pk_fma_f32 v[20:21], v[66:67], v[24:25], v[20:21]
  v_add_f32 v18, v18, v19
  v_add_f32 v20, v20, v21
  s_add_u32 m0, s100, 9216
  v_lshrrev_b32 v10, 1, v217
  v_add_u32 v10, v10, v242
  v_mad_u64_u32 v[30:31], s[64:65], v10, 1, v[28:29]
  global_load_lds_dwordx4 v[30:31], off
  v_perm_b32 v129, v134, v132, s56
  v_perm_b32 v134, v134, v132, s57
  v_perm_b32 v132, v135, v133, s56
  v_perm_b32 v135, v135, v133, s57
  s_waitcnt vmcnt(12)
  v_dot2_f32_bf16 v22, v129, v44, 0
  v_add_f32_dpp v239, v18, v18 row_ror:8 row_mask:0xf bank_mask:0xc
  v_add_f32_dpp v239, v20, v20 row_ror:8 row_mask:0xf bank_mask:0x3
  v_dot2_f32_bf16 v23, v134, v45, 0
  v_dot2_f32_bf16 v24, v132, v46, 0
  v_dot2_f32_bf16 v25, v135, v47, 0
  v_cvt_f32_i32 v68, v68
  v_cvt_f32_i32 v69, v69
  v_cvt_f32_i32 v70, v70
  v_cvt_f32_i32_e64 v71, v71
  v_pk_mul_f32 v[20:21], v[68:69], v[22:23]
  v_pk_add_f32 v[18:19], v[22:23], v[24:25]
  v_pk_fma_f32 v[20:21], v[70:71], v[24:25], v[20:21]
  v_add_f32 v18, v18, v19
  v_add_f32 v20, v20, v21
  s_cmpk_gt_i32 s69, 0x13
  s_cbranch_scc1 L_p5_3
  s_cmp_gt_i32 s69, L_order_end-L_order-16421
  s_cbranch_scc1 L_p5_1
  s_waitcnt vmcnt(6)
L_p5_1:
  s_waitcnt vmcnt(10)
L_p5_3:
  s_waitcnt vmcnt(11)
  buffer_load_dwordx4 v[100:103], v215, s[32:35], s80 offen nt
  v_dot2_f32_bf16 v22, v125, v48, 0
  v_add_f32_dpp v21, v18, v18 row_ror:8 row_mask:0xf bank_mask:0xc
  v_add_f32_dpp v21, v20, v20 row_ror:8 row_mask:0xf bank_mask:0x3
  v_add_f32_dpp v20, v239, v239 row_half_mirror row_mask:0xf bank_mask:0x5
  v_dot2_f32_bf16 v23, v130, v49, 0
  v_add_f32_dpp v20, v21, v21 row_half_mirror row_mask:0xf bank_mask:0xa
  v_dot2_f32_bf16 v24, v128, v50, 0
  v_dot2_f32_bf16 v25, v131, v51, 0
  v_add_f32_dpp v20, v20, v20 quad_perm:[2,3,0,1] row_mask:0xf bank_mask:0xf
  v_cvt_f32_i32 v72, v72
  v_cvt_f32_i32 v73, v73
  v_add_f32_dpp v20, v20, v20 quad_perm:[1,0,3,2] row_mask:0xf bank_mask:0xf
  v_cndmask_b32_e64 v236, v236, v20, s[52:53]
  v_cvt_f32_i32 v74, v74
  v_cvt_f32_i32 v75, v75
  v_pk_mul_f32 v[20:21], v[72:73], v[22:23]
  v_pk_add_f32 v[18:19], v[22:23], v[24:25]
  v_pk_fma_f32 v[20:21], v[74:75], v[24:25], v[20:21]
  v_add_f32 v18, v18, v19
  v_add_f32 v20, v20, v21
  s_cmpk_gt_i32 s69, 0x13
  s_cbranch_scc1 L_p6_3
  s_cmp_gt_i32 s69, L_order_end-L_order-16391
  s_cbranch_scc1 L_p6_2
  s_waitcnt vmcnt(7)
L_p6_2:
  s_waitcnt vmcnt(11)
L_p6_3:
  s_waitcnt vmcnt(12)
  buffer_load_dwordx4 v[104:107], v214, s[32:35], s3 offen nt
  s_cmpk_gt_i32 s69, 0x13
  s_cbranch_scc1 L_p7_3
  s_cmp_gt_i32 s69, L_order_end-L_order-16445
  s_cbranch_scc1 L_p7_0
  s_waitcnt vmcnt(7)
L_p7_0:
  s_waitcnt vmcnt(8)
L_p7_3:
  s_waitcnt vmcnt(12)
  buffer_load_dwordx4 v[108:111], v215, s[32:35], s3 offen nt
L_it5:
  s_waitcnt lgkmcnt(0)
  ds_read_b128 v[40:43], v253 offset:512
  ds_read_b128 v[44:47], v252 offset:512
  ds_read_b128 v[48:51], v253 offset:1536
  s_waitcnt vmcnt(9)
  s_mov_b64 exec, 3
  s_add_u32 s44, s78, 0x03030303
  v_msad_u8 v9, s78, v36, 0
  v_msad_u8 v10, s44, v36, 0
  v_msad_u8 v9, s78, v37, v9
  v_msad_u8 v10, s44, v37, v10
  v_msad_u8 v9, s78, v38, v9
  v_msad_u8 v10, s44, v38, v10
  global_load_dwordx2 v[26:27], v11, s[30:31] sc1
  global_store_byte v7, v8, s[30:31]
  global_load_dwordx3 v[36:38], v233, s[30:31] sc1
  v_sub_u32 v9, v9, v10
  v_add_u32_e64 v8, 1, v8
  v_readlane_b32 s66, v9, 0
  v_readlane_b32 s67, v9, 1
  s_add_u32 s78, s78, 0x01010101
  s_mov_b64 exec, -1
  s_lshl1_add_u32 s69, s91, s95
  s_add_u32 s95, s66, s67
  s_add_u32 s69, s69, s95
  v_dot2_f32_bf16 v22, v129, v52, 0
  v_add_f32_dpp v240, v18, v18 row_ror:8 row_mask:0xf bank_mask:0xc
  v_add_f32_dpp v240, v20, v20 row_ror:8 row_mask:0xf bank_mask:0x3
  v_dot2_f32_bf16 v23, v134, v53, 0
  v_dot2_f32_bf16 v24, v132, v54, 0
  v_dot2_f32_bf16 v25, v135, v55, 0
  v_cvt_f32_i32 v76, v76
  v_cvt_f32_i32 v77, v77
  v_cvt_f32_i32 v78, v78
  v_cvt_f32_i32 v79, v79
  v_pk_mul_f32 v[20:21], v[76:77], v[22:23]
  v_pk_add_f32 v[18:19], v[22:23], v[24:25]
  v_pk_fma_f32 v[20:21], v[78:79], v[24:25], v[20:21]
  v_add_f32 v18, v18, v19
  v_add_f32 v20, v20, v21
  s_add_u32 m0, s100, 10240
  v_lshrrev_b32 v10, 1, v218
  v_add_u32 v10, v10, v244
  v_mad_u64_u32 v[30:31], s[64:65], v10, 1, v[28:29]
  global_load_lds_dwordx4 v[30:31], off
  v_dot2_f32_bf16 v22, v125, v56, 0
  v_add_f32_dpp v21, v18, v18 row_ror:8 row_mask:0xf bank_mask:0xc
  v_add_f32_dpp v21, v20, v20 row_ror:8 row_mask:0xf bank_mask:0x3
  v_add_f32_dpp v20, v240, v240 row_half_mirror row_mask:0xf bank_mask:0x5
  v_dot2_f32_bf16 v23, v130, v57, 0
  v_add_f32_dpp v20, v21, v21 row_half_mirror row_mask:0xf bank_mask:0xa
  v_dot2_f32_bf16 v24, v128, v58, 0
  v_dot2_f32_bf16 v25, v131, v59, 0
  v_add_f32_dpp v20, v20, v20 quad_perm:[2,3,0,1] row_mask:0xf bank_mask:0xf
  v_cvt_f32_i32 v80, v80
  v_cvt_f32_i32 v81, v81
  v_add_f32_dpp v20, v20, v20 quad_perm:[1,0,3,2] row_mask:0xf bank_mask:0xf
  v_cndmask_b32_e64 v237, v237, v20, s[52:53]
  v_cvt_f32_i32 v82, v82
  v_cvt_f32_i32 v83, v83
  v_pk_mul_f32 v[20:21], v[80:81], v[22:23]
  v_pk_add_f32 v[18:19], v[22:23], v[24:25]
  v_pk_fma_f32 v[20:21], v[82:83], v[24:25], v[20:21]
  v_add_f32 v18, v18, v19
  v_add_f32 v20, v20, v21
  s_cmpk_gt_i32 s69, 0x13
  s_cbranch_scc1 L_p8_3
  s_cmp_gt_i32 s69, L_order_end-L_order-16421
  s_cbranch_scc1 L_p8_1
  s_waitcnt vmcnt(7)
L_p8_1:
  s_waitcnt vmcnt(11)
L_p8_3:
  s_waitcnt vmcnt(12)
  buffer_load_dwordx4 v[64:67], v216, s[32:35], 0 offen nt
  ds_read_b64 v[136:137], v12 offset:6144
  ds_read_b64 v[138:139], v12 offset:6272
  ds_read_b64 v[140:141], v12 offset:7168
  ds_read_b64 v[142:143], v12 offset:7296
  v_dot2_f32_bf16 v22, v129, v60, 0
  v_add_f32_dpp v241, v18, v18 row_ror:8 row_mask:0xf bank_mask:0xc
  v_add_f32_dpp v241, v20, v20 row_ror:8 row_mask:0xf bank_mask:0x3
  v_dot2_f32_bf16 v23, v134, v61, 0
  v_dot2_f32_bf16 v24, v132, v62, 0
  v_dot2_f32_bf16 v25, v135, v63, 0
  v_cvt_f32_i32 v84, v84
  v_cvt_f32_i32 v85, v85
  v_cvt_f32_i32 v86, v86
  v_cvt_f32_i32 v87, v87
  v_pk_mul_f32 v[20:21], v[84:85], v[22:23]
  v_pk_add_f32 v[18:19], v[22:23], v[24:25]
  v_pk_fma_f32 v[20:21], v[86:87], v[24:25], v[20:21]
  v_add_f32 v18, v18, v19
  v_add_f32 v20, v20, v21
  s_cmpk_gt_i32 s69, 0x13
  s_cbranch_scc1 L_p9_3
  s_cmp_gt_i32 s69, L_order_end-L_order-16391
  s_cbranch_scc1 L_p9_2
  s_waitcnt vmcnt(8)
L_p9_2:
  s_waitcnt vmcnt(12)
L_p9_3:
  s_waitcnt vmcnt(13)
  buffer_load_dwordx4 v[68:71], v217, s[32:35], 0 offen nt
  s_cmpk_gt_i32 s69, 0x13
  s_cbranch_scc1 L_p10_3
  s_cmp_gt_i32 s69, L_order_end-L_order-16445
  s_cbranch_scc1 L_p10_0
  s_waitcnt vmcnt(8)
L_p10_0:
  s_waitcnt vmcnt(9)
L_p10_3:
  s_waitcnt vmcnt(13)
  buffer_load_dwordx4 v[72:75], v216, s[32:35], s80 offen nt
L_it6:
  s_waitcnt lgkmcnt(0)
  ds_read_b128 v[52:55], v252 offset:1536
  ds_read_b128 v[56:59], v253 offset:2560
  ds_read_b128 v[60:63], v252 offset:2560
  s_waitcnt vmcnt(10)
  s_mov_b64 exec, 3
  s_add_u32 s44, s78, 0x03030303
  v_msad_u8 v9, s78, v32, 0
  v_msad_u8 v10, s44, v32, 0
  v_msad_u8 v9, s78, v33, v9
  v_msad_u8 v10, s44, v33, v10
  v_msad_u8 v9, s78, v34, v9
  v_msad_u8 v10, s44, v34, v10
  global_store_byte v7, v8, s[30:31]
  global_load_dwordx3 v[32:34], v234, s[30:31] sc1
  v_sub_u32 v9, v9, v10
  v_add_u32_e64 v8, 1, v8
  v_readlane_b32 s66, v9, 0
  v_readlane_b32 s67, v9, 1
  s_add_u32 s78, s78, 0x01010101
  s_mov_b64 exec, -1
  s_lshl1_add_u32 s69, s91, s95
  s_add_u32 s95, s66, s67
  s_add_u32 s69, s69, s95
  v_perm_b32 v133, v138, v136, s56
  v_perm_b32 v138, v138, v136, s57
  v_perm_b32 v136, v139, v137, s56
  v_perm_b32 v139, v139, v137, s57
  v_dot2_f32_bf16 v22, v133, v40, 0
  v_add_f32_dpp v21, v18, v18 row_ror:8 row_mask:0xf bank_mask:0xc
  v_add_f32_dpp v21, v20, v20 row_ror:8 row_mask:0xf bank_mask:0x3
  v_add_f32_dpp v20, v241, v241 row_half_mirror row_mask:0xf bank_mask:0x5
  v_dot2_f32_bf16 v23, v138, v41, 0
  v_add_f32_dpp v20, v21, v21 row_half_mirror row_mask:0xf bank_mask:0xa
  v_dot2_f32_bf16 v24, v136, v42, 0
  v_dot2_f32_bf16 v25, v139, v43, 0
  v_add_f32_dpp v20, v20, v20 quad_perm:[2,3,0,1] row_mask:0xf bank_mask:0xf
  v_cvt_f32_i32 v88, v88
  v_cvt_f32_i32 v89, v89
  v_add_f32_dpp v20, v20, v20 quad_perm:[1,0,3,2] row_mask:0xf bank_mask:0xf
  v_cndmask_b32_e64 v238, v238, v20, s[52:53]
  v_cvt_f32_i32 v90, v90
  v_cvt_f32_i32 v91, v91
  v_pk_mul_f32 v[20:21], v[88:89], v[22:23]
  v_pk_add_f32 v[18:19], v[22:23], v[24:25]
  v_pk_fma_f32 v[20:21], v[90:91], v[24:25], v[20:21]
  v_add_f32 v18, v18, v19
  v_add_f32 v20, v20, v21
  s_add_u32 m0, s100, 11264
  v_lshrrev_b32 v10, 1, v219
  v_add_u32 v10, v10, v243
  v_mad_u64_u32 v[30:31], s[64:65], v10, 1, v[28:29]
  global_load_lds_dwordx4 v[30:31], off
  v_perm_b32 v137, v142, v140, s56
  v_perm_b32 v142, v142, v140, s57
  v_perm_b32 v140, v143, v141, s56
  v_perm_b32 v143, v143, v141, s57
  v_dot2_f32_bf16 v22, v137, v44, 0
  v_add_f32_dpp v239, v18, v18 row_ror:8 row_mask:0xf bank_mask:0xc
  v_add_f32_dpp v239, v20, v20 row_ror:8 row_mask:0xf bank_mask:0x3
  v_dot2_f32_bf16 v23, v142, v45, 0
  v_dot2_f32_bf16 v24, v140, v46, 0
  v_dot2_f32_bf16 v25, v143, v47, 0
  v_cvt_f32_i32 v92, v92
  v_cvt_f32_i32 v93, v93
  v_cvt_f32_i32 v94, v94
  v_cvt_f32_i32 v95, v95
  v_pk_mul_f32 v[20:21], v[92:93], v[22:23]
  v_pk_add_f32 v[18:19], v[22:23], v[24:25]
  v_pk_fma_f32 v[20:21], v[94:95], v[24:25], v[20:21]
  v_add_f32 v18, v18, v19
  v_add_f32 v20, v20, v21
  s_cmpk_gt_i32 s69, 0x13
  s_cbranch_scc1 L_p11_3
  s_cmp_gt_i32 s69, L_order_end-L_order-16421
  s_cbranch_scc1 L_p11_1
  s_waitcnt vmcnt(6)
L_p11_1:
  s_waitcnt vmcnt(11)
L_p11_3:
  s_waitcnt vmcnt(12)
  buffer_load_dwordx4 v[76:79], v217, s[32:35], s80 offen nt
  v_dot2_f32_bf16 v22, v133, v48, 0
  v_add_f32_dpp v21, v18, v18 row_ror:8 row_mask:0xf bank_mask:0xc
  v_add_f32_dpp v21, v20, v20 row_ror:8 row_mask:0xf bank_mask:0x3
  v_add_f32_dpp v20, v239, v239 row_half_mirror row_mask:0xf bank_mask:0x5
  v_dot2_f32_bf16 v23, v138, v49, 0
  v_add_f32_dpp v20, v21, v21 row_half_mirror row_mask:0xf bank_mask:0xa
  v_dot2_f32_bf16 v24, v136, v50, 0
  v_dot2_f32_bf16 v25, v139, v51, 0
  v_add_f32_dpp v20, v20, v20 quad_perm:[2,3,0,1] row_mask:0xf bank_mask:0xf
  v_cvt_f32_i32 v96, v96
  v_cvt_f32_i32 v97, v97
  v_add_f32_dpp v20, v20, v20 quad_perm:[1,0,3,2] row_mask:0xf bank_mask:0xf
  v_cndmask_b32_e64 v236, v236, v20, s[54:55]
  ds_write_b32 v15, v236 offset:0
  v_cvt_f32_i32 v98, v98
  v_cvt_f32_i32 v99, v99
  v_pk_mul_f32 v[20:21], v[96:97], v[22:23]
  v_pk_add_f32 v[18:19], v[22:23], v[24:25]
  v_pk_fma_f32 v[20:21], v[98:99], v[24:25], v[20:21]
  v_add_f32 v18, v18, v19
  v_add_f32 v20, v20, v21
  s_cmpk_gt_i32 s69, 0x13
  s_cbranch_scc1 L_p12_3
  s_cmp_gt_i32 s69, L_order_end-L_order-16391
  s_cbranch_scc1 L_p12_2
  s_waitcnt vmcnt(7)
L_p12_2:
  s_waitcnt vmcnt(12)
L_p12_3:
  s_waitcnt vmcnt(13)
  buffer_load_dwordx4 v[80:83], v216, s[32:35], s3 offen nt
  s_cmpk_gt_i32 s69, 0x13
  s_cbranch_scc1 L_p13_3
  s_cmp_gt_i32 s69, L_order_end-L_order-16445
  s_cbranch_scc1 L_p13_0
  s_waitcnt vmcnt(7)
L_p13_0:
  s_waitcnt vmcnt(8)
L_p13_3:
  s_waitcnt vmcnt(13)
  buffer_load_dwordx4 v[84:87], v217, s[32:35], s3 offen nt
L_it7:
  s_waitcnt lgkmcnt(0)
  ds_read_b128 v[40:43], v249 offset:512
  ds_read_b128 v[44:47], v248 offset:512
  ds_read_b128 v[48:51], v249 offset:1536
  s_waitcnt vmcnt(9)
  s_mov_b64 exec, 3
  s_add_u32 s44, s78, 0x03030303
  v_msad_u8 v9, s78, v36, 0
  v_msad_u8 v10, s44, v36, 0
  v_msad_u8 v9, s78, v37, v9
  v_msad_u8 v10, s44, v37, v10
  v_msad_u8 v9, s78, v38, v9
  v_msad_u8 v10, s44, v38, v10
  global_store_byte v7, v8, s[30:31]
  global_load_dwordx3 v[36:38], v235, s[30:31] sc1
  v_sub_u32 v9, v9, v10
  v_add_u32_e64 v8, 1, v8
  v_add3_u32 v10, v26, v27, s58
  v_readlane_b32 s66, v9, 0
  v_readlane_b32 s67, v9, 1
  v_readlane_b32 s91, v10, 0
  s_add_u32 s78, s78, 0x01010101
  s_mov_b64 exec, -1
  s_lshl1_add_u32 s69, s91, s95
  s_add_u32 s95, s66, s67
  s_add_u32 s69, s69, s95
  v_dot2_f32_bf16 v22, v137, v52, 0
  v_add_f32_dpp v240, v18, v18 row_ror:8 row_mask:0xf bank_mask:0xc
  v_add_f32_dpp v240, v20, v20 row_ror:8 row_mask:0xf bank_mask:0x3
  v_dot2_f32_bf16 v23, v142, v53, 0
  v_dot2_f32_bf16 v24, v140, v54, 0
  v_dot2_f32_bf16 v25, v143, v55, 0
  v_cvt_f32_i32 v100, v100
  v_cvt_f32_i32 v101, v101
  v_cvt_f32_i32 v102, v102
  v_cvt_f32_i32 v103, v103
  v_pk_mul_f32 v[20:21], v[100:101], v[22:23]
  v_pk_add_f32 v[18:19], v[22:23], v[24:25]
  v_pk_fma_f32 v[20:21], v[102:103], v[24:25], v[20:21]
  v_add_f32 v18, v18, v19
  v_add_f32 v20, v20, v21
  s_add_u32 m0, s100, 12288
  v_lshrrev_b32 v10, 1, v220
  v_add_u32 v10, v10, v247
  v_mad_u64_u32 v[30:31], s[64:65], v10, 1, v[28:29]
  global_load_lds_dwordx4 v[30:31], off
  v_dot2_f32_bf16 v22, v133, v56, 0
  v_add_f32_dpp v21, v18, v18 row_ror:8 row_mask:0xf bank_mask:0xc
  v_add_f32_dpp v21, v20, v20 row_ror:8 row_mask:0xf bank_mask:0x3
  v_add_f32_dpp v20, v240, v240 row_half_mirror row_mask:0xf bank_mask:0x5
  v_dot2_f32_bf16 v23, v138, v57, 0
  v_add_f32_dpp v20, v21, v21 row_half_mirror row_mask:0xf bank_mask:0xa
  v_dot2_f32_bf16 v24, v136, v58, 0
  v_dot2_f32_bf16 v25, v139, v59, 0
  v_add_f32_dpp v20, v20, v20 quad_perm:[2,3,0,1] row_mask:0xf bank_mask:0xf
  v_cvt_f32_i32 v104, v104
  v_cvt_f32_i32 v105, v105
  v_add_f32_dpp v20, v20, v20 quad_perm:[1,0,3,2] row_mask:0xf bank_mask:0xf
  v_cndmask_b32_e64 v237, v237, v20, s[54:55]
  ds_write_b32 v15, v237 offset:3072
  v_cvt_f32_i32 v106, v106
  v_cvt_f32_i32 v107, v107
  v_pk_mul_f32 v[20:21], v[104:105], v[22:23]
  v_pk_add_f32 v[18:19], v[22:23], v[24:25]
  v_pk_fma_f32 v[20:21], v[106:107], v[24:25], v[20:21]
  v_add_f32 v18, v18, v19
  v_add_f32 v20, v20, v21
  s_cmpk_gt_i32 s69, 0x13
  s_cbranch_scc1 L_p14_3
  s_cmp_gt_i32 s69, L_order_end-L_order-16421
  s_cbranch_scc1 L_p14_1
  s_waitcnt vmcnt(6)
L_p14_1:
  s_waitcnt vmcnt(10)
L_p14_3:
  s_waitcnt vmcnt(11)
  buffer_load_dwordx4 v[88:91], v218, s[32:35], 0 offen nt
  ds_read_b64 v[144:145], v12 offset:8192
  ds_read_b64 v[146:147], v12 offset:8320
  ds_read_b64 v[148:149], v12 offset:9216
  ds_read_b64 v[150:151], v12 offset:9344
  v_dot2_f32_bf16 v22, v137, v60, 0
  v_add_f32_dpp v241, v18, v18 row_ror:8 row_mask:0xf bank_mask:0xc
  v_add_f32_dpp v241, v20, v20 row_ror:8 row_mask:0xf bank_mask:0x3
  v_dot2_f32_bf16 v23, v142, v61, 0
  v_dot2_f32_bf16 v24, v140, v62, 0
  v_dot2_f32_bf16 v25, v143, v63, 0
  v_cvt_f32_i32 v108, v108
  v_cvt_f32_i32 v109, v109
  v_cvt_f32_i32 v110, v110
  v_cvt_f32_i32 v111, v111
  v_pk_mul_f32 v[20:21], v[108:109], v[22:23]
  v_pk_add_f32 v[18:19], v[22:23], v[24:25]
  v_pk_fma_f32 v[20:21], v[110:111], v[24:25], v[20:21]
  v_add_f32 v18, v18, v19
  v_add_f32 v20, v20, v21
  s_cmpk_gt_i32 s69, 0x13
  s_cbranch_scc1 L_p15_3
  s_cmp_gt_i32 s69, L_order_end-L_order-16391
  s_cbranch_scc1 L_p15_2
  s_waitcnt vmcnt(7)
L_p15_2:
  s_waitcnt vmcnt(11)
L_p15_3:
  s_waitcnt vmcnt(12)
  buffer_load_dwordx4 v[92:95], v219, s[32:35], 0 offen nt
  s_cmpk_gt_i32 s69, 0x13
  s_cbranch_scc1 L_p16_3
  s_cmp_gt_i32 s69, L_order_end-L_order-16445
  s_cbranch_scc1 L_p16_0
  s_waitcnt vmcnt(7)
L_p16_0:
  s_waitcnt vmcnt(8)
L_p16_3:
  s_waitcnt vmcnt(12)
  buffer_load_dwordx4 v[96:99], v218, s[32:35], s80 offen nt
  v_mov_b32_e64 v9, 1
  ds_write_b32 v6, v9 offset:0
L_it8:
  s_waitcnt lgkmcnt(0)
  ds_read_b128 v[52:55], v248 offset:1536
  ds_read_b128 v[56:59], v249 offset:2560
  ds_read_b128 v[60:63], v248 offset:2560
  s_waitcnt vmcnt(9)
  s_mov_b64 exec, 3
  s_add_u32 s44, s78, 0x03030303
  v_msad_u8 v9, s78, v32, 0
  v_msad_u8 v10, s44, v32, 0
  v_msad_u8 v9, s78, v33, v9
  v_msad_u8 v10, s44, v33, v10
  v_msad_u8 v9, s78, v34, v9
  v_msad_u8 v10, s44, v34, v10
  global_store_byte v7, v8, s[30:31]
  global_load_dwordx3 v[32:34], v232, s[30:31] sc1
  v_sub_u32 v9, v9, v10
  v_add_u32_e64 v8, 1, v8
  v_readlane_b32 s66, v9, 0
  v_readlane_b32 s67, v9, 1
  s_add_u32 s78, s78, 0x01010101
  s_mov_b64 exec, -1
  s_lshl1_add_u32 s69, s91, s95
  s_add_u32 s95, s66, s67
  s_add_u32 s69, s69, s95
  v_perm_b32 v141, v146, v144, s56
  v_perm_b32 v146, v146, v144, s57
  v_perm_b32 v144, v147, v145, s56
  v_perm_b32 v147, v147, v145, s57
  v_dot2_f32_bf16 v22, v141, v40, 0
  v_add_f32_dpp v21, v18, v18 row_ror:8 row_mask:0xf bank_mask:0xc
  v_add_f32_dpp v21, v20, v20 row_ror:8 row_mask:0xf bank_mask:0x3
  v_add_f32_dpp v20, v241, v241 row_half_mirror row_mask:0xf bank_mask:0x5
  v_dot2_f32_bf16 v23, v146, v41, 0
  v_add_f32_dpp v20, v21, v21 row_half_mirror row_mask:0xf bank_mask:0xa
  v_dot2_f32_bf16 v24, v144, v42, 0
  v_dot2_f32_bf16 v25, v147, v43, 0
  v_add_f32_dpp v20, v20, v20 quad_perm:[2,3,0,1] row_mask:0xf bank_mask:0xf
  v_cvt_f32_i32 v64, v64
  v_cvt_f32_i32 v65, v65
  v_add_f32_dpp v20, v20, v20 quad_perm:[1,0,3,2] row_mask:0xf bank_mask:0xf
  v_cndmask_b32_e64 v238, v238, v20, s[54:55]
  ds_write_b32 v15, v238 offset:6144
  v_cvt_f32_i32 v66, v66
  v_cvt_f32_i32 v67, v67
  v_pk_mul_f32 v[20:21], v[64:65], v[22:23]
  v_pk_add_f32 v[18:19], v[22:23], v[24:25]
  v_pk_fma_f32 v[20:21], v[66:67], v[24:25], v[20:21]
  v_add_f32 v18, v18, v19
  v_add_f32 v20, v20, v21
  s_add_u32 m0, s100, 13312
  v_lshrrev_b32 v10, 1, v221
  v_add_u32 v10, v10, v246
  v_mad_u64_u32 v[30:31], s[64:65], v10, 1, v[28:29]
  global_load_lds_dwordx4 v[30:31], off
  v_perm_b32 v145, v150, v148, s56
  v_perm_b32 v150, v150, v148, s57
  v_perm_b32 v148, v151, v149, s56
  v_perm_b32 v151, v151, v149, s57
  v_dot2_f32_bf16 v22, v145, v44, 0
  v_add_f32_dpp v239, v18, v18 row_ror:8 row_mask:0xf bank_mask:0xc
  v_add_f32_dpp v239, v20, v20 row_ror:8 row_mask:0xf bank_mask:0x3
  v_dot2_f32_bf16 v23, v150, v45, 0
  v_dot2_f32_bf16 v24, v148, v46, 0
  v_dot2_f32_bf16 v25, v151, v47, 0
  v_cvt_f32_i32 v68, v68
  v_cvt_f32_i32 v69, v69
  v_cvt_f32_i32 v70, v70
  v_cvt_f32_i32 v71, v71
  v_pk_mul_f32 v[20:21], v[68:69], v[22:23]
  v_pk_add_f32 v[18:19], v[22:23], v[24:25]
  v_pk_fma_f32 v[20:21], v[70:71], v[24:25], v[20:21]
  v_add_f32 v18, v18, v19
  v_add_f32 v20, v20, v21
  s_cmpk_gt_i32 s69, 0x13
  s_cbranch_scc1 L_p17_3
  s_cmp_gt_i32 s69, L_order_end-L_order-16421
  s_cbranch_scc1 L_p17_1
  s_waitcnt vmcnt(6)
L_p17_1:
  s_waitcnt vmcnt(10)
L_p17_3:
  s_waitcnt vmcnt(11)
  buffer_load_dwordx4 v[100:103], v219, s[32:35], s80 offen nt
  v_dot2_f32_bf16 v22, v141, v48, 0
  v_add_f32_dpp v21, v18, v18 row_ror:8 row_mask:0xf bank_mask:0xc
  v_add_f32_dpp v21, v20, v20 row_ror:8 row_mask:0xf bank_mask:0x3
  v_add_f32_dpp v20, v239, v239 row_half_mirror row_mask:0xf bank_mask:0x5
  v_dot2_f32_bf16 v23, v146, v49, 0
  v_add_f32_dpp v20, v21, v21 row_half_mirror row_mask:0xf bank_mask:0xa
  v_dot2_f32_bf16 v24, v144, v50, 0
  v_dot2_f32_bf16 v25, v147, v51, 0
  v_add_f32_dpp v20, v20, v20 quad_perm:[2,3,0,1] row_mask:0xf bank_mask:0xf
  v_cvt_f32_i32 v72, v72
  v_cvt_f32_i32 v73, v73
  v_add_f32_dpp v20, v20, v20 quad_perm:[1,0,3,2] row_mask:0xf bank_mask:0xf
  v_cndmask_b32_e64 v236, v236, v20, s[48:49]
  v_cvt_f32_i32 v74, v74
  v_cvt_f32_i32 v75, v75
  v_pk_mul_f32 v[20:21], v[72:73], v[22:23]
  v_pk_add_f32 v[18:19], v[22:23], v[24:25]
  v_pk_fma_f32 v[20:21], v[74:75], v[24:25], v[20:21]
  v_add_f32 v18, v18, v19
  v_add_f32 v20, v20, v21
  s_cmpk_gt_i32 s69, 0x13
  s_cbranch_scc1 L_p18_3
  s_cmp_gt_i32 s69, L_order_end-L_order-16391
  s_cbranch_scc1 L_p18_2
  s_waitcnt vmcnt(7)
L_p18_2:
  s_waitcnt vmcnt(11)
L_p18_3:
  s_waitcnt vmcnt(12)
  buffer_load_dwordx4 v[104:107], v218, s[32:35], s3 offen nt
  s_cmpk_gt_i32 s69, 0x13
  s_cbranch_scc1 L_p19_3
  s_cmp_gt_i32 s69, L_order_end-L_order-16445
  s_cbranch_scc1 L_p19_0
  s_waitcnt vmcnt(7)
L_p19_0:
  s_waitcnt vmcnt(8)
L_p19_3:
  s_waitcnt vmcnt(12)
  buffer_load_dwordx4 v[108:111], v219, s[32:35], s3 offen nt
L_it9:
  s_waitcnt lgkmcnt(0)
  ds_read_b128 v[40:43], v250 offset:512
  ds_read_b128 v[44:47], v249 offset:512
  ds_read_b128 v[48:51], v250 offset:1536
  s_waitcnt vmcnt(9)
  s_mov_b64 exec, 3
  s_add_u32 s44, s78, 0x03030303
  v_msad_u8 v9, s78, v36, 0
  v_msad_u8 v10, s44, v36, 0
  v_msad_u8 v9, s78, v37, v9
  v_msad_u8 v10, s44, v37, v10
  v_msad_u8 v9, s78, v38, v9
  v_msad_u8 v10, s44, v38, v10
  global_store_byte v7, v8, s[30:31]
  global_load_dwordx3 v[36:38], v233, s[30:31] sc1
  v_sub_u32 v9, v9, v10
  v_add_u32_e64 v8, 1, v8
  v_readlane_b32 s66, v9, 0
  v_readlane_b32 s67, v9, 1
  s_add_u32 s78, s78, 0x01010101
  s_mov_b64 exec, -1
  s_lshl1_add_u32 s69, s91, s95
  s_add_u32 s95, s66, s67
  s_add_u32 s69, s69, s95
  v_dot2_f32_bf16 v22, v145, v52, 0
  v_add_f32_dpp v240, v18, v18 row_ror:8 row_mask:0xf bank_mask:0xc
  v_add_f32_dpp v240, v20, v20 row_ror:8 row_mask:0xf bank_mask:0x3
  v_dot2_f32_bf16 v23, v150, v53, 0
  v_dot2_f32_bf16 v24, v148, v54, 0
  v_dot2_f32_bf16 v25, v151, v55, 0
  v_cvt_f32_i32 v76, v76
  v_cvt_f32_i32 v77, v77
  v_cvt_f32_i32 v78, v78
  v_cvt_f32_i32 v79, v79
  v_pk_mul_f32 v[20:21], v[76:77], v[22:23]
  v_pk_add_f32 v[18:19], v[22:23], v[24:25]
  v_pk_fma_f32 v[20:21], v[78:79], v[24:25], v[20:21]
  v_add_f32 v18, v18, v19
  v_add_f32 v20, v20, v21
  s_add_u32 m0, s100, 14336
  v_lshrrev_b32 v10, 1, v222
  v_add_u32 v10, v10, v245
  v_mad_u64_u32 v[30:31], s[64:65], v10, 1, v[28:29]
  global_load_lds_dwordx4 v[30:31], off
  v_dot2_f32_bf16 v22, v141, v56, 0
  v_add_f32_dpp v21, v18, v18 row_ror:8 row_mask:0xf bank_mask:0xc
  v_add_f32_dpp v21, v20, v20 row_ror:8 row_mask:0xf bank_mask:0x3
  v_add_f32_dpp v20, v240, v240 row_half_mirror row_mask:0xf bank_mask:0x5
  v_dot2_f32_bf16 v23, v146, v57, 0
  v_add_f32_dpp v20, v21, v21 row_half_mirror row_mask:0xf bank_mask:0xa
  v_dot2_f32_bf16 v24, v144, v58, 0
  v_dot2_f32_bf16 v25, v147, v59, 0
  v_add_f32_dpp v20, v20, v20 quad_perm:[2,3,0,1] row_mask:0xf bank_mask:0xf
  v_cvt_f32_i32 v80, v80
  v_cvt_f32_i32 v81, v81
  v_add_f32_dpp v20, v20, v20 quad_perm:[1,0,3,2] row_mask:0xf bank_mask:0xf
  v_cndmask_b32_e64 v237, v237, v20, s[48:49]
  v_cvt_f32_i32 v82, v82
  v_cvt_f32_i32 v83, v83
  v_pk_mul_f32 v[20:21], v[80:81], v[22:23]
  v_pk_add_f32 v[18:19], v[22:23], v[24:25]
  v_pk_fma_f32 v[20:21], v[82:83], v[24:25], v[20:21]
  v_add_f32 v18, v18, v19
  v_add_f32 v20, v20, v21
  s_cmpk_gt_i32 s69, 0x13
  s_cbranch_scc1 L_p20_3
  s_cmp_gt_i32 s69, L_order_end-L_order-16421
  s_cbranch_scc1 L_p20_1
  s_waitcnt vmcnt(6)
L_p20_1:
  s_waitcnt vmcnt(10)
L_p20_3:
  s_waitcnt vmcnt(11)
  buffer_load_dwordx4 v[64:67], v220, s[32:35], 0 offen nt
  ds_read_b64 v[152:153], v12 offset:10240
  ds_read_b64 v[154:155], v12 offset:10368
  ds_read_b64 v[156:157], v12 offset:11264
  ds_read_b64 v[158:159], v12 offset:11392
  v_dot2_f32_bf16 v22, v145, v60, 0
  v_add_f32_dpp v241, v18, v18 row_ror:8 row_mask:0xf bank_mask:0xc
  v_add_f32_dpp v241, v20, v20 row_ror:8 row_mask:0xf bank_mask:0x3
  v_dot2_f32_bf16 v23, v150, v61, 0
  v_dot2_f32_bf16 v24, v148, v62, 0
  v_dot2_f32_bf16 v25, v151, v63, 0
  v_cvt_f32_i32 v84, v84
  v_cvt_f32_i32 v85, v85
  v_cvt_f32_i32 v86, v86
  v_cvt_f32_i32 v87, v87
  v_pk_mul_f32 v[20:21], v[84:85], v[22:23]
  v_pk_add_f32 v[18:19], v[22:23], v[24:25]
  v_pk_fma_f32 v[20:21], v[86:87], v[24:25], v[20:21]
  v_add_f32 v18, v18, v19
  v_add_f32 v20, v20, v21
  s_cmpk_gt_i32 s69, 0x13
  s_cbranch_scc1 L_p21_3
  s_cmp_gt_i32 s69, L_order_end-L_order-16391
  s_cbranch_scc1 L_p21_2
  s_waitcnt vmcnt(7)
L_p21_2:
  s_waitcnt vmcnt(11)
L_p21_3:
  s_waitcnt vmcnt(12)
  buffer_load_dwordx4 v[68:71], v221, s[32:35], 0 offen nt
  s_cmpk_gt_i32 s69, 0x13
  s_cbranch_scc1 L_p22_3
  s_cmp_gt_i32 s69, L_order_end-L_order-16445
  s_cbranch_scc1 L_p22_0
  s_waitcnt vmcnt(7)
L_p22_0:
  s_waitcnt vmcnt(8)
L_p22_3:
  s_waitcnt vmcnt(12)
  buffer_load_dwordx4 v[72:75], v220, s[32:35], s80 offen nt
L_it10:
  s_waitcnt lgkmcnt(0)
  ds_read_b128 v[52:55], v249 offset:1536
  ds_read_b128 v[56:59], v250 offset:2560
  ds_read_b128 v[60:63], v249 offset:2560
  s_waitcnt vmcnt(9)
  s_mov_b64 exec, 3
  s_add_u32 s44, s78, 0x03030303
  v_msad_u8 v9, s78, v32, 0
  v_msad_u8 v10, s44, v32, 0
  v_msad_u8 v9, s78, v33, v9
  v_msad_u8 v10, s44, v33, v10
  v_msad_u8 v9, s78, v34, v9
  v_msad_u8 v10, s44, v34, v10
  global_store_byte v7, v8, s[30:31]
  global_load_dwordx3 v[32:34], v234, s[30:31] sc1
  v_sub_u32 v9, v9, v10
  v_add_u32_e64 v8, 1, v8
  v_readlane_b32 s66, v9, 0
  v_readlane_b32 s67, v9, 1
  s_add_u32 s78, s78, 0x01010101
  s_mov_b64 exec, -1
  s_lshl1_add_u32 s69, s91, s95
  s_add_u32 s95, s66, s67
  s_add_u32 s69, s69, s95
  v_perm_b32 v149, v154, v152, s56
  v_perm_b32 v154, v154, v152, s57
  v_perm_b32 v152, v155, v153, s56
  v_perm_b32 v155, v155, v153, s57
  v_dot2_f32_bf16 v22, v149, v40, 0
  v_add_f32_dpp v21, v18, v18 row_ror:8 row_mask:0xf bank_mask:0xc
  v_add_f32_dpp v21, v20, v20 row_ror:8 row_mask:0xf bank_mask:0x3
  v_add_f32_dpp v20, v241, v241 row_half_mirror row_mask:0xf bank_mask:0x5
  v_dot2_f32_bf16 v23, v154, v41, 0
  v_add_f32_dpp v20, v21, v21 row_half_mirror row_mask:0xf bank_mask:0xa
  v_dot2_f32_bf16 v24, v152, v42, 0
  v_dot2_f32_bf16 v25, v155, v43, 0
  v_add_f32_dpp v20, v20, v20 quad_perm:[2,3,0,1] row_mask:0xf bank_mask:0xf
  v_cvt_f32_i32 v88, v88
  v_cvt_f32_i32 v89, v89
  v_add_f32_dpp v20, v20, v20 quad_perm:[1,0,3,2] row_mask:0xf bank_mask:0xf
  v_cndmask_b32_e64 v238, v238, v20, s[48:49]
  v_cvt_f32_i32 v90, v90
  v_cvt_f32_i32 v91, v91
  v_pk_mul_f32 v[20:21], v[88:89], v[22:23]
  v_pk_add_f32 v[18:19], v[22:23], v[24:25]
  v_pk_fma_f32 v[20:21], v[90:91], v[24:25], v[20:21]
  v_add_f32 v18, v18, v19
  v_add_f32 v20, v20, v21
  s_add_u32 m0, s100, 15360
  v_lshrrev_b32 v10, 1, v223
  v_add_u32 v10, v10, v247
  v_mad_u64_u32 v[30:31], s[64:65], v10, 1, v[28:29]
  global_load_lds_dwordx4 v[30:31], off
  v_perm_b32 v153, v158, v156, s56
  v_perm_b32 v158, v158, v156, s57
  v_perm_b32 v156, v159, v157, s56
  v_perm_b32 v159, v159, v157, s57
  v_dot2_f32_bf16 v22, v153, v44, 0
  v_add_f32_dpp v239, v18, v18 row_ror:8 row_mask:0xf bank_mask:0xc
  v_add_f32_dpp v239, v20, v20 row_ror:8 row_mask:0xf bank_mask:0x3
  v_dot2_f32_bf16 v23, v158, v45, 0
  v_dot2_f32_bf16 v24, v156, v46, 0
  v_dot2_f32_bf16 v25, v159, v47, 0
  v_cvt_f32_i32 v92, v92
  v_cvt_f32_i32 v93, v93
  v_cvt_f32_i32 v94, v94
  v_cvt_f32_i32 v95, v95
  v_pk_mul_f32 v[20:21], v[92:93], v[22:23]
  v_pk_add_f32 v[18:19], v[22:23], v[24:25]
  v_pk_fma_f32 v[20:21], v[94:95], v[24:25], v[20:21]
  v_add_f32 v18, v18, v19
  v_add_f32 v20, v20, v21
  s_cmpk_gt_i32 s69, 0x13
  s_cbranch_scc1 L_p23_3
  s_cmp_gt_i32 s69, L_order_end-L_order-16421
  s_cbranch_scc1 L_p23_1
  s_waitcnt vmcnt(6)
L_p23_1:
  s_waitcnt vmcnt(10)
L_p23_3:
  s_waitcnt vmcnt(11)
  buffer_load_dwordx4 v[76:79], v221, s[32:35], s80 offen nt
  v_dot2_f32_bf16 v22, v149, v48, 0
  v_add_f32_dpp v21, v18, v18 row_ror:8 row_mask:0xf bank_mask:0xc
  v_add_f32_dpp v21, v20, v20 row_ror:8 row_mask:0xf bank_mask:0x3
  v_add_f32_dpp v20, v239, v239 row_half_mirror row_mask:0xf bank_mask:0x5
  v_dot2_f32_bf16 v23, v154, v49, 0
  v_add_f32_dpp v20, v21, v21 row_half_mirror row_mask:0xf bank_mask:0xa
  v_dot2_f32_bf16 v24, v152, v50, 0
  v_dot2_f32_bf16 v25, v155, v51, 0
  v_add_f32_dpp v20, v20, v20 quad_perm:[2,3,0,1] row_mask:0xf bank_mask:0xf
  v_cvt_f32_i32 v96, v96
  v_cvt_f32_i32 v97, v97
  v_add_f32_dpp v20, v20, v20 quad_perm:[1,0,3,2] row_mask:0xf bank_mask:0xf
  v_cndmask_b32_e64 v236, v236, v20, s[50:51]
  v_cvt_f32_i32 v98, v98
  v_cvt_f32_i32 v99, v99
  v_pk_mul_f32 v[20:21], v[96:97], v[22:23]
  v_pk_add_f32 v[18:19], v[22:23], v[24:25]
  v_pk_fma_f32 v[20:21], v[98:99], v[24:25], v[20:21]
  v_add_f32 v18, v18, v19
  v_add_f32 v20, v20, v21
  s_cmpk_gt_i32 s69, 0x13
  s_cbranch_scc1 L_p24_3
  s_cmp_gt_i32 s69, L_order_end-L_order-16391
  s_cbranch_scc1 L_p24_2
  s_waitcnt vmcnt(7)
L_p24_2:
  s_waitcnt vmcnt(11)
L_p24_3:
  s_waitcnt vmcnt(12)
  buffer_load_dwordx4 v[80:83], v220, s[32:35], s3 offen nt
  s_cmpk_gt_i32 s69, 0x13
  s_cbranch_scc1 L_p25_3
  s_cmp_gt_i32 s69, L_order_end-L_order-16445
  s_cbranch_scc1 L_p25_0
  s_waitcnt vmcnt(7)
L_p25_0:
  s_waitcnt vmcnt(8)
L_p25_3:
  s_waitcnt vmcnt(12)
  buffer_load_dwordx4 v[84:87], v221, s[32:35], s3 offen nt
L_it11:
  s_waitcnt lgkmcnt(0)
  ds_read_b128 v[40:43], v253 offset:512
  ds_read_b128 v[44:47], v252 offset:512
  ds_read_b128 v[48:51], v253 offset:1536
  s_waitcnt vmcnt(9)
  s_mov_b64 exec, 3
  s_add_u32 s44, s78, 0x03030303
  v_msad_u8 v9, s78, v36, 0
  v_msad_u8 v10, s44, v36, 0
  v_msad_u8 v9, s78, v37, v9
  v_msad_u8 v10, s44, v37, v10
  v_msad_u8 v9, s78, v38, v9
  v_msad_u8 v10, s44, v38, v10
  global_store_byte v7, v8, s[30:31]
  global_load_dwordx3 v[36:38], v235, s[30:31] sc1
  v_sub_u32 v9, v9, v10
  v_add_u32_e64 v8, 1, v8
  v_readlane_b32 s66, v9, 0
  v_readlane_b32 s67, v9, 1
  s_add_u32 s78, s78, 0x01010101
  s_mov_b64 exec, -1
  s_lshl1_add_u32 s69, s91, s95
  s_add_u32 s95, s66, s67
  s_add_u32 s69, s69, s95
  v_dot2_f32_bf16 v22, v153, v52, 0
  v_add_f32_dpp v240, v18, v18 row_ror:8 row_mask:0xf bank_mask:0xc
  v_add_f32_dpp v240, v20, v20 row_ror:8 row_mask:0xf bank_mask:0x3
  v_dot2_f32_bf16 v23, v158, v53, 0
  v_dot2_f32_bf16 v24, v156, v54, 0
  v_dot2_f32_bf16 v25, v159, v55, 0
  v_cvt_f32_i32 v100, v100
  v_cvt_f32_i32 v101, v101
  v_cvt_f32_i32 v102, v102
  v_cvt_f32_i32 v103, v103
  v_pk_mul_f32 v[20:21], v[100:101], v[22:23]
  v_pk_add_f32 v[18:19], v[22:23], v[24:25]
  v_pk_fma_f32 v[20:21], v[102:103], v[24:25], v[20:21]
  v_add_f32 v18, v18, v19
  v_add_f32 v20, v20, v21
  s_add_u32 m0, s100, 16384
  v_lshrrev_b32 v10, 1, v224
  v_add_u32 v10, v10, v244
  v_mad_u64_u32 v[30:31], s[64:65], v10, 1, v[28:29]
  global_load_lds_dwordx4 v[30:31], off
  v_dot2_f32_bf16 v22, v149, v56, 0
  v_add_f32_dpp v21, v18, v18 row_ror:8 row_mask:0xf bank_mask:0xc
  v_add_f32_dpp v21, v20, v20 row_ror:8 row_mask:0xf bank_mask:0x3
  v_add_f32_dpp v20, v240, v240 row_half_mirror row_mask:0xf bank_mask:0x5
  v_dot2_f32_bf16 v23, v154, v57, 0
  v_add_f32_dpp v20, v21, v21 row_half_mirror row_mask:0xf bank_mask:0xa
  v_dot2_f32_bf16 v24, v152, v58, 0
  v_dot2_f32_bf16 v25, v155, v59, 0
  v_add_f32_dpp v20, v20, v20 quad_perm:[2,3,0,1] row_mask:0xf bank_mask:0xf
  v_cvt_f32_i32 v104, v104
  v_cvt_f32_i32 v105, v105
  v_add_f32_dpp v20, v20, v20 quad_perm:[1,0,3,2] row_mask:0xf bank_mask:0xf
  v_cndmask_b32_e64 v237, v237, v20, s[50:51]
  v_cvt_f32_i32 v106, v106
  v_cvt_f32_i32 v107, v107
  v_pk_mul_f32 v[20:21], v[104:105], v[22:23]
  v_pk_add_f32 v[18:19], v[22:23], v[24:25]
  v_pk_fma_f32 v[20:21], v[106:107], v[24:25], v[20:21]
  v_add_f32 v18, v18, v19
  v_add_f32 v20, v20, v21
  s_cmpk_gt_i32 s69, 0x13
  s_cbranch_scc1 L_p26_3
  s_cmp_gt_i32 s69, L_order_end-L_order-16421
  s_cbranch_scc1 L_p26_1
  s_waitcnt vmcnt(6)
L_p26_1:
  s_waitcnt vmcnt(10)
L_p26_3:
  s_waitcnt vmcnt(11)
  buffer_load_dwordx4 v[88:91], v222, s[32:35], 0 offen nt
  ds_read_b64 v[160:161], v12 offset:12288
  ds_read_b64 v[162:163], v12 offset:12416
  ds_read_b64 v[164:165], v12 offset:13312
  ds_read_b64 v[166:167], v12 offset:13440
  v_dot2_f32_bf16 v22, v153, v60, 0
  v_add_f32_dpp v241, v18, v18 row_ror:8 row_mask:0xf bank_mask:0xc
  v_add_f32_dpp v241, v20, v20 row_ror:8 row_mask:0xf bank_mask:0x3
  v_dot2_f32_bf16 v23, v158, v61, 0
  v_dot2_f32_bf16 v24, v156, v62, 0
  v_dot2_f32_bf16 v25, v159, v63, 0
  v_cvt_f32_i32 v108, v108
  v_cvt_f32_i32 v109, v109
  v_cvt_f32_i32 v110, v110
  v_cvt_f32_i32 v111, v111
  v_pk_mul_f32 v[20:21], v[108:109], v[22:23]
  v_pk_add_f32 v[18:19], v[22:23], v[24:25]
  v_pk_fma_f32 v[20:21], v[110:111], v[24:25], v[20:21]
  v_add_f32 v18, v18, v19
  v_add_f32 v20, v20, v21
  s_cmpk_gt_i32 s69, 0x13
  s_cbranch_scc1 L_p27_3
  s_cmp_gt_i32 s69, L_order_end-L_order-16391
  s_cbranch_scc1 L_p27_2
  s_waitcnt vmcnt(7)
L_p27_2:
  s_waitcnt vmcnt(11)
L_p27_3:
  s_waitcnt vmcnt(12)
  buffer_load_dwordx4 v[92:95], v223, s[32:35], 0 offen nt
  s_cmpk_gt_i32 s69, 0x13
  s_cbranch_scc1 L_p28_3
  s_cmp_gt_i32 s69, L_order_end-L_order-16445
  s_cbranch_scc1 L_p28_0
  s_waitcnt vmcnt(7)
L_p28_0:
  s_waitcnt vmcnt(8)
L_p28_3:
  s_waitcnt vmcnt(12)
  buffer_load_dwordx4 v[96:99], v222, s[32:35], s80 offen nt
L_it12:
  s_waitcnt lgkmcnt(0)
  ds_read_b128 v[52:55], v252 offset:1536
  ds_read_b128 v[56:59], v253 offset:2560
  ds_read_b128 v[60:63], v252 offset:2560
  s_waitcnt vmcnt(9)
  s_mov_b64 exec, 3
  s_add_u32 s44, s78, 0x03030303
  v_msad_u8 v9, s78, v32, 0
  v_msad_u8 v10, s44, v32, 0
  v_msad_u8 v9, s78, v33, v9
  v_msad_u8 v10, s44, v33, v10
  v_msad_u8 v9, s78, v34, v9
  v_msad_u8 v10, s44, v34, v10
  global_store_byte v7, v8, s[30:31]
  global_load_dwordx3 v[32:34], v232, s[30:31] sc1
  v_sub_u32 v9, v9, v10
  v_add_u32_e64 v8, 1, v8
  v_readlane_b32 s66, v9, 0
  v_readlane_b32 s67, v9, 1
  s_add_u32 s78, s78, 0x01010101
  s_mov_b64 exec, -1
  s_lshl1_add_u32 s69, s91, s95
  s_add_u32 s95, s66, s67
  s_add_u32 s69, s69, s95
  v_perm_b32 v157, v162, v160, s56
  v_perm_b32 v162, v162, v160, s57
  v_perm_b32 v160, v163, v161, s56
  v_perm_b32 v163, v163, v161, s57
  v_dot2_f32_bf16 v22, v157, v40, 0
  v_add_f32_dpp v21, v18, v18 row_ror:8 row_mask:0xf bank_mask:0xc
  v_add_f32_dpp v21, v20, v20 row_ror:8 row_mask:0xf bank_mask:0x3
  v_add_f32_dpp v20, v241, v241 row_half_mirror row_mask:0xf bank_mask:0x5
  v_dot2_f32_bf16 v23, v162, v41, 0
  v_add_f32_dpp v20, v21, v21 row_half_mirror row_mask:0xf bank_mask:0xa
  v_dot2_f32_bf16 v24, v160, v42, 0
  v_dot2_f32_bf16 v25, v163, v43, 0
  v_add_f32_dpp v20, v20, v20 quad_perm:[2,3,0,1] row_mask:0xf bank_mask:0xf
  v_cvt_f32_i32 v64, v64
  v_cvt_f32_i32 v65, v65
  v_add_f32_dpp v20, v20, v20 quad_perm:[1,0,3,2] row_mask:0xf bank_mask:0xf
  v_cndmask_b32_e64 v238, v238, v20, s[50:51]
  v_cvt_f32_i32 v66, v66
  v_cvt_f32_i32 v67, v67
  v_pk_mul_f32 v[20:21], v[64:65], v[22:23]
  v_pk_add_f32 v[18:19], v[22:23], v[24:25]
  v_pk_fma_f32 v[20:21], v[66:67], v[24:25], v[20:21]
  v_add_f32 v18, v18, v19
  v_add_f32 v20, v20, v21
  s_add_u32 m0, s100, 17408
  v_lshrrev_b32 v10, 1, v225
  v_add_u32 v10, v10, v243
  v_mad_u64_u32 v[30:31], s[64:65], v10, 1, v[28:29]
  global_load_lds_dwordx4 v[30:31], off
  v_perm_b32 v161, v166, v164, s56
  v_perm_b32 v166, v166, v164, s57
  v_perm_b32 v164, v167, v165, s56
  v_perm_b32 v167, v167, v165, s57
  v_dot2_f32_bf16 v22, v161, v44, 0
  v_add_f32_dpp v239, v18, v18 row_ror:8 row_mask:0xf bank_mask:0xc
  v_add_f32_dpp v239, v20, v20 row_ror:8 row_mask:0xf bank_mask:0x3
  v_dot2_f32_bf16 v23, v166, v45, 0
  v_dot2_f32_bf16 v24, v164, v46, 0
  v_dot2_f32_bf16 v25, v167, v47, 0
  v_cvt_f32_i32 v68, v68
  v_cvt_f32_i32 v69, v69
  v_cvt_f32_i32 v70, v70
  v_cvt_f32_i32 v71, v71
  v_pk_mul_f32 v[20:21], v[68:69], v[22:23]
  v_pk_add_f32 v[18:19], v[22:23], v[24:25]
  v_pk_fma_f32 v[20:21], v[70:71], v[24:25], v[20:21]
  v_add_f32 v18, v18, v19
  v_add_f32 v20, v20, v21
  s_cmpk_gt_i32 s69, 0x13
  s_cbranch_scc1 L_p29_3
  s_cmp_gt_i32 s69, L_order_end-L_order-16421
  s_cbranch_scc1 L_p29_1
  s_waitcnt vmcnt(6)
L_p29_1:
  s_waitcnt vmcnt(10)
L_p29_3:
  s_waitcnt vmcnt(11)
  buffer_load_dwordx4 v[100:103], v223, s[32:35], s80 offen nt
  v_dot2_f32_bf16 v22, v157, v48, 0
  v_add_f32_dpp v21, v18, v18 row_ror:8 row_mask:0xf bank_mask:0xc
  v_add_f32_dpp v21, v20, v20 row_ror:8 row_mask:0xf bank_mask:0x3
  v_add_f32_dpp v20, v239, v239 row_half_mirror row_mask:0xf bank_mask:0x5
  v_dot2_f32_bf16 v23, v162, v49, 0
  v_add_f32_dpp v20, v21, v21 row_half_mirror row_mask:0xf bank_mask:0xa
  v_dot2_f32_bf16 v24, v160, v50, 0
  v_dot2_f32_bf16 v25, v163, v51, 0
  v_add_f32_dpp v20, v20, v20 quad_perm:[2,3,0,1] row_mask:0xf bank_mask:0xf
  v_cvt_f32_i32 v72, v72
  v_cvt_f32_i32 v73, v73
  v_add_f32_dpp v20, v20, v20 quad_perm:[1,0,3,2] row_mask:0xf bank_mask:0xf
  v_cndmask_b32_e64 v236, v236, v20, s[52:53]
  v_cvt_f32_i32 v74, v74
  v_cvt_f32_i32 v75, v75
  v_pk_mul_f32 v[20:21], v[72:73], v[22:23]
  v_pk_add_f32 v[18:19], v[22:23], v[24:25]
  v_pk_fma_f32 v[20:21], v[74:75], v[24:25], v[20:21]
  v_add_f32 v18, v18, v19
  v_add_f32 v20, v20, v21
  s_cmpk_gt_i32 s69, 0x13
  s_cbranch_scc1 L_p30_3
  s_cmp_gt_i32 s69, L_order_end-L_order-16391
  s_cbranch_scc1 L_p30_2
  s_waitcnt vmcnt(7)
L_p30_2:
  s_waitcnt vmcnt(11)
L_p30_3:
  s_waitcnt vmcnt(12)
  buffer_load_dwordx4 v[104:107], v222, s[32:35], s3 offen nt
  s_cmpk_gt_i32 s69, 0x13
  s_cbranch_scc1 L_p31_3
  s_cmp_gt_i32 s69, L_order_end-L_order-16445
  s_cbranch_scc1 L_p31_0
  s_waitcnt vmcnt(7)
L_p31_0:
  s_waitcnt vmcnt(8)
L_p31_3:
  s_waitcnt vmcnt(12)
  buffer_load_dwordx4 v[108:111], v223, s[32:35], s3 offen nt
L_it13:
  s_waitcnt lgkmcnt(0)
  ds_read_b128 v[40:43], v251 offset:512
  ds_read_b128 v[44:47], v253 offset:512
  ds_read_b128 v[48:51], v251 offset:1536
  s_waitcnt vmcnt(9)
  s_mov_b64 exec, 3
  s_add_u32 s44, s78, 0x03030303
  v_msad_u8 v9, s78, v36, 0
  v_msad_u8 v10, s44, v36, 0
  v_msad_u8 v9, s78, v37, v9
  v_msad_u8 v10, s44, v37, v10
  v_msad_u8 v9, s78, v38, v9
  v_msad_u8 v10, s44, v38, v10
  global_load_dwordx2 v[26:27], v11, s[30:31] sc1
  global_store_byte v7, v8, s[30:31]
  global_load_dwordx3 v[36:38], v233, s[30:31] sc1
  v_sub_u32 v9, v9, v10
  v_add_u32_e64 v8, 1, v8
  v_readlane_b32 s66, v9, 0
  v_readlane_b32 s67, v9, 1
  s_add_u32 s78, s78, 0x01010101
  s_mov_b64 exec, -1
  s_lshl1_add_u32 s69, s91, s95
  s_add_u32 s95, s66, s67
  s_add_u32 s69, s69, s95
  v_dot2_f32_bf16 v22, v161, v52, 0
  v_add_f32_dpp v240, v18, v18 row_ror:8 row_mask:0xf bank_mask:0xc
  v_add_f32_dpp v240, v20, v20 row_ror:8 row_mask:0xf bank_mask:0x3
  v_dot2_f32_bf16 v23, v166, v53, 0
  v_dot2_f32_bf16 v24, v164, v54, 0
  v_dot2_f32_bf16 v25, v167, v55, 0
  v_cvt_f32_i32 v76, v76
  v_cvt_f32_i32 v77, v77
  v_cvt_f32_i32 v78, v78
  v_cvt_f32_i32 v79, v79
  v_pk_mul_f32 v[20:21], v[76:77], v[22:23]
  v_pk_add_f32 v[18:19], v[22:23], v[24:25]
  v_pk_fma_f32 v[20:21], v[78:79], v[24:25], v[20:21]
  v_add_f32 v18, v18, v19
  v_add_f32 v20, v20, v21
  s_add_u32 m0, s100, 18432
  v_lshrrev_b32 v10, 1, v226
  v_add_u32 v10, v10, v242
  v_mad_u64_u32 v[30:31], s[64:65], v10, 1, v[28:29]
  global_load_lds_dwordx4 v[30:31], off
  v_dot2_f32_bf16 v22, v157, v56, 0
  v_add_f32_dpp v21, v18, v18 row_ror:8 row_mask:0xf bank_mask:0xc
  v_add_f32_dpp v21, v20, v20 row_ror:8 row_mask:0xf bank_mask:0x3
  v_add_f32_dpp v20, v240, v240 row_half_mirror row_mask:0xf bank_mask:0x5
  v_dot2_f32_bf16 v23, v162, v57, 0
  v_add_f32_dpp v20, v21, v21 row_half_mirror row_mask:0xf bank_mask:0xa
  v_dot2_f32_bf16 v24, v160, v58, 0
  v_dot2_f32_bf16 v25, v163, v59, 0
  v_add_f32_dpp v20, v20, v20 quad_perm:[2,3,0,1] row_mask:0xf bank_mask:0xf
  v_cvt_f32_i32 v80, v80
  v_cvt_f32_i32 v81, v81
  v_add_f32_dpp v20, v20, v20 quad_perm:[1,0,3,2] row_mask:0xf bank_mask:0xf
  v_cndmask_b32_e64 v237, v237, v20, s[52:53]
  v_cvt_f32_i32 v82, v82
  v_cvt_f32_i32 v83, v83
  v_pk_mul_f32 v[20:21], v[80:81], v[22:23]
  v_pk_add_f32 v[18:19], v[22:23], v[24:25]
  v_pk_fma_f32 v[20:21], v[82:83], v[24:25], v[20:21]
  v_add_f32 v18, v18, v19
  v_add_f32 v20, v20, v21
  s_cmpk_gt_i32 s69, 0x13
  s_cbranch_scc1 L_p32_3
  s_cmp_gt_i32 s69, L_order_end-L_order-16421
  s_cbranch_scc1 L_p32_1
  s_waitcnt vmcnt(7)
L_p32_1:
  s_waitcnt vmcnt(11)
L_p32_3:
  s_waitcnt vmcnt(12)
  buffer_load_dwordx4 v[64:67], v224, s[32:35], 0 offen nt
  ds_read_b64 v[168:169], v12 offset:14336
  ds_read_b64 v[170:171], v12 offset:14464
  ds_read_b64 v[172:173], v12 offset:15360
  ds_read_b64 v[174:175], v12 offset:15488
  v_dot2_f32_bf16 v22, v161, v60, 0
  v_add_f32_dpp v241, v18, v18 row_ror:8 row_mask:0xf bank_mask:0xc
  v_add_f32_dpp v241, v20, v20 row_ror:8 row_mask:0xf bank_mask:0x3
  v_dot2_f32_bf16 v23, v166, v61, 0
  v_dot2_f32_bf16 v24, v164, v62, 0
  v_dot2_f32_bf16 v25, v167, v63, 0
  v_cvt_f32_i32 v84, v84
  v_cvt_f32_i32 v85, v85
  v_cvt_f32_i32 v86, v86
  v_cvt_f32_i32 v87, v87
  v_pk_mul_f32 v[20:21], v[84:85], v[22:23]
  v_pk_add_f32 v[18:19], v[22:23], v[24:25]
  v_pk_fma_f32 v[20:21], v[86:87], v[24:25], v[20:21]
  v_add_f32 v18, v18, v19
  v_add_f32 v20, v20, v21
  s_cmpk_gt_i32 s69, 0x13
  s_cbranch_scc1 L_p33_3
  s_cmp_gt_i32 s69, L_order_end-L_order-16391
  s_cbranch_scc1 L_p33_2
  s_waitcnt vmcnt(8)
L_p33_2:
  s_waitcnt vmcnt(12)
L_p33_3:
  s_waitcnt vmcnt(13)
  buffer_load_dwordx4 v[68:71], v225, s[32:35], 0 offen nt
  s_cmpk_gt_i32 s69, 0x13
  s_cbranch_scc1 L_p34_3
  s_cmp_gt_i32 s69, L_order_end-L_order-16445
  s_cbranch_scc1 L_p34_0
  s_waitcnt vmcnt(8)
L_p34_0:
  s_waitcnt vmcnt(9)
L_p34_3:
  s_waitcnt vmcnt(13)
  buffer_load_dwordx4 v[72:75], v224, s[32:35], s80 offen nt
L_it14:
  s_waitcnt lgkmcnt(0)
  ds_read_b128 v[52:55], v253 offset:1536
  ds_read_b128 v[56:59], v251 offset:2560
  ds_read_b128 v[60:63], v253 offset:2560
  s_waitcnt vmcnt(10)
  s_mov_b64 exec, 3
  s_add_u32 s44, s78, 0x03030303
  v_msad_u8 v9, s78, v32, 0
  v_msad_u8 v10, s44, v32, 0
  v_msad_u8 v9, s78, v33, v9
  v_msad_u8 v10, s44, v33, v10
  v_msad_u8 v9, s78, v34, v9
  v_msad_u8 v10, s44, v34, v10
  global_store_byte v7, v8, s[30:31]
  global_load_dwordx3 v[32:34], v234, s[30:31] sc1
  v_sub_u32 v9, v9, v10
  v_add_u32_e64 v8, 1, v8
  v_readlane_b32 s66, v9, 0
  v_readlane_b32 s67, v9, 1
  s_add_u32 s78, s78, 0x01010101
  s_mov_b64 exec, -1
  s_lshl1_add_u32 s69, s91, s95
  s_add_u32 s95, s66, s67
  s_add_u32 s69, s69, s95
  v_perm_b32 v165, v170, v168, s56
  v_perm_b32 v170, v170, v168, s57
  v_perm_b32 v168, v171, v169, s56
  v_perm_b32 v171, v171, v169, s57
  v_dot2_f32_bf16 v22, v165, v40, 0
  v_add_f32_dpp v21, v18, v18 row_ror:8 row_mask:0xf bank_mask:0xc
  v_add_f32_dpp v21, v20, v20 row_ror:8 row_mask:0xf bank_mask:0x3
  v_add_f32_dpp v20, v241, v241 row_half_mirror row_mask:0xf bank_mask:0x5
  v_dot2_f32_bf16 v23, v170, v41, 0
  v_add_f32_dpp v20, v21, v21 row_half_mirror row_mask:0xf bank_mask:0xa
  v_dot2_f32_bf16 v24, v168, v42, 0
  v_dot2_f32_bf16 v25, v171, v43, 0
  v_add_f32_dpp v20, v20, v20 quad_perm:[2,3,0,1] row_mask:0xf bank_mask:0xf
  v_cvt_f32_i32 v88, v88
  v_cvt_f32_i32 v89, v89
  v_add_f32_dpp v20, v20, v20 quad_perm:[1,0,3,2] row_mask:0xf bank_mask:0xf
  v_cndmask_b32_e64 v238, v238, v20, s[52:53]
  v_cvt_f32_i32 v90, v90
  v_cvt_f32_i32 v91, v91
  v_pk_mul_f32 v[20:21], v[88:89], v[22:23]
  v_pk_add_f32 v[18:19], v[22:23], v[24:25]
  v_pk_fma_f32 v[20:21], v[90:91], v[24:25], v[20:21]
  v_add_f32 v18, v18, v19
  v_add_f32 v20, v20, v21
  s_add_u32 m0, s100, 19456
  v_lshrrev_b32 v10, 1, v227
  v_add_u32 v10, v10, v244
  v_mad_u64_u32 v[30:31], s[64:65], v10, 1, v[28:29]
  global_load_lds_dwordx4 v[30:31], off
  v_perm_b32 v169, v174, v172, s56
  v_perm_b32 v174, v174, v172, s57
  v_perm_b32 v172, v175, v173, s56
  v_perm_b32 v175, v175, v173, s57
  v_dot2_f32_bf16 v22, v169, v44, 0
  v_add_f32_dpp v239, v18, v18 row_ror:8 row_mask:0xf bank_mask:0xc
  v_add_f32_dpp v239, v20, v20 row_ror:8 row_mask:0xf bank_mask:0x3
  v_dot2_f32_bf16 v23, v174, v45, 0
  v_dot2_f32_bf16 v24, v172, v46, 0
  v_dot2_f32_bf16 v25, v175, v47, 0
  v_cvt_f32_i32 v92, v92
  v_cvt_f32_i32 v93, v93
  v_cvt_f32_i32 v94, v94
  v_cvt_f32_i32 v95, v95
  v_pk_mul_f32 v[20:21], v[92:93], v[22:23]
  v_pk_add_f32 v[18:19], v[22:23], v[24:25]
  v_pk_fma_f32 v[20:21], v[94:95], v[24:25], v[20:21]
  v_add_f32 v18, v18, v19
  v_add_f32 v20, v20, v21
  s_cmpk_gt_i32 s69, 0x13
  s_cbranch_scc1 L_p35_3
  s_cmp_gt_i32 s69, L_order_end-L_order-16421
  s_cbranch_scc1 L_p35_1
  s_waitcnt vmcnt(6)
L_p35_1:
  s_waitcnt vmcnt(11)
L_p35_3:
  s_waitcnt vmcnt(12)
  buffer_load_dwordx4 v[76:79], v225, s[32:35], s80 offen nt
  v_dot2_f32_bf16 v22, v165, v48, 0
  v_add_f32_dpp v21, v18, v18 row_ror:8 row_mask:0xf bank_mask:0xc
  v_add_f32_dpp v21, v20, v20 row_ror:8 row_mask:0xf bank_mask:0x3
  v_add_f32_dpp v20, v239, v239 row_half_mirror row_mask:0xf bank_mask:0x5
  v_dot2_f32_bf16 v23, v170, v49, 0
  v_add_f32_dpp v20, v21, v21 row_half_mirror row_mask:0xf bank_mask:0xa
  v_dot2_f32_bf16 v24, v168, v50, 0
  v_dot2_f32_bf16 v25, v171, v51, 0
  v_add_f32_dpp v20, v20, v20 quad_perm:[2,3,0,1] row_mask:0xf bank_mask:0xf
  v_cvt_f32_i32 v96, v96
  v_cvt_f32_i32 v97, v97
  v_add_f32_dpp v20, v20, v20 quad_perm:[1,0,3,2] row_mask:0xf bank_mask:0xf
  v_cndmask_b32_e64 v236, v236, v20, s[54:55]
  ds_write_b32 v16, v236 offset:0
  v_cvt_f32_i32 v98, v98
  v_cvt_f32_i32 v99, v99
  v_pk_mul_f32 v[20:21], v[96:97], v[22:23]
  v_pk_add_f32 v[18:19], v[22:23], v[24:25]
  v_pk_fma_f32 v[20:21], v[98:99], v[24:25], v[20:21]
  v_add_f32 v18, v18, v19
  v_add_f32 v20, v20, v21
  s_cmpk_gt_i32 s69, 0x13
  s_cbranch_scc1 L_p36_3
  s_cmp_gt_i32 s69, L_order_end-L_order-16391
  s_cbranch_scc1 L_p36_2
  s_waitcnt vmcnt(7)
L_p36_2:
  s_waitcnt vmcnt(12)
L_p36_3:
  s_waitcnt vmcnt(13)
  buffer_load_dwordx4 v[80:83], v224, s[32:35], s3 offen nt
  s_cmpk_gt_i32 s69, 0x13
  s_cbranch_scc1 L_p37_3
  s_cmp_gt_i32 s69, L_order_end-L_order-16445
  s_cbranch_scc1 L_p37_0
  s_waitcnt vmcnt(7)
L_p37_0:
  s_waitcnt vmcnt(8)
L_p37_3:
  s_waitcnt vmcnt(13)
  buffer_load_dwordx4 v[84:87], v225, s[32:35], s3 offen nt
L_it15:
  s_waitcnt lgkmcnt(0)
  ds_read_b128 v[40:43], v250 offset:512
  ds_read_b128 v[44:47], v249 offset:512
  ds_read_b128 v[48:51], v250 offset:1536
  s_waitcnt vmcnt(9)
  s_mov_b64 exec, 3
  s_add_u32 s44, s78, 0x03030303
  v_msad_u8 v9, s78, v36, 0
  v_msad_u8 v10, s44, v36, 0
  v_msad_u8 v9, s78, v37, v9
  v_msad_u8 v10, s44, v37, v10
  v_msad_u8 v9, s78, v38, v9
  v_msad_u8 v10, s44, v38, v10
  global_store_byte v7, v8, s[30:31]
  global_load_dwordx3 v[36:38], v235, s[30:31] sc1
  v_sub_u32 v9, v9, v10
  v_add_u32_e64 v8, 1, v8
  v_add3_u32 v10, v26, v27, s58
  v_readlane_b32 s66, v9, 0
  v_readlane_b32 s67, v9, 1
  v_readlane_b32 s91, v10, 0
  s_add_u32 s78, s78, 0x01010101
  s_mov_b64 exec, -1
  s_lshl1_add_u32 s69, s91, s95
  s_add_u32 s95, s66, s67
  s_add_u32 s69, s69, s95
  v_dot2_f32_bf16 v22, v169, v52, 0
  v_add_f32_dpp v240, v18, v18 row_ror:8 row_mask:0xf bank_mask:0xc
  v_add_f32_dpp v240, v20, v20 row_ror:8 row_mask:0xf bank_mask:0x3
  v_dot2_f32_bf16 v23, v174, v53, 0
  v_dot2_f32_bf16 v24, v172, v54, 0
  v_dot2_f32_bf16 v25, v175, v55, 0
  v_cvt_f32_i32 v100, v100
  v_cvt_f32_i32 v101, v101
  v_cvt_f32_i32 v102, v102
  v_cvt_f32_i32 v103, v103
  v_pk_mul_f32 v[20:21], v[100:101], v[22:23]
  v_pk_add_f32 v[18:19], v[22:23], v[24:25]
  v_pk_fma_f32 v[20:21], v[102:103], v[24:25], v[20:21]
  v_add_f32 v18, v18, v19
  v_add_f32 v20, v20, v21
  s_add_u32 m0, s100, 20480
  v_lshrrev_b32 v10, 1, v228
  v_add_u32 v10, v10, v245
  v_mad_u64_u32 v[30:31], s[64:65], v10, 1, v[28:29]
  global_load_lds_dwordx4 v[30:31], off
  v_dot2_f32_bf16 v22, v165, v56, 0
  v_add_f32_dpp v21, v18, v18 row_ror:8 row_mask:0xf bank_mask:0xc
  v_add_f32_dpp v21, v20, v20 row_ror:8 row_mask:0xf bank_mask:0x3
  v_add_f32_dpp v20, v240, v240 row_half_mirror row_mask:0xf bank_mask:0x5
  v_dot2_f32_bf16 v23, v170, v57, 0
  v_add_f32_dpp v20, v21, v21 row_half_mirror row_mask:0xf bank_mask:0xa
  v_dot2_f32_bf16 v24, v168, v58, 0
  v_dot2_f32_bf16 v25, v171, v59, 0
  v_add_f32_dpp v20, v20, v20 quad_perm:[2,3,0,1] row_mask:0xf bank_mask:0xf
  v_cvt_f32_i32 v104, v104
  v_cvt_f32_i32 v105, v105
  v_add_f32_dpp v20, v20, v20 quad_perm:[1,0,3,2] row_mask:0xf bank_mask:0xf
  v_cndmask_b32_e64 v237, v237, v20, s[54:55]
  ds_write_b32 v16, v237 offset:3072
  v_cvt_f32_i32 v106, v106
  v_cvt_f32_i32 v107, v107
  v_pk_mul_f32 v[20:21], v[104:105], v[22:23]
  v_pk_add_f32 v[18:19], v[22:23], v[24:25]
  v_pk_fma_f32 v[20:21], v[106:107], v[24:25], v[20:21]
  v_add_f32 v18, v18, v19
  v_add_f32 v20, v20, v21
  s_cmpk_gt_i32 s69, 0x13
  s_cbranch_scc1 L_p38_3
  s_cmp_gt_i32 s69, L_order_end-L_order-16421
  s_cbranch_scc1 L_p38_1
  s_waitcnt vmcnt(6)
L_p38_1:
  s_waitcnt vmcnt(10)
L_p38_3:
  s_waitcnt vmcnt(11)
  buffer_load_dwordx4 v[88:91], v226, s[32:35], 0 offen nt
  ds_read_b64 v[176:177], v12 offset:16384
  ds_read_b64 v[178:179], v12 offset:16512
  ds_read_b64 v[180:181], v12 offset:17408
  ds_read_b64 v[182:183], v12 offset:17536
  v_dot2_f32_bf16 v22, v169, v60, 0
  v_add_f32_dpp v241, v18, v18 row_ror:8 row_mask:0xf bank_mask:0xc
  v_add_f32_dpp v241, v20, v20 row_ror:8 row_mask:0xf bank_mask:0x3
  v_dot2_f32_bf16 v23, v174, v61, 0
  v_dot2_f32_bf16 v24, v172, v62, 0
  v_dot2_f32_bf16 v25, v175, v63, 0
  v_cvt_f32_i32 v108, v108
  v_cvt_f32_i32 v109, v109
  v_cvt_f32_i32 v110, v110
  v_cvt_f32_i32 v111, v111
  v_pk_mul_f32 v[20:21], v[108:109], v[22:23]
  v_pk_add_f32 v[18:19], v[22:23], v[24:25]
  v_pk_fma_f32 v[20:21], v[110:111], v[24:25], v[20:21]
  v_add_f32 v18, v18, v19
  v_add_f32 v20, v20, v21
  s_cmpk_gt_i32 s69, 0x13
  s_cbranch_scc1 L_p39_3
  s_cmp_gt_i32 s69, L_order_end-L_order-16391
  s_cbranch_scc1 L_p39_2
  s_waitcnt vmcnt(7)
L_p39_2:
  s_waitcnt vmcnt(11)
L_p39_3:
  s_waitcnt vmcnt(12)
  buffer_load_dwordx4 v[92:95], v227, s[32:35], 0 offen nt
  s_cmpk_gt_i32 s69, 0x13
  s_cbranch_scc1 L_p40_3
  s_cmp_gt_i32 s69, L_order_end-L_order-16445
  s_cbranch_scc1 L_p40_0
  s_waitcnt vmcnt(7)
L_p40_0:
  s_waitcnt vmcnt(8)
L_p40_3:
  s_waitcnt vmcnt(12)
  buffer_load_dwordx4 v[96:99], v226, s[32:35], s80 offen nt
  v_mov_b32_e64 v9, 2
  ds_write_b32 v6, v9 offset:0
L_it16:
  s_waitcnt lgkmcnt(0)
  ds_read_b128 v[52:55], v249 offset:1536
  ds_read_b128 v[56:59], v250 offset:2560
  ds_read_b128 v[60:63], v249 offset:2560
  s_waitcnt vmcnt(9)
  s_mov_b64 exec, 3
  s_add_u32 s44, s78, 0x03030303
  v_msad_u8 v9, s78, v32, 0
  v_msad_u8 v10, s44, v32, 0
  v_msad_u8 v9, s78, v33, v9
  v_msad_u8 v10, s44, v33, v10
  v_msad_u8 v9, s78, v34, v9
  v_msad_u8 v10, s44, v34, v10
  global_store_byte v7, v8, s[30:31]
  global_load_dwordx3 v[32:34], v232, s[30:31] sc1
  v_sub_u32 v9, v9, v10
  v_add_u32_e64 v8, 1, v8
  v_readlane_b32 s66, v9, 0
  v_readlane_b32 s67, v9, 1
  s_add_u32 s78, s78, 0x01010101
  s_mov_b64 exec, -1
  s_lshl1_add_u32 s69, s91, s95
  s_add_u32 s95, s66, s67
  s_add_u32 s69, s69, s95
  v_perm_b32 v173, v178, v176, s56
  v_perm_b32 v178, v178, v176, s57
  v_perm_b32 v176, v179, v177, s56
  v_perm_b32 v179, v179, v177, s57
  v_dot2_f32_bf16 v22, v173, v40, 0
  v_add_f32_dpp v21, v18, v18 row_ror:8 row_mask:0xf bank_mask:0xc
  v_add_f32_dpp v21, v20, v20 row_ror:8 row_mask:0xf bank_mask:0x3
  v_add_f32_dpp v20, v241, v241 row_half_mirror row_mask:0xf bank_mask:0x5
  v_dot2_f32_bf16 v23, v178, v41, 0
  v_add_f32_dpp v20, v21, v21 row_half_mirror row_mask:0xf bank_mask:0xa
  v_dot2_f32_bf16 v24, v176, v42, 0
  v_dot2_f32_bf16 v25, v179, v43, 0
  v_add_f32_dpp v20, v20, v20 quad_perm:[2,3,0,1] row_mask:0xf bank_mask:0xf
  v_cvt_f32_i32 v64, v64
  v_cvt_f32_i32 v65, v65
  v_add_f32_dpp v20, v20, v20 quad_perm:[1,0,3,2] row_mask:0xf bank_mask:0xf
  v_cndmask_b32_e64 v238, v238, v20, s[54:55]
  ds_write_b32 v16, v238 offset:6144
  v_cvt_f32_i32 v66, v66
  v_cvt_f32_i32 v67, v67
  v_pk_mul_f32 v[20:21], v[64:65], v[22:23]
  v_pk_add_f32 v[18:19], v[22:23], v[24:25]
  v_pk_fma_f32 v[20:21], v[66:67], v[24:25], v[20:21]
  v_add_f32 v18, v18, v19
  v_add_f32 v20, v20, v21
  s_add_u32 m0, s100, 21504
  v_lshrrev_b32 v10, 1, v229
  v_add_u32 v10, v10, v247
  v_mad_u64_u32 v[30:31], s[64:65], v10, 1, v[28:29]
  global_load_lds_dwordx4 v[30:31], off
  v_perm_b32 v177, v182, v180, s56
  v_perm_b32 v182, v182, v180, s57
  v_perm_b32 v180, v183, v181, s56
  v_perm_b32 v183, v183, v181, s57
  v_dot2_f32_bf16 v22, v177, v44, 0
  v_add_f32_dpp v239, v18, v18 row_ror:8 row_mask:0xf bank_mask:0xc
  v_add_f32_dpp v239, v20, v20 row_ror:8 row_mask:0xf bank_mask:0x3
  v_dot2_f32_bf16 v23, v182, v45, 0
  v_dot2_f32_bf16 v24, v180, v46, 0
  v_dot2_f32_bf16 v25, v183, v47, 0
  v_cvt_f32_i32 v68, v68
  v_cvt_f32_i32 v69, v69
  v_cvt_f32_i32 v70, v70
  v_cvt_f32_i32 v71, v71
  v_pk_mul_f32 v[20:21], v[68:69], v[22:23]
  v_pk_add_f32 v[18:19], v[22:23], v[24:25]
  v_pk_fma_f32 v[20:21], v[70:71], v[24:25], v[20:21]
  v_add_f32 v18, v18, v19
  v_add_f32 v20, v20, v21
  s_cmpk_gt_i32 s69, 0x13
  s_cbranch_scc1 L_p41_3
  s_cmp_gt_i32 s69, L_order_end-L_order-16421
  s_cbranch_scc1 L_p41_1
  s_waitcnt vmcnt(6)
L_p41_1:
  s_waitcnt vmcnt(10)
L_p41_3:
  s_waitcnt vmcnt(11)
  buffer_load_dwordx4 v[100:103], v227, s[32:35], s80 offen nt
  v_dot2_f32_bf16 v22, v173, v48, 0
  v_add_f32_dpp v21, v18, v18 row_ror:8 row_mask:0xf bank_mask:0xc
  v_add_f32_dpp v21, v20, v20 row_ror:8 row_mask:0xf bank_mask:0x3
  v_add_f32_dpp v20, v239, v239 row_half_mirror row_mask:0xf bank_mask:0x5
  v_dot2_f32_bf16 v23, v178, v49, 0
  v_add_f32_dpp v20, v21, v21 row_half_mirror row_mask:0xf bank_mask:0xa
  v_dot2_f32_bf16 v24, v176, v50, 0
  v_dot2_f32_bf16 v25, v179, v51, 0
  v_add_f32_dpp v20, v20, v20 quad_perm:[2,3,0,1] row_mask:0xf bank_mask:0xf
  v_cvt_f32_i32 v72, v72
  v_cvt_f32_i32 v73, v73
  v_add_f32_dpp v20, v20, v20 quad_perm:[1,0,3,2] row_mask:0xf bank_mask:0xf
  v_cndmask_b32_e64 v236, v236, v20, s[48:49]
  v_cvt_f32_i32 v74, v74
  v_cvt_f32_i32 v75, v75
  v_pk_mul_f32 v[20:21], v[72:73], v[22:23]
  v_pk_add_f32 v[18:19], v[22:23], v[24:25]
  v_pk_fma_f32 v[20:21], v[74:75], v[24:25], v[20:21]
  v_add_f32 v18, v18, v19
  v_add_f32 v20, v20, v21
  s_cmpk_gt_i32 s69, 0x13
  s_cbranch_scc1 L_p42_3
  s_cmp_gt_i32 s69, L_order_end-L_order-16391
  s_cbranch_scc1 L_p42_2
  s_waitcnt vmcnt(7)
L_p42_2:
  s_waitcnt vmcnt(11)
L_p42_3:
  s_waitcnt vmcnt(12)
  buffer_load_dwordx4 v[104:107], v226, s[32:35], s3 offen nt
  s_cmpk_gt_i32 s69, 0x13
  s_cbranch_scc1 L_p43_3
  s_cmp_gt_i32 s69, L_order_end-L_order-16445
  s_cbranch_scc1 L_p43_0
  s_waitcnt vmcnt(7)
L_p43_0:
  s_waitcnt vmcnt(8)
L_p43_3:
  s_waitcnt vmcnt(12)
  buffer_load_dwordx4 v[108:111], v227, s[32:35], s3 offen nt
L_it17:
  s_waitcnt lgkmcnt(0)
  ds_read_b128 v[40:43], v248 offset:512
  ds_read_b128 v[44:47], v250 offset:512
  ds_read_b128 v[48:51], v248 offset:1536
  s_waitcnt vmcnt(9)
  s_mov_b64 exec, 3
  s_add_u32 s44, s78, 0x03030303
  v_msad_u8 v9, s78, v36, 0
  v_msad_u8 v10, s44, v36, 0
  v_msad_u8 v9, s78, v37, v9
  v_msad_u8 v10, s44, v37, v10
  v_msad_u8 v9, s78, v38, v9
  v_msad_u8 v10, s44, v38, v10
  global_store_byte v7, v8, s[30:31]
  global_load_dwordx3 v[36:38], v233, s[30:31] sc1
  v_sub_u32 v9, v9, v10
  v_add_u32_e64 v8, 1, v8
  v_readlane_b32 s66, v9, 0
  v_readlane_b32 s67, v9, 1
  s_add_u32 s78, s78, 0x01010101
  s_mov_b64 exec, -1
  s_lshl1_add_u32 s69, s91, s95
  s_add_u32 s95, s66, s67
  s_add_u32 s69, s69, s95
  v_dot2_f32_bf16 v22, v177, v52, 0
  v_add_f32_dpp v240, v18, v18 row_ror:8 row_mask:0xf bank_mask:0xc
  v_add_f32_dpp v240, v20, v20 row_ror:8 row_mask:0xf bank_mask:0x3
  v_dot2_f32_bf16 v23, v182, v53, 0
  v_dot2_f32_bf16 v24, v180, v54, 0
  v_dot2_f32_bf16 v25, v183, v55, 0
  v_cvt_f32_i32 v76, v76
  v_cvt_f32_i32 v77, v77
  v_cvt_f32_i32 v78, v78
  v_cvt_f32_i32 v79, v79
  v_pk_mul_f32 v[20:21], v[76:77], v[22:23]
  v_pk_add_f32 v[18:19], v[22:23], v[24:25]
  v_pk_fma_f32 v[20:21], v[78:79], v[24:25], v[20:21]
  v_add_f32 v18, v18, v19
  v_add_f32 v20, v20, v21
  s_add_u32 m0, s100, 22528
  v_lshrrev_b32 v10, 1, v230
  v_add_u32 v10, v10, v246
  v_mad_u64_u32 v[30:31], s[64:65], v10, 1, v[28:29]
  global_load_lds_dwordx4 v[30:31], off
  v_dot2_f32_bf16 v22, v173, v56, 0
  v_add_f32_dpp v21, v18, v18 row_ror:8 row_mask:0xf bank_mask:0xc
  v_add_f32_dpp v21, v20, v20 row_ror:8 row_mask:0xf bank_mask:0x3
  v_add_f32_dpp v20, v240, v240 row_half_mirror row_mask:0xf bank_mask:0x5
  v_dot2_f32_bf16 v23, v178, v57, 0
  v_add_f32_dpp v20, v21, v21 row_half_mirror row_mask:0xf bank_mask:0xa
  v_dot2_f32_bf16 v24, v176, v58, 0
  v_dot2_f32_bf16 v25, v179, v59, 0
  v_add_f32_dpp v20, v20, v20 quad_perm:[2,3,0,1] row_mask:0xf bank_mask:0xf
  v_cvt_f32_i32 v80, v80
  v_cvt_f32_i32 v81, v81
  v_add_f32_dpp v20, v20, v20 quad_perm:[1,0,3,2] row_mask:0xf bank_mask:0xf
  v_cndmask_b32_e64 v237, v237, v20, s[48:49]
  v_cvt_f32_i32 v82, v82
  v_cvt_f32_i32 v83, v83
  v_pk_mul_f32 v[20:21], v[80:81], v[22:23]
  v_pk_add_f32 v[18:19], v[22:23], v[24:25]
  v_pk_fma_f32 v[20:21], v[82:83], v[24:25], v[20:21]
  v_add_f32 v18, v18, v19
  v_add_f32 v20, v20, v21
  s_cmpk_gt_i32 s69, 0x13
  s_cbranch_scc1 L_p44_3
  s_cmp_gt_i32 s69, L_order_end-L_order-16421
  s_cbranch_scc1 L_p44_1
  s_waitcnt vmcnt(6)
L_p44_1:
  s_waitcnt vmcnt(10)
L_p44_3:
  s_waitcnt vmcnt(11)
  buffer_load_dwordx4 v[64:67], v228, s[32:35], 0 offen nt
  ds_read_b64 v[184:185], v12 offset:18432
  ds_read_b64 v[186:187], v12 offset:18560
  ds_read_b64 v[188:189], v12 offset:19456
  ds_read_b64 v[190:191], v12 offset:19584
  v_dot2_f32_bf16 v22, v177, v60, 0
  v_add_f32_dpp v241, v18, v18 row_ror:8 row_mask:0xf bank_mask:0xc
  v_add_f32_dpp v241, v20, v20 row_ror:8 row_mask:0xf bank_mask:0x3
  v_dot2_f32_bf16 v23, v182, v61, 0
  v_dot2_f32_bf16 v24, v180, v62, 0
  v_dot2_f32_bf16 v25, v183, v63, 0
  v_cvt_f32_i32 v84, v84
  v_cvt_f32_i32 v85, v85
  v_cvt_f32_i32 v86, v86
  v_cvt_f32_i32 v87, v87
  v_pk_mul_f32 v[20:21], v[84:85], v[22:23]
  v_pk_add_f32 v[18:19], v[22:23], v[24:25]
  v_pk_fma_f32 v[20:21], v[86:87], v[24:25], v[20:21]
  v_add_f32 v18, v18, v19
  v_add_f32 v20, v20, v21
  s_cmpk_gt_i32 s69, 0x13
  s_cbranch_scc1 L_p45_3
  s_cmp_gt_i32 s69, L_order_end-L_order-16391
  s_cbranch_scc1 L_p45_2
  s_waitcnt vmcnt(7)
L_p45_2:
  s_waitcnt vmcnt(11)
L_p45_3:
  s_waitcnt vmcnt(12)
  buffer_load_dwordx4 v[68:71], v229, s[32:35], 0 offen nt
  s_cmpk_gt_i32 s69, 0x13
  s_cbranch_scc1 L_p46_3
  s_cmp_gt_i32 s69, L_order_end-L_order-16445
  s_cbranch_scc1 L_p46_0
  s_waitcnt vmcnt(7)
L_p46_0:
  s_waitcnt vmcnt(8)
L_p46_3:
  s_waitcnt vmcnt(12)
  buffer_load_dwordx4 v[72:75], v228, s[32:35], s80 offen nt
L_it18:
  s_waitcnt lgkmcnt(0)
  ds_read_b128 v[52:55], v250 offset:1536
  ds_read_b128 v[56:59], v248 offset:2560
  ds_read_b128 v[60:63], v250 offset:2560
  s_waitcnt vmcnt(9)
  s_mov_b64 exec, 3
  s_add_u32 s44, s78, 0x03030303
  v_msad_u8 v9, s78, v32, 0
  v_msad_u8 v10, s44, v32, 0
  v_msad_u8 v9, s78, v33, v9
  v_msad_u8 v10, s44, v33, v10
  v_msad_u8 v9, s78, v34, v9
  v_msad_u8 v10, s44, v34, v10
  global_store_byte v7, v8, s[30:31]
  global_load_dwordx3 v[32:34], v234, s[30:31] sc1
  v_sub_u32 v9, v9, v10
  v_add_u32_e64 v8, 1, v8
  v_readlane_b32 s66, v9, 0
  v_readlane_b32 s67, v9, 1
  s_add_u32 s78, s78, 0x01010101
  s_mov_b64 exec, -1
  s_lshl1_add_u32 s69, s91, s95
  s_add_u32 s95, s66, s67
  s_add_u32 s69, s69, s95
  v_perm_b32 v181, v186, v184, s56
  v_perm_b32 v186, v186, v184, s57
  v_perm_b32 v184, v187, v185, s56
  v_perm_b32 v187, v187, v185, s57
  v_dot2_f32_bf16 v22, v181, v40, 0
  v_add_f32_dpp v21, v18, v18 row_ror:8 row_mask:0xf bank_mask:0xc
  v_add_f32_dpp v21, v20, v20 row_ror:8 row_mask:0xf bank_mask:0x3
  v_add_f32_dpp v20, v241, v241 row_half_mirror row_mask:0xf bank_mask:0x5
  v_dot2_f32_bf16 v23, v186, v41, 0
  v_add_f32_dpp v20, v21, v21 row_half_mirror row_mask:0xf bank_mask:0xa
  v_dot2_f32_bf16 v24, v184, v42, 0
  v_dot2_f32_bf16 v25, v187, v43, 0
  v_add_f32_dpp v20, v20, v20 quad_perm:[2,3,0,1] row_mask:0xf bank_mask:0xf
  v_cvt_f32_i32 v88, v88
  v_cvt_f32_i32 v89, v89
  v_add_f32_dpp v20, v20, v20 quad_perm:[1,0,3,2] row_mask:0xf bank_mask:0xf
  v_cndmask_b32_e64 v238, v238, v20, s[48:49]
  v_cvt_f32_i32 v90, v90
  v_cvt_f32_i32 v91, v91
  v_pk_mul_f32 v[20:21], v[88:89], v[22:23]
  v_pk_add_f32 v[18:19], v[22:23], v[24:25]
  v_pk_fma_f32 v[20:21], v[90:91], v[24:25], v[20:21]
  v_add_f32 v18, v18, v19
  v_add_f32 v20, v20, v21
  s_add_u32 m0, s100, 23552
  v_lshrrev_b32 v10, 1, v231
  v_add_u32 v10, v10, v245
  v_mad_u64_u32 v[30:31], s[64:65], v10, 1, v[28:29]
  global_load_lds_dwordx4 v[30:31], off
  v_perm_b32 v185, v190, v188, s56
  v_perm_b32 v190, v190, v188, s57
  v_perm_b32 v188, v191, v189, s56
  v_perm_b32 v191, v191, v189, s57
  v_dot2_f32_bf16 v22, v185, v44, 0
  v_add_f32_dpp v239, v18, v18 row_ror:8 row_mask:0xf bank_mask:0xc
  v_add_f32_dpp v239, v20, v20 row_ror:8 row_mask:0xf bank_mask:0x3
  v_dot2_f32_bf16 v23, v190, v45, 0
  v_dot2_f32_bf16 v24, v188, v46, 0
  v_dot2_f32_bf16 v25, v191, v47, 0
  v_cvt_f32_i32 v92, v92
  v_cvt_f32_i32 v93, v93
  v_cvt_f32_i32 v94, v94
  v_cvt_f32_i32 v95, v95
  v_pk_mul_f32 v[20:21], v[92:93], v[22:23]
  v_pk_add_f32 v[18:19], v[22:23], v[24:25]
  v_pk_fma_f32 v[20:21], v[94:95], v[24:25], v[20:21]
  v_add_f32 v18, v18, v19
  v_add_f32 v20, v20, v21
  s_cmpk_gt_i32 s69, 0x13
  s_cbranch_scc1 L_p47_3
  s_cmp_gt_i32 s69, L_order_end-L_order-16421
  s_cbranch_scc1 L_p47_1
  s_waitcnt vmcnt(6)
L_p47_1:
  s_waitcnt vmcnt(10)
L_p47_3:
  s_waitcnt vmcnt(11)
  buffer_load_dwordx4 v[76:79], v229, s[32:35], s80 offen nt
  v_dot2_f32_bf16 v22, v181, v48, 0
  v_add_f32_dpp v21, v18, v18 row_ror:8 row_mask:0xf bank_mask:0xc
  v_add_f32_dpp v21, v20, v20 row_ror:8 row_mask:0xf bank_mask:0x3
  v_add_f32_dpp v20, v239, v239 row_half_mirror row_mask:0xf bank_mask:0x5
  v_dot2_f32_bf16 v23, v186, v49, 0
  v_add_f32_dpp v20, v21, v21 row_half_mirror row_mask:0xf bank_mask:0xa
  v_dot2_f32_bf16 v24, v184, v50, 0
  v_dot2_f32_bf16 v25, v187, v51, 0
  v_add_f32_dpp v20, v20, v20 quad_perm:[2,3,0,1] row_mask:0xf bank_mask:0xf
  v_cvt_f32_i32 v96, v96
  v_cvt_f32_i32 v97, v97
  v_add_f32_dpp v20, v20, v20 quad_perm:[1,0,3,2] row_mask:0xf bank_mask:0xf
  v_cndmask_b32_e64 v236, v236, v20, s[50:51]
  v_cvt_f32_i32 v98, v98
  v_cvt_f32_i32 v99, v99
  v_pk_mul_f32 v[20:21], v[96:97], v[22:23]
  v_pk_add_f32 v[18:19], v[22:23], v[24:25]
  v_pk_fma_f32 v[20:21], v[98:99], v[24:25], v[20:21]
  v_add_f32 v18, v18, v19
  v_add_f32 v20, v20, v21
  s_cmpk_gt_i32 s69, 0x13
  s_cbranch_scc1 L_p48_3
  s_cmp_gt_i32 s69, L_order_end-L_order-16391
  s_cbranch_scc1 L_p48_2
  s_waitcnt vmcnt(7)
L_p48_2:
  s_waitcnt vmcnt(11)
L_p48_3:
  s_waitcnt vmcnt(12)
  buffer_load_dwordx4 v[80:83], v228, s[32:35], s3 offen nt
  s_cmpk_gt_i32 s69, 0x13
  s_cbranch_scc1 L_p49_3
  s_cmp_gt_i32 s69, L_order_end-L_order-16445
  s_cbranch_scc1 L_p49_0
  s_waitcnt vmcnt(7)
L_p49_0:
  s_waitcnt vmcnt(8)
L_p49_3:
  s_waitcnt vmcnt(12)
  buffer_load_dwordx4 v[84:87], v229, s[32:35], s3 offen nt
L_it19:
  s_waitcnt lgkmcnt(0)
  ds_read_b128 v[40:43], v251 offset:512
  ds_read_b128 v[44:47], v253 offset:512
  ds_read_b128 v[48:51], v251 offset:1536
  s_waitcnt vmcnt(9)
  s_mov_b64 exec, 3
  s_add_u32 s44, s78, 0x03030303
  v_msad_u8 v9, s78, v36, 0
  v_msad_u8 v10, s44, v36, 0
  v_msad_u8 v9, s78, v37, v9
  v_msad_u8 v10, s44, v37, v10
  v_msad_u8 v9, s78, v38, v9
  v_msad_u8 v10, s44, v38, v10
  global_store_byte v7, v8, s[30:31]
  global_load_dwordx3 v[36:38], v235, s[30:31] sc1
  v_sub_u32 v9, v9, v10
  v_add_u32_e64 v8, 1, v8
  v_readlane_b32 s66, v9, 0
  v_readlane_b32 s67, v9, 1
  s_add_u32 s78, s78, 0x01010101
  s_mov_b64 exec, -1
  s_lshl1_add_u32 s69, s91, s95
  s_add_u32 s95, s66, s67
  s_add_u32 s69, s69, s95
  v_dot2_f32_bf16 v22, v185, v52, 0
  v_add_f32_dpp v240, v18, v18 row_ror:8 row_mask:0xf bank_mask:0xc
  v_add_f32_dpp v240, v20, v20 row_ror:8 row_mask:0xf bank_mask:0x3
  v_dot2_f32_bf16 v23, v190, v53, 0
  v_dot2_f32_bf16 v24, v188, v54, 0
  v_dot2_f32_bf16 v25, v191, v55, 0
  v_cvt_f32_i32 v100, v100
  v_cvt_f32_i32 v101, v101
  v_cvt_f32_i32 v102, v102
  v_cvt_f32_i32 v103, v103
  v_pk_mul_f32 v[20:21], v[100:101], v[22:23]
  v_pk_add_f32 v[18:19], v[22:23], v[24:25]
  v_pk_fma_f32 v[20:21], v[102:103], v[24:25], v[20:21]
  v_add_f32 v18, v18, v19
  v_add_f32 v20, v20, v21
  v_dot2_f32_bf16 v22, v181, v56, 0
  v_add_f32_dpp v21, v18, v18 row_ror:8 row_mask:0xf bank_mask:0xc
  v_add_f32_dpp v21, v20, v20 row_ror:8 row_mask:0xf bank_mask:0x3
  v_add_f32_dpp v20, v240, v240 row_half_mirror row_mask:0xf bank_mask:0x5
  v_dot2_f32_bf16 v23, v186, v57, 0
  v_add_f32_dpp v20, v21, v21 row_half_mirror row_mask:0xf bank_mask:0xa
  v_dot2_f32_bf16 v24, v184, v58, 0
  v_dot2_f32_bf16 v25, v187, v59, 0
  v_add_f32_dpp v20, v20, v20 quad_perm:[2,3,0,1] row_mask:0xf bank_mask:0xf
  v_cvt_f32_i32 v104, v104
  v_cvt_f32_i32 v105, v105
  v_add_f32_dpp v20, v20, v20 quad_perm:[1,0,3,2] row_mask:0xf bank_mask:0xf
  v_cndmask_b32_e64 v237, v237, v20, s[50:51]
  v_cvt_f32_i32 v106, v106
  v_cvt_f32_i32 v107, v107
  v_pk_mul_f32 v[20:21], v[104:105], v[22:23]
  v_pk_add_f32 v[18:19], v[22:23], v[24:25]
  v_pk_fma_f32 v[20:21], v[106:107], v[24:25], v[20:21]
  v_add_f32 v18, v18, v19
  v_add_f32 v20, v20, v21
  s_cmpk_gt_i32 s69, 0x13
  s_cbranch_scc1 L_p50_3
  s_cmp_gt_i32 s69, L_order_end-L_order-16421
  s_cbranch_scc1 L_p50_1
  s_waitcnt vmcnt(5)
L_p50_1:
  s_waitcnt vmcnt(9)
L_p50_3:
  s_waitcnt vmcnt(10)
  buffer_load_dwordx4 v[88:91], v230, s[32:35], 0 offen nt
  ds_read_b64 v[192:193], v12 offset:20480
  ds_read_b64 v[194:195], v12 offset:20608
  ds_read_b64 v[196:197], v12 offset:21504
  ds_read_b64 v[198:199], v12 offset:21632
  v_dot2_f32_bf16 v22, v185, v60, 0
  v_add_f32_dpp v241, v18, v18 row_ror:8 row_mask:0xf bank_mask:0xc
  v_add_f32_dpp v241, v20, v20 row_ror:8 row_mask:0xf bank_mask:0x3
  v_dot2_f32_bf16 v23, v190, v61, 0
  v_dot2_f32_bf16 v24, v188, v62, 0
  v_dot2_f32_bf16 v25, v191, v63, 0
  v_cvt_f32_i32 v108, v108
  v_cvt_f32_i32 v109, v109
  v_cvt_f32_i32 v110, v110
  v_cvt_f32_i32 v111, v111
  v_pk_mul_f32 v[20:21], v[108:109], v[22:23]
  v_pk_add_f32 v[18:19], v[22:23], v[24:25]
  v_pk_fma_f32 v[20:21], v[110:111], v[24:25], v[20:21]
  v_add_f32 v18, v18, v19
  v_add_f32 v20, v20, v21
  s_cmpk_gt_i32 s69, 0x13
  s_cbranch_scc1 L_p51_3
  s_cmp_gt_i32 s69, L_order_end-L_order-16391
  s_cbranch_scc1 L_p51_2
  s_waitcnt vmcnt(6)
L_p51_2:
  s_waitcnt vmcnt(10)
L_p51_3:
  s_waitcnt vmcnt(11)
  buffer_load_dwordx4 v[92:95], v231, s[32:35], 0 offen nt
  s_cmpk_gt_i32 s69, 0x13
  s_cbranch_scc1 L_p52_3
  s_cmp_gt_i32 s69, L_order_end-L_order-16445
  s_cbranch_scc1 L_p52_0
  s_waitcnt vmcnt(6)
L_p52_0:
  s_waitcnt vmcnt(7)
L_p52_3:
  s_waitcnt vmcnt(11)
  buffer_load_dwordx4 v[96:99], v230, s[32:35], s80 offen nt
L_it20:
  s_waitcnt lgkmcnt(0)
  ds_read_b128 v[52:55], v253 offset:1536
  ds_read_b128 v[56:59], v251 offset:2560
  ds_read_b128 v[60:63], v253 offset:2560
  s_waitcnt vmcnt(8)
  s_mov_b64 exec, 3
  s_add_u32 s44, s78, 0x03030303
  v_msad_u8 v9, s78, v32, 0
  v_msad_u8 v10, s44, v32, 0
  v_msad_u8 v9, s78, v33, v9
  v_msad_u8 v10, s44, v33, v10
  v_msad_u8 v9, s78, v34, v9
  v_msad_u8 v10, s44, v34, v10
  global_store_byte v7, v8, s[30:31]
  global_load_dwordx3 v[32:34], v232, s[30:31] sc1
  v_sub_u32 v9, v9, v10
  v_add_u32_e64 v8, 1, v8
  v_readlane_b32 s66, v9, 0
  v_readlane_b32 s67, v9, 1
  s_add_u32 s78, s78, 0x01010101
  s_mov_b64 exec, -1
  s_lshl1_add_u32 s69, s91, s95
  s_add_u32 s95, s66, s67
  s_add_u32 s69, s69, s95
  v_perm_b32 v189, v194, v192, s56
  v_perm_b32 v194, v194, v192, s57
  v_perm_b32 v192, v195, v193, s56
  v_perm_b32 v195, v195, v193, s57
  v_dot2_f32_bf16 v22, v189, v40, 0
  v_add_f32_dpp v21, v18, v18 row_ror:8 row_mask:0xf bank_mask:0xc
  v_add_f32_dpp v21, v20, v20 row_ror:8 row_mask:0xf bank_mask:0x3
  v_add_f32_dpp v20, v241, v241 row_half_mirror row_mask:0xf bank_mask:0x5
  v_dot2_f32_bf16 v23, v194, v41, 0
  v_add_f32_dpp v20, v21, v21 row_half_mirror row_mask:0xf bank_mask:0xa
  v_dot2_f32_bf16 v24, v192, v42, 0
  v_dot2_f32_bf16 v25, v195, v43, 0
  v_add_f32_dpp v20, v20, v20 quad_perm:[2,3,0,1] row_mask:0xf bank_mask:0xf
  v_cvt_f32_i32 v64, v64
  v_cvt_f32_i32 v65, v65
  v_add_f32_dpp v20, v20, v20 quad_perm:[1,0,3,2] row_mask:0xf bank_mask:0xf
  v_cndmask_b32_e64 v238, v238, v20, s[50:51]
  v_cvt_f32_i32 v66, v66
  v_cvt_f32_i32 v67, v67
  v_pk_mul_f32 v[20:21], v[64:65], v[22:23]
  v_pk_add_f32 v[18:19], v[22:23], v[24:25]
  v_pk_fma_f32 v[20:21], v[66:67], v[24:25], v[20:21]
  v_add_f32 v18, v18, v19
  v_add_f32 v20, v20, v21
  v_perm_b32 v193, v198, v196, s56
  v_perm_b32 v198, v198, v196, s57
  v_perm_b32 v196, v199, v197, s56
  v_perm_b32 v199, v199, v197, s57
  v_dot2_f32_bf16 v22, v193, v44, 0
  v_add_f32_dpp v239, v18, v18 row_ror:8 row_mask:0xf bank_mask:0xc
  v_add_f32_dpp v239, v20, v20 row_ror:8 row_mask:0xf bank_mask:0x3
  v_dot2_f32_bf16 v23, v198, v45, 0
  v_dot2_f32_bf16 v24, v196, v46, 0
  v_dot2_f32_bf16 v25, v199, v47, 0
  v_cvt_f32_i32 v68, v68
  v_cvt_f32_i32 v69, v69
  v_cvt_f32_i32 v70, v70
  v_cvt_f32_i32 v71, v71
  v_pk_mul_f32 v[20:21], v[68:69], v[22:23]
  v_pk_add_f32 v[18:19], v[22:23], v[24:25]
  v_pk_fma_f32 v[20:21], v[70:71], v[24:25], v[20:21]
  v_add_f32 v18, v18, v19
  v_add_f32 v20, v20, v21
  s_cmpk_gt_i32 s69, 0x13
  s_cbranch_scc1 L_p53_3
  s_cmp_gt_i32 s69, L_order_end-L_order-16421
  s_cbranch_scc1 L_p53_1
  s_waitcnt vmcnt(5)
L_p53_1:
  s_waitcnt vmcnt(8)
L_p53_3:
  s_waitcnt vmcnt(9)
  buffer_load_dwordx4 v[100:103], v231, s[32:35], s80 offen nt
  v_dot2_f32_bf16 v22, v189, v48, 0
  v_add_f32_dpp v21, v18, v18 row_ror:8 row_mask:0xf bank_mask:0xc
  v_add_f32_dpp v21, v20, v20 row_ror:8 row_mask:0xf bank_mask:0x3
  v_add_f32_dpp v20, v239, v239 row_half_mirror row_mask:0xf bank_mask:0x5
  v_dot2_f32_bf16 v23, v194, v49, 0
  v_add_f32_dpp v20, v21, v21 row_half_mirror row_mask:0xf bank_mask:0xa
  v_dot2_f32_bf16 v24, v192, v50, 0
  v_dot2_f32_bf16 v25, v195, v51, 0
  v_add_f32_dpp v20, v20, v20 quad_perm:[2,3,0,1] row_mask:0xf bank_mask:0xf
  v_cvt_f32_i32 v72, v72
  v_cvt_f32_i32 v73, v73
  v_add_f32_dpp v20, v20, v20 quad_perm:[1,0,3,2] row_mask:0xf bank_mask:0xf
  v_cndmask_b32_e64 v236, v236, v20, s[52:53]
  v_cvt_f32_i32 v74, v74
  v_cvt_f32_i32 v75, v75
  v_pk_mul_f32 v[20:21], v[72:73], v[22:23]
  v_pk_add_f32 v[18:19], v[22:23], v[24:25]
  v_pk_fma_f32 v[20:21], v[74:75], v[24:25], v[20:21]
  v_add_f32 v18, v18, v19
  v_add_f32 v20, v20, v21
  s_cmpk_gt_i32 s69, 0x13
  s_cbranch_scc1 L_p54_3
  s_cmp_gt_i32 s69, L_order_end-L_order-16391
  s_cbranch_scc1 L_p54_2
  s_waitcnt vmcnt(6)
L_p54_2:
  s_waitcnt vmcnt(9)
L_p54_3:
  s_waitcnt vmcnt(10)
  buffer_load_dwordx4 v[104:107], v230, s[32:35], s3 offen nt
  s_cmpk_gt_i32 s69, 0x13
  s_cbranch_scc1 L_p55_3
  s_cmp_gt_i32 s69, L_order_end-L_order-16445
  s_cbranch_scc1 L_p55_0
  s_waitcnt vmcnt(6)
L_p55_0:
  s_waitcnt vmcnt(7)
L_p55_3:
  s_waitcnt vmcnt(10)
  buffer_load_dwordx4 v[108:111], v231, s[32:35], s3 offen nt
L_it21:
  s_waitcnt lgkmcnt(0)
  ds_read_b128 v[40:43], v252 offset:512
  ds_read_b128 v[44:47], v251 offset:512
  ds_read_b128 v[48:51], v252 offset:1536
  s_waitcnt vmcnt(7)
  s_mov_b64 exec, 3
  s_add_u32 s44, s78, 0x03030303
  v_msad_u8 v9, s78, v36, 0
  v_msad_u8 v10, s44, v36, 0
  v_msad_u8 v9, s78, v37, v9
  v_msad_u8 v10, s44, v37, v10
  v_msad_u8 v9, s78, v38, v9
  v_msad_u8 v10, s44, v38, v10
  global_load_dwordx2 v[26:27], v11, s[30:31] sc1
  global_store_byte v7, v8, s[30:31]
  global_load_dwordx3 v[36:38], v233, s[30:31] sc1
  v_sub_u32 v9, v9, v10
  v_add_u32_e64 v8, 1, v8
  v_readlane_b32 s66, v9, 0
  v_readlane_b32 s67, v9, 1
  s_add_u32 s78, s78, 0x01010101
  s_mov_b64 exec, -1
  s_lshl1_add_u32 s69, s91, s95
  s_add_u32 s95, s66, s67
  s_add_u32 s69, s69, s95
  v_dot2_f32_bf16 v22, v193, v52, 0
  v_add_f32_dpp v240, v18, v18 row_ror:8 row_mask:0xf bank_mask:0xc
  v_add_f32_dpp v240, v20, v20 row_ror:8 row_mask:0xf bank_mask:0x3
  v_dot2_f32_bf16 v23, v198, v53, 0
  v_dot2_f32_bf16 v24, v196, v54, 0
  v_dot2_f32_bf16 v25, v199, v55, 0
  v_cvt_f32_i32 v76, v76
  v_cvt_f32_i32 v77, v77
  v_cvt_f32_i32 v78, v78
  v_cvt_f32_i32 v79, v79
  v_pk_mul_f32 v[20:21], v[76:77], v[22:23]
  v_pk_add_f32 v[18:19], v[22:23], v[24:25]
  v_pk_fma_f32 v[20:21], v[78:79], v[24:25], v[20:21]
  v_add_f32 v18, v18, v19
  v_add_f32 v20, v20, v21
  v_dot2_f32_bf16 v22, v189, v56, 0
  v_add_f32_dpp v21, v18, v18 row_ror:8 row_mask:0xf bank_mask:0xc
  v_add_f32_dpp v21, v20, v20 row_ror:8 row_mask:0xf bank_mask:0x3
  v_add_f32_dpp v20, v240, v240 row_half_mirror row_mask:0xf bank_mask:0x5
  v_dot2_f32_bf16 v23, v194, v57, 0
  v_add_f32_dpp v20, v21, v21 row_half_mirror row_mask:0xf bank_mask:0xa
  v_dot2_f32_bf16 v24, v192, v58, 0
  v_dot2_f32_bf16 v25, v195, v59, 0
  v_add_f32_dpp v20, v20, v20 quad_perm:[2,3,0,1] row_mask:0xf bank_mask:0xf
  v_cvt_f32_i32 v80, v80
  v_cvt_f32_i32 v81, v81
  v_add_f32_dpp v20, v20, v20 quad_perm:[1,0,3,2] row_mask:0xf bank_mask:0xf
  v_cndmask_b32_e64 v237, v237, v20, s[52:53]
  v_cvt_f32_i32 v82, v82
  v_cvt_f32_i32 v83, v83
  v_pk_mul_f32 v[20:21], v[80:81], v[22:23]
  v_pk_add_f32 v[18:19], v[22:23], v[24:25]
  v_pk_fma_f32 v[20:21], v[82:83], v[24:25], v[20:21]
  v_add_f32 v18, v18, v19
  v_add_f32 v20, v20, v21
  s_cmpk_gt_i32 s69, 0x13
  s_cbranch_scc1 L_p56_3
  s_cmp_gt_i32 s69, L_order_end-L_order-16421
  s_cbranch_scc1 L_p56_1
  s_waitcnt vmcnt(6)
L_p56_1:
  s_waitcnt vmcnt(9)
L_p56_3:
  s_waitcnt vmcnt(10)
  buffer_load_dwordx4 v[64:67], v208, s[32:35], s98 offen nt
  ds_read_b64 v[200:201], v12 offset:22528
  ds_read_b64 v[202:203], v12 offset:22656
  ds_read_b64 v[204:205], v12 offset:23552
  ds_read_b64 v[206:207], v12 offset:23680
  v_dot2_f32_bf16 v22, v193, v60, 0
  v_add_f32_dpp v241, v18, v18 row_ror:8 row_mask:0xf bank_mask:0xc
  v_add_f32_dpp v241, v20, v20 row_ror:8 row_mask:0xf bank_mask:0x3
  v_dot2_f32_bf16 v23, v198, v61, 0
  v_dot2_f32_bf16 v24, v196, v62, 0
  v_dot2_f32_bf16 v25, v199, v63, 0
  v_cvt_f32_i32 v84, v84
  v_cvt_f32_i32 v85, v85
  v_cvt_f32_i32 v86, v86
  v_cvt_f32_i32 v87, v87
  v_pk_mul_f32 v[20:21], v[84:85], v[22:23]
  v_pk_add_f32 v[18:19], v[22:23], v[24:25]
  v_pk_fma_f32 v[20:21], v[86:87], v[24:25], v[20:21]
  v_add_f32 v18, v18, v19
  v_add_f32 v20, v20, v21
  s_cmpk_gt_i32 s69, 0x13
  s_cbranch_scc1 L_p57_3
  s_cmp_gt_i32 s69, L_order_end-L_order-16391
  s_cbranch_scc1 L_p57_2
  s_waitcnt vmcnt(7)
L_p57_2:
  s_waitcnt vmcnt(10)
L_p57_3:
  s_waitcnt vmcnt(11)
  buffer_load_dwordx4 v[68:71], v209, s[32:35], s98 offen nt
  s_cmpk_gt_i32 s69, 0x13
  s_cbranch_scc1 L_p58_3
  s_cmp_gt_i32 s69, L_order_end-L_order-16445
  s_cbranch_scc1 L_p58_0
  s_waitcnt vmcnt(7)
L_p58_0:
  s_waitcnt vmcnt(8)
L_p58_3:
  s_waitcnt vmcnt(11)
  buffer_load_dwordx4 v[72:75], v210, s[32:35], s98 offen nt
L_it22:
  s_waitcnt lgkmcnt(0)
  ds_read_b128 v[52:55], v251 offset:1536
  ds_read_b128 v[56:59], v252 offset:2560
  ds_read_b128 v[60:63], v251 offset:2560
  ds_read_b32 v4, v14 offset:16
  s_waitcnt vmcnt(8)
  s_mov_b64 exec, 3
  s_add_u32 s44, s78, 0x03030303
  v_msad_u8 v9, s78, v32, 0
  v_msad_u8 v10, s44, v32, 0
  v_msad_u8 v9, s78, v33, v9
  v_msad_u8 v10, s44, v33, v10
  v_msad_u8 v9, s78, v34, v9
  v_msad_u8 v10, s44, v34, v10
  global_store_byte v7, v8, s[30:31]
  global_load_dwordx3 v[32:34], v234, s[30:31] sc1
  v_sub_u32 v9, v9, v10
  v_add_u32_e64 v8, 1, v8
  v_readlane_b32 s66, v9, 0
  v_readlane_b32 s67, v9, 1
  s_add_u32 s78, s78, 0x01010101
  s_mov_b64 exec, -1
  s_lshl1_add_u32 s69, s91, s95
  s_add_u32 s95, s66, s67
  s_add_u32 s69, s69, s95
  v_perm_b32 v197, v202, v200, s56
  v_perm_b32 v202, v202, v200, s57
  v_perm_b32 v200, v203, v201, s56
  v_perm_b32 v203, v203, v201, s57
  v_dot2_f32_bf16 v22, v197, v40, 0
  v_add_f32_dpp v21, v18, v18 row_ror:8 row_mask:0xf bank_mask:0xc
  v_add_f32_dpp v21, v20, v20 row_ror:8 row_mask:0xf bank_mask:0x3
  v_add_f32_dpp v20, v241, v241 row_half_mirror row_mask:0xf bank_mask:0x5
  v_dot2_f32_bf16 v23, v202, v41, 0
  v_add_f32_dpp v20, v21, v21 row_half_mirror row_mask:0xf bank_mask:0xa
  v_dot2_f32_bf16 v24, v200, v42, 0
  v_dot2_f32_bf16 v25, v203, v43, 0
  v_add_f32_dpp v20, v20, v20 quad_perm:[2,3,0,1] row_mask:0xf bank_mask:0xf
  v_cvt_f32_i32 v88, v88
  v_cvt_f32_i32 v89, v89
  v_add_f32_dpp v20, v20, v20 quad_perm:[1,0,3,2] row_mask:0xf bank_mask:0xf
  v_cndmask_b32_e64 v238, v238, v20, s[52:53]
  v_cvt_f32_i32 v90, v90
  v_cvt_f32_i32 v91, v91
  v_pk_mul_f32 v[20:21], v[88:89], v[22:23]
  v_pk_add_f32 v[18:19], v[22:23], v[24:25]
  v_pk_fma_f32 v[20:21], v[90:91], v[24:25], v[20:21]
  v_add_f32 v18, v18, v19
  v_add_f32 v20, v20, v21
  v_perm_b32 v201, v206, v204, s56
  v_perm_b32 v206, v206, v204, s57
  v_perm_b32 v204, v207, v205, s56
  v_perm_b32 v207, v207, v205, s57
  v_dot2_f32_bf16 v22, v201, v44, 0
  v_add_f32_dpp v239, v18, v18 row_ror:8 row_mask:0xf bank_mask:0xc
  v_add_f32_dpp v239, v20, v20 row_ror:8 row_mask:0xf bank_mask:0x3
  v_dot2_f32_bf16 v23, v206, v45, 0
  v_dot2_f32_bf16 v24, v204, v46, 0
  v_dot2_f32_bf16 v25, v207, v47, 0
  v_cvt_f32_i32 v92, v92
  v_cvt_f32_i32 v93, v93
  v_cvt_f32_i32 v94, v94
  v_cvt_f32_i32 v95, v95
  v_pk_mul_f32 v[20:21], v[92:93], v[22:23]
  v_pk_add_f32 v[18:19], v[22:23], v[24:25]
  v_pk_fma_f32 v[20:21], v[94:95], v[24:25], v[20:21]
  v_add_f32 v18, v18, v19
  v_add_f32 v20, v20, v21
  s_cmpk_gt_i32 s69, 0x13
  s_cbranch_scc1 L_p59_3
  s_cmp_gt_i32 s69, L_order_end-L_order-16421
  s_cbranch_scc1 L_p59_1
  s_waitcnt vmcnt(5)
L_p59_1:
  s_waitcnt vmcnt(9)
L_p59_3:
  s_waitcnt vmcnt(10)
  buffer_load_dwordx4 v[76:79], v211, s[32:35], s98 offen nt
  v_dot2_f32_bf16 v22, v197, v48, 0
  v_add_f32_dpp v21, v18, v18 row_ror:8 row_mask:0xf bank_mask:0xc
  v_add_f32_dpp v21, v20, v20 row_ror:8 row_mask:0xf bank_mask:0x3
  v_add_f32_dpp v20, v239, v239 row_half_mirror row_mask:0xf bank_mask:0x5
  v_dot2_f32_bf16 v23, v202, v49, 0
  v_add_f32_dpp v20, v21, v21 row_half_mirror row_mask:0xf bank_mask:0xa
  v_dot2_f32_bf16 v24, v200, v50, 0
  v_dot2_f32_bf16 v25, v203, v51, 0
  v_add_f32_dpp v20, v20, v20 quad_perm:[2,3,0,1] row_mask:0xf bank_mask:0xf
  v_cvt_f32_i32 v96, v96
  v_cvt_f32_i32 v97, v97
  v_add_f32_dpp v20, v20, v20 quad_perm:[1,0,3,2] row_mask:0xf bank_mask:0xf
  v_cndmask_b32_e64 v236, v236, v20, s[54:55]
  ds_write_b32 v17, v236 offset:0
  v_cvt_f32_i32 v98, v98
  v_cvt_f32_i32 v99, v99
  v_pk_mul_f32 v[20:21], v[96:97], v[22:23]
  v_pk_add_f32 v[18:19], v[22:23], v[24:25]
  v_pk_fma_f32 v[20:21], v[98:99], v[24:25], v[20:21]
  v_add_f32 v18, v18, v19
  v_add_f32 v20, v20, v21
  s_cmpk_gt_i32 s69, 0x13
  s_cbranch_scc1 L_p60_3
  s_cmp_gt_i32 s69, L_order_end-L_order-16391
  s_cbranch_scc1 L_p60_2
  s_waitcnt vmcnt(6)
L_p60_2:
  s_waitcnt vmcnt(10)
L_p60_3:
  s_waitcnt vmcnt(11)
  buffer_load_dwordx4 v[80:83], v212, s[32:35], s98 offen nt
  s_cmpk_gt_i32 s69, 0x13
  s_cbranch_scc1 L_p61_3
  s_cmp_gt_i32 s69, L_order_end-L_order-16445
  s_cbranch_scc1 L_p61_0
  s_waitcnt vmcnt(6)
L_p61_0:
  s_waitcnt vmcnt(7)
L_p61_3:
  s_waitcnt vmcnt(11)
  buffer_load_dwordx4 v[84:87], v213, s[32:35], s98 offen nt
L_it23:
  s_mov_b32 s47, 4
L_fq23:
  s_waitcnt lgkmcnt(0)
  v_readfirstlane_b32 s46, v4
  s_cmp_ge_u32 s46, s47
  s_cbranch_scc1 L_fq23_ok
  s_cmp_eq_u32 s94, 0
  s_cbranch_scc1 L_fq23_ok
  s_sub_u32 s94, s94, 1
  ds_read_b32 v4, v14 offset:16
  s_branch L_fq23
L_fq23_ok:
  ds_read_b128 v[40:43], v248 offset:3584
  ds_read_b128 v[44:47], v249 offset:3584
  ds_read_b128 v[48:51], v250 offset:3584
  s_waitcnt vmcnt(7)
  s_mov_b64 exec, 3
  s_add_u32 s44, s78, 0x03030303
  v_msad_u8 v9, s78, v36, 0
  v_msad_u8 v10, s44, v36, 0
  v_msad_u8 v9, s78, v37, v9
  v_msad_u8 v10, s44, v37, v10
  v_msad_u8 v9, s78, v38, v9
  v_msad_u8 v10, s44, v38, v10
  global_store_byte v7, v8, s[30:31]
  global_load_dwordx3 v[36:38], v235, s[30:31] sc1
  v_sub_u32 v9, v9, v10
  v_add_u32_e64 v8, 1, v8
  v_add3_u32 v10, v26, v27, s58
  v_readlane_b32 s66, v9, 0
  v_readlane_b32 s67, v9, 1
  v_readlane_b32 s91, v10, 0
  s_add_u32 s78, s78, 0x01010101
  s_mov_b64 exec, -1
  s_lshl1_add_u32 s69, s91, s95
  s_add_u32 s95, s66, s67
  s_add_u32 s69, s69, s95
  v_dot2_f32_bf16 v22, v201, v52, 0
  v_add_f32_dpp v240, v18, v18 row_ror:8 row_mask:0xf bank_mask:0xc
  v_add_f32_dpp v240, v20, v20 row_ror:8 row_mask:0xf bank_mask:0x3
  v_dot2_f32_bf16 v23, v206, v53, 0
  v_dot2_f32_bf16 v24, v204, v54, 0
  v_dot2_f32_bf16 v25, v207, v55, 0
  v_cvt_f32_i32 v100, v100
  v_cvt_f32_i32 v101, v101
  v_cvt_f32_i32 v102, v102
  v_cvt_f32_i32 v103, v103
  v_pk_mul_f32 v[20:21], v[100:101], v[22:23]
  v_pk_add_f32 v[18:19], v[22:23], v[24:25]
  v_pk_fma_f32 v[20:21], v[102:103], v[24:25], v[20:21]
  v_add_f32 v18, v18, v19
  v_add_f32 v20, v20, v21
  v_dot2_f32_bf16 v22, v197, v56, 0
  v_add_f32_dpp v21, v18, v18 row_ror:8 row_mask:0xf bank_mask:0xc
  v_add_f32_dpp v21, v20, v20 row_ror:8 row_mask:0xf bank_mask:0x3
  v_add_f32_dpp v20, v240, v240 row_half_mirror row_mask:0xf bank_mask:0x5
  v_dot2_f32_bf16 v23, v202, v57, 0
  v_add_f32_dpp v20, v21, v21 row_half_mirror row_mask:0xf bank_mask:0xa
  v_dot2_f32_bf16 v24, v200, v58, 0
  v_dot2_f32_bf16 v25, v203, v59, 0
  v_add_f32_dpp v20, v20, v20 quad_perm:[2,3,0,1] row_mask:0xf bank_mask:0xf
  v_cvt_f32_i32 v104, v104
  v_cvt_f32_i32 v105, v105
  v_add_f32_dpp v20, v20, v20 quad_perm:[1,0,3,2] row_mask:0xf bank_mask:0xf
  v_cndmask_b32_e64 v237, v237, v20, s[54:55]
  ds_write_b32 v17, v237 offset:3072
  v_cvt_f32_i32 v106, v106
  v_cvt_f32_i32 v107, v107
  v_pk_mul_f32 v[20:21], v[104:105], v[22:23]
  v_pk_add_f32 v[18:19], v[22:23], v[24:25]
  v_pk_fma_f32 v[20:21], v[106:107], v[24:25], v[20:21]
  v_add_f32 v18, v18, v19
  v_add_f32 v20, v20, v21
  s_cmpk_gt_i32 s69, 0x13
  s_cbranch_scc1 L_p62_3
  s_cmp_gt_i32 s69, L_order_end-L_order-16421
  s_cbranch_scc1 L_p62_1
  s_waitcnt vmcnt(5)
L_p62_1:
  s_waitcnt vmcnt(8)
L_p62_3:
  s_waitcnt vmcnt(9)
  buffer_load_dwordx4 v[88:91], v214, s[32:35], s98 offen nt
  v_dot2_f32_bf16 v22, v201, v60, 0
  v_add_f32_dpp v241, v18, v18 row_ror:8 row_mask:0xf bank_mask:0xc
  v_add_f32_dpp v241, v20, v20 row_ror:8 row_mask:0xf bank_mask:0x3
  v_dot2_f32_bf16 v23, v206, v61, 0
  v_dot2_f32_bf16 v24, v204, v62, 0
  v_dot2_f32_bf16 v25, v207, v63, 0
  v_cvt_f32_i32 v108, v108
  v_cvt_f32_i32 v109, v109
  v_cvt_f32_i32 v110, v110
  v_cvt_f32_i32 v111, v111
  v_pk_mul_f32 v[20:21], v[108:109], v[22:23]
  v_pk_add_f32 v[18:19], v[22:23], v[24:25]
  v_pk_fma_f32 v[20:21], v[110:111], v[24:25], v[20:21]
  v_add_f32 v18, v18, v19
  v_add_f32 v20, v20, v21
  s_cmpk_gt_i32 s69, 0x13
  s_cbranch_scc1 L_p63_3
  s_cmp_gt_i32 s69, L_order_end-L_order-16391
  s_cbranch_scc1 L_p63_2
  s_waitcnt vmcnt(6)
L_p63_2:
  s_waitcnt vmcnt(9)
L_p63_3:
  s_waitcnt vmcnt(10)
  buffer_load_dwordx4 v[92:95], v215, s[32:35], s98 offen nt
  s_cmpk_gt_i32 s69, 0x13
  s_cbranch_scc1 L_p64_3
  s_cmp_gt_i32 s69, L_order_end-L_order-16445
  s_cbranch_scc1 L_p64_0
  s_waitcnt vmcnt(6)
L_p64_0:
  s_waitcnt vmcnt(7)
L_p64_3:
  s_waitcnt vmcnt(10)
  buffer_load_dwordx4 v[96:99], v216, s[32:35], s98 offen nt
  s_nop 0
  v_add_f32_dpp v21, v18, v18 row_ror:8 row_mask:0xf bank_mask:0xc
  v_add_f32_dpp v21, v20, v20 row_ror:8 row_mask:0xf bank_mask:0x3
  v_add_f32_dpp v20, v241, v241 row_half_mirror row_mask:0xf bank_mask:0x5
  s_nop 0
  v_add_f32_dpp v20, v21, v21 row_half_mirror row_mask:0xf bank_mask:0xa
  s_nop 1
  v_add_f32_dpp v20, v20, v20 quad_perm:[2,3,0,1] row_mask:0xf bank_mask:0xf
  s_nop 1
  v_add_f32_dpp v20, v20, v20 quad_perm:[1,0,3,2] row_mask:0xf bank_mask:0xf
  v_cndmask_b32_e64 v238, v238, v20, s[54:55]
  ds_write_b32 v17, v238 offset:6144
  v_mov_b32_e64 v9, 3
  ds_write_b32 v6, v9 offset:0
  ds_read_b128 v[52:55], v251 offset:3584
  ds_read_b128 v[56:59], v252 offset:3584
  ds_read_b128 v[60:63], v253 offset:3584
  s_movk_i32 s59, 3072
  s_mov_b32 s43, 3
  s_movk_i32 s101, 9216
  s_mov_b32 s34, 1572864
  s_add_u32 s32, s32, s98
  s_addc_u32 s33, s33, 0
  s_mov_b32 s68, 4
  s_lshl_b32 s44, s68, 2
  s_lshr_b64 s[64:65], s[96:97], s44
  s_and_b32 s64, s64, 15
  s_lshl4_add_u32 s68, s68, s64
  s_mul_i32 s44, s68, 1572864
  s_add_u32 s36, s6, s44
  s_addc_u32 s37, s7, 0
.p2align 6
L_k:
  s_add_u32 s44, s43, 2
  s_min_u32 s47, s44, 16
  s_addk_i32 s59, 1024
  s_cmpk_eq_u32 s59, 4096
  s_cselect_b32 s59, 0, s59
  s_waitcnt lgkmcnt(0)
  s_waitcnt vmcnt(8)
  s_mov_b64 exec, 3
  s_add_u32 s44, s78, 0x03030303
  v_msad_u8 v9, s78, v32, 0
  v_msad_u8 v10, s44, v32, 0
  v_msad_u8 v9, s78, v33, v9
  v_msad_u8 v10, s44, v33, v10
  v_msad_u8 v9, s78, v34, v9
  v_msad_u8 v10, s44, v34, v10
  global_store_byte v7, v8, s[30:31]
  global_load_dwordx3 v[32:34], v232, s[30:31] sc1
  v_sub_u32 v9, v9, v10
  v_add_u32 v8, 1, v8
  v_readlane_b32 s66, v9, 0
  v_readlane_b32 s67, v9, 1
  s_add_u32 s78, s78, 0x01010101
  s_mov_b64 exec, -1
  s_lshl1_add_u32 s69, s91, s95
  s_add_u32 s95, s66, s67
  s_add_u32 s69, s69, s95
  v_dot2_f32_bf16 v22, v13, v40, 0
  v_dot2_f32_bf16 v23, v114, v41, 0
  v_dot2_f32_bf16 v24, v112, v42, 0
  v_dot2_f32_bf16 v25, v115, v43, 0
  v_cvt_f32_i32 v64, v64
  v_cvt_f32_i32 v65, v65
  v_cvt_f32_i32 v66, v66
  v_cvt_f32_i32 v67, v67
  v_pk_mul_f32 v[20:21], v[64:65], v[22:23]
  v_pk_add_f32 v[18:19], v[22:23], v[24:25]
  v_pk_fma_f32 v[20:21], v[66:67], v[24:25], v[20:21]
  v_add_f32 v18, v18, v19
  v_add_f32 v20, v20, v21
  s_cmpk_gt_i32 s69, 0x1d
  s_cbranch_scc1 L_p65_3
  s_cmp_gt_i32 s69, L_order_end-L_order-16411
  s_cbranch_scc1 L_p65_1
  s_waitcnt vmcnt(5)
L_p65_1:
  s_waitcnt vmcnt(8)
L_p65_3:
  s_waitcnt vmcnt(9)
  buffer_load_dwordx4 v[100:103], v217, s[32:35], 0 offen nt
  v_dot2_f32_bf16 v22, v113, v48, 0
  v_add_f32_dpp v239, v18, v18 row_ror:8 row_mask:0xf bank_mask:0xc
  v_add_f32_dpp v239, v20, v20 row_ror:8 row_mask:0xf bank_mask:0x3
  v_dot2_f32_bf16 v23, v118, v49, 0
  v_dot2_f32_bf16 v24, v116, v50, 0
  v_dot2_f32_bf16 v25, v119, v51, 0
  v_cvt_f32_i32 v68, v68
  v_cvt_f32_i32 v69, v69
  v_cvt_f32_i32 v70, v70
  v_cvt_f32_i32 v71, v71
  v_pk_mul_f32 v[20:21], v[68:69], v[22:23]
  v_pk_add_f32 v[18:19], v[22:23], v[24:25]
  v_pk_fma_f32 v[20:21], v[70:71], v[24:25], v[20:21]
  v_add_f32 v18, v18, v19
  v_add_f32 v20, v20, v21
  s_cmpk_gt_i32 s69, 0x1d
  s_cbranch_scc1 L_p66_3
  s_cmp_gt_i32 s69, L_order_end-L_order-16381
  s_cbranch_scc1 L_p66_2
  s_waitcnt vmcnt(6)
L_p66_2:
  s_waitcnt vmcnt(9)
L_p66_3:
  s_waitcnt vmcnt(10)
  buffer_load_dwordx4 v[104:107], v218, s[32:35], 0 offen nt
  v_dot2_f32_bf16 v22, v117, v44, 0
  v_add_f32_dpp v21, v18, v18 row_ror:8 row_mask:0xf bank_mask:0xc
  v_add_f32_dpp v21, v20, v20 row_ror:8 row_mask:0xf bank_mask:0x3
  v_add_f32_dpp v20, v239, v239 row_half_mirror row_mask:0xf bank_mask:0x5
  v_dot2_f32_bf16 v23, v122, v45, 0
  v_add_f32_dpp v20, v21, v21 row_half_mirror row_mask:0xf bank_mask:0xa
  v_dot2_f32_bf16 v24, v120, v46, 0
  v_dot2_f32_bf16 v25, v123, v47, 0
  v_add_f32_dpp v20, v20, v20 quad_perm:[2,3,0,1] row_mask:0xf bank_mask:0xf
  v_cvt_f32_i32 v72, v72
  v_cvt_f32_i32 v73, v73
  v_add_f32_dpp v20, v20, v20 quad_perm:[1,0,3,2] row_mask:0xf bank_mask:0xf
  v_cndmask_b32_e64 v236, v236, v20, s[48:49]
  v_cvt_f32_i32 v74, v74
  v_cvt_f32_i32 v75, v75
  v_pk_mul_f32 v[20:21], v[72:73], v[22:23]
  v_pk_add_f32 v[18:19], v[22:23], v[24:25]
  v_pk_fma_f32 v[20:21], v[74:75], v[24:25], v[20:21]
  v_add_f32 v18, v18, v19
  v_add_f32 v20, v20, v21
  s_cmpk_gt_i32 s69, 0x1d
  s_cbranch_scc1 L_p67_3
  s_cmp_gt_i32 s69, L_order_end-L_order-16435
  s_cbranch_scc1 L_p67_0
  s_waitcnt vmcnt(6)
L_p67_0:
  s_waitcnt vmcnt(7)
L_p67_3:
  s_waitcnt vmcnt(10)
  buffer_load_dwordx4 v[108:111], v219, s[32:35], 0 offen nt
  s_waitcnt vmcnt(8)
  s_mov_b64 exec, 3
  s_add_u32 s44, s78, 0x03030303
  v_msad_u8 v9, s78, v36, 0
  v_msad_u8 v10, s44, v36, 0
  v_msad_u8 v9, s78, v37, v9
  v_msad_u8 v10, s44, v37, v10
  v_msad_u8 v9, s78, v38, v9
  v_msad_u8 v10, s44, v38, v10
  global_store_byte v7, v8, s[30:31]
  global_load_dwordx3 v[36:38], v233, s[30:31] sc1
  v_sub_u32 v9, v9, v10
  v_add_u32 v8, 1, v8
  v_readlane_b32 s66, v9, 0
  v_readlane_b32 s67, v9, 1
  s_add_u32 s78, s78, 0x01010101
  s_mov_b64 exec, -1
  s_lshl1_add_u32 s69, s91, s95
  s_add_u32 s95, s66, s67
  s_add_u32 s69, s69, s95
  v_dot2_f32_bf16 v22, v121, v40, 0
  v_add_f32_dpp v239, v18, v18 row_ror:8 row_mask:0xf bank_mask:0xc
  v_add_f32_dpp v239, v20, v20 row_ror:8 row_mask:0xf bank_mask:0x3
  v_dot2_f32_bf16 v23, v126, v41, 0
  v_dot2_f32_bf16 v24, v124, v42, 0
  v_dot2_f32_bf16 v25, v127, v43, 0
  v_cvt_f32_i32 v76, v76
  v_cvt_f32_i32 v77, v77
  v_cvt_f32_i32 v78, v78
  v_cvt_f32_i32 v79, v79
  v_pk_mul_f32 v[20:21], v[76:77], v[22:23]
  v_pk_add_f32 v[18:19], v[22:23], v[24:25]
  v_pk_fma_f32 v[20:21], v[78:79], v[24:25], v[20:21]
  v_add_f32 v18, v18, v19
  v_add_f32 v20, v20, v21
  s_cmpk_gt_i32 s69, 0x1d
  s_cbranch_scc1 L_p68_3
  s_cmp_gt_i32 s69, L_order_end-L_order-16411
  s_cbranch_scc1 L_p68_1
  s_waitcnt vmcnt(5)
L_p68_1:
  s_waitcnt vmcnt(8)
L_p68_3:
  s_waitcnt vmcnt(9)
  buffer_load_dwordx4 v[64:67], v220, s[32:35], 0 offen nt
  v_dot2_f32_bf16 v22, v125, v56, 0
  v_add_f32_dpp v21, v18, v18 row_ror:8 row_mask:0xf bank_mask:0xc
  v_add_f32_dpp v21, v20, v20 row_ror:8 row_mask:0xf bank_mask:0x3
  v_add_f32_dpp v20, v239, v239 row_half_mirror row_mask:0xf bank_mask:0x5
  v_dot2_f32_bf16 v23, v130, v57, 0
  v_add_f32_dpp v20, v21, v21 row_half_mirror row_mask:0xf bank_mask:0xa
  v_dot2_f32_bf16 v24, v128, v58, 0
  v_dot2_f32_bf16 v25, v131, v59, 0
  v_add_f32_dpp v20, v20, v20 quad_perm:[2,3,0,1] row_mask:0xf bank_mask:0xf
  v_cvt_f32_i32 v80, v80
  v_cvt_f32_i32 v81, v81
  v_add_f32_dpp v20, v20, v20 quad_perm:[1,0,3,2] row_mask:0xf bank_mask:0xf
  v_cndmask_b32_e64 v236, v236, v20, s[50:51]
  v_cvt_f32_i32 v82, v82
  v_cvt_f32_i32 v83, v83
  v_pk_mul_f32 v[20:21], v[80:81], v[22:23]
  v_pk_add_f32 v[18:19], v[22:23], v[24:25]
  v_pk_fma_f32 v[20:21], v[82:83], v[24:25], v[20:21]
  v_add_f32 v18, v18, v19
  v_add_f32 v20, v20, v21
  s_cmpk_gt_i32 s69, 0x1d
  s_cbranch_scc1 L_p69_3
  s_cmp_gt_i32 s69, L_order_end-L_order-16381
  s_cbranch_scc1 L_p69_2
  s_waitcnt vmcnt(6)
L_p69_2:
  s_waitcnt vmcnt(9)
L_p69_3:
  s_waitcnt vmcnt(10)
  buffer_load_dwordx4 v[68:71], v221, s[32:35], 0 offen nt
  v_dot2_f32_bf16 v22, v129, v52, 0
  v_add_f32_dpp v239, v18, v18 row_ror:8 row_mask:0xf bank_mask:0xc
  v_add_f32_dpp v239, v20, v20 row_ror:8 row_mask:0xf bank_mask:0x3
  v_dot2_f32_bf16 v23, v134, v53, 0
  v_dot2_f32_bf16 v24, v132, v54, 0
  v_dot2_f32_bf16 v25, v135, v55, 0
  v_cvt_f32_i32 v84, v84
  v_cvt_f32_i32 v85, v85
  v_cvt_f32_i32 v86, v86
  v_cvt_f32_i32 v87, v87
  v_pk_mul_f32 v[20:21], v[84:85], v[22:23]
  v_pk_add_f32 v[18:19], v[22:23], v[24:25]
  v_pk_fma_f32 v[20:21], v[86:87], v[24:25], v[20:21]
  v_add_f32 v18, v18, v19
  v_add_f32 v20, v20, v21
  s_cmpk_gt_i32 s69, 0x1d
  s_cbranch_scc1 L_p70_3
  s_cmp_gt_i32 s69, L_order_end-L_order-16435
  s_cbranch_scc1 L_p70_0
  s_waitcnt vmcnt(6)
L_p70_0:
  s_waitcnt vmcnt(7)
L_p70_3:
  s_waitcnt vmcnt(10)
  buffer_load_dwordx4 v[72:75], v222, s[32:35], 0 offen nt
  s_waitcnt vmcnt(8)
  s_mov_b64 exec, 3
  s_add_u32 s44, s78, 0x03030303
  v_msad_u8 v9, s78, v32, 0
  v_msad_u8 v10, s44, v32, 0
  v_msad_u8 v9, s78, v33, v9
  v_msad_u8 v10, s44, v33, v10
  v_msad_u8 v9, s78, v34, v9
  v_msad_u8 v10, s44, v34, v10
  global_store_byte v7, v8, s[30:31]
  global_load_dwordx3 v[32:34], v234, s[30:31] sc1
  v_sub_u32 v9, v9, v10
  v_add_u32 v8, 1, v8
  v_readlane_b32 s66, v9, 0
  v_readlane_b32 s67, v9, 1
  s_add_u32 s78, s78, 0x01010101
  s_mov_b64 exec, -1
  s_lshl1_add_u32 s69, s91, s95
  s_add_u32 s95, s66, s67
  s_add_u32 s69, s69, s95
  v_dot2_f32_bf16 v22, v133, v60, 0
  v_add_f32_dpp v21, v18, v18 row_ror:8 row_mask:0xf bank_mask:0xc
  v_add_f32_dpp v21, v20, v20 row_ror:8 row_mask:0xf bank_mask:0x3
  v_add_f32_dpp v20, v239, v239 row_half_mirror row_mask:0xf bank_mask:0x5
  v_dot2_f32_bf16 v23, v138, v61, 0
  v_add_f32_dpp v20, v21, v21 row_half_mirror row_mask:0xf bank_mask:0xa
  v_dot2_f32_bf16 v24, v136, v62, 0
  v_dot2_f32_bf16 v25, v139, v63, 0
  v_add_f32_dpp v20, v20, v20 quad_perm:[2,3,0,1] row_mask:0xf bank_mask:0xf
  v_cvt_f32_i32 v88, v88
  v_cvt_f32_i32 v89, v89
  v_add_f32_dpp v20, v20, v20 quad_perm:[1,0,3,2] row_mask:0xf bank_mask:0xf
  v_cndmask_b32_e64 v236, v236, v20, s[52:53]
  v_cvt_f32_i32 v90, v90
  v_cvt_f32_i32 v91, v91
  v_pk_mul_f32 v[20:21], v[88:89], v[22:23]
  v_pk_add_f32 v[18:19], v[22:23], v[24:25]
  v_pk_fma_f32 v[20:21], v[90:91], v[24:25], v[20:21]
  v_add_f32 v18, v18, v19
  v_add_f32 v20, v20, v21
  s_cmpk_gt_i32 s69, 0x1d
  s_cbranch_scc1 L_p71_3
  s_cmp_gt_i32 s69, L_order_end-L_order-16411
  s_cbranch_scc1 L_p71_1
  s_waitcnt vmcnt(5)
L_p71_1:
  s_waitcnt vmcnt(8)
L_p71_3:
  s_waitcnt vmcnt(9)
  buffer_load_dwordx4 v[76:79], v223, s[32:35], 0 offen nt
  v_dot2_f32_bf16 v22, v137, v56, 0
  v_add_f32_dpp v239, v18, v18 row_ror:8 row_mask:0xf bank_mask:0xc
  v_add_f32_dpp v239, v20, v20 row_ror:8 row_mask:0xf bank_mask:0x3
  v_dot2_f32_bf16 v23, v142, v57, 0
  v_dot2_f32_bf16 v24, v140, v58, 0
  v_dot2_f32_bf16 v25, v143, v59, 0
  v_cvt_f32_i32 v92, v92
  v_cvt_f32_i32 v93, v93
  v_cvt_f32_i32 v94, v94
  v_cvt_f32_i32 v95, v95
  v_pk_mul_f32 v[20:21], v[92:93], v[22:23]
  v_pk_add_f32 v[18:19], v[22:23], v[24:25]
  v_pk_fma_f32 v[20:21], v[94:95], v[24:25], v[20:21]
  v_add_f32 v18, v18, v19
  v_add_f32 v20, v20, v21
  s_cmpk_gt_i32 s69, 0x1d
  s_cbranch_scc1 L_p72_3
  s_cmp_gt_i32 s69, L_order_end-L_order-16381
  s_cbranch_scc1 L_p72_2
  s_waitcnt vmcnt(6)
L_p72_2:
  s_waitcnt vmcnt(9)
L_p72_3:
  s_waitcnt vmcnt(10)
  buffer_load_dwordx4 v[80:83], v224, s[32:35], 0 offen nt
  v_dot2_f32_bf16 v22, v141, v44, 0
  v_add_f32_dpp v21, v18, v18 row_ror:8 row_mask:0xf bank_mask:0xc
  v_add_f32_dpp v21, v20, v20 row_ror:8 row_mask:0xf bank_mask:0x3
  v_add_f32_dpp v20, v239, v239 row_half_mirror row_mask:0xf bank_mask:0x5
  v_dot2_f32_bf16 v23, v146, v45, 0
  v_add_f32_dpp v20, v21, v21 row_half_mirror row_mask:0xf bank_mask:0xa
  v_dot2_f32_bf16 v24, v144, v46, 0
  v_dot2_f32_bf16 v25, v147, v47, 0
  v_add_f32_dpp v20, v20, v20 quad_perm:[2,3,0,1] row_mask:0xf bank_mask:0xf
  v_cvt_f32_i32 v96, v96
  v_cvt_f32_i32 v97, v97
  v_add_f32_dpp v20, v20, v20 quad_perm:[1,0,3,2] row_mask:0xf bank_mask:0xf
  v_cndmask_b32_e64 v236, v236, v20, s[54:55]
  v_add_u32_e64 v2, s101, v15
  ds_write_b32 v2, v236
  v_cvt_f32_i32 v98, v98
  v_cvt_f32_i32 v99, v99
  v_pk_mul_f32 v[20:21], v[96:97], v[22:23]
  v_pk_add_f32 v[18:19], v[22:23], v[24:25]
  v_pk_fma_f32 v[20:21], v[98:99], v[24:25], v[20:21]
  v_add_f32 v18, v18, v19
  v_add_f32 v20, v20, v21
  s_cmpk_gt_i32 s69, 0x1d
  s_cbranch_scc1 L_p73_3
  s_cmp_gt_i32 s69, L_order_end-L_order-16435
  s_cbranch_scc1 L_p73_0
  s_waitcnt vmcnt(6)
L_p73_0:
  s_waitcnt vmcnt(7)
L_p73_3:
  s_waitcnt vmcnt(10)
  buffer_load_dwordx4 v[84:87], v225, s[32:35], 0 offen nt
  s_waitcnt vmcnt(8)
  s_mov_b64 exec, 3
  s_add_u32 s44, s78, 0x03030303
  v_msad_u8 v9, s78, v36, 0
  v_msad_u8 v10, s44, v36, 0
  v_msad_u8 v9, s78, v37, v9
  v_msad_u8 v10, s44, v37, v10
  v_msad_u8 v9, s78, v38, v9
  v_msad_u8 v10, s44, v38, v10
  global_store_byte v7, v8, s[30:31]
  global_load_dwordx3 v[36:38], v235, s[30:31] sc1
  v_sub_u32 v9, v9, v10
  v_add_u32 v8, 1, v8
  v_readlane_b32 s66, v9, 0
  v_readlane_b32 s67, v9, 1
  s_add_u32 s78, s78, 0x01010101
  s_mov_b64 exec, -1
  s_lshl1_add_u32 s69, s91, s95
  s_add_u32 s95, s66, s67
  s_add_u32 s69, s69, s95
  v_dot2_f32_bf16 v22, v145, v40, 0
  v_add_f32_dpp v239, v18, v18 row_ror:8 row_mask:0xf bank_mask:0xc
  v_add_f32_dpp v239, v20, v20 row_ror:8 row_mask:0xf bank_mask:0x3
  v_dot2_f32_bf16 v23, v150, v41, 0
  v_dot2_f32_bf16 v24, v148, v42, 0
  v_dot2_f32_bf16 v25, v151, v43, 0
  v_cvt_f32_i32 v100, v100
  v_cvt_f32_i32 v101, v101
  v_cvt_f32_i32 v102, v102
  v_cvt_f32_i32 v103, v103
  v_pk_mul_f32 v[20:21], v[100:101], v[22:23]
  v_pk_add_f32 v[18:19], v[22:23], v[24:25]
  v_pk_fma_f32 v[20:21], v[102:103], v[24:25], v[20:21]
  v_add_f32 v18, v18, v19
  v_add_f32 v20, v20, v21
  s_cmpk_gt_i32 s69, 0x1d
  s_cbranch_scc1 L_p74_3
  s_cmp_gt_i32 s69, L_order_end-L_order-16411
  s_cbranch_scc1 L_p74_1
  s_waitcnt vmcnt(5)
L_p74_1:
  s_waitcnt vmcnt(8)
L_p74_3:
  s_waitcnt vmcnt(9)
  buffer_load_dwordx4 v[88:91], v226, s[32:35], 0 offen nt
  v_dot2_f32_bf16 v22, v149, v48, 0
  v_add_f32_dpp v21, v18, v18 row_ror:8 row_mask:0xf bank_mask:0xc
  v_add_f32_dpp v21, v20, v20 row_ror:8 row_mask:0xf bank_mask:0x3
  v_add_f32_dpp v20, v239, v239 row_half_mirror row_mask:0xf bank_mask:0x5
  v_dot2_f32_bf16 v23, v154, v49, 0
  v_add_f32_dpp v20, v21, v21 row_half_mirror row_mask:0xf bank_mask:0xa
  v_dot2_f32_bf16 v24, v152, v50, 0
  v_dot2_f32_bf16 v25, v155, v51, 0
  v_add_f32_dpp v20, v20, v20 quad_perm:[2,3,0,1] row_mask:0xf bank_mask:0xf
  v_cvt_f32_i32 v104, v104
  v_cvt_f32_i32 v105, v105
  v_add_f32_dpp v20, v20, v20 quad_perm:[1,0,3,2] row_mask:0xf bank_mask:0xf
  v_cndmask_b32_e64 v236, v236, v20, s[48:49]
  v_cvt_f32_i32 v106, v106
  v_cvt_f32_i32 v107, v107
  v_pk_mul_f32 v[20:21], v[104:105], v[22:23]
  v_pk_add_f32 v[18:19], v[22:23], v[24:25]
  v_pk_fma_f32 v[20:21], v[106:107], v[24:25], v[20:21]
  v_add_f32 v18, v18, v19
  v_add_f32 v20, v20, v21
  s_cmpk_gt_i32 s69, 0x1d
  s_cbranch_scc1 L_p75_3
  s_cmp_gt_i32 s69, L_order_end-L_order-16381
  s_cbranch_scc1 L_p75_2
  s_waitcnt vmcnt(6)
L_p75_2:
  s_waitcnt vmcnt(9)
L_p75_3:
  s_waitcnt vmcnt(10)
  buffer_load_dwordx4 v[92:95], v227, s[32:35], 0 offen nt
  v_dot2_f32_bf16 v22, v153, v44, 0
  v_add_f32_dpp v239, v18, v18 row_ror:8 row_mask:0xf bank_mask:0xc
  v_add_f32_dpp v239, v20, v20 row_ror:8 row_mask:0xf bank_mask:0x3
  v_dot2_f32_bf16 v23, v158, v45, 0
  v_dot2_f32_bf16 v24, v156, v46, 0
  v_dot2_f32_bf16 v25, v159, v47, 0
  v_cvt_f32_i32 v108, v108
  v_cvt_f32_i32 v109, v109
  v_cvt_f32_i32 v110, v110
  v_cvt_f32_i32 v111, v111
  v_pk_mul_f32 v[20:21], v[108:109], v[22:23]
  v_pk_add_f32 v[18:19], v[22:23], v[24:25]
  v_pk_fma_f32 v[20:21], v[110:111], v[24:25], v[20:21]
  v_add_f32 v18, v18, v19
  v_add_f32 v20, v20, v21
  s_cmpk_gt_i32 s69, 0x1d
  s_cbranch_scc1 L_p76_3
  s_cmp_gt_i32 s69, L_order_end-L_order-16435
  s_cbranch_scc1 L_p76_0
  s_waitcnt vmcnt(6)
L_p76_0:
  s_waitcnt vmcnt(7)
L_p76_3:
  s_waitcnt vmcnt(10)
  buffer_load_dwordx4 v[96:99], v228, s[32:35], 0 offen nt
  s_waitcnt vmcnt(8)
  s_mov_b64 exec, 3
  s_add_u32 s44, s78, 0x03030303
  v_msad_u8 v9, s78, v32, 0
  v_msad_u8 v10, s44, v32, 0
  v_msad_u8 v9, s78, v33, v9
  v_msad_u8 v10, s44, v33, v10
  v_msad_u8 v9, s78, v34, v9
  v_msad_u8 v10, s44, v34, v10
  global_store_byte v7, v8, s[30:31]
  global_load_dwordx3 v[32:34], v232, s[30:31] sc1
  v_sub_u32 v9, v9, v10
  v_add_u32 v8, 1, v8
  v_readlane_b32 s66, v9, 0
  v_readlane_b32 s67, v9, 1
  s_add_u32 s78, s78, 0x01010101
  s_mov_b64 exec, -1
  s_lshl1_add_u32 s69, s91, s95
  s_add_u32 s95, s66, s67
  s_add_u32 s69, s69, s95
  v_dot2_f32_bf16 v22, v157, v60, 0
  v_add_f32_dpp v21, v18, v18 row_ror:8 row_mask:0xf bank_mask:0xc
  v_add_f32_dpp v21, v20, v20 row_ror:8 row_mask:0xf bank_mask:0x3
  v_add_f32_dpp v20, v239, v239 row_half_mirror row_mask:0xf bank_mask:0x5
  v_dot2_f32_bf16 v23, v162, v61, 0
  v_add_f32_dpp v20, v21, v21 row_half_mirror row_mask:0xf bank_mask:0xa
  v_dot2_f32_bf16 v24, v160, v62, 0
  v_dot2_f32_bf16 v25, v163, v63, 0
  v_add_f32_dpp v20, v20, v20 quad_perm:[2,3,0,1] row_mask:0xf bank_mask:0xf
  v_cvt_f32_i32 v64, v64
  v_cvt_f32_i32 v65, v65
  v_add_f32_dpp v20, v20, v20 quad_perm:[1,0,3,2] row_mask:0xf bank_mask:0xf
  v_cndmask_b32_e64 v236, v236, v20, s[50:51]
  v_cvt_f32_i32 v66, v66
  v_cvt_f32_i32 v67, v67
  v_pk_mul_f32 v[20:21], v[64:65], v[22:23]
  v_pk_add_f32 v[18:19], v[22:23], v[24:25]
  v_pk_fma_f32 v[20:21], v[66:67], v[24:25], v[20:21]
  v_add_f32 v18, v18, v19
  v_add_f32 v20, v20, v21
  s_cmpk_gt_i32 s69, 0x1d
  s_cbranch_scc1 L_p77_3
  s_cmp_gt_i32 s69, L_order_end-L_order-16411
  s_cbranch_scc1 L_p77_1
  s_waitcnt vmcnt(5)
L_p77_1:
  s_waitcnt vmcnt(8)
L_p77_3:
  s_waitcnt vmcnt(9)
  buffer_load_dwordx4 v[100:103], v229, s[32:35], 0 offen nt
  v_dot2_f32_bf16 v22, v161, v56, 0
  v_add_f32_dpp v239, v18, v18 row_ror:8 row_mask:0xf bank_mask:0xc
  v_add_f32_dpp v239, v20, v20 row_ror:8 row_mask:0xf bank_mask:0x3
  v_dot2_f32_bf16 v23, v166, v57, 0
  v_dot2_f32_bf16 v24, v164, v58, 0
  v_dot2_f32_bf16 v25, v167, v59, 0
  v_cvt_f32_i32 v68, v68
  v_cvt_f32_i32 v69, v69
  v_cvt_f32_i32 v70, v70
  v_cvt_f32_i32 v71, v71
  v_pk_mul_f32 v[20:21], v[68:69], v[22:23]
  v_pk_add_f32 v[18:19], v[22:23], v[24:25]
  v_pk_fma_f32 v[20:21], v[70:71], v[24:25], v[20:21]
  v_add_f32 v18, v18, v19
  v_add_f32 v20, v20, v21
  s_cmpk_gt_i32 s69, 0x1d
  s_cbranch_scc1 L_p78_3
  s_cmp_gt_i32 s69, L_order_end-L_order-16381
  s_cbranch_scc1 L_p78_2
  s_waitcnt vmcnt(6)
L_p78_2:
  s_waitcnt vmcnt(9)
L_p78_3:
  s_waitcnt vmcnt(10)
  buffer_load_dwordx4 v[104:107], v230, s[32:35], 0 offen nt
  v_dot2_f32_bf16 v22, v165, v52, 0
  v_add_f32_dpp v21, v18, v18 row_ror:8 row_mask:0xf bank_mask:0xc
  v_add_f32_dpp v21, v20, v20 row_ror:8 row_mask:0xf bank_mask:0x3
  v_add_f32_dpp v20, v239, v239 row_half_mirror row_mask:0xf bank_mask:0x5
  v_dot2_f32_bf16 v23, v170, v53, 0
  v_add_f32_dpp v20, v21, v21 row_half_mirror row_mask:0xf bank_mask:0xa
  v_dot2_f32_bf16 v24, v168, v54, 0
  v_dot2_f32_bf16 v25, v171, v55, 0
  v_add_f32_dpp v20, v20, v20 quad_perm:[2,3,0,1] row_mask:0xf bank_mask:0xf
  v_cvt_f32_i32 v72, v72
  v_cvt_f32_i32 v73, v73
  v_add_f32_dpp v20, v20, v20 quad_perm:[1,0,3,2] row_mask:0xf bank_mask:0xf
  v_cndmask_b32_e64 v236, v236, v20, s[52:53]
  v_cvt_f32_i32 v74, v74
  v_cvt_f32_i32 v75, v75
  v_pk_mul_f32 v[20:21], v[72:73], v[22:23]
  v_pk_add_f32 v[18:19], v[22:23], v[24:25]
  v_pk_fma_f32 v[20:21], v[74:75], v[24:25], v[20:21]
  v_add_f32 v18, v18, v19
  v_add_f32 v20, v20, v21
  s_cmpk_gt_i32 s69, 0x1d
  s_cbranch_scc1 L_p79_3
  s_cmp_gt_i32 s69, L_order_end-L_order-16435
  s_cbranch_scc1 L_p79_0
  s_waitcnt vmcnt(6)
L_p79_0:
  s_waitcnt vmcnt(7)
L_p79_3:
  s_waitcnt vmcnt(10)
  buffer_load_dwordx4 v[108:111], v231, s[32:35], 0 offen nt
  s_waitcnt vmcnt(8)
  s_mov_b64 exec, 3
  s_add_u32 s44, s78, 0x03030303
  v_msad_u8 v9, s78, v36, 0
  v_msad_u8 v10, s44, v36, 0
  v_msad_u8 v9, s78, v37, v9
  v_msad_u8 v10, s44, v37, v10
  v_msad_u8 v9, s78, v38, v9
  v_msad_u8 v10, s44, v38, v10
  global_load_dwordx2 v[26:27], v11, s[30:31] sc1
  global_store_byte v7, v8, s[30:31]
  global_load_dwordx3 v[36:38], v233, s[30:31] sc1
  v_sub_u32 v9, v9, v10
  v_add_u32 v8, 1, v8
  v_readlane_b32 s66, v9, 0
  v_readlane_b32 s67, v9, 1
  s_add_u32 s78, s78, 0x01010101
  s_mov_b64 exec, -1
  s_lshl1_add_u32 s69, s91, s95
  s_add_u32 s95, s66, s67
  s_add_u32 s69, s69, s95
  v_dot2_f32_bf16 v22, v169, v60, 0
  v_add_f32_dpp v239, v18, v18 row_ror:8 row_mask:0xf bank_mask:0xc
  v_add_f32_dpp v239, v20, v20 row_ror:8 row_mask:0xf bank_mask:0x3
  v_dot2_f32_bf16 v23, v174, v61, 0
  v_dot2_f32_bf16 v24, v172, v62, 0
  v_dot2_f32_bf16 v25, v175, v63, 0
  v_cvt_f32_i32 v76, v76
  v_cvt_f32_i32 v77, v77
  v_cvt_f32_i32 v78, v78
  v_cvt_f32_i32 v79, v79
  v_pk_mul_f32 v[20:21], v[76:77], v[22:23]
  v_pk_add_f32 v[18:19], v[22:23], v[24:25]
  v_pk_fma_f32 v[20:21], v[78:79], v[24:25], v[20:21]
  v_add_f32 v18, v18, v19
  v_add_f32 v20, v20, v21
  s_cmpk_gt_i32 s69, 0x1d
  s_cbranch_scc1 L_p80_3
  s_cmp_gt_i32 s69, L_order_end-L_order-16411
  s_cbranch_scc1 L_p80_1
  s_waitcnt vmcnt(6)
L_p80_1:
  s_waitcnt vmcnt(9)
L_p80_3:
  s_waitcnt vmcnt(10)
  buffer_load_dwordx4 v[64:67], v208, s[36:39], 0 offen nt
  v_dot2_f32_bf16 v22, v173, v48, 0
  v_add_f32_dpp v21, v18, v18 row_ror:8 row_mask:0xf bank_mask:0xc
  v_add_f32_dpp v21, v20, v20 row_ror:8 row_mask:0xf bank_mask:0x3
  v_add_f32_dpp v20, v239, v239 row_half_mirror row_mask:0xf bank_mask:0x5
  v_dot2_f32_bf16 v23, v178, v49, 0
  v_add_f32_dpp v20, v21, v21 row_half_mirror row_mask:0xf bank_mask:0xa
  v_dot2_f32_bf16 v24, v176, v50, 0
  v_dot2_f32_bf16 v25, v179, v51, 0
  v_add_f32_dpp v20, v20, v20 quad_perm:[2,3,0,1] row_mask:0xf bank_mask:0xf
  v_cvt_f32_i32 v80, v80
  v_cvt_f32_i32 v81, v81
  v_add_f32_dpp v20, v20, v20 quad_perm:[1,0,3,2] row_mask:0xf bank_mask:0xf
  v_cndmask_b32_e64 v236, v236, v20, s[54:55]
  v_add_u32_e64 v2, s101, v16
  ds_write_b32 v2, v236
  v_cvt_f32_i32 v82, v82
  v_cvt_f32_i32 v83, v83
  v_pk_mul_f32 v[20:21], v[80:81], v[22:23]
  v_pk_add_f32 v[18:19], v[22:23], v[24:25]
  v_pk_fma_f32 v[20:21], v[82:83], v[24:25], v[20:21]
  v_add_f32 v18, v18, v19
  v_add_f32 v20, v20, v21
  s_cmpk_gt_i32 s69, 0x1d
  s_cbranch_scc1 L_p81_3
  s_cmp_gt_i32 s69, L_order_end-L_order-16381
  s_cbranch_scc1 L_p81_2
  s_waitcnt vmcnt(7)
L_p81_2:
  s_waitcnt vmcnt(10)
L_p81_3:
  s_waitcnt vmcnt(11)
  buffer_load_dwordx4 v[68:71], v209, s[36:39], 0 offen nt
  v_dot2_f32_bf16 v22, v177, v44, 0
  v_add_f32_dpp v239, v18, v18 row_ror:8 row_mask:0xf bank_mask:0xc
  v_add_f32_dpp v239, v20, v20 row_ror:8 row_mask:0xf bank_mask:0x3
  v_dot2_f32_bf16 v23, v182, v45, 0
  v_dot2_f32_bf16 v24, v180, v46, 0
  v_dot2_f32_bf16 v25, v183, v47, 0
  v_cvt_f32_i32 v84, v84
  v_cvt_f32_i32 v85, v85
  v_cvt_f32_i32 v86, v86
  v_cvt_f32_i32 v87, v87
  v_pk_mul_f32 v[20:21], v[84:85], v[22:23]
  v_pk_add_f32 v[18:19], v[22:23], v[24:25]
  v_pk_fma_f32 v[20:21], v[86:87], v[24:25], v[20:21]
  v_add_f32 v18, v18, v19
  v_add_f32 v20, v20, v21
  s_cmpk_gt_i32 s69, 0x1d
  s_cbranch_scc1 L_p82_3
  s_cmp_gt_i32 s69, L_order_end-L_order-16435
  s_cbranch_scc1 L_p82_0
  s_waitcnt vmcnt(7)
L_p82_0:
  s_waitcnt vmcnt(8)
L_p82_3:
  s_waitcnt vmcnt(11)
  buffer_load_dwordx4 v[72:75], v210, s[36:39], 0 offen nt
  ds_read_b32 v4, v14 offset:16
  s_waitcnt vmcnt(9)
  s_mov_b64 exec, 3
  s_add_u32 s44, s78, 0x03030303
  v_msad_u8 v9, s78, v32, 0
  v_msad_u8 v10, s44, v32, 0
  v_msad_u8 v9, s78, v33, v9
  v_msad_u8 v10, s44, v33, v10
  v_msad_u8 v9, s78, v34, v9
  v_msad_u8 v10, s44, v34, v10
  global_store_byte v7, v8, s[30:31]
  global_load_dwordx3 v[32:34], v234, s[30:31] sc1
  v_sub_u32 v9, v9, v10
  v_add_u32 v8, 1, v8
  v_readlane_b32 s66, v9, 0
  v_readlane_b32 s67, v9, 1
  s_add_u32 s78, s78, 0x01010101
  s_mov_b64 exec, -1
  s_lshl1_add_u32 s69, s91, s95
  s_add_u32 s95, s66, s67
  s_add_u32 s69, s69, s95
  v_dot2_f32_bf16 v22, v181, v40, 0
  v_add_f32_dpp v21, v18, v18 row_ror:8 row_mask:0xf bank_mask:0xc
  v_add_f32_dpp v21, v20, v20 row_ror:8 row_mask:0xf bank_mask:0x3
  v_add_f32_dpp v20, v239, v239 row_half_mirror row_mask:0xf bank_mask:0x5
  v_dot2_f32_bf16 v23, v186, v41, 0
  v_add_f32_dpp v20, v21, v21 row_half_mirror row_mask:0xf bank_mask:0xa
  v_dot2_f32_bf16 v24, v184, v42, 0
  v_dot2_f32_bf16 v25, v187, v43, 0
  v_add_f32_dpp v20, v20, v20 quad_perm:[2,3,0,1] row_mask:0xf bank_mask:0xf
  v_cvt_f32_i32 v88, v88
  v_cvt_f32_i32 v89, v89
  v_add_f32_dpp v20, v20, v20 quad_perm:[1,0,3,2] row_mask:0xf bank_mask:0xf
  v_cndmask_b32_e64 v236, v236, v20, s[48:49]
  v_cvt_f32_i32 v90, v90
  v_cvt_f32_i32 v91, v91
  v_pk_mul_f32 v[20:21], v[88:89], v[22:23]
  v_pk_add_f32 v[18:19], v[22:23], v[24:25]
  v_pk_fma_f32 v[20:21], v[90:91], v[24:25], v[20:21]
  v_add_f32 v18, v18, v19
  v_add_f32 v20, v20, v21
  s_cmpk_gt_i32 s69, 0x1d
  s_cbranch_scc1 L_p83_3
  s_cmp_gt_i32 s69, L_order_end-L_order-16411
  s_cbranch_scc1 L_p83_1
  s_waitcnt vmcnt(5)
L_p83_1:
  s_waitcnt vmcnt(9)
L_p83_3:
  s_waitcnt vmcnt(10)
  buffer_load_dwordx4 v[76:79], v211, s[36:39], 0 offen nt
  v_dot2_f32_bf16 v22, v185, v48, 0
  v_add_f32_dpp v239, v18, v18 row_ror:8 row_mask:0xf bank_mask:0xc
  v_add_f32_dpp v239, v20, v20 row_ror:8 row_mask:0xf bank_mask:0x3
  v_dot2_f32_bf16 v23, v190, v49, 0
  v_dot2_f32_bf16 v24, v188, v50, 0
  v_dot2_f32_bf16 v25, v191, v51, 0
  v_cvt_f32_i32 v92, v92
  v_cvt_f32_i32 v93, v93
  v_cvt_f32_i32 v94, v94
  v_cvt_f32_i32 v95, v95
  v_pk_mul_f32 v[20:21], v[92:93], v[22:23]
  v_pk_add_f32 v[18:19], v[22:23], v[24:25]
  v_pk_fma_f32 v[20:21], v[94:95], v[24:25], v[20:21]
  v_add_f32 v18, v18, v19
  v_add_f32 v20, v20, v21
  s_cmpk_gt_i32 s69, 0x1d
  s_cbranch_scc1 L_p84_3
  s_cmp_gt_i32 s69, L_order_end-L_order-16381
  s_cbranch_scc1 L_p84_2
  s_waitcnt vmcnt(6)
L_p84_2:
  s_waitcnt vmcnt(10)
L_p84_3:
  s_waitcnt vmcnt(11)
  buffer_load_dwordx4 v[80:83], v212, s[36:39], 0 offen nt
  v_dot2_f32_bf16 v22, v189, v52, 0
  v_add_f32_dpp v21, v18, v18 row_ror:8 row_mask:0xf bank_mask:0xc
  v_add_f32_dpp v21, v20, v20 row_ror:8 row_mask:0xf bank_mask:0x3
  v_add_f32_dpp v20, v239, v239 row_half_mirror row_mask:0xf bank_mask:0x5
  v_dot2_f32_bf16 v23, v194, v53, 0
  v_add_f32_dpp v20, v21, v21 row_half_mirror row_mask:0xf bank_mask:0xa
  v_dot2_f32_bf16 v24, v192, v54, 0
  v_dot2_f32_bf16 v25, v195, v55, 0
  v_add_f32_dpp v20, v20, v20 quad_perm:[2,3,0,1] row_mask:0xf bank_mask:0xf
  v_cvt_f32_i32 v96, v96
  v_cvt_f32_i32 v97, v97
  v_add_f32_dpp v20, v20, v20 quad_perm:[1,0,3,2] row_mask:0xf bank_mask:0xf
  v_cndmask_b32_e64 v236, v236, v20, s[50:51]
  v_cvt_f32_i32 v98, v98
  v_cvt_f32_i32 v99, v99
  v_pk_mul_f32 v[20:21], v[96:97], v[22:23]
  v_pk_add_f32 v[18:19], v[22:23], v[24:25]
  v_pk_fma_f32 v[20:21], v[98:99], v[24:25], v[20:21]
  v_add_f32 v18, v18, v19
  v_add_f32 v20, v20, v21
  s_cmpk_gt_i32 s69, 0x1d
  s_cbranch_scc1 L_p85_3
  s_cmp_gt_i32 s69, L_order_end-L_order-16435
  s_cbranch_scc1 L_p85_0
  s_waitcnt vmcnt(6)
L_p85_0:
  s_waitcnt vmcnt(7)
L_p85_3:
  s_waitcnt vmcnt(11)
  buffer_load_dwordx4 v[84:87], v213, s[36:39], 0 offen nt
L_qn:
  s_waitcnt lgkmcnt(0)
  v_readfirstlane_b32 s46, v4
  s_cmp_ge_u32 s46, s47
  s_cbranch_scc1 L_qn_ok
  s_cmp_eq_u32 s94, 0
  s_cbranch_scc1 L_qn_ok
  s_sub_u32 s94, s94, 1
  ds_read_b32 v4, v14 offset:16
  s_branch L_qn
L_qn_ok:
  v_add_u32_e64 v10, s59, v248
  ds_read_b128 v[40:43], v10 offset:512
  v_add_u32_e64 v10, s59, v249
  ds_read_b128 v[44:47], v10 offset:512
  v_add_u32_e64 v10, s59, v250
  ds_read_b128 v[48:51], v10 offset:512
  s_waitcnt vmcnt(8)
  s_mov_b64 exec, 3
  s_add_u32 s44, s78, 0x03030303
  v_msad_u8 v9, s78, v36, 0
  v_msad_u8 v10, s44, v36, 0
  v_msad_u8 v9, s78, v37, v9
  v_msad_u8 v10, s44, v37, v10
  v_msad_u8 v9, s78, v38, v9
  v_msad_u8 v10, s44, v38, v10
  global_store_byte v7, v8, s[30:31]
  global_load_dwordx3 v[36:38], v235, s[30:31] sc1
  v_sub_u32 v9, v9, v10
  v_add_u32 v8, 1, v8
  v_add3_u32 v10, v26, v27, s58
  v_readlane_b32 s66, v9, 0
  v_readlane_b32 s67, v9, 1
  v_readlane_b32 s91, v10, 0
  s_add_u32 s78, s78, 0x01010101
  s_mov_b64 exec, -1
  s_lshl1_add_u32 s69, s91, s95
  s_add_u32 s95, s66, s67
  s_add_u32 s69, s69, s95
  v_dot2_f32_bf16 v22, v193, v60, 0
  v_add_f32_dpp v239, v18, v18 row_ror:8 row_mask:0xf bank_mask:0xc
  v_add_f32_dpp v239, v20, v20 row_ror:8 row_mask:0xf bank_mask:0x3
  v_dot2_f32_bf16 v23, v198, v61, 0
  v_dot2_f32_bf16 v24, v196, v62, 0
  v_dot2_f32_bf16 v25, v199, v63, 0
  v_cvt_f32_i32 v100, v100
  v_cvt_f32_i32 v101, v101
  v_cvt_f32_i32 v102, v102
  v_cvt_f32_i32 v103, v103
  v_add_u32_e64 v10, s59, v253
  ds_read_b128 v[60:63], v10 offset:512
  v_pk_mul_f32 v[20:21], v[100:101], v[22:23]
  v_pk_add_f32 v[18:19], v[22:23], v[24:25]
  v_pk_fma_f32 v[20:21], v[102:103], v[24:25], v[20:21]
  v_add_f32 v18, v18, v19
  v_add_f32 v20, v20, v21
  s_cmpk_gt_i32 s69, 0x1d
  s_cbranch_scc1 L_p86_3
  s_cmp_gt_i32 s69, L_order_end-L_order-16411
  s_cbranch_scc1 L_p86_1
  s_waitcnt vmcnt(5)
L_p86_1:
  s_waitcnt vmcnt(8)
L_p86_3:
  s_waitcnt vmcnt(9)
  buffer_load_dwordx4 v[88:91], v214, s[36:39], 0 offen nt
  v_dot2_f32_bf16 v22, v197, v56, 0
  v_add_f32_dpp v21, v18, v18 row_ror:8 row_mask:0xf bank_mask:0xc
  v_add_f32_dpp v21, v20, v20 row_ror:8 row_mask:0xf bank_mask:0x3
  v_add_f32_dpp v20, v239, v239 row_half_mirror row_mask:0xf bank_mask:0x5
  v_dot2_f32_bf16 v23, v202, v57, 0
  v_add_f32_dpp v20, v21, v21 row_half_mirror row_mask:0xf bank_mask:0xa
  v_dot2_f32_bf16 v24, v200, v58, 0
  v_dot2_f32_bf16 v25, v203, v59, 0
  v_add_f32_dpp v20, v20, v20 quad_perm:[2,3,0,1] row_mask:0xf bank_mask:0xf
  v_cvt_f32_i32 v104, v104
  v_cvt_f32_i32 v105, v105
  v_add_f32_dpp v20, v20, v20 quad_perm:[1,0,3,2] row_mask:0xf bank_mask:0xf
  v_cndmask_b32_e64 v236, v236, v20, s[52:53]
  v_cvt_f32_i32 v106, v106
  v_cvt_f32_i32 v107, v107
  v_add_u32_e64 v10, s59, v252
  ds_read_b128 v[56:59], v10 offset:512
  v_pk_mul_f32 v[20:21], v[104:105], v[22:23]
  v_pk_add_f32 v[18:19], v[22:23], v[24:25]
  v_pk_fma_f32 v[20:21], v[106:107], v[24:25], v[20:21]
  v_add_f32 v18, v18, v19
  v_add_f32 v20, v20, v21
  s_cmpk_gt_i32 s69, 0x1d
  s_cbranch_scc1 L_p87_3
  s_cmp_gt_i32 s69, L_order_end-L_order-16381
  s_cbranch_scc1 L_p87_2
  s_waitcnt vmcnt(6)
L_p87_2:
  s_waitcnt vmcnt(9)
L_p87_3:
  s_waitcnt vmcnt(10)
  buffer_load_dwordx4 v[92:95], v215, s[36:39], 0 offen nt
  v_dot2_f32_bf16 v22, v201, v52, 0
  v_add_f32_dpp v239, v18, v18 row_ror:8 row_mask:0xf bank_mask:0xc
  v_add_f32_dpp v239, v20, v20 row_ror:8 row_mask:0xf bank_mask:0x3
  v_dot2_f32_bf16 v23, v206, v53, 0
  v_dot2_f32_bf16 v24, v204, v54, 0
  v_dot2_f32_bf16 v25, v207, v55, 0
  v_cvt_f32_i32 v108, v108
  v_cvt_f32_i32 v109, v109
  v_cvt_f32_i32 v110, v110
  v_cvt_f32_i32 v111, v111
  v_add_u32_e64 v10, s59, v251
  ds_read_b128 v[52:55], v10 offset:512
  v_pk_mul_f32 v[20:21], v[108:109], v[22:23]
  v_pk_add_f32 v[18:19], v[22:23], v[24:25]
  v_pk_fma_f32 v[20:21], v[110:111], v[24:25], v[20:21]
  v_add_f32 v18, v18, v19
  v_add_f32 v20, v20, v21
  s_cmpk_gt_i32 s69, 0x1d
  s_cbranch_scc1 L_p88_3
  s_cmp_gt_i32 s69, L_order_end-L_order-16435
  s_cbranch_scc1 L_p88_0
  s_waitcnt vmcnt(6)
L_p88_0:
  s_waitcnt vmcnt(7)
L_p88_3:
  s_waitcnt vmcnt(10)
  buffer_load_dwordx4 v[96:99], v216, s[36:39], 0 offen nt
  s_nop 0
  v_add_f32_dpp v21, v18, v18 row_ror:8 row_mask:0xf bank_mask:0xc
  v_add_f32_dpp v21, v20, v20 row_ror:8 row_mask:0xf bank_mask:0x3
  v_add_f32_dpp v20, v239, v239 row_half_mirror row_mask:0xf bank_mask:0x5
  s_nop 0
  v_add_f32_dpp v20, v21, v21 row_half_mirror row_mask:0xf bank_mask:0xa
  s_nop 1
  v_add_f32_dpp v20, v20, v20 quad_perm:[2,3,0,1] row_mask:0xf bank_mask:0xf
  s_nop 1
  v_add_f32_dpp v20, v20, v20 quad_perm:[1,0,3,2] row_mask:0xf bank_mask:0xf
  v_cndmask_b32_e64 v236, v236, v20, s[54:55]
  v_add_u32_e64 v2, s101, v17
  ds_write_b32 v2, v236
  s_addk_i32 s101, 3072
  s_cmpk_eq_u32 s101, 18432
  s_cselect_b32 s101, 0, s101
  s_add_u32 s43, s43, 1
  v_mov_b32_e64 v4, s43
  ds_write_b32 v6, v4 offset:0
  s_mov_b64 s[32:33], s[36:37]
  s_add_u32 s68, s43, 1
  s_sub_u32 s45, s68, 16
  s_lshl_b32 s46, s45, 2
  s_lshr_b64 s[64:65], s[92:93], s46
  s_and_b32 s46, s64, 15
  s_cmp_lt_u32 s68, 16
  s_cselect_b32 s68, s68, s46
  s_cselect_b32 s70, s6, s12
  s_cselect_b32 s71, s7, s13
  s_lshl_b32 s44, s68, 2
  s_lshr_b64 s[64:65], s[96:97], s44
  s_and_b32 s64, s64, 15
  s_lshl4_add_u32 s68, s68, s64
  s_mul_i32 s44, s68, 1572864
  s_add_u32 s36, s70, s44
  s_addc_u32 s37, s71, 0
  s_cmp_lt_u32 s43, 16
  s_cbranch_scc1 L_k
L_vpre:
  v_subrev_u32 v116, 45568, v15
  v_mul_u32_u24 v116, 683, v116
  v_lshrrev_b32 v116, 13, v116
  v_lshlrev_b32 v116, 2, v116
  v_subrev_u32 v117, 45568, v16
  v_mul_u32_u24 v117, 683, v117
  v_lshrrev_b32 v117, 13, v117
  v_lshlrev_b32 v117, 2, v117
  v_subrev_u32 v118, 45568, v17
  v_mul_u32_u24 v118, 683, v118
  v_lshrrev_b32 v118, 13, v118
  v_lshlrev_b32 v118, 2, v118
  s_mov_b64 vcc, 0
  s_mov_b32 s43, 0
  s_lshl_b32 s68, s43, 2
  s_lshr_b64 s[64:65], s[92:93], s68
  s_and_b32 s68, s64, 15
  s_add_u32 s47, s68, 1
  ds_read_b32 v4, v14 offset:20
L_a0:
  s_waitcnt lgkmcnt(0)
  v_readfirstlane_b32 s46, v4
  s_cmp_ge_u32 s46, s47
  s_cbranch_scc1 L_a0_ok
  s_cmp_eq_u32 s94, 0
  s_cbranch_scc1 L_a0_ok
  s_sub_u32 s94, s94, 1
  ds_read_b32 v4, v14 offset:20
  s_branch L_a0
L_a0_ok:
  v_lshl_add_u32 v120, s68, 9, v116
  v_lshl_add_u32 v121, s68, 9, v117
  v_lshl_add_u32 v122, s68, 9, v118
  ds_read_b32 v112, v120 offset:37376
  ds_read_b32 v113, v121 offset:37376
  ds_read_b32 v114, v122 offset:37376
.p2align 6
L_v:
  s_cmp_eq_u32 s43, 8
  s_cselect_b32 s44, 4, 0
  s_sub_u32 s58, s58, s44
  s_add_u32 s45, s43, 1
  s_min_u32 s45, s45, 15
  s_lshl_b32 s68, s45, 2
  s_lshr_b64 s[64:65], s[92:93], s68
  s_and_b32 s68, s64, 15
  s_add_u32 s47, s68, 1
  v_lshl_add_u32 v120, s68, 9, v116
  v_lshl_add_u32 v121, s68, 9, v117
  v_lshl_add_u32 v122, s68, 9, v118
  s_waitcnt lgkmcnt(0)
  s_waitcnt vmcnt(8)
  s_mov_b64 exec, 3
  s_add_u32 s44, s78, 0x03030303
  v_msad_u8 v9, s78, v32, 0
  v_msad_u8 v10, s44, v32, 0
  v_msad_u8 v9, s78, v33, v9
  v_msad_u8 v10, s44, v33, v10
  v_msad_u8 v9, s78, v34, v9
  v_msad_u8 v10, s44, v34, v10
  global_store_byte v7, v8, s[30:31]
  global_load_dwordx3 v[32:34], v232, s[30:31] sc1
  v_sub_u32 v9, v9, v10
  v_add_u32 v8, 1, v8
  v_readlane_b32 s66, v9, 0
  v_readlane_b32 s67, v9, 1
  s_add_u32 s78, s78, 0x01010101
  s_mov_b64 exec, -1
  s_lshl1_add_u32 s69, s91, s95
  s_add_u32 s95, s66, s67
  s_add_u32 s69, s69, s95
  v_mov_b32_dpp v18, v112 row_newbcast:0 row_mask:0xf bank_mask:0xf
  v_cvt_f32_i32 v64, v64
  v_cvt_f32_i32 v65, v65
  v_cvt_f32_i32 v66, v66
  v_cvt_f32_i32 v67, v67
  v_pk_mul_f32 v[40:41], v[64:65], v[18:19] op_sel_hi:[1,0]
  v_pk_mul_f32 v[42:43], v[66:67], v[18:19] op_sel_hi:[1,0]
  s_cmpk_gt_i32 s69, 0x29
  s_cbranch_scc1 L_p89_3
  s_cmp_gt_i32 s69, L_order_end-L_order-16399
  s_cbranch_scc1 L_p89_1
  s_waitcnt vmcnt(5)
L_p89_1:
  s_waitcnt vmcnt(8)
L_p89_3:
  s_waitcnt vmcnt(9)
  buffer_load_dwordx4 v[100:103], v217, s[32:35], 0 offen nt
  v_mov_b32_dpp v18, v112 row_newbcast:4 row_mask:0xf bank_mask:0xf
  v_cvt_f32_i32 v68, v68
  v_cvt_f32_i32 v69, v69
  v_cvt_f32_i32 v70, v70
  v_cvt_f32_i32 v71, v71
  v_pk_mul_f32 v[48:49], v[68:69], v[18:19] op_sel_hi:[1,0]
  v_pk_mul_f32 v[50:51], v[70:71], v[18:19] op_sel_hi:[1,0]
  s_cmpk_gt_i32 s69, 0x29
  s_cbranch_scc1 L_p90_3
  s_cmp_gt_i32 s69, L_order_end-L_order-16369
  s_cbranch_scc1 L_p90_2
  s_waitcnt vmcnt(6)
L_p90_2:
  s_waitcnt vmcnt(9)
L_p90_3:
  s_waitcnt vmcnt(10)
  buffer_load_dwordx4 v[104:107], v218, s[32:35], 0 offen nt
  v_mov_b32_dpp v18, v112 row_newbcast:1 row_mask:0xf bank_mask:0xf
  v_cvt_f32_i32 v72, v72
  v_cvt_f32_i32 v73, v73
  v_cvt_f32_i32 v74, v74
  v_cvt_f32_i32 v75, v75
  v_pk_mul_f32 v[44:45], v[72:73], v[18:19] op_sel_hi:[1,0]
  v_pk_mul_f32 v[46:47], v[74:75], v[18:19] op_sel_hi:[1,0]
  s_cmpk_gt_i32 s69, 0x29
  s_cbranch_scc1 L_p91_3
  s_cmp_gt_i32 s69, L_order_end-L_order-16423
  s_cbranch_scc1 L_p91_0
  s_waitcnt vmcnt(6)
L_p91_0:
  s_waitcnt vmcnt(7)
L_p91_3:
  s_waitcnt vmcnt(10)
  buffer_load_dwordx4 v[108:111], v219, s[32:35], 0 offen nt
  s_waitcnt vmcnt(8)
  s_mov_b64 exec, 3
  s_add_u32 s44, s78, 0x03030303
  v_msad_u8 v9, s78, v36, 0
  v_msad_u8 v10, s44, v36, 0
  v_msad_u8 v9, s78, v37, v9
  v_msad_u8 v10, s44, v37, v10
  v_msad_u8 v9, s78, v38, v9
  v_msad_u8 v10, s44, v38, v10
  global_store_byte v7, v8, s[30:31]
  global_load_dwordx3 v[36:38], v233, s[30:31] sc1
  v_sub_u32 v9, v9, v10
  v_add_u32 v8, 1, v8
  v_readlane_b32 s66, v9, 0
  v_readlane_b32 s67, v9, 1
  s_add_u32 s78, s78, 0x01010101
  s_mov_b64 exec, -1
  s_lshl1_add_u32 s69, s91, s95
  s_add_u32 s95, s66, s67
  s_add_u32 s69, s69, s95
  v_mov_b32_dpp v18, v112 row_newbcast:5 row_mask:0xf bank_mask:0xf
  v_cvt_f32_i32 v76, v76
  v_cvt_f32_i32 v77, v77
  v_cvt_f32_i32 v78, v78
  v_cvt_f32_i32 v79, v79
  v_pk_fma_f32 v[40:41], v[76:77], v[18:19], v[40:41] op_sel_hi:[1,0,1]
  v_pk_fma_f32 v[42:43], v[78:79], v[18:19], v[42:43] op_sel_hi:[1,0,1]
  s_cmpk_gt_i32 s69, 0x29
  s_cbranch_scc1 L_p92_3
  s_cmp_gt_i32 s69, L_order_end-L_order-16399
  s_cbranch_scc1 L_p92_1
  s_waitcnt vmcnt(5)
L_p92_1:
  s_waitcnt vmcnt(8)
L_p92_3:
  s_waitcnt vmcnt(9)
  buffer_load_dwordx4 v[64:67], v220, s[32:35], 0 offen nt
  v_mov_b32_dpp v18, v112 row_newbcast:2 row_mask:0xf bank_mask:0xf
  v_cvt_f32_i32 v80, v80
  v_cvt_f32_i32 v81, v81
  v_cvt_f32_i32 v82, v82
  v_cvt_f32_i32 v83, v83
  v_pk_mul_f32 v[56:57], v[80:81], v[18:19] op_sel_hi:[1,0]
  v_pk_mul_f32 v[58:59], v[82:83], v[18:19] op_sel_hi:[1,0]
  s_cmpk_gt_i32 s69, 0x29
  s_cbranch_scc1 L_p93_3
  s_cmp_gt_i32 s69, L_order_end-L_order-16369
  s_cbranch_scc1 L_p93_2
  s_waitcnt vmcnt(6)
L_p93_2:
  s_waitcnt vmcnt(9)
L_p93_3:
  s_waitcnt vmcnt(10)
  buffer_load_dwordx4 v[68:71], v221, s[32:35], 0 offen nt
  v_mov_b32_dpp v18, v112 row_newbcast:6 row_mask:0xf bank_mask:0xf
  v_cvt_f32_i32 v84, v84
  v_cvt_f32_i32 v85, v85
  v_cvt_f32_i32 v86, v86
  v_cvt_f32_i32 v87, v87
  v_pk_mul_f32 v[52:53], v[84:85], v[18:19] op_sel_hi:[1,0]
  v_pk_mul_f32 v[54:55], v[86:87], v[18:19] op_sel_hi:[1,0]
  s_cmpk_gt_i32 s69, 0x29
  s_cbranch_scc1 L_p94_3
  s_cmp_gt_i32 s69, L_order_end-L_order-16423
  s_cbranch_scc1 L_p94_0
  s_waitcnt vmcnt(6)
L_p94_0:
  s_waitcnt vmcnt(7)
L_p94_3:
  s_waitcnt vmcnt(10)
  buffer_load_dwordx4 v[72:75], v222, s[32:35], 0 offen nt
  v_add_u32_e64 v9, s43, 16
  ds_write_b32 v14, v9 offset:28
  s_waitcnt vmcnt(8)
  s_mov_b64 exec, 3
  s_add_u32 s44, s78, 0x03030303
  v_msad_u8 v9, s78, v32, 0
  v_msad_u8 v10, s44, v32, 0
  v_msad_u8 v9, s78, v33, v9
  v_msad_u8 v10, s44, v33, v10
  v_msad_u8 v9, s78, v34, v9
  v_msad_u8 v10, s44, v34, v10
  global_store_byte v7, v8, s[30:31]
  global_load_dwordx3 v[32:34], v234, s[30:31] sc1
  v_sub_u32 v9, v9, v10
  v_add_u32 v8, 1, v8
  v_readlane_b32 s66, v9, 0
  v_readlane_b32 s67, v9, 1
  s_add_u32 s78, s78, 0x01010101
  s_mov_b64 exec, -1
  s_lshl1_add_u32 s69, s91, s95
  s_add_u32 s95, s66, s67
  s_add_u32 s69, s69, s95
  v_mov_b32_dpp v18, v112 row_newbcast:3 row_mask:0xf bank_mask:0xf
  v_cvt_f32_i32 v88, v88
  v_cvt_f32_i32 v89, v89
  v_cvt_f32_i32 v90, v90
  v_cvt_f32_i32 v91, v91
  v_pk_mul_f32 v[60:61], v[88:89], v[18:19] op_sel_hi:[1,0]
  v_pk_mul_f32 v[62:63], v[90:91], v[18:19] op_sel_hi:[1,0]
  s_cmpk_gt_i32 s69, 0x29
  s_cbranch_scc1 L_p95_3
  s_cmp_gt_i32 s69, L_order_end-L_order-16399
  s_cbranch_scc1 L_p95_1
  s_waitcnt vmcnt(5)
L_p95_1:
  s_waitcnt vmcnt(8)
L_p95_3:
  s_waitcnt vmcnt(9)
  buffer_load_dwordx4 v[76:79], v223, s[32:35], 0 offen nt
  v_mov_b32_dpp v18, v112 row_newbcast:7 row_mask:0xf bank_mask:0xf
  v_cvt_f32_i32 v92, v92
  v_cvt_f32_i32 v93, v93
  v_cvt_f32_i32 v94, v94
  v_cvt_f32_i32 v95, v95
  v_pk_fma_f32 v[56:57], v[92:93], v[18:19], v[56:57] op_sel_hi:[1,0,1]
  v_pk_fma_f32 v[58:59], v[94:95], v[18:19], v[58:59] op_sel_hi:[1,0,1]
  s_cmpk_gt_i32 s69, 0x29
  s_cbranch_scc1 L_p96_3
  s_cmp_gt_i32 s69, L_order_end-L_order-16369
  s_cbranch_scc1 L_p96_2
  s_waitcnt vmcnt(6)
L_p96_2:
  s_waitcnt vmcnt(9)
L_p96_3:
  s_waitcnt vmcnt(10)
  buffer_load_dwordx4 v[80:83], v224, s[32:35], 0 offen nt
  v_mov_b32_dpp v18, v113 row_newbcast:0 row_mask:0xf bank_mask:0xf
  v_cvt_f32_i32 v96, v96
  v_cvt_f32_i32 v97, v97
  v_cvt_f32_i32 v98, v98
  v_cvt_f32_i32 v99, v99
  v_pk_fma_f32 v[44:45], v[96:97], v[18:19], v[44:45] op_sel_hi:[1,0,1]
  v_pk_fma_f32 v[46:47], v[98:99], v[18:19], v[46:47] op_sel_hi:[1,0,1]
  s_cmpk_gt_i32 s69, 0x29
  s_cbranch_scc1 L_p97_3
  s_cmp_gt_i32 s69, L_order_end-L_order-16423
  s_cbranch_scc1 L_p97_0
  s_waitcnt vmcnt(6)
L_p97_0:
  s_waitcnt vmcnt(7)
L_p97_3:
  s_waitcnt vmcnt(10)
  buffer_load_dwordx4 v[84:87], v225, s[32:35], 0 offen nt
  s_waitcnt vmcnt(8)
  s_mov_b64 exec, 3
  s_add_u32 s44, s78, 0x03030303
  v_msad_u8 v9, s78, v36, 0
  v_msad_u8 v10, s44, v36, 0
  v_msad_u8 v9, s78, v37, v9
  v_msad_u8 v10, s44, v37, v10
  v_msad_u8 v9, s78, v38, v9
  v_msad_u8 v10, s44, v38, v10
  global_store_byte v7, v8, s[30:31]
  global_load_dwordx3 v[36:38], v235, s[30:31] sc1
  v_sub_u32 v9, v9, v10
  v_add_u32 v8, 1, v8
  v_readlane_b32 s66, v9, 0
  v_readlane_b32 s67, v9, 1
  s_add_u32 s78, s78, 0x01010101
  s_mov_b64 exec, -1
  s_lshl1_add_u32 s69, s91, s95
  s_add_u32 s95, s66, s67
  s_add_u32 s69, s69, s95
  v_mov_b32_dpp v18, v113 row_newbcast:4 row_mask:0xf bank_mask:0xf
  v_cvt_f32_i32 v100, v100
  v_cvt_f32_i32 v101, v101
  v_cvt_f32_i32 v102, v102
  v_cvt_f32_i32 v103, v103
  v_pk_fma_f32 v[40:41], v[100:101], v[18:19], v[40:41] op_sel_hi:[1,0,1]
  v_pk_fma_f32 v[42:43], v[102:103], v[18:19], v[42:43] op_sel_hi:[1,0,1]
  s_cmpk_gt_i32 s69, 0x29
  s_cbranch_scc1 L_p98_3
  s_cmp_gt_i32 s69, L_order_end-L_order-16399
  s_cbranch_scc1 L_p98_1
  s_waitcnt vmcnt(5)
L_p98_1:
  s_waitcnt vmcnt(8)
L_p98_3:
  s_waitcnt vmcnt(9)
  buffer_load_dwordx4 v[88:91], v226, s[32:35], 0 offen nt
  v_mov_b32_dpp v18, v113 row_newbcast:1 row_mask:0xf bank_mask:0xf
  v_cvt_f32_i32 v104, v104
  v_cvt_f32_i32 v105, v105
  v_cvt_f32_i32 v106, v106
  v_cvt_f32_i32 v107, v107
  v_pk_fma_f32 v[48:49], v[104:105], v[18:19], v[48:49] op_sel_hi:[1,0,1]
  v_pk_fma_f32 v[50:51], v[106:107], v[18:19], v[50:51] op_sel_hi:[1,0,1]
  s_cmpk_gt_i32 s69, 0x29
  s_cbranch_scc1 L_p99_3
  s_cmp_gt_i32 s69, L_order_end-L_order-16369
  s_cbranch_scc1 L_p99_2
  s_waitcnt vmcnt(6)
L_p99_2:
  s_waitcnt vmcnt(9)
L_p99_3:
  s_waitcnt vmcnt(10)
  buffer_load_dwordx4 v[92:95], v227, s[32:35], 0 offen nt
  v_mov_b32_dpp v18, v113 row_newbcast:5 row_mask:0xf bank_mask:0xf
  v_cvt_f32_i32 v108, v108
  v_cvt_f32_i32 v109, v109
  v_cvt_f32_i32 v110, v110
  v_cvt_f32_i32 v111, v111
  v_pk_fma_f32 v[44:45], v[108:109], v[18:19], v[44:45] op_sel_hi:[1,0,1]
  v_pk_fma_f32 v[46:47], v[110:111], v[18:19], v[46:47] op_sel_hi:[1,0,1]
  s_cmpk_gt_i32 s69, 0x29
  s_cbranch_scc1 L_p100_3
  s_cmp_gt_i32 s69, L_order_end-L_order-16423
  s_cbranch_scc1 L_p100_0
  s_waitcnt vmcnt(6)
L_p100_0:
  s_waitcnt vmcnt(7)
L_p100_3:
  s_waitcnt vmcnt(10)
  buffer_load_dwordx4 v[96:99], v228, s[32:35], 0 offen nt
  s_waitcnt vmcnt(8)
  s_mov_b64 exec, 3
  s_add_u32 s44, s78, 0x03030303
  v_msad_u8 v9, s78, v32, 0
  v_msad_u8 v10, s44, v32, 0
  v_msad_u8 v9, s78, v33, v9
  v_msad_u8 v10, s44, v33, v10
  v_msad_u8 v9, s78, v34, v9
  v_msad_u8 v10, s44, v34, v10
  global_store_byte v7, v8, s[30:31]
  global_load_dwordx3 v[32:34], v232, s[30:31] sc1
  v_sub_u32 v9, v9, v10
  v_add_u32 v8, 1, v8
  v_readlane_b32 s66, v9, 0
  v_readlane_b32 s67, v9, 1
  s_add_u32 s78, s78, 0x01010101
  s_mov_b64 exec, -1
  s_lshl1_add_u32 s69, s91, s95
  s_add_u32 s95, s66, s67
  s_add_u32 s69, s69, s95
  v_mov_b32_dpp v18, v113 row_newbcast:2 row_mask:0xf bank_mask:0xf
  v_cvt_f32_i32 v64, v64
  v_cvt_f32_i32 v65, v65
  v_cvt_f32_i32 v66, v66
  v_cvt_f32_i32 v67, v67
  v_pk_fma_f32 v[60:61], v[64:65], v[18:19], v[60:61] op_sel_hi:[1,0,1]
  v_pk_fma_f32 v[62:63], v[66:67], v[18:19], v[62:63] op_sel_hi:[1,0,1]
  s_cmpk_gt_i32 s69, 0x29
  s_cbranch_scc1 L_p101_3
  s_cmp_gt_i32 s69, L_order_end-L_order-16399
  s_cbranch_scc1 L_p101_1
  s_waitcnt vmcnt(5)
L_p101_1:
  s_waitcnt vmcnt(8)
L_p101_3:
  s_waitcnt vmcnt(9)
  buffer_load_dwordx4 v[100:103], v229, s[32:35], 0 offen nt
  v_mov_b32_dpp v18, v113 row_newbcast:6 row_mask:0xf bank_mask:0xf
  v_cvt_f32_i32 v68, v68
  v_cvt_f32_i32 v69, v69
  v_cvt_f32_i32 v70, v70
  v_cvt_f32_i32 v71, v71
  v_pk_fma_f32 v[56:57], v[68:69], v[18:19], v[56:57] op_sel_hi:[1,0,1]
  v_pk_fma_f32 v[58:59], v[70:71], v[18:19], v[58:59] op_sel_hi:[1,0,1]
  s_cmpk_gt_i32 s69, 0x29
  s_cbranch_scc1 L_p102_3
  s_cmp_gt_i32 s69, L_order_end-L_order-16369
  s_cbranch_scc1 L_p102_2
  s_waitcnt vmcnt(6)
L_p102_2:
  s_waitcnt vmcnt(9)
L_p102_3:
  s_waitcnt vmcnt(10)
  buffer_load_dwordx4 v[104:107], v230, s[32:35], 0 offen nt
  v_mov_b32_dpp v18, v113 row_newbcast:3 row_mask:0xf bank_mask:0xf
  v_cvt_f32_i32 v72, v72
  v_cvt_f32_i32 v73, v73
  v_cvt_f32_i32 v74, v74
  v_cvt_f32_i32 v75, v75
  v_pk_fma_f32 v[52:53], v[72:73], v[18:19], v[52:53] op_sel_hi:[1,0,1]
  v_pk_fma_f32 v[54:55], v[74:75], v[18:19], v[54:55] op_sel_hi:[1,0,1]
  s_cmpk_gt_i32 s69, 0x29
  s_cbranch_scc1 L_p103_3
  s_cmp_gt_i32 s69, L_order_end-L_order-16423
  s_cbranch_scc1 L_p103_0
  s_waitcnt vmcnt(6)
L_p103_0:
  s_waitcnt vmcnt(7)
L_p103_3:
  s_waitcnt vmcnt(10)
  buffer_load_dwordx4 v[108:111], v231, s[32:35], 0 offen nt
  s_cbranch_vccnz L_vtail
  ds_read_b32 v4, v14 offset:20
  s_waitcnt vmcnt(8)
  s_mov_b64 exec, 3
  s_add_u32 s44, s78, 0x03030303
  v_msad_u8 v9, s78, v36, 0
  v_msad_u8 v10, s44, v36, 0
  v_msad_u8 v9, s78, v37, v9
  v_msad_u8 v10, s44, v37, v10
  v_msad_u8 v9, s78, v38, v9
  v_msad_u8 v10, s44, v38, v10
  global_load_dwordx2 v[26:27], v11, s[30:31] sc1
  global_store_byte v7, v8, s[30:31]
  global_load_dwordx3 v[36:38], v233, s[30:31] sc1
  v_sub_u32 v9, v9, v10
  v_add_u32_e64 v8, 1, v8
  v_readlane_b32 s66, v9, 0
  v_readlane_b32 s67, v9, 1
  s_add_u32 s78, s78, 0x01010101
  s_mov_b64 exec, -1
  s_lshl1_add_u32 s69, s91, s95
  s_add_u32 s95, s66, s67
  s_add_u32 s69, s69, s95
  v_mov_b32_dpp v18, v113 row_newbcast:7 row_mask:0xf bank_mask:0xf
  v_cvt_f32_i32 v76, v76
  v_cvt_f32_i32 v77, v77
  v_cvt_f32_i32 v78, v78
  v_cvt_f32_i32 v79, v79
  v_pk_fma_f32 v[60:61], v[76:77], v[18:19], v[60:61] op_sel_hi:[1,0,1]
  v_pk_fma_f32 v[62:63], v[78:79], v[18:19], v[62:63] op_sel_hi:[1,0,1]
  s_cmpk_gt_i32 s69, 0x29
  s_cbranch_scc1 L_p104_3
  s_cmp_gt_i32 s69, L_order_end-L_order-16399
  s_cbranch_scc1 L_p104_1
  s_waitcnt vmcnt(6)
L_p104_1:
  s_waitcnt vmcnt(9)
L_p104_3:
  s_waitcnt vmcnt(10)
  buffer_load_dwordx4 v[64:67], v208, s[36:39], 0 offen nt
  v_mov_b32_dpp v18, v114 row_newbcast:0 row_mask:0xf bank_mask:0xf
  v_cvt_f32_i32 v80, v80
  v_cvt_f32_i32 v81, v81
  v_cvt_f32_i32 v82, v82
  v_cvt_f32_i32 v83, v83
  v_pk_fma_f32 v[48:49], v[80:81], v[18:19], v[48:49] op_sel_hi:[1,0,1]
  v_pk_fma_f32 v[50:51], v[82:83], v[18:19], v[50:51] op_sel_hi:[1,0,1]
  s_cmpk_gt_i32 s69, 0x29
  s_cbranch_scc1 L_p105_3
  s_cmp_gt_i32 s69, L_order_end-L_order-16369
  s_cbranch_scc1 L_p105_2
  s_waitcnt vmcnt(7)
L_p105_2:
  s_waitcnt vmcnt(10)
L_p105_3:
  s_waitcnt vmcnt(11)
  buffer_load_dwordx4 v[68:71], v209, s[36:39], 0 offen nt
  v_mov_b32_dpp v18, v114 row_newbcast:4 row_mask:0xf bank_mask:0xf
  v_cvt_f32_i32 v84, v84
  v_cvt_f32_i32 v85, v85
  v_cvt_f32_i32 v86, v86
  v_cvt_f32_i32 v87, v87
  v_pk_fma_f32 v[44:45], v[84:85], v[18:19], v[44:45] op_sel_hi:[1,0,1]
  v_pk_fma_f32 v[46:47], v[86:87], v[18:19], v[46:47] op_sel_hi:[1,0,1]
  s_cmpk_gt_i32 s69, 0x29
  s_cbranch_scc1 L_p106_3
  s_cmp_gt_i32 s69, L_order_end-L_order-16423
  s_cbranch_scc1 L_p106_0
  s_waitcnt vmcnt(7)
L_p106_0:
  s_waitcnt vmcnt(8)
L_p106_3:
  s_waitcnt vmcnt(11)
  buffer_load_dwordx4 v[72:75], v210, s[36:39], 0 offen nt
L_an:
  s_waitcnt lgkmcnt(0)
  v_readfirstlane_b32 s46, v4
  s_cmp_ge_u32 s46, s47
  s_cbranch_scc1 L_an_ok
  s_cmp_eq_u32 s94, 0
  s_cbranch_scc1 L_an_ok
  s_sub_u32 s94, s94, 1
  ds_read_b32 v4, v14 offset:20
  s_branch L_an
L_an_ok:
  ds_read_b32 v112, v120 offset:37376
  ds_read_b32 v113, v121 offset:37376
  ds_read_b32 v115, v122 offset:37376
  s_waitcnt vmcnt(9)
  s_mov_b64 exec, 3
  s_add_u32 s44, s78, 0x03030303
  v_msad_u8 v9, s78, v32, 0
  v_msad_u8 v10, s44, v32, 0
  v_msad_u8 v9, s78, v33, v9
  v_msad_u8 v10, s44, v33, v10
  v_msad_u8 v9, s78, v34, v9
  v_msad_u8 v10, s44, v34, v10
  global_store_byte v7, v8, s[30:31]
  global_load_dwordx3 v[32:34], v234, s[30:31] sc1
  v_sub_u32 v9, v9, v10
  v_add_u32 v8, 1, v8
  v_readlane_b32 s66, v9, 0
  v_readlane_b32 s67, v9, 1
  s_add_u32 s78, s78, 0x01010101
  s_mov_b64 exec, -1
  s_lshl1_add_u32 s69, s91, s95
  s_add_u32 s95, s66, s67
  s_add_u32 s69, s69, s95
  v_mov_b32_dpp v18, v114 row_newbcast:1 row_mask:0xf bank_mask:0xf
  v_cvt_f32_i32 v88, v88
  v_cvt_f32_i32 v89, v89
  v_cvt_f32_i32 v90, v90
  v_cvt_f32_i32 v91, v91
  v_pk_fma_f32 v[40:41], v[88:89], v[18:19], v[40:41] op_sel_hi:[1,0,1]
  v_pk_fma_f32 v[42:43], v[90:91], v[18:19], v[42:43] op_sel_hi:[1,0,1]
  s_cmpk_gt_i32 s69, 0x29
  s_cbranch_scc1 L_p107_3
  s_cmp_gt_i32 s69, L_order_end-L_order-16399
  s_cbranch_scc1 L_p107_1
  s_waitcnt vmcnt(5)
L_p107_1:
  s_waitcnt vmcnt(9)
L_p107_3:
  s_waitcnt vmcnt(10)
  buffer_load_dwordx4 v[76:79], v211, s[36:39], 0 offen nt
  v_mov_b32_dpp v18, v114 row_newbcast:5 row_mask:0xf bank_mask:0xf
  v_cvt_f32_i32 v92, v92
  v_cvt_f32_i32 v93, v93
  v_cvt_f32_i32 v94, v94
  v_cvt_f32_i32 v95, v95
  v_pk_fma_f32 v[48:49], v[92:93], v[18:19], v[48:49] op_sel_hi:[1,0,1]
  v_pk_fma_f32 v[50:51], v[94:95], v[18:19], v[50:51] op_sel_hi:[1,0,1]
  s_cmpk_gt_i32 s69, 0x29
  s_cbranch_scc1 L_p108_3
  s_cmp_gt_i32 s69, L_order_end-L_order-16369
  s_cbranch_scc1 L_p108_2
  s_waitcnt vmcnt(6)
L_p108_2:
  s_waitcnt vmcnt(10)
L_p108_3:
  s_waitcnt vmcnt(11)
  buffer_load_dwordx4 v[80:83], v212, s[36:39], 0 offen nt
  v_mov_b32_dpp v18, v114 row_newbcast:2 row_mask:0xf bank_mask:0xf
  v_cvt_f32_i32 v96, v96
  v_cvt_f32_i32 v97, v97
  v_cvt_f32_i32 v98, v98
  v_cvt_f32_i32 v99, v99
  v_pk_fma_f32 v[52:53], v[96:97], v[18:19], v[52:53] op_sel_hi:[1,0,1]
  v_pk_fma_f32 v[54:55], v[98:99], v[18:19], v[54:55] op_sel_hi:[1,0,1]
  s_cmpk_gt_i32 s69, 0x29
  s_cbranch_scc1 L_p109_3
  s_cmp_gt_i32 s69, L_order_end-L_order-16423
  s_cbranch_scc1 L_p109_0
  s_waitcnt vmcnt(6)
L_p109_0:
  s_waitcnt vmcnt(7)
L_p109_3:
  s_waitcnt vmcnt(11)
  buffer_load_dwordx4 v[84:87], v213, s[36:39], 0 offen nt
  s_cmp_eq_u32 s62, 0
  s_cbranch_scc1 L_flv
  v_pk_add_f32 v[52:53], v[52:53], v[44:45]
  v_pk_add_f32 v[54:55], v[54:55], v[46:47]
  v_pk_add_f32 v[56:57], v[56:57], v[48:49]
  v_pk_add_f32 v[58:59], v[58:59], v[50:51]
  v_pk_add_f32 v[60:61], v[60:61], v[40:41]
  v_pk_add_f32 v[62:63], v[62:63], v[42:43]
  s_branch L_fmv
.p2align 3
L_flv:
  v_pk_add_f32 v[52:53], v[52:53], v[40:41]
  v_pk_add_f32 v[54:55], v[54:55], v[42:43]
  v_pk_add_f32 v[56:57], v[56:57], v[44:45]
  v_pk_add_f32 v[58:59], v[58:59], v[46:47]
  v_pk_add_f32 v[60:61], v[60:61], v[48:49]
  v_pk_add_f32 v[62:63], v[62:63], v[50:51]
L_fmv:
  v_add_u32_e64 v9, s43, 16
  ds_write_b32 v14, v9 offset:24
  s_waitcnt vmcnt(8)
  s_mov_b64 exec, 3
  s_add_u32 s44, s78, 0x03030303
  v_msad_u8 v9, s78, v36, 0
  v_msad_u8 v10, s44, v36, 0
  v_msad_u8 v9, s78, v37, v9
  v_msad_u8 v10, s44, v37, v10
  v_msad_u8 v9, s78, v38, v9
  v_msad_u8 v10, s44, v38, v10
  global_store_byte v7, v8, s[30:31]
  global_load_dwordx3 v[36:38], v235, s[30:31] sc1
  v_sub_u32 v9, v9, v10
  v_add_u32 v8, 1, v8
  v_add3_u32 v10, v26, v27, s58
  v_readlane_b32 s66, v9, 0
  v_readlane_b32 s67, v9, 1
  v_readlane_b32 s91, v10, 0
  s_add_u32 s78, s78, 0x01010101
  s_mov_b64 exec, -1
  s_lshl1_add_u32 s69, s91, s95
  s_add_u32 s95, s66, s67
  s_add_u32 s69, s69, s95
  v_mov_b32_dpp v18, v114 row_newbcast:6 row_mask:0xf bank_mask:0xf
  v_cvt_f32_i32 v100, v100
  v_cvt_f32_i32 v101, v101
  v_cvt_f32_i32 v102, v102
  v_cvt_f32_i32 v103, v103
  v_pk_fma_f32 v[60:61], v[100:101], v[18:19], v[60:61] op_sel_hi:[1,0,1]
  v_pk_fma_f32 v[62:63], v[102:103], v[18:19], v[62:63] op_sel_hi:[1,0,1]
  s_cmpk_gt_i32 s69, 0x29
  s_cbranch_scc1 L_p110_3
  s_cmp_gt_i32 s69, L_order_end-L_order-16399
  s_cbranch_scc1 L_p110_1
  s_waitcnt vmcnt(5)
L_p110_1:
  s_waitcnt vmcnt(8)
L_p110_3:
  s_waitcnt vmcnt(9)
  buffer_load_dwordx4 v[88:91], v214, s[36:39], 0 offen nt
  v_mov_b32_dpp v18, v114 row_newbcast:3 row_mask:0xf bank_mask:0xf
  v_cvt_f32_i32 v104, v104
  v_cvt_f32_i32 v105, v105
  v_cvt_f32_i32 v106, v106
  v_cvt_f32_i32 v107, v107
  v_pk_fma_f32 v[56:57], v[104:105], v[18:19], v[56:57] op_sel_hi:[1,0,1]
  v_pk_fma_f32 v[58:59], v[106:107], v[18:19], v[58:59] op_sel_hi:[1,0,1]
  s_cmpk_gt_i32 s69, 0x29
  s_cbranch_scc1 L_p111_3
  s_cmp_gt_i32 s69, L_order_end-L_order-16369
  s_cbranch_scc1 L_p111_2
  s_waitcnt vmcnt(6)
L_p111_2:
  s_waitcnt vmcnt(9)
L_p111_3:
  s_waitcnt vmcnt(10)
  buffer_load_dwordx4 v[92:95], v215, s[36:39], 0 offen nt
  v_mov_b32_dpp v18, v114 row_newbcast:7 row_mask:0xf bank_mask:0xf
  v_cvt_f32_i32 v108, v108
  v_cvt_f32_i32 v109, v109
  v_cvt_f32_i32 v110, v110
  v_cvt_f32_i32 v111, v111
  v_pk_fma_f32 v[52:53], v[108:109], v[18:19], v[52:53] op_sel_hi:[1,0,1]
  v_pk_fma_f32 v[54:55], v[110:111], v[18:19], v[54:55] op_sel_hi:[1,0,1]
  s_cmpk_gt_i32 s69, 0x29
  s_cbranch_scc1 L_p112_3
  s_cmp_gt_i32 s69, L_order_end-L_order-16423
  s_cbranch_scc1 L_p112_0
  s_waitcnt vmcnt(6)
L_p112_0:
  s_waitcnt vmcnt(7)
L_p112_3:
  s_waitcnt vmcnt(10)
  buffer_load_dwordx4 v[96:99], v216, s[36:39], 0 offen nt
  s_add_u32 s43, s43, 1
  v_permlane32_swap_b32 v52, v54
  v_permlane32_swap_b32 v53, v55
  v_permlane32_swap_b32 v56, v58
  v_permlane32_swap_b32 v57, v59
  v_permlane32_swap_b32 v60, v62
  v_permlane32_swap_b32 v61, v63
  v_add_f32 v52, v52, v58
  v_add_f32 v53, v53, v59
  v_add_f32 v56, v56, v62
  v_add_f32 v57, v57, v63
  v_add_f32 v60, v60, v54
  v_add_f32 v61, v61, v55
  s_add_u32 s44, s43, 16
  s_cmp_eq_u32 s43, 15
  s_cselect_b64 vcc, -1, 0
  v_mov_b32 v4, s44
  v_permlane16_swap_b32 v52, v53
  v_permlane16_swap_b32 v56, v57
  v_permlane16_swap_b32 v60, v61
  v_add_f32 v52, v52, v61
  v_add_f32 v56, v56, v53
  v_add_f32 v60, v60, v57
  s_waitcnt lgkmcnt(0)
  ds_write_b32 v3, v52 offset:0
  ds_write_b32 v3, v56 offset:256
  ds_write_b32 v3, v60 offset:512
  ds_write_b32 v6, v4 offset:0
  v_mov_b32_e64 v114, v115
  v_add_u32 v3, 3072, v3
  s_mov_b64 s[32:33], s[36:37]
  s_add_u32 s45, s43, 1
  s_min_u32 s45, s45, 15
  s_lshl_b32 s68, s45, 2
  s_lshr_b64 s[64:65], s[92:93], s68
  s_and_b32 s68, s64, 15
  s_lshl_b32 s44, s68, 2
  s_lshr_b64 s[64:65], s[96:97], s44
  s_and_b32 s64, s64, 15
  s_lshl4_add_u32 s68, s68, s64
  s_mul_i32 s44, s68, 1572864
  s_add_u32 s36, s12, s44
  s_addc_u32 s37, s13, 0
  s_branch L_v
L_vtail:
  s_waitcnt vmcnt(10)
  v_mov_b32_dpp v18, v113 row_newbcast:7 row_mask:0xf bank_mask:0xf
  v_cvt_f32_i32 v76, v76
  v_cvt_f32_i32 v77, v77
  v_cvt_f32_i32 v78, v78
  v_cvt_f32_i32 v79, v79
  v_pk_fma_f32 v[60:61], v[76:77], v[18:19], v[60:61] op_sel_hi:[1,0,1]
  v_pk_fma_f32 v[62:63], v[78:79], v[18:19], v[62:63] op_sel_hi:[1,0,1]
  s_waitcnt vmcnt(9)
  v_mov_b32_dpp v18, v114 row_newbcast:0 row_mask:0xf bank_mask:0xf
  v_cvt_f32_i32 v80, v80
  v_cvt_f32_i32 v81, v81
  v_cvt_f32_i32 v82, v82
  v_cvt_f32_i32_e64 v83, v83
  v_pk_fma_f32 v[48:49], v[80:81], v[18:19], v[48:49] op_sel_hi:[1,0,1]
  v_pk_fma_f32 v[50:51], v[82:83], v[18:19], v[50:51] op_sel_hi:[1,0,1]
  s_waitcnt vmcnt(8)
  v_mov_b32_dpp v18, v114 row_newbcast:4 row_mask:0xf bank_mask:0xf
  v_cvt_f32_i32 v84, v84
  v_cvt_f32_i32 v85, v85
  v_cvt_f32_i32 v86, v86
  v_cvt_f32_i32_e64 v87, v87
  v_pk_fma_f32 v[44:45], v[84:85], v[18:19], v[44:45] op_sel_hi:[1,0,1]
  v_pk_fma_f32 v[46:47], v[86:87], v[18:19], v[46:47] op_sel_hi:[1,0,1]
  s_waitcnt vmcnt(6)
  v_mov_b32_dpp v18, v114 row_newbcast:1 row_mask:0xf bank_mask:0xf
  v_cvt_f32_i32 v88, v88
  v_cvt_f32_i32 v89, v89
  v_cvt_f32_i32 v90, v90
  v_cvt_f32_i32_e64 v91, v91
  v_pk_fma_f32 v[40:41], v[88:89], v[18:19], v[40:41] op_sel_hi:[1,0,1]
  v_pk_fma_f32 v[42:43], v[90:91], v[18:19], v[42:43] op_sel_hi:[1,0,1]
  s_waitcnt vmcnt(5)
  v_mov_b32_dpp v18, v114 row_newbcast:5 row_mask:0xf bank_mask:0xf
  v_cvt_f32_i32 v92, v92
  v_cvt_f32_i32 v93, v93
  v_cvt_f32_i32 v94, v94
  v_cvt_f32_i32_e64 v95, v95
  v_pk_fma_f32 v[48:49], v[92:93], v[18:19], v[48:49] op_sel_hi:[1,0,1]
  v_pk_fma_f32 v[50:51], v[94:95], v[18:19], v[50:51] op_sel_hi:[1,0,1]
  s_cmp_eq_u32 s62, 0
  s_cbranch_scc1 L_flt
  v_pk_add_f32 v[52:53], v[52:53], v[44:45]
  v_pk_add_f32 v[54:55], v[54:55], v[46:47]
  v_pk_add_f32 v[56:57], v[56:57], v[48:49]
  v_pk_add_f32 v[58:59], v[58:59], v[50:51]
  v_pk_add_f32 v[60:61], v[60:61], v[40:41]
  v_pk_add_f32 v[62:63], v[62:63], v[42:43]
  s_branch L_fmt
.p2align 3
L_flt:
  v_pk_add_f32 v[52:53], v[52:53], v[40:41]
  v_pk_add_f32 v[54:55], v[54:55], v[42:43]
  v_pk_add_f32 v[56:57], v[56:57], v[44:45]
  v_pk_add_f32 v[58:59], v[58:59], v[46:47]
  v_pk_add_f32 v[60:61], v[60:61], v[48:49]
  v_pk_add_f32 v[62:63], v[62:63], v[50:51]
L_fmt:
  s_waitcnt vmcnt(4)
  v_mov_b32_dpp v18, v114 row_newbcast:2 row_mask:0xf bank_mask:0xf
  v_cvt_f32_i32 v96, v96
  v_cvt_f32_i32 v97, v97
  v_cvt_f32_i32 v98, v98
  v_cvt_f32_i32_e64 v99, v99
  v_pk_fma_f32 v[52:53], v[96:97], v[18:19], v[52:53] op_sel_hi:[1,0,1]
  v_pk_fma_f32 v[54:55], v[98:99], v[18:19], v[54:55] op_sel_hi:[1,0,1]
  s_waitcnt vmcnt(2)
  v_mov_b32_dpp v18, v114 row_newbcast:6 row_mask:0xf bank_mask:0xf
  v_cvt_f32_i32 v100, v100
  v_cvt_f32_i32 v101, v101
  v_cvt_f32_i32 v102, v102
  v_cvt_f32_i32_e64 v103, v103
  v_pk_fma_f32 v[60:61], v[100:101], v[18:19], v[60:61] op_sel_hi:[1,0,1]
  v_pk_fma_f32 v[62:63], v[102:103], v[18:19], v[62:63] op_sel_hi:[1,0,1]
  s_waitcnt vmcnt(1)
  v_mov_b32_dpp v18, v114 row_newbcast:3 row_mask:0xf bank_mask:0xf
  v_cvt_f32_i32 v104, v104
  v_cvt_f32_i32 v105, v105
  v_cvt_f32_i32 v106, v106
  v_cvt_f32_i32_e64 v107, v107
  v_pk_fma_f32 v[56:57], v[104:105], v[18:19], v[56:57] op_sel_hi:[1,0,1]
  v_pk_fma_f32 v[58:59], v[106:107], v[18:19], v[58:59] op_sel_hi:[1,0,1]
  v_permlane32_swap_b32 v60, v62
  v_permlane32_swap_b32 v61, v63
  v_permlane32_swap_b32 v56, v58
  v_permlane32_swap_b32 v57, v59
  v_add_f32_e64 v56, v56, v62
  v_add_f32 v57, v57, v63
  s_waitcnt vmcnt(0)
  v_mov_b32_dpp v18, v114 row_newbcast:7 row_mask:0xf bank_mask:0xf
  v_cvt_f32_i32 v108, v108
  v_cvt_f32_i32 v109, v109
  v_cvt_f32_i32 v110, v110
  v_cvt_f32_i32 v111, v111
  v_pk_fma_f32 v[52:53], v[108:109], v[18:19], v[52:53] op_sel_hi:[1,0,1]
  v_pk_fma_f32 v[54:55], v[110:111], v[18:19], v[54:55] op_sel_hi:[1,0,1]
  v_permlane16_swap_b32 v56, v57
  s_nop 0
  v_permlane32_swap_b32 v52, v54
  v_permlane32_swap_b32 v53, v55
  v_add_f32 v60, v60, v54
  v_add_f32 v61, v61, v55
  v_add_f32_e64 v52, v52, v58
  v_add_f32 v53, v53, v59
  v_permlane16_swap_b32 v60, v61
  v_add_f32 v60, v60, v57
  v_permlane16_swap_b32 v52, v53
  ds_write_b32 v3, v60 offset:512
  v_add_f32 v56, v56, v53
  v_add_f32 v52, v52, v61
  ds_write_b32 v3, v56 offset:256
  ds_write_b32 v3, v52 offset:0
  s_waitcnt lgkmcnt(0)
  s_barrier
  s_endpgm
L_helper:
  s_getreg_b32 s81, hwreg(HW_REG_HW_ID, 13, 2)
  s_getreg_b32 s79, hwreg(HW_REG_HW_ID, 8, 4)
  s_getreg_b32 s46, hwreg(HW_REG_XCC_ID, 0, 3)
  s_mul_i32 s46, s46, 4352
  s_add_u32 s46, s46, 8126464
  v_lshrrev_b32_e64 v24, 1, v20
  v_lshl_add_u32 v42, v24, 8, s46
  v_and_b32_e64 v24, 1, v20
  v_lshl_add_u32 v42, v24, 4, v42
  s_mov_b64 exec, 0x3ffff
  global_store_dwordx4 v42, v[48:51], s[30:31]
  s_mov_b64 exec, -1
  s_mov_b32 s43, 2
  s_add_u32 s68, s42, 48
  s_mul_i32 s44, s68, 384
  s_add_u32 s32, s4, s44
  s_addc_u32 s33, s5, 0
  global_load_dwordx2 v[68:69], v26, s[32:33]
  global_load_dwordx2 v[70:71], v27, s[32:33]
  s_setprio 0
  s_getpc_b64 s[82:83]
L_pc113:
  s_lshl_b32 s44, s2, 6
  s_add_u32 s44, s44, L_order-L_pc113
  s_add_u32 s82, s82, s44
  s_addc_u32 s83, s83, 0
  s_load_dwordx2 s[92:93], s[82:83], 0
  s_load_dwordx2 s[96:97], s[82:83], 8
  s_mov_b32 s94, 4000000
  s_and_b32 s41, s2, 7
  s_lshl_b32 s41, s41, 1
  s_bitcmp1_b32 s2, 3
  s_addc_u32 s41, s41, 0
  s_load_dword s3, s[82:83], 24
  s_load_dwordx2 s[98:99], s[82:83], 16
  s_waitcnt vmcnt(0)
  ds_write_b32 v14, v38 offset:24
  s_waitcnt lgkmcnt(0)
  v_min_u32 v22, 2, v20
  v_lshlrev_b32 v23, 3, v22
  v_bfe_u32 v23, s99, v23, 8
  v_mul_u32_u24 v36, 4352, v23
  v_add_u32 v36, 7340032, v36
  v_and_b32 v23, 15, v23
  v_lshlrev_b32 v37, 4, v23
  v_lshl_add_u32 v22, v22, 4, s42
  v_mul_u32_u24 v45, 4352, v22
  v_add_u32 v45, 7340032, v45
  s_and_b32 s45, s81, 2
  s_lshl_b32 s44, s45, 9
  s_add_u32 s44, s44, s46
  v_add_u32 v44, s44, v20
  s_lshl_b32 s45, s45, 1
  s_add_u32 s46, s46, s45
  s_add_u32 s46, s46, 2048
  v_mov_b32_e64 v43, s46
  v_mul_u32_u24 v39, 384, v20
  v_add_u32 v39, 7864320, v39
  v_mov_b32 v40, 0
  s_mov_b32 s47, 0
  s_mov_b32 s90, 0
  s_mov_b32 s80, 0
  v_add_u32 v33, 0, v20
  s_and_b32 s44, s41, 1
  v_add_u32_e64 v23, s44, v33
  v_cmp_le_u32 vcc, 43, v23
  s_add_u32 s45, s44, 42
  v_mov_b32 v24, s45
  v_cndmask_b32 v24, 0, v24, vcc
  v_cmp_le_u32 vcc, 86, v23
  v_add_u32 v22, v33, v24
  s_sub_u32 s45, 43, s44
  v_mov_b32 v24, s45
  v_cndmask_b32 v24, 0, v24, vcc
  s_mul_i32 s44, s44, 43
  s_lshr_b32 s45, s41, 1
  s_lshl_b32 s45, s45, 8
  s_add_u32 s44, s44, s45
  v_add3_u32 v22, v22, v24, s44
  v_and_b32 v33, 255, v22
  v_lshlrev_b32 v33, 1, v33
  v_add_u32 v34, 64, v20
  s_and_b32 s44, s41, 1
  v_add_u32 v23, s44, v34
  v_cmp_le_u32 vcc, 43, v23
  s_add_u32 s45, s44, 42
  v_mov_b32 v24, s45
  v_cndmask_b32 v24, 0, v24, vcc
  v_cmp_le_u32 vcc, 86, v23
  v_add_u32 v22, v34, v24
  s_sub_u32 s45, 43, s44
  v_mov_b32 v24, s45
  v_cndmask_b32 v24, 0, v24, vcc
  s_mul_i32 s44, s44, 43
  s_lshr_b32 s45, s41, 1
  s_lshl_b32 s45, s45, 8
  s_add_u32 s44, s44, s45
  v_add3_u32 v22, v22, v24, s44
  v_and_b32 v34, 255, v22
  v_lshlrev_b32 v34, 1, v34
  v_lshlrev_b32 v46, 2, v20
  v_mul_u32_u24_e64 v199, 12, v20
  v_add_u32 v199, 45568, v199
  s_mov_b32 s101, 0
  v_mov_b32 v47, 118912
  v_mov_b32 v51, -1
  v_mov_b32 v60, 0
  v_mov_b32 v61, 0
  v_mov_b32 v62, 0
  v_mov_b32 v63, 0
  v_mov_b32 v64, 0
  v_mov_b32 v65, 0
  v_mov_b32 v66, 0
  v_mov_b32 v67, 0
  s_and_b32 s45, s2, 7
  s_lshl_b32 s45, s45, 9
  v_and_b32_e64 v22, 31, v20
  v_lshl_add_u32 v22, v22, 4, s45
  v_lshrrev_b32_e64 v23, 5, v20
  v_lshl_add_u32 v22, v23, 16, v22
  v_lshlrev_b32 v23, 2, v23
  s_lshr_b32 s44, s96, 0
  v_bfe_u32 v24, s44, v23, 4
  v_lshl_add_u32 v188, v24, 12, v22
  v_add_u32 v22, 0x20000, v22
  s_lshr_b32 s44, s96, 8
  v_bfe_u32 v24, s44, v23, 4
  v_lshl_add_u32 v189, v24, 12, v22
  v_add_u32 v22, 0x20000, v22
  s_lshr_b32 s44, s96, 16
  v_bfe_u32 v24, s44, v23, 4
  v_lshl_add_u32 v190, v24, 12, v22
  v_add_u32 v22, 0x20000, v22
  s_lshr_b32 s44, s96, 24
  v_bfe_u32 v24, s44, v23, 4
  v_lshl_add_u32 v191, v24, 12, v22
  v_add_u32 v22, 0x20000, v22
  s_lshr_b32 s44, s97, 0
  v_bfe_u32 v24, s44, v23, 4
  v_lshl_add_u32 v192, v24, 12, v22
  v_add_u32 v22, 0x20000, v22
  s_lshr_b32 s44, s97, 8
  v_bfe_u32 v24, s44, v23, 4
  v_lshl_add_u32 v193, v24, 12, v22
  v_add_u32 v22, 0x20000, v22
  s_lshr_b32 s44, s97, 16
  v_bfe_u32 v24, s44, v23, 4
  v_lshl_add_u32 v194, v24, 12, v22
  v_add_u32 v22, 0x20000, v22
  s_lshr_b32 s44, s97, 24
  v_bfe_u32 v24, s44, v23, 4
  v_lshl_add_u32 v195, v24, 12, v22
  s_mov_b32 s69, 0
  s_movk_i32 m0, 4608
  s_branch L_hq_nl
L_hk:
  s_sub_u32 s47, s43, 1
L_hsw:
  ds_read_b128 v[104:107], v14 offset:0
  s_waitcnt lgkmcnt(0)
  v_min_u32_e64 v104, v104, v105
  v_min3_u32 v104, v104, v106, v107
  s_nop 0
  v_readfirstlane_b32 s46, v104
  s_cmp_ge_u32 s46, s47
  s_cbranch_scc1 L_hsw_ok
  s_cmp_eq_u32 s94, 0
  s_cbranch_scc1 L_hsw_ok
  s_sub_u32 s94, s94, 1
  s_sleep 1
  s_branch L_hsw
L_hsw_ok:
  s_bitcmp1_b32 s80, s47
  s_cbranch_scc0 L_fas
  s_mul_i32 s44, s47, 384
  s_add_u32 s44, s44, 7864320
  s_movk_i32 s78, 1
  s_atomic_add s78, s[30:31], s44 glc
  s_mov_b64 exec, 1
  global_load_dword v41, v43, s[30:31] offset:8 sc1
  s_mov_b64 exec, -1
L_fas:
  s_cmp_lt_u32 s43, 6
  s_cbranch_scc1 L_hs_done
  s_add_u32 s68, s69, 2
  s_min_u32 s68, s68, s47
L_hs:
  ds_read_u16_d16_hi v60, v33 offset:4608
  ds_read_u16_d16_hi v61, v34 offset:4608
  ds_read_u16_d16_hi v62, v33 offset:12800
  ds_read_u16_d16_hi v63, v34 offset:12800
  ds_read_u16_d16_hi v64, v33 offset:20992
  ds_read_u16_d16_hi v65, v34 offset:20992
  ds_read_u16_d16_hi v66, v33 offset:29184
  ds_read_u16_d16_hi v67, v34 offset:29184
  v_add_u32_e64 v200, s101, v199
  v_add_u32 v201, 1536, v200
  s_addk_i32 s101, 3072
  s_cmpk_eq_u32 s101, 18432
  s_cselect_b32 s101, 0, s101
  s_add_u32 s69, s69, 1
  s_waitcnt lgkmcnt(4)
  ds_read2_b32 v[76:77], v200 offset0:0 offset1:1
  ds_read_b32 v72, v200 offset:8
  ds_read2_b32 v[78:79], v200 offset0:192 offset1:193
  ds_read_b32 v73, v200 offset:776
  ds_read2_b32 v[80:81], v201 offset0:0 offset1:1
  ds_read_b32 v74, v201 offset:8
  ds_read2_b32 v[82:83], v201 offset0:192 offset1:193
  ds_read_b32 v75, v201 offset:776
  s_waitcnt lgkmcnt(0)
  v_add_f32 v76, v76, v77
  v_add_f32 v78, v78, v79
  v_add_f32 v80, v80, v81
  v_add_f32 v82, v82, v83
  v_add_f32 v72, v72, v76
  v_add_f32 v73, v73, v78
  v_add_f32 v74, v74, v80
  v_add_f32 v75, v75, v82
  v_fma_f32 v72, -v62, v74, v72
  v_fma_f32 v73, -v63, v75, v73
  v_mul_f32 v74, s67, v60
  v_mul_f32 v75, s67, v61
  v_mul_f32 v72, v72, v74
  v_mul_f32 v73, v73, v75
  v_max_f32 v48, v72, v73
  s_nop 1
  v_max_f32_dpp v48, v48, v48 row_ror:8 row_mask:0xf bank_mask:0xf
  s_nop 1
  v_max_f32_dpp v48, v48, v48 row_ror:4 row_mask:0xf bank_mask:0xf
  s_nop 1
  v_max_f32_dpp v48, v48, v48 row_ror:2 row_mask:0xf bank_mask:0xf
  s_nop 1
  v_max_f32_dpp v48, v48, v48 row_ror:1 row_mask:0xf bank_mask:0xf
  v_mov_b32 v22, v48
  s_nop 1
  v_permlane16_swap_b32 v48, v22
  v_max_f32 v48, v48, v22
  v_mov_b32 v22, v48
  s_nop 1
  v_permlane32_swap_b32 v48, v22
  v_max_f32 v48, v48, v22
  v_sub_f32 v72, v72, v48
  v_sub_f32 v73, v73, v48
  v_exp_f32 v72, v72
  v_exp_f32 v73, v73
  s_nop 0
  v_add_f32 v49, v72, v73
  v_mul_f32 v72, v72, v64
  v_mul_f32 v73, v73, v65
  v_mul_f32 v50, v72, v66
  v_fmac_f32_e64 v50, v73, v67
  ds_write_b32 v46, v72 offset:37376
  ds_write_b32 v46, v73 offset:37632
  s_nop 1
  v_add_f32_dpp v49, v49, v49 row_ror:8 row_mask:0xf bank_mask:0xf
  s_nop 1
  v_add_f32_dpp v49, v49, v49 row_ror:4 row_mask:0xf bank_mask:0xf
  s_nop 1
  v_add_f32_dpp v49, v49, v49 row_ror:2 row_mask:0xf bank_mask:0xf
  s_nop 1
  v_add_f32_dpp v49, v49, v49 row_ror:1 row_mask:0xf bank_mask:0xf
  v_mov_b32 v22, v49
  s_nop 1
  v_permlane16_swap_b32 v49, v22
  v_add_f32 v49, v49, v22
  v_mov_b32_e64 v22, v49
  s_nop 1
  v_permlane32_swap_b32 v49, v22
  v_add_f32 v49, v49, v22
  s_nop 1
  v_add_f32_dpp v50, v50, v50 row_ror:8 row_mask:0xf bank_mask:0xf
  s_nop 1
  v_add_f32_dpp v50, v50, v50 row_ror:4 row_mask:0xf bank_mask:0xf
  s_nop 1
  v_add_f32_dpp v50, v50, v50 row_ror:2 row_mask:0xf bank_mask:0xf
  s_nop 1
  v_add_f32_dpp v50, v50, v50 row_ror:1 row_mask:0xf bank_mask:0xf
  v_mov_b32 v22, v50
  s_nop 1
  v_permlane16_swap_b32 v50, v22
  v_add_f32 v50, v50, v22
  v_mov_b32 v22, v50
  s_nop 1
  v_permlane32_swap_b32 v50, v22
  v_add_f32 v50, v50, v22
  v_mov_b32 v22, s69
  ds_write_b128 v47, v[48:51]
  ds_write_b32 v14, v22 offset:20
  v_add_u32 v46, 512, v46
  v_add_u32_e64 v47, 16, v47
  v_add_u32 v33, 512, v33
  v_add_u32 v34, 512, v34
  s_cmp_lt_u32 s69, s68
  s_cbranch_scc1 L_hs
L_hs_done:
  s_bitcmp1_b32 s80, s47
  s_cbranch_scc0 L_fbs
  s_waitcnt vmcnt(0) lgkmcnt(0)
  v_readlane_b32 s46, v40, s47
  s_sub_u32 s78, s78, s46
  s_bfe_u32 s46, s78, 0x80000
  s_min_u32 s46, s46, 15
  s_lshl_b32 s46, s46, 1
  s_sub_u32 s46, s46, 15
  v_readfirstlane_b32 s95, v41
  s_mul_i32 s45, s46, 6
  s_ashr_i32 s44, s95, 3
  s_sub_u32 s95, s95, s44
  s_cmp_lt_i32 s46, 0
  s_cselect_b32 s95, s95, 0
  s_cselect_b32 s45, -48, 0
  s_add_u32 s45, s45, s95
  v_mov_b32_e64 v41, s45
  s_lshl4_add_u32 s46, s46, s95
  s_cmp_gt_i32 s46, 0
  s_cselect_b32 s44, 3, 6
  s_mul_i32 s46, s46, s44
  s_add_u32 s46, s46, 128
  s_ashr_i32 s46, s46, 8
  v_mov_b32_e64 v42, s46
  s_mov_b64 exec, 1
  global_store_dword v43, v42, s[30:31]
  global_store_dword v43, v41, s[30:31] offset:8
  s_mov_b64 exec, -1
L_fbs:
  s_cmp_eq_u32 s47, 1
  s_cbranch_scc0 L_el
  s_bitcmp0_b32 s81, 0
  s_cbranch_scc0 L_el
  s_mov_b64 exec, 0xffff
  global_load_ubyte v42, v44, s[30:31] sc1
  s_waitcnt vmcnt(0)
  v_cmp_ne_u32 s[64:65], 0, v42
  s_lshr_b32 s44, s64, s79
  s_bcnt1_i32_b32 s44, s44
  s_sub_u32 s45, s44, 1
  s_cmp_lt_u32 s45, 7
  s_cbranch_scc0 L_el
  s_lshl_b32 s80, 0x10204081, s45
  s_and_b32 s80, s80, 0x7ffffffc
  s_mov_b32 exec_lo, s80
  global_load_dword v40, v39, s[30:31] sc1
L_el:
  s_mov_b64 exec, -1
L_hq:
  s_add_u32 s43, s43, 1
  s_sub_u32 s44, s43, 4
  s_cmp_gt_u32 s44, 12
  s_cbranch_scc1 L_hq_nl
  s_waitcnt vmcnt(0)
  v_lshlrev_b32 v76, 16, v68
  v_and_b32 v77, s66, v68
  v_lshlrev_b32 v78, 16, v69
  v_and_b32 v79, s66, v69
  v_lshlrev_b32 v80, 16, v70
  v_and_b32 v81, s66, v70
  v_lshlrev_b32 v82, 16, v71
  v_and_b32 v83, s66, v71
  v_mul_f32 v76, v76, v52
  v_mul_f32 v77, v77, v53
  v_mul_f32 v78, v78, v54
  v_mul_f32 v79, v79, v55
  v_mul_f32 v80, v80, v56
  v_mul_f32 v81, v81, v57
  v_mul_f32 v82, v82, v58
  v_mul_f32 v83, v83, v59
  v_cvt_pk_bf16_f32 v84, v76, v80
  v_cvt_pk_bf16_f32 v85, v77, v81
  v_cvt_pk_bf16_f32 v86, v78, v82
  v_cvt_pk_bf16_f32 v87, v79, v83
  v_lshlrev_b32 v76, 16, v84
  v_and_b32 v80, s66, v84
  v_lshlrev_b32 v77, 16, v85
  v_and_b32 v81, s66, v85
  v_lshlrev_b32 v78, 16, v86
  v_and_b32 v82, s66, v86
  v_lshlrev_b32 v79, 16, v87
  v_and_b32 v83, s66, v87
  v_fma_f32 v76, v80, v30, v76
  v_fma_f32 v77, v81, v30, v77
  v_fma_f32 v78, v82, v30, v78
  v_fma_f32 v79, v83, v30, v79
  v_cvt_pk_bf16_f32 v84, v76, v77
  v_cvt_pk_bf16_f32 v85, v78, v79
  v_xor_b32 v86, v31, v84
  v_xor_b32 v87, v31, v85
  v_mov_b32_e64 v22, s43
  ds_write_b16 v28, v84 offset:512
  ds_write_b16_d16_hi v28, v84 offset:516
  ds_write_b16 v28, v85 offset:520
  ds_write_b16_d16_hi v28, v85 offset:524
  ds_write_b16 v29, v86 offset:514
  ds_write_b16_d16_hi v29, v86 offset:518
  ds_write_b16 v29, v87 offset:522
  ds_write_b16_d16_hi v29, v87 offset:526
  ds_write_b32 v14, v22 offset:16
  v_add_u32 v28, 1024, v28
  v_add_u32 v29, 1024, v29
  v_and_b32 v28, 0xfff, v28
  v_and_b32 v29, 0xfff, v29
  s_cmp_eq_u32 s43, 16
  s_cbranch_scc1 L_hq_nl
  s_lshl_b32 s44, s43, 2
  s_lshr_b64 s[64:65], s[96:97], s44
  s_and_b32 s64, s64, 15
  s_lshl4_add_u32 s68, s43, s64
  s_mul_i32 s44, s68, 384
  s_add_u32 s32, s4, s44
  s_addc_u32 s33, s5, 0
  global_load_dwordx2 v[68:69], v26, s[32:33]
  global_load_dwordx2 v[70:71], v27, s[32:33]
L_hq_nl:
  s_sub_u32 s44, s43, 5
  s_cmp_lt_u32 s44, 2
  s_cbranch_scc0 L_sc_done
  global_load_lds_dwordx4 v188, s[8:9]
  s_addk_i32 m0, 1024
  s_waitcnt vmcnt(3)
  global_load_lds_dwordx4 v189, s[8:9]
  s_addk_i32 m0, 1024
  s_waitcnt vmcnt(3)
  global_load_lds_dwordx4 v190, s[8:9]
  s_addk_i32 m0, 1024
  s_waitcnt vmcnt(3)
  global_load_lds_dwordx4 v191, s[8:9]
  s_addk_i32 m0, 1024
  s_waitcnt vmcnt(3)
  global_load_lds_dwordx4 v192, s[8:9]
  s_addk_i32 m0, 1024
  s_waitcnt vmcnt(3)
  global_load_lds_dwordx4 v193, s[8:9]
  s_addk_i32 m0, 1024
  s_waitcnt vmcnt(3)
  global_load_lds_dwordx4 v194, s[8:9]
  s_addk_i32 m0, 1024
  s_waitcnt vmcnt(3)
  global_load_lds_dwordx4 v195, s[8:9]
  s_addk_i32 m0, 1024
  s_mov_b64 s[8:9], s[10:11]
  s_mov_b64 s[10:11], s[14:15]
  s_mov_b64 s[14:15], s[16:17]
  s_waitcnt vmcnt(3)
  global_load_lds_dwordx4 v188, s[8:9]
  s_addk_i32 m0, 1024
  s_waitcnt vmcnt(3)
  global_load_lds_dwordx4 v189, s[8:9]
  s_addk_i32 m0, 1024
  s_waitcnt vmcnt(3)
  global_load_lds_dwordx4 v190, s[8:9]
  s_addk_i32 m0, 1024
  s_waitcnt vmcnt(3)
  global_load_lds_dwordx4 v191, s[8:9]
  s_addk_i32 m0, 1024
  s_waitcnt vmcnt(3)
  global_load_lds_dwordx4 v192, s[8:9]
  s_addk_i32 m0, 1024
  s_waitcnt vmcnt(3)
  global_load_lds_dwordx4 v193, s[8:9]
  s_addk_i32 m0, 1024
  s_waitcnt vmcnt(3)
  global_load_lds_dwordx4 v194, s[8:9]
  s_addk_i32 m0, 1024
  s_waitcnt vmcnt(3)
  global_load_lds_dwordx4 v195, s[8:9]
  s_addk_i32 m0, 1024
  s_mov_b64 s[8:9], s[10:11]
  s_mov_b64 s[10:11], s[14:15]
  s_mov_b64 s[14:15], s[16:17]
  s_cmp_eq_u32 s43, 6
  s_cbranch_scc0 L_sc_done
  s_waitcnt vmcnt(0)
L_sc_done:
  s_cmp_eq_u32 s43, 16
  s_cbranch_scc0 L_hq_skip
  s_cmp_eq_u32 s3, 0
  s_cbranch_scc0 L_hq_skip
  s_mov_b64 exec, 7
  global_store_dword v45, v14, s[30:31] sc1
  s_waitcnt vmcnt(0)
  s_mov_b64 exec, 1
  global_store_dword v37, v38, s[28:29] sc1
  s_mov_b64 exec, -1
L_hq_skip:
  s_waitcnt lgkmcnt(0)
  s_cmp_lt_u32 s43, 18
  s_cbranch_scc1 L_hk
  v_and_b32 v24, 15, v20
  v_lshlrev_b32 v24, 1, v24
  global_load_ushort v25, v24, s[82:83] offset:32
  s_mov_b32 s43, 0
  v_min_u32 v28, 23, v20
  v_lshlrev_b32_e64 v28, 4, v28
  v_lshlrev_b32 v22, 1, v28
  s_and_b32 s44, s41, 1
  v_lshl_add_u32 v196, s44, 8, v22
  v_subrev_u32 v197, 768, v196
  v_min_u32_e64 v196, v196, v197
  v_subrev_u32 v29, 256, v196
  v_add_u32 v197, 512, v196
  v_min_u32_e64 v197, v29, v197
  v_subrev_u32 v29, 512, v196
  v_add_u32 v198, 256, v196
  v_min_u32_e64 v198, v29, v198
  v_add_u32 v196, 64000, v196
  v_add_u32 v197, 64000, v197
  v_add_u32 v198, 64000, v198
  v_add_u32 v28, 113152, v28
  v_lshlrev_b32_e64 v32, 4, v20
  v_add_u32 v30, 113152, v32
  v_cmp_gt_u32 vcc, 24, v20
  v_lshrrev_b32 v21, 1, v35
  s_mul_i32 s44, s98, 384
  s_add_u32 s26, s26, s44
  s_addc_u32 s27, s27, 0
  v_mov_b32_e64 v31, s2
  v_mul_u32_u24 v31, 6144, v31
  v_add_u32 v31, 8388608, v31
  v_add_u32 v23, 0, v32
  v_add_u32 v188, v23, v31
  v_add_u32 v23, 1024, v32
  v_add_u32_e64 v189, v23, v31
  v_add_u32 v23, 2048, v32
  v_add_u32_e64 v190, v23, v31
  v_add_u32 v23, 3072, v32
  v_add_u32_e64 v191, v23, v31
  v_add_u32 v23, 4096, v32
  v_add_u32_e64 v192, v23, v31
  v_add_u32 v23, 5120, v32
  v_add_u32_e64 v193, v23, v31
  s_mov_b32 s45, 14
  s_lshl_b32 s68, s45, 2
  s_lshr_b64 s[64:65], s[92:93], s68
  s_and_b32 s68, s64, 15
  v_lshl_add_u32 v23, s68, 4, v32
  v_cndmask_b32 v23, v23, v32, vcc
  v_add_u32 v23, 5376, v23
  v_add_u32 v168, v23, v31
  s_waitcnt vmcnt(0)
  v_lshrrev_b32 v31, 4, v25
  v_mul_u32_u24 v31, 6144, v31
  v_add_u32 v31, 8388608, v31
  v_and_b32_e64 v25, 15, v25
  v_mul_u32_u24 v25, 384, v25
  s_lshl4_add_u32 s44, s3, 5760
  v_mov_b32 v23, s44
  v_add_u32 v187, v23, v31
  v_add_u32_dpp v23, v25, v21 row_newbcast:0 row_mask:0xf bank_mask:0xf
  v_mov_b32_dpp v29, v31 row_newbcast:0 row_mask:0xf bank_mask:0xf
  v_add_u32_e64 v172, v23, v29
  v_add_u32_dpp v23, v25, v21 row_newbcast:1 row_mask:0xf bank_mask:0xf
  v_mov_b32_dpp v29, v31 row_newbcast:1 row_mask:0xf bank_mask:0xf
  v_add_u32_e64 v173, v23, v29
  v_add_u32_dpp v23, v25, v21 row_newbcast:2 row_mask:0xf bank_mask:0xf
  v_mov_b32_dpp v29, v31 row_newbcast:2 row_mask:0xf bank_mask:0xf
  v_add_u32_e64 v174, v23, v29
  v_add_u32_dpp v23, v25, v21 row_newbcast:3 row_mask:0xf bank_mask:0xf
  v_mov_b32_dpp v29, v31 row_newbcast:3 row_mask:0xf bank_mask:0xf
  v_add_u32_e64 v175, v23, v29
  v_add_u32_dpp v23, v25, v21 row_newbcast:4 row_mask:0xf bank_mask:0xf
  v_mov_b32_dpp v29, v31 row_newbcast:4 row_mask:0xf bank_mask:0xf
  v_add_u32_e64 v176, v23, v29
  v_add_u32_dpp v23, v25, v21 row_newbcast:5 row_mask:0xf bank_mask:0xf
  v_mov_b32_dpp v29, v31 row_newbcast:5 row_mask:0xf bank_mask:0xf
  v_add_u32_e64 v177, v23, v29
  v_add_u32_dpp v23, v25, v21 row_newbcast:6 row_mask:0xf bank_mask:0xf
  v_mov_b32_dpp v29, v31 row_newbcast:6 row_mask:0xf bank_mask:0xf
  v_add_u32_e64 v178, v23, v29
  v_add_u32_dpp v23, v25, v21 row_newbcast:7 row_mask:0xf bank_mask:0xf
  v_mov_b32_dpp v29, v31 row_newbcast:7 row_mask:0xf bank_mask:0xf
  v_add_u32_e64 v179, v23, v29
  v_add_u32_dpp v23, v25, v21 row_newbcast:8 row_mask:0xf bank_mask:0xf
  v_mov_b32_dpp v29, v31 row_newbcast:8 row_mask:0xf bank_mask:0xf
  v_add_u32_e64 v180, v23, v29
  v_add_u32_dpp v23, v25, v21 row_newbcast:9 row_mask:0xf bank_mask:0xf
  v_mov_b32_dpp v29, v31 row_newbcast:9 row_mask:0xf bank_mask:0xf
  v_add_u32_e64 v181, v23, v29
  v_add_u32_dpp v23, v25, v21 row_newbcast:10 row_mask:0xf bank_mask:0xf
  v_mov_b32_dpp v29, v31 row_newbcast:10 row_mask:0xf bank_mask:0xf
  v_add_u32_e64 v182, v23, v29
  v_add_u32_dpp v23, v25, v21 row_newbcast:11 row_mask:0xf bank_mask:0xf
  v_mov_b32_dpp v29, v31 row_newbcast:11 row_mask:0xf bank_mask:0xf
  v_add_u32_e64 v183, v23, v29
  v_add_u32_dpp v23, v25, v21 row_newbcast:12 row_mask:0xf bank_mask:0xf
  v_mov_b32_dpp v29, v31 row_newbcast:12 row_mask:0xf bank_mask:0xf
  v_add_u32_e64 v184, v23, v29
  v_add_u32_dpp v23, v25, v21 row_newbcast:13 row_mask:0xf bank_mask:0xf
  v_mov_b32_dpp v29, v31 row_newbcast:13 row_mask:0xf bank_mask:0xf
  v_add_u32_e64 v185, v23, v29
  v_add_u32_dpp v23, v25, v21 row_newbcast:14 row_mask:0xf bank_mask:0xf
  v_mov_b32_dpp v29, v31 row_newbcast:14 row_mask:0xf bank_mask:0xf
  v_add_u32 v186, v23, v29
  v_mov_b32 v108, -1
  v_mov_b32 v109, -1
  v_mov_b32 v110, -1
  v_mov_b32_e64 v111, -1
  s_lshl4_add_u32 s44, s3, 118912
  v_mov_b32_e64 v23, s44
  ds_write_b128 v28, v[108:111] offset:5376
  ds_write_b32 v23, v38 offset:12
L_hp:
  s_min_u32 s44, s3, 13
  s_cmp_eq_u32 s44, s43
  s_cbranch_scc0 L_hc_ok
L_hc:
  global_load_dword v104, v37, s[28:29] sc1
  s_waitcnt vmcnt(0)
  v_cmp_ne_u32 s[64:65], 1, v104
  s_cmp_eq_u64 s[64:65], 0
  s_cbranch_scc1 L_hc_ok
  s_cmp_eq_u32 s94, 0
  s_cbranch_scc1 L_hc_ok
  s_sub_u32 s94, s94, 1
  s_sleep 64
  s_branch L_hc
L_hc_ok:
  s_lshl_b32 s68, s43, 2
  s_lshr_b64 s[64:65], s[92:93], s68
  s_and_b32 s68, s64, 15
  s_lshl4_add_u32 s44, s68, 118912
  v_mov_b32_e64 v23, s44
  s_cmp_eq_u32 s43, 14
  s_cbranch_scc0 L_hp_mid
  ds_read_b128 v[144:147], v30 offset:0
  ds_read_b128 v[148:151], v30 offset:1024
  ds_read_b128 v[152:155], v30 offset:2048
  ds_read_b128 v[156:159], v30 offset:3072
  ds_read_b128 v[160:163], v30 offset:4096
  ds_read_b128 v[164:167], v30 offset:5120
L_hm:
  ds_read_b32 v104, v14 offset:24
  s_waitcnt lgkmcnt(0)
  v_readfirstlane_b32 s46, v104
  s_cmp_ge_u32 s46, 30
  s_cbranch_scc1 L_hm_ok
  s_cmp_eq_u32 s94, 0
  s_cbranch_scc1 L_hm_ok
  s_sub_u32 s94, s94, 1
  s_sleep 1
  s_branch L_hm
L_hm_ok:
  global_store_dwordx4 v188, v[144:147], s[30:31] sc1
  global_store_dwordx4 v189, v[148:151], s[30:31] sc1
  global_store_dwordx4 v190, v[152:155], s[30:31] sc1
  global_store_dwordx4 v191, v[156:159], s[30:31] sc1
  global_store_dwordx4 v192, v[160:163], s[30:31] sc1
  s_mov_b32 exec_hi, 0xffffff
  global_store_dwordx4 v193, v[164:167], s[30:31] sc1
  s_mov_b64 exec, 7
  s_waitcnt vmcnt(0)
  global_atomic_add v36, v38, s[30:31] sc1
  s_mov_b64 exec, -1
L_hp_mid:
  s_add_u32 s43, s43, 1
  s_add_u32 s47, s43, 16
L_hpw:
  ds_read_b128 v[104:107], v14 offset:0
  s_waitcnt lgkmcnt(0)
  v_min_u32 v104, v104, v105
  v_min3_u32 v104, v104, v106, v107
  s_nop 0
  v_readfirstlane_b32 s46, v104
  s_cmp_ge_u32 s46, s47
  s_cbranch_scc1 L_hpw_ok
  s_cmp_eq_u32 s94, 0
  s_cbranch_scc1 L_hpw_ok
  s_sub_u32 s94, s94, 1
  s_sleep 1
  s_branch L_hpw
L_hpw_ok:
  s_bitcmp1_b32 s80, s47
  s_cbranch_scc0 L_fap
  s_mul_i32 s44, s47, 384
  s_add_u32 s44, s44, 7864320
  s_movk_i32 s78, 1
  s_atomic_add s78, s[30:31], s44 glc
  s_mov_b64 exec, 1
  global_load_dword v41, v43, s[30:31] offset:8 sc1
  s_mov_b64 exec, -1
L_fap:
  ds_read_b128 v[72:75], v196 offset:0
  ds_read_b128 v[76:79], v196 offset:16
  ds_read_b128 v[80:83], v197 offset:768
  ds_read_b128 v[84:87], v197 offset:784
  ds_read_b128 v[88:91], v197 offset:1536
  ds_read_b128 v[92:95], v197 offset:1552
  ds_read_b128 v[96:99], v198 offset:2304
  ds_read_b128 v[100:103], v198 offset:2320
  ds_read_b128 v[48:51], v23
  s_waitcnt lgkmcnt(0)
  v_pk_add_f32 v[72:73], v[72:73], v[80:81]
  v_pk_add_f32 v[88:89], v[88:89], v[96:97]
  v_pk_add_f32 v[74:75], v[74:75], v[82:83]
  v_pk_add_f32 v[90:91], v[90:91], v[98:99]
  v_pk_add_f32 v[76:77], v[76:77], v[84:85]
  v_pk_add_f32 v[92:93], v[92:93], v[100:101]
  v_pk_add_f32 v[78:79], v[78:79], v[86:87]
  v_pk_add_f32 v[94:95], v[94:95], v[102:103]
  v_pk_add_f32 v[72:73], v[72:73], v[88:89]
  v_pk_add_f32 v[74:75], v[74:75], v[90:91]
  v_pk_add_f32 v[76:77], v[76:77], v[92:93]
  v_pk_add_f32 v[78:79], v[78:79], v[94:95]
  v_pk_add_f32 v[72:73], v[72:73], v[50:51] op_sel_hi:[1,0] neg_lo:[0,1] neg_hi:[0,1]
  v_pk_add_f32 v[74:75], v[74:75], v[50:51] op_sel_hi:[1,0] neg_lo:[0,1] neg_hi:[0,1]
  v_pk_add_f32 v[76:77], v[76:77], v[50:51] op_sel_hi:[1,0] neg_lo:[0,1] neg_hi:[0,1]
  v_pk_add_f32 v[78:79], v[78:79], v[50:51] op_sel_hi:[1,0] neg_lo:[0,1] neg_hi:[0,1]
  v_max3_f32 v25, |v72|, |v73|, |v74|
  v_max3_f32 v25, v25, |v75|, |v76|
  v_max3_f32 v25, v25, |v77|, |v78|
  v_max_f32_e64 v25, v25, |v79|
  s_nop 1
  v_max_f32_dpp v25, v25, v25 row_ror:8 row_mask:0xf bank_mask:0xf
  s_nop 1
  v_max_f32_dpp v25, v25, v25 row_ror:4 row_mask:0xf bank_mask:0xf
  s_nop 1
  v_max_f32_dpp v25, v25, v25 row_ror:2 row_mask:0xf bank_mask:0xf
  s_nop 1
  v_max_f32_dpp v25, v25, v25 row_ror:1 row_mask:0xf bank_mask:0xf
  v_mov_b32 v29, v25
  s_nop 1
  v_permlane16_swap_b32 v25, v29
  v_max_f32 v25, v25, v29
  v_mov_b32 v29, v25
  s_nop 1
  v_permlane32_swap_b32 v25, v29
  v_max_f32 v25, v25, v29
  v_frexp_exp_i32_f32 v25, v25
  v_sub_u32_e64 v29, 14, v25
  v_add_u32 v51, 242, v25
  v_ldexp_f32 v72, v72, v29
  v_ldexp_f32 v73, v73, v29
  v_ldexp_f32 v74, v74, v29
  v_ldexp_f32 v75, v75, v29
  v_ldexp_f32 v76, v76, v29
  v_ldexp_f32 v77, v77, v29
  v_ldexp_f32 v78, v78, v29
  v_ldexp_f32 v79, v79, v29
  v_cvt_pk_f16_f32 v108, v72, v73
  v_cvt_pk_f16_f32 v109, v74, v75
  v_cvt_pk_f16_f32 v110, v76, v77
  v_cvt_pk_f16_f32 v111, v78, v79
  v_min_u32 v108, -2, v108
  v_min_u32 v109, -2, v109
  v_min_u32 v110, -2, v110
  v_min_u32 v111, -2, v111
  s_cmp_eq_u32 s43, 15
  s_cbranch_scc1 L_hp_last
  ds_write_b32 v23, v51 offset:12
  v_add_u32 v196, 3072, v196
  v_add_u32 v197, 3072, v197
  v_add_u32 v198, 3072, v198
  ds_write_b128 v28, v[108:111]
  v_add_u32 v28, 384, v28
  s_bitcmp1_b32 s80, s47
  s_cbranch_scc0 L_fbp
  s_waitcnt vmcnt(0) lgkmcnt(0)
  v_readlane_b32 s46, v40, s47
  s_sub_u32 s78, s78, s46
  s_bfe_u32 s46, s78, 0x80000
  s_min_u32 s46, s46, 15
  s_lshl_b32 s46, s46, 1
  s_sub_u32 s46, s46, 15
  v_readfirstlane_b32 s95, v41
  s_mul_i32 s45, s46, 6
  s_ashr_i32 s44, s95, 3
  s_sub_u32 s95, s95, s44
  s_cmp_lt_i32 s46, 0
  s_cselect_b32 s95, s95, 0
  s_cselect_b32 s45, -48, 0
  s_add_u32 s45, s45, s95
  v_mov_b32_e64 v41, s45
  s_lshl4_add_u32 s46, s46, s95
  s_cmp_gt_i32 s46, 0
  s_cselect_b32 s44, 3, 6
  s_mul_i32 s46, s46, s44
  s_add_u32 s46, s46, 128
  s_ashr_i32 s46, s46, 8
  v_mov_b32_e64 v42, s46
  s_mov_b64 exec, 1
  global_store_dword v43, v42, s[30:31]
  global_store_dword v43, v41, s[30:31] offset:8
  s_mov_b64 exec, -1
L_fbp:
  s_branch L_hp
L_hp_last:
  v_cndmask_b32 v108, v48, v108, vcc
  v_cndmask_b32 v109, v49, v109, vcc
  v_cndmask_b32 v110, v50, v110, vcc
  v_cndmask_b32 v111, v51, v111, vcc
  s_mov_b64 exec, 0x1ffffff
  global_store_dwordx4 v168, v[108:111], s[30:31] sc1
  s_mov_b64 exec, -1
  s_and_b32 s44, s41, 1
  v_lshl_add_u32 v196, s44, 8, v35
  v_subrev_u32 v197, 768, v196
  v_min_u32_e64 v196, v196, v197
  v_subrev_u32 v29, 256, v196
  v_add_u32 v197, 512, v196
  v_min_u32_e64 v197, v29, v197
  v_subrev_u32 v29, 512, v196
  v_add_u32 v198, 256, v196
  v_min_u32_e64 v198, v29, v198
  v_add_u32 v196, 110080, v196
  v_add_u32 v197, 110080, v197
  v_add_u32 v198, 110080, v198
L_hn:
  ds_read_b32 v104, v14 offset:28
  s_waitcnt lgkmcnt(0)
  v_readfirstlane_b32 s46, v104
  s_cmp_ge_u32 s46, 31
  s_cbranch_scc1 L_hn_ok
  s_cmp_eq_u32 s94, 0
  s_cbranch_scc1 L_hn_ok
  s_sub_u32 s94, s94, 1
  s_sleep 1
  s_branch L_hn
L_hn_ok:
  s_mov_b64 exec, 1
L_hw:
  global_atomic_add v68, v36, v14, s[30:31] sc0 sc1
  s_waitcnt vmcnt(0)
  v_readfirstlane_b32 s46, v68
  s_cmp_ge_u32 s46, 16
  s_cbranch_scc1 L_hw_ok
  s_cmp_eq_u32 s94, 0
  s_cbranch_scc1 L_hw_ok
  s_sub_u32 s94, s94, 1
  s_branch L_hw
L_hw_ok:
  s_mov_b64 exec, -1
L_hg:
  global_load_dwordx4 v[52:55], v187, s[30:31] sc1
  global_load_dwordx2 v[112:113], v172, s[30:31] sc1
  global_load_dwordx2 v[114:115], v173, s[30:31] sc1
  global_load_dwordx2 v[116:117], v174, s[30:31] sc1
  global_load_dwordx2 v[118:119], v175, s[30:31] sc1
  global_load_dwordx2 v[120:121], v176, s[30:31] sc1
  global_load_dwordx2 v[122:123], v177, s[30:31] sc1
  global_load_dwordx2 v[124:125], v178, s[30:31] sc1
  global_load_dwordx2 v[126:127], v179, s[30:31] sc1
  global_load_dwordx2 v[128:129], v180, s[30:31] sc1
  global_load_dwordx2 v[130:131], v181, s[30:31] sc1
  global_load_dwordx2 v[132:133], v182, s[30:31] sc1
  global_load_dwordx2 v[134:135], v183, s[30:31] sc1
  global_load_dwordx2 v[136:137], v184, s[30:31] sc1
  global_load_dwordx2 v[138:139], v185, s[30:31] sc1
  global_load_dwordx2 v[140:141], v186, s[30:31] sc1
  s_waitcnt vmcnt(15)
  v_mov_b32_e64 v23, v55
  v_mov_b32 v24, v52
  s_nop 1
  v_max_f32_dpp v24, v24, v24 row_ror:8 row_mask:0xf bank_mask:0xf
  s_nop 1
  v_max_f32_dpp v24, v24, v24 row_ror:4 row_mask:0xf bank_mask:0xf
  s_nop 1
  v_max_f32_dpp v24, v24, v24 row_ror:2 row_mask:0xf bank_mask:0xf
  s_nop 1
  v_max_f32_dpp v24, v24, v24 row_ror:1 row_mask:0xf bank_mask:0xf
  v_sub_f32 v24, v52, v24
  v_exp_f32_e64 v24, v24
  v_subrev_u32 v55, 256, v55
  v_mul_f32 v25, v24, v53
  s_nop 1
  v_add_f32_dpp v25, v25, v25 row_ror:8 row_mask:0xf bank_mask:0xf
  s_nop 1
  v_add_f32_dpp v25, v25, v25 row_ror:4 row_mask:0xf bank_mask:0xf
  s_nop 1
  v_add_f32_dpp v25, v25, v25 row_ror:2 row_mask:0xf bank_mask:0xf
  s_nop 1
  v_add_f32_dpp v25, v25, v25 row_ror:1 row_mask:0xf bank_mask:0xf
  v_rcp_f32 v25, v25
  s_nop 0
  v_mul_f32 v24, v24, v25
  v_ldexp_f32 v25, v24, v55
  v_mul_f32_e64 v54, v24, -v54
  v_readlane_b32 s63, v24, 15
  v_readlane_b32 s44, v54, 15
  v_readlane_b32 s48, v25, 0
  v_readlane_b32 s49, v25, 1
  v_readlane_b32 s50, v25, 2
  v_readlane_b32 s51, v25, 3
  v_readlane_b32 s52, v25, 4
  v_readlane_b32 s53, v25, 5
  v_readlane_b32 s54, v25, 6
  v_readlane_b32 s55, v25, 7
  v_readlane_b32 s56, v25, 8
  v_readlane_b32 s57, v25, 9
  v_readlane_b32 s58, v25, 10
  v_readlane_b32 s59, v25, 11
  v_readlane_b32 s60, v25, 12
  v_readlane_b32 s61, v25, 13
  v_readlane_b32 s62, v25, 14
  v_mov_b32 v108, s44
  v_mov_b32 v109, s44
  v_mov_b32_e64 v110, s44
  v_mov_b32 v111, s44
  s_waitcnt vmcnt(14)
  v_max3_u32 v23, v23, v112, v113
  v_fma_mix_f32 v108, v112, s48, v108 op_sel:[0,0,0] op_sel_hi:[1,0,0]
  v_fma_mix_f32 v109, v112, s48, v109 op_sel:[1,0,0] op_sel_hi:[1,0,0]
  v_fma_mix_f32 v110, v113, s48, v110 op_sel:[0,0,0] op_sel_hi:[1,0,0]
  v_fma_mix_f32 v111, v113, s48, v111 op_sel:[1,0,0] op_sel_hi:[1,0,0]
  s_waitcnt vmcnt(13)
  v_max3_u32 v23, v23, v114, v115
  v_fma_mix_f32 v108, v114, s49, v108 op_sel:[0,0,0] op_sel_hi:[1,0,0]
  v_fma_mix_f32 v109, v114, s49, v109 op_sel:[1,0,0] op_sel_hi:[1,0,0]
  v_fma_mix_f32 v110, v115, s49, v110 op_sel:[0,0,0] op_sel_hi:[1,0,0]
  v_fma_mix_f32 v111, v115, s49, v111 op_sel:[1,0,0] op_sel_hi:[1,0,0]
  s_waitcnt vmcnt(12)
  v_max3_u32 v23, v23, v116, v117
  v_fma_mix_f32 v108, v116, s50, v108 op_sel:[0,0,0] op_sel_hi:[1,0,0]
  v_fma_mix_f32 v109, v116, s50, v109 op_sel:[1,0,0] op_sel_hi:[1,0,0]
  v_fma_mix_f32 v110, v117, s50, v110 op_sel:[0,0,0] op_sel_hi:[1,0,0]
  v_fma_mix_f32 v111, v117, s50, v111 op_sel:[1,0,0] op_sel_hi:[1,0,0]
  s_waitcnt vmcnt(11)
  v_max3_u32 v23, v23, v118, v119
  v_fma_mix_f32 v108, v118, s51, v108 op_sel:[0,0,0] op_sel_hi:[1,0,0]
  v_fma_mix_f32 v109, v118, s51, v109 op_sel:[1,0,0] op_sel_hi:[1,0,0]
  v_fma_mix_f32 v110, v119, s51, v110 op_sel:[0,0,0] op_sel_hi:[1,0,0]
  v_fma_mix_f32 v111, v119, s51, v111 op_sel:[1,0,0] op_sel_hi:[1,0,0]
  s_waitcnt vmcnt(10)
  v_max3_u32 v23, v23, v120, v121
  v_fma_mix_f32 v108, v120, s52, v108 op_sel:[0,0,0] op_sel_hi:[1,0,0]
  v_fma_mix_f32 v109, v120, s52, v109 op_sel:[1,0,0] op_sel_hi:[1,0,0]
  v_fma_mix_f32 v110, v121, s52, v110 op_sel:[0,0,0] op_sel_hi:[1,0,0]
  v_fma_mix_f32 v111, v121, s52, v111 op_sel:[1,0,0] op_sel_hi:[1,0,0]
  s_waitcnt vmcnt(9)
  v_max3_u32 v23, v23, v122, v123
  v_fma_mix_f32 v108, v122, s53, v108 op_sel:[0,0,0] op_sel_hi:[1,0,0]
  v_fma_mix_f32 v109, v122, s53, v109 op_sel:[1,0,0] op_sel_hi:[1,0,0]
  v_fma_mix_f32 v110, v123, s53, v110 op_sel:[0,0,0] op_sel_hi:[1,0,0]
  v_fma_mix_f32 v111, v123, s53, v111 op_sel:[1,0,0] op_sel_hi:[1,0,0]
  s_waitcnt vmcnt(8)
  v_max3_u32 v23, v23, v124, v125
  v_fma_mix_f32 v108, v124, s54, v108 op_sel:[0,0,0] op_sel_hi:[1,0,0]
  v_fma_mix_f32 v109, v124, s54, v109 op_sel:[1,0,0] op_sel_hi:[1,0,0]
  v_fma_mix_f32 v110, v125, s54, v110 op_sel:[0,0,0] op_sel_hi:[1,0,0]
  v_fma_mix_f32 v111, v125, s54, v111 op_sel:[1,0,0] op_sel_hi:[1,0,0]
  s_waitcnt vmcnt(7)
  v_max3_u32 v23, v23, v126, v127
  v_fma_mix_f32 v108, v126, s55, v108 op_sel:[0,0,0] op_sel_hi:[1,0,0]
  v_fma_mix_f32 v109, v126, s55, v109 op_sel:[1,0,0] op_sel_hi:[1,0,0]
  v_fma_mix_f32 v110, v127, s55, v110 op_sel:[0,0,0] op_sel_hi:[1,0,0]
  v_fma_mix_f32 v111, v127, s55, v111 op_sel:[1,0,0] op_sel_hi:[1,0,0]
  s_waitcnt vmcnt(6)
  v_max3_u32 v23, v23, v128, v129
  v_fma_mix_f32 v108, v128, s56, v108 op_sel:[0,0,0] op_sel_hi:[1,0,0]
  v_fma_mix_f32 v109, v128, s56, v109 op_sel:[1,0,0] op_sel_hi:[1,0,0]
  v_fma_mix_f32 v110, v129, s56, v110 op_sel:[0,0,0] op_sel_hi:[1,0,0]
  v_fma_mix_f32 v111, v129, s56, v111 op_sel:[1,0,0] op_sel_hi:[1,0,0]
  s_waitcnt vmcnt(5)
  v_max3_u32 v23, v23, v130, v131
  v_fma_mix_f32 v108, v130, s57, v108 op_sel:[0,0,0] op_sel_hi:[1,0,0]
  v_fma_mix_f32 v109, v130, s57, v109 op_sel:[1,0,0] op_sel_hi:[1,0,0]
  v_fma_mix_f32 v110, v131, s57, v110 op_sel:[0,0,0] op_sel_hi:[1,0,0]
  v_fma_mix_f32 v111, v131, s57, v111 op_sel:[1,0,0] op_sel_hi:[1,0,0]
  s_waitcnt vmcnt(4)
  v_max3_u32 v23, v23, v132, v133
  v_fma_mix_f32 v108, v132, s58, v108 op_sel:[0,0,0] op_sel_hi:[1,0,0]
  v_fma_mix_f32 v109, v132, s58, v109 op_sel:[1,0,0] op_sel_hi:[1,0,0]
  v_fma_mix_f32 v110, v133, s58, v110 op_sel:[0,0,0] op_sel_hi:[1,0,0]
  v_fma_mix_f32 v111, v133, s58, v111 op_sel:[1,0,0] op_sel_hi:[1,0,0]
  s_waitcnt vmcnt(3)
  v_max3_u32 v23, v23, v134, v135
  v_fma_mix_f32 v108, v134, s59, v108 op_sel:[0,0,0] op_sel_hi:[1,0,0]
  v_fma_mix_f32 v109, v134, s59, v109 op_sel:[1,0,0] op_sel_hi:[1,0,0]
  v_fma_mix_f32 v110, v135, s59, v110 op_sel:[0,0,0] op_sel_hi:[1,0,0]
  v_fma_mix_f32 v111, v135, s59, v111 op_sel:[1,0,0] op_sel_hi:[1,0,0]
  s_waitcnt vmcnt(2)
  v_max3_u32 v23, v23, v136, v137
  v_fma_mix_f32 v108, v136, s60, v108 op_sel:[0,0,0] op_sel_hi:[1,0,0]
  v_fma_mix_f32 v109, v136, s60, v109 op_sel:[1,0,0] op_sel_hi:[1,0,0]
  v_fma_mix_f32 v110, v137, s60, v110 op_sel:[0,0,0] op_sel_hi:[1,0,0]
  v_fma_mix_f32 v111, v137, s60, v111 op_sel:[1,0,0] op_sel_hi:[1,0,0]
  s_waitcnt vmcnt(1)
  v_max3_u32 v23, v23, v138, v139
  v_fma_mix_f32 v108, v138, s61, v108 op_sel:[0,0,0] op_sel_hi:[1,0,0]
  v_fma_mix_f32 v109, v138, s61, v109 op_sel:[1,0,0] op_sel_hi:[1,0,0]
  v_fma_mix_f32 v110, v139, s61, v110 op_sel:[0,0,0] op_sel_hi:[1,0,0]
  v_fma_mix_f32 v111, v139, s61, v111 op_sel:[1,0,0] op_sel_hi:[1,0,0]
  s_waitcnt vmcnt(0)
  v_max3_u32 v23, v23, v140, v141
  v_cmp_eq_u32 s[64:65], -1, v23
  v_fma_mix_f32 v108, v140, s62, v108 op_sel:[0,0,0] op_sel_hi:[1,0,0]
  v_fma_mix_f32 v109, v140, s62, v109 op_sel:[1,0,0] op_sel_hi:[1,0,0]
  v_fma_mix_f32 v110, v141, s62, v110 op_sel:[0,0,0] op_sel_hi:[1,0,0]
  v_fma_mix_f32 v111, v141, s62, v111 op_sel:[1,0,0] op_sel_hi:[1,0,0]
  s_cmp_eq_u64 s[64:65], 0
  s_cbranch_scc1 L_hg_ok
  s_cmp_eq_u32 s94, 0
  s_cbranch_scc1 L_hg_ok
  s_sub_u32 s94, s94, 1
  s_branch L_hg
L_hg_ok:
  v_mov_b32_e64 v168, s63
  s_mov_b32 exec_hi, 0xffff
  s_barrier
  ds_read_b128 v[72:75], v196 offset:0
  ds_read_b128 v[76:79], v197 offset:768
  ds_read_b128 v[80:83], v197 offset:1536
  ds_read_b128 v[84:87], v198 offset:2304
  s_waitcnt lgkmcnt(3)
  v_pk_fma_f32 v[108:109], v[72:73], v[168:169], v[108:109] op_sel_hi:[1,0,1]
  v_pk_fma_f32 v[110:111], v[74:75], v[168:169], v[110:111] op_sel_hi:[1,0,1]
  s_waitcnt lgkmcnt(2)
  v_pk_fma_f32 v[108:109], v[76:77], v[168:169], v[108:109] op_sel_hi:[1,0,1]
  v_pk_fma_f32 v[110:111], v[78:79], v[168:169], v[110:111] op_sel_hi:[1,0,1]
  s_waitcnt lgkmcnt(1)
  v_pk_fma_f32 v[108:109], v[80:81], v[168:169], v[108:109] op_sel_hi:[1,0,1]
  v_pk_fma_f32 v[110:111], v[82:83], v[168:169], v[110:111] op_sel_hi:[1,0,1]
  s_waitcnt lgkmcnt(0)
  v_pk_fma_f32 v[108:109], v[84:85], v[168:169], v[108:109] op_sel_hi:[1,0,1]
  v_pk_fma_f32 v[110:111], v[86:87], v[168:169], v[110:111] op_sel_hi:[1,0,1]
  v_cvt_pk_bf16_f32 v108, v108, v109
  v_cvt_pk_bf16_f32 v109, v110, v111
  global_store_dwordx2 v21, v[108:109], s[26:27]
L_end:
  s_endpgm
.p2align 6
.type L_order,@object
L_order:
  .long 0x76afedcb, 0x45321098, 0x500000, 0x300, 0x40, 0x251300, 0x4, 0x0
  .long 0x2e001e, 0x4e003e, 0x6e005e, 0x8d007e, 0xae009e, 0xce00be, 0xee00de, 0xf00fe
  .long 0x96afedcb, 0x74321058, 0x700000, 0x700, 0x70, 0x271700, 0x7, 0x0
  .long 0x270007, 0x470037, 0x670057, 0x870077, 0xa70097, 0xc700b7, 0xe700d7, 0x1f00f7
  .long 0x765aedfb, 0xc4321098, 0xd00000, 0xf00, 0xc0, 0x2d1f00, 0xc, 0x0
  .long 0x110001, 0x410031, 0x610051, 0x810071, 0xa10091, 0xc100b1, 0xe100d1, 0x2f00f1
  .long 0x785fedcb, 0x6432109a, 0x900000, 0x200, 0x60, 0x291200, 0x6, 0x0
  .long 0x160006, 0x460026, 0x660056, 0x860076, 0xa60096, 0xc600b6, 0xe600d6, 0x3f00f6
  .long 0x765faecb, 0xd4321098, 0xf00000, 0xd00, 0xd0, 0x2f1d00, 0xd, 0x0
  .long 0x120002, 0x320022, 0x620052, 0x820072, 0xa20092, 0xc200b2, 0xe200d2, 0x4f00f2
  .long 0x765fedca, 0xb4321098, 0x800000, 0xf00, 0xb0, 0x281f00, 0xb, 0x0
  .long 0x100000, 0x300020, 0x600040, 0x800070, 0xa00090, 0xc000b0, 0xe000d0, 0x5f00f0
  .long 0x76afedcb, 0x24351098, 0x400000, 0x0, 0x20, 0x241000, 0x2, 0x0
  .long 0x1c000c, 0x3c002c, 0x5c004c, 0x8c007c, 0xac009c, 0xcc00bc, 0xea00dc, 0x6f00fc
  .long 0x76afedcb, 0x14325098, 0x400000, 0x400, 0x10, 0x241400, 0x1, 0x0
  .long 0x1b000b, 0x3b002b, 0x5b004b, 0x8b006b, 0xab009b, 0xcb00bb, 0xeb00db, 0x7f00fb
  .long 0x76afedcb, 0x35421098, 0x500000, 0x300, 0x30, 0x251300, 0x3, 0x0
  .long 0x1d000d, 0x3d002d, 0x5d004d, 0x7d006d, 0xad009d, 0xcd00bd, 0xed00dd, 0x8f00fd
  .long 0x76afedcb, 0x94321058, 0x700000, 0x700, 0x90, 0x271700, 0x9, 0x0
  .long 0x170009, 0x390029, 0x590049, 0x790069, 0xa90089, 0xc900b9, 0xe900d9, 0x9f00f9
  .long 0x765aedcb, 0xf4321098, 0xd00000, 0xf00, 0xf0, 0x2d1f00, 0xf, 0x0
  .long 0x140004, 0x340021, 0x540044, 0x740064, 0x940084, 0xc400b4, 0xe400d4, 0xaf00f4
  .long 0x765fedcb, 0x8432109a, 0x900000, 0x200, 0x80, 0x291200, 0x8, 0x0
  .long 0x180008, 0x360028, 0x580048, 0x780068, 0x980088, 0xc800a8, 0xe800d8, 0xbf00f8
  .long 0x765fadcb, 0xe4321098, 0xf00000, 0xd00, 0xe0, 0x2f1d00, 0xe, 0x0
  .long 0x130003, 0x330023, 0x530042, 0x730063, 0x930083, 0xb300a3, 0xe300d3, 0xcf00f3
  .long 0x765fedcb, 0xa4321098, 0x800000, 0xf00, 0xaf, 0x28001f, 0xa, 0x0
  .long 0x500024, 0x14400a4, 0x2b40234, 0x6f40674, 0x7830703, 0xc1408c2, 0xd630c94, 0xdf0de3
  .long 0x76afedcb, 0x4351298, 0x400000, 0x0, 0x0, 0x241000, 0x0, 0x0
  .long 0x1a000a, 0x3a002a, 0x5a004a, 0x7a006a, 0x9a008a, 0xba00aa, 0xda00ca, 0xef00fa
  .long 0x76afedcb, 0x54321098, 0x400000, 0x400, 0x54, 0x140024, 0x5, 0x0
  .long 0x7b006c, 0x1cc00ec, 0x4be043e, 0x58d050d, 0x7de075e, 0xe1c084d, 0xe9c0e2e, 0xff0eae
  .long 0x765fadce, 0xb4321098, 0x11911111, 0x11111e11, 0xb1, 0x291e01, 0xb, 0x0
  .long 0x1200110, 0x1400130, 0x1600150, 0x1800170, 0x1a00190, 0x1c001b0, 0x1e001d0, 0x10f01f0
  .long 0x76afedcb, 0x94321058, 0x11b11111, 0x11111011, 0x91, 0x2b1001, 0x9, 0x0
  .long 0x1290109, 0x1490139, 0x1690159, 0x1890179, 0x1a90199, 0x1c901b9, 0x1e901d9, 0x11f01f9
  .long 0x765fedcb, 0x8432109a, 0x11a11111, 0x11111111, 0x81, 0x2a1101, 0x8, 0x0
  .long 0x1180108, 0x1480138, 0x1680158, 0x1880178, 0x1a70198, 0x1c801b8, 0x1e801d8, 0x12f01f8
  .long 0x765feadb, 0xc4321098, 0x11811111, 0x11111e11, 0xc1, 0x281e01, 0xc, 0x0
  .long 0x1110101, 0x1410121, 0x1610151, 0x1810171, 0x1a10191, 0x1c101b1, 0x1e101d1, 0x13f01f1
  .long 0x765aedcb, 0xf4321098, 0x11e11111, 0x11111f11, 0xf1, 0x2e1f01, 0xf, 0x0
  .long 0x1140104, 0x1340124, 0x1640154, 0x1840174, 0x1a40194, 0x1c401b4, 0x1e401d4, 0x14f01f4
  .long 0x76afedcb, 0x45321098, 0x11311111, 0x11111811, 0x41, 0x231801, 0x4, 0x0
  .long 0x11e010e, 0x13e012e, 0x16e014e, 0x18e017e, 0x1ae019e, 0x1ce01be, 0x1ee01dd, 0x15f01fe
  .long 0x7a5fedcb, 0x64321098, 0x11811111, 0x11111311, 0x61, 0x281301, 0x6, 0x0
  .long 0x1160106, 0x1360126, 0x1560146, 0x1860176, 0x1a60196, 0x1c601b6, 0x1e601d6, 0x16f01f6
  .long 0x76afedcb, 0x14325098, 0x11011111, 0x11111311, 0x11, 0x201301, 0x1, 0x0
  .long 0x11b010b, 0x13b012b, 0x15b014b, 0x18b016b, 0x1ab019b, 0x1cb01bb, 0x1eb01db, 0x17f01fa
  .long 0x765fadcb, 0xe4321098, 0x11911111, 0x11111e11, 0xe1, 0x291e01, 0xe, 0x0
  .long 0x1130100, 0x1330123, 0x1530143, 0x1730163, 0x1a30193, 0x1c301b3, 0x1e301d3, 0x18f01f3
  .long 0x76afedcb, 0x54321098, 0x11b11111, 0x11111011, 0x5b, 0x10012b, 0x5, 0x0
  .long 0x3090119, 0x5450389, 0xc2505c5, 0xd650ca5, 0xe750de5, 0xf380ef5, 0xfb80f55, 0x19f0fd5
  .long 0x865fedcb, 0x7432109a, 0x11a11111, 0x11111111, 0x71, 0x2a1101, 0x7, 0x0
  .long 0x1170107, 0x1370127, 0x1570147, 0x1770167, 0x1970187, 0x1c701b7, 0x1e701d7, 0x1af01f7
  .long 0x765feacb, 0xd4321098, 0x11811111, 0x11111e11, 0xd1, 0x281e01, 0xd, 0x0
  .long 0x1120102, 0x1310122, 0x1520142, 0x1720162, 0x1920182, 0x1c201a2, 0x1e201d2, 0x1bf01f2
  .long 0x76afedcb, 0x24351098, 0x11411111, 0x11111711, 0x21, 0x241701, 0x2, 0x0
  .long 0x11c010c, 0x13c012c, 0x15c014c, 0x17c016c, 0x19c018c, 0x1bc01ac, 0x1ec01dc, 0x1cf01fc
  .long 0x76afedcb, 0x35421098, 0x11311111, 0x11111811, 0x31, 0x231801, 0x3, 0x0
  .long 0x11d010d, 0x13d012d, 0x15d014d, 0x17d016d, 0x19d018d, 0x1bd01ad, 0x1ed01cd, 0x1df01fd
  .long 0x765fedcb, 0xa4321098, 0x11811111, 0x11111311, 0xa3, 0x280113, 0xa, 0x0
  .long 0x850005, 0x1750166, 0x62501f5, 0x74506a5, 0xbd507c5, 0xd350d15, 0xdb50d95, 0x1ef0e55
  .long 0x76afedcb, 0x4325198, 0x11011111, 0x11111311, 0x1, 0x201301, 0x0, 0x0
  .long 0x11a010a, 0x13a012a, 0x15a014a, 0x17a016a, 0x19a018a, 0x1ba01aa, 0x1da01ca, 0x1ff01ea
  .long 0x76afedcb, 0x45321098, 0x22222222, 0x22222a22, 0x42, 0x221a02, 0x4, 0x0
  .long 0x22e021e, 0x24e023e, 0x26e025e, 0x28b027e, 0x2ae029e, 0x2ce02be, 0x2ee02de, 0x20f02fe
  .long 0x7a5fedcb, 0x64321098, 0x22c22222, 0x22222622, 0x62, 0x2c1602, 0x6, 0x0
  .long 0x2260206, 0x2460236, 0x2660256, 0x2860276, 0x2a60296, 0x2c602b6, 0x2e602d6, 0x21f02f6
  .long 0x76afedcb, 0x54321098, 0x22922222, 0x22222522, 0x59, 0x150229, 0x5, 0x0
  .long 0xb50035, 0x1850105, 0x2f502a8, 0x3550315, 0x3d50395, 0x6650575, 0x94506e5, 0x22f09c5
  .long 0x765aedcb, 0xf4321098, 0x22f22222, 0x22222f22, 0xf2, 0x2f1f02, 0xf, 0x0
  .long 0x2140204, 0x2440224, 0x2640254, 0x2840274, 0x2a40294, 0x2c402b2, 0x2e402d4, 0x23f02f4
  .long 0x76afedcb, 0x24351098, 0x22222222, 0x22222522, 0x22, 0x221502, 0x2, 0x0
  .long 0x21c020c, 0x23c022c, 0x26c025c, 0x28c027c, 0x2ac029c, 0x2ca02bc, 0x2ec02dc, 0x24f02fc
  .long 0x965fedcb, 0x743210a8, 0x22722222, 0x22222022, 0x72, 0x271002, 0x7, 0x0
  .long 0x2170207, 0x2370227, 0x2670247, 0x2870277, 0x2a70297, 0x2c702b7, 0x2e702d7, 0x25f02f7
  .long 0x765fadce, 0xb4321098, 0x22a22222, 0x22222e22, 0xb2, 0x2a1e02, 0xb, 0x0
  .long 0x2100200, 0x2300220, 0x2500240, 0x2800270, 0x2a00290, 0x2c002b0, 0x2e002d0, 0x26f02f0
  .long 0x76afedcb, 0x34521098, 0x22222222, 0x22222822, 0x32, 0x221802, 0x3, 0x0
  .long 0x21d020d, 0x23d022d, 0x25d024d, 0x28d026d, 0x2ad029d, 0x2cd02bd, 0x2ed02dd, 0x27f02fd
  .long 0x76afedcb, 0x15324098, 0x22222222, 0x22222a22, 0x12, 0x221a02, 0x1, 0x0
  .long 0x21b020b, 0x23b022b, 0x25b024b, 0x27b026b, 0x2ab029b, 0x2cb02bb, 0x2eb02db, 0x28f02fb
  .long 0x765fedcb, 0xa4321098, 0x22c22222, 0x22222622, 0xa6, 0x2c0216, 0xa, 0x0
  .long 0x3650216, 0x42503e5, 0x73504a5, 0x7750755, 0x7d507b5, 0xb4507f5, 0xd050bc5, 0x29f0d85
  .long 0x76afedcb, 0x84321095, 0x22922222, 0x22222522, 0x82, 0x291502, 0x8, 0x0
  .long 0x2180208, 0x2380228, 0x2580248, 0x2780268, 0x2980288, 0x2c802b8, 0x2e802d8, 0x2af02f8
  .long 0x765aefcb, 0xd4321098, 0x22f22222, 0x22222f22, 0xd2, 0x2f1f02, 0xd, 0x0
  .long 0x2120202, 0x2320222, 0x2520242, 0x2720262, 0x2920282, 0x2c202a2, 0x2e202d2, 0x2bf02f2
  .long 0x76afedcb, 0x4351298, 0x22222222, 0x22222522, 0x2, 0x221502, 0x0, 0x0
  .long 0x21a020a, 0x23a022a, 0x25a024a, 0x27a026a, 0x29a028a, 0x2ba02aa, 0x2ea02da, 0x2cf02fa
  .long 0x765fedcb, 0x943210a8, 0x22722222, 0x22222022, 0x92, 0x271002, 0x9, 0x0
  .long 0x2190209, 0x2390229, 0x2570249, 0x2790269, 0x2990289, 0x2b902a9, 0x2e902c9, 0x2df02f9
  .long 0x765fadcb, 0xe4321098, 0x22a22222, 0x22222e22, 0xe2, 0x2a1e02, 0xe, 0x0
  .long 0x2130203, 0x2330223, 0x2530243, 0x2730260, 0x2930283, 0x2b302a3, 0x2d302c3, 0x2ef02f3
  .long 0x765fedab, 0xc4321098, 0x22922222, 0x22222d22, 0xc2, 0x291d02, 0xc, 0x0
  .long 0x2110201, 0x2310221, 0x2510241, 0x2710261, 0x2910281, 0x2b102a1, 0x2d102c1, 0x2ff02e1
  .long 0x76afedcb, 0x84321059, 0x33b33333, 0x33333133, 0x83, 0x2b1103, 0x8, 0x0
  .long 0x3280318, 0x3480338, 0x3680358, 0x3880378, 0x3a80398, 0x3c803b8, 0x3e803d8, 0x30f03f8
  .long 0x765aedcb, 0xf4321098, 0x33933333, 0x33333e33, 0xf3, 0x291e03, 0xf, 0x0
  .long 0x3240304, 0x3440334, 0x3640354, 0x3840374, 0x3a40394, 0x3c403b4, 0x3e403d4, 0x31f03f4
  .long 0x76afedcb, 0x4321598, 0x33033333, 0x33333233, 0x3, 0x201203, 0x0, 0x0
  .long 0x31a030a, 0x34a033a, 0x36a035a, 0x38a037a, 0x3aa039a, 0x3ca03ba, 0x3ea03da, 0x32f03fa
  .long 0x765fedac, 0xb4321098, 0x33a33333, 0x33333b33, 0xb3, 0x2a1b03, 0xb, 0x0
  .long 0x3100300, 0x3400320, 0x3600350, 0x3800370, 0x3a00390, 0x3c003b0, 0x3e003d0, 0x33f03f0
  .long 0x76afedcb, 0x24531098, 0x33133333, 0x33333a33, 0x23, 0x211a03, 0x2, 0x0
  .long 0x31c030c, 0x33c032c, 0x36c035c, 0x38c037c, 0x3ac039c, 0x3cc03bc, 0x3ec03dc, 0x34f03fc
  .long 0xa65fedcb, 0x74321098, 0x33933333, 0x33333133, 0x73, 0x291103, 0x7, 0x0
  .long 0x3170307, 0x3370327, 0x3670347, 0x3870377, 0x3a70397, 0x3c703b7, 0x3e703d6, 0x35f03f7
  .long 0x76afedcb, 0x15324098, 0x33333333, 0x33333633, 0x13, 0x231603, 0x1, 0x0
  .long 0x31b030b, 0x33b032b, 0x35b034b, 0x38b037b, 0x3ab039b, 0x3cb03bb, 0x3eb03db, 0x36f03fb
  .long 0x765fadcb, 0xe4321098, 0x33e33333, 0x33333a33, 0xe3, 0x2e1a03, 0xe, 0x0
  .long 0x3130303, 0x3330323, 0x3530343, 0x3830363, 0x3a30393, 0x3c303b3, 0x3e303d3, 0x37f03f2
  .long 0x76afedcb, 0x94321058, 0x33b33333, 0x33333133, 0x93, 0x2b1103, 0x9, 0x0
  .long 0x3190308, 0x3390329, 0x3590349, 0x3790369, 0x3a90399, 0x3c903b9, 0x3e903d9, 0x38f03f9
  .long 0x765fedcb, 0xa4321098, 0x33933333, 0x33333e33, 0xae, 0x29031e, 0xa, 0x0
  .long 0x1320103, 0x1b20183, 0x2e30263, 0x4740314, 0x82304f4, 0xd5208a3, 0xe420dd2, 0x39f0ec2
  .long 0x76afedcb, 0x54321098, 0x33033333, 0x33333233, 0x50, 0x120320, 0x5, 0x0
  .long 0x1fb017b, 0x65e032a, 0x73c06de, 0xaeb07bc, 0xc6a0c4d, 0xd0c0ccd, 0xf1e0d8c, 0x3af0f9e
  .long 0x765fedab, 0xc4321098, 0x33a33333, 0x33333b33, 0xc3, 0x2a1b03, 0xc, 0x0
  .long 0x3110301, 0x3300321, 0x3510341, 0x3710361, 0x3910381, 0x3c103a1, 0x3e103d1, 0x3bf03f1
  .long 0x76afedcb, 0x34521098, 0x33133333, 0x33333a33, 0x33, 0x211a03, 0x3, 0x0
  .long 0x31d030d, 0x33d032d, 0x35d034c, 0x37d036d, 0x39d038d, 0x3bd03ad, 0x3ed03dd, 0x3cf03fd
  .long 0xa75fedcb, 0x64321098, 0x33933333, 0x33333133, 0x63, 0x291103, 0x6, 0x0
  .long 0x3160306, 0x3360326, 0x3560346, 0x3760366, 0x3960386, 0x3b603a6, 0x3e603c6, 0x3df03f6
  .long 0x76afedcb, 0x45321098, 0x33333333, 0x33333633, 0x43, 0x231603, 0x4, 0x0
  .long 0x31e030e, 0x33e032e, 0x35e034e, 0x37e036b, 0x39e038e, 0x3be03ae, 0x3de03ce, 0x3ef03fe
  .long 0x765faecb, 0xd4321098, 0x33e33333, 0x33333a33, 0xd3, 0x2e1a03, 0xd, 0x0
  .long 0x3120302, 0x3320322, 0x3520342, 0x3720362, 0x3920382, 0x3b203a2, 0x3d203c2, 0x3ff03e2
  .long 0x765fedcb, 0x8432109a, 0x44a44444, 0x44444944, 0x84, 0x2a1904, 0x8, 0x0
  .long 0x4280418, 0x4480438, 0x4680458, 0x4870478, 0x4a80498, 0x4c804b8, 0x4e804d8, 0x40f04f8
  .long 0x76afedcb, 0x4521398, 0x44544444, 0x44444544, 0x4, 0x251504, 0x0, 0x0
  .long 0x42a040a, 0x44a043a, 0x46a045a, 0x48a047a, 0x4aa049a, 0x4ca04ba, 0x4ea04da, 0x41f04fa
  .long 0x76afedcb, 0x24351098, 0x44344444, 0x44444644, 0x24, 0x231604, 0x2, 0x0
  .long 0x41c040c, 0x44c043c, 0x46c045c, 0x48c047c, 0x4ac049c, 0x4cc04bc, 0x4ec04dc, 0x42f04fc
  .long 0x76afedcb, 0x45321098, 0x44444444, 0x44444a44, 0x44, 0x241a04, 0x4, 0x0
  .long 0x41e040e, 0x44e042e, 0x46e045e, 0x48e047e, 0x4ae049e, 0x4ce04bb, 0x4ee04de, 0x43f04fe
  .long 0x765fadce, 0xb4321098, 0x44744444, 0x44444b44, 0xb4, 0x271b04, 0xb, 0x0
  .long 0x4100400, 0x4300420, 0x4600450, 0x4800470, 0x4a00490, 0x4c004b0, 0x4e004d0, 0x44f04f0
  .long 0x765feacb, 0xd4321098, 0x44644444, 0x44444c44, 0xd4, 0x261c04, 0xd, 0x0
  .long 0x4120402, 0x4320422, 0x4620442, 0x4820472, 0x4a20492, 0x4c204b2, 0x4e204d2, 0x45f04f2
  .long 0x79afedcb, 0x64321058, 0x44744444, 0x44444744, 0x64, 0x271704, 0x6, 0x0
  .long 0x4160406, 0x4360426, 0x4560446, 0x4860476, 0x4a60496, 0x4c604b6, 0x4e604d6, 0x46f04f6
  .long 0x765aedcb, 0xf4321098, 0x44644444, 0x44444e44, 0xf4, 0x261e04, 0xf, 0x0
  .long 0x4140404, 0x4340424, 0x4540444, 0x4840464, 0x4a40494, 0x4c404b4, 0x4e404d4, 0x47f04f1
  .long 0x865fedcb, 0x7432109a, 0x44a44444, 0x44444944, 0x74, 0x2a1904, 0x7, 0x0
  .long 0x4170407, 0x4370427, 0x4570447, 0x4770467, 0x4a70497, 0x4c704b7, 0x4e704d7, 0x48f04f7
  .long 0x76afedcb, 0x34521098, 0x44544444, 0x44444544, 0x34, 0x251504, 0x3, 0x0
  .long 0x41a040d, 0x43d042d, 0x45d044d, 0x47d046d, 0x4ad048d, 0x4cd04bd, 0x4ed04dd, 0x49f04fd
  .long 0x76afedcb, 0x54321098, 0x44344444, 0x44444644, 0x53, 0x160423, 0x5, 0x0
  .long 0x1de015e, 0x3ee036e, 0x81b042c, 0x89b087e, 0x93d08fe, 0xd4e09bd, 0xf0d0dce, 0x4af0f8d
  .long 0x76afedcb, 0x15324098, 0x44444444, 0x44444a44, 0x14, 0x241a04, 0x1, 0x0
  .long 0x41b040b, 0x43b042b, 0x45b044b, 0x47b046b, 0x49b048b, 0x4cb04ab, 0x4eb04db, 0x4bf04fb
  .long 0x765fadcb, 0xe4321098, 0x44744444, 0x44444b44, 0xe4, 0x271b04, 0xe, 0x0
  .long 0x4130403, 0x4330423, 0x4530440, 0x4730463, 0x4930483, 0x4b304a3, 0x4e304d3, 0x4cf04f3
  .long 0x765fedcb, 0xa4321098, 0x44644444, 0x44444c44, 0xac, 0x26041c, 0xa, 0x0
  .long 0x5230452, 0x76405a3, 0x94207e4, 0xb1109c2, 0xb910b34, 0xc030bb4, 0xf740c83, 0x4df0ff4
  .long 0x76afedcb, 0x94321058, 0x44744444, 0x44444744, 0x94, 0x271704, 0x9, 0x0
  .long 0x4190409, 0x4390429, 0x4590449, 0x4790466, 0x4990489, 0x4b904a9, 0x4d904c9, 0x4ef04f9
  .long 0x765aedfb, 0xc4321098, 0x44644444, 0x44444e44, 0xc4, 0x261e04, 0xc, 0x0
  .long 0x4110401, 0x4310421, 0x4510441, 0x4710461, 0x4910481, 0x4b104a1, 0x4d104c1, 0x4ff04e1
  .long 0x76afedcb, 0x34521098, 0x55455555, 0x55555855, 0x35, 0x241805, 0x3, 0x0
  .long 0x52d051d, 0x54d053d, 0x56d055d, 0x58c057d, 0x5ad059d, 0x5cd05bd, 0x5ed05dd, 0x50f05fd
  .long 0x765fedcb, 0x943210a8, 0x55f55555, 0x55555a55, 0x95, 0x2f1a05, 0x9, 0x0
  .long 0x5290509, 0x5490539, 0x5690559, 0x5890579, 0x5a90596, 0x5c905b9, 0x5e905d9, 0x51f05f9
  .long 0x765fadeb, 0xc4321098, 0x55755555, 0x55555c55, 0xc5, 0x271c05, 0xc, 0x0
  .long 0x5110501, 0x5410531, 0x5610551, 0x5810571, 0x5a10591, 0x5c105b1, 0x5e105d1, 0x52f05f1
  .long 0x765feacd, 0xb4321098, 0x55c55555, 0x55555d55, 0xb5, 0x2c1d05, 0xb, 0x0
  .long 0x5100500, 0x5400520, 0x5600550, 0x5800570, 0x5a00590, 0x5c005b0, 0x5e005d0, 0x53f05f0
  .long 0xa65fedcb, 0x74321098, 0x55b55555, 0x55555455, 0x75, 0x2b1405, 0x7, 0x0
  .long 0x5170507, 0x5370527, 0x5670557, 0x5870577, 0x5a70597, 0x5c705b7, 0x5e705d7, 0x54f05f7
  .long 0x76afedcb, 0x84321095, 0x55f55555, 0x55555755, 0x85, 0x2f1705, 0x8, 0x0
  .long 0x5180508, 0x5380528, 0x5680548, 0x5880578, 0x5a80598, 0x5c805b8, 0x5e805d8, 0x55f05f8
  .long 0x76afedcb, 0x4325198, 0x55255555, 0x55555255, 0x5, 0x221205, 0x0, 0x0
  .long 0x51a050a, 0x53a052a, 0x55a054a, 0x58a057a, 0x5aa059a, 0x5ca05ba, 0x5ea05da, 0x56f05fa
  .long 0x765aedcb, 0xf4321098, 0x55955555, 0x55555d55, 0xf5, 0x291d05, 0xf, 0x0
  .long 0x5140504, 0x5340524, 0x5540544, 0x5840564, 0x5a40594, 0x5c405b4, 0x5e405d4, 0x57f05f4
  .long 0x76afedcb, 0x24531098, 0x55455555, 0x55555855, 0x25, 0x241805, 0x2, 0x0
  .long 0x51c050c, 0x53c052c, 0x55c054c, 0x57c056c, 0x5ac059c, 0x5cc05bc, 0x5ec05dc, 0x58f05fc
  .long 0x795fedcb, 0x643210a8, 0x55f55555, 0x55555a55, 0x65, 0x2f1a05, 0x6, 0x0
  .long 0x5160506, 0x5360526, 0x5560546, 0x5760566, 0x5a60586, 0x5c605b6, 0x5e605d6, 0x59f05f6
  .long 0x765fadcb, 0xe4321098, 0x55755555, 0x55555c55, 0xe5, 0x271c05, 0xe, 0x0
  .long 0x5130503, 0x5330521, 0x5530543, 0x5730563, 0x5930583, 0x5c305b3, 0x5e305d3, 0x5af05f3
  .long 0x765feacb, 0xd4321098, 0x55c55555, 0x55555d55, 0xd5, 0x2c1d05, 0xd, 0x0
  .long 0x5120502, 0x5300522, 0x5520542, 0x5720562, 0x5920582, 0x5c205a2, 0x5e205d2, 0x5bf05f2
  .long 0x765fedcb, 0xa4321098, 0x55b55555, 0x55555455, 0xa4, 0x2b0514, 0xa, 0x0
  .long 0xf50075, 0x6350547, 0x81506b5, 0x8950855, 0xb6508d5, 0xc290be5, 0xf050ca9, 0x5cf0f85
  .long 0x76afedcb, 0x54321098, 0x55f55555, 0x55555755, 0x5f, 0x17052f, 0x5, 0x0
  .long 0xc50045, 0x2b50235, 0x5580515, 0x8650595, 0xd2508e5, 0xdf50d75, 0xe850e05, 0x5df0fa5
  .long 0x76afedcb, 0x14325098, 0x55255555, 0x55555255, 0x15, 0x221205, 0x1, 0x0
  .long 0x51b050b, 0x53b052b, 0x55b054b, 0x57b056a, 0x59b058b, 0x5bb05ab, 0x5db05cb, 0x5ef05fb
  .long 0x76afedcb, 0x45321098, 0x55255555, 0x55555855, 0x45, 0x221805, 0x4, 0x0
  .long 0x51e050e, 0x53e052e, 0x55e054e, 0x57e056e, 0x59e058e, 0x5be05ae, 0x5de05ce, 0x5ff05ee
  .long 0x76afedcb, 0x24351098, 0x66166666, 0x66666566, 0x26, 0x211506, 0x2, 0x0
  .long 0x62c061c, 0x64c063c, 0x66c065c, 0x68c067c, 0x6ac069c, 0x6cc06bc, 0x6ec06dc, 0x60f06fc
  .long 0x765feacd, 0xb4321098, 0x66a66666, 0x66666b66, 0xb6, 0x2a1b06, 0xb, 0x0
  .long 0x6200600, 0x6400630, 0x6600650, 0x6800670, 0x6a00690, 0x6c006b0, 0x6e006d0, 0x61f06f0
  .long 0x76afedcb, 0x94321058, 0x66e66666, 0x66666366, 0x96, 0x2e1306, 0x9, 0x0
  .long 0x6190609, 0x6490639, 0x6690659, 0x6890679, 0x6a70699, 0x6c906b9, 0x6e906d9, 0x62f06f9
  .long 0x76afedcb, 0x4325198, 0x66166666, 0x66666466, 0x6, 0x211406, 0x0, 0x0
  .long 0x61a060a, 0x64a062a, 0x66a065a, 0x68a067a, 0x6aa069a, 0x6ca06ba, 0x6ea06da, 0x63f06fa
  .long 0x76afedcb, 0x84321095, 0x66566666, 0x66666966, 0x86, 0x251906, 0x8, 0x0
  .long 0x6180608, 0x6380628, 0x6680658, 0x6880678, 0x6a80698, 0x6c606b8, 0x6e806d8, 0x64f06f8
  .long 0x76afedcb, 0x45321098, 0x66066666, 0x66666566, 0x46, 0x201506, 0x4, 0x0
  .long 0x61e060e, 0x63e062e, 0x66e064e, 0x68e067e, 0x6ae069e, 0x6ce06be, 0x6ee06dd, 0x65f06fe
  .long 0x765fedcb, 0xa4321098, 0x66966666, 0x66666a66, 0xaa, 0x29061a, 0xa, 0x0
  .long 0x2850205, 0x3730345, 0x3f303c5, 0x4b50435, 0x5990519, 0x92506e3, 0xb5209a5, 0x66f0ed4
  .long 0x765aedfb, 0xc4321098, 0x66866666, 0x66666f66, 0xc6, 0x281f06, 0xc, 0x0
  .long 0x6110601, 0x6310621, 0x6510641, 0x6810661, 0x6a10691, 0x6c106b1, 0x6e106d1, 0x67f06f1
  .long 0x76afedcb, 0x54321098, 0x66166666, 0x66666566, 0x51, 0x150621, 0x5, 0x0
  .long 0x3cd034d, 0x63b060c, 0x91e06bb, 0xa2d099e, 0xb6d0aad, 0xbdc0b7e, 0xbfe0bed, 0x68f0e5d
  .long 0x765feacb, 0xd4321098, 0x66a66666, 0x66666b66, 0xd6, 0x2a1b06, 0xd, 0x0
  .long 0x6100602, 0x6320622, 0x6520642, 0x6720662, 0x6a20682, 0x6c206b2, 0x6e206d2, 0x69f06f2
  .long 0x96afedcb, 0x74321058, 0x66e66666, 0x66666366, 0x76, 0x2e1306, 0x7, 0x0
  .long 0x6170607, 0x6370627, 0x6570647, 0x6770667, 0x6970687, 0x6c706b7, 0x6e706d7, 0x6af06f7
  .long 0x76afedcb, 0x14325098, 0x66166666, 0x66666466, 0x16, 0x211406, 0x1, 0x0
  .long 0x61b060b, 0x63a062b, 0x65b064b, 0x67b066b, 0x69b068b, 0x6cb06ab, 0x6eb06db, 0x6bf06fb
  .long 0x78afedcb, 0x64321095, 0x66566666, 0x66666966, 0x66, 0x251906, 0x6, 0x0
  .long 0x6160606, 0x6360626, 0x6560646, 0x6760666, 0x6960686, 0x6b606a6, 0x6e606d6, 0x6cf06f6
  .long 0x76afedcb, 0x35421098, 0x66066666, 0x66666566, 0x36, 0x201506, 0x3, 0x0
  .long 0x61d060d, 0x63d062d, 0x65d064d, 0x67d066d, 0x69d068d, 0x6bd06ad, 0x6ed06cd, 0x6df06fd
  .long 0x765fadcb, 0xe4321098, 0x66966666, 0x66666a66, 0xe6, 0x291a06, 0xe, 0x0
  .long 0x6130603, 0x6330623, 0x6530643, 0x6730663, 0x6930683, 0x6b306a3, 0x6d306c3, 0x6ef06f3
  .long 0x765aedcb, 0xf4321098, 0x66866666, 0x66666f66, 0xf6, 0x281f06, 0xf, 0x0
  .long 0x6140604, 0x6340624, 0x6540644, 0x6710664, 0x6940684, 0x6b406a4, 0x6d406c4, 0x6ff06e4
  .long 0x765fadcb, 0xe4321098, 0x77d77777, 0x77777f77, 0xe7, 0x2d1f07, 0xe, 0x0
  .long 0x7230713, 0x7430733, 0x7630753, 0x7800773, 0x7a30793, 0x7c307b3, 0x7e307d3, 0x70f07f3
  .long 0x76afedcb, 0x4321598, 0x77277777, 0x77777177, 0x7, 0x221107, 0x0, 0x0
  .long 0x72a070a, 0x74a073a, 0x76a075a, 0x78a077a, 0x7aa079a, 0x7ca07ba, 0x7ea07da, 0x71f07fa
  .long 0x765fedcb, 0xa4321098, 0x77877777, 0x77777d77, 0xad, 0x28071d, 0xa, 0x0
  .long 0xc30043, 0x53202f1, 0x5b20574, 0x96307a1, 0xa0409e3, 0xa840a13, 0xf520a93, 0x72f0fd2
  .long 0x76afedcb, 0x24351098, 0x77077777, 0x77777677, 0x27, 0x201607, 0x2, 0x0
  .long 0x71c070c, 0x74c072c, 0x76c075c, 0x78c077c, 0x7ac079c, 0x7cc07bb, 0x7ec07dc, 0x73f07fc
  .long 0x56afedcb, 0x74321098, 0x77677777, 0x77777377, 0x77, 0x261307, 0x7, 0x0
  .long 0x7170707, 0x7370727, 0x7670757, 0x7870777, 0x7a70797, 0x7c607b7, 0x7e707d7, 0x74f07f7
  .long 0x76afedcb, 0x45321098, 0x77477777, 0x77777677, 0x47, 0x241607, 0x4, 0x0
  .long 0x71e070e, 0x73e072e, 0x76e074e, 0x78e077e, 0x7ae079e, 0x7ce07be, 0x7ee07dd, 0x75f07fe
  .long 0x765aefcb, 0xd4321098, 0x77e77777, 0x77777c77, 0xd7, 0x2e1c07, 0xd, 0x0
  .long 0x7120702, 0x7320722, 0x7520742, 0x7820772, 0x7a20792, 0x7c207b2, 0x7e207d2, 0x76f07f2
  .long 0x76afedcb, 0x94321058, 0x77c77777, 0x77777677, 0x97, 0x2c1607, 0x9, 0x0
  .long 0x7190709, 0x7390729, 0x7590749, 0x7890769, 0x7a90799, 0x7c907b9, 0x7e907d9, 0x77f07f8
  .long 0x765fadce, 0xb4321098, 0x77d77777, 0x77777f77, 0xb7, 0x2d1f07, 0xb, 0x0
  .long 0x7100700, 0x7300720, 0x7500740, 0x7700760, 0x7a00790, 0x7c007b0, 0x7e007d0, 0x78f07f0
  .long 0x76afedcb, 0x54321098, 0x77277777, 0x77777177, 0x52, 0x110722, 0x5, 0x0
  .long 0x24c020e, 0x28e027d, 0x56b02cc, 0x5fe05eb, 0xa3e071a, 0xc5e0abe, 0xdad0cde, 0x79f0f2a
  .long 0x765fedab, 0xc4321098, 0x77877777, 0x77777d77, 0xc7, 0x281d07, 0xc, 0x0
  .long 0x7110701, 0x7310721, 0x7510741, 0x7710761, 0x7910781, 0x7c107b1, 0x7e107d1, 0x7af07f1
  .long 0x76afedcb, 0x14352098, 0x77077777, 0x77777677, 0x17, 0x201607, 0x1, 0x0
  .long 0x71b070b, 0x73b072b, 0x75b074b, 0x77b076b, 0x79b078b, 0x7cb07ab, 0x7eb07db, 0x7bf07fb
  .long 0x57afedcb, 0x64321098, 0x77677777, 0x77777377, 0x67, 0x261307, 0x6, 0x0
  .long 0x7160706, 0x7360726, 0x7560746, 0x7760766, 0x7960786, 0x7b607a6, 0x7e607d6, 0x7cf07f6
  .long 0x76afedcb, 0x35421098, 0x77477777, 0x77777677, 0x37, 0x241607, 0x3, 0x0
  .long 0x71d070d, 0x73d072d, 0x75d074d, 0x77d076d, 0x79d078d, 0x7bd07ad, 0x7ed07cd, 0x7df07fd
  .long 0x765aedcb, 0xf4321098, 0x77e77777, 0x77777c77, 0xf7, 0x2e1c07, 0xf, 0x0
  .long 0x7140704, 0x7340724, 0x7540744, 0x7740762, 0x7940784, 0x7b407a4, 0x7d407c4, 0x7ef07f4
  .long 0x76afedcb, 0x84321059, 0x77c77777, 0x77777677, 0x87, 0x2c1607, 0x8, 0x0
  .long 0x7180708, 0x7380728, 0x7580748, 0x7780768, 0x7980788, 0x7b807a8, 0x7d807c8, 0x7ff07e8
  .long 0x765aedcb, 0xf4321098, 0x88e88888, 0x88888b88, 0xf8, 0x2e1b08, 0xf, 0x0
  .long 0x8240814, 0x8440834, 0x8640854, 0x8810874, 0x8a40894, 0x8c408b4, 0x8e408d4, 0x80f08f4
  .long 0x76afedcb, 0x14325098, 0x88388888, 0x88888488, 0x18, 0x231408, 0x1, 0x0
  .long 0x82b080b, 0x84b083b, 0x86b085b, 0x88b087b, 0x8ab089a, 0x8cb08bb, 0x8eb08db, 0x81f08fb
  .long 0x765fadcb, 0xe4321098, 0x88688888, 0x88888e88, 0xe8, 0x261e08, 0xe, 0x0
  .long 0x8130803, 0x8430833, 0x8630853, 0x8830873, 0x8a00893, 0x8c308b3, 0x8e308d3, 0x82f08f3
  .long 0x96afedcb, 0x74321058, 0x88788888, 0x88888888, 0x78, 0x271808, 0x7, 0x0
  .long 0x8170807, 0x8470827, 0x8670857, 0x8870877, 0x8a70897, 0x8c708b7, 0x8e708d7, 0x83f08f7
  .long 0x76afedcb, 0x34521098, 0x88488888, 0x88888788, 0x38, 0x241708, 0x3, 0x0
  .long 0x81d080d, 0x83d082d, 0x86d085d, 0x88d087d, 0x8ad089d, 0x8cd08bd, 0x8ed08dd, 0x84f08fd
  .long 0x76afedcb, 0x54321098, 0x88e88888, 0x88888488, 0x5e, 0x14082e, 0x5, 0x0
  .long 0x3750145, 0x62903f5, 0x76506a9, 0x80507e5, 0x8c50885, 0xa1508d6, 0xc350a95, 0x85f0cb5
  .long 0x765fedcb, 0x8432109a, 0x88f88888, 0x88888988, 0x88, 0x2f1908, 0x8, 0x0
  .long 0x8180808, 0x8380828, 0x8580848, 0x8880878, 0x8a80898, 0x8c808b8, 0x8e808d8, 0x86f08f8
  .long 0x76afedcb, 0x45321098, 0x88388888, 0x88888788, 0x48, 0x231708, 0x4, 0x0
  .long 0x81e080e, 0x83e082e, 0x85e084e, 0x88e086e, 0x8ae089e, 0x8ce08be, 0x8ee08de, 0x87f08fc
  .long 0x765aedfb, 0xc4321098, 0x88e88888, 0x88888b88, 0xc8, 0x2e1b08, 0xc, 0x0
  .long 0x8110801, 0x8310821, 0x8510841, 0x8710861, 0x8a10891, 0x8c108b1, 0x8e108d1, 0x88f08f1
  .long 0x76afedcb, 0x4325198, 0x88388888, 0x88888488, 0x8, 0x231408, 0x0, 0x0
  .long 0x81a080a, 0x83a082a, 0x85a084a, 0x87a086a, 0x8aa088a, 0x8ca08ba, 0x8ea08da, 0x89f08fa
  .long 0x765fadce, 0xb4321098, 0x88688888, 0x88888e88, 0xb8, 0x261e08, 0xb, 0x0
  .long 0x8100800, 0x8300820, 0x8500840, 0x8700860, 0x8900880, 0x8c008b0, 0x8e008d0, 0x8af08f0
  .long 0x76afedcb, 0x94321058, 0x88788888, 0x88888888, 0x98, 0x271808, 0x9, 0x0
  .long 0x8190809, 0x8370829, 0x8590849, 0x8790869, 0x8990889, 0x8c908a9, 0x8e908d9, 0x8bf08f9
  .long 0x765feacb, 0xd4321098, 0x88e88888, 0x88888f88, 0xd8, 0x2e1f08, 0xd, 0x0
  .long 0x8120802, 0x8320822, 0x8520842, 0x8720862, 0x8920882, 0x8b208a2, 0x8e208d2, 0x8cf08f2
  .long 0x75afedcb, 0x64321098, 0x88e88888, 0x88888488, 0x68, 0x2e1408, 0x6, 0x0
  .long 0x8160806, 0x8360826, 0x8560846, 0x8760866, 0x8960886, 0x8b608a6, 0x8e608c6, 0x8df08f6
  .long 0x765fedcb, 0xa4321098, 0x88f88888, 0x88888988, 0xa9, 0x2f0819, 0xa, 0x0
  .long 0x4880408, 0x6c50645, 0xa350868, 0xc550ab5, 0xcd50c75, 0xe250cf5, 0xf150ea5, 0x8ef0f95
  .long 0x76afedcb, 0x25341098, 0x88388888, 0x88888788, 0x28, 0x231708, 0x2, 0x0
  .long 0x81c080c, 0x83c082c, 0x85c084c, 0x87c086c, 0x89c088c, 0x8bc08ac, 0x8dc08cc, 0x8ff08ec
  .long 0x78afedcb, 0x64321095, 0x99799999, 0x99999099, 0x69, 0x271009, 0x6, 0x0
  .long 0x9260916, 0x9460936, 0x9660956, 0x9860976, 0x9a60996, 0x9c609b6, 0x9e609d6, 0x90f09f6
  .long 0x76afedcb, 0x45321098, 0x99199999, 0x99999899, 0x49, 0x211809, 0x4, 0x0
  .long 0x92e090e, 0x94e093e, 0x96e095e, 0x98e097e, 0x9ae099c, 0x9ce09be, 0x9ee09de, 0x91f09fe
  .long 0x76afedcb, 0x14325098, 0x99599999, 0x99999a99, 0x19, 0x251a09, 0x1, 0x0
  .long 0x91b090b, 0x94b093b, 0x96b095b, 0x98b097b, 0x9ab099b, 0x9cb09bb, 0x9eb09db, 0x92f09fb
  .long 0x76afedcb, 0x4521398, 0x99399999, 0x99999599, 0x9, 0x231509, 0x0, 0x0
  .long 0x91a090a, 0x94a092a, 0x96a095a, 0x98a097a, 0x9aa099a, 0x9ca09ba, 0x9ea09da, 0x93f09fa
  .long 0x765feacb, 0xd4321098, 0x99999999, 0x99999c99, 0xd9, 0x291c09, 0xd, 0x0
  .long 0x9120902, 0x9320922, 0x9620952, 0x9820972, 0x9a20992, 0x9c009b2, 0x9e209d2, 0x94f09f2
  .long 0x765aedcb, 0xf4321098, 0x99c99999, 0x99999b99, 0xf9, 0x2c1b09, 0xf, 0x0
  .long 0x9140904, 0x9340924, 0x9640944, 0x9840974, 0x9a40994, 0x9c409b4, 0x9e409d4, 0x95f09f4
  .long 0x765fadcb, 0xe4321098, 0x99599999, 0x99999d99, 0xe9, 0x251d09, 0xe, 0x0
  .long 0x9130903, 0x9330923, 0x9530943, 0x9830973, 0x9a30993, 0x9c309b3, 0x9e109d3, 0x96f09f3
  .long 0x76afedcb, 0x94321058, 0x99d99999, 0x99999599, 0x99, 0x2d1509, 0x9, 0x0
  .long 0x9190909, 0x9390929, 0x9590949, 0x9890969, 0x9a90999, 0x9c909b9, 0x9e909d9, 0x97f09f7
  .long 0x76afedcb, 0x84321095, 0x99799999, 0x99999099, 0x89, 0x271009, 0x8, 0x0
  .long 0x9180906, 0x9380928, 0x9580948, 0x9780968, 0x9a80998, 0x9c809b8, 0x9e809d8, 0x98f09f8
  .long 0x76afedcb, 0x25341098, 0x99199999, 0x99999899, 0x29, 0x211809, 0x2, 0x0
  .long 0x91c090c, 0x93c092c, 0x95c094c, 0x97c096c, 0x9ac098c, 0x9cc09bc, 0x9ec09dc, 0x99f09fc
  .long 0x76afedcb, 0x54321098, 0x99599999, 0x99999a99, 0x55, 0x1a0925, 0x5, 0x0
  .long 0x8e000e, 0x49d041d, 0x6c80648, 0x965092b, 0xb5509e5, 0xeb80e38, 0xf750ed5, 0x9af0ff5
  .long 0x76afedcb, 0x34521098, 0x99399999, 0x99999599, 0x39, 0x231509, 0x3, 0x0
  .long 0x91d090d, 0x93a092d, 0x95d094d, 0x97d096d, 0x99d098d, 0x9cd09ad, 0x9ed09dd, 0x9bf09fd
  .long 0x765feacd, 0xb4321098, 0x99999999, 0x99999c99, 0xb9, 0x291c09, 0xb, 0x0
  .long 0x9100900, 0x9300920, 0x9500940, 0x9700960, 0x9900980, 0x9b009a0, 0x9e009d0, 0x9cf09f0
  .long 0x765fedcb, 0xa4321098, 0x99c99999, 0x99999b99, 0xab, 0x2c091b, 0xa, 0x0
  .long 0x3b10331, 0x4c30443, 0x6920612, 0x8840804, 0xa610954, 0xd240ce2, 0xef30e73, 0x9df0fa3
  .long 0x765fadeb, 0xc4321098, 0x99599999, 0x99999d99, 0xc9, 0x251d09, 0xc, 0x0
  .long 0x9110901, 0x9310921, 0x9510941, 0x9710961, 0x9910981, 0x9b109a1, 0x9d109c1, 0x9ef09f1
  .long 0x96afedcb, 0x74321058, 0x99d99999, 0x99999599, 0x79, 0x2d1509, 0x7, 0x0
  .long 0x9170907, 0x9370927, 0x9570947, 0x9770967, 0x9970987, 0x9b709a7, 0x9d709c7, 0x9ff09e7
  .long 0x765aedcb, 0xf4321098, 0xaa6aaaaa, 0xaaaaadaa, 0xfa, 0x261d0a, 0xf, 0x0
  .long 0xa240a14, 0xa440a34, 0xa640a54, 0xa820a74, 0xaa40a94, 0xac40ab4, 0xae40ad4, 0xa0f0af4
  .long 0x765fadce, 0xb4321098, 0xaaeaaaaa, 0xaaaaadaa, 0xba, 0x2e1d0a, 0xb, 0x0
  .long 0xa200a00, 0xa400a30, 0xa600a50, 0xa800a70, 0xaa00a90, 0xac00ab0, 0xae00ad0, 0xa1f0af0
  .long 0x76afedcb, 0x34521098, 0xaa1aaaaa, 0xaaaaa7aa, 0x3a, 0x21170a, 0x3, 0x0
  .long 0xa1d0a0d, 0xa4d0a3d, 0xa6d0a5d, 0xa8d0a7d, 0xaac0a9d, 0xacd0abd, 0xaed0add, 0xa2f0afd
  .long 0x76afedcb, 0x45321098, 0xaa2aaaaa, 0xaaaaa9aa, 0x4a, 0x22190a, 0x4, 0x0
  .long 0xa1e0a0e, 0xa4e0a2e, 0xa6e0a5e, 0xa8e0a7e, 0xaae0a9e, 0xace0aba, 0xaee0ade, 0xa3f0afe
  .long 0x765fedcb, 0xa4321098, 0xaaaaaaaa, 0xaaaaa8aa, 0xa8, 0x2a0a18, 0xa, 0x0
  .long 0x1d50155, 0x5050275, 0x5f50585, 0x8b50835, 0x9950915, 0xda50ac5, 0xee50e65, 0xa4f0f25
  .long 0x86afedcb, 0x74321095, 0xaadaaaaa, 0xaaaaa2aa, 0x7a, 0x2d120a, 0x7, 0x0
  .long 0xa170a07, 0xa370a27, 0xa670a47, 0xa870a77, 0xaa70a97, 0xac70ab7, 0xae70ad7, 0xa5f0af7
  .long 0x765fedab, 0xc4321098, 0xaa6aaaaa, 0xaaaaabaa, 0xca, 0x261b0a, 0xc, 0x0
  .long 0xa110a01, 0xa310a21, 0xa510a41, 0xa810a71, 0xaa10a91, 0xac10ab1, 0xae10ad1, 0xa6f0af1
  .long 0x765fedcb, 0x943210a8, 0xaaaaaaaa, 0xaaaaa1aa, 0x9a, 0x2a110a, 0x9, 0x0
  .long 0xa190a09, 0xa390a29, 0xa590a49, 0xa890a69, 0xaa90a99, 0xac90ab9, 0xae90ad9, 0xa7f0af6
  .long 0x765aefcb, 0xd4321098, 0xaa6aaaaa, 0xaaaaadaa, 0xda, 0x261d0a, 0xd, 0x0
  .long 0xa120a02, 0xa320a22, 0xa520a42, 0xa720a62, 0xaa20a92, 0xac20ab2, 0xae20ad2, 0xa8f0af2
  .long 0x765fadcb, 0xe4321098, 0xaaeaaaaa, 0xaaaaadaa, 0xea, 0x2e1d0a, 0xe, 0x0
  .long 0xa100a03, 0xa330a23, 0xa530a43, 0xa730a63, 0xaa30a83, 0xac30ab3, 0xae30ad3, 0xa9f0af3
  .long 0x76afedcb, 0x24531098, 0xaa1aaaaa, 0xaaaaa7aa, 0x2a, 0x21170a, 0x2, 0x0
  .long 0xa1c0a0c, 0xa3c0a2c, 0xa5c0a4c, 0xa7c0a6c, 0xa9c0a8c, 0xacc0abc, 0xaec0adc, 0xaaf0afc
  .long 0x76afedcb, 0x5321498, 0xaa2aaaaa, 0xaaaaa9aa, 0xa, 0x22190a, 0x0, 0x0
  .long 0xa1a0a0a, 0xa3a0a2a, 0xa5a0a4a, 0xa7a0a6a, 0xa9a0a8a, 0xaca0aaa, 0xaea0ada, 0xabf0afa
  .long 0x76afedcb, 0x54321098, 0xaaaaaaaa, 0xaaaaa8aa, 0x5a, 0x180a2a, 0x5, 0x0
  .long 0x1a50125, 0x2e50265, 0x3b50335, 0x4850405, 0x6950615, 0xa750a45, 0xd550af5, 0xacf0dd5
  .long 0x76afedcb, 0x84321095, 0xaadaaaaa, 0xaaaaa2aa, 0x8a, 0x2d120a, 0x8, 0x0
  .long 0xa180a08, 0xa380a28, 0xa570a48, 0xa780a68, 0xa980a88, 0xab80aa8, 0xae80ac8, 0xadf0af8
  .long 0x76afedcb, 0x14325098, 0xaa0aaaaa, 0xaaaaa1aa, 0x1a, 0x20110a, 0x1, 0x0
  .long 0xa1b0a0b, 0xa3b0a2b, 0xa5b0a4b, 0xa7b0a6b, 0xa9b0a8b, 0xabb0aab, 0xadb0acb, 0xaef0afb
  .long 0x795fedcb, 0x643210a8, 0xaaaaaaaa, 0xaaaaa1aa, 0x6a, 0x2a110a, 0x6, 0x0
  .long 0xa160a06, 0xa360a26, 0xa560a46, 0xa760a66, 0xa960a86, 0xab60aa6, 0xad60ac6, 0xaff0ae6
  .long 0x765fedcb, 0xa4321098, 0xbb8bbbbb, 0xbbbbb7bb, 0xa7, 0x280b17, 0xa, 0x0
  .long 0x950015, 0x46501c5, 0x55504e5, 0x84505d5, 0x8f50875, 0xaa50a25, 0xf350b86, 0xb0f0fb5
  .long 0x765fedac, 0xb4321098, 0xbbdbbbbb, 0xbbbbbcbb, 0xbb, 0x2d1c0b, 0xb, 0x0
  .long 0xb200b00, 0xb400b30, 0xb600b50, 0xb800b70, 0xba00b90, 0xbc00bb0, 0xbe00bd0, 0xb1f0bf0
  .long 0x765fedcb, 0x943210a8, 0xbbcbbbbb, 0xbbbbb0bb, 0x9b, 0x2c100b, 0x9, 0x0
  .long 0xb190b09, 0xb490b39, 0xb690b59, 0xb890b79, 0xba70b99, 0xbc90bb9, 0xbe90bd9, 0xb2f0bf9
  .long 0x765afdcb, 0xe4321098, 0xbb6bbbbb, 0xbbbbbcbb, 0xeb, 0x261c0b, 0xe, 0x0
  .long 0xb130b03, 0xb430b23, 0xb630b53, 0xb830b73, 0xba30b93, 0xbc30bb3, 0xbe30bd3, 0xb3f0bf3
  .long 0x76afedcb, 0x84321095, 0xbb8bbbbb, 0xbbbbb6bb, 0x8b, 0x28160b, 0x8, 0x0
  .long 0xb180b08, 0xb380b28, 0xb680b58, 0xb880b78, 0xba80b98, 0xbc80bb8, 0xbe80bd8, 0xb4f0bf8
  .long 0x765feacb, 0xd4321098, 0xbb5bbbbb, 0xbbbbbabb, 0xdb, 0x251a0b, 0xd, 0x0
  .long 0xb120b02, 0xb320b22, 0xb620b42, 0xb820b72, 0xba20b92, 0xbc20bb2, 0xbe20bd2, 0xb5f0bf2
  .long 0x76afedcb, 0x34521098, 0xbb1bbbbb, 0xbbbbb4bb, 0x3b, 0x21140b, 0x3, 0x0
  .long 0xb1d0b0d, 0xb3d0b2d, 0xb5d0b4d, 0xb8d0b7d, 0xbad0b9d, 0xbcd0bbd, 0xbeb0bdd, 0xb6f0bfd
  .long 0x76afedcb, 0x5321498, 0xbb1bbbbb, 0xbbbbb2bb, 0xb, 0x21120b, 0x0, 0x0
  .long 0xb1a0b0a, 0xb3a0b2a, 0xb5a0b4a, 0xb8a0b6a, 0xbaa0b9a, 0xbca0bba, 0xbea0bda, 0xb7f0bfa
  .long 0x7a5fedcb, 0x64321098, 0xbb8bbbbb, 0xbbbbb7bb, 0x6b, 0x28170b, 0x6, 0x0
  .long 0xb160b06, 0xb360b26, 0xb560b46, 0xb760b66, 0xba60b96, 0xbc60bb6, 0xbe60bd6, 0xb8f0bf6
  .long 0x765fedab, 0xc4321098, 0xbbdbbbbb, 0xbbbbbcbb, 0xcb, 0x2d1c0b, 0xc, 0x0
  .long 0xb100b01, 0xb310b21, 0xb510b41, 0xb710b61, 0xba10b81, 0xbc10bb1, 0xbe10bd1, 0xb9f0bf1
  .long 0x965fedcb, 0x743210a8, 0xbbcbbbbb, 0xbbbbb0bb, 0x7b, 0x2c100b, 0x7, 0x0
  .long 0xb170b07, 0xb370b27, 0xb570b47, 0xb770b67, 0xb970b87, 0xbc70bb7, 0xbe70bd7, 0xbaf0bf7
  .long 0x765aedcb, 0xf4321098, 0xbb6bbbbb, 0xbbbbbcbb, 0xfb, 0x261c0b, 0xf, 0x0
  .long 0xb140b04, 0xb330b24, 0xb540b44, 0xb740b64, 0xb940b84, 0xbc40ba4, 0xbe40bd4, 0xbbf0bf4
  .long 0x76afedcb, 0x54321098, 0xbb8bbbbb, 0xbbbbb6bb, 0x58, 0x160b28, 0x5, 0x0
  .long 0xd50055, 0x1650135, 0x1e501b5, 0x6f50675, 0x7a50725, 0xb480b05, 0xc150b85, 0xbcf0c95
  .long 0x76afedcb, 0x24351098, 0xbb1bbbbb, 0xbbbbb3bb, 0x2b, 0x21130b, 0x2, 0x0
  .long 0xb1c0b0c, 0xb3c0b2c, 0xb5c0b4c, 0xb7c0b6c, 0xb9c0b8c, 0xbbc0bac, 0xbec0bcc, 0xbdf0bfc
  .long 0x76afedcb, 0x14523098, 0xbb1bbbbb, 0xbbbbb4bb, 0x1b, 0x21140b, 0x1, 0x0
  .long 0xb1b0b0b, 0xb3b0b2b, 0xb5b0b4b, 0xb7b0b6b, 0xb9b0b8b, 0xbbb0bab, 0xbdb0bcb, 0xbef0bfb
  .long 0x76afedcb, 0x45321098, 0xbb1bbbbb, 0xbbbbb2bb, 0x4b, 0x21120b, 0x4, 0x0
  .long 0xb1e0b0e, 0xb3e0b2e, 0xb5e0b4e, 0xb7a0b6e, 0xb9e0b8e, 0xbbe0bae, 0xbde0bce, 0xbff0bee
  .long 0x765fadce, 0xb4321098, 0xcccccccc, 0xcccccccc, 0xbc, 0x2c1c0c, 0xb, 0x0
  .long 0xc200c10, 0xc400c30, 0xc600c50, 0xc800c70, 0xca00c90, 0xcc00cb0, 0xce00cd0, 0xc0f0cf0
  .long 0x765aedfb, 0xc4321098, 0xcc8ccccc, 0xcccccfcc, 0xcc, 0x281f0c, 0xc, 0x0
  .long 0xc210c01, 0xc410c31, 0xc610c51, 0xc810c71, 0xca10c91, 0xcc10cb1, 0xce10cd1, 0xc1f0cf1
  .long 0x765fedcb, 0x843210a9, 0xccbccccc, 0xccccc4cc, 0x8c, 0x2b140c, 0x8, 0x0
  .long 0xc180c08, 0xc480c38, 0xc680c58, 0xc880c78, 0xca80c98, 0xcc80cb8, 0xce80cd8, 0xc2f0cf8
  .long 0x765fedcb, 0xa4321098, 0xcceccccc, 0xccccc1cc, 0xa1, 0x2e0c11, 0xa, 0x0
  .long 0x1a80128, 0x3570305, 0x3d70385, 0x7950715, 0xae50a79, 0xc450af9, 0xcb70c65, 0xc3f0cc5
  .long 0x76afedcb, 0x34521098, 0xcc0ccccc, 0xccccc1cc, 0x3c, 0x20110c, 0x3, 0x0
  .long 0xc1d0c0d, 0xc3d0c2d, 0xc6d0c5d, 0xc8d0c7d, 0xcad0c9d, 0xccb0cbd, 0xced0cdd, 0xc4f0cfd
  .long 0x76afedcb, 0x25341098, 0xcc2ccccc, 0xccccc9cc, 0x2c, 0x22190c, 0x2, 0x0
  .long 0xc1c0c0c, 0xc3c0c2c, 0xc6c0c4c, 0xc8c0c7c, 0xcac0c9c, 0xccc0cbc, 0xcec0cdc, 0xc5f0cfc
  .long 0x76afedcb, 0x4321598, 0xcc0ccccc, 0xccccc1cc, 0xc, 0x20110c, 0x0, 0x0
  .long 0xc1a0c0a, 0xc3a0c2a, 0xc5a0c4a, 0xc8a0c7a, 0xcaa0c9a, 0xcca0cba, 0xcea0cda, 0xc6f0cfa
  .long 0x76afedcb, 0x54321098, 0xcc7ccccc, 0xccccc9cc, 0x57, 0x190c27, 0x5, 0x0
  .long 0x990019, 0x2d50255, 0x4690445, 0x4e904c5, 0x5a50525, 0x8b90839, 0x9880908, 0xc7f0cf6
  .long 0x765fadcb, 0xe4321098, 0xcccccccc, 0xcccccccc, 0xec, 0x2c1c0c, 0xe, 0x0
  .long 0xc130c00, 0xc330c23, 0xc530c43, 0xc730c63, 0xca30c93, 0xcc30cb3, 0xce30cd3, 0xc8f0cf3
  .long 0x765aedcb, 0xf4321098, 0xcc8ccccc, 0xcccccfcc, 0xfc, 0x281f0c, 0xf, 0x0
  .long 0xc110c04, 0xc340c24, 0xc540c44, 0xc740c64, 0xca40c84, 0xcc40cb4, 0xce40cd4, 0xc9f0cf4
  .long 0x765fedcb, 0x943210a8, 0xccbccccc, 0xccccc4cc, 0x9c, 0x2b140c, 0x9, 0x0
  .long 0xc190c09, 0xc390c28, 0xc590c49, 0xc790c69, 0xc990c89, 0xcc90cb9, 0xce90cd9, 0xcaf0cf9
  .long 0xa65fedcb, 0x74321098, 0xcceccccc, 0xccccc1cc, 0x7c, 0x2e110c, 0x7, 0x0
  .long 0xc170c07, 0xc370c27, 0xc570c47, 0xc770c67, 0xc970c87, 0xcc70ca7, 0xce70cd7, 0xcbf0cf7
  .long 0x76afedcb, 0x14523098, 0xcc0ccccc, 0xccccc1cc, 0x1c, 0x20110c, 0x1, 0x0
  .long 0xc1b0c0b, 0xc3b0c2b, 0xc5b0c4b, 0xc7b0c6b, 0xc9b0c8b, 0xcbb0cab, 0xceb0cdb, 0xccf0cfb
  .long 0x76afedcb, 0x45321098, 0xcc2ccccc, 0xccccc9cc, 0x4c, 0x22190c, 0x4, 0x0
  .long 0xc1e0c0e, 0xc3e0c2e, 0xc5c0c4e, 0xc7e0c6e, 0xc9e0c8e, 0xcbe0cae, 0xcee0cce, 0xcdf0cfe
  .long 0x765feacb, 0xd4321098, 0xcc6ccccc, 0xcccccbcc, 0xdc, 0x261b0c, 0xd, 0x0
  .long 0xc120c02, 0xc320c22, 0xc520c42, 0xc720c62, 0xc920c82, 0xcb20ca2, 0xcd20cc2, 0xcef0cf2
  .long 0x75afedcb, 0x64321098, 0xcc7ccccc, 0xccccc9cc, 0x6c, 0x27190c, 0x6, 0x0
  .long 0xc160c06, 0xc360c26, 0xc560c46, 0xc760c66, 0xc960c86, 0xcb60ca6, 0xcd60cc6, 0xcff0ce6
  .long 0x76afedcb, 0x24351098, 0xdd0ddddd, 0xddddd6dd, 0x2d, 0x20160d, 0x2, 0x0
  .long 0xd2c0d1c, 0xd4c0d3c, 0xd6c0d5c, 0xd8b0d7c, 0xdac0d9c, 0xdcc0dbc, 0xdec0ddc, 0xd0f0dfc
  .long 0x56afedcb, 0x74321098, 0xdd6ddddd, 0xddddd3dd, 0x7d, 0x26130d, 0x7, 0x0
  .long 0xd270d07, 0xd470d37, 0xd670d57, 0xd870d77, 0xda70d97, 0xdc70db7, 0xde70dd7, 0xd1f0df7
  .long 0x765aedcb, 0xf4321098, 0xddfddddd, 0xdddddbdd, 0xfd, 0x2f1b0d, 0xf, 0x0
  .long 0xd140d04, 0xd440d34, 0xd640d54, 0xd840d74, 0xda40d94, 0xdc40db4, 0xde40dd4, 0xd2f0df4
  .long 0x76afedcb, 0x94321058, 0xdddddddd, 0xddddd3dd, 0x9d, 0x2d130d, 0x9, 0x0
  .long 0xd190d09, 0xd490d29, 0xd690d59, 0xd890d79, 0xda90d99, 0xdc90db6, 0xde90dd9, 0xd3f0df9
  .long 0x76afedcb, 0x45321098, 0xdd3ddddd, 0xddddd0dd, 0x4d, 0x23100d, 0x4, 0x0
  .long 0xd1e0d0e, 0xd3e0d2e, 0xd6e0d5e, 0xd8e0d7e, 0xdae0d9e, 0xdca0dbe, 0xdee0dde, 0xd4f0dfe
  .long 0x765feadb, 0xc4321098, 0xddaddddd, 0xdddddedd, 0xcd, 0x2a1e0d, 0xc, 0x0
  .long 0xd110d01, 0xd310d21, 0xd610d41, 0xd810d71, 0xda10d91, 0xdc10db1, 0xde10dd1, 0xd5f0df1
  .long 0x765fadce, 0xb4321098, 0xddbddddd, 0xdddddfdd, 0xbd, 0x2b1f0d, 0xb, 0x0
  .long 0xd100d00, 0xd300d20, 0xd500d40, 0xd800d70, 0xda00d90, 0xdc00db0, 0xde00dd0, 0xd6f0df0
  .long 0x765fedcb, 0xa4321098, 0xddfddddd, 0xddddd0dd, 0xa0, 0x2f0d10, 0xa, 0x0
  .long 0xe50065, 0x1950115, 0x2d90259, 0x9850905, 0xba90b29, 0xdc50d45, 0xe350df8, 0xd7f0eb5
  .long 0x76afedcb, 0x14352098, 0xdd0ddddd, 0xddddd6dd, 0x1d, 0x20160d, 0x1, 0x0
  .long 0xd1b0d0b, 0xd3b0d2b, 0xd5b0d4b, 0xd7b0d6b, 0xdab0d9b, 0xdcb0dbb, 0xdeb0ddb, 0xd8f0dfb
  .long 0x76afedcb, 0x54321098, 0xdd6ddddd, 0xddddd3dd, 0x56, 0x130d26, 0x5, 0x0
  .long 0x4750455, 0x4f504d5, 0x7c70747, 0x8a50825, 0xa650a05, 0xb350a85, 0xce50bb5, 0xd9f0d17
  .long 0x76afedcb, 0x34521098, 0xdd2ddddd, 0xddddd8dd, 0x3d, 0x22180d, 0x3, 0x0
  .long 0xd1d0d0d, 0xd3d0d2d, 0xd5d0d4d, 0xd7d0d6d, 0xd9d0d8d, 0xdcd0dbd, 0xded0ddd, 0xdaf0dfd
  .long 0x79afedcb, 0x64321058, 0xdddddddd, 0xddddd3dd, 0x6d, 0x2d130d, 0x6, 0x0
  .long 0xd160d06, 0xd360d26, 0xd560d46, 0xd760d66, 0xd960d86, 0xdc60da6, 0xde60dd6, 0xdbf0df6
  .long 0x76afedcb, 0x5321498, 0xdd3ddddd, 0xddddd0dd, 0xd, 0x23100d, 0x0, 0x0
  .long 0xd1a0d0a, 0xd3a0d2a, 0xd5a0d4a, 0xd7a0d6a, 0xd9a0d8a, 0xdba0daa, 0xdea0dda, 0xdcf0dfa
  .long 0x765feacb, 0xd4321098, 0xddaddddd, 0xdddddedd, 0xdd, 0x2a1e0d, 0xd, 0x0
  .long 0xd120d02, 0xd320d22, 0xd510d42, 0xd720d62, 0xd920d82, 0xdb20da2, 0xde20dc2, 0xddf0df2
  .long 0x765fadcb, 0xe4321098, 0xddbddddd, 0xdddddfdd, 0xed, 0x2b1f0d, 0xe, 0x0
  .long 0xd130d03, 0xd330d23, 0xd530d43, 0xd730d60, 0xd930d83, 0xdb30da3, 0xdd30dc3, 0xdef0df3
  .long 0x765fedcb, 0x8432109a, 0xddfddddd, 0xddddd0dd, 0x8d, 0x2f100d, 0x8, 0x0
  .long 0xd180d08, 0xd380d28, 0xd580d48, 0xd780d68, 0xd980d88, 0xdb80da8, 0xdd80dc8, 0xdff0de8
  .long 0x7a5fedcb, 0x64321098, 0xeefeeeee, 0xeeeee2ee, 0x6e, 0x2f120e, 0x6, 0x0
  .long 0xe260e16, 0xe460e36, 0xe660e56, 0xe860e76, 0xea60e96, 0xec60eb6, 0xee60ed6, 0xe0f0ef6
  .long 0x76afedcb, 0x4351298, 0xee4eeeee, 0xeeeee2ee, 0xe, 0x24120e, 0x0, 0x0
  .long 0xe2a0e0a, 0xe4a0e3a, 0xe6a0e5a, 0xe8a0e7a, 0xeaa0e9a, 0xeca0eba, 0xeea0eda, 0xe1f0efa
  .long 0x76afedcb, 0x45321098, 0xee4eeeee, 0xeeeee9ee, 0x4e, 0x24190e, 0x4, 0x0
  .long 0xe1e0e0e, 0xe4e0e3e, 0xe6e0e5e, 0xe8e0e7e, 0xeab0e9e, 0xece0ebe, 0xeee0ede, 0xe2f0efe
  .long 0x76afedcb, 0x84321095, 0xee5eeeee, 0xeeeee0ee, 0x8e, 0x25100e, 0x8, 0x0
  .long 0xe180e08, 0xe480e28, 0xe680e58, 0xe880e78, 0xea80e98, 0xec80eb7, 0xee80ed8, 0xe3f0ef8
  .long 0x765feadb, 0xc4321098, 0xeeceeeee, 0xeeeeeeee, 0xce, 0x2c1e0e, 0xc, 0x0
  .long 0xe110e01, 0xe310e21, 0xe610e51, 0xe810e71, 0xea10e91, 0xec10eb1, 0xee10ed1, 0xe4f0ef1
  .long 0x76afedcb, 0x34521098, 0xee1eeeee, 0xeeeee3ee, 0x3e, 0x21130e, 0x3, 0x0
  .long 0xe1d0e0d, 0xe3d0e2d, 0xe6d0e4d, 0xe8d0e7d, 0xead0e9d, 0xecd0ebd, 0xeed0edd, 0xe5f0efd
  .long 0x76afedcb, 0x54321098, 0xeedeeeee, 0xeeeee8ee, 0x5d, 0x180e2d, 0x5, 0x0
  .long 0xa50025, 0x7850705, 0x9f90979, 0xad80a58, 0xb950b15, 0xdb90d39, 0xf450ee9, 0xe6f0fc5
  .long 0x765fadce, 0xb4321098, 0xeebeeeee, 0xeeeeebee, 0xbe, 0x2b1b0e, 0xb, 0x0
  .long 0xe100e00, 0xe300e20, 0xe500e40, 0xe800e60, 0xea00e90, 0xec00eb0, 0xee00ed0, 0xe7f0ef0
  .long 0x765fedcb, 0xa4321098, 0xeefeeeee, 0xeeeee2ee, 0xa2, 0x2f0e12, 0xa, 0x0
  .long 0xb80038, 0x3a50325, 0x5e50565, 0xad50a55, 0xbf50b75, 0xe150e06, 0xf490e95, 0xe8f0fc9
  .long 0x76afedcb, 0x24351098, 0xee4eeeee, 0xeeeee2ee, 0x2e, 0x24120e, 0x2, 0x0
  .long 0xe1a0e0c, 0xe3c0e2c, 0xe5c0e4c, 0xe7c0e6c, 0xeac0e8c, 0xecc0ebc, 0xeec0edc, 0xe9f0efc
  .long 0x76afedcb, 0x15324098, 0xee4eeeee, 0xeeeee9ee, 0x1e, 0x24190e, 0x1, 0x0
  .long 0xe1b0e0b, 0xe3b0e2b, 0xe5b0e4b, 0xe7b0e6b, 0xe9b0e8b, 0xecb0ebb, 0xeeb0edb, 0xeaf0efb
  .long 0x86afedcb, 0x74321095, 0xee5eeeee, 0xeeeee0ee, 0x7e, 0x25100e, 0x7, 0x0
  .long 0xe170e07, 0xe370e27, 0xe570e47, 0xe770e67, 0xe970e87, 0xec70ea7, 0xee70ed7, 0xebf0ef7
  .long 0x765feacb, 0xd4321098, 0xeeceeeee, 0xeeeeeeee, 0xde, 0x2c1e0e, 0xd, 0x0
  .long 0xe120e02, 0xe320e22, 0xe520e41, 0xe720e62, 0xe920e82, 0xeb20ea2, 0xee20ed2, 0xecf0ef2
  .long 0x765aedcb, 0xf4321098, 0xee5eeeee, 0xeeeeeaee, 0xfe, 0x251a0e, 0xf, 0x0
  .long 0xe140e04, 0xe340e24, 0xe540e44, 0xe740e64, 0xe940e84, 0xeb40ea4, 0xee40ec4, 0xedf0ef4
  .long 0x76afedcb, 0x94321058, 0xeedeeeee, 0xeeeee8ee, 0x9e, 0x2d180e, 0x9, 0x0
  .long 0xe190e09, 0xe390e29, 0xe590e49, 0xe790e69, 0xe990e89, 0xeb90ea9, 0xed90ec9, 0xeef0ef9
  .long 0x765fadcb, 0xe4321098, 0xeebeeeee, 0xeeeeebee, 0xee, 0x2b1b0e, 0xe, 0x0
  .long 0xe130e03, 0xe330e23, 0xe530e43, 0xe700e63, 0xe930e83, 0xeb30ea3, 0xed30ec3, 0xeff0ee3
  .long 0x76afedcb, 0x34521098, 0xff3fffff, 0xfffff4ff, 0x3f, 0x23140f, 0x3, 0x0
  .long 0xf2d0f1d, 0xf4d0f3d, 0xf6d0f5d, 0xf8b0f7d, 0xfad0f9d, 0xfcd0fbd, 0xfed0fdd, 0xf0f0ffd
  .long 0x76afedcb, 0x25341098, 0xff0fffff, 0xfffff9ff, 0x2f, 0x20190f, 0x2, 0x0
  .long 0xf2c0f0c, 0xf4c0f3c, 0xf6c0f5c, 0xf8c0f7c, 0xfac0f9c, 0xfcc0fbc, 0xfec0fdc, 0xf1f0ffc
  .long 0x76afedcb, 0x4321598, 0xff2fffff, 0xfffff8ff, 0xf, 0x22180f, 0x0, 0x0
  .long 0xf1a0f0a, 0xf4a0f3a, 0xf6a0f5a, 0xf8a0f7a, 0xfaa0f9a, 0xfca0fba, 0xfea0fda, 0xf2f0ffa
  .long 0x86afedcb, 0x74321095, 0xffbfffff, 0xfffff7ff, 0x7f, 0x2b170f, 0x7, 0x0
  .long 0xf170f07, 0xf470f27, 0xf670f57, 0xf870f77, 0xfa70f97, 0xfc70fb7, 0xfe70fd7, 0xf3f0ff7
  .long 0x795fedcb, 0x643210a8, 0xffdfffff, 0xfffff2ff, 0x6f, 0x2d120f, 0x6, 0x0
  .long 0xf160f06, 0xf360f26, 0xf660f56, 0xf860f76, 0xfa60f96, 0xfc60fb6, 0xfe60fd6, 0xf4f0ff6
  .long 0x765feacb, 0xd4321098, 0xffbfffff, 0xfffffdff, 0xdf, 0x2b1d0f, 0xd, 0x0
  .long 0xf120f02, 0xf320f22, 0xf620f42, 0xf820f72, 0xfa20f92, 0xfc20fb2, 0xfe20fd1, 0xf5f0ff2
  .long 0x76afedcb, 0x54321098, 0xffcfffff, 0xfffff5ff, 0x5c, 0x150f2c, 0x5, 0x0
  .long 0x2950215, 0x5b50535, 0x7f90779, 0x9d50955, 0xba50b25, 0xc850c05, 0xec50e45, 0xf6f0fe5
  .long 0x765aedcf, 0xb4321098, 0xff5fffff, 0xfffffcff, 0xbf, 0x251c0f, 0xb, 0x0
  .long 0xf100f00, 0xf300f20, 0xf500f40, 0xf800f60, 0xfa00f90, 0xfc00fb0, 0xfe00fd0, 0xf7f0ff0
  .long 0x76afedcb, 0x14523098, 0xff3fffff, 0xfffff4ff, 0x1f, 0x23140f, 0x1, 0x0
  .long 0xf1b0f0b, 0xf3b0f2b, 0xf5b0f4b, 0xf7b0f6b, 0xfab0f9b, 0xfcb0fbb, 0xfeb0fdb, 0xf8f0ffb
  .long 0x76afedcb, 0x45321098, 0xff0fffff, 0xfffff9ff, 0x4f, 0x20190f, 0x4, 0x0
  .long 0xf1c0f0e, 0xf3e0f2e, 0xf5e0f4e, 0xf7e0f6e, 0xfae0f8e, 0xfce0fbe, 0xfee0fde, 0xf9f0ffe
  .long 0x765fadcb, 0xe4321098, 0xffffffff, 0xfffffbff, 0xef, 0x2f1b0f, 0xe, 0x0
  .long 0xf130f03, 0xf330f23, 0xf530f43, 0xf730f63, 0xf930f83, 0xfc30fb3, 0xfe30fd3, 0xfaf0ff3
  .long 0x76afedcb, 0x84321095, 0xffbfffff, 0xfffff7ff, 0x8f, 0x2b170f, 0x8, 0x0
  .long 0xf180f08, 0xf370f28, 0xf580f48, 0xf780f68, 0xf980f88, 0xfc80fa8, 0xfe80fd8, 0xfbf0ff8
  .long 0x765fedcb, 0x943210a8, 0xffdfffff, 0xfffff2ff, 0x9f, 0x2d120f, 0x9, 0x0
  .long 0xf190f09, 0xf390f29, 0xf590f46, 0xf790f69, 0xf990f89, 0xfb90fa9, 0xfe90fd9, 0xfcf0ff9
  .long 0x765feadb, 0xc4321098, 0xffbfffff, 0xfffffdff, 0xcf, 0x2b1d0f, 0xc, 0x0
  .long 0xf110f01, 0xf310f21, 0xf510f41, 0xf710f61, 0xf910f81, 0xfb10fa1, 0xfe10fc1, 0xfdf0ff1
  .long 0x765fedcb, 0xa4321098, 0xffcfffff, 0xfffff5ff, 0xa5, 0x2c0f15, 0xa, 0x0
  .long 0x2450225, 0x2c502a5, 0x4950415, 0x6550605, 0x6d50685, 0x9750935, 0x9f509b5, 0xfef0f65
  .long 0x765aedcb, 0xf4321098, 0xff5fffff, 0xfffffcff, 0xff, 0x251c0f, 0xf, 0x0
  .long 0xf140f04, 0xf340f24, 0xf540f44, 0xf700f64, 0xf940f84, 0xfb40fa4, 0xfd40fc4, 0xfff0fe4
L_order_end:
.section .rodata,"a"
.p2align 6
.amdhsa_kernel standalone__kv_cache_quant_pre_rope_vs_post_rope__sampling_kernel
  .amdhsa_next_free_vgpr 254
  .amdhsa_next_free_sgpr 102
  .amdhsa_accum_offset 256
  .amdhsa_group_segment_fixed_size 0
  .amdhsa_kernarg_size 112
  .amdhsa_user_sgpr_count 2
  .amdhsa_user_sgpr_kernarg_segment_ptr 1
  .amdhsa_system_sgpr_workgroup_id_x 1
.end_amdhsa_kernel
```
